```python
import torch

def _softmax(x, axis=-1):
    return torch.softmax(x, dim=axis)
def _gelu(x):
    return torch.nn.functional.gelu(x, approximate="tanh")
def _silu(x):
    return torch.nn.functional.silu(x)
def _sigmoid(x):
    return torch.sigmoid(x)
def _layernorm(x, axis=-1, eps=1e-5):
    m = x.mean(dim=axis, keepdim=True)
    v = x.var(dim=axis, keepdim=True, unbiased=False)
    return (x - m) / torch.sqrt(v + eps)
def _scatter_add(tgt, idx, src, axis=0):
    return tgt.clone().index_add_(axis, idx, src)
def _segment_sum(src, seg, n):
    out = torch.zeros((n,) + src.shape[1:], dtype=src.dtype)
    return out.index_add_(0, seg, src)
def _pad(x, pw):
    flat = tuple(v for pair in reversed(pw) for v in pair)
    return torch.nn.functional.pad(x, flat)

kernel_name = 'parallel_sum__ssm_conv_s4d__moe_arch_mod__prompt'

def setup_inputs():

    _w = (lambda a: (lambda t: t.to(torch.bfloat16) if t.is_floating_point() else t)(torch.as_tensor(a)))
    def _A_setup():
        Bsz, L, D, N = 1, 2048, 1024, 128
        return {
            "u": _w((lambda *s: torch.randn(*s, dtype=torch.bfloat16) * 0.05)(Bsz, L, D)),
            "log_A_real": _w((lambda *s: torch.randn(*s, dtype=torch.bfloat16) * 3.2)(D, N) * 0.5),
            "A_imag": _w((lambda *s: torch.randn(*s, dtype=torch.bfloat16) * 0.2)(D, N) * 3.14),
            "C_real": _w((lambda *s: torch.randn(*s, dtype=torch.bfloat16) * 3.2)(D, N) / N ** 0.5),
            "C_imag": _w((lambda *s: torch.randn(*s, dtype=torch.bfloat16) * 3.2)(D, N) / N ** 0.5),
            "log_dt": _w((lambda *s: torch.randn(*s, dtype=torch.bfloat16) * 0.2)(D) * 0.5 - 4.0),
            "D_skip": _w((lambda *s: torch.randn(*s, dtype=torch.bfloat16) * 0.4)(D)),
        }
    _A_in = _A_setup()

    def _B_setup():
        B, S, D, F, C = 1, 2048, 1024, 3584, 8
        return {
            "x": _w((lambda *s: torch.randn(*s, dtype=torch.bfloat16) * 0.05)(B, S, D)),
            "w_r": _w((lambda *s: torch.randn(*s, dtype=torch.bfloat16) * 0.05)(D)),
            "w_gate": _w((lambda *s: torch.randn(*s, dtype=torch.bfloat16) * 0.05)(D, F)),
            "w_up": _w((lambda *s: torch.randn(*s, dtype=torch.bfloat16) * 0.05)(D, F)),
            "w_down": _w((lambda *s: torch.randn(*s, dtype=torch.bfloat16) * 0.05)(F, D)),
        }
    _B_in = _B_setup()

    return {
        "A_u": _A_in["u"],
        "A_log_A_real": _A_in["log_A_real"],
        "A_A_imag": _A_in["A_imag"],
        "A_C_real": _A_in["C_real"],
        "A_C_imag": _A_in["C_imag"],
        "A_log_dt": _A_in["log_dt"],
        "A_D_skip": _A_in["D_skip"],
        "B_x": _B_in["x"],
        "B_w_r": _B_in["w_r"],
        "B_w_gate": _B_in["w_gate"],
        "B_w_up": _B_in["w_up"],
        "B_w_down": _B_in["w_down"],
    }

def reference(A_u, A_log_A_real, A_A_imag, A_C_real, A_C_imag, A_log_dt, A_D_skip, B_x, B_w_r, B_w_gate, B_w_up, B_w_down):
    def _A_ref(u, log_A_real, A_imag, C_real, C_imag, log_dt, D_skip):
        L = u.shape[1]
        dt = torch.exp(log_dt)
        A = -torch.exp(log_A_real) + 1j * A_imag
        C = (C_real + 1j * C_imag) * dt[:, None]
        pos = (lambda x, dt: x.to(dt))(torch.arange(L), log_dt.dtype)
        P = torch.exp((A * dt[:, None])[:, :, None] * pos[None, None, :])
        K = 2.0 * torch.einsum("dn,dnl->dl", C, P).real
        L2 = 2 * L
        u_t = (lambda x, *d: x.permute(*d))(u, 0, 2, 1)
        Kf = (lambda x, *a, **k: torch.fft.rfft(x.float(), *a, **k))(K, L2)
        Uf = (lambda x, *a, **k: torch.fft.rfft(x.float(), *a, **k))(u_t, L2)
        y = (lambda x, *a, **k: torch.fft.irfft(x, *a, **k).to(torch.bfloat16))(Uf * Kf[None, :, :], L2)[:, :, :L]
        y = (lambda x, *d: x.permute(*d))(y, 0, 2, 1)
        return y + u * D_skip[None, None, :]

    def _B_ref(x, w_r, w_gate, w_up, w_down):
        B, S, D = x.shape
        C = 8
        r = x @ w_r
        idx = torch.argsort(-r, axis=-1)[:, :C]
        idx_e = (lambda x, n, axis: torch.repeat_interleave(x, n, dim=axis))(idx.reshape(B, C, 1), D, axis=2)
        x_sel = (lambda x, i, axis: torch.take_along_dim(x, i, dim=axis))(x, idx_e, axis=1)
        g = _silu(x_sel @ w_gate)
        u = x_sel @ w_up
        y = (g * u) @ w_down
        r_sel = _sigmoid((lambda x, i, axis: torch.take_along_dim(x, i, dim=axis))(r, idx, axis=1))
        y = y * r_sel.reshape(B, C, 1)
        b_off = (torch.arange(B) * S).reshape(B, 1)
        flat_idx = (idx + b_off).reshape(B * C)
        zero = (x * 0.0).reshape(B * S, D)
        upd = _scatter_add(zero, flat_idx, y.reshape(B * C, D), axis=0)
        return x + upd.reshape(B, S, D)

    x = A_u
    xn = _layernorm(x, axis=-1)
    return x + _A_ref(xn, A_log_A_real, A_A_imag, A_C_real, A_C_imag, A_log_dt, A_D_skip) + _B_ref(xn, B_w_r, B_w_gate, B_w_up, B_w_down)
```

```asm
; @launch kernel=ln_kernel grid=(256,1,1) block=(256,1,1) lds=0
; @launch kernel=conv_kernel grid=(256,1,1) block=(256,1,1) lds=68864
; @launch kernel=ffn_kernel grid=(224,1,1) block=(256,1,1) lds=106496
; @launch kernel=fix_kernel grid=(256,1,1) block=(256,1,1) lds=512
.amdgcn_target "amdgcn-amd-amdhsa--gfx950"
.text
.globl ln_kernel
.p2align 8
.type ln_kernel,@function
ln_kernel:
    s_cmp_ge_u32 s2, 256
    s_cbranch_scc1 ln_kernel_end
    s_load_dwordx2 s[4:5], s[0:1], 0
    s_load_dwordx2 s[8:9], s[0:1], 64
    s_load_dwordx2 s[12:13], s[0:1], 112
    v_and_b32 v1, 63, v0
    v_lshrrev_b32 v2, 6, v0
    s_lshl_b32 s3, s2, 14
    v_lshlrev_b32 v3, 12, v2
    v_lshlrev_b32 v28, 4, v1
    v_add3_u32 v3, v3, v28, s3
    s_waitcnt lgkmcnt(0)
    s_mov_b32 s6, 4194304
    s_mov_b32 s7, 0x00020000
    s_mov_b32 s10, 2048
    s_mov_b32 s11, 0x00020000
    s_mov_b32 s14, 16384
    s_mov_b32 s15, 0x00020000
    buffer_load_dwordx4 v[4:7], v3, s[4:7], 0 offen offset:0
    buffer_load_dwordx4 v[8:11], v3, s[4:7], 0 offen offset:1024
    buffer_load_dwordx4 v[12:15], v3, s[4:7], 0 offen offset:2048
    buffer_load_dwordx4 v[16:19], v3, s[4:7], 0 offen offset:3072
    buffer_load_dwordx4 v[20:23], v28, s[8:11], 0 offen offset:0
    buffer_load_dwordx4 v[24:27], v28, s[8:11], 0 offen offset:1024
    s_waitcnt vmcnt(4)
    v_lshlrev_b32 v48, 16, v4
    v_and_b32 v49, 0xffff0000, v4
    v_lshlrev_b32 v50, 16, v5
    v_and_b32 v51, 0xffff0000, v5
    v_lshlrev_b32 v52, 16, v6
    v_and_b32 v53, 0xffff0000, v6
    v_lshlrev_b32 v54, 16, v7
    v_and_b32 v55, 0xffff0000, v7
    v_lshlrev_b32 v56, 16, v8
    v_and_b32 v57, 0xffff0000, v8
    v_lshlrev_b32 v58, 16, v9
    v_and_b32 v59, 0xffff0000, v9
    v_lshlrev_b32 v60, 16, v10
    v_and_b32 v61, 0xffff0000, v10
    v_lshlrev_b32 v62, 16, v11
    v_and_b32 v63, 0xffff0000, v11
    s_waitcnt vmcnt(2)
    v_lshlrev_b32 v64, 16, v12
    v_and_b32 v65, 0xffff0000, v12
    v_lshlrev_b32 v66, 16, v13
    v_and_b32 v67, 0xffff0000, v13
    v_lshlrev_b32 v68, 16, v14
    v_and_b32 v69, 0xffff0000, v14
    v_lshlrev_b32 v70, 16, v15
    v_and_b32 v71, 0xffff0000, v15
    v_lshlrev_b32 v72, 16, v16
    v_and_b32 v73, 0xffff0000, v16
    v_lshlrev_b32 v74, 16, v17
    v_and_b32 v75, 0xffff0000, v17
    v_lshlrev_b32 v76, 16, v18
    v_and_b32 v77, 0xffff0000, v18
    v_lshlrev_b32 v78, 16, v19
    v_and_b32 v79, 0xffff0000, v19
    v_readfirstlane_b32 s16, v48
    v_readfirstlane_b32 s17, v64
    s_waitcnt vmcnt(0)
    v_lshlrev_b32 v32, 16, v20
    v_and_b32 v33, 0xffff0000, v20
    v_lshlrev_b32 v34, 16, v21
    v_and_b32 v35, 0xffff0000, v21
    v_lshlrev_b32 v36, 16, v22
    v_and_b32 v37, 0xffff0000, v22
    v_lshlrev_b32 v38, 16, v23
    v_and_b32 v39, 0xffff0000, v23
    v_lshlrev_b32 v40, 16, v24
    v_and_b32 v41, 0xffff0000, v24
    v_lshlrev_b32 v42, 16, v25
    v_and_b32 v43, 0xffff0000, v25
    v_lshlrev_b32 v44, 16, v26
    v_and_b32 v45, 0xffff0000, v26
    v_lshlrev_b32 v46, 16, v27
    v_and_b32 v47, 0xffff0000, v27
    v_pk_add_f32 v[48:49], v[48:49], s[16:17] op_sel:[0,0] op_sel_hi:[1,0] neg_lo:[0,1] neg_hi:[0,1]
    v_pk_add_f32 v[64:65], v[64:65], s[16:17] op_sel:[0,1] op_sel_hi:[1,1] neg_lo:[0,1] neg_hi:[0,1]
    v_pk_add_f32 v[50:51], v[50:51], s[16:17] op_sel:[0,0] op_sel_hi:[1,0] neg_lo:[0,1] neg_hi:[0,1]
    v_pk_add_f32 v[66:67], v[66:67], s[16:17] op_sel:[0,1] op_sel_hi:[1,1] neg_lo:[0,1] neg_hi:[0,1]
    v_pk_add_f32 v[52:53], v[52:53], s[16:17] op_sel:[0,0] op_sel_hi:[1,0] neg_lo:[0,1] neg_hi:[0,1]
    v_pk_add_f32 v[68:69], v[68:69], s[16:17] op_sel:[0,1] op_sel_hi:[1,1] neg_lo:[0,1] neg_hi:[0,1]
    v_pk_add_f32 v[54:55], v[54:55], s[16:17] op_sel:[0,0] op_sel_hi:[1,0] neg_lo:[0,1] neg_hi:[0,1]
    v_pk_add_f32 v[70:71], v[70:71], s[16:17] op_sel:[0,1] op_sel_hi:[1,1] neg_lo:[0,1] neg_hi:[0,1]
    v_pk_add_f32 v[56:57], v[56:57], s[16:17] op_sel:[0,0] op_sel_hi:[1,0] neg_lo:[0,1] neg_hi:[0,1]
    v_pk_add_f32 v[72:73], v[72:73], s[16:17] op_sel:[0,1] op_sel_hi:[1,1] neg_lo:[0,1] neg_hi:[0,1]
    v_pk_add_f32 v[58:59], v[58:59], s[16:17] op_sel:[0,0] op_sel_hi:[1,0] neg_lo:[0,1] neg_hi:[0,1]
    v_pk_add_f32 v[74:75], v[74:75], s[16:17] op_sel:[0,1] op_sel_hi:[1,1] neg_lo:[0,1] neg_hi:[0,1]
    v_pk_add_f32 v[60:61], v[60:61], s[16:17] op_sel:[0,0] op_sel_hi:[1,0] neg_lo:[0,1] neg_hi:[0,1]
    v_pk_add_f32 v[76:77], v[76:77], s[16:17] op_sel:[0,1] op_sel_hi:[1,1] neg_lo:[0,1] neg_hi:[0,1]
    v_pk_add_f32 v[62:63], v[62:63], s[16:17] op_sel:[0,0] op_sel_hi:[1,0] neg_lo:[0,1] neg_hi:[0,1]
    v_pk_add_f32 v[78:79], v[78:79], s[16:17] op_sel:[0,1] op_sel_hi:[1,1] neg_lo:[0,1] neg_hi:[0,1]
    v_pk_add_f32 v[80:81], v[48:49], v[50:51]
    v_pk_add_f32 v[82:83], v[64:65], v[66:67]
    v_pk_add_f32 v[92:93], v[32:33], v[34:35]
    v_pk_mul_f32 v[84:85], v[48:49], v[48:49]
    v_pk_mul_f32 v[86:87], v[64:65], v[64:65]
    v_pk_mul_f32 v[88:89], v[48:49], v[32:33]
    v_pk_mul_f32 v[90:91], v[64:65], v[32:33]
    v_pk_fma_f32 v[84:85], v[50:51], v[50:51], v[84:85]
    v_pk_fma_f32 v[86:87], v[66:67], v[66:67], v[86:87]
    v_pk_fma_f32 v[88:89], v[50:51], v[34:35], v[88:89]
    v_pk_fma_f32 v[90:91], v[66:67], v[34:35], v[90:91]
    v_pk_add_f32 v[80:81], v[80:81], v[52:53]
    v_pk_add_f32 v[82:83], v[82:83], v[68:69]
    v_pk_add_f32 v[92:93], v[92:93], v[36:37]
    v_pk_fma_f32 v[84:85], v[52:53], v[52:53], v[84:85]
    v_pk_fma_f32 v[86:87], v[68:69], v[68:69], v[86:87]
    v_pk_fma_f32 v[88:89], v[52:53], v[36:37], v[88:89]
    v_pk_fma_f32 v[90:91], v[68:69], v[36:37], v[90:91]
    v_pk_add_f32 v[80:81], v[80:81], v[54:55]
    v_pk_add_f32 v[82:83], v[82:83], v[70:71]
    v_pk_add_f32 v[92:93], v[92:93], v[38:39]
    v_pk_fma_f32 v[84:85], v[54:55], v[54:55], v[84:85]
    v_pk_fma_f32 v[86:87], v[70:71], v[70:71], v[86:87]
    v_pk_fma_f32 v[88:89], v[54:55], v[38:39], v[88:89]
    v_pk_fma_f32 v[90:91], v[70:71], v[38:39], v[90:91]
    v_pk_add_f32 v[80:81], v[80:81], v[56:57]
    v_pk_add_f32 v[82:83], v[82:83], v[72:73]
    v_pk_add_f32 v[92:93], v[92:93], v[40:41]
    v_pk_fma_f32 v[84:85], v[56:57], v[56:57], v[84:85]
    v_pk_fma_f32 v[86:87], v[72:73], v[72:73], v[86:87]
    v_pk_fma_f32 v[88:89], v[56:57], v[40:41], v[88:89]
    v_pk_fma_f32 v[90:91], v[72:73], v[40:41], v[90:91]
    v_pk_add_f32 v[80:81], v[80:81], v[58:59]
    v_pk_add_f32 v[82:83], v[82:83], v[74:75]
    v_pk_add_f32 v[92:93], v[92:93], v[42:43]
    v_pk_fma_f32 v[84:85], v[58:59], v[58:59], v[84:85]
    v_pk_fma_f32 v[86:87], v[74:75], v[74:75], v[86:87]
    v_pk_fma_f32 v[88:89], v[58:59], v[42:43], v[88:89]
    v_pk_fma_f32 v[90:91], v[74:75], v[42:43], v[90:91]
    v_pk_add_f32 v[80:81], v[80:81], v[60:61]
    v_pk_add_f32 v[82:83], v[82:83], v[76:77]
    v_pk_add_f32 v[92:93], v[92:93], v[44:45]
    v_pk_fma_f32 v[84:85], v[60:61], v[60:61], v[84:85]
    v_pk_fma_f32 v[86:87], v[76:77], v[76:77], v[86:87]
    v_pk_fma_f32 v[88:89], v[60:61], v[44:45], v[88:89]
    v_pk_fma_f32 v[90:91], v[76:77], v[44:45], v[90:91]
    v_pk_add_f32 v[80:81], v[80:81], v[62:63]
    v_pk_add_f32 v[82:83], v[82:83], v[78:79]
    v_pk_add_f32 v[92:93], v[92:93], v[46:47]
    v_pk_fma_f32 v[84:85], v[62:63], v[62:63], v[84:85]
    v_pk_fma_f32 v[86:87], v[78:79], v[78:79], v[86:87]
    v_pk_fma_f32 v[88:89], v[62:63], v[46:47], v[88:89]
    v_pk_fma_f32 v[90:91], v[78:79], v[46:47], v[90:91]
    v_add_f32 v80, v80, v81
    v_add_f32 v82, v82, v83
    v_add_f32 v84, v84, v85
    v_add_f32 v86, v86, v87
    v_add_f32 v88, v88, v89
    v_add_f32 v90, v90, v91
    v_add_f32 v92, v92, v93
    v_mov_b32 v93, v92
    v_permlane32_swap_b32 v80, v82
    v_permlane32_swap_b32 v84, v86
    v_permlane32_swap_b32 v88, v90
    v_permlane32_swap_b32 v92, v93
    v_add_f32 v80, v80, v82
    v_add_f32 v84, v84, v86
    v_add_f32 v88, v88, v90
    v_add_f32 v92, v92, v93
    v_add_f32_dpp v80, v80, v80 row_ror:8 row_mask:0xf bank_mask:0xf
    v_add_f32_dpp v84, v84, v84 row_ror:8 row_mask:0xf bank_mask:0xf
    v_add_f32_dpp v88, v88, v88 row_ror:8 row_mask:0xf bank_mask:0xf
    v_add_f32_dpp v92, v92, v92 row_ror:8 row_mask:0xf bank_mask:0xf
    v_add_f32_dpp v80, v80, v80 row_ror:4 row_mask:0xf bank_mask:0xf
    v_add_f32_dpp v84, v84, v84 row_ror:4 row_mask:0xf bank_mask:0xf
    v_add_f32_dpp v88, v88, v88 row_ror:4 row_mask:0xf bank_mask:0xf
    v_add_f32_dpp v92, v92, v92 row_ror:4 row_mask:0xf bank_mask:0xf
    v_add_f32_dpp v80, v80, v80 row_ror:2 row_mask:0xf bank_mask:0xf
    v_add_f32_dpp v84, v84, v84 row_ror:2 row_mask:0xf bank_mask:0xf
    v_add_f32_dpp v88, v88, v88 row_ror:2 row_mask:0xf bank_mask:0xf
    v_add_f32_dpp v92, v92, v92 row_ror:2 row_mask:0xf bank_mask:0xf
    v_add_f32_dpp v80, v80, v80 row_ror:1 row_mask:0xf bank_mask:0xf
    v_add_f32_dpp v84, v84, v84 row_ror:1 row_mask:0xf bank_mask:0xf
    v_add_f32_dpp v88, v88, v88 row_ror:1 row_mask:0xf bank_mask:0xf
    v_add_f32_dpp v92, v92, v92 row_ror:1 row_mask:0xf bank_mask:0xf
    v_mov_b32 v81, v80
    v_mov_b32 v85, v84
    v_mov_b32 v89, v88
    v_mov_b32 v93, v92
    v_permlane16_swap_b32 v80, v81
    v_permlane16_swap_b32 v84, v85
    v_permlane16_swap_b32 v88, v89
    v_permlane16_swap_b32 v92, v93
    v_add_f32 v80, v80, v81
    v_add_f32 v84, v84, v85
    v_add_f32 v88, v88, v89
    v_add_f32 v92, v92, v93
    v_cmp_gt_u32 vcc, 32, v1
    v_mov_b32 v40, s17
    v_mov_b32 v44, s16
    v_cndmask_b32 v40, v40, v44, vcc
    v_mul_f32 v41, 0x3a800000, v80
    v_mul_f32 v43, 0x3a800000, v84
    v_add_f32 v42, v40, v41
    v_fma_f32 v43, -v41, v41, v43
    v_max_f32 v43, 0, v43
    v_cvt_pk_bf16_f32 v42, v42, v43
    v_and_b32 v43, 0xffff0000, v42
    v_lshlrev_b32 v45, 16, v42
    v_add_f32 v43, 0x3727c5ac, v43
    v_cvt_pk_bf16_f32 v43, v43, v43
    v_and_b32 v43, 0xffff0000, v43
    v_sqrt_f32 v43, v43
    v_sub_f32 v44, v40, v45
    v_cvt_pk_bf16_f32 v50, v45, v43
    v_and_b32 v43, 0xffff0000, v50
    v_rcp_f32 v46, v43
    v_fma_f32 v44, v44, v92, v88
    v_mul_f32 v44, v44, v46
    v_cvt_pk_bf16_f32 v51, v44, 0
    v_lshrrev_b32 v4, 5, v0
    s_lshl_b32 s3, s2, 6
    v_lshl_add_u32 v4, v4, 3, s3
    s_mov_b32 exec_lo, 1
    s_mov_b32 exec_hi, 1
    buffer_store_dwordx2 v[50:51], v4, s[12:15], 0 offen
ln_kernel_end:
    s_endpgm
.text
.globl conv_kernel
.p2align 8
.type conv_kernel,@function
conv_kernel:
    s_cmp_ge_u32 s2, 256
    s_cbranch_scc1 conv_kernel_end
    s_load_dwordx2 s[4:5], s[0:1], 0
    s_load_dwordx2 s[8:9], s[0:1], 8
    s_load_dwordx2 s[12:13], s[0:1], 16
    s_load_dwordx2 s[16:17], s[0:1], 24
    s_load_dwordx2 s[20:21], s[0:1], 32
    s_load_dwordx2 s[24:25], s[0:1], 40
    s_load_dwordx2 s[28:29], s[0:1], 48
    s_load_dwordx2 s[32:33], s[0:1], 96
    s_load_dwordx2 s[36:37], s[0:1], 112
    s_and_b32 s44, s2, 7
    s_lshl_b32 s44, s44, 5
    s_lshr_b32 s3, s2, 3
    s_add_u32 s44, s44, s3
    v_and_b32 v1, 63, v0
    v_and_b32 v2, 15, v0
    v_bfe_u32 v3, v0, 4, 2
    v_lshrrev_b32 v4, 6, v0
    s_nop 0
    v_readfirstlane_b32 s45, v4
    s_mov_b32 s40, 0x3fb8aa3b
    s_mov_b32 s41, 0x32a57060
    s_lshl_b32 s46, s44, 2
    s_add_u32 s46, s46, s45
    s_lshl_b32 s47, s46, 8
    s_lshl_b32 s48, s46, 1
    s_lshl_b32 s49, s44, 3
    v_lshl_add_u32 v4, v1, 2, s47
    v_mov_b32 v5, s48
    v_mov_b32 v6, s49
    v_lshlrev_b32 v7, 14, v0
    v_add_u32 v7, s49, v7
    v_lshlrev_b32 v8, 6, v0
    s_mov_b32 s53, 4096
    s_mov_b32 s54, 8192
    s_mov_b32 s55, 12288
    s_waitcnt lgkmcnt(0)
    s_mov_b32 s6, 4194304
    s_mov_b32 s7, 0x00020000
    s_mov_b32 s10, 262144
    s_mov_b32 s11, 0x00020000
    s_mov_b32 s14, 262144
    s_mov_b32 s15, 0x00020000
    s_mov_b32 s18, 262144
    s_mov_b32 s19, 0x00020000
    s_mov_b32 s22, 262144
    s_mov_b32 s23, 0x00020000
    s_mov_b32 s26, 2048
    s_mov_b32 s27, 0x00020000
    s_mov_b32 s30, 2048
    s_mov_b32 s31, 0x00020000
    s_mov_b32 s34, 4194304
    s_mov_b32 s35, 0x00020000
    s_mov_b32 s38, 16384
    s_mov_b32 s39, 0x00020000
    buffer_load_ushort v15, v5, s[24:27], 0 offen
    buffer_load_dword v16, v4, s[8:11], 0 offen
    buffer_load_dword v17, v4, s[12:15], 0 offen
    buffer_load_dword v18, v4, s[16:19], 0 offen
    buffer_load_dword v19, v4, s[20:23], 0 offen
    buffer_load_dwordx2 v[236:237], v6, s[28:31], 0 offen
    buffer_load_dwordx2 v[240:241], v7, s[4:7], 0 offen offset:0
    buffer_load_dwordx2 v[242:243], v7, s[4:7], 0 offen offset:2048
    buffer_load_dwordx2 v[244:245], v7, s[4:7], s53 offen offset:0
    buffer_load_dwordx2 v[246:247], v7, s[4:7], s53 offen offset:2048
    buffer_load_dwordx2 v[248:249], v7, s[4:7], s54 offen offset:0
    buffer_load_dwordx2 v[250:251], v7, s[4:7], s54 offen offset:2048
    buffer_load_dwordx2 v[252:253], v7, s[4:7], s55 offen offset:0
    buffer_load_dwordx2 v[254:255], v7, s[4:7], s55 offen offset:2048
    buffer_load_dwordx4 v[144:147], v8, s[36:39], 0 offen offset:0
    buffer_load_dwordx4 v[148:151], v8, s[36:39], 0 offen offset:16
    buffer_load_dwordx4 v[152:155], v8, s[36:39], 0 offen offset:32
    buffer_load_dwordx4 v[156:159], v8, s[36:39], 0 offen offset:48
    v_lshlrev_b32 v4, 3, v3
    v_sub_u32 v4, v4, v2
    v_add_u32 v4, 15, v4
    v_min_u32 v4, 31, v4
    s_mov_b32 s43, 0x3e00000
    v_lshrrev_b32 v5, v4, s43
    v_bfe_i32 v6, v5, 0, 1
    v_bfe_i32 v7, v5, 1, 1
    v_and_b32 v6, 0x3f80, v6
    v_and_b32 v7, 0x3f800000, v7
    v_or_b32 v128, v6, v7
    v_bfe_i32 v6, v5, 2, 1
    v_bfe_i32 v7, v5, 3, 1
    v_and_b32 v6, 0x3f80, v6
    v_and_b32 v7, 0x3f800000, v7
    v_or_b32 v129, v6, v7
    v_bfe_i32 v6, v5, 4, 1
    v_bfe_i32 v7, v5, 5, 1
    v_and_b32 v6, 0x3f80, v6
    v_and_b32 v7, 0x3f800000, v7
    v_or_b32 v130, v6, v7
    v_bfe_i32 v6, v5, 6, 1
    v_bfe_i32 v7, v5, 7, 1
    v_and_b32 v6, 0x3f80, v6
    v_and_b32 v7, 0x3f800000, v7
    v_or_b32 v131, v6, v7
    s_mov_b32 s43, 0x1c0000
    v_lshrrev_b32 v5, v4, s43
    v_bfe_i32 v6, v5, 0, 1
    v_bfe_i32 v7, v5, 1, 1
    v_and_b32 v6, 0x3f80, v6
    v_and_b32 v7, 0x3f800000, v7
    v_or_b32 v132, v6, v7
    v_bfe_i32 v6, v5, 2, 1
    v_bfe_i32 v7, v5, 3, 1
    v_and_b32 v6, 0x3f80, v6
    v_and_b32 v7, 0x3f800000, v7
    v_or_b32 v133, v6, v7
    v_bfe_i32 v6, v5, 4, 1
    v_bfe_i32 v7, v5, 5, 1
    v_and_b32 v6, 0x3f80, v6
    v_and_b32 v7, 0x3f800000, v7
    v_or_b32 v134, v6, v7
    v_bfe_i32 v6, v5, 6, 1
    v_bfe_i32 v7, v5, 7, 1
    v_and_b32 v6, 0x3f80, v6
    v_and_b32 v7, 0x3f800000, v7
    v_or_b32 v135, v6, v7
    s_mov_b32 s43, 0xff80000
    v_lshrrev_b32 v5, v4, s43
    v_bfe_i32 v6, v5, 0, 1
    v_bfe_i32 v7, v5, 1, 1
    v_and_b32 v6, 0x3f80, v6
    v_and_b32 v7, 0x3f800000, v7
    v_or_b32 v136, v6, v7
    v_bfe_i32 v6, v5, 2, 1
    v_bfe_i32 v7, v5, 3, 1
    v_and_b32 v6, 0x3f80, v6
    v_and_b32 v7, 0x3f800000, v7
    v_or_b32 v137, v6, v7
    v_bfe_i32 v6, v5, 4, 1
    v_bfe_i32 v7, v5, 5, 1
    v_and_b32 v6, 0x3f80, v6
    v_and_b32 v7, 0x3f800000, v7
    v_or_b32 v138, v6, v7
    v_bfe_i32 v6, v5, 6, 1
    v_bfe_i32 v7, v5, 7, 1
    v_and_b32 v6, 0x3f80, v6
    v_and_b32 v7, 0x3f800000, v7
    v_or_b32 v139, v6, v7
    s_mov_b32 s43, 0x7f00000
    v_lshrrev_b32 v5, v4, s43
    v_bfe_i32 v6, v5, 0, 1
    v_bfe_i32 v7, v5, 1, 1
    v_and_b32 v6, 0x3f80, v6
    v_and_b32 v7, 0x3f800000, v7
    v_or_b32 v140, v6, v7
    v_bfe_i32 v6, v5, 2, 1
    v_bfe_i32 v7, v5, 3, 1
    v_and_b32 v6, 0x3f80, v6
    v_and_b32 v7, 0x3f800000, v7
    v_or_b32 v141, v6, v7
    v_bfe_i32 v6, v5, 4, 1
    v_bfe_i32 v7, v5, 5, 1
    v_and_b32 v6, 0x3f80, v6
    v_and_b32 v7, 0x3f800000, v7
    v_or_b32 v142, v6, v7
    v_bfe_i32 v6, v5, 6, 1
    v_bfe_i32 v7, v5, 7, 1
    v_and_b32 v6, 0x3f80, v6
    v_and_b32 v7, 0x3f800000, v7
    v_or_b32 v143, v6, v7
    s_mov_b32 s43, 0x18000000
    v_lshrrev_b32 v5, v4, s43
    v_bfe_i32 v6, v5, 0, 1
    v_bfe_i32 v7, v5, 1, 1
    v_and_b32 v6, 0xffff, v6
    v_and_b32 v7, 0xffff0000, v7
    v_or_b32 v124, v6, v7
    v_bfe_i32 v6, v5, 2, 1
    v_bfe_i32 v7, v5, 3, 1
    v_and_b32 v6, 0xffff, v6
    v_and_b32 v7, 0xffff0000, v7
    v_or_b32 v125, v6, v7
    v_bfe_i32 v6, v5, 4, 1
    v_bfe_i32 v7, v5, 5, 1
    v_and_b32 v6, 0xffff, v6
    v_and_b32 v7, 0xffff0000, v7
    v_or_b32 v126, v6, v7
    v_bfe_i32 v6, v5, 6, 1
    v_bfe_i32 v7, v5, 7, 1
    v_and_b32 v6, 0xffff, v6
    v_and_b32 v7, 0xffff0000, v7
    v_or_b32 v127, v6, v7
    s_mul_i32 s50, s45, 8448
    s_add_u32 s50, s50, 35072
    v_mov_b32 v4, s50
    v_lshl_add_u32 v5, v1, 3, s50
    v_mul_u32_u24 v6, 528, v2
    v_and_b32 v10, 1, v3
    v_lshl_add_u32 v6, v10, 8, v6
    v_lshrrev_b32 v10, 1, v3
    v_lshl_add_u32 v6, v10, 4, v6
    v_add_u32 v6, s50, v6
    s_mul_i32 s51, s45, 4608
    v_lshlrev_b32 v10, 5, v2
    v_lshl_add_u32 v7, v3, 4, v10
    v_add3_u32 v7, v7, s51, 32
    s_mul_i32 s52, s45, 4160
    s_add_u32 s52, s52, 18432
    v_lshl_add_u32 v8, v3, 3, v10
    v_add_u32 v8, s52, v8
    v_lshlrev_b32 v9, 4, v0
    v_mov_b32 v12, 0
    v_mov_b32 v13, 0
    v_lshl_add_u32 v10, v1, 3, s51
    ds_write_b64 v10, v[12:13]
    s_waitcnt vmcnt(13)
    v_lshlrev_b32 v15, 16, v15
    v_mul_f32 v64, s40, v15
    v_fma_f32 v65, v15, s40, -v64
    v_fma_f32 v65, v15, s41, v65
    v_exp_f32 v76, v64
    v_mul_f32 v65, 0x3f317218, v65
    v_fma_f32 v76, v76, v65, v76
    v_cvt_pk_bf16_f32 v76, v76, v76
    v_and_b32 v76, 0xffff0000, v76
    v_lshlrev_b32 v66, 16, v16
    v_mul_f32 v64, s40, v66
    v_fma_f32 v65, v66, s40, -v64
    v_fma_f32 v65, v66, s41, v65
    v_exp_f32 v72, v64
    v_mul_f32 v65, 0x3f317218, v65
    v_fma_f32 v72, v72, v65, v72
    v_lshlrev_b32 v74, 16, v17
    v_lshlrev_b32 v32, 16, v18
    v_lshlrev_b32 v33, 16, v19
    v_and_b32 v66, 0xffff0000, v16
    v_mul_f32 v64, s40, v66
    v_fma_f32 v65, v66, s40, -v64
    v_fma_f32 v65, v66, s41, v65
    v_exp_f32 v73, v64
    v_mul_f32 v65, 0x3f317218, v65
    v_fma_f32 v73, v73, v65, v73
    v_and_b32 v75, 0xffff0000, v17
    v_and_b32 v34, 0xffff0000, v18
    v_and_b32 v35, 0xffff0000, v19
    v_cvt_pk_bf16_f32 v64, v72, v73
    v_lshlrev_b32 v72, 16, v64
    v_and_b32 v73, 0xffff0000, v64
    v_add_f32 v77, v76, v76
    v_mul_f32 v72, v72, v76
    v_mul_f32 v74, v74, v76
    v_pk_mul_f32 v[32:33], v[32:33], v[76:77] op_sel:[0,1] op_sel_hi:[1,1]
    v_mul_f32 v72, 0xbfb8aa3b, v72
    v_mul_f32 v74, 0.15915494, v74
    v_mul_f32 v73, v73, v76
    v_mul_f32 v75, v75, v76
    v_pk_mul_f32 v[34:35], v[34:35], v[76:77] op_sel:[0,1] op_sel_hi:[1,1]
    v_mul_f32 v73, 0xbfb8aa3b, v73
    v_mul_f32 v75, 0.15915494, v75
    v_mul_f32 v64, 0x3f800000, v72
    v_mul_f32 v65, 0x3f800000, v74
    v_exp_f32 v64, v64
    v_fract_f32 v65, v65
    v_cos_f32 v20, v65
    v_sin_f32 v21, v65
    s_nop 0
    v_pk_mul_f32 v[20:21], v[20:21], v[64:65] op_sel:[0,0] op_sel_hi:[1,0]
    v_mul_f32 v68, 0x3f800000, v73
    v_mul_f32 v69, 0x3f800000, v75
    v_exp_f32 v68, v68
    v_fract_f32 v69, v69
    v_cos_f32 v22, v69
    v_sin_f32 v23, v69
    s_nop 0
    v_pk_mul_f32 v[22:23], v[22:23], v[68:69] op_sel:[0,0] op_sel_hi:[1,0]
    v_mul_f32 v64, 0x41000000, v72
    v_mul_f32 v65, 0x41000000, v74
    v_exp_f32 v64, v64
    v_fract_f32 v65, v65
    v_cos_f32 v24, v65
    v_sin_f32 v25, v65
    s_nop 0
    v_pk_mul_f32 v[24:25], v[24:25], v[64:65] op_sel:[0,0] op_sel_hi:[1,0] neg_hi:[1,0]
    v_mul_f32 v68, 0x41000000, v73
    v_mul_f32 v69, 0x41000000, v75
    v_exp_f32 v68, v68
    v_fract_f32 v69, v69
    v_cos_f32 v26, v69
    v_sin_f32 v27, v69
    s_nop 0
    v_pk_mul_f32 v[26:27], v[26:27], v[68:69] op_sel:[0,0] op_sel_hi:[1,0] neg_hi:[1,0]
    v_mul_f32 v64, 0x43000000, v72
    v_mul_f32 v65, 0x43000000, v74
    v_exp_f32 v64, v64
    v_fract_f32 v65, v65
    v_cos_f32 v28, v65
    v_sin_f32 v29, v65
    s_nop 0
    v_pk_mul_f32 v[28:29], v[28:29], v[64:65] op_sel:[0,0] op_sel_hi:[1,0]
    v_mul_f32 v68, 0x43000000, v73
    v_mul_f32 v69, 0x43000000, v75
    v_exp_f32 v68, v68
    v_fract_f32 v69, v69
    v_cos_f32 v30, v69
    v_sin_f32 v31, v69
    s_nop 0
    v_pk_mul_f32 v[30:31], v[30:31], v[68:69] op_sel:[0,0] op_sel_hi:[1,0]
    v_mov_b32 v68, 0x3f80
    v_mov_b32 v69, 0x3f80
    ds_write_b64 v5, v[68:69] offset:0
    v_cvt_pk_bf16_f32 v70, v24, v25
    v_cvt_pk_bf16_f32 v71, v26, v27
    ds_write_b64 v5, v[70:71] offset:528
    v_pk_mul_f32 v[64:65], v[24:25], v[24:25] op_sel:[1,1] op_sel_hi:[1,0] neg_lo:[1,0]
    v_pk_mul_f32 v[66:67], v[26:27], v[26:27] op_sel:[1,1] op_sel_hi:[1,0] neg_lo:[1,0]
    v_pk_fma_f32 v[12:13], v[24:25], v[24:25], v[64:65] op_sel:[0,0,0] op_sel_hi:[0,1,1]
    v_pk_fma_f32 v[14:15], v[26:27], v[26:27], v[66:67] op_sel:[0,0,0] op_sel_hi:[0,1,1]
    v_cvt_pk_bf16_f32 v68, v12, v13
    v_cvt_pk_bf16_f32 v69, v14, v15
    ds_write_b64 v5, v[68:69] offset:1056
    v_pk_mul_f32 v[64:65], v[12:13], v[24:25] op_sel:[1,1] op_sel_hi:[1,0] neg_lo:[1,0]
    v_pk_mul_f32 v[66:67], v[14:15], v[26:27] op_sel:[1,1] op_sel_hi:[1,0] neg_lo:[1,0]
    v_pk_fma_f32 v[12:13], v[12:13], v[24:25], v[64:65] op_sel:[0,0,0] op_sel_hi:[0,1,1]
    v_pk_fma_f32 v[14:15], v[14:15], v[26:27], v[66:67] op_sel:[0,0,0] op_sel_hi:[0,1,1]
    v_cvt_pk_bf16_f32 v70, v12, v13
    v_cvt_pk_bf16_f32 v71, v14, v15
    ds_write_b64 v5, v[70:71] offset:1584
    v_pk_mul_f32 v[64:65], v[12:13], v[24:25] op_sel:[1,1] op_sel_hi:[1,0] neg_lo:[1,0]
    v_pk_mul_f32 v[66:67], v[14:15], v[26:27] op_sel:[1,1] op_sel_hi:[1,0] neg_lo:[1,0]
    v_pk_fma_f32 v[12:13], v[12:13], v[24:25], v[64:65] op_sel:[0,0,0] op_sel_hi:[0,1,1]
    v_pk_fma_f32 v[14:15], v[14:15], v[26:27], v[66:67] op_sel:[0,0,0] op_sel_hi:[0,1,1]
    v_cvt_pk_bf16_f32 v68, v12, v13
    v_cvt_pk_bf16_f32 v69, v14, v15
    ds_write_b64 v5, v[68:69] offset:2112
    v_pk_mul_f32 v[64:65], v[12:13], v[24:25] op_sel:[1,1] op_sel_hi:[1,0] neg_lo:[1,0]
    v_pk_mul_f32 v[66:67], v[14:15], v[26:27] op_sel:[1,1] op_sel_hi:[1,0] neg_lo:[1,0]
    v_pk_fma_f32 v[12:13], v[12:13], v[24:25], v[64:65] op_sel:[0,0,0] op_sel_hi:[0,1,1]
    v_pk_fma_f32 v[14:15], v[14:15], v[26:27], v[66:67] op_sel:[0,0,0] op_sel_hi:[0,1,1]
    v_cvt_pk_bf16_f32 v70, v12, v13
    v_cvt_pk_bf16_f32 v71, v14, v15
    ds_write_b64 v5, v[70:71] offset:2640
    v_pk_mul_f32 v[64:65], v[12:13], v[24:25] op_sel:[1,1] op_sel_hi:[1,0] neg_lo:[1,0]
    v_pk_mul_f32 v[66:67], v[14:15], v[26:27] op_sel:[1,1] op_sel_hi:[1,0] neg_lo:[1,0]
    v_pk_fma_f32 v[12:13], v[12:13], v[24:25], v[64:65] op_sel:[0,0,0] op_sel_hi:[0,1,1]
    v_pk_fma_f32 v[14:15], v[14:15], v[26:27], v[66:67] op_sel:[0,0,0] op_sel_hi:[0,1,1]
    v_cvt_pk_bf16_f32 v68, v12, v13
    v_cvt_pk_bf16_f32 v69, v14, v15
    ds_write_b64 v5, v[68:69] offset:3168
    v_pk_mul_f32 v[64:65], v[12:13], v[24:25] op_sel:[1,1] op_sel_hi:[1,0] neg_lo:[1,0]
    v_pk_mul_f32 v[66:67], v[14:15], v[26:27] op_sel:[1,1] op_sel_hi:[1,0] neg_lo:[1,0]
    v_pk_fma_f32 v[12:13], v[12:13], v[24:25], v[64:65] op_sel:[0,0,0] op_sel_hi:[0,1,1]
    v_pk_fma_f32 v[14:15], v[14:15], v[26:27], v[66:67] op_sel:[0,0,0] op_sel_hi:[0,1,1]
    v_cvt_pk_bf16_f32 v70, v12, v13
    v_cvt_pk_bf16_f32 v71, v14, v15
    ds_write_b64 v5, v[70:71] offset:3696
    v_pk_mul_f32 v[64:65], v[12:13], v[24:25] op_sel:[1,1] op_sel_hi:[1,0] neg_lo:[1,0]
    v_pk_mul_f32 v[66:67], v[14:15], v[26:27] op_sel:[1,1] op_sel_hi:[1,0] neg_lo:[1,0]
    v_pk_fma_f32 v[12:13], v[12:13], v[24:25], v[64:65] op_sel:[0,0,0] op_sel_hi:[0,1,1]
    v_pk_fma_f32 v[14:15], v[14:15], v[26:27], v[66:67] op_sel:[0,0,0] op_sel_hi:[0,1,1]
    v_cvt_pk_bf16_f32 v68, v12, v13
    v_cvt_pk_bf16_f32 v69, v14, v15
    ds_write_b64 v5, v[68:69] offset:4224
    v_pk_mul_f32 v[64:65], v[12:13], v[24:25] op_sel:[1,1] op_sel_hi:[1,0] neg_lo:[1,0]
    v_pk_mul_f32 v[66:67], v[14:15], v[26:27] op_sel:[1,1] op_sel_hi:[1,0] neg_lo:[1,0]
    v_pk_fma_f32 v[12:13], v[12:13], v[24:25], v[64:65] op_sel:[0,0,0] op_sel_hi:[0,1,1]
    v_pk_fma_f32 v[14:15], v[14:15], v[26:27], v[66:67] op_sel:[0,0,0] op_sel_hi:[0,1,1]
    v_cvt_pk_bf16_f32 v70, v12, v13
    v_cvt_pk_bf16_f32 v71, v14, v15
    ds_write_b64 v5, v[70:71] offset:4752
    v_pk_mul_f32 v[64:65], v[12:13], v[24:25] op_sel:[1,1] op_sel_hi:[1,0] neg_lo:[1,0]
    v_pk_mul_f32 v[66:67], v[14:15], v[26:27] op_sel:[1,1] op_sel_hi:[1,0] neg_lo:[1,0]
    v_pk_fma_f32 v[12:13], v[12:13], v[24:25], v[64:65] op_sel:[0,0,0] op_sel_hi:[0,1,1]
    v_pk_fma_f32 v[14:15], v[14:15], v[26:27], v[66:67] op_sel:[0,0,0] op_sel_hi:[0,1,1]
    v_cvt_pk_bf16_f32 v68, v12, v13
    v_cvt_pk_bf16_f32 v69, v14, v15
    ds_write_b64 v5, v[68:69] offset:5280
    v_pk_mul_f32 v[64:65], v[12:13], v[24:25] op_sel:[1,1] op_sel_hi:[1,0] neg_lo:[1,0]
    v_pk_mul_f32 v[66:67], v[14:15], v[26:27] op_sel:[1,1] op_sel_hi:[1,0] neg_lo:[1,0]
    v_pk_fma_f32 v[12:13], v[12:13], v[24:25], v[64:65] op_sel:[0,0,0] op_sel_hi:[0,1,1]
    v_pk_fma_f32 v[14:15], v[14:15], v[26:27], v[66:67] op_sel:[0,0,0] op_sel_hi:[0,1,1]
    v_cvt_pk_bf16_f32 v70, v12, v13
    v_cvt_pk_bf16_f32 v71, v14, v15
    ds_write_b64 v5, v[70:71] offset:5808
    v_pk_mul_f32 v[64:65], v[12:13], v[24:25] op_sel:[1,1] op_sel_hi:[1,0] neg_lo:[1,0]
    v_pk_mul_f32 v[66:67], v[14:15], v[26:27] op_sel:[1,1] op_sel_hi:[1,0] neg_lo:[1,0]
    v_pk_fma_f32 v[12:13], v[12:13], v[24:25], v[64:65] op_sel:[0,0,0] op_sel_hi:[0,1,1]
    v_pk_fma_f32 v[14:15], v[14:15], v[26:27], v[66:67] op_sel:[0,0,0] op_sel_hi:[0,1,1]
    v_cvt_pk_bf16_f32 v68, v12, v13
    v_cvt_pk_bf16_f32 v69, v14, v15
    ds_write_b64 v5, v[68:69] offset:6336
    v_pk_mul_f32 v[64:65], v[12:13], v[24:25] op_sel:[1,1] op_sel_hi:[1,0] neg_lo:[1,0]
    v_pk_mul_f32 v[66:67], v[14:15], v[26:27] op_sel:[1,1] op_sel_hi:[1,0] neg_lo:[1,0]
    v_pk_fma_f32 v[12:13], v[12:13], v[24:25], v[64:65] op_sel:[0,0,0] op_sel_hi:[0,1,1]
    v_pk_fma_f32 v[14:15], v[14:15], v[26:27], v[66:67] op_sel:[0,0,0] op_sel_hi:[0,1,1]
    v_cvt_pk_bf16_f32 v70, v12, v13
    v_cvt_pk_bf16_f32 v71, v14, v15
    ds_write_b64 v5, v[70:71] offset:6864
    v_pk_mul_f32 v[64:65], v[12:13], v[24:25] op_sel:[1,1] op_sel_hi:[1,0] neg_lo:[1,0]
    v_pk_mul_f32 v[66:67], v[14:15], v[26:27] op_sel:[1,1] op_sel_hi:[1,0] neg_lo:[1,0]
    v_pk_fma_f32 v[12:13], v[12:13], v[24:25], v[64:65] op_sel:[0,0,0] op_sel_hi:[0,1,1]
    v_pk_fma_f32 v[14:15], v[14:15], v[26:27], v[66:67] op_sel:[0,0,0] op_sel_hi:[0,1,1]
    v_cvt_pk_bf16_f32 v68, v12, v13
    v_cvt_pk_bf16_f32 v69, v14, v15
    ds_write_b64 v5, v[68:69] offset:7392
    v_pk_mul_f32 v[64:65], v[12:13], v[24:25] op_sel:[1,1] op_sel_hi:[1,0] neg_lo:[1,0]
    v_pk_mul_f32 v[66:67], v[14:15], v[26:27] op_sel:[1,1] op_sel_hi:[1,0] neg_lo:[1,0]
    v_pk_fma_f32 v[12:13], v[12:13], v[24:25], v[64:65] op_sel:[0,0,0] op_sel_hi:[0,1,1]
    v_pk_fma_f32 v[14:15], v[14:15], v[26:27], v[66:67] op_sel:[0,0,0] op_sel_hi:[0,1,1]
    v_cvt_pk_bf16_f32 v70, v12, v13
    v_cvt_pk_bf16_f32 v71, v14, v15
    ds_write_b64 v5, v[70:71] offset:7920
    ds_read_b128 v[80:83], v6 offset:0
    ds_read_b128 v[84:87], v6 offset:32
    ds_read_b128 v[88:91], v6 offset:64
    ds_read_b128 v[92:95], v6 offset:96
    ds_read_b128 v[96:99], v6 offset:128
    ds_read_b128 v[100:103], v6 offset:160
    ds_read_b128 v[104:107], v6 offset:192
    ds_read_b128 v[108:111], v6 offset:224
    v_cvt_pk_bf16_f32 v68, v32, v33
    v_cvt_pk_bf16_f32 v69, v34, v35
    ds_write_b64 v5, v[68:69] offset:0
    v_pk_mul_f32 v[64:65], v[32:33], v[20:21] op_sel:[1,1] op_sel_hi:[1,0] neg_lo:[1,0]
    v_pk_mul_f32 v[66:67], v[34:35], v[22:23] op_sel:[1,1] op_sel_hi:[1,0] neg_lo:[1,0]
    v_pk_fma_f32 v[36:37], v[32:33], v[20:21], v[64:65] op_sel:[0,0,0] op_sel_hi:[0,1,1]
    v_pk_fma_f32 v[38:39], v[34:35], v[22:23], v[66:67] op_sel:[0,0,0] op_sel_hi:[0,1,1]
    v_cvt_pk_bf16_f32 v70, v36, v37
    v_cvt_pk_bf16_f32 v71, v38, v39
    ds_write_b64 v5, v[70:71] offset:528
    v_pk_mul_f32 v[64:65], v[36:37], v[20:21] op_sel:[1,1] op_sel_hi:[1,0] neg_lo:[1,0]
    v_pk_mul_f32 v[66:67], v[38:39], v[22:23] op_sel:[1,1] op_sel_hi:[1,0] neg_lo:[1,0]
    v_pk_fma_f32 v[40:41], v[36:37], v[20:21], v[64:65] op_sel:[0,0,0] op_sel_hi:[0,1,1]
    v_pk_fma_f32 v[42:43], v[38:39], v[22:23], v[66:67] op_sel:[0,0,0] op_sel_hi:[0,1,1]
    v_cvt_pk_bf16_f32 v68, v40, v41
    v_cvt_pk_bf16_f32 v69, v42, v43
    ds_write_b64 v5, v[68:69] offset:1056
    v_pk_mul_f32 v[64:65], v[40:41], v[20:21] op_sel:[1,1] op_sel_hi:[1,0] neg_lo:[1,0]
    v_pk_mul_f32 v[66:67], v[42:43], v[22:23] op_sel:[1,1] op_sel_hi:[1,0] neg_lo:[1,0]
    v_pk_fma_f32 v[44:45], v[40:41], v[20:21], v[64:65] op_sel:[0,0,0] op_sel_hi:[0,1,1]
    v_pk_fma_f32 v[46:47], v[42:43], v[22:23], v[66:67] op_sel:[0,0,0] op_sel_hi:[0,1,1]
    v_cvt_pk_bf16_f32 v70, v44, v45
    v_cvt_pk_bf16_f32 v71, v46, v47
    ds_write_b64 v5, v[70:71] offset:1584
    v_pk_mul_f32 v[64:65], v[44:45], v[20:21] op_sel:[1,1] op_sel_hi:[1,0] neg_lo:[1,0]
    v_pk_mul_f32 v[66:67], v[46:47], v[22:23] op_sel:[1,1] op_sel_hi:[1,0] neg_lo:[1,0]
    v_pk_fma_f32 v[48:49], v[44:45], v[20:21], v[64:65] op_sel:[0,0,0] op_sel_hi:[0,1,1]
    v_pk_fma_f32 v[50:51], v[46:47], v[22:23], v[66:67] op_sel:[0,0,0] op_sel_hi:[0,1,1]
    v_cvt_pk_bf16_f32 v68, v48, v49
    v_cvt_pk_bf16_f32 v69, v50, v51
    ds_write_b64 v5, v[68:69] offset:2112
    v_pk_mul_f32 v[64:65], v[48:49], v[20:21] op_sel:[1,1] op_sel_hi:[1,0] neg_lo:[1,0]
    v_pk_mul_f32 v[66:67], v[50:51], v[22:23] op_sel:[1,1] op_sel_hi:[1,0] neg_lo:[1,0]
    v_pk_fma_f32 v[52:53], v[48:49], v[20:21], v[64:65] op_sel:[0,0,0] op_sel_hi:[0,1,1]
    v_pk_fma_f32 v[54:55], v[50:51], v[22:23], v[66:67] op_sel:[0,0,0] op_sel_hi:[0,1,1]
    v_cvt_pk_bf16_f32 v70, v52, v53
    v_cvt_pk_bf16_f32 v71, v54, v55
    ds_write_b64 v5, v[70:71] offset:2640
    v_pk_mul_f32 v[64:65], v[52:53], v[20:21] op_sel:[1,1] op_sel_hi:[1,0] neg_lo:[1,0]
    v_pk_mul_f32 v[66:67], v[54:55], v[22:23] op_sel:[1,1] op_sel_hi:[1,0] neg_lo:[1,0]
    v_pk_fma_f32 v[56:57], v[52:53], v[20:21], v[64:65] op_sel:[0,0,0] op_sel_hi:[0,1,1]
    v_pk_fma_f32 v[58:59], v[54:55], v[22:23], v[66:67] op_sel:[0,0,0] op_sel_hi:[0,1,1]
    v_cvt_pk_bf16_f32 v68, v56, v57
    v_cvt_pk_bf16_f32 v69, v58, v59
    ds_write_b64 v5, v[68:69] offset:3168
    v_pk_mul_f32 v[64:65], v[56:57], v[20:21] op_sel:[1,1] op_sel_hi:[1,0] neg_lo:[1,0]
    v_pk_mul_f32 v[66:67], v[58:59], v[22:23] op_sel:[1,1] op_sel_hi:[1,0] neg_lo:[1,0]
    v_pk_fma_f32 v[60:61], v[56:57], v[20:21], v[64:65] op_sel:[0,0,0] op_sel_hi:[0,1,1]
    v_pk_fma_f32 v[62:63], v[58:59], v[22:23], v[66:67] op_sel:[0,0,0] op_sel_hi:[0,1,1]
    v_cvt_pk_bf16_f32 v70, v60, v61
    v_cvt_pk_bf16_f32 v71, v62, v63
    ds_write_b64 v5, v[70:71] offset:3696
    v_pk_mul_f32 v[64:65], v[32:33], v[28:29] op_sel:[1,1] op_sel_hi:[1,0] neg_lo:[1,0]
    v_pk_mul_f32 v[66:67], v[34:35], v[30:31] op_sel:[1,1] op_sel_hi:[1,0] neg_lo:[1,0]
    v_pk_fma_f32 v[32:33], v[32:33], v[28:29], v[64:65] op_sel:[0,0,0] op_sel_hi:[0,1,1]
    v_pk_fma_f32 v[34:35], v[34:35], v[30:31], v[66:67] op_sel:[0,0,0] op_sel_hi:[0,1,1]
    v_cvt_pk_bf16_f32 v68, v32, v33
    v_cvt_pk_bf16_f32 v69, v34, v35
    ds_write_b64 v5, v[68:69] offset:4224
    v_pk_mul_f32 v[64:65], v[36:37], v[28:29] op_sel:[1,1] op_sel_hi:[1,0] neg_lo:[1,0]
    v_pk_mul_f32 v[66:67], v[38:39], v[30:31] op_sel:[1,1] op_sel_hi:[1,0] neg_lo:[1,0]
    v_pk_fma_f32 v[36:37], v[36:37], v[28:29], v[64:65] op_sel:[0,0,0] op_sel_hi:[0,1,1]
    v_pk_fma_f32 v[38:39], v[38:39], v[30:31], v[66:67] op_sel:[0,0,0] op_sel_hi:[0,1,1]
    v_cvt_pk_bf16_f32 v70, v36, v37
    v_cvt_pk_bf16_f32 v71, v38, v39
    ds_write_b64 v5, v[70:71] offset:4752
    v_pk_mul_f32 v[64:65], v[40:41], v[28:29] op_sel:[1,1] op_sel_hi:[1,0] neg_lo:[1,0]
    v_pk_mul_f32 v[66:67], v[42:43], v[30:31] op_sel:[1,1] op_sel_hi:[1,0] neg_lo:[1,0]
    v_pk_fma_f32 v[40:41], v[40:41], v[28:29], v[64:65] op_sel:[0,0,0] op_sel_hi:[0,1,1]
    v_pk_fma_f32 v[42:43], v[42:43], v[30:31], v[66:67] op_sel:[0,0,0] op_sel_hi:[0,1,1]
    v_cvt_pk_bf16_f32 v68, v40, v41
    v_cvt_pk_bf16_f32 v69, v42, v43
    ds_write_b64 v5, v[68:69] offset:5280
    v_pk_mul_f32 v[64:65], v[44:45], v[28:29] op_sel:[1,1] op_sel_hi:[1,0] neg_lo:[1,0]
    v_pk_mul_f32 v[66:67], v[46:47], v[30:31] op_sel:[1,1] op_sel_hi:[1,0] neg_lo:[1,0]
    v_pk_fma_f32 v[44:45], v[44:45], v[28:29], v[64:65] op_sel:[0,0,0] op_sel_hi:[0,1,1]
    v_pk_fma_f32 v[46:47], v[46:47], v[30:31], v[66:67] op_sel:[0,0,0] op_sel_hi:[0,1,1]
    v_cvt_pk_bf16_f32 v70, v44, v45
    v_cvt_pk_bf16_f32 v71, v46, v47
    ds_write_b64 v5, v[70:71] offset:5808
    v_pk_mul_f32 v[64:65], v[48:49], v[28:29] op_sel:[1,1] op_sel_hi:[1,0] neg_lo:[1,0]
    v_pk_mul_f32 v[66:67], v[50:51], v[30:31] op_sel:[1,1] op_sel_hi:[1,0] neg_lo:[1,0]
    v_pk_fma_f32 v[48:49], v[48:49], v[28:29], v[64:65] op_sel:[0,0,0] op_sel_hi:[0,1,1]
    v_pk_fma_f32 v[50:51], v[50:51], v[30:31], v[66:67] op_sel:[0,0,0] op_sel_hi:[0,1,1]
    v_cvt_pk_bf16_f32 v68, v48, v49
    v_cvt_pk_bf16_f32 v69, v50, v51
    ds_write_b64 v5, v[68:69] offset:6336
    v_pk_mul_f32 v[64:65], v[52:53], v[28:29] op_sel:[1,1] op_sel_hi:[1,0] neg_lo:[1,0]
    v_pk_mul_f32 v[66:67], v[54:55], v[30:31] op_sel:[1,1] op_sel_hi:[1,0] neg_lo:[1,0]
    v_pk_fma_f32 v[52:53], v[52:53], v[28:29], v[64:65] op_sel:[0,0,0] op_sel_hi:[0,1,1]
    v_pk_fma_f32 v[54:55], v[54:55], v[30:31], v[66:67] op_sel:[0,0,0] op_sel_hi:[0,1,1]
    v_cvt_pk_bf16_f32 v70, v52, v53
    v_cvt_pk_bf16_f32 v71, v54, v55
    ds_write_b64 v5, v[70:71] offset:6864
    v_pk_mul_f32 v[64:65], v[56:57], v[28:29] op_sel:[1,1] op_sel_hi:[1,0] neg_lo:[1,0]
    v_pk_mul_f32 v[66:67], v[58:59], v[30:31] op_sel:[1,1] op_sel_hi:[1,0] neg_lo:[1,0]
    v_pk_fma_f32 v[56:57], v[56:57], v[28:29], v[64:65] op_sel:[0,0,0] op_sel_hi:[0,1,1]
    v_pk_fma_f32 v[58:59], v[58:59], v[30:31], v[66:67] op_sel:[0,0,0] op_sel_hi:[0,1,1]
    v_cvt_pk_bf16_f32 v68, v56, v57
    v_cvt_pk_bf16_f32 v69, v58, v59
    ds_write_b64 v5, v[68:69] offset:7392
    v_pk_mul_f32 v[64:65], v[60:61], v[28:29] op_sel:[1,1] op_sel_hi:[1,0] neg_lo:[1,0]
    v_pk_mul_f32 v[66:67], v[62:63], v[30:31] op_sel:[1,1] op_sel_hi:[1,0] neg_lo:[1,0]
    v_pk_fma_f32 v[60:61], v[60:61], v[28:29], v[64:65] op_sel:[0,0,0] op_sel_hi:[0,1,1]
    v_pk_fma_f32 v[62:63], v[62:63], v[30:31], v[66:67] op_sel:[0,0,0] op_sel_hi:[0,1,1]
    v_cvt_pk_bf16_f32 v70, v60, v61
    v_cvt_pk_bf16_f32 v71, v62, v63
    ds_write_b64 v5, v[70:71] offset:7920
    ds_read_b128 v[176:179], v6 offset:0
    ds_read_b128 v[180:183], v6 offset:32
    ds_read_b128 v[184:187], v6 offset:64
    ds_read_b128 v[188:191], v6 offset:96
    ds_read_b128 v[192:195], v6 offset:128
    ds_read_b128 v[196:199], v6 offset:160
    ds_read_b128 v[200:203], v6 offset:192
    ds_read_b128 v[204:207], v6 offset:224
    v_pk_mul_f32 v[64:65], v[32:33], v[28:29] op_sel:[1,1] op_sel_hi:[1,0] neg_lo:[1,0]
    v_pk_mul_f32 v[66:67], v[34:35], v[30:31] op_sel:[1,1] op_sel_hi:[1,0] neg_lo:[1,0]
    v_pk_fma_f32 v[32:33], v[32:33], v[28:29], v[64:65] op_sel:[0,0,0] op_sel_hi:[0,1,1]
    v_pk_fma_f32 v[34:35], v[34:35], v[30:31], v[66:67] op_sel:[0,0,0] op_sel_hi:[0,1,1]
    v_cvt_pk_bf16_f32 v68, v32, v33
    v_cvt_pk_bf16_f32 v69, v34, v35
    ds_write_b64 v5, v[68:69] offset:0
    v_pk_mul_f32 v[64:65], v[40:41], v[28:29] op_sel:[1,1] op_sel_hi:[1,0] neg_lo:[1,0]
    v_pk_mul_f32 v[66:67], v[42:43], v[30:31] op_sel:[1,1] op_sel_hi:[1,0] neg_lo:[1,0]
    v_pk_fma_f32 v[40:41], v[40:41], v[28:29], v[64:65] op_sel:[0,0,0] op_sel_hi:[0,1,1]
    v_pk_fma_f32 v[42:43], v[42:43], v[30:31], v[66:67] op_sel:[0,0,0] op_sel_hi:[0,1,1]
    v_cvt_pk_bf16_f32 v70, v40, v41
    v_cvt_pk_bf16_f32 v71, v42, v43
    ds_write_b64 v5, v[70:71] offset:528
    v_pk_mul_f32 v[64:65], v[48:49], v[28:29] op_sel:[1,1] op_sel_hi:[1,0] neg_lo:[1,0]
    v_pk_mul_f32 v[66:67], v[50:51], v[30:31] op_sel:[1,1] op_sel_hi:[1,0] neg_lo:[1,0]
    v_pk_fma_f32 v[48:49], v[48:49], v[28:29], v[64:65] op_sel:[0,0,0] op_sel_hi:[0,1,1]
    v_pk_fma_f32 v[50:51], v[50:51], v[30:31], v[66:67] op_sel:[0,0,0] op_sel_hi:[0,1,1]
    v_cvt_pk_bf16_f32 v68, v48, v49
    v_cvt_pk_bf16_f32 v69, v50, v51
    ds_write_b64 v5, v[68:69] offset:1056
    v_pk_mul_f32 v[64:65], v[56:57], v[28:29] op_sel:[1,1] op_sel_hi:[1,0] neg_lo:[1,0]
    v_pk_mul_f32 v[66:67], v[58:59], v[30:31] op_sel:[1,1] op_sel_hi:[1,0] neg_lo:[1,0]
    v_pk_fma_f32 v[56:57], v[56:57], v[28:29], v[64:65] op_sel:[0,0,0] op_sel_hi:[0,1,1]
    v_pk_fma_f32 v[58:59], v[58:59], v[30:31], v[66:67] op_sel:[0,0,0] op_sel_hi:[0,1,1]
    v_cvt_pk_bf16_f32 v70, v56, v57
    v_cvt_pk_bf16_f32 v71, v58, v59
    ds_write_b64 v5, v[70:71] offset:1584
    s_waitcnt lgkmcnt(11)
    v_mfma_f32_16x16x32_bf16 v[208:211], v[176:179], v[80:83], 0
    s_waitcnt lgkmcnt(10)
    v_mfma_f32_16x16x32_bf16 v[208:211], v[180:183], v[84:87], v[208:211]
    s_waitcnt lgkmcnt(9)
    v_mfma_f32_16x16x32_bf16 v[208:211], v[184:187], v[88:91], v[208:211]
    s_waitcnt lgkmcnt(8)
    v_mfma_f32_16x16x32_bf16 v[208:211], v[188:191], v[92:95], v[208:211]
    s_waitcnt lgkmcnt(7)
    v_mfma_f32_16x16x32_bf16 v[208:211], v[192:195], v[96:99], v[208:211]
    s_waitcnt lgkmcnt(6)
    v_mfma_f32_16x16x32_bf16 v[208:211], v[196:199], v[100:103], v[208:211]
    s_waitcnt lgkmcnt(5)
    v_mfma_f32_16x16x32_bf16 v[208:211], v[200:203], v[104:107], v[208:211]
    s_waitcnt lgkmcnt(4)
    v_mfma_f32_16x16x32_bf16 v[208:211], v[204:207], v[108:111], v[208:211]
    v_pk_mul_f32 v[64:65], v[32:33], v[28:29] op_sel:[1,1] op_sel_hi:[1,0] neg_lo:[1,0]
    v_pk_mul_f32 v[66:67], v[34:35], v[30:31] op_sel:[1,1] op_sel_hi:[1,0] neg_lo:[1,0]
    v_pk_fma_f32 v[32:33], v[32:33], v[28:29], v[64:65] op_sel:[0,0,0] op_sel_hi:[0,1,1]
    v_pk_fma_f32 v[34:35], v[34:35], v[30:31], v[66:67] op_sel:[0,0,0] op_sel_hi:[0,1,1]
    v_cvt_pk_bf16_f32 v68, v32, v33
    v_cvt_pk_bf16_f32 v69, v34, v35
    ds_write_b64 v5, v[68:69] offset:2112
    v_pk_mul_f32 v[64:65], v[40:41], v[28:29] op_sel:[1,1] op_sel_hi:[1,0] neg_lo:[1,0]
    v_pk_mul_f32 v[66:67], v[42:43], v[30:31] op_sel:[1,1] op_sel_hi:[1,0] neg_lo:[1,0]
    v_pk_fma_f32 v[40:41], v[40:41], v[28:29], v[64:65] op_sel:[0,0,0] op_sel_hi:[0,1,1]
    v_pk_fma_f32 v[42:43], v[42:43], v[30:31], v[66:67] op_sel:[0,0,0] op_sel_hi:[0,1,1]
    v_cvt_pk_bf16_f32 v70, v40, v41
    v_cvt_pk_bf16_f32 v71, v42, v43
    ds_write_b64 v5, v[70:71] offset:2640
    v_pk_mul_f32 v[64:65], v[48:49], v[28:29] op_sel:[1,1] op_sel_hi:[1,0] neg_lo:[1,0]
    v_pk_mul_f32 v[66:67], v[50:51], v[30:31] op_sel:[1,1] op_sel_hi:[1,0] neg_lo:[1,0]
    v_pk_fma_f32 v[48:49], v[48:49], v[28:29], v[64:65] op_sel:[0,0,0] op_sel_hi:[0,1,1]
    v_pk_fma_f32 v[50:51], v[50:51], v[30:31], v[66:67] op_sel:[0,0,0] op_sel_hi:[0,1,1]
    v_cvt_pk_bf16_f32 v68, v48, v49
    v_cvt_pk_bf16_f32 v69, v50, v51
    ds_write_b64 v5, v[68:69] offset:3168
    v_pk_mul_f32 v[64:65], v[56:57], v[28:29] op_sel:[1,1] op_sel_hi:[1,0] neg_lo:[1,0]
    v_pk_mul_f32 v[66:67], v[58:59], v[30:31] op_sel:[1,1] op_sel_hi:[1,0] neg_lo:[1,0]
    v_pk_fma_f32 v[56:57], v[56:57], v[28:29], v[64:65] op_sel:[0,0,0] op_sel_hi:[0,1,1]
    v_pk_fma_f32 v[58:59], v[58:59], v[30:31], v[66:67] op_sel:[0,0,0] op_sel_hi:[0,1,1]
    v_cvt_pk_bf16_f32 v70, v56, v57
    v_cvt_pk_bf16_f32 v71, v58, v59
    ds_write_b64 v5, v[70:71] offset:3696
    v_pk_mul_f32 v[64:65], v[32:33], v[28:29] op_sel:[1,1] op_sel_hi:[1,0] neg_lo:[1,0]
    v_pk_mul_f32 v[66:67], v[34:35], v[30:31] op_sel:[1,1] op_sel_hi:[1,0] neg_lo:[1,0]
    v_pk_fma_f32 v[32:33], v[32:33], v[28:29], v[64:65] op_sel:[0,0,0] op_sel_hi:[0,1,1]
    v_pk_fma_f32 v[34:35], v[34:35], v[30:31], v[66:67] op_sel:[0,0,0] op_sel_hi:[0,1,1]
    v_cvt_pk_bf16_f32 v68, v32, v33
    v_cvt_pk_bf16_f32 v69, v34, v35
    ds_write_b64 v5, v[68:69] offset:4224
    v_pk_mul_f32 v[64:65], v[48:49], v[28:29] op_sel:[1,1] op_sel_hi:[1,0] neg_lo:[1,0]
    v_pk_mul_f32 v[66:67], v[50:51], v[30:31] op_sel:[1,1] op_sel_hi:[1,0] neg_lo:[1,0]
    v_pk_fma_f32 v[48:49], v[48:49], v[28:29], v[64:65] op_sel:[0,0,0] op_sel_hi:[0,1,1]
    v_pk_fma_f32 v[50:51], v[50:51], v[30:31], v[66:67] op_sel:[0,0,0] op_sel_hi:[0,1,1]
    v_cvt_pk_bf16_f32 v70, v48, v49
    v_cvt_pk_bf16_f32 v71, v50, v51
    ds_write_b64 v5, v[70:71] offset:4752
    v_pk_mul_f32 v[64:65], v[32:33], v[28:29] op_sel:[1,1] op_sel_hi:[1,0] neg_lo:[1,0]
    v_pk_mul_f32 v[66:67], v[34:35], v[30:31] op_sel:[1,1] op_sel_hi:[1,0] neg_lo:[1,0]
    v_pk_fma_f32 v[32:33], v[32:33], v[28:29], v[64:65] op_sel:[0,0,0] op_sel_hi:[0,1,1]
    v_pk_fma_f32 v[34:35], v[34:35], v[30:31], v[66:67] op_sel:[0,0,0] op_sel_hi:[0,1,1]
    v_cvt_pk_bf16_f32 v68, v32, v33
    v_cvt_pk_bf16_f32 v69, v34, v35
    ds_write_b64 v5, v[68:69] offset:5280
    v_pk_mul_f32 v[64:65], v[48:49], v[28:29] op_sel:[1,1] op_sel_hi:[1,0] neg_lo:[1,0]
    v_pk_mul_f32 v[66:67], v[50:51], v[30:31] op_sel:[1,1] op_sel_hi:[1,0] neg_lo:[1,0]
    v_pk_fma_f32 v[48:49], v[48:49], v[28:29], v[64:65] op_sel:[0,0,0] op_sel_hi:[0,1,1]
    v_pk_fma_f32 v[50:51], v[50:51], v[30:31], v[66:67] op_sel:[0,0,0] op_sel_hi:[0,1,1]
    v_cvt_pk_bf16_f32 v70, v48, v49
    v_cvt_pk_bf16_f32 v71, v50, v51
    ds_write_b64 v5, v[70:71] offset:5808
    v_pk_mul_f32 v[64:65], v[32:33], v[28:29] op_sel:[1,1] op_sel_hi:[1,0] neg_lo:[1,0]
    v_pk_mul_f32 v[66:67], v[34:35], v[30:31] op_sel:[1,1] op_sel_hi:[1,0] neg_lo:[1,0]
    v_pk_fma_f32 v[32:33], v[32:33], v[28:29], v[64:65] op_sel:[0,0,0] op_sel_hi:[0,1,1]
    v_pk_fma_f32 v[34:35], v[34:35], v[30:31], v[66:67] op_sel:[0,0,0] op_sel_hi:[0,1,1]
    v_cvt_pk_bf16_f32 v68, v32, v33
    v_cvt_pk_bf16_f32 v69, v34, v35
    ds_write_b64 v5, v[68:69] offset:6336
    v_pk_mul_f32 v[64:65], v[48:49], v[28:29] op_sel:[1,1] op_sel_hi:[1,0] neg_lo:[1,0]
    v_pk_mul_f32 v[66:67], v[50:51], v[30:31] op_sel:[1,1] op_sel_hi:[1,0] neg_lo:[1,0]
    v_pk_fma_f32 v[48:49], v[48:49], v[28:29], v[64:65] op_sel:[0,0,0] op_sel_hi:[0,1,1]
    v_pk_fma_f32 v[50:51], v[50:51], v[30:31], v[66:67] op_sel:[0,0,0] op_sel_hi:[0,1,1]
    v_cvt_pk_bf16_f32 v70, v48, v49
    v_cvt_pk_bf16_f32 v71, v50, v51
    ds_write_b64 v5, v[70:71] offset:6864
    v_pk_mul_f32 v[64:65], v[32:33], v[28:29] op_sel:[1,1] op_sel_hi:[1,0] neg_lo:[1,0]
    v_pk_mul_f32 v[66:67], v[34:35], v[30:31] op_sel:[1,1] op_sel_hi:[1,0] neg_lo:[1,0]
    v_pk_fma_f32 v[32:33], v[32:33], v[28:29], v[64:65] op_sel:[0,0,0] op_sel_hi:[0,1,1]
    v_pk_fma_f32 v[34:35], v[34:35], v[30:31], v[66:67] op_sel:[0,0,0] op_sel_hi:[0,1,1]
    v_cvt_pk_bf16_f32 v68, v32, v33
    v_cvt_pk_bf16_f32 v69, v34, v35
    ds_write_b64 v5, v[68:69] offset:7392
    v_pk_mul_f32 v[64:65], v[48:49], v[28:29] op_sel:[1,1] op_sel_hi:[1,0] neg_lo:[1,0]
    v_pk_mul_f32 v[66:67], v[50:51], v[30:31] op_sel:[1,1] op_sel_hi:[1,0] neg_lo:[1,0]
    v_pk_fma_f32 v[48:49], v[48:49], v[28:29], v[64:65] op_sel:[0,0,0] op_sel_hi:[0,1,1]
    v_pk_fma_f32 v[50:51], v[50:51], v[30:31], v[66:67] op_sel:[0,0,0] op_sel_hi:[0,1,1]
    v_cvt_pk_bf16_f32 v70, v48, v49
    v_cvt_pk_bf16_f32 v71, v50, v51
    ds_write_b64 v5, v[70:71] offset:7920
    ds_read_b128 v[176:179], v6 offset:0
    ds_read_b128 v[180:183], v6 offset:32
    ds_read_b128 v[184:187], v6 offset:64
    ds_read_b128 v[188:191], v6 offset:96
    ds_read_b128 v[192:195], v6 offset:128
    ds_read_b128 v[196:199], v6 offset:160
    ds_read_b128 v[200:203], v6 offset:192
    ds_read_b128 v[204:207], v6 offset:224
    v_pk_mul_f32 v[64:65], v[32:33], v[28:29] op_sel:[1,1] op_sel_hi:[1,0] neg_lo:[1,0]
    v_pk_mul_f32 v[66:67], v[34:35], v[30:31] op_sel:[1,1] op_sel_hi:[1,0] neg_lo:[1,0]
    v_pk_fma_f32 v[32:33], v[32:33], v[28:29], v[64:65] op_sel:[0,0,0] op_sel_hi:[0,1,1]
    v_pk_fma_f32 v[34:35], v[34:35], v[30:31], v[66:67] op_sel:[0,0,0] op_sel_hi:[0,1,1]
    v_cvt_pk_bf16_f32 v68, v32, v33
    v_cvt_pk_bf16_f32 v69, v34, v35
    ds_write_b64 v5, v[68:69] offset:0
    v_pk_mul_f32 v[64:65], v[32:33], v[28:29] op_sel:[1,1] op_sel_hi:[1,0] neg_lo:[1,0]
    v_pk_mul_f32 v[66:67], v[34:35], v[30:31] op_sel:[1,1] op_sel_hi:[1,0] neg_lo:[1,0]
    v_pk_fma_f32 v[32:33], v[32:33], v[28:29], v[64:65] op_sel:[0,0,0] op_sel_hi:[0,1,1]
    v_pk_fma_f32 v[34:35], v[34:35], v[30:31], v[66:67] op_sel:[0,0,0] op_sel_hi:[0,1,1]
    v_cvt_pk_bf16_f32 v70, v32, v33
    v_cvt_pk_bf16_f32 v71, v34, v35
    ds_write_b64 v5, v[70:71] offset:528
    v_pk_mul_f32 v[64:65], v[32:33], v[28:29] op_sel:[1,1] op_sel_hi:[1,0] neg_lo:[1,0]
    v_pk_mul_f32 v[66:67], v[34:35], v[30:31] op_sel:[1,1] op_sel_hi:[1,0] neg_lo:[1,0]
    v_pk_fma_f32 v[32:33], v[32:33], v[28:29], v[64:65] op_sel:[0,0,0] op_sel_hi:[0,1,1]
    v_pk_fma_f32 v[34:35], v[34:35], v[30:31], v[66:67] op_sel:[0,0,0] op_sel_hi:[0,1,1]
    v_cvt_pk_bf16_f32 v68, v32, v33
    v_cvt_pk_bf16_f32 v69, v34, v35
    ds_write_b64 v5, v[68:69] offset:1056
    v_pk_mul_f32 v[64:65], v[32:33], v[28:29] op_sel:[1,1] op_sel_hi:[1,0] neg_lo:[1,0]
    v_pk_mul_f32 v[66:67], v[34:35], v[30:31] op_sel:[1,1] op_sel_hi:[1,0] neg_lo:[1,0]
    v_pk_fma_f32 v[32:33], v[32:33], v[28:29], v[64:65] op_sel:[0,0,0] op_sel_hi:[0,1,1]
    v_pk_fma_f32 v[34:35], v[34:35], v[30:31], v[66:67] op_sel:[0,0,0] op_sel_hi:[0,1,1]
    v_cvt_pk_bf16_f32 v70, v32, v33
    v_cvt_pk_bf16_f32 v71, v34, v35
    ds_write_b64 v5, v[70:71] offset:1584
    s_waitcnt lgkmcnt(11)
    v_mfma_f32_16x16x32_bf16 v[212:215], v[176:179], v[80:83], 0
    s_waitcnt lgkmcnt(10)
    v_mfma_f32_16x16x32_bf16 v[212:215], v[180:183], v[84:87], v[212:215]
    s_waitcnt lgkmcnt(9)
    v_mfma_f32_16x16x32_bf16 v[212:215], v[184:187], v[88:91], v[212:215]
    s_waitcnt lgkmcnt(8)
    v_mfma_f32_16x16x32_bf16 v[212:215], v[188:191], v[92:95], v[212:215]
    s_waitcnt lgkmcnt(7)
    v_mfma_f32_16x16x32_bf16 v[212:215], v[192:195], v[96:99], v[212:215]
    s_waitcnt lgkmcnt(6)
    v_mfma_f32_16x16x32_bf16 v[212:215], v[196:199], v[100:103], v[212:215]
    s_waitcnt lgkmcnt(5)
    v_mfma_f32_16x16x32_bf16 v[212:215], v[200:203], v[104:107], v[212:215]
    s_waitcnt lgkmcnt(4)
    v_mfma_f32_16x16x32_bf16 v[212:215], v[204:207], v[108:111], v[212:215]
    v_pk_mul_f32 v[64:65], v[32:33], v[28:29] op_sel:[1,1] op_sel_hi:[1,0] neg_lo:[1,0]
    v_pk_mul_f32 v[66:67], v[34:35], v[30:31] op_sel:[1,1] op_sel_hi:[1,0] neg_lo:[1,0]
    v_pk_fma_f32 v[32:33], v[32:33], v[28:29], v[64:65] op_sel:[0,0,0] op_sel_hi:[0,1,1]
    v_pk_fma_f32 v[34:35], v[34:35], v[30:31], v[66:67] op_sel:[0,0,0] op_sel_hi:[0,1,1]
    v_cvt_pk_bf16_f32 v68, v32, v33
    v_cvt_pk_bf16_f32 v69, v34, v35
    ds_write_b64 v5, v[68:69] offset:2112
    v_pk_mul_f32 v[64:65], v[32:33], v[28:29] op_sel:[1,1] op_sel_hi:[1,0] neg_lo:[1,0]
    v_pk_mul_f32 v[66:67], v[34:35], v[30:31] op_sel:[1,1] op_sel_hi:[1,0] neg_lo:[1,0]
    v_pk_fma_f32 v[32:33], v[32:33], v[28:29], v[64:65] op_sel:[0,0,0] op_sel_hi:[0,1,1]
    v_pk_fma_f32 v[34:35], v[34:35], v[30:31], v[66:67] op_sel:[0,0,0] op_sel_hi:[0,1,1]
    v_cvt_pk_bf16_f32 v70, v32, v33
    v_cvt_pk_bf16_f32 v71, v34, v35
    ds_write_b64 v5, v[70:71] offset:2640
    v_pk_mul_f32 v[64:65], v[32:33], v[28:29] op_sel:[1,1] op_sel_hi:[1,0] neg_lo:[1,0]
    v_pk_mul_f32 v[66:67], v[34:35], v[30:31] op_sel:[1,1] op_sel_hi:[1,0] neg_lo:[1,0]
    v_pk_fma_f32 v[32:33], v[32:33], v[28:29], v[64:65] op_sel:[0,0,0] op_sel_hi:[0,1,1]
    v_pk_fma_f32 v[34:35], v[34:35], v[30:31], v[66:67] op_sel:[0,0,0] op_sel_hi:[0,1,1]
    v_cvt_pk_bf16_f32 v68, v32, v33
    v_cvt_pk_bf16_f32 v69, v34, v35
    ds_write_b64 v5, v[68:69] offset:3168
    v_pk_mul_f32 v[64:65], v[32:33], v[28:29] op_sel:[1,1] op_sel_hi:[1,0] neg_lo:[1,0]
    v_pk_mul_f32 v[66:67], v[34:35], v[30:31] op_sel:[1,1] op_sel_hi:[1,0] neg_lo:[1,0]
    v_pk_fma_f32 v[32:33], v[32:33], v[28:29], v[64:65] op_sel:[0,0,0] op_sel_hi:[0,1,1]
    v_pk_fma_f32 v[34:35], v[34:35], v[30:31], v[66:67] op_sel:[0,0,0] op_sel_hi:[0,1,1]
    v_cvt_pk_bf16_f32 v70, v32, v33
    v_cvt_pk_bf16_f32 v71, v34, v35
    ds_write_b64 v5, v[70:71] offset:3696
    v_pk_mul_f32 v[64:65], v[32:33], v[28:29] op_sel:[1,1] op_sel_hi:[1,0] neg_lo:[1,0]
    v_pk_mul_f32 v[66:67], v[34:35], v[30:31] op_sel:[1,1] op_sel_hi:[1,0] neg_lo:[1,0]
    v_pk_fma_f32 v[32:33], v[32:33], v[28:29], v[64:65] op_sel:[0,0,0] op_sel_hi:[0,1,1]
    v_pk_fma_f32 v[34:35], v[34:35], v[30:31], v[66:67] op_sel:[0,0,0] op_sel_hi:[0,1,1]
    v_cvt_pk_bf16_f32 v68, v32, v33
    v_cvt_pk_bf16_f32 v69, v34, v35
    ds_write_b64 v5, v[68:69] offset:4224
    ds_read_b128 v[176:179], v6 offset:0
    ds_read_b128 v[180:183], v6 offset:32
    ds_read_b128 v[184:187], v6 offset:64
    ds_read_b128 v[188:191], v6 offset:96
    ds_read_b128 v[192:195], v6 offset:128
    ds_read_b128 v[196:199], v6 offset:160
    ds_read_b128 v[200:203], v6 offset:192
    ds_read_b128 v[204:207], v6 offset:224
    s_waitcnt lgkmcnt(7)
    v_mfma_f32_16x16x32_bf16 v[216:219], v[176:179], v[80:83], 0
    s_waitcnt lgkmcnt(6)
    v_mfma_f32_16x16x32_bf16 v[216:219], v[180:183], v[84:87], v[216:219]
    s_waitcnt lgkmcnt(5)
    v_mfma_f32_16x16x32_bf16 v[216:219], v[184:187], v[88:91], v[216:219]
    s_waitcnt lgkmcnt(4)
    v_mfma_f32_16x16x32_bf16 v[216:219], v[188:191], v[92:95], v[216:219]
    s_waitcnt lgkmcnt(3)
    v_mfma_f32_16x16x32_bf16 v[216:219], v[192:195], v[96:99], v[216:219]
    s_waitcnt lgkmcnt(2)
    v_mfma_f32_16x16x32_bf16 v[216:219], v[196:199], v[100:103], v[216:219]
    s_waitcnt lgkmcnt(1)
    v_mfma_f32_16x16x32_bf16 v[216:219], v[200:203], v[104:107], v[216:219]
    s_waitcnt lgkmcnt(0)
    v_mfma_f32_16x16x32_bf16 v[216:219], v[204:207], v[108:111], v[216:219]
    v_mov_b32 v64, 0
    v_mov_b32 v65, 0
    v_mov_b32 v66, 0
    v_mov_b32 v67, 0
    v_lshl_add_u32 v12, v1, 4, v4
    ds_write_b128 v12, v[64:67] offset:0
    ds_write_b128 v12, v[64:67] offset:1024
    ds_write_b128 v12, v[64:67] offset:2048
    ds_write_b128 v12, v[64:67] offset:3072
    v_cmp_eq_u32 vcc, 32, v1
    v_lshlrev_b32 v12, 5, v2
    v_lshl_add_u32 v12, v3, 9, v12
    v_add_u32 v12, v12, v4
    v_add_u32 v12, 1084, v12
    v_cndmask_b32 v72, v213, v212, vcc
    v_cndmask_b32 v73, v214, v213, vcc
    v_cndmask_b32 v74, v215, v64, vcc
    v_cvt_pk_bf16_f32 v76, v212, v213
    v_cvt_pk_bf16_f32 v77, v214, v215
    v_cndmask_b32 v76, v76, v64, vcc
    v_cvt_pk_bf16_f32 v64, v212, v212
    v_cvt_pk_bf16_f32 v65, v212, v212
    v_cvt_pk_bf16_f32 v66, v72, v212
    v_cvt_pk_bf16_f32 v67, v73, v72
    v_cvt_pk_bf16_f32 v68, v73, v73
    v_cvt_pk_bf16_f32 v69, v73, v73
    v_cvt_pk_bf16_f32 v70, v74, v73
    v_cvt_pk_bf16_f32 v71, v74, v74
    s_mov_b32 exec_hi, 1
    ds_write_b128 v12, v[64:67] offset:4
    ds_write_b128 v12, v[68:71] offset:20
    ds_write_b16 v12, v64
    s_mov_b32 exec_hi, -1
    v_and_b32 v13, 1, v3
    v_lshrrev_b32 v14, 1, v3
    v_lshlrev_b32 v12, 5, v2
    v_lshl_add_u32 v12, v13, 4, v12
    v_lshl_add_u32 v12, v14, 9, v12
    v_add3_u32 v12, v12, v4, 64
    v_cvt_pk_bf16_f32 v64, v208, v211
    v_cvt_pk_bf16_f32 v65, v209, v208
    v_cvt_pk_bf16_f32 v66, v210, v209
    v_cvt_pk_bf16_f32 v67, v211, v210
    ds_write_b16 v12, v64
    ds_write2_b32 v12, v65, v66 offset0:1 offset1:2
    ds_write_b32 v12, v67 offset:12
    ds_write_b16_d16_hi v12, v64 offset:18
    v_and_b32 v13, 1, v2
    v_lshrrev_b32 v14, 1, v2
    v_lshlrev_b32 v12, 2, v14
    v_lshl_add_u32 v12, v3, 6, v12
    v_mul_u32_u24 v14, 260, v13
    v_add3_u32 v12, v12, v14, v4
    v_add_u32 v12, 2172, v12
    s_mov_b32 exec_lo, 0
    ds_write2_b32 v12, v76, v77 offset0:0 offset1:8
    s_mov_b32 exec_lo, -1
    v_lshlrev_b32 v12, 1, v2
    v_lshl_add_u32 v12, v3, 7, v12
    v_lshl_add_u32 v12, v13, 2, v12
    v_add_u32 v12, v12, v4
    v_add_u32 v12, 2812, v12
    v_add_u32 v14, 2428, v4
    v_cmp_eq_u32 vcc, 0, v1
    v_cvt_pk_bf16_f32 v64, v216, v217
    v_cvt_pk_bf16_f32 v65, v218, v219
    v_cvt_pk_bf16_f32 v66, v216, v216
    v_cndmask_b32 v14, v12, v14, vcc
    ds_write_b16 v14, v64
    ds_write_b16_d16_hi v12, v64 offset:32
    ds_write_b16 v12, v65 offset:64
    ds_write_b16_d16_hi v12, v65 offset:96
    v_readlane_b32 s42, v66, 0
    v_lshlrev_b32 v12, 2, v2
    v_add_u32 v12, v12, v4
    v_lshlrev_b32 v13, 5, v3
    v_sub_u32 v13, v12, v13
    v_add_u32 v13, 104, v13
    v_add_u32 v14, 1024, v13
    v_add_u32 v15, 2048, v13
    v_lshlrev_b32 v64, 4, v3
    v_sub_u32 v12, v12, v64
    v_add_u32 v12, 2292, v12
    v_and_b32 v124, s42, v124
    v_and_b32 v125, s42, v125
    v_and_b32 v126, s42, v126
    v_and_b32 v127, s42, v127
    ds_read2_b32 v[16:17], v13 offset0:6 offset1:4
    ds_read2_b32 v[18:19], v13 offset0:2 offset1:0
    ds_read2_b32 v[20:21], v13 offset0:38 offset1:36
    ds_read2_b32 v[22:23], v13 offset0:34 offset1:32
    ds_read2_b32 v[24:25], v13 offset0:70 offset1:68
    ds_read2_b32 v[26:27], v13 offset0:66 offset1:64
    ds_read2_b32 v[28:29], v13 offset0:102 offset1:100
    ds_read2_b32 v[30:31], v13 offset0:98 offset1:96
    ds_read2_b32 v[32:33], v13 offset0:134 offset1:132
    ds_read2_b32 v[34:35], v13 offset0:130 offset1:128
    ds_read2_b32 v[36:37], v13 offset0:166 offset1:164
    ds_read2_b32 v[38:39], v13 offset0:162 offset1:160
    ds_read2_b32 v[40:41], v13 offset0:198 offset1:196
    ds_read2_b32 v[42:43], v13 offset0:194 offset1:192
    ds_read2_b32 v[44:45], v13 offset0:230 offset1:228
    ds_read2_b32 v[46:47], v13 offset0:226 offset1:224
    ds_read2_b32 v[48:49], v14 offset0:6 offset1:4
    ds_read2_b32 v[50:51], v14 offset0:2 offset1:0
    ds_read2_b32 v[52:53], v14 offset0:38 offset1:36
    ds_read2_b32 v[54:55], v14 offset0:34 offset1:32
    ds_read2_b32 v[56:57], v14 offset0:70 offset1:68
    ds_read2_b32 v[58:59], v14 offset0:66 offset1:64
    ds_read2_b32 v[60:61], v14 offset0:102 offset1:100
    ds_read2_b32 v[62:63], v14 offset0:98 offset1:96
    ds_read2_b32 v[64:65], v14 offset0:134 offset1:132
    ds_read2_b32 v[66:67], v14 offset0:130 offset1:128
    ds_read2_b32 v[68:69], v14 offset0:166 offset1:164
    ds_read2_b32 v[70:71], v14 offset0:162 offset1:160
    ds_read2_b32 v[72:73], v14 offset0:198 offset1:196
    ds_read2_b32 v[74:75], v14 offset0:194 offset1:192
    ds_read2_b32 v[76:77], v14 offset0:230 offset1:228
    ds_read2_b32 v[78:79], v14 offset0:226 offset1:224
    ds_read2_b32 v[80:81], v15 offset0:6 offset1:4
    ds_read2_b32 v[82:83], v15 offset0:2 offset1:0
    ds_read2_b32 v[84:85], v12 offset0:3 offset1:2
    ds_read2_b32 v[86:87], v12 offset0:1 offset1:0
    ds_read2_b32 v[88:89], v12 offset0:19 offset1:18
    ds_read2_b32 v[90:91], v12 offset0:17 offset1:16
    ds_read2_b32 v[92:93], v12 offset0:35 offset1:34
    ds_read2_b32 v[94:95], v12 offset0:33 offset1:32
    ds_read2_b32 v[96:97], v12 offset0:67 offset1:66
    ds_read2_b32 v[98:99], v12 offset0:65 offset1:64
    ds_read2_b32 v[100:101], v12 offset0:83 offset1:82
    ds_read2_b32 v[102:103], v12 offset0:81 offset1:80
    ds_read2_b32 v[104:105], v12 offset0:99 offset1:98
    ds_read2_b32 v[106:107], v12 offset0:97 offset1:96
    ds_read2_b32 v[108:109], v12 offset0:131 offset1:130
    ds_read2_b32 v[110:111], v12 offset0:129 offset1:128
    ds_read2_b32 v[112:113], v12 offset0:147 offset1:146
    ds_read2_b32 v[114:115], v12 offset0:145 offset1:144
    ds_read2_b32 v[116:117], v12 offset0:163 offset1:162
    ds_read2_b32 v[118:119], v12 offset0:161 offset1:160
    ds_read2_b32 v[120:121], v12 offset0:179 offset1:178
    ds_read2_b32 v[122:123], v12 offset0:177 offset1:176
    s_waitcnt vmcnt(0)
    v_lshlrev_b32 v232, 16, v236
    v_and_b32 v233, 0xffff0000, v236
    v_lshlrev_b32 v234, 16, v237
    v_and_b32 v235, 0xffff0000, v237
    v_add_f32 v232, 1.0, v232
    v_add_f32 v233, 1.0, v233
    v_add_f32 v234, 1.0, v234
    v_add_f32 v235, 1.0, v235
    v_lshlrev_b32 v176, 16, v240
    v_lshlrev_b32 v177, 16, v242
    v_lshlrev_b32 v178, 16, v244
    v_lshlrev_b32 v179, 16, v246
    v_lshlrev_b32 v180, 16, v248
    v_lshlrev_b32 v181, 16, v250
    v_lshlrev_b32 v182, 16, v252
    v_lshlrev_b32 v183, 16, v254
    v_and_b32 v184, 0xffff0000, v240
    v_and_b32 v185, 0xffff0000, v242
    v_and_b32 v186, 0xffff0000, v244
    v_and_b32 v187, 0xffff0000, v246
    v_and_b32 v188, 0xffff0000, v248
    v_and_b32 v189, 0xffff0000, v250
    v_and_b32 v190, 0xffff0000, v252
    v_and_b32 v191, 0xffff0000, v254
    v_lshlrev_b32 v192, 16, v241
    v_lshlrev_b32 v193, 16, v243
    v_lshlrev_b32 v194, 16, v245
    v_lshlrev_b32 v195, 16, v247
    v_lshlrev_b32 v196, 16, v249
    v_lshlrev_b32 v197, 16, v251
    v_lshlrev_b32 v198, 16, v253
    v_lshlrev_b32 v199, 16, v255
    v_and_b32 v200, 0xffff0000, v241
    v_and_b32 v201, 0xffff0000, v243
    v_and_b32 v202, 0xffff0000, v245
    v_and_b32 v203, 0xffff0000, v247
    v_and_b32 v204, 0xffff0000, v249
    v_and_b32 v205, 0xffff0000, v251
    v_and_b32 v206, 0xffff0000, v253
    v_and_b32 v207, 0xffff0000, v255
    v_and_b32 v160, 0xffff0000, v144
    v_lshlrev_b32 v168, 16, v144
    v_rcp_f32 v160, v160
    v_and_b32 v161, 0xffff0000, v146
    v_lshlrev_b32 v169, 16, v146
    v_rcp_f32 v161, v161
    v_and_b32 v162, 0xffff0000, v148
    v_lshlrev_b32 v170, 16, v148
    v_rcp_f32 v162, v162
    v_and_b32 v163, 0xffff0000, v150
    v_lshlrev_b32 v171, 16, v150
    v_rcp_f32 v163, v163
    v_and_b32 v164, 0xffff0000, v152
    v_lshlrev_b32 v172, 16, v152
    v_rcp_f32 v164, v164
    v_and_b32 v165, 0xffff0000, v154
    v_lshlrev_b32 v173, 16, v154
    v_rcp_f32 v165, v165
    v_and_b32 v166, 0xffff0000, v156
    v_lshlrev_b32 v174, 16, v156
    v_rcp_f32 v166, v166
    v_and_b32 v167, 0xffff0000, v158
    v_lshlrev_b32 v175, 16, v158
    v_rcp_f32 v167, v167
    v_pk_mul_f32 v[168:169], v[168:169], v[160:161] neg_lo:[1,0] neg_hi:[1,0]
    v_pk_mul_f32 v[170:171], v[170:171], v[162:163] neg_lo:[1,0] neg_hi:[1,0]
    v_pk_mul_f32 v[172:173], v[172:173], v[164:165] neg_lo:[1,0] neg_hi:[1,0]
    v_pk_mul_f32 v[174:175], v[174:175], v[166:167] neg_lo:[1,0] neg_hi:[1,0]
    v_pk_fma_f32 v[208:209], v[176:177], v[160:161], v[168:169]
    v_pk_fma_f32 v[210:211], v[178:179], v[162:163], v[170:171]
    v_pk_fma_f32 v[212:213], v[180:181], v[164:165], v[172:173]
    v_pk_fma_f32 v[214:215], v[182:183], v[166:167], v[174:175]
    v_cvt_pk_bf16_f32 v216, v208, v209
    v_pk_fma_f32 v[208:209], v[208:209], v[232:233], v[176:177] op_sel:[0,0,0] op_sel_hi:[1,0,1]
    v_cvt_pk_bf16_f32 v217, v210, v211
    v_pk_fma_f32 v[210:211], v[210:211], v[232:233], v[178:179] op_sel:[0,0,0] op_sel_hi:[1,0,1]
    v_cvt_pk_bf16_f32 v218, v212, v213
    v_pk_fma_f32 v[212:213], v[212:213], v[232:233], v[180:181] op_sel:[0,0,0] op_sel_hi:[1,0,1]
    v_cvt_pk_bf16_f32 v219, v214, v215
    v_pk_fma_f32 v[214:215], v[214:215], v[232:233], v[182:183] op_sel:[0,0,0] op_sel_hi:[1,0,1]
    v_cvt_pk_bf16_f32 v220, v208, v209
    v_cvt_pk_bf16_f32 v221, v210, v211
    v_cvt_pk_bf16_f32 v222, v212, v213
    v_cvt_pk_bf16_f32 v223, v214, v215
    ds_write_b128 v9, v[216:219] offset:512
    ds_write_b128 v9, v[220:223] offset:18432
    v_pk_fma_f32 v[208:209], v[184:185], v[160:161], v[168:169]
    v_pk_fma_f32 v[210:211], v[186:187], v[162:163], v[170:171]
    v_pk_fma_f32 v[212:213], v[188:189], v[164:165], v[172:173]
    v_pk_fma_f32 v[214:215], v[190:191], v[166:167], v[174:175]
    v_cvt_pk_bf16_f32 v224, v208, v209
    v_pk_fma_f32 v[208:209], v[208:209], v[232:233], v[184:185] op_sel:[0,1,0] op_sel_hi:[1,1,1]
    v_cvt_pk_bf16_f32 v225, v210, v211
    v_pk_fma_f32 v[210:211], v[210:211], v[232:233], v[186:187] op_sel:[0,1,0] op_sel_hi:[1,1,1]
    v_cvt_pk_bf16_f32 v226, v212, v213
    v_pk_fma_f32 v[212:213], v[212:213], v[232:233], v[188:189] op_sel:[0,1,0] op_sel_hi:[1,1,1]
    v_cvt_pk_bf16_f32 v227, v214, v215
    v_pk_fma_f32 v[214:215], v[214:215], v[232:233], v[190:191] op_sel:[0,1,0] op_sel_hi:[1,1,1]
    v_cvt_pk_bf16_f32 v228, v208, v209
    v_cvt_pk_bf16_f32 v229, v210, v211
    v_cvt_pk_bf16_f32 v230, v212, v213
    v_cvt_pk_bf16_f32 v231, v214, v215
    ds_write_b128 v9, v[224:227] offset:5120
    ds_write_b128 v9, v[228:231] offset:22592
    v_pk_fma_f32 v[208:209], v[192:193], v[160:161], v[168:169]
    v_pk_fma_f32 v[210:211], v[194:195], v[162:163], v[170:171]
    v_pk_fma_f32 v[212:213], v[196:197], v[164:165], v[172:173]
    v_pk_fma_f32 v[214:215], v[198:199], v[166:167], v[174:175]
    v_cvt_pk_bf16_f32 v216, v208, v209
    v_pk_fma_f32 v[208:209], v[208:209], v[234:235], v[192:193] op_sel:[0,0,0] op_sel_hi:[1,0,1]
    v_cvt_pk_bf16_f32 v217, v210, v211
    v_pk_fma_f32 v[210:211], v[210:211], v[234:235], v[194:195] op_sel:[0,0,0] op_sel_hi:[1,0,1]
    v_cvt_pk_bf16_f32 v218, v212, v213
    v_pk_fma_f32 v[212:213], v[212:213], v[234:235], v[196:197] op_sel:[0,0,0] op_sel_hi:[1,0,1]
    v_cvt_pk_bf16_f32 v219, v214, v215
    v_pk_fma_f32 v[214:215], v[214:215], v[234:235], v[198:199] op_sel:[0,0,0] op_sel_hi:[1,0,1]
    v_cvt_pk_bf16_f32 v220, v208, v209
    v_cvt_pk_bf16_f32 v221, v210, v211
    v_cvt_pk_bf16_f32 v222, v212, v213
    v_cvt_pk_bf16_f32 v223, v214, v215
    ds_write_b128 v9, v[216:219] offset:9728
    ds_write_b128 v9, v[220:223] offset:26752
    v_pk_fma_f32 v[208:209], v[200:201], v[160:161], v[168:169]
    v_pk_fma_f32 v[210:211], v[202:203], v[162:163], v[170:171]
    v_pk_fma_f32 v[212:213], v[204:205], v[164:165], v[172:173]
    v_pk_fma_f32 v[214:215], v[206:207], v[166:167], v[174:175]
    v_cvt_pk_bf16_f32 v224, v208, v209
    v_pk_fma_f32 v[208:209], v[208:209], v[234:235], v[200:201] op_sel:[0,1,0] op_sel_hi:[1,1,1]
    v_cvt_pk_bf16_f32 v225, v210, v211
    v_pk_fma_f32 v[210:211], v[210:211], v[234:235], v[202:203] op_sel:[0,1,0] op_sel_hi:[1,1,1]
    v_cvt_pk_bf16_f32 v226, v212, v213
    v_pk_fma_f32 v[212:213], v[212:213], v[234:235], v[204:205] op_sel:[0,1,0] op_sel_hi:[1,1,1]
    v_cvt_pk_bf16_f32 v227, v214, v215
    v_pk_fma_f32 v[214:215], v[214:215], v[234:235], v[206:207] op_sel:[0,1,0] op_sel_hi:[1,1,1]
    v_cvt_pk_bf16_f32 v228, v208, v209
    v_cvt_pk_bf16_f32 v229, v210, v211
    v_cvt_pk_bf16_f32 v230, v212, v213
    v_cvt_pk_bf16_f32 v231, v214, v215
    ds_write_b128 v9, v[224:227] offset:14336
    ds_write_b128 v9, v[228:231] offset:30912
    s_waitcnt lgkmcnt(0)
    s_barrier
    ds_read_b128 v[176:179], v7 offset:0
    ds_read_b128 v[180:183], v7 offset:64
    ds_read_b128 v[184:187], v7 offset:128
    ds_read_b128 v[188:191], v7 offset:192
    ds_read_b64 v[204:205], v8 offset:0
    s_waitcnt lgkmcnt(0)
    v_lshlrev_b32 v144, 16, v204
    v_and_b32 v145, 0xffff0000, v204
    v_lshlrev_b32 v146, 16, v205
    v_and_b32 v147, 0xffff0000, v205
    ds_read_b64 v[206:207], v8 offset:512
    s_waitcnt lgkmcnt(0)
    v_lshlrev_b32 v148, 16, v206
    v_and_b32 v149, 0xffff0000, v206
    v_lshlrev_b32 v150, 16, v207
    v_and_b32 v151, 0xffff0000, v207
    v_mfma_f32_16x16x32_bf16 v[144:147], v[44:47], v[176:179], v[144:147]
    ds_read_b128 v[192:195], v7 offset:256
    ds_read_b128 v[196:199], v7 offset:320
    v_mfma_f32_16x16x32_bf16 v[148:151], v[76:79], v[176:179], v[148:151]
    ds_read_b128 v[176:179], v7 offset:384
    ds_read_b64 v[208:209], v8 offset:1024
    v_mfma_f32_16x16x32_bf16 v[144:147], v[40:43], v[180:183], v[144:147]
    ds_read_b64 v[210:211], v8 offset:1536
    ds_read_b64 v[212:213], v8 offset:2048
    v_mfma_f32_16x16x32_bf16 v[148:151], v[72:75], v[180:183], v[148:151]
    ds_read_b128 v[180:183], v7 offset:448
    ds_read_b64 v[214:215], v8 offset:2560
    v_mfma_f32_16x16x32_bf16 v[144:147], v[36:39], v[184:187], v[144:147]
    ds_read_b64 v[216:217], v8 offset:3072
    ds_read_b64 v[218:219], v8 offset:3584
    v_mfma_f32_16x16x32_bf16 v[148:151], v[68:71], v[184:187], v[148:151]
    ds_read_b128 v[200:203], v7 offset:432
    s_waitcnt lgkmcnt(7)
    v_lshlrev_b32 v152, 16, v208
    v_mfma_f32_16x16x32_bf16 v[144:147], v[32:35], v[188:191], v[144:147]
    v_and_b32 v153, 0xffff0000, v208
    v_lshlrev_b32 v154, 16, v209
    v_mfma_f32_16x16x32_bf16 v[148:151], v[64:67], v[188:191], v[148:151]
    v_and_b32 v155, 0xffff0000, v209
    s_waitcnt lgkmcnt(6)
    v_lshlrev_b32 v156, 16, v210
    v_mfma_f32_16x16x32_bf16 v[144:147], v[28:31], v[192:195], v[144:147]
    v_and_b32 v157, 0xffff0000, v210
    v_lshlrev_b32 v158, 16, v211
    v_mfma_f32_16x16x32_bf16 v[148:151], v[60:63], v[192:195], v[148:151]
    v_and_b32 v159, 0xffff0000, v211
    s_waitcnt lgkmcnt(5)
    v_lshlrev_b32 v160, 16, v212
    v_mfma_f32_16x16x32_bf16 v[144:147], v[24:27], v[196:199], v[144:147]
    v_and_b32 v161, 0xffff0000, v212
    v_lshlrev_b32 v162, 16, v213
    v_mfma_f32_16x16x32_bf16 v[148:151], v[56:59], v[196:199], v[148:151]
    v_and_b32 v163, 0xffff0000, v213
    s_waitcnt lgkmcnt(3)
    v_lshlrev_b32 v164, 16, v214
    v_mfma_f32_16x16x32_bf16 v[144:147], v[20:23], v[176:179], v[144:147]
    v_and_b32 v165, 0xffff0000, v214
    v_lshlrev_b32 v166, 16, v215
    v_mfma_f32_16x16x32_bf16 v[148:151], v[52:55], v[176:179], v[148:151]
    v_and_b32 v167, 0xffff0000, v215
    s_waitcnt lgkmcnt(2)
    v_lshlrev_b32 v168, 16, v216
    v_mfma_f32_16x16x32_bf16 v[144:147], v[16:19], v[180:183], v[144:147]
    v_and_b32 v169, 0xffff0000, v216
    v_lshlrev_b32 v170, 16, v217
    v_mfma_f32_16x16x32_bf16 v[148:151], v[48:51], v[180:183], v[148:151]
    v_and_b32 v171, 0xffff0000, v217
    s_waitcnt lgkmcnt(1)
    v_lshlrev_b32 v172, 16, v218
    v_and_b32 v173, 0xffff0000, v218
    v_lshlrev_b32 v174, 16, v219
    v_and_b32 v175, 0xffff0000, v219
    v_mfma_f32_16x16x32_bf16 v[152:155], v[80:83], v[180:183], v[152:155]
    ds_read_b128 v[184:187], v7 offset:512
    ds_read_b128 v[188:191], v7 offset:576
    v_mfma_f32_16x16x32_bf16 v[212:215], v[180:183], v[128:131], 0
    ds_read_b128 v[192:195], v7 offset:640
    ds_read_b128 v[196:199], v7 offset:704
    v_mfma_f32_16x16x32_bf16 v[216:219], v[180:183], v[132:135], 0
    v_cvt_pk_bf16_f32 v12, v144, v145
    v_cvt_pk_bf16_f32 v13, v146, v147
    v_mfma_f32_16x16x32_bf16 v[224:227], v[180:183], v[140:143], 0
    ds_write_b64 v8, v[12:13] offset:0
    ds_read_b128 v[176:179], v7 offset:768
    v_mfma_f32_16x16x32_bf16 v[160:163], v[124:127], v[180:183], v[160:163]
    ds_read_b128 v[180:183], v7 offset:832
    s_waitcnt lgkmcnt(7)
    v_mfma_f32_16x16x32_bf16 v[204:207], v[200:203], v[128:131], 0
    v_cvt_pk_bf16_f32 v232, v212, v216
    v_cvt_pk_bf16_f32 v233, v213, v217
    v_mfma_f32_16x16x32_bf16 v[208:211], v[200:203], v[132:135], 0
    v_cvt_pk_bf16_f32 v234, v214, v218
    v_cvt_pk_bf16_f32 v235, v215, v219
    v_mfma_f32_16x16x32_bf16 v[220:223], v[200:203], v[136:139], 0
    ds_read_b128 v[200:203], v7 offset:944
    s_waitcnt lgkmcnt(7)
    v_mfma_f32_16x16x32_bf16 v[148:151], v[44:47], v[184:187], v[148:151]
    v_mfma_f32_16x16x32_bf16 v[152:155], v[76:79], v[184:187], v[152:155]
    s_nop 0
    v_cvt_pk_bf16_f32 v228, v204, v208
    v_cvt_pk_bf16_f32 v229, v205, v209
    s_waitcnt lgkmcnt(6)
    v_mfma_f32_16x16x32_bf16 v[148:151], v[40:43], v[188:191], v[148:151]
    v_cvt_pk_bf16_f32 v230, v206, v210
    v_cvt_pk_bf16_f32 v231, v207, v211
    v_mfma_f32_16x16x32_bf16 v[152:155], v[72:75], v[188:191], v[152:155]
    v_cvt_pk_bf16_f32 v236, v220, v224
    v_cvt_pk_bf16_f32 v237, v221, v225
    v_mfma_f32_16x16x32_bf16 v[152:155], v[232:235], v[96:99], v[152:155]
    v_cvt_pk_bf16_f32 v238, v222, v226
    v_cvt_pk_bf16_f32 v239, v223, v227
    v_mfma_f32_16x16x32_bf16 v[156:159], v[232:235], v[100:103], v[156:159]
    ds_read_b128 v[184:187], v7 offset:896
    ds_read_b128 v[188:191], v7 offset:960
    v_mfma_f32_16x16x32_bf16 v[160:163], v[232:235], v[104:107], v[160:163]
    s_waitcnt lgkmcnt(7)
    v_mfma_f32_16x16x32_bf16 v[148:151], v[36:39], v[192:195], v[148:151]
    v_mfma_f32_16x16x32_bf16 v[152:155], v[68:71], v[192:195], v[152:155]
    ds_read_b128 v[192:195], v7 offset:1024
    v_mfma_f32_16x16x32_bf16 v[152:155], v[228:231], v[84:87], v[152:155]
    v_mfma_f32_16x16x32_bf16 v[156:159], v[228:231], v[88:91], v[156:159]
    v_mfma_f32_16x16x32_bf16 v[160:163], v[228:231], v[92:95], v[160:163]
    s_waitcnt lgkmcnt(7)
    v_mfma_f32_16x16x32_bf16 v[148:151], v[32:35], v[196:199], v[148:151]
    v_mfma_f32_16x16x32_bf16 v[152:155], v[64:67], v[196:199], v[152:155]
    ds_read_b128 v[196:199], v7 offset:1088
    v_mfma_f32_16x16x32_bf16 v[160:163], v[236:239], v[108:111], v[160:163]
    v_mfma_f32_16x16x32_bf16 v[164:167], v[236:239], v[112:115], v[164:167]
    v_mfma_f32_16x16x32_bf16 v[168:171], v[236:239], v[116:119], v[168:171]
    v_mfma_f32_16x16x32_bf16 v[172:175], v[236:239], v[120:123], v[172:175]
    s_waitcnt lgkmcnt(6)
    v_mfma_f32_16x16x32_bf16 v[148:151], v[28:31], v[176:179], v[148:151]
    v_mfma_f32_16x16x32_bf16 v[152:155], v[60:63], v[176:179], v[152:155]
    ds_read_b128 v[176:179], v7 offset:1152
    s_waitcnt lgkmcnt(6)
    v_mfma_f32_16x16x32_bf16 v[148:151], v[24:27], v[180:183], v[148:151]
    v_mfma_f32_16x16x32_bf16 v[152:155], v[56:59], v[180:183], v[152:155]
    ds_read_b128 v[180:183], v7 offset:1216
    s_waitcnt lgkmcnt(5)
    v_mfma_f32_16x16x32_bf16 v[148:151], v[20:23], v[184:187], v[148:151]
    v_mfma_f32_16x16x32_bf16 v[152:155], v[52:55], v[184:187], v[152:155]
    ds_read_b128 v[184:187], v7 offset:1280
    s_waitcnt lgkmcnt(5)
    v_mfma_f32_16x16x32_bf16 v[148:151], v[16:19], v[188:191], v[148:151]
    v_mfma_f32_16x16x32_bf16 v[152:155], v[48:51], v[188:191], v[152:155]
    v_mfma_f32_16x16x32_bf16 v[156:159], v[80:83], v[188:191], v[156:159]
    v_mfma_f32_16x16x32_bf16 v[212:215], v[188:191], v[128:131], 0
    v_mfma_f32_16x16x32_bf16 v[216:219], v[188:191], v[132:135], 0
    s_nop 3
    v_cvt_pk_bf16_f32 v14, v148, v149
    v_cvt_pk_bf16_f32 v15, v150, v151
    v_mfma_f32_16x16x32_bf16 v[224:227], v[188:191], v[140:143], 0
    ds_write_b64 v8, v[14:15] offset:512
    v_mfma_f32_16x16x32_bf16 v[164:167], v[124:127], v[188:191], v[164:167]
    ds_read_b128 v[188:191], v7 offset:1344
    v_mfma_f32_16x16x32_bf16 v[204:207], v[200:203], v[128:131], 0
    v_cvt_pk_bf16_f32 v232, v212, v216
    v_cvt_pk_bf16_f32 v233, v213, v217
    v_mfma_f32_16x16x32_bf16 v[208:211], v[200:203], v[132:135], 0
    v_cvt_pk_bf16_f32 v234, v214, v218
    v_cvt_pk_bf16_f32 v235, v215, v219
    v_mfma_f32_16x16x32_bf16 v[220:223], v[200:203], v[136:139], 0
    ds_read_b128 v[200:203], v7 offset:1456
    s_waitcnt lgkmcnt(7)
    v_mfma_f32_16x16x32_bf16 v[152:155], v[44:47], v[192:195], v[152:155]
    v_mfma_f32_16x16x32_bf16 v[156:159], v[76:79], v[192:195], v[156:159]
    s_nop 0
    v_cvt_pk_bf16_f32 v228, v204, v208
    v_cvt_pk_bf16_f32 v229, v205, v209
    s_waitcnt lgkmcnt(6)
    v_mfma_f32_16x16x32_bf16 v[152:155], v[40:43], v[196:199], v[152:155]
    v_cvt_pk_bf16_f32 v230, v206, v210
    v_cvt_pk_bf16_f32 v231, v207, v211
    v_mfma_f32_16x16x32_bf16 v[156:159], v[72:75], v[196:199], v[156:159]
    v_cvt_pk_bf16_f32 v236, v220, v224
    v_cvt_pk_bf16_f32 v237, v221, v225
    v_mfma_f32_16x16x32_bf16 v[156:159], v[232:235], v[96:99], v[156:159]
    v_cvt_pk_bf16_f32 v238, v222, v226
    v_cvt_pk_bf16_f32 v239, v223, v227
    v_mfma_f32_16x16x32_bf16 v[160:163], v[232:235], v[100:103], v[160:163]
    ds_read_b128 v[192:195], v7 offset:1408
    ds_read_b128 v[196:199], v7 offset:1472
    v_mfma_f32_16x16x32_bf16 v[164:167], v[232:235], v[104:107], v[164:167]
    s_waitcnt lgkmcnt(7)
    v_mfma_f32_16x16x32_bf16 v[152:155], v[36:39], v[176:179], v[152:155]
    v_mfma_f32_16x16x32_bf16 v[156:159], v[68:71], v[176:179], v[156:159]
    ds_read_b128 v[176:179], v7 offset:1536
    v_mfma_f32_16x16x32_bf16 v[156:159], v[228:231], v[84:87], v[156:159]
    v_mfma_f32_16x16x32_bf16 v[160:163], v[228:231], v[88:91], v[160:163]
    v_mfma_f32_16x16x32_bf16 v[164:167], v[228:231], v[92:95], v[164:167]
    s_waitcnt lgkmcnt(7)
    v_mfma_f32_16x16x32_bf16 v[152:155], v[32:35], v[180:183], v[152:155]
    v_mfma_f32_16x16x32_bf16 v[156:159], v[64:67], v[180:183], v[156:159]
    ds_read_b128 v[180:183], v7 offset:1600
    v_mfma_f32_16x16x32_bf16 v[164:167], v[236:239], v[108:111], v[164:167]
    v_mfma_f32_16x16x32_bf16 v[168:171], v[236:239], v[112:115], v[168:171]
    v_mfma_f32_16x16x32_bf16 v[172:175], v[236:239], v[116:119], v[172:175]
    s_waitcnt lgkmcnt(7)
    v_mfma_f32_16x16x32_bf16 v[152:155], v[28:31], v[184:187], v[152:155]
    v_mfma_f32_16x16x32_bf16 v[156:159], v[60:63], v[184:187], v[156:159]
    ds_read_b128 v[184:187], v7 offset:1664
    s_waitcnt lgkmcnt(6)
    v_mfma_f32_16x16x32_bf16 v[152:155], v[24:27], v[188:191], v[152:155]
    v_mfma_f32_16x16x32_bf16 v[156:159], v[56:59], v[188:191], v[156:159]
    ds_read_b128 v[188:191], v7 offset:1728
    s_waitcnt lgkmcnt(5)
    v_mfma_f32_16x16x32_bf16 v[152:155], v[20:23], v[192:195], v[152:155]
    v_mfma_f32_16x16x32_bf16 v[156:159], v[52:55], v[192:195], v[156:159]
    ds_read_b128 v[192:195], v7 offset:1792
    s_waitcnt lgkmcnt(5)
    v_mfma_f32_16x16x32_bf16 v[152:155], v[16:19], v[196:199], v[152:155]
    v_mfma_f32_16x16x32_bf16 v[156:159], v[48:51], v[196:199], v[156:159]
    v_mfma_f32_16x16x32_bf16 v[160:163], v[80:83], v[196:199], v[160:163]
    v_mfma_f32_16x16x32_bf16 v[212:215], v[196:199], v[128:131], 0
    v_mfma_f32_16x16x32_bf16 v[216:219], v[196:199], v[132:135], 0
    s_nop 3
    v_cvt_pk_bf16_f32 v12, v152, v153
    v_cvt_pk_bf16_f32 v13, v154, v155
    v_mfma_f32_16x16x32_bf16 v[224:227], v[196:199], v[140:143], 0
    ds_write_b64 v8, v[12:13] offset:1024
    v_mfma_f32_16x16x32_bf16 v[168:171], v[124:127], v[196:199], v[168:171]
    ds_read_b128 v[196:199], v7 offset:1856
    v_mfma_f32_16x16x32_bf16 v[204:207], v[200:203], v[128:131], 0
    v_cvt_pk_bf16_f32 v232, v212, v216
    v_cvt_pk_bf16_f32 v233, v213, v217
    v_mfma_f32_16x16x32_bf16 v[208:211], v[200:203], v[132:135], 0
    v_cvt_pk_bf16_f32 v234, v214, v218
    v_cvt_pk_bf16_f32 v235, v215, v219
    v_mfma_f32_16x16x32_bf16 v[220:223], v[200:203], v[136:139], 0
    ds_read_b128 v[200:203], v7 offset:1968
    s_waitcnt lgkmcnt(7)
    v_mfma_f32_16x16x32_bf16 v[156:159], v[44:47], v[176:179], v[156:159]
    v_mfma_f32_16x16x32_bf16 v[160:163], v[76:79], v[176:179], v[160:163]
    s_nop 0
    v_cvt_pk_bf16_f32 v228, v204, v208
    v_cvt_pk_bf16_f32 v229, v205, v209
    s_waitcnt lgkmcnt(6)
    v_mfma_f32_16x16x32_bf16 v[156:159], v[40:43], v[180:183], v[156:159]
    v_cvt_pk_bf16_f32 v230, v206, v210
    v_cvt_pk_bf16_f32 v231, v207, v211
    v_mfma_f32_16x16x32_bf16 v[160:163], v[72:75], v[180:183], v[160:163]
    v_cvt_pk_bf16_f32 v236, v220, v224
    v_cvt_pk_bf16_f32 v237, v221, v225
    v_mfma_f32_16x16x32_bf16 v[160:163], v[232:235], v[96:99], v[160:163]
    v_cvt_pk_bf16_f32 v238, v222, v226
    v_cvt_pk_bf16_f32 v239, v223, v227
    v_mfma_f32_16x16x32_bf16 v[164:167], v[232:235], v[100:103], v[164:167]
    ds_read_b128 v[176:179], v7 offset:1920
    ds_read_b128 v[180:183], v7 offset:1984
    v_mfma_f32_16x16x32_bf16 v[168:171], v[232:235], v[104:107], v[168:171]
    s_waitcnt lgkmcnt(7)
    v_mfma_f32_16x16x32_bf16 v[156:159], v[36:39], v[184:187], v[156:159]
    v_mfma_f32_16x16x32_bf16 v[160:163], v[68:71], v[184:187], v[160:163]
    ds_read_b128 v[184:187], v7 offset:2048
    v_mfma_f32_16x16x32_bf16 v[160:163], v[228:231], v[84:87], v[160:163]
    v_mfma_f32_16x16x32_bf16 v[164:167], v[228:231], v[88:91], v[164:167]
    v_mfma_f32_16x16x32_bf16 v[168:171], v[228:231], v[92:95], v[168:171]
    s_waitcnt lgkmcnt(7)
    v_mfma_f32_16x16x32_bf16 v[156:159], v[32:35], v[188:191], v[156:159]
    v_mfma_f32_16x16x32_bf16 v[160:163], v[64:67], v[188:191], v[160:163]
    ds_read_b128 v[188:191], v7 offset:2112
    v_mfma_f32_16x16x32_bf16 v[168:171], v[236:239], v[108:111], v[168:171]
    v_mfma_f32_16x16x32_bf16 v[172:175], v[236:239], v[112:115], v[172:175]
    s_waitcnt lgkmcnt(7)
    v_mfma_f32_16x16x32_bf16 v[156:159], v[28:31], v[192:195], v[156:159]
    v_mfma_f32_16x16x32_bf16 v[160:163], v[60:63], v[192:195], v[160:163]
    ds_read_b128 v[192:195], v7 offset:2176
    s_waitcnt lgkmcnt(6)
    v_mfma_f32_16x16x32_bf16 v[156:159], v[24:27], v[196:199], v[156:159]
    v_mfma_f32_16x16x32_bf16 v[160:163], v[56:59], v[196:199], v[160:163]
    ds_read_b128 v[196:199], v7 offset:2240
    s_waitcnt lgkmcnt(5)
    v_mfma_f32_16x16x32_bf16 v[156:159], v[20:23], v[176:179], v[156:159]
    v_mfma_f32_16x16x32_bf16 v[160:163], v[52:55], v[176:179], v[160:163]
    ds_read_b128 v[176:179], v7 offset:2304
    s_waitcnt lgkmcnt(5)
    v_mfma_f32_16x16x32_bf16 v[156:159], v[16:19], v[180:183], v[156:159]
    v_mfma_f32_16x16x32_bf16 v[160:163], v[48:51], v[180:183], v[160:163]
    v_mfma_f32_16x16x32_bf16 v[164:167], v[80:83], v[180:183], v[164:167]
    v_mfma_f32_16x16x32_bf16 v[212:215], v[180:183], v[128:131], 0
    v_mfma_f32_16x16x32_bf16 v[216:219], v[180:183], v[132:135], 0
    s_nop 3
    v_cvt_pk_bf16_f32 v14, v156, v157
    v_cvt_pk_bf16_f32 v15, v158, v159
    v_mfma_f32_16x16x32_bf16 v[224:227], v[180:183], v[140:143], 0
    ds_write_b64 v8, v[14:15] offset:1536
    v_mfma_f32_16x16x32_bf16 v[172:175], v[124:127], v[180:183], v[172:175]
    ds_read_b128 v[180:183], v7 offset:2368
    v_mfma_f32_16x16x32_bf16 v[204:207], v[200:203], v[128:131], 0
    v_cvt_pk_bf16_f32 v232, v212, v216
    v_cvt_pk_bf16_f32 v233, v213, v217
    v_mfma_f32_16x16x32_bf16 v[208:211], v[200:203], v[132:135], 0
    v_cvt_pk_bf16_f32 v234, v214, v218
    v_cvt_pk_bf16_f32 v235, v215, v219
    v_mfma_f32_16x16x32_bf16 v[220:223], v[200:203], v[136:139], 0
    ds_read_b128 v[200:203], v7 offset:2480
    s_waitcnt lgkmcnt(7)
    v_mfma_f32_16x16x32_bf16 v[160:163], v[44:47], v[184:187], v[160:163]
    v_mfma_f32_16x16x32_bf16 v[164:167], v[76:79], v[184:187], v[164:167]
    s_nop 0
    v_cvt_pk_bf16_f32 v228, v204, v208
    v_cvt_pk_bf16_f32 v229, v205, v209
    s_waitcnt lgkmcnt(6)
    v_mfma_f32_16x16x32_bf16 v[160:163], v[40:43], v[188:191], v[160:163]
    v_cvt_pk_bf16_f32 v230, v206, v210
    v_cvt_pk_bf16_f32 v231, v207, v211
    v_mfma_f32_16x16x32_bf16 v[164:167], v[72:75], v[188:191], v[164:167]
    ds_read_b128 v[184:187], v7 offset:2432
    v_cvt_pk_bf16_f32 v236, v220, v224
    v_mfma_f32_16x16x32_bf16 v[164:167], v[232:235], v[96:99], v[164:167]
    v_cvt_pk_bf16_f32 v237, v221, v225
    v_cvt_pk_bf16_f32 v238, v222, v226
    v_mfma_f32_16x16x32_bf16 v[168:171], v[232:235], v[100:103], v[168:171]
    v_cvt_pk_bf16_f32 v239, v223, v227
    ds_read_b128 v[188:191], v7 offset:2496
    v_mfma_f32_16x16x32_bf16 v[172:175], v[232:235], v[104:107], v[172:175]
    s_waitcnt lgkmcnt(7)
    v_mfma_f32_16x16x32_bf16 v[160:163], v[36:39], v[192:195], v[160:163]
    v_mfma_f32_16x16x32_bf16 v[164:167], v[68:71], v[192:195], v[164:167]
    ds_read_b128 v[192:195], v7 offset:2560
    v_mfma_f32_16x16x32_bf16 v[164:167], v[228:231], v[84:87], v[164:167]
    v_mfma_f32_16x16x32_bf16 v[168:171], v[228:231], v[88:91], v[168:171]
    v_mfma_f32_16x16x32_bf16 v[172:175], v[228:231], v[92:95], v[172:175]
    s_waitcnt lgkmcnt(7)
    v_mfma_f32_16x16x32_bf16 v[160:163], v[32:35], v[196:199], v[160:163]
    v_mfma_f32_16x16x32_bf16 v[164:167], v[64:67], v[196:199], v[164:167]
    ds_read_b128 v[196:199], v7 offset:2624
    v_mfma_f32_16x16x32_bf16 v[172:175], v[236:239], v[108:111], v[172:175]
    s_waitcnt lgkmcnt(7)
    v_mfma_f32_16x16x32_bf16 v[160:163], v[28:31], v[176:179], v[160:163]
    v_mfma_f32_16x16x32_bf16 v[164:167], v[60:63], v[176:179], v[164:167]
    ds_read_b128 v[176:179], v7 offset:2688
    s_waitcnt lgkmcnt(6)
    v_mfma_f32_16x16x32_bf16 v[160:163], v[24:27], v[180:183], v[160:163]
    v_mfma_f32_16x16x32_bf16 v[164:167], v[56:59], v[180:183], v[164:167]
    ds_read_b128 v[180:183], v7 offset:2752
    s_waitcnt lgkmcnt(5)
    v_mfma_f32_16x16x32_bf16 v[160:163], v[20:23], v[184:187], v[160:163]
    v_mfma_f32_16x16x32_bf16 v[164:167], v[52:55], v[184:187], v[164:167]
    ds_read_b128 v[184:187], v7 offset:2816
    s_waitcnt lgkmcnt(5)
    v_mfma_f32_16x16x32_bf16 v[160:163], v[16:19], v[188:191], v[160:163]
    v_mfma_f32_16x16x32_bf16 v[164:167], v[48:51], v[188:191], v[164:167]
    v_mfma_f32_16x16x32_bf16 v[168:171], v[80:83], v[188:191], v[168:171]
    v_mfma_f32_16x16x32_bf16 v[212:215], v[188:191], v[128:131], 0
    v_mfma_f32_16x16x32_bf16 v[216:219], v[188:191], v[132:135], 0
    s_nop 3
    v_cvt_pk_bf16_f32 v12, v160, v161
    v_cvt_pk_bf16_f32 v13, v162, v163
    v_mfma_f32_16x16x32_bf16 v[204:207], v[200:203], v[128:131], 0
    ds_write_b64 v8, v[12:13] offset:2048
    ds_read_b128 v[188:191], v7 offset:2880
    v_mfma_f32_16x16x32_bf16 v[208:211], v[200:203], v[132:135], 0
    ds_read_b128 v[200:203], v7 offset:2992
    s_waitcnt lgkmcnt(7)
    v_mfma_f32_16x16x32_bf16 v[164:167], v[44:47], v[192:195], v[164:167]
    v_cvt_pk_bf16_f32 v232, v212, v216
    v_cvt_pk_bf16_f32 v233, v213, v217
    v_mfma_f32_16x16x32_bf16 v[168:171], v[76:79], v[192:195], v[168:171]
    v_cvt_pk_bf16_f32 v234, v214, v218
    v_cvt_pk_bf16_f32 v235, v215, v219
    s_waitcnt lgkmcnt(6)
    v_mfma_f32_16x16x32_bf16 v[164:167], v[40:43], v[196:199], v[164:167]
    v_cvt_pk_bf16_f32 v228, v204, v208
    v_cvt_pk_bf16_f32 v229, v205, v209
    v_mfma_f32_16x16x32_bf16 v[168:171], v[72:75], v[196:199], v[168:171]
    v_cvt_pk_bf16_f32 v230, v206, v210
    v_cvt_pk_bf16_f32 v231, v207, v211
    v_mfma_f32_16x16x32_bf16 v[168:171], v[232:235], v[96:99], v[168:171]
    ds_read_b128 v[192:195], v7 offset:2944
    ds_read_b128 v[196:199], v7 offset:3008
    v_mfma_f32_16x16x32_bf16 v[172:175], v[232:235], v[100:103], v[172:175]
    s_waitcnt lgkmcnt(7)
    v_mfma_f32_16x16x32_bf16 v[164:167], v[36:39], v[176:179], v[164:167]
    v_mfma_f32_16x16x32_bf16 v[168:171], v[68:71], v[176:179], v[168:171]
    ds_read_b128 v[176:179], v7 offset:3072
    v_mfma_f32_16x16x32_bf16 v[168:171], v[228:231], v[84:87], v[168:171]
    v_mfma_f32_16x16x32_bf16 v[172:175], v[228:231], v[88:91], v[172:175]
    s_waitcnt lgkmcnt(7)
    v_mfma_f32_16x16x32_bf16 v[164:167], v[32:35], v[180:183], v[164:167]
    v_mfma_f32_16x16x32_bf16 v[168:171], v[64:67], v[180:183], v[168:171]
    ds_read_b128 v[180:183], v7 offset:3136
    s_waitcnt lgkmcnt(7)
    v_mfma_f32_16x16x32_bf16 v[164:167], v[28:31], v[184:187], v[164:167]
    v_mfma_f32_16x16x32_bf16 v[168:171], v[60:63], v[184:187], v[168:171]
    ds_read_b128 v[184:187], v7 offset:3200
    s_waitcnt lgkmcnt(6)
    v_mfma_f32_16x16x32_bf16 v[164:167], v[24:27], v[188:191], v[164:167]
    v_mfma_f32_16x16x32_bf16 v[168:171], v[56:59], v[188:191], v[168:171]
    ds_read_b128 v[188:191], v7 offset:3264
    s_waitcnt lgkmcnt(5)
    v_mfma_f32_16x16x32_bf16 v[164:167], v[20:23], v[192:195], v[164:167]
    v_mfma_f32_16x16x32_bf16 v[168:171], v[52:55], v[192:195], v[168:171]
    ds_read_b128 v[192:195], v7 offset:3328
    s_waitcnt lgkmcnt(5)
    v_mfma_f32_16x16x32_bf16 v[164:167], v[16:19], v[196:199], v[164:167]
    v_mfma_f32_16x16x32_bf16 v[168:171], v[48:51], v[196:199], v[168:171]
    v_mfma_f32_16x16x32_bf16 v[172:175], v[80:83], v[196:199], v[172:175]
    v_mfma_f32_16x16x32_bf16 v[212:215], v[196:199], v[128:131], 0
    v_mfma_f32_16x16x32_bf16 v[216:219], v[196:199], v[132:135], 0
    s_nop 3
    v_cvt_pk_bf16_f32 v14, v164, v165
    v_cvt_pk_bf16_f32 v15, v166, v167
    v_mfma_f32_16x16x32_bf16 v[204:207], v[200:203], v[128:131], 0
    ds_read_b128 v[196:199], v7 offset:3392
    ds_write_b64 v8, v[14:15] offset:2560
    v_mfma_f32_16x16x32_bf16 v[208:211], v[200:203], v[132:135], 0
    s_waitcnt lgkmcnt(6)
    v_mfma_f32_16x16x32_bf16 v[168:171], v[44:47], v[176:179], v[168:171]
    v_cvt_pk_bf16_f32 v232, v212, v216
    v_cvt_pk_bf16_f32 v233, v213, v217
    v_mfma_f32_16x16x32_bf16 v[172:175], v[76:79], v[176:179], v[172:175]
    v_cvt_pk_bf16_f32 v234, v214, v218
    v_cvt_pk_bf16_f32 v235, v215, v219
    s_waitcnt lgkmcnt(5)
    v_mfma_f32_16x16x32_bf16 v[168:171], v[40:43], v[180:183], v[168:171]
    v_cvt_pk_bf16_f32 v228, v204, v208
    v_cvt_pk_bf16_f32 v229, v205, v209
    v_mfma_f32_16x16x32_bf16 v[172:175], v[72:75], v[180:183], v[172:175]
    v_cvt_pk_bf16_f32 v230, v206, v210
    v_cvt_pk_bf16_f32 v231, v207, v211
    v_mfma_f32_16x16x32_bf16 v[172:175], v[232:235], v[96:99], v[172:175]
    ds_read_b128 v[176:179], v7 offset:3456
    ds_read_b128 v[180:183], v7 offset:3520
    s_waitcnt lgkmcnt(6)
    v_mfma_f32_16x16x32_bf16 v[168:171], v[36:39], v[184:187], v[168:171]
    v_mfma_f32_16x16x32_bf16 v[172:175], v[68:71], v[184:187], v[172:175]
    ds_read_b128 v[184:187], v7 offset:3584
    v_mfma_f32_16x16x32_bf16 v[172:175], v[228:231], v[84:87], v[172:175]
    s_waitcnt lgkmcnt(6)
    v_mfma_f32_16x16x32_bf16 v[168:171], v[32:35], v[188:191], v[168:171]
    v_mfma_f32_16x16x32_bf16 v[172:175], v[64:67], v[188:191], v[172:175]
    ds_read_b128 v[188:191], v7 offset:3648
    s_waitcnt lgkmcnt(6)
    v_mfma_f32_16x16x32_bf16 v[168:171], v[28:31], v[192:195], v[168:171]
    v_mfma_f32_16x16x32_bf16 v[172:175], v[60:63], v[192:195], v[172:175]
    ds_read_b128 v[192:195], v7 offset:3712
    s_waitcnt lgkmcnt(6)
    v_mfma_f32_16x16x32_bf16 v[168:171], v[24:27], v[196:199], v[168:171]
    v_mfma_f32_16x16x32_bf16 v[172:175], v[56:59], v[196:199], v[172:175]
    ds_read_b128 v[196:199], v7 offset:3776
    s_waitcnt lgkmcnt(5)
    v_mfma_f32_16x16x32_bf16 v[168:171], v[20:23], v[176:179], v[168:171]
    v_mfma_f32_16x16x32_bf16 v[172:175], v[52:55], v[176:179], v[172:175]
    ds_read_b128 v[176:179], v7 offset:3840
    s_waitcnt lgkmcnt(5)
    v_mfma_f32_16x16x32_bf16 v[168:171], v[16:19], v[180:183], v[168:171]
    v_mfma_f32_16x16x32_bf16 v[172:175], v[48:51], v[180:183], v[172:175]
    ds_read_b128 v[180:183], v7 offset:3904
    s_waitcnt lgkmcnt(5)
    v_mfma_f32_16x16x32_bf16 v[172:175], v[44:47], v[184:187], v[172:175]
    ds_read_b128 v[184:187], v7 offset:3968
    s_waitcnt lgkmcnt(5)
    v_mfma_f32_16x16x32_bf16 v[172:175], v[40:43], v[188:191], v[172:175]
    ds_read_b128 v[188:191], v7 offset:4032
    s_waitcnt lgkmcnt(5)
    v_mfma_f32_16x16x32_bf16 v[172:175], v[36:39], v[192:195], v[172:175]
    v_cvt_pk_bf16_f32 v12, v168, v169
    v_cvt_pk_bf16_f32 v13, v170, v171
    s_waitcnt lgkmcnt(4)
    v_mfma_f32_16x16x32_bf16 v[172:175], v[32:35], v[196:199], v[172:175]
    ds_write_b64 v8, v[12:13] offset:3072
    s_waitcnt lgkmcnt(4)
    v_mfma_f32_16x16x32_bf16 v[172:175], v[28:31], v[176:179], v[172:175]
    s_waitcnt lgkmcnt(3)
    v_mfma_f32_16x16x32_bf16 v[172:175], v[24:27], v[180:183], v[172:175]
    s_waitcnt lgkmcnt(2)
    v_mfma_f32_16x16x32_bf16 v[172:175], v[20:23], v[184:187], v[172:175]
    s_waitcnt lgkmcnt(1)
    v_mfma_f32_16x16x32_bf16 v[172:175], v[16:19], v[188:191], v[172:175]
    s_nop 7
    v_cvt_pk_bf16_f32 v14, v172, v173
    v_cvt_pk_bf16_f32 v15, v174, v175
    ds_write_b64 v8, v[14:15] offset:3584
    s_waitcnt lgkmcnt(0)
    s_barrier
    v_bfe_u32 v10, v0, 2, 2
    v_mul_u32_u24 v10, 4160, v10
    v_lshrrev_b32 v11, 4, v0
    v_lshl_add_u32 v10, v11, 5, v10
    v_and_b32 v11, 3, v0
    v_lshl_add_u32 v10, v11, 3, v10
    v_lshlrev_b32 v11, 11, v0
    v_add_u32 v11, s49, v11
    ds_read_b64_tr_b16 v[16:17], v10 offset:18432
    ds_read_b64_tr_b16 v[18:19], v10 offset:18944
    ds_read_b64_tr_b16 v[20:21], v10 offset:19456
    ds_read_b64_tr_b16 v[22:23], v10 offset:19968
    ds_read_b64_tr_b16 v[24:25], v10 offset:20480
    ds_read_b64_tr_b16 v[26:27], v10 offset:20992
    ds_read_b64_tr_b16 v[28:29], v10 offset:21504
    ds_read_b64_tr_b16 v[30:31], v10 offset:22016
    s_mov_b32 s53, 0
    s_waitcnt lgkmcnt(7)
    buffer_store_dwordx2 v[16:17], v11, s[32:35], s53 offen
    s_mov_b32 s53, 524288
    s_waitcnt lgkmcnt(6)
    buffer_store_dwordx2 v[18:19], v11, s[32:35], s53 offen
    s_mov_b32 s53, 1048576
    s_waitcnt lgkmcnt(5)
    buffer_store_dwordx2 v[20:21], v11, s[32:35], s53 offen
    s_mov_b32 s53, 1572864
    s_waitcnt lgkmcnt(4)
    buffer_store_dwordx2 v[22:23], v11, s[32:35], s53 offen
    s_mov_b32 s53, 2097152
    s_waitcnt lgkmcnt(3)
    buffer_store_dwordx2 v[24:25], v11, s[32:35], s53 offen
    s_mov_b32 s53, 2621440
    s_waitcnt lgkmcnt(2)
    buffer_store_dwordx2 v[26:27], v11, s[32:35], s53 offen
    s_mov_b32 s53, 3145728
    s_waitcnt lgkmcnt(1)
    buffer_store_dwordx2 v[28:29], v11, s[32:35], s53 offen
    s_mov_b32 s53, 3670016
    s_waitcnt lgkmcnt(0)
    buffer_store_dwordx2 v[30:31], v11, s[32:35], s53 offen
conv_kernel_end:
    s_endpgm
.text
.globl ffn_kernel
.p2align 8
.type ffn_kernel,@function
ffn_kernel:
    s_cmp_ge_u32 s2, 224
    s_cbranch_scc1 ffn_kernel_end
    s_load_dwordx2 s[4:5], s[0:1], 0
    s_load_dwordx2 s[8:9], s[0:1], 72
    s_load_dwordx2 s[12:13], s[0:1], 80
    s_load_dwordx2 s[16:17], s[0:1], 88
    s_load_dwordx2 s[20:21], s[0:1], 112
    s_load_dwordx2 s[24:25], s[0:1], 112
    v_and_b32 v1, 63, v0
    v_and_b32 v2, 15, v0
    v_bfe_u32 v3, v0, 4, 2
    v_lshrrev_b32 v4, 6, v0
    s_nop 0
    v_readfirstlane_b32 s45, v4
    s_lshl_b32 s46, s2, 5
    v_bfe_u32 v5, v1, 1, 2
    v_bfe_u32 v6, v1, 3, 2
    v_lshrrev_b32 v7, 5, v1
    v_lshl_add_u32 v5, v6, 3, v5
    v_lshl_add_u32 v5, v7, 2, v5
    v_lshl_add_u32 v5, v4, 8, v5
    v_mul_u32_u24 v5, 7168, v5
    v_and_b32 v6, 1, v1
    v_lshlrev_b32 v6, 4, v6
    v_add3_u32 v5, v5, v6, s46
    v_bfe_u32 v8, v1, 1, 4
    v_lshlrev_b32 v8, 11, v8
    v_lshl_add_u32 v8, v7, 5, v8
    v_add_u32 v8, v8, v6
    v_lshl_add_u32 v8, v4, 9, v8
    s_lshl_b32 s47, s2, 15
    v_add_u32 v8, s47, v8
    v_lshlrev_b32 v9, 4, v1
    s_waitcnt lgkmcnt(0)
    s_mov_b32 s6, 4194304
    s_mov_b32 s7, 0x00020000
    s_mov_b32 s10, 7340032
    s_mov_b32 s11, 0x00020000
    s_mov_b32 s14, 7340032
    s_mov_b32 s15, 0x00020000
    s_mov_b32 s18, 7340032
    s_mov_b32 s19, 0x00020000
    s_mov_b32 s22, 65536
    s_mov_b32 s23, 0x00020000
    s_add_u32 s24, s24, 1048576
    s_addc_u32 s25, s25, 0
    s_mov_b32 s26, 7340032
    s_mov_b32 s27, 0x00020000
    s_mov_b32 s52, 0
    s_mov_b32 s53, 4096
    s_mov_b32 s54, 8192
    s_mov_b32 s55, 12288
    buffer_load_dwordx4 v[32:35], v9, s[20:23], s52 offen offset:0
    buffer_load_dwordx4 v[36:39], v9, s[20:23], s52 offen offset:1024
    buffer_load_dwordx4 v[40:43], v9, s[20:23], s52 offen offset:2048
    buffer_load_dwordx4 v[44:47], v9, s[20:23], s52 offen offset:3072
    buffer_load_dwordx4 v[48:51], v9, s[20:23], s53 offen offset:0
    buffer_load_dwordx4 v[52:55], v9, s[20:23], s53 offen offset:1024
    buffer_load_dwordx4 v[56:59], v9, s[20:23], s53 offen offset:2048
    buffer_load_dwordx4 v[60:63], v9, s[20:23], s53 offen offset:3072
    buffer_load_dwordx4 v[64:67], v9, s[20:23], s54 offen offset:0
    buffer_load_dwordx4 v[68:71], v9, s[20:23], s54 offen offset:1024
    buffer_load_dwordx4 v[72:75], v9, s[20:23], s54 offen offset:2048
    buffer_load_dwordx4 v[76:79], v9, s[20:23], s54 offen offset:3072
    buffer_load_dwordx4 v[80:83], v9, s[20:23], s55 offen offset:0
    buffer_load_dwordx4 v[84:87], v9, s[20:23], s55 offen offset:1024
    buffer_load_dwordx4 v[88:91], v9, s[20:23], s55 offen offset:2048
    buffer_load_dwordx4 v[92:95], v9, s[20:23], s55 offen offset:3072
    s_lshl_b32 s48, s45, 13
    s_mov_b32 s49, 0
    s_add_u32 m0, s48, 0
    s_nop 0
    buffer_load_dwordx4 v5, s[8:11], s49 offen lds
    s_add_u32 m0, s48, 32768
    s_nop 0
    buffer_load_dwordx4 v5, s[12:15], s49 offen lds
    s_mov_b32 s49, 229376
    s_add_u32 m0, s48, 1024
    s_nop 0
    buffer_load_dwordx4 v5, s[8:11], s49 offen lds
    s_add_u32 m0, s48, 33792
    s_nop 0
    buffer_load_dwordx4 v5, s[12:15], s49 offen lds
    s_mov_b32 s49, 458752
    s_add_u32 m0, s48, 2048
    s_nop 0
    buffer_load_dwordx4 v5, s[8:11], s49 offen lds
    s_add_u32 m0, s48, 34816
    s_nop 0
    buffer_load_dwordx4 v5, s[12:15], s49 offen lds
    s_mov_b32 s49, 688128
    s_add_u32 m0, s48, 3072
    s_nop 0
    buffer_load_dwordx4 v5, s[8:11], s49 offen lds
    s_add_u32 m0, s48, 35840
    s_nop 0
    buffer_load_dwordx4 v5, s[12:15], s49 offen lds
    s_mov_b32 s49, 917504
    s_add_u32 m0, s48, 4096
    s_nop 0
    buffer_load_dwordx4 v5, s[8:11], s49 offen lds
    s_add_u32 m0, s48, 36864
    s_nop 0
    buffer_load_dwordx4 v5, s[12:15], s49 offen lds
    s_mov_b32 s49, 1146880
    s_add_u32 m0, s48, 5120
    s_nop 0
    buffer_load_dwordx4 v5, s[8:11], s49 offen lds
    s_add_u32 m0, s48, 37888
    s_nop 0
    buffer_load_dwordx4 v5, s[12:15], s49 offen lds
    s_mov_b32 s49, 1376256
    s_add_u32 m0, s48, 6144
    s_nop 0
    buffer_load_dwordx4 v5, s[8:11], s49 offen lds
    s_add_u32 m0, s48, 38912
    s_nop 0
    buffer_load_dwordx4 v5, s[12:15], s49 offen lds
    s_mov_b32 s49, 1605632
    s_add_u32 m0, s48, 7168
    s_nop 0
    buffer_load_dwordx4 v5, s[8:11], s49 offen lds
    s_add_u32 m0, s48, 39936
    s_nop 0
    buffer_load_dwordx4 v5, s[12:15], s49 offen lds
    s_mov_b32 s49, 0
    s_add_u32 m0, s48, 65536
    s_nop 0
    buffer_load_dwordx4 v8, s[16:19], s49 offen lds
    s_mov_b32 s49, 64
    s_add_u32 m0, s48, 66560
    s_nop 0
    buffer_load_dwordx4 v8, s[16:19], s49 offen lds
    s_mov_b32 s49, 128
    s_add_u32 m0, s48, 67584
    s_nop 0
    buffer_load_dwordx4 v8, s[16:19], s49 offen lds
    s_mov_b32 s49, 192
    s_add_u32 m0, s48, 68608
    s_nop 0
    buffer_load_dwordx4 v8, s[16:19], s49 offen lds
    s_mov_b32 s49, 256
    s_add_u32 m0, s48, 69632
    s_nop 0
    buffer_load_dwordx4 v8, s[16:19], s49 offen lds
    s_mov_b32 s49, 320
    s_add_u32 m0, s48, 70656
    s_nop 0
    buffer_load_dwordx4 v8, s[16:19], s49 offen lds
    s_mov_b32 s49, 384
    s_add_u32 m0, s48, 71680
    s_nop 0
    buffer_load_dwordx4 v8, s[16:19], s49 offen lds
    s_mov_b32 s49, 448
    s_add_u32 m0, s48, 72704
    s_nop 0
    buffer_load_dwordx4 v8, s[16:19], s49 offen lds
    s_waitcnt vmcnt(24)
    v_lshlrev_b32 v10, 1, v1
    v_sub_u32 v10, 0x7ff, v10
    v_lshlrev_b32 v96, 16, v33
    v_ashrrev_i32 v11, 31, v96
    v_or_b32 v11, 0x80000000, v11
    v_xor_b32 v96, v96, v11
    v_and_b32 v96, 0xffff0000, v96
    v_subrev_u32 v11, 0, v10
    v_or_b32 v96, v96, v11
    v_lshlrev_b32 v97, 16, v35
    v_ashrrev_i32 v11, 31, v97
    v_or_b32 v11, 0x80000000, v11
    v_xor_b32 v97, v97, v11
    v_and_b32 v97, 0xffff0000, v97
    v_subrev_u32 v11, 1, v10
    v_or_b32 v97, v97, v11
    v_lshlrev_b32 v98, 16, v37
    v_ashrrev_i32 v11, 31, v98
    v_or_b32 v11, 0x80000000, v11
    v_xor_b32 v98, v98, v11
    v_and_b32 v98, 0xffff0000, v98
    v_subrev_u32 v11, 128, v10
    v_or_b32 v98, v98, v11
    v_lshlrev_b32 v99, 16, v39
    v_ashrrev_i32 v11, 31, v99
    v_or_b32 v11, 0x80000000, v11
    v_xor_b32 v99, v99, v11
    v_and_b32 v99, 0xffff0000, v99
    v_subrev_u32 v11, 129, v10
    v_or_b32 v99, v99, v11
    v_lshlrev_b32 v100, 16, v41
    v_ashrrev_i32 v11, 31, v100
    v_or_b32 v11, 0x80000000, v11
    v_xor_b32 v100, v100, v11
    v_and_b32 v100, 0xffff0000, v100
    v_subrev_u32 v11, 256, v10
    v_or_b32 v100, v100, v11
    v_lshlrev_b32 v101, 16, v43
    v_ashrrev_i32 v11, 31, v101
    v_or_b32 v11, 0x80000000, v11
    v_xor_b32 v101, v101, v11
    v_and_b32 v101, 0xffff0000, v101
    v_subrev_u32 v11, 257, v10
    v_or_b32 v101, v101, v11
    v_lshlrev_b32 v102, 16, v45
    v_ashrrev_i32 v11, 31, v102
    v_or_b32 v11, 0x80000000, v11
    v_xor_b32 v102, v102, v11
    v_and_b32 v102, 0xffff0000, v102
    v_subrev_u32 v11, 384, v10
    v_or_b32 v102, v102, v11
    v_lshlrev_b32 v103, 16, v47
    v_ashrrev_i32 v11, 31, v103
    v_or_b32 v11, 0x80000000, v11
    v_xor_b32 v103, v103, v11
    v_and_b32 v103, 0xffff0000, v103
    v_subrev_u32 v11, 385, v10
    v_or_b32 v103, v103, v11
    v_lshlrev_b32 v104, 16, v49
    v_ashrrev_i32 v11, 31, v104
    v_or_b32 v11, 0x80000000, v11
    v_xor_b32 v104, v104, v11
    v_and_b32 v104, 0xffff0000, v104
    v_subrev_u32 v11, 512, v10
    v_or_b32 v104, v104, v11
    v_lshlrev_b32 v105, 16, v51
    v_ashrrev_i32 v11, 31, v105
    v_or_b32 v11, 0x80000000, v11
    v_xor_b32 v105, v105, v11
    v_and_b32 v105, 0xffff0000, v105
    v_subrev_u32 v11, 513, v10
    v_or_b32 v105, v105, v11
    v_lshlrev_b32 v106, 16, v53
    v_ashrrev_i32 v11, 31, v106
    v_or_b32 v11, 0x80000000, v11
    v_xor_b32 v106, v106, v11
    v_and_b32 v106, 0xffff0000, v106
    v_subrev_u32 v11, 640, v10
    v_or_b32 v106, v106, v11
    v_lshlrev_b32 v107, 16, v55
    v_ashrrev_i32 v11, 31, v107
    v_or_b32 v11, 0x80000000, v11
    v_xor_b32 v107, v107, v11
    v_and_b32 v107, 0xffff0000, v107
    v_subrev_u32 v11, 641, v10
    v_or_b32 v107, v107, v11
    v_lshlrev_b32 v108, 16, v57
    v_ashrrev_i32 v11, 31, v108
    v_or_b32 v11, 0x80000000, v11
    v_xor_b32 v108, v108, v11
    v_and_b32 v108, 0xffff0000, v108
    v_subrev_u32 v11, 768, v10
    v_or_b32 v108, v108, v11
    v_lshlrev_b32 v109, 16, v59
    v_ashrrev_i32 v11, 31, v109
    v_or_b32 v11, 0x80000000, v11
    v_xor_b32 v109, v109, v11
    v_and_b32 v109, 0xffff0000, v109
    v_subrev_u32 v11, 769, v10
    v_or_b32 v109, v109, v11
    v_lshlrev_b32 v110, 16, v61
    v_ashrrev_i32 v11, 31, v110
    v_or_b32 v11, 0x80000000, v11
    v_xor_b32 v110, v110, v11
    v_and_b32 v110, 0xffff0000, v110
    v_subrev_u32 v11, 896, v10
    v_or_b32 v110, v110, v11
    v_lshlrev_b32 v111, 16, v63
    v_ashrrev_i32 v11, 31, v111
    v_or_b32 v11, 0x80000000, v11
    v_xor_b32 v111, v111, v11
    v_and_b32 v111, 0xffff0000, v111
    v_subrev_u32 v11, 897, v10
    v_or_b32 v111, v111, v11
    v_lshlrev_b32 v112, 16, v65
    v_ashrrev_i32 v11, 31, v112
    v_or_b32 v11, 0x80000000, v11
    v_xor_b32 v112, v112, v11
    v_and_b32 v112, 0xffff0000, v112
    v_subrev_u32 v11, 1024, v10
    v_or_b32 v112, v112, v11
    v_lshlrev_b32 v113, 16, v67
    v_ashrrev_i32 v11, 31, v113
    v_or_b32 v11, 0x80000000, v11
    v_xor_b32 v113, v113, v11
    v_and_b32 v113, 0xffff0000, v113
    v_subrev_u32 v11, 1025, v10
    v_or_b32 v113, v113, v11
    v_lshlrev_b32 v114, 16, v69
    v_ashrrev_i32 v11, 31, v114
    v_or_b32 v11, 0x80000000, v11
    v_xor_b32 v114, v114, v11
    v_and_b32 v114, 0xffff0000, v114
    v_subrev_u32 v11, 1152, v10
    v_or_b32 v114, v114, v11
    v_lshlrev_b32 v115, 16, v71
    v_ashrrev_i32 v11, 31, v115
    v_or_b32 v11, 0x80000000, v11
    v_xor_b32 v115, v115, v11
    v_and_b32 v115, 0xffff0000, v115
    v_subrev_u32 v11, 1153, v10
    v_or_b32 v115, v115, v11
    v_lshlrev_b32 v116, 16, v73
    v_ashrrev_i32 v11, 31, v116
    v_or_b32 v11, 0x80000000, v11
    v_xor_b32 v116, v116, v11
    v_and_b32 v116, 0xffff0000, v116
    v_subrev_u32 v11, 1280, v10
    v_or_b32 v116, v116, v11
    v_lshlrev_b32 v117, 16, v75
    v_ashrrev_i32 v11, 31, v117
    v_or_b32 v11, 0x80000000, v11
    v_xor_b32 v117, v117, v11
    v_and_b32 v117, 0xffff0000, v117
    v_subrev_u32 v11, 1281, v10
    v_or_b32 v117, v117, v11
    v_lshlrev_b32 v118, 16, v77
    v_ashrrev_i32 v11, 31, v118
    v_or_b32 v11, 0x80000000, v11
    v_xor_b32 v118, v118, v11
    v_and_b32 v118, 0xffff0000, v118
    v_subrev_u32 v11, 1408, v10
    v_or_b32 v118, v118, v11
    v_lshlrev_b32 v119, 16, v79
    v_ashrrev_i32 v11, 31, v119
    v_or_b32 v11, 0x80000000, v11
    v_xor_b32 v119, v119, v11
    v_and_b32 v119, 0xffff0000, v119
    v_subrev_u32 v11, 1409, v10
    v_or_b32 v119, v119, v11
    v_lshlrev_b32 v120, 16, v81
    v_ashrrev_i32 v11, 31, v120
    v_or_b32 v11, 0x80000000, v11
    v_xor_b32 v120, v120, v11
    v_and_b32 v120, 0xffff0000, v120
    v_subrev_u32 v11, 1536, v10
    v_or_b32 v120, v120, v11
    v_lshlrev_b32 v121, 16, v83
    v_ashrrev_i32 v11, 31, v121
    v_or_b32 v11, 0x80000000, v11
    v_xor_b32 v121, v121, v11
    v_and_b32 v121, 0xffff0000, v121
    v_subrev_u32 v11, 1537, v10
    v_or_b32 v121, v121, v11
    v_lshlrev_b32 v122, 16, v85
    v_ashrrev_i32 v11, 31, v122
    v_or_b32 v11, 0x80000000, v11
    v_xor_b32 v122, v122, v11
    v_and_b32 v122, 0xffff0000, v122
    v_subrev_u32 v11, 1664, v10
    v_or_b32 v122, v122, v11
    v_lshlrev_b32 v123, 16, v87
    v_ashrrev_i32 v11, 31, v123
    v_or_b32 v11, 0x80000000, v11
    v_xor_b32 v123, v123, v11
    v_and_b32 v123, 0xffff0000, v123
    v_subrev_u32 v11, 1665, v10
    v_or_b32 v123, v123, v11
    v_lshlrev_b32 v124, 16, v89
    v_ashrrev_i32 v11, 31, v124
    v_or_b32 v11, 0x80000000, v11
    v_xor_b32 v124, v124, v11
    v_and_b32 v124, 0xffff0000, v124
    v_subrev_u32 v11, 1792, v10
    v_or_b32 v124, v124, v11
    v_lshlrev_b32 v125, 16, v91
    v_ashrrev_i32 v11, 31, v125
    v_or_b32 v11, 0x80000000, v11
    v_xor_b32 v125, v125, v11
    v_and_b32 v125, 0xffff0000, v125
    v_subrev_u32 v11, 1793, v10
    v_or_b32 v125, v125, v11
    v_lshlrev_b32 v126, 16, v93
    v_ashrrev_i32 v11, 31, v126
    v_or_b32 v11, 0x80000000, v11
    v_xor_b32 v126, v126, v11
    v_and_b32 v126, 0xffff0000, v126
    v_subrev_u32 v11, 1920, v10
    v_or_b32 v126, v126, v11
    v_lshlrev_b32 v127, 16, v95
    v_ashrrev_i32 v11, 31, v127
    v_or_b32 v11, 0x80000000, v11
    v_xor_b32 v127, v127, v11
    v_and_b32 v127, 0xffff0000, v127
    v_subrev_u32 v11, 1921, v10
    v_or_b32 v127, v127, v11
    v_max3_u32 v10, v96, v97, v98
    v_max3_u32 v10, v10, v99, v100
    v_max3_u32 v10, v10, v101, v102
    v_max3_u32 v10, v10, v103, v104
    v_max3_u32 v10, v10, v105, v106
    v_max3_u32 v10, v10, v107, v108
    v_max3_u32 v10, v10, v109, v110
    v_max3_u32 v10, v10, v111, v112
    v_max3_u32 v10, v10, v113, v114
    v_max3_u32 v10, v10, v115, v116
    v_max3_u32 v10, v10, v117, v118
    v_max3_u32 v10, v10, v119, v120
    v_max3_u32 v10, v10, v121, v122
    v_max3_u32 v10, v10, v123, v124
    v_max3_u32 v10, v10, v125, v126
    v_max_u32 v10, v10, v127
    s_nop 1
    v_max_u32_dpp v10, v10, v10 row_ror:8 row_mask:0xf bank_mask:0xf
    s_nop 1
    v_max_u32_dpp v10, v10, v10 row_ror:4 row_mask:0xf bank_mask:0xf
    s_nop 1
    v_max_u32_dpp v10, v10, v10 row_ror:2 row_mask:0xf bank_mask:0xf
    s_nop 1
    v_max_u32_dpp v10, v10, v10 row_ror:1 row_mask:0xf bank_mask:0xf
    v_mov_b32 v11, v10
    s_nop 1
    v_permlane16_swap_b32 v10, v11
    v_max_u32 v10, v10, v11
    v_mov_b32 v11, v10
    s_nop 1
    v_permlane32_swap_b32 v10, v11
    v_max_u32 v10, v10, v11
    s_nop 0
    v_readfirstlane_b32 s60, v10
    v_cmp_ne_u32 vcc, v10, v96
    s_nop 1
    v_cndmask_b32 v96, 0, v96, vcc
    v_cmp_ne_u32 vcc, v10, v97
    s_nop 1
    v_cndmask_b32 v97, 0, v97, vcc
    v_cmp_ne_u32 vcc, v10, v98
    s_nop 1
    v_cndmask_b32 v98, 0, v98, vcc
    v_cmp_ne_u32 vcc, v10, v99
    s_nop 1
    v_cndmask_b32 v99, 0, v99, vcc
    v_cmp_ne_u32 vcc, v10, v100
    s_nop 1
    v_cndmask_b32 v100, 0, v100, vcc
    v_cmp_ne_u32 vcc, v10, v101
    s_nop 1
    v_cndmask_b32 v101, 0, v101, vcc
    v_cmp_ne_u32 vcc, v10, v102
    s_nop 1
    v_cndmask_b32 v102, 0, v102, vcc
    v_cmp_ne_u32 vcc, v10, v103
    s_nop 1
    v_cndmask_b32 v103, 0, v103, vcc
    v_cmp_ne_u32 vcc, v10, v104
    s_nop 1
    v_cndmask_b32 v104, 0, v104, vcc
    v_cmp_ne_u32 vcc, v10, v105
    s_nop 1
    v_cndmask_b32 v105, 0, v105, vcc
    v_cmp_ne_u32 vcc, v10, v106
    s_nop 1
    v_cndmask_b32 v106, 0, v106, vcc
    v_cmp_ne_u32 vcc, v10, v107
    s_nop 1
    v_cndmask_b32 v107, 0, v107, vcc
    v_cmp_ne_u32 vcc, v10, v108
    s_nop 1
    v_cndmask_b32 v108, 0, v108, vcc
    v_cmp_ne_u32 vcc, v10, v109
    s_nop 1
    v_cndmask_b32 v109, 0, v109, vcc
    v_cmp_ne_u32 vcc, v10, v110
    s_nop 1
    v_cndmask_b32 v110, 0, v110, vcc
    v_cmp_ne_u32 vcc, v10, v111
    s_nop 1
    v_cndmask_b32 v111, 0, v111, vcc
    v_cmp_ne_u32 vcc, v10, v112
    s_nop 1
    v_cndmask_b32 v112, 0, v112, vcc
    v_cmp_ne_u32 vcc, v10, v113
    s_nop 1
    v_cndmask_b32 v113, 0, v113, vcc
    v_cmp_ne_u32 vcc, v10, v114
    s_nop 1
    v_cndmask_b32 v114, 0, v114, vcc
    v_cmp_ne_u32 vcc, v10, v115
    s_nop 1
    v_cndmask_b32 v115, 0, v115, vcc
    v_cmp_ne_u32 vcc, v10, v116
    s_nop 1
    v_cndmask_b32 v116, 0, v116, vcc
    v_cmp_ne_u32 vcc, v10, v117
    s_nop 1
    v_cndmask_b32 v117, 0, v117, vcc
    v_cmp_ne_u32 vcc, v10, v118
    s_nop 1
    v_cndmask_b32 v118, 0, v118, vcc
    v_cmp_ne_u32 vcc, v10, v119
    s_nop 1
    v_cndmask_b32 v119, 0, v119, vcc
    v_cmp_ne_u32 vcc, v10, v120
    s_nop 1
    v_cndmask_b32 v120, 0, v120, vcc
    v_cmp_ne_u32 vcc, v10, v121
    s_nop 1
    v_cndmask_b32 v121, 0, v121, vcc
    v_cmp_ne_u32 vcc, v10, v122
    s_nop 1
    v_cndmask_b32 v122, 0, v122, vcc
    v_cmp_ne_u32 vcc, v10, v123
    s_nop 1
    v_cndmask_b32 v123, 0, v123, vcc
    v_cmp_ne_u32 vcc, v10, v124
    s_nop 1
    v_cndmask_b32 v124, 0, v124, vcc
    v_cmp_ne_u32 vcc, v10, v125
    s_nop 1
    v_cndmask_b32 v125, 0, v125, vcc
    v_cmp_ne_u32 vcc, v10, v126
    s_nop 1
    v_cndmask_b32 v126, 0, v126, vcc
    v_cmp_ne_u32 vcc, v10, v127
    s_nop 1
    v_cndmask_b32 v127, 0, v127, vcc
    v_max3_u32 v10, v96, v97, v98
    v_max3_u32 v10, v10, v99, v100
    v_max3_u32 v10, v10, v101, v102
    v_max3_u32 v10, v10, v103, v104
    v_max3_u32 v10, v10, v105, v106
    v_max3_u32 v10, v10, v107, v108
    v_max3_u32 v10, v10, v109, v110
    v_max3_u32 v10, v10, v111, v112
    v_max3_u32 v10, v10, v113, v114
    v_max3_u32 v10, v10, v115, v116
    v_max3_u32 v10, v10, v117, v118
    v_max3_u32 v10, v10, v119, v120
    v_max3_u32 v10, v10, v121, v122
    v_max3_u32 v10, v10, v123, v124
    v_max3_u32 v10, v10, v125, v126
    v_max_u32 v10, v10, v127
    s_nop 1
    v_max_u32_dpp v10, v10, v10 row_ror:8 row_mask:0xf bank_mask:0xf
    s_nop 1
    v_max_u32_dpp v10, v10, v10 row_ror:4 row_mask:0xf bank_mask:0xf
    s_nop 1
    v_max_u32_dpp v10, v10, v10 row_ror:2 row_mask:0xf bank_mask:0xf
    s_nop 1
    v_max_u32_dpp v10, v10, v10 row_ror:1 row_mask:0xf bank_mask:0xf
    v_mov_b32 v11, v10
    s_nop 1
    v_permlane16_swap_b32 v10, v11
    v_max_u32 v10, v10, v11
    v_mov_b32 v11, v10
    s_nop 1
    v_permlane32_swap_b32 v10, v11
    v_max_u32 v10, v10, v11
    s_nop 0
    v_readfirstlane_b32 s61, v10
    v_cmp_ne_u32 vcc, v10, v96
    s_nop 1
    v_cndmask_b32 v96, 0, v96, vcc
    v_cmp_ne_u32 vcc, v10, v97
    s_nop 1
    v_cndmask_b32 v97, 0, v97, vcc
    v_cmp_ne_u32 vcc, v10, v98
    s_nop 1
    v_cndmask_b32 v98, 0, v98, vcc
    v_cmp_ne_u32 vcc, v10, v99
    s_nop 1
    v_cndmask_b32 v99, 0, v99, vcc
    v_cmp_ne_u32 vcc, v10, v100
    s_nop 1
    v_cndmask_b32 v100, 0, v100, vcc
    v_cmp_ne_u32 vcc, v10, v101
    s_nop 1
    v_cndmask_b32 v101, 0, v101, vcc
    v_cmp_ne_u32 vcc, v10, v102
    s_nop 1
    v_cndmask_b32 v102, 0, v102, vcc
    v_cmp_ne_u32 vcc, v10, v103
    s_nop 1
    v_cndmask_b32 v103, 0, v103, vcc
    v_cmp_ne_u32 vcc, v10, v104
    s_nop 1
    v_cndmask_b32 v104, 0, v104, vcc
    v_cmp_ne_u32 vcc, v10, v105
    s_nop 1
    v_cndmask_b32 v105, 0, v105, vcc
    v_cmp_ne_u32 vcc, v10, v106
    s_nop 1
    v_cndmask_b32 v106, 0, v106, vcc
    v_cmp_ne_u32 vcc, v10, v107
    s_nop 1
    v_cndmask_b32 v107, 0, v107, vcc
    v_cmp_ne_u32 vcc, v10, v108
    s_nop 1
    v_cndmask_b32 v108, 0, v108, vcc
    v_cmp_ne_u32 vcc, v10, v109
    s_nop 1
    v_cndmask_b32 v109, 0, v109, vcc
    v_cmp_ne_u32 vcc, v10, v110
    s_nop 1
    v_cndmask_b32 v110, 0, v110, vcc
    v_cmp_ne_u32 vcc, v10, v111
    s_nop 1
    v_cndmask_b32 v111, 0, v111, vcc
    v_cmp_ne_u32 vcc, v10, v112
    s_nop 1
    v_cndmask_b32 v112, 0, v112, vcc
    v_cmp_ne_u32 vcc, v10, v113
    s_nop 1
    v_cndmask_b32 v113, 0, v113, vcc
    v_cmp_ne_u32 vcc, v10, v114
    s_nop 1
    v_cndmask_b32 v114, 0, v114, vcc
    v_cmp_ne_u32 vcc, v10, v115
    s_nop 1
    v_cndmask_b32 v115, 0, v115, vcc
    v_cmp_ne_u32 vcc, v10, v116
    s_nop 1
    v_cndmask_b32 v116, 0, v116, vcc
    v_cmp_ne_u32 vcc, v10, v117
    s_nop 1
    v_cndmask_b32 v117, 0, v117, vcc
    v_cmp_ne_u32 vcc, v10, v118
    s_nop 1
    v_cndmask_b32 v118, 0, v118, vcc
    v_cmp_ne_u32 vcc, v10, v119
    s_nop 1
    v_cndmask_b32 v119, 0, v119, vcc
    v_cmp_ne_u32 vcc, v10, v120
    s_nop 1
    v_cndmask_b32 v120, 0, v120, vcc
    v_cmp_ne_u32 vcc, v10, v121
    s_nop 1
    v_cndmask_b32 v121, 0, v121, vcc
    v_cmp_ne_u32 vcc, v10, v122
    s_nop 1
    v_cndmask_b32 v122, 0, v122, vcc
    v_cmp_ne_u32 vcc, v10, v123
    s_nop 1
    v_cndmask_b32 v123, 0, v123, vcc
    v_cmp_ne_u32 vcc, v10, v124
    s_nop 1
    v_cndmask_b32 v124, 0, v124, vcc
    v_cmp_ne_u32 vcc, v10, v125
    s_nop 1
    v_cndmask_b32 v125, 0, v125, vcc
    v_cmp_ne_u32 vcc, v10, v126
    s_nop 1
    v_cndmask_b32 v126, 0, v126, vcc
    v_cmp_ne_u32 vcc, v10, v127
    s_nop 1
    v_cndmask_b32 v127, 0, v127, vcc
    v_max3_u32 v10, v96, v97, v98
    v_max3_u32 v10, v10, v99, v100
    v_max3_u32 v10, v10, v101, v102
    v_max3_u32 v10, v10, v103, v104
    v_max3_u32 v10, v10, v105, v106
    v_max3_u32 v10, v10, v107, v108
    v_max3_u32 v10, v10, v109, v110
    v_max3_u32 v10, v10, v111, v112
    v_max3_u32 v10, v10, v113, v114
    v_max3_u32 v10, v10, v115, v116
    v_max3_u32 v10, v10, v117, v118
    v_max3_u32 v10, v10, v119, v120
    v_max3_u32 v10, v10, v121, v122
    v_max3_u32 v10, v10, v123, v124
    v_max3_u32 v10, v10, v125, v126
    v_max_u32 v10, v10, v127
    s_nop 1
    v_max_u32_dpp v10, v10, v10 row_ror:8 row_mask:0xf bank_mask:0xf
    s_nop 1
    v_max_u32_dpp v10, v10, v10 row_ror:4 row_mask:0xf bank_mask:0xf
    s_nop 1
    v_max_u32_dpp v10, v10, v10 row_ror:2 row_mask:0xf bank_mask:0xf
    s_nop 1
    v_max_u32_dpp v10, v10, v10 row_ror:1 row_mask:0xf bank_mask:0xf
    v_mov_b32 v11, v10
    s_nop 1
    v_permlane16_swap_b32 v10, v11
    v_max_u32 v10, v10, v11
    v_mov_b32 v11, v10
    s_nop 1
    v_permlane32_swap_b32 v10, v11
    v_max_u32 v10, v10, v11
    s_nop 0
    v_readfirstlane_b32 s62, v10
    v_cmp_ne_u32 vcc, v10, v96
    s_nop 1
    v_cndmask_b32 v96, 0, v96, vcc
    v_cmp_ne_u32 vcc, v10, v97
    s_nop 1
    v_cndmask_b32 v97, 0, v97, vcc
    v_cmp_ne_u32 vcc, v10, v98
    s_nop 1
    v_cndmask_b32 v98, 0, v98, vcc
    v_cmp_ne_u32 vcc, v10, v99
    s_nop 1
    v_cndmask_b32 v99, 0, v99, vcc
    v_cmp_ne_u32 vcc, v10, v100
    s_nop 1
    v_cndmask_b32 v100, 0, v100, vcc
    v_cmp_ne_u32 vcc, v10, v101
    s_nop 1
    v_cndmask_b32 v101, 0, v101, vcc
    v_cmp_ne_u32 vcc, v10, v102
    s_nop 1
    v_cndmask_b32 v102, 0, v102, vcc
    v_cmp_ne_u32 vcc, v10, v103
    s_nop 1
    v_cndmask_b32 v103, 0, v103, vcc
    v_cmp_ne_u32 vcc, v10, v104
    s_nop 1
    v_cndmask_b32 v104, 0, v104, vcc
    v_cmp_ne_u32 vcc, v10, v105
    s_nop 1
    v_cndmask_b32 v105, 0, v105, vcc
    v_cmp_ne_u32 vcc, v10, v106
    s_nop 1
    v_cndmask_b32 v106, 0, v106, vcc
    v_cmp_ne_u32 vcc, v10, v107
    s_nop 1
    v_cndmask_b32 v107, 0, v107, vcc
    v_cmp_ne_u32 vcc, v10, v108
    s_nop 1
    v_cndmask_b32 v108, 0, v108, vcc
    v_cmp_ne_u32 vcc, v10, v109
    s_nop 1
    v_cndmask_b32 v109, 0, v109, vcc
    v_cmp_ne_u32 vcc, v10, v110
    s_nop 1
    v_cndmask_b32 v110, 0, v110, vcc
    v_cmp_ne_u32 vcc, v10, v111
    s_nop 1
    v_cndmask_b32 v111, 0, v111, vcc
    v_cmp_ne_u32 vcc, v10, v112
    s_nop 1
    v_cndmask_b32 v112, 0, v112, vcc
    v_cmp_ne_u32 vcc, v10, v113
    s_nop 1
    v_cndmask_b32 v113, 0, v113, vcc
    v_cmp_ne_u32 vcc, v10, v114
    s_nop 1
    v_cndmask_b32 v114, 0, v114, vcc
    v_cmp_ne_u32 vcc, v10, v115
    s_nop 1
    v_cndmask_b32 v115, 0, v115, vcc
    v_cmp_ne_u32 vcc, v10, v116
    s_nop 1
    v_cndmask_b32 v116, 0, v116, vcc
    v_cmp_ne_u32 vcc, v10, v117
    s_nop 1
    v_cndmask_b32 v117, 0, v117, vcc
    v_cmp_ne_u32 vcc, v10, v118
    s_nop 1
    v_cndmask_b32 v118, 0, v118, vcc
    v_cmp_ne_u32 vcc, v10, v119
    s_nop 1
    v_cndmask_b32 v119, 0, v119, vcc
    v_cmp_ne_u32 vcc, v10, v120
    s_nop 1
    v_cndmask_b32 v120, 0, v120, vcc
    v_cmp_ne_u32 vcc, v10, v121
    s_nop 1
    v_cndmask_b32 v121, 0, v121, vcc
    v_cmp_ne_u32 vcc, v10, v122
    s_nop 1
    v_cndmask_b32 v122, 0, v122, vcc
    v_cmp_ne_u32 vcc, v10, v123
    s_nop 1
    v_cndmask_b32 v123, 0, v123, vcc
    v_cmp_ne_u32 vcc, v10, v124
    s_nop 1
    v_cndmask_b32 v124, 0, v124, vcc
    v_cmp_ne_u32 vcc, v10, v125
    s_nop 1
    v_cndmask_b32 v125, 0, v125, vcc
    v_cmp_ne_u32 vcc, v10, v126
    s_nop 1
    v_cndmask_b32 v126, 0, v126, vcc
    v_cmp_ne_u32 vcc, v10, v127
    s_nop 1
    v_cndmask_b32 v127, 0, v127, vcc
    v_max3_u32 v10, v96, v97, v98
    v_max3_u32 v10, v10, v99, v100
    v_max3_u32 v10, v10, v101, v102
    v_max3_u32 v10, v10, v103, v104
    v_max3_u32 v10, v10, v105, v106
    v_max3_u32 v10, v10, v107, v108
    v_max3_u32 v10, v10, v109, v110
    v_max3_u32 v10, v10, v111, v112
    v_max3_u32 v10, v10, v113, v114
    v_max3_u32 v10, v10, v115, v116
    v_max3_u32 v10, v10, v117, v118
    v_max3_u32 v10, v10, v119, v120
    v_max3_u32 v10, v10, v121, v122
    v_max3_u32 v10, v10, v123, v124
    v_max3_u32 v10, v10, v125, v126
    v_max_u32 v10, v10, v127
    s_nop 1
    v_max_u32_dpp v10, v10, v10 row_ror:8 row_mask:0xf bank_mask:0xf
    s_nop 1
    v_max_u32_dpp v10, v10, v10 row_ror:4 row_mask:0xf bank_mask:0xf
    s_nop 1
    v_max_u32_dpp v10, v10, v10 row_ror:2 row_mask:0xf bank_mask:0xf
    s_nop 1
    v_max_u32_dpp v10, v10, v10 row_ror:1 row_mask:0xf bank_mask:0xf
    v_mov_b32 v11, v10
    s_nop 1
    v_permlane16_swap_b32 v10, v11
    v_max_u32 v10, v10, v11
    v_mov_b32 v11, v10
    s_nop 1
    v_permlane32_swap_b32 v10, v11
    v_max_u32 v10, v10, v11
    s_nop 0
    v_readfirstlane_b32 s63, v10
    v_cmp_ne_u32 vcc, v10, v96
    s_nop 1
    v_cndmask_b32 v96, 0, v96, vcc
    v_cmp_ne_u32 vcc, v10, v97
    s_nop 1
    v_cndmask_b32 v97, 0, v97, vcc
    v_cmp_ne_u32 vcc, v10, v98
    s_nop 1
    v_cndmask_b32 v98, 0, v98, vcc
    v_cmp_ne_u32 vcc, v10, v99
    s_nop 1
    v_cndmask_b32 v99, 0, v99, vcc
    v_cmp_ne_u32 vcc, v10, v100
    s_nop 1
    v_cndmask_b32 v100, 0, v100, vcc
    v_cmp_ne_u32 vcc, v10, v101
    s_nop 1
    v_cndmask_b32 v101, 0, v101, vcc
    v_cmp_ne_u32 vcc, v10, v102
    s_nop 1
    v_cndmask_b32 v102, 0, v102, vcc
    v_cmp_ne_u32 vcc, v10, v103
    s_nop 1
    v_cndmask_b32 v103, 0, v103, vcc
    v_cmp_ne_u32 vcc, v10, v104
    s_nop 1
    v_cndmask_b32 v104, 0, v104, vcc
    v_cmp_ne_u32 vcc, v10, v105
    s_nop 1
    v_cndmask_b32 v105, 0, v105, vcc
    v_cmp_ne_u32 vcc, v10, v106
    s_nop 1
    v_cndmask_b32 v106, 0, v106, vcc
    v_cmp_ne_u32 vcc, v10, v107
    s_nop 1
    v_cndmask_b32 v107, 0, v107, vcc
    v_cmp_ne_u32 vcc, v10, v108
    s_nop 1
    v_cndmask_b32 v108, 0, v108, vcc
    v_cmp_ne_u32 vcc, v10, v109
    s_nop 1
    v_cndmask_b32 v109, 0, v109, vcc
    v_cmp_ne_u32 vcc, v10, v110
    s_nop 1
    v_cndmask_b32 v110, 0, v110, vcc
    v_cmp_ne_u32 vcc, v10, v111
    s_nop 1
    v_cndmask_b32 v111, 0, v111, vcc
    v_cmp_ne_u32 vcc, v10, v112
    s_nop 1
    v_cndmask_b32 v112, 0, v112, vcc
    v_cmp_ne_u32 vcc, v10, v113
    s_nop 1
    v_cndmask_b32 v113, 0, v113, vcc
    v_cmp_ne_u32 vcc, v10, v114
    s_nop 1
    v_cndmask_b32 v114, 0, v114, vcc
    v_cmp_ne_u32 vcc, v10, v115
    s_nop 1
    v_cndmask_b32 v115, 0, v115, vcc
    v_cmp_ne_u32 vcc, v10, v116
    s_nop 1
    v_cndmask_b32 v116, 0, v116, vcc
    v_cmp_ne_u32 vcc, v10, v117
    s_nop 1
    v_cndmask_b32 v117, 0, v117, vcc
    v_cmp_ne_u32 vcc, v10, v118
    s_nop 1
    v_cndmask_b32 v118, 0, v118, vcc
    v_cmp_ne_u32 vcc, v10, v119
    s_nop 1
    v_cndmask_b32 v119, 0, v119, vcc
    v_cmp_ne_u32 vcc, v10, v120
    s_nop 1
    v_cndmask_b32 v120, 0, v120, vcc
    v_cmp_ne_u32 vcc, v10, v121
    s_nop 1
    v_cndmask_b32 v121, 0, v121, vcc
    v_cmp_ne_u32 vcc, v10, v122
    s_nop 1
    v_cndmask_b32 v122, 0, v122, vcc
    v_cmp_ne_u32 vcc, v10, v123
    s_nop 1
    v_cndmask_b32 v123, 0, v123, vcc
    v_cmp_ne_u32 vcc, v10, v124
    s_nop 1
    v_cndmask_b32 v124, 0, v124, vcc
    v_cmp_ne_u32 vcc, v10, v125
    s_nop 1
    v_cndmask_b32 v125, 0, v125, vcc
    v_cmp_ne_u32 vcc, v10, v126
    s_nop 1
    v_cndmask_b32 v126, 0, v126, vcc
    v_cmp_ne_u32 vcc, v10, v127
    s_nop 1
    v_cndmask_b32 v127, 0, v127, vcc
    v_max3_u32 v10, v96, v97, v98
    v_max3_u32 v10, v10, v99, v100
    v_max3_u32 v10, v10, v101, v102
    v_max3_u32 v10, v10, v103, v104
    v_max3_u32 v10, v10, v105, v106
    v_max3_u32 v10, v10, v107, v108
    v_max3_u32 v10, v10, v109, v110
    v_max3_u32 v10, v10, v111, v112
    v_max3_u32 v10, v10, v113, v114
    v_max3_u32 v10, v10, v115, v116
    v_max3_u32 v10, v10, v117, v118
    v_max3_u32 v10, v10, v119, v120
    v_max3_u32 v10, v10, v121, v122
    v_max3_u32 v10, v10, v123, v124
    v_max3_u32 v10, v10, v125, v126
    v_max_u32 v10, v10, v127
    s_nop 1
    v_max_u32_dpp v10, v10, v10 row_ror:8 row_mask:0xf bank_mask:0xf
    s_nop 1
    v_max_u32_dpp v10, v10, v10 row_ror:4 row_mask:0xf bank_mask:0xf
    s_nop 1
    v_max_u32_dpp v10, v10, v10 row_ror:2 row_mask:0xf bank_mask:0xf
    s_nop 1
    v_max_u32_dpp v10, v10, v10 row_ror:1 row_mask:0xf bank_mask:0xf
    v_mov_b32 v11, v10
    s_nop 1
    v_permlane16_swap_b32 v10, v11
    v_max_u32 v10, v10, v11
    v_mov_b32 v11, v10
    s_nop 1
    v_permlane32_swap_b32 v10, v11
    v_max_u32 v10, v10, v11
    s_nop 0
    v_readfirstlane_b32 s64, v10
    v_cmp_ne_u32 vcc, v10, v96
    s_nop 1
    v_cndmask_b32 v96, 0, v96, vcc
    v_cmp_ne_u32 vcc, v10, v97
    s_nop 1
    v_cndmask_b32 v97, 0, v97, vcc
    v_cmp_ne_u32 vcc, v10, v98
    s_nop 1
    v_cndmask_b32 v98, 0, v98, vcc
    v_cmp_ne_u32 vcc, v10, v99
    s_nop 1
    v_cndmask_b32 v99, 0, v99, vcc
    v_cmp_ne_u32 vcc, v10, v100
    s_nop 1
    v_cndmask_b32 v100, 0, v100, vcc
    v_cmp_ne_u32 vcc, v10, v101
    s_nop 1
    v_cndmask_b32 v101, 0, v101, vcc
    v_cmp_ne_u32 vcc, v10, v102
    s_nop 1
    v_cndmask_b32 v102, 0, v102, vcc
    v_cmp_ne_u32 vcc, v10, v103
    s_nop 1
    v_cndmask_b32 v103, 0, v103, vcc
    v_cmp_ne_u32 vcc, v10, v104
    s_nop 1
    v_cndmask_b32 v104, 0, v104, vcc
    v_cmp_ne_u32 vcc, v10, v105
    s_nop 1
    v_cndmask_b32 v105, 0, v105, vcc
    v_cmp_ne_u32 vcc, v10, v106
    s_nop 1
    v_cndmask_b32 v106, 0, v106, vcc
    v_cmp_ne_u32 vcc, v10, v107
    s_nop 1
    v_cndmask_b32 v107, 0, v107, vcc
    v_cmp_ne_u32 vcc, v10, v108
    s_nop 1
    v_cndmask_b32 v108, 0, v108, vcc
    v_cmp_ne_u32 vcc, v10, v109
    s_nop 1
    v_cndmask_b32 v109, 0, v109, vcc
    v_cmp_ne_u32 vcc, v10, v110
    s_nop 1
    v_cndmask_b32 v110, 0, v110, vcc
    v_cmp_ne_u32 vcc, v10, v111
    s_nop 1
    v_cndmask_b32 v111, 0, v111, vcc
    v_cmp_ne_u32 vcc, v10, v112
    s_nop 1
    v_cndmask_b32 v112, 0, v112, vcc
    v_cmp_ne_u32 vcc, v10, v113
    s_nop 1
    v_cndmask_b32 v113, 0, v113, vcc
    v_cmp_ne_u32 vcc, v10, v114
    s_nop 1
    v_cndmask_b32 v114, 0, v114, vcc
    v_cmp_ne_u32 vcc, v10, v115
    s_nop 1
    v_cndmask_b32 v115, 0, v115, vcc
    v_cmp_ne_u32 vcc, v10, v116
    s_nop 1
    v_cndmask_b32 v116, 0, v116, vcc
    v_cmp_ne_u32 vcc, v10, v117
    s_nop 1
    v_cndmask_b32 v117, 0, v117, vcc
    v_cmp_ne_u32 vcc, v10, v118
    s_nop 1
    v_cndmask_b32 v118, 0, v118, vcc
    v_cmp_ne_u32 vcc, v10, v119
    s_nop 1
    v_cndmask_b32 v119, 0, v119, vcc
    v_cmp_ne_u32 vcc, v10, v120
    s_nop 1
    v_cndmask_b32 v120, 0, v120, vcc
    v_cmp_ne_u32 vcc, v10, v121
    s_nop 1
    v_cndmask_b32 v121, 0, v121, vcc
    v_cmp_ne_u32 vcc, v10, v122
    s_nop 1
    v_cndmask_b32 v122, 0, v122, vcc
    v_cmp_ne_u32 vcc, v10, v123
    s_nop 1
    v_cndmask_b32 v123, 0, v123, vcc
    v_cmp_ne_u32 vcc, v10, v124
    s_nop 1
    v_cndmask_b32 v124, 0, v124, vcc
    v_cmp_ne_u32 vcc, v10, v125
    s_nop 1
    v_cndmask_b32 v125, 0, v125, vcc
    v_cmp_ne_u32 vcc, v10, v126
    s_nop 1
    v_cndmask_b32 v126, 0, v126, vcc
    v_cmp_ne_u32 vcc, v10, v127
    s_nop 1
    v_cndmask_b32 v127, 0, v127, vcc
    v_max3_u32 v10, v96, v97, v98
    v_max3_u32 v10, v10, v99, v100
    v_max3_u32 v10, v10, v101, v102
    v_max3_u32 v10, v10, v103, v104
    v_max3_u32 v10, v10, v105, v106
    v_max3_u32 v10, v10, v107, v108
    v_max3_u32 v10, v10, v109, v110
    v_max3_u32 v10, v10, v111, v112
    v_max3_u32 v10, v10, v113, v114
    v_max3_u32 v10, v10, v115, v116
    v_max3_u32 v10, v10, v117, v118
    v_max3_u32 v10, v10, v119, v120
    v_max3_u32 v10, v10, v121, v122
    v_max3_u32 v10, v10, v123, v124
    v_max3_u32 v10, v10, v125, v126
    v_max_u32 v10, v10, v127
    s_nop 1
    v_max_u32_dpp v10, v10, v10 row_ror:8 row_mask:0xf bank_mask:0xf
    s_nop 1
    v_max_u32_dpp v10, v10, v10 row_ror:4 row_mask:0xf bank_mask:0xf
    s_nop 1
    v_max_u32_dpp v10, v10, v10 row_ror:2 row_mask:0xf bank_mask:0xf
    s_nop 1
    v_max_u32_dpp v10, v10, v10 row_ror:1 row_mask:0xf bank_mask:0xf
    v_mov_b32 v11, v10
    s_nop 1
    v_permlane16_swap_b32 v10, v11
    v_max_u32 v10, v10, v11
    v_mov_b32 v11, v10
    s_nop 1
    v_permlane32_swap_b32 v10, v11
    v_max_u32 v10, v10, v11
    s_nop 0
    v_readfirstlane_b32 s65, v10
    v_cmp_ne_u32 vcc, v10, v96
    s_nop 1
    v_cndmask_b32 v96, 0, v96, vcc
    v_cmp_ne_u32 vcc, v10, v97
    s_nop 1
    v_cndmask_b32 v97, 0, v97, vcc
    v_cmp_ne_u32 vcc, v10, v98
    s_nop 1
    v_cndmask_b32 v98, 0, v98, vcc
    v_cmp_ne_u32 vcc, v10, v99
    s_nop 1
    v_cndmask_b32 v99, 0, v99, vcc
    v_cmp_ne_u32 vcc, v10, v100
    s_nop 1
    v_cndmask_b32 v100, 0, v100, vcc
    v_cmp_ne_u32 vcc, v10, v101
    s_nop 1
    v_cndmask_b32 v101, 0, v101, vcc
    v_cmp_ne_u32 vcc, v10, v102
    s_nop 1
    v_cndmask_b32 v102, 0, v102, vcc
    v_cmp_ne_u32 vcc, v10, v103
    s_nop 1
    v_cndmask_b32 v103, 0, v103, vcc
    v_cmp_ne_u32 vcc, v10, v104
    s_nop 1
    v_cndmask_b32 v104, 0, v104, vcc
    v_cmp_ne_u32 vcc, v10, v105
    s_nop 1
    v_cndmask_b32 v105, 0, v105, vcc
    v_cmp_ne_u32 vcc, v10, v106
    s_nop 1
    v_cndmask_b32 v106, 0, v106, vcc
    v_cmp_ne_u32 vcc, v10, v107
    s_nop 1
    v_cndmask_b32 v107, 0, v107, vcc
    v_cmp_ne_u32 vcc, v10, v108
    s_nop 1
    v_cndmask_b32 v108, 0, v108, vcc
    v_cmp_ne_u32 vcc, v10, v109
    s_nop 1
    v_cndmask_b32 v109, 0, v109, vcc
    v_cmp_ne_u32 vcc, v10, v110
    s_nop 1
    v_cndmask_b32 v110, 0, v110, vcc
    v_cmp_ne_u32 vcc, v10, v111
    s_nop 1
    v_cndmask_b32 v111, 0, v111, vcc
    v_cmp_ne_u32 vcc, v10, v112
    s_nop 1
    v_cndmask_b32 v112, 0, v112, vcc
    v_cmp_ne_u32 vcc, v10, v113
    s_nop 1
    v_cndmask_b32 v113, 0, v113, vcc
    v_cmp_ne_u32 vcc, v10, v114
    s_nop 1
    v_cndmask_b32 v114, 0, v114, vcc
    v_cmp_ne_u32 vcc, v10, v115
    s_nop 1
    v_cndmask_b32 v115, 0, v115, vcc
    v_cmp_ne_u32 vcc, v10, v116
    s_nop 1
    v_cndmask_b32 v116, 0, v116, vcc
    v_cmp_ne_u32 vcc, v10, v117
    s_nop 1
    v_cndmask_b32 v117, 0, v117, vcc
    v_cmp_ne_u32 vcc, v10, v118
    s_nop 1
    v_cndmask_b32 v118, 0, v118, vcc
    v_cmp_ne_u32 vcc, v10, v119
    s_nop 1
    v_cndmask_b32 v119, 0, v119, vcc
    v_cmp_ne_u32 vcc, v10, v120
    s_nop 1
    v_cndmask_b32 v120, 0, v120, vcc
    v_cmp_ne_u32 vcc, v10, v121
    s_nop 1
    v_cndmask_b32 v121, 0, v121, vcc
    v_cmp_ne_u32 vcc, v10, v122
    s_nop 1
    v_cndmask_b32 v122, 0, v122, vcc
    v_cmp_ne_u32 vcc, v10, v123
    s_nop 1
    v_cndmask_b32 v123, 0, v123, vcc
    v_cmp_ne_u32 vcc, v10, v124
    s_nop 1
    v_cndmask_b32 v124, 0, v124, vcc
    v_cmp_ne_u32 vcc, v10, v125
    s_nop 1
    v_cndmask_b32 v125, 0, v125, vcc
    v_cmp_ne_u32 vcc, v10, v126
    s_nop 1
    v_cndmask_b32 v126, 0, v126, vcc
    v_cmp_ne_u32 vcc, v10, v127
    s_nop 1
    v_cndmask_b32 v127, 0, v127, vcc
    v_max3_u32 v10, v96, v97, v98
    v_max3_u32 v10, v10, v99, v100
    v_max3_u32 v10, v10, v101, v102
    v_max3_u32 v10, v10, v103, v104
    v_max3_u32 v10, v10, v105, v106
    v_max3_u32 v10, v10, v107, v108
    v_max3_u32 v10, v10, v109, v110
    v_max3_u32 v10, v10, v111, v112
    v_max3_u32 v10, v10, v113, v114
    v_max3_u32 v10, v10, v115, v116
    v_max3_u32 v10, v10, v117, v118
    v_max3_u32 v10, v10, v119, v120
    v_max3_u32 v10, v10, v121, v122
    v_max3_u32 v10, v10, v123, v124
    v_max3_u32 v10, v10, v125, v126
    v_max_u32 v10, v10, v127
    s_nop 1
    v_max_u32_dpp v10, v10, v10 row_ror:8 row_mask:0xf bank_mask:0xf
    s_nop 1
    v_max_u32_dpp v10, v10, v10 row_ror:4 row_mask:0xf bank_mask:0xf
    s_nop 1
    v_max_u32_dpp v10, v10, v10 row_ror:2 row_mask:0xf bank_mask:0xf
    s_nop 1
    v_max_u32_dpp v10, v10, v10 row_ror:1 row_mask:0xf bank_mask:0xf
    v_mov_b32 v11, v10
    s_nop 1
    v_permlane16_swap_b32 v10, v11
    v_max_u32 v10, v10, v11
    v_mov_b32 v11, v10
    s_nop 1
    v_permlane32_swap_b32 v10, v11
    v_max_u32 v10, v10, v11
    s_nop 0
    v_readfirstlane_b32 s66, v10
    v_cmp_ne_u32 vcc, v10, v96
    s_nop 1
    v_cndmask_b32 v96, 0, v96, vcc
    v_cmp_ne_u32 vcc, v10, v97
    s_nop 1
    v_cndmask_b32 v97, 0, v97, vcc
    v_cmp_ne_u32 vcc, v10, v98
    s_nop 1
    v_cndmask_b32 v98, 0, v98, vcc
    v_cmp_ne_u32 vcc, v10, v99
    s_nop 1
    v_cndmask_b32 v99, 0, v99, vcc
    v_cmp_ne_u32 vcc, v10, v100
    s_nop 1
    v_cndmask_b32 v100, 0, v100, vcc
    v_cmp_ne_u32 vcc, v10, v101
    s_nop 1
    v_cndmask_b32 v101, 0, v101, vcc
    v_cmp_ne_u32 vcc, v10, v102
    s_nop 1
    v_cndmask_b32 v102, 0, v102, vcc
    v_cmp_ne_u32 vcc, v10, v103
    s_nop 1
    v_cndmask_b32 v103, 0, v103, vcc
    v_cmp_ne_u32 vcc, v10, v104
    s_nop 1
    v_cndmask_b32 v104, 0, v104, vcc
    v_cmp_ne_u32 vcc, v10, v105
    s_nop 1
    v_cndmask_b32 v105, 0, v105, vcc
    v_cmp_ne_u32 vcc, v10, v106
    s_nop 1
    v_cndmask_b32 v106, 0, v106, vcc
    v_cmp_ne_u32 vcc, v10, v107
    s_nop 1
    v_cndmask_b32 v107, 0, v107, vcc
    v_cmp_ne_u32 vcc, v10, v108
    s_nop 1
    v_cndmask_b32 v108, 0, v108, vcc
    v_cmp_ne_u32 vcc, v10, v109
    s_nop 1
    v_cndmask_b32 v109, 0, v109, vcc
    v_cmp_ne_u32 vcc, v10, v110
    s_nop 1
    v_cndmask_b32 v110, 0, v110, vcc
    v_cmp_ne_u32 vcc, v10, v111
    s_nop 1
    v_cndmask_b32 v111, 0, v111, vcc
    v_cmp_ne_u32 vcc, v10, v112
    s_nop 1
    v_cndmask_b32 v112, 0, v112, vcc
    v_cmp_ne_u32 vcc, v10, v113
    s_nop 1
    v_cndmask_b32 v113, 0, v113, vcc
    v_cmp_ne_u32 vcc, v10, v114
    s_nop 1
    v_cndmask_b32 v114, 0, v114, vcc
    v_cmp_ne_u32 vcc, v10, v115
    s_nop 1
    v_cndmask_b32 v115, 0, v115, vcc
    v_cmp_ne_u32 vcc, v10, v116
    s_nop 1
    v_cndmask_b32 v116, 0, v116, vcc
    v_cmp_ne_u32 vcc, v10, v117
    s_nop 1
    v_cndmask_b32 v117, 0, v117, vcc
    v_cmp_ne_u32 vcc, v10, v118
    s_nop 1
    v_cndmask_b32 v118, 0, v118, vcc
    v_cmp_ne_u32 vcc, v10, v119
    s_nop 1
    v_cndmask_b32 v119, 0, v119, vcc
    v_cmp_ne_u32 vcc, v10, v120
    s_nop 1
    v_cndmask_b32 v120, 0, v120, vcc
    v_cmp_ne_u32 vcc, v10, v121
    s_nop 1
    v_cndmask_b32 v121, 0, v121, vcc
    v_cmp_ne_u32 vcc, v10, v122
    s_nop 1
    v_cndmask_b32 v122, 0, v122, vcc
    v_cmp_ne_u32 vcc, v10, v123
    s_nop 1
    v_cndmask_b32 v123, 0, v123, vcc
    v_cmp_ne_u32 vcc, v10, v124
    s_nop 1
    v_cndmask_b32 v124, 0, v124, vcc
    v_cmp_ne_u32 vcc, v10, v125
    s_nop 1
    v_cndmask_b32 v125, 0, v125, vcc
    v_cmp_ne_u32 vcc, v10, v126
    s_nop 1
    v_cndmask_b32 v126, 0, v126, vcc
    v_cmp_ne_u32 vcc, v10, v127
    s_nop 1
    v_cndmask_b32 v127, 0, v127, vcc
    v_max3_u32 v10, v96, v97, v98
    v_max3_u32 v10, v10, v99, v100
    v_max3_u32 v10, v10, v101, v102
    v_max3_u32 v10, v10, v103, v104
    v_max3_u32 v10, v10, v105, v106
    v_max3_u32 v10, v10, v107, v108
    v_max3_u32 v10, v10, v109, v110
    v_max3_u32 v10, v10, v111, v112
    v_max3_u32 v10, v10, v113, v114
    v_max3_u32 v10, v10, v115, v116
    v_max3_u32 v10, v10, v117, v118
    v_max3_u32 v10, v10, v119, v120
    v_max3_u32 v10, v10, v121, v122
    v_max3_u32 v10, v10, v123, v124
    v_max3_u32 v10, v10, v125, v126
    v_max_u32 v10, v10, v127
    s_nop 1
    v_max_u32_dpp v10, v10, v10 row_ror:8 row_mask:0xf bank_mask:0xf
    s_nop 1
    v_max_u32_dpp v10, v10, v10 row_ror:4 row_mask:0xf bank_mask:0xf
    s_nop 1
    v_max_u32_dpp v10, v10, v10 row_ror:2 row_mask:0xf bank_mask:0xf
    s_nop 1
    v_max_u32_dpp v10, v10, v10 row_ror:1 row_mask:0xf bank_mask:0xf
    v_mov_b32 v11, v10
    s_nop 1
    v_permlane16_swap_b32 v10, v11
    v_max_u32 v10, v10, v11
    v_mov_b32 v11, v10
    s_nop 1
    v_permlane32_swap_b32 v10, v11
    v_max_u32 v10, v10, v11
    s_nop 0
    v_readfirstlane_b32 s67, v10
    v_and_b32 v10, 7, v1
    v_mov_b32 v12, s60
    v_cmp_eq_u32 vcc, 1, v10
    v_mov_b32 v11, s61
    s_nop 0
    v_cndmask_b32 v12, v12, v11, vcc
    v_cmp_eq_u32 vcc, 2, v10
    v_mov_b32 v11, s62
    s_nop 0
    v_cndmask_b32 v12, v12, v11, vcc
    v_cmp_eq_u32 vcc, 3, v10
    v_mov_b32 v11, s63
    s_nop 0
    v_cndmask_b32 v12, v12, v11, vcc
    v_cmp_eq_u32 vcc, 4, v10
    v_mov_b32 v11, s64
    s_nop 0
    v_cndmask_b32 v12, v12, v11, vcc
    v_cmp_eq_u32 vcc, 5, v10
    v_mov_b32 v11, s65
    s_nop 0
    v_cndmask_b32 v12, v12, v11, vcc
    v_cmp_eq_u32 vcc, 6, v10
    v_mov_b32 v11, s66
    s_nop 0
    v_cndmask_b32 v12, v12, v11, vcc
    v_cmp_eq_u32 vcc, 7, v10
    v_mov_b32 v11, s67
    s_nop 0
    v_cndmask_b32 v12, v12, v11, vcc
    v_and_b32 v12, 0x7ff, v12
    v_sub_u32 v12, 0x7ff, v12
    v_lshlrev_b32 v10, 3, v12
    buffer_load_dwordx2 v[14:15], v10, s[20:23], 0 offen
    v_cmp_eq_u32 vcc, 8, v2
    v_mov_b32 v11, 0x3f803f80
    s_nop 0
    v_cndmask_b32 v32, 0, v11, vcc
    v_mov_b32 v33, v32
    v_mov_b32 v34, v32
    v_mov_b32 v35, v32
    v_mov_b32 v36, v32
    v_mov_b32 v37, v32
    v_mov_b32 v38, v32
    v_mov_b32 v39, v32
    v_mov_b32 v40, v32
    v_mov_b32 v41, v32
    v_mov_b32 v42, v32
    v_mov_b32 v43, v32
    v_mov_b32 v44, v32
    v_mov_b32 v45, v32
    v_mov_b32 v46, v32
    v_mov_b32 v47, v32
    v_mov_b32 v48, v32
    v_mov_b32 v49, v32
    v_mov_b32 v50, v32
    v_mov_b32 v51, v32
    v_mov_b32 v52, v32
    v_mov_b32 v53, v32
    v_mov_b32 v54, v32
    v_mov_b32 v55, v32
    v_mov_b32 v56, v32
    v_mov_b32 v57, v32
    v_mov_b32 v58, v32
    v_mov_b32 v59, v32
    v_mov_b32 v60, v32
    v_mov_b32 v61, v32
    v_mov_b32 v62, v32
    v_mov_b32 v63, v32
    v_lshlrev_b32 v10, 11, v12
    v_lshl_add_u32 v10, v3, 4, v10
    v_lshl_add_u32 v10, v4, 9, v10
    s_mov_b32 exec_lo, 0x00ff00ff
    s_mov_b32 exec_hi, 0x00ff00ff
    buffer_load_dwordx4 v[32:35], v10, s[4:7], 0 offen offset:0
    buffer_load_dwordx4 v[36:39], v10, s[4:7], 0 offen offset:64
    buffer_load_dwordx4 v[40:43], v10, s[4:7], 0 offen offset:128
    buffer_load_dwordx4 v[44:47], v10, s[4:7], 0 offen offset:192
    buffer_load_dwordx4 v[48:51], v10, s[4:7], 0 offen offset:256
    buffer_load_dwordx4 v[52:55], v10, s[4:7], 0 offen offset:320
    buffer_load_dwordx4 v[56:59], v10, s[4:7], 0 offen offset:384
    buffer_load_dwordx4 v[60:63], v10, s[4:7], 0 offen offset:448
    s_mov_b64 exec, -1
    v_lshlrev_b32 v13, 3, v1
    v_add_u32 v13, s48, v13
    s_waitcnt vmcnt(9)
    ds_read_b64_tr_b16 v[64:65], v13 offset:0
    ds_read_b64_tr_b16 v[66:67], v13 offset:512
    ds_read_b64_tr_b16 v[96:97], v13 offset:32768
    ds_read_b64_tr_b16 v[98:99], v13 offset:33280
    ds_read_b64_tr_b16 v[68:69], v13 offset:1024
    ds_read_b64_tr_b16 v[70:71], v13 offset:1536
    ds_read_b64_tr_b16 v[100:101], v13 offset:33792
    ds_read_b64_tr_b16 v[102:103], v13 offset:34304
    ds_read_b64_tr_b16 v[72:73], v13 offset:2048
    ds_read_b64_tr_b16 v[74:75], v13 offset:2560
    ds_read_b64_tr_b16 v[104:105], v13 offset:34816
    ds_read_b64_tr_b16 v[106:107], v13 offset:35328
    ds_read_b64_tr_b16 v[76:77], v13 offset:3072
    ds_read_b64_tr_b16 v[78:79], v13 offset:3584
    ds_read_b64_tr_b16 v[108:109], v13 offset:35840
    ds_read_b64_tr_b16 v[110:111], v13 offset:36352
    ds_read_b64_tr_b16 v[80:81], v13 offset:4096
    ds_read_b64_tr_b16 v[82:83], v13 offset:4608
    ds_read_b64_tr_b16 v[112:113], v13 offset:36864
    ds_read_b64_tr_b16 v[114:115], v13 offset:37376
    ds_read_b64_tr_b16 v[84:85], v13 offset:5120
    ds_read_b64_tr_b16 v[86:87], v13 offset:5632
    ds_read_b64_tr_b16 v[116:117], v13 offset:37888
    ds_read_b64_tr_b16 v[118:119], v13 offset:38400
    ds_read_b64_tr_b16 v[88:89], v13 offset:6144
    ds_read_b64_tr_b16 v[90:91], v13 offset:6656
    ds_read_b64_tr_b16 v[120:121], v13 offset:38912
    ds_read_b64_tr_b16 v[122:123], v13 offset:39424
    ds_read_b64_tr_b16 v[92:93], v13 offset:7168
    ds_read_b64_tr_b16 v[94:95], v13 offset:7680
    ds_read_b64_tr_b16 v[124:125], v13 offset:39936
    ds_read_b64_tr_b16 v[126:127], v13 offset:40448
    v_add_u32 v11, 65536, v13
    ds_read_b64_tr_b16 v[128:129], v11 offset:0
    ds_read_b64_tr_b16 v[130:131], v11 offset:512
    ds_read_b64_tr_b16 v[132:133], v11 offset:1024
    ds_read_b64_tr_b16 v[134:135], v11 offset:1536
    ds_read_b64_tr_b16 v[136:137], v11 offset:2048
    ds_read_b64_tr_b16 v[138:139], v11 offset:2560
    ds_read_b64_tr_b16 v[140:141], v11 offset:3072
    ds_read_b64_tr_b16 v[142:143], v11 offset:3584
    ds_read_b64_tr_b16 v[144:145], v11 offset:4096
    ds_read_b64_tr_b16 v[146:147], v11 offset:4608
    ds_read_b64_tr_b16 v[148:149], v11 offset:5120
    ds_read_b64_tr_b16 v[150:151], v11 offset:5632
    ds_read_b64_tr_b16 v[152:153], v11 offset:6144
    ds_read_b64_tr_b16 v[154:155], v11 offset:6656
    ds_read_b64_tr_b16 v[156:157], v11 offset:7168
    ds_read_b64_tr_b16 v[158:159], v11 offset:7680
    s_waitcnt lgkmcnt(0)
    s_waitcnt vmcnt(0)
    v_mfma_f32_16x16x32_bf16 v[16:19], v[64:67], v[32:35], 0
    v_mfma_f32_16x16x32_bf16 v[20:23], v[96:99], v[32:35], 0
    v_mfma_f32_16x16x32_bf16 v[16:19], v[68:71], v[36:39], v[16:19]
    v_mfma_f32_16x16x32_bf16 v[20:23], v[100:103], v[36:39], v[20:23]
    v_mfma_f32_16x16x32_bf16 v[16:19], v[72:75], v[40:43], v[16:19]
    v_mfma_f32_16x16x32_bf16 v[20:23], v[104:107], v[40:43], v[20:23]
    v_mfma_f32_16x16x32_bf16 v[16:19], v[76:79], v[44:47], v[16:19]
    v_mfma_f32_16x16x32_bf16 v[20:23], v[108:111], v[44:47], v[20:23]
    v_mfma_f32_16x16x32_bf16 v[16:19], v[80:83], v[48:51], v[16:19]
    v_mfma_f32_16x16x32_bf16 v[20:23], v[112:115], v[48:51], v[20:23]
    v_mfma_f32_16x16x32_bf16 v[16:19], v[84:87], v[52:55], v[16:19]
    v_mfma_f32_16x16x32_bf16 v[20:23], v[116:119], v[52:55], v[20:23]
    v_mfma_f32_16x16x32_bf16 v[16:19], v[88:91], v[56:59], v[16:19]
    v_mfma_f32_16x16x32_bf16 v[20:23], v[120:123], v[56:59], v[20:23]
    v_mfma_f32_16x16x32_bf16 v[16:19], v[92:95], v[60:63], v[16:19]
    v_mfma_f32_16x16x32_bf16 v[20:23], v[124:127], v[60:63], v[20:23]
    v_lshlrev_b32 v10, 6, v2
    v_lshl_add_u32 v10, v3, 4, v10
    v_lshl_add_u32 v10, v4, 10, v10
    v_add_u32 v10, 98304, v10
    s_nop 2
    ds_write_b128 v10, v[16:19]
    ds_write_b128 v10, v[20:23] offset:4096
    v_lshrrev_b32 v11, 3, v2
    v_lshlrev_b32 v11, 3, v11
    v_lshl_add_u32 v11, v3, 4, v11
    v_add_u32 v11, 98304, v11
    v_and_b32 v10, 7, v2
    v_lshl_add_u32 v10, v10, 6, v11
    s_waitcnt lgkmcnt(0)
    s_barrier
    ds_read_b64 v[64:65], v10 offset:0
    ds_read_b64 v[72:73], v11 offset:512
    ds_read_b64 v[66:67], v10 offset:1024
    ds_read_b64 v[74:75], v11 offset:1536
    ds_read_b64 v[68:69], v10 offset:2048
    ds_read_b64 v[76:77], v11 offset:2560
    ds_read_b64 v[70:71], v10 offset:3072
    ds_read_b64 v[78:79], v11 offset:3584
    ds_read_b64 v[80:81], v10 offset:4096
    ds_read_b64 v[88:89], v11 offset:4608
    ds_read_b64 v[82:83], v10 offset:5120
    ds_read_b64 v[90:91], v11 offset:5632
    ds_read_b64 v[84:85], v10 offset:6144
    ds_read_b64 v[92:93], v11 offset:6656
    ds_read_b64 v[86:87], v10 offset:7168
    ds_read_b64 v[94:95], v11 offset:7680
    v_lshlrev_b32 v24, 16, v14
    v_and_b32 v25, 0xffff0000, v14
    v_rcp_f32 v25, v25
    s_waitcnt lgkmcnt(0)
    v_pk_add_f32 v[64:65], v[64:65], v[66:67]
    v_pk_add_f32 v[68:69], v[68:69], v[70:71]
    v_pk_add_f32 v[64:65], v[64:65], v[68:69]
    v_pk_add_f32 v[72:73], v[72:73], v[74:75]
    v_pk_add_f32 v[76:77], v[76:77], v[78:79]
    v_pk_add_f32 v[72:73], v[72:73], v[76:77]
    v_pk_add_f32 v[80:81], v[80:81], v[82:83]
    v_pk_add_f32 v[84:85], v[84:85], v[86:87]
    v_pk_add_f32 v[80:81], v[80:81], v[84:85]
    v_pk_add_f32 v[88:89], v[88:89], v[90:91]
    v_pk_add_f32 v[92:93], v[92:93], v[94:95]
    v_pk_add_f32 v[88:89], v[88:89], v[92:93]
    v_pk_fma_f32 v[64:65], v[72:73], v[24:25], v[64:65] op_sel:[0,0,0] op_sel_hi:[1,0,1] neg_lo:[1,0,0] neg_hi:[1,0,0]
    v_pk_mul_f32 v[64:65], v[64:65], v[24:25] op_sel:[0,1] op_sel_hi:[1,1]
    v_pk_fma_f32 v[80:81], v[88:89], v[24:25], v[80:81] op_sel:[0,0,0] op_sel_hi:[1,0,1] neg_lo:[1,0,0] neg_hi:[1,0,0]
    v_pk_mul_f32 v[80:81], v[80:81], v[24:25] op_sel:[0,1] op_sel_hi:[1,1]
    v_mul_f32 v66, 0xbfb8aa3b, v64
    v_mul_f32 v67, 0xbfb8aa3b, v65
    v_exp_f32 v66, v66
    v_exp_f32 v67, v67
    v_add_f32 v66, 1.0, v66
    v_add_f32 v67, 1.0, v67
    v_rcp_f32 v66, v66
    v_rcp_f32 v67, v67
    v_pk_mul_f32 v[64:65], v[64:65], v[80:81]
    v_pk_mul_f32 v[64:65], v[64:65], v[66:67]
    v_cvt_pk_bf16_f32 v64, v64, v65
    s_nop 1
    v_mov_b32_dpp v65, v64 row_ror:8 row_mask:0xf bank_mask:0xf
    v_cmp_gt_u32 vcc, 8, v2
    s_nop 1
    v_cndmask_b32 v28, 0, v64, vcc
    v_cndmask_b32 v29, 0, v65, vcc
    v_cndmask_b32 v30, v65, 0, vcc
    v_cndmask_b32 v31, v64, 0, vcc
    v_lshrrev_b32 v10, 3, v2
    v_lshl_add_u32 v10, v10, 2, v3
    v_lshl_add_u32 v10, v4, 6, v10
    v_mul_u32_u24 v10, 28672, v10
    v_and_b32 v11, 7, v2
    v_lshlrev_b32 v11, 4, v11
    s_lshl_b32 s49, s2, 7
    v_add3_u32 v10, v10, v11, s49
    v_mfma_f32_16x16x32_bf16 v[32:35], v[128:131], v[28:31], 0
    v_mfma_f32_16x16x32_bf16 v[36:39], v[132:135], v[28:31], 0
    v_mfma_f32_16x16x32_bf16 v[40:43], v[136:139], v[28:31], 0
    v_mfma_f32_16x16x32_bf16 v[44:47], v[140:143], v[28:31], 0
    v_mfma_f32_16x16x32_bf16 v[48:51], v[144:147], v[28:31], 0
    v_mfma_f32_16x16x32_bf16 v[52:55], v[148:151], v[28:31], 0
    v_mfma_f32_16x16x32_bf16 v[56:59], v[152:155], v[28:31], 0
    v_mfma_f32_16x16x32_bf16 v[60:63], v[156:159], v[28:31], 0
    s_mov_b32 s49, 0
    buffer_store_dwordx4 v[32:35], v10, s[24:27], s49 offen
    s_mov_b32 s49, 229376
    buffer_store_dwordx4 v[36:39], v10, s[24:27], s49 offen
    s_mov_b32 s49, 458752
    buffer_store_dwordx4 v[40:43], v10, s[24:27], s49 offen
    s_mov_b32 s49, 688128
    buffer_store_dwordx4 v[44:47], v10, s[24:27], s49 offen
    s_mov_b32 s49, 917504
    buffer_store_dwordx4 v[48:51], v10, s[24:27], s49 offen
    s_mov_b32 s49, 1146880
    buffer_store_dwordx4 v[52:55], v10, s[24:27], s49 offen
    s_mov_b32 s49, 1376256
    buffer_store_dwordx4 v[56:59], v10, s[24:27], s49 offen
    s_mov_b32 s49, 1605632
    buffer_store_dwordx4 v[60:63], v10, s[24:27], s49 offen
    s_or_b32 s49, s2, s45
    s_cmp_lg_u32 s49, 0
    s_cbranch_scc1 ffn_kernel_end
    v_lshlrev_b32 v16, 16, v15
    v_mul_f32 v16, 0xbfb8aa3b, v16
    v_exp_f32 v16, v16
    s_nop 0
    v_add_f32 v16, 1.0, v16
    v_rcp_f32 v16, v16
    s_nop 0
    v_cvt_pk_bf16_f32 v16, v16, v16
    v_and_b32 v17, 0xffff0000, v16
    v_mov_b32 v16, v12
    v_lshlrev_b32 v10, 3, v1
    v_add_u32 v10, 32768, v10
    s_mov_b64 exec, 0xff
    buffer_store_dwordx2 v[16:17], v10, s[20:23], 0 offen
ffn_kernel_end:
    s_endpgm
.text
.globl fix_kernel
.p2align 8
.type fix_kernel,@function
fix_kernel:
    s_cmp_ge_u32 s2, 256
    s_cbranch_scc1 fix_kernel_end
    s_load_dwordx2 s[4:5], s[0:1], 96
    s_load_dwordx2 s[20:21], s[0:1], 112
    s_load_dwordx2 s[24:25], s[0:1], 112
    s_mul_i32 s3, s2, 28672
    v_lshl_add_u32 v4, v0, 4, s3
    v_and_b32 v5, 7, v0
    v_lshlrev_b32 v6, 3, v5
    v_add_u32 v6, 32768, v6
    s_mov_b32 s52, 0
    s_mov_b32 s53, 4096
    s_mov_b32 s54, 8192
    s_mov_b32 s55, 12288
    s_mov_b32 s56, 16384
    s_mov_b32 s57, 20480
    s_mov_b32 s58, 24576
    s_waitcnt lgkmcnt(0)
    s_mov_b32 s6, 4194304
    s_mov_b32 s7, 0x00020000
    s_mov_b32 s22, 65536
    s_mov_b32 s23, 0x00020000
    s_add_u32 s24, s24, 1048576
    s_addc_u32 s25, s25, 0
    s_mov_b32 s26, 7340032
    s_mov_b32 s27, 0x00020000
    buffer_load_dwordx2 v[8:9], v6, s[20:23], 0 offen
    buffer_load_dwordx4 v[16:19], v4, s[24:27], s52 offen
    buffer_load_dwordx4 v[20:23], v4, s[24:27], s53 offen
    buffer_load_dwordx4 v[24:27], v4, s[24:27], s54 offen
    buffer_load_dwordx4 v[28:31], v4, s[24:27], s55 offen
    buffer_load_dwordx4 v[32:35], v4, s[24:27], s56 offen
    buffer_load_dwordx4 v[36:39], v4, s[24:27], s57 offen
    buffer_load_dwordx4 v[40:43], v4, s[24:27], s58 offen
    s_waitcnt vmcnt(7)
    s_lshl_b32 s3, s2, 3
    v_lshl_add_u32 v7, v8, 11, s3
    buffer_load_dwordx2 v[10:11], v7, s[4:7], 0 offen
    s_waitcnt vmcnt(1)
    v_pk_add_f32 v[16:17], v[16:17], v[20:21]
    v_pk_add_f32 v[18:19], v[18:19], v[22:23]
    v_pk_add_f32 v[16:17], v[16:17], v[24:25]
    v_pk_add_f32 v[18:19], v[18:19], v[26:27]
    v_pk_add_f32 v[16:17], v[16:17], v[28:29]
    v_pk_add_f32 v[18:19], v[18:19], v[30:31]
    v_pk_add_f32 v[16:17], v[16:17], v[32:33]
    v_pk_add_f32 v[18:19], v[18:19], v[34:35]
    v_pk_add_f32 v[16:17], v[16:17], v[36:37]
    v_pk_add_f32 v[18:19], v[18:19], v[38:39]
    v_pk_add_f32 v[16:17], v[16:17], v[40:41]
    v_pk_add_f32 v[18:19], v[18:19], v[42:43]
    s_nop 0
    v_add_f32_dpp v16, v16, v16 row_ror:8 row_mask:0xf bank_mask:0xf
    v_add_f32_dpp v17, v17, v17 row_ror:8 row_mask:0xf bank_mask:0xf
    v_add_f32_dpp v18, v18, v18 row_ror:8 row_mask:0xf bank_mask:0xf
    v_add_f32_dpp v19, v19, v19 row_ror:8 row_mask:0xf bank_mask:0xf
    v_mov_b32 v20, v16
    v_mov_b32 v21, v17
    v_mov_b32 v22, v18
    v_mov_b32 v23, v19
    v_permlane16_swap_b32 v16, v20
    v_permlane16_swap_b32 v17, v21
    v_permlane16_swap_b32 v18, v22
    v_permlane16_swap_b32 v19, v23
    v_add_f32 v16, v16, v20
    v_add_f32 v17, v17, v21
    v_add_f32 v18, v18, v22
    v_add_f32 v19, v19, v23
    v_mov_b32 v20, v16
    v_mov_b32 v21, v17
    v_mov_b32 v22, v18
    v_mov_b32 v23, v19
    v_permlane32_swap_b32 v16, v20
    v_permlane32_swap_b32 v17, v21
    v_permlane32_swap_b32 v18, v22
    v_permlane32_swap_b32 v19, v23
    v_add_f32 v16, v16, v20
    v_add_f32 v17, v17, v21
    v_add_f32 v18, v18, v22
    v_add_f32 v19, v19, v23
    v_lshrrev_b32 v12, 6, v0
    v_lshlrev_b32 v12, 7, v12
    v_lshl_add_u32 v12, v5, 4, v12
    ds_write_b128 v12, v[16:19]
    s_waitcnt lgkmcnt(0)
    s_barrier
    v_lshlrev_b32 v12, 4, v5
    ds_read_b128 v[16:19], v12 offset:0
    ds_read_b128 v[20:23], v12 offset:128
    ds_read_b128 v[24:27], v12 offset:256
    ds_read_b128 v[28:31], v12 offset:384
    s_waitcnt lgkmcnt(0)
    v_pk_add_f32 v[16:17], v[16:17], v[20:21]
    v_pk_add_f32 v[18:19], v[18:19], v[22:23]
    v_pk_add_f32 v[16:17], v[16:17], v[24:25]
    v_pk_add_f32 v[18:19], v[18:19], v[26:27]
    v_pk_add_f32 v[16:17], v[16:17], v[28:29]
    v_pk_add_f32 v[18:19], v[18:19], v[30:31]
    s_waitcnt vmcnt(0)
    v_lshlrev_b32 v20, 16, v10
    v_and_b32 v21, 0xffff0000, v10
    v_lshlrev_b32 v22, 16, v11
    v_and_b32 v23, 0xffff0000, v11
    v_fma_f32 v16, v16, v9, v20
    v_fma_f32 v17, v17, v9, v21
    v_fma_f32 v18, v18, v9, v22
    v_fma_f32 v19, v19, v9, v23
    v_cvt_pk_bf16_f32 v16, v16, v17
    v_cvt_pk_bf16_f32 v17, v18, v19
    v_cmp_gt_u32 vcc, 8, v0
    s_and_saveexec_b64 s[30:31], vcc
    s_cbranch_execz fix_kernel_end
    buffer_store_dwordx2 v[16:17], v7, s[4:7], 0 offen
fix_kernel_end:
    s_endpgm
.section .rodata,"a"
.p2align 6
.amdhsa_kernel ln_kernel
  .amdhsa_next_free_vgpr 96
  .amdhsa_next_free_sgpr 24
  .amdhsa_accum_offset 96
  .amdhsa_group_segment_fixed_size 0
  .amdhsa_kernarg_size 120
  .amdhsa_user_sgpr_count 2
  .amdhsa_user_sgpr_kernarg_segment_ptr 1
  .amdhsa_system_sgpr_workgroup_id_x 1
.end_amdhsa_kernel
.section .rodata,"a"
.p2align 6
.amdhsa_kernel conv_kernel
  .amdhsa_next_free_vgpr 256
  .amdhsa_next_free_sgpr 64
  .amdhsa_accum_offset 256
  .amdhsa_group_segment_fixed_size 0
  .amdhsa_kernarg_size 120
  .amdhsa_user_sgpr_count 2
  .amdhsa_user_sgpr_kernarg_segment_ptr 1
  .amdhsa_system_sgpr_workgroup_id_x 1
.end_amdhsa_kernel
.section .rodata,"a"
.p2align 6
.amdhsa_kernel ffn_kernel
  .amdhsa_next_free_vgpr 160
  .amdhsa_next_free_sgpr 72
  .amdhsa_accum_offset 160
  .amdhsa_group_segment_fixed_size 0
  .amdhsa_kernarg_size 120
  .amdhsa_user_sgpr_count 2
  .amdhsa_user_sgpr_kernarg_segment_ptr 1
  .amdhsa_system_sgpr_workgroup_id_x 1
.end_amdhsa_kernel
.section .rodata,"a"
.p2align 6
.amdhsa_kernel fix_kernel
  .amdhsa_next_free_vgpr 48
  .amdhsa_next_free_sgpr 64
  .amdhsa_accum_offset 48
  .amdhsa_group_segment_fixed_size 0
  .amdhsa_kernarg_size 120
  .amdhsa_user_sgpr_count 2
  .amdhsa_user_sgpr_kernarg_segment_ptr 1
  .amdhsa_system_sgpr_workgroup_id_x 1
.end_amdhsa_kernel
```

```asm
; @launch grid=(256,1,1) block=(512,1,1) lds=148480
.amdgcn_target "amdgcn-amd-amdhsa--gfx950"
.text
.globl parallel_sum__ssm_conv_s4d__moe_arch_mod__prompt_kernel
.p2align 8
.type parallel_sum__ssm_conv_s4d__moe_arch_mod__prompt_kernel,@function
parallel_sum__ssm_conv_s4d__moe_arch_mod__prompt_kernel:
    s_cmp_ge_u32 s2, 256
    s_cbranch_scc1 L_exit
    s_lshr_b32 s3, s2, 3
    s_cmp_ge_u32 s3, 16
    s_cbranch_scc1 L_conv
    s_load_dwordx2 s[4:5], s[0:1], 0
    s_load_dwordx2 s[8:9], s[0:1], 64
    s_load_dwordx2 s[12:13], s[0:1], 112
    s_load_dwordx2 s[16:17], s[0:1], 72
    s_load_dwordx2 s[20:21], s[0:1], 80
    s_and_b32 s30, s2, 7
    s_lshl_b32 s30, s30, 4
    s_add_u32 s30, s30, s3
    v_and_b32 v1, 63, v0
    v_and_b32 v2, 15, v0
    v_bfe_u32 v3, v0, 4, 2
    v_lshrrev_b32 v29, 6, v0
    s_nop 0
    v_readfirstlane_b32 s31, v29
    s_lshl_b32 s32, s30, 15
    v_lshlrev_b32 v30, 12, v29
    v_lshlrev_b32 v28, 4, v1
    v_add3_u32 v30, v30, v28, s32
    s_waitcnt lgkmcnt(0)
    s_load_dword s28, s[12:13], 0
    s_mov_b32 s6, 4194304
    s_mov_b32 s7, 0x00020000
    s_mov_b32 s10, 2048
    s_mov_b32 s11, 0x00020000
    buffer_load_dwordx4 v[4:7], v30, s[4:7], 0 offen offset:0
    buffer_load_dwordx4 v[8:11], v30, s[4:7], 0 offen offset:1024
    buffer_load_dwordx4 v[12:15], v30, s[4:7], 0 offen offset:2048
    buffer_load_dwordx4 v[16:19], v30, s[4:7], 0 offen offset:3072
    buffer_load_dwordx4 v[20:23], v28, s[8:11], 0 offen offset:0
    buffer_load_dwordx4 v[24:27], v28, s[8:11], 0 offen offset:1024
    s_mov_b32 s14, 147584
    s_mov_b32 s15, 0x00020000
    s_mov_b32 s18, 7340032
    s_mov_b32 s19, 0x00020000
    s_mov_b32 s22, 7340032
    s_mov_b32 s23, 0x00020000
    v_mov_b32 v96, 0
    v_mov_b32 v97, 0
    v_lshlrev_b32 v98, 3, v1
    v_add_u32 v98, 139264, v98
    s_cmp_lg_u32 s31, 0
    s_cbranch_scc1 L_aux_noz
    ds_write_b64 v98, v[96:97]
L_aux_noz:
    v_bfe_u32 v96, v1, 2, 2
    v_lshl_add_u32 v96, v3, 3, v96
    v_mul_u32_u24 v96, 7168, v96
    v_and_b32 v97, 1, v3
    v_lshlrev_b32 v97, 1, v97
    v_and_b32 v98, 3, v1
    v_xor_b32 v97, v97, v98
    s_lshl_b32 s33, s30, 6
    v_lshl_add_u32 v96, v97, 4, v96
    v_add_u32 v96, s33, v96
    s_sub_u32 s36, s31, 4
    s_mul_i32 s34, s36, 1835008
    s_lshl_b32 s36, s36, 15
    s_cmp_ge_u32 s31, 4
    s_cselect_b32 s37, 1, 0
    s_cmp_lt_u32 s30, 112
    s_cselect_b32 s37, s37, 0
    s_waitcnt vmcnt(4)
    v_lshlrev_b32 v48, 16, v4
    v_and_b32 v49, 0xffff0000, v4
    v_lshlrev_b32 v50, 16, v5
    v_and_b32 v51, 0xffff0000, v5
    v_lshlrev_b32 v52, 16, v6
    v_and_b32 v53, 0xffff0000, v6
    v_lshlrev_b32 v54, 16, v7
    v_and_b32 v55, 0xffff0000, v7
    v_lshlrev_b32 v56, 16, v8
    v_and_b32 v57, 0xffff0000, v8
    v_lshlrev_b32 v58, 16, v9
    v_and_b32 v59, 0xffff0000, v9
    v_lshlrev_b32 v60, 16, v10
    v_and_b32 v61, 0xffff0000, v10
    v_lshlrev_b32 v62, 16, v11
    v_and_b32 v63, 0xffff0000, v11
    s_waitcnt vmcnt(2)
    v_lshlrev_b32 v64, 16, v12
    v_and_b32 v65, 0xffff0000, v12
    v_lshlrev_b32 v66, 16, v13
    v_and_b32 v67, 0xffff0000, v13
    v_lshlrev_b32 v68, 16, v14
    v_and_b32 v69, 0xffff0000, v14
    v_lshlrev_b32 v70, 16, v15
    v_and_b32 v71, 0xffff0000, v15
    v_lshlrev_b32 v72, 16, v16
    v_and_b32 v73, 0xffff0000, v16
    v_lshlrev_b32 v74, 16, v17
    v_and_b32 v75, 0xffff0000, v17
    v_lshlrev_b32 v76, 16, v18
    v_and_b32 v77, 0xffff0000, v18
    v_lshlrev_b32 v78, 16, v19
    v_and_b32 v79, 0xffff0000, v19
    v_readfirstlane_b32 s38, v48
    v_readfirstlane_b32 s39, v64
    s_waitcnt vmcnt(0)
    v_lshlrev_b32 v32, 16, v20
    v_and_b32 v33, 0xffff0000, v20
    v_lshlrev_b32 v34, 16, v21
    v_and_b32 v35, 0xffff0000, v21
    v_lshlrev_b32 v36, 16, v22
    v_and_b32 v37, 0xffff0000, v22
    v_lshlrev_b32 v38, 16, v23
    v_and_b32 v39, 0xffff0000, v23
    v_lshlrev_b32 v40, 16, v24
    v_and_b32 v41, 0xffff0000, v24
    v_lshlrev_b32 v42, 16, v25
    v_and_b32 v43, 0xffff0000, v25
    v_lshlrev_b32 v44, 16, v26
    v_and_b32 v45, 0xffff0000, v26
    v_lshlrev_b32 v46, 16, v27
    v_and_b32 v47, 0xffff0000, v27
    v_pk_add_f32 v[48:49], v[48:49], s[38:39] op_sel:[0,0] op_sel_hi:[1,0] neg_lo:[0,1] neg_hi:[0,1]
    v_pk_add_f32 v[64:65], v[64:65], s[38:39] op_sel:[0,1] op_sel_hi:[1,1] neg_lo:[0,1] neg_hi:[0,1]
    v_pk_add_f32 v[50:51], v[50:51], s[38:39] op_sel:[0,0] op_sel_hi:[1,0] neg_lo:[0,1] neg_hi:[0,1]
    v_pk_add_f32 v[66:67], v[66:67], s[38:39] op_sel:[0,1] op_sel_hi:[1,1] neg_lo:[0,1] neg_hi:[0,1]
    v_pk_add_f32 v[52:53], v[52:53], s[38:39] op_sel:[0,0] op_sel_hi:[1,0] neg_lo:[0,1] neg_hi:[0,1]
    v_pk_add_f32 v[68:69], v[68:69], s[38:39] op_sel:[0,1] op_sel_hi:[1,1] neg_lo:[0,1] neg_hi:[0,1]
    v_pk_add_f32 v[54:55], v[54:55], s[38:39] op_sel:[0,0] op_sel_hi:[1,0] neg_lo:[0,1] neg_hi:[0,1]
    v_pk_add_f32 v[70:71], v[70:71], s[38:39] op_sel:[0,1] op_sel_hi:[1,1] neg_lo:[0,1] neg_hi:[0,1]
    v_pk_add_f32 v[56:57], v[56:57], s[38:39] op_sel:[0,0] op_sel_hi:[1,0] neg_lo:[0,1] neg_hi:[0,1]
    v_pk_add_f32 v[72:73], v[72:73], s[38:39] op_sel:[0,1] op_sel_hi:[1,1] neg_lo:[0,1] neg_hi:[0,1]
    v_pk_add_f32 v[58:59], v[58:59], s[38:39] op_sel:[0,0] op_sel_hi:[1,0] neg_lo:[0,1] neg_hi:[0,1]
    v_pk_add_f32 v[74:75], v[74:75], s[38:39] op_sel:[0,1] op_sel_hi:[1,1] neg_lo:[0,1] neg_hi:[0,1]
    v_pk_add_f32 v[60:61], v[60:61], s[38:39] op_sel:[0,0] op_sel_hi:[1,0] neg_lo:[0,1] neg_hi:[0,1]
    v_pk_add_f32 v[76:77], v[76:77], s[38:39] op_sel:[0,1] op_sel_hi:[1,1] neg_lo:[0,1] neg_hi:[0,1]
    v_pk_add_f32 v[62:63], v[62:63], s[38:39] op_sel:[0,0] op_sel_hi:[1,0] neg_lo:[0,1] neg_hi:[0,1]
    v_pk_add_f32 v[78:79], v[78:79], s[38:39] op_sel:[0,1] op_sel_hi:[1,1] neg_lo:[0,1] neg_hi:[0,1]
    v_pk_add_f32 v[80:81], v[48:49], v[50:51]
    v_pk_add_f32 v[82:83], v[64:65], v[66:67]
    v_pk_add_f32 v[92:93], v[32:33], v[34:35]
    v_pk_mul_f32 v[84:85], v[48:49], v[48:49]
    v_pk_mul_f32 v[86:87], v[64:65], v[64:65]
    v_pk_mul_f32 v[88:89], v[48:49], v[32:33]
    v_pk_mul_f32 v[90:91], v[64:65], v[32:33]
    v_pk_fma_f32 v[84:85], v[50:51], v[50:51], v[84:85]
    v_pk_fma_f32 v[86:87], v[66:67], v[66:67], v[86:87]
    v_pk_fma_f32 v[88:89], v[50:51], v[34:35], v[88:89]
    v_pk_fma_f32 v[90:91], v[66:67], v[34:35], v[90:91]
    v_pk_add_f32 v[80:81], v[80:81], v[52:53]
    v_pk_add_f32 v[82:83], v[82:83], v[68:69]
    v_pk_add_f32 v[92:93], v[92:93], v[36:37]
    v_pk_fma_f32 v[84:85], v[52:53], v[52:53], v[84:85]
    v_pk_fma_f32 v[86:87], v[68:69], v[68:69], v[86:87]
    v_pk_fma_f32 v[88:89], v[52:53], v[36:37], v[88:89]
    v_pk_fma_f32 v[90:91], v[68:69], v[36:37], v[90:91]
    v_pk_add_f32 v[80:81], v[80:81], v[54:55]
    v_pk_add_f32 v[82:83], v[82:83], v[70:71]
    v_pk_add_f32 v[92:93], v[92:93], v[38:39]
    v_pk_fma_f32 v[84:85], v[54:55], v[54:55], v[84:85]
    v_pk_fma_f32 v[86:87], v[70:71], v[70:71], v[86:87]
    v_pk_fma_f32 v[88:89], v[54:55], v[38:39], v[88:89]
    v_pk_fma_f32 v[90:91], v[70:71], v[38:39], v[90:91]
    v_pk_add_f32 v[80:81], v[80:81], v[56:57]
    v_pk_add_f32 v[82:83], v[82:83], v[72:73]
    v_pk_add_f32 v[92:93], v[92:93], v[40:41]
    v_pk_fma_f32 v[84:85], v[56:57], v[56:57], v[84:85]
    v_pk_fma_f32 v[86:87], v[72:73], v[72:73], v[86:87]
    v_pk_fma_f32 v[88:89], v[56:57], v[40:41], v[88:89]
    v_pk_fma_f32 v[90:91], v[72:73], v[40:41], v[90:91]
    v_pk_add_f32 v[80:81], v[80:81], v[58:59]
    v_pk_add_f32 v[82:83], v[82:83], v[74:75]
    v_pk_add_f32 v[92:93], v[92:93], v[42:43]
    v_pk_fma_f32 v[84:85], v[58:59], v[58:59], v[84:85]
    v_pk_fma_f32 v[86:87], v[74:75], v[74:75], v[86:87]
    v_pk_fma_f32 v[88:89], v[58:59], v[42:43], v[88:89]
    v_pk_fma_f32 v[90:91], v[74:75], v[42:43], v[90:91]
    v_pk_add_f32 v[80:81], v[80:81], v[60:61]
    v_pk_add_f32 v[82:83], v[82:83], v[76:77]
    v_pk_add_f32 v[92:93], v[92:93], v[44:45]
    v_pk_fma_f32 v[84:85], v[60:61], v[60:61], v[84:85]
    v_pk_fma_f32 v[86:87], v[76:77], v[76:77], v[86:87]
    v_pk_fma_f32 v[88:89], v[60:61], v[44:45], v[88:89]
    v_pk_fma_f32 v[90:91], v[76:77], v[44:45], v[90:91]
    v_pk_add_f32 v[80:81], v[80:81], v[62:63]
    v_pk_add_f32 v[82:83], v[82:83], v[78:79]
    v_pk_add_f32 v[92:93], v[92:93], v[46:47]
    v_pk_fma_f32 v[84:85], v[62:63], v[62:63], v[84:85]
    v_pk_fma_f32 v[86:87], v[78:79], v[78:79], v[86:87]
    v_pk_fma_f32 v[88:89], v[62:63], v[46:47], v[88:89]
    v_pk_fma_f32 v[90:91], v[78:79], v[46:47], v[90:91]
    v_add_f32 v80, v80, v81
    v_add_f32 v82, v82, v83
    v_add_f32 v84, v84, v85
    v_add_f32 v86, v86, v87
    v_add_f32 v88, v88, v89
    v_add_f32 v90, v90, v91
    v_add_f32 v92, v92, v93
    v_mov_b32 v93, v92
    v_permlane32_swap_b32 v80, v82
    v_permlane32_swap_b32 v84, v86
    v_permlane32_swap_b32 v88, v90
    v_permlane32_swap_b32 v92, v93
    v_add_f32 v80, v80, v82
    v_add_f32 v84, v84, v86
    v_add_f32 v88, v88, v90
    v_add_f32 v92, v92, v93
    v_add_f32_dpp v80, v80, v80 row_ror:8 row_mask:0xf bank_mask:0xf
    v_add_f32_dpp v84, v84, v84 row_ror:8 row_mask:0xf bank_mask:0xf
    v_add_f32_dpp v88, v88, v88 row_ror:8 row_mask:0xf bank_mask:0xf
    v_add_f32_dpp v92, v92, v92 row_ror:8 row_mask:0xf bank_mask:0xf
    v_add_f32_dpp v80, v80, v80 row_ror:4 row_mask:0xf bank_mask:0xf
    v_add_f32_dpp v84, v84, v84 row_ror:4 row_mask:0xf bank_mask:0xf
    v_add_f32_dpp v88, v88, v88 row_ror:4 row_mask:0xf bank_mask:0xf
    v_add_f32_dpp v92, v92, v92 row_ror:4 row_mask:0xf bank_mask:0xf
    v_add_f32_dpp v80, v80, v80 row_ror:2 row_mask:0xf bank_mask:0xf
    v_add_f32_dpp v84, v84, v84 row_ror:2 row_mask:0xf bank_mask:0xf
    v_add_f32_dpp v88, v88, v88 row_ror:2 row_mask:0xf bank_mask:0xf
    v_add_f32_dpp v92, v92, v92 row_ror:2 row_mask:0xf bank_mask:0xf
    v_add_f32_dpp v80, v80, v80 row_ror:1 row_mask:0xf bank_mask:0xf
    v_add_f32_dpp v84, v84, v84 row_ror:1 row_mask:0xf bank_mask:0xf
    v_add_f32_dpp v88, v88, v88 row_ror:1 row_mask:0xf bank_mask:0xf
    v_add_f32_dpp v92, v92, v92 row_ror:1 row_mask:0xf bank_mask:0xf
    v_mov_b32 v81, v80
    v_mov_b32 v85, v84
    v_mov_b32 v89, v88
    v_mov_b32 v93, v92
    v_permlane16_swap_b32 v80, v81
    v_permlane16_swap_b32 v84, v85
    v_permlane16_swap_b32 v88, v89
    v_permlane16_swap_b32 v92, v93
    v_add_f32 v80, v80, v81
    v_add_f32 v84, v84, v85
    v_add_f32 v88, v88, v89
    v_add_f32 v92, v92, v93
    v_cmp_gt_u32 vcc, 32, v1
    v_mov_b32 v40, s39
    v_mov_b32 v44, s38
    v_cndmask_b32 v40, v40, v44, vcc
    v_mul_f32 v41, 0x3a800000, v80
    v_mul_f32 v43, 0x3a800000, v84
    v_add_f32 v42, v40, v41
    v_fma_f32 v43, -v41, v41, v43
    v_max_f32 v43, 0, v43
    v_cvt_pk_bf16_f32 v42, v42, v43
    v_and_b32 v43, 0xffff0000, v42
    v_lshlrev_b32 v45, 16, v42
    v_add_f32 v43, 0x3727c5ac, v43
    v_cvt_pk_bf16_f32 v43, v43, v43
    v_and_b32 v43, 0xffff0000, v43
    v_sqrt_f32 v43, v43
    v_sub_f32 v44, v40, v45
    v_cvt_pk_bf16_f32 v60, v45, v43
    v_and_b32 v43, 0xffff0000, v60
    v_rcp_f32 v46, v43
    v_fma_f32 v44, v44, v92, v88
    v_mov_b32 v61, v60
    v_mul_f32 v44, v44, v46
    v_cvt_pk_bf16_f32 v64, v44, v44
    v_ashrrev_i32 v65, 31, v64
    v_or_b32 v65, 0x80000000, v65
    v_xor_b32 v64, v64, v65
    v_permlane32_swap_b32 v60, v61
    v_lshrrev_b32 v64, 16, v64
    v_mov_b32 v65, v64
    s_waitcnt lgkmcnt(0)
    s_mul_i32 s29, s28, 0x9e3779b1
    s_add_u32 s29, s29, 0x7f4a7c15
    v_permlane32_swap_b32 v64, v65
    s_lshl_b32 s32, s30, 3
    s_add_u32 s32, s32, s31
    s_and_b32 s33, s32, 1
    s_lshl_b32 s33, s33, 9
    s_lshr_b32 s32, s32, 1
    s_add_u32 s32, s32, s33
    s_lshl_b32 s32, s32, 4
    s_add_u32 s32, s32, 4096
    v_lshl_or_b32 v62, v65, 16, v64
    v_mov_b32 v63, s29
    v_mov_b32 v66, s32
    s_mov_b64 exec, 1
    buffer_store_dwordx4 v[60:63], v66, s[12:15], 0 offen sc1
    s_mov_b64 exec, -1
    v_cmp_eq_u32 vcc, 8, v2
    v_mov_b32 v11, 0x3f803f80
    s_nop 0
    v_cndmask_b32 v32, 0, v11, vcc
    v_mov_b32 v33, v32
    v_mov_b32 v34, v32
    v_mov_b32 v35, v32
    v_mov_b32 v36, v32
    v_mov_b32 v37, v32
    v_mov_b32 v38, v32
    v_mov_b32 v39, v32
    v_mov_b32 v40, v32
    v_mov_b32 v41, v32
    v_mov_b32 v42, v32
    v_mov_b32 v43, v32
    v_mov_b32 v44, v32
    v_mov_b32 v45, v32
    v_mov_b32 v46, v32
    v_mov_b32 v47, v32
    s_cmp_lt_u32 s31, 4
    s_cbranch_scc1 L_aux_poller
    s_cmp_eq_u32 s37, 0
    s_cbranch_scc1 L_aux_nodma1
    s_add_u32 s35, s34, 0
    s_add_u32 m0, s36, 0
    s_nop 0
    buffer_load_dwordx4 v96, s[16:19], s35 offen lds
    s_add_u32 s35, s34, 28672
    s_add_u32 m0, s36, 1024
    s_nop 0
    buffer_load_dwordx4 v96, s[16:19], s35 offen lds
    s_add_u32 s35, s34, 229376
    s_add_u32 m0, s36, 2048
    s_nop 0
    buffer_load_dwordx4 v96, s[16:19], s35 offen lds
    s_add_u32 s35, s34, 258048
    s_add_u32 m0, s36, 3072
    s_nop 0
    buffer_load_dwordx4 v96, s[16:19], s35 offen lds
    s_add_u32 s35, s34, 458752
    s_add_u32 m0, s36, 4096
    s_nop 0
    buffer_load_dwordx4 v96, s[16:19], s35 offen lds
    s_add_u32 s35, s34, 487424
    s_add_u32 m0, s36, 5120
    s_nop 0
    buffer_load_dwordx4 v96, s[16:19], s35 offen lds
    s_add_u32 s35, s34, 688128
    s_add_u32 m0, s36, 6144
    s_nop 0
    buffer_load_dwordx4 v96, s[16:19], s35 offen lds
    s_add_u32 s35, s34, 716800
    s_add_u32 m0, s36, 7168
    s_nop 0
    buffer_load_dwordx4 v96, s[16:19], s35 offen lds
    s_add_u32 s35, s34, 0
    s_add_u32 m0, s36, 8192
    s_nop 0
    buffer_load_dwordx4 v96, s[20:23], s35 offen lds
    s_add_u32 s35, s34, 28672
    s_add_u32 m0, s36, 9216
    s_nop 0
    buffer_load_dwordx4 v96, s[20:23], s35 offen lds
    s_add_u32 s35, s34, 229376
    s_add_u32 m0, s36, 10240
    s_nop 0
    buffer_load_dwordx4 v96, s[20:23], s35 offen lds
    s_add_u32 s35, s34, 258048
    s_add_u32 m0, s36, 11264
    s_nop 0
    buffer_load_dwordx4 v96, s[20:23], s35 offen lds
    s_add_u32 s35, s34, 458752
    s_add_u32 m0, s36, 12288
    s_nop 0
    buffer_load_dwordx4 v96, s[20:23], s35 offen lds
    s_add_u32 s35, s34, 487424
    s_add_u32 m0, s36, 13312
    s_nop 0
    buffer_load_dwordx4 v96, s[20:23], s35 offen lds
    s_add_u32 s35, s34, 688128
    s_add_u32 m0, s36, 14336
    s_nop 0
    buffer_load_dwordx4 v96, s[20:23], s35 offen lds
    s_add_u32 s35, s34, 716800
    s_add_u32 m0, s36, 15360
    s_nop 0
    buffer_load_dwordx4 v96, s[20:23], s35 offen lds
    s_add_u32 s35, s34, 917504
    s_add_u32 m0, s36, 16384
    s_nop 0
    buffer_load_dwordx4 v96, s[16:19], s35 offen lds
    s_add_u32 s35, s34, 946176
    s_add_u32 m0, s36, 17408
    s_nop 0
    buffer_load_dwordx4 v96, s[16:19], s35 offen lds
    s_add_u32 s35, s34, 1146880
    s_add_u32 m0, s36, 18432
    s_nop 0
    buffer_load_dwordx4 v96, s[16:19], s35 offen lds
    s_add_u32 s35, s34, 1175552
    s_add_u32 m0, s36, 19456
    s_nop 0
    buffer_load_dwordx4 v96, s[16:19], s35 offen lds
    s_add_u32 s35, s34, 1376256
    s_add_u32 m0, s36, 20480
    s_nop 0
    buffer_load_dwordx4 v96, s[16:19], s35 offen lds
    s_add_u32 s35, s34, 1404928
    s_add_u32 m0, s36, 21504
    s_nop 0
    buffer_load_dwordx4 v96, s[16:19], s35 offen lds
    s_add_u32 s35, s34, 1605632
    s_add_u32 m0, s36, 22528
    s_nop 0
    buffer_load_dwordx4 v96, s[16:19], s35 offen lds
    s_add_u32 s35, s34, 1634304
    s_add_u32 m0, s36, 23552
    s_nop 0
    buffer_load_dwordx4 v96, s[16:19], s35 offen lds
    s_add_u32 s35, s34, 917504
    s_add_u32 m0, s36, 24576
    s_nop 0
    buffer_load_dwordx4 v96, s[20:23], s35 offen lds
    s_add_u32 s35, s34, 946176
    s_add_u32 m0, s36, 25600
    s_nop 0
    buffer_load_dwordx4 v96, s[20:23], s35 offen lds
    s_add_u32 s35, s34, 1146880
    s_add_u32 m0, s36, 26624
    s_nop 0
    buffer_load_dwordx4 v96, s[20:23], s35 offen lds
    s_add_u32 s35, s34, 1175552
    s_add_u32 m0, s36, 27648
    s_nop 0
    buffer_load_dwordx4 v96, s[20:23], s35 offen lds
    s_add_u32 s35, s34, 1376256
    s_add_u32 m0, s36, 28672
    s_nop 0
    buffer_load_dwordx4 v96, s[20:23], s35 offen lds
    s_add_u32 s35, s34, 1404928
    s_add_u32 m0, s36, 29696
    s_nop 0
    buffer_load_dwordx4 v96, s[20:23], s35 offen lds
    s_add_u32 s35, s34, 1605632
    s_add_u32 m0, s36, 30720
    s_nop 0
    buffer_load_dwordx4 v96, s[20:23], s35 offen lds
    s_add_u32 s35, s34, 1634304
    s_add_u32 m0, s36, 31744
    s_nop 0
    buffer_load_dwordx4 v96, s[20:23], s35 offen lds
L_aux_nodma1:
    s_barrier
    s_branch L_aux_b2
L_aux_poller:
    v_lshlrev_b32 v12, 4, v0
    v_add_u32 v12, 4096, v12
    v_lshlrev_b32 v13, 2, v0
    v_sub_u32 v13, 0x7ff, v13
    v_subrev_u32 v88, 0, v13
    v_subrev_u32 v89, 1, v13
    v_subrev_u32 v90, 1024, v13
    v_subrev_u32 v91, 1025, v13
    v_subrev_u32 v92, 2, v13
    v_subrev_u32 v93, 3, v13
    v_subrev_u32 v94, 1026, v13
    v_subrev_u32 v95, 1027, v13
    s_mov_b32 s40, 4096
    s_mov_b32 s41, 8192
    s_mov_b32 s42, 12288
    s_mov_b32 s45, 0xffff0000
    s_sleep 8
    s_mov_b32 s43, 0
L_poll_aux:
    buffer_load_dwordx4 v[64:67], v12, s[12:15], 0 offen sc1
    buffer_load_dwordx4 v[68:71], v12, s[12:15], s40 offen sc1
    buffer_load_dwordx4 v[72:75], v12, s[12:15], s41 offen sc1
    buffer_load_dwordx4 v[76:79], v12, s[12:15], s42 offen sc1
    s_waitcnt vmcnt(0)
    v_xor_b32 v14, s29, v67
    v_bitop3_b32 v14, v14, v71, s29 bitop3:0xf6
    v_bitop3_b32 v14, v14, v75, s29 bitop3:0xf6
    v_bitop3_b32 v14, v14, v79, s29 bitop3:0xf6
    v_cmp_ne_u32 vcc, 0, v14
    s_cbranch_vccz L_polled_aux
    s_add_u32 s43, s43, 1
    s_cmp_ge_u32 s43, 65536
    s_cbranch_scc1 L_polled_aux
    s_sleep 2
    s_branch L_poll_aux
L_polled_aux:
    v_lshl_or_b32 v80, v66, 16, v88
    v_and_or_b32 v81, v66, s45, v89
    v_lshl_or_b32 v82, v70, 16, v90
    v_and_or_b32 v83, v70, s45, v91
    v_lshl_or_b32 v84, v74, 16, v92
    v_and_or_b32 v85, v74, s45, v93
    v_lshl_or_b32 v86, v78, 16, v94
    v_and_or_b32 v87, v78, s45, v95
    v_max3_u32 v17, v80, v81, v82
    v_max3_u32 v18, v83, v84, v85
    v_max3_u32 v17, v17, v86, v87
    v_max_u32 v17, v17, v18
    s_nop 1
    v_max_u32_dpp v17, v17, v17 row_ror:8 row_mask:0xf bank_mask:0xf
    s_nop 1
    v_max_u32_dpp v17, v17, v17 row_ror:4 row_mask:0xf bank_mask:0xf
    s_nop 1
    v_max_u32_dpp v17, v17, v17 row_ror:2 row_mask:0xf bank_mask:0xf
    s_nop 1
    v_max_u32_dpp v17, v17, v17 row_ror:1 row_mask:0xf bank_mask:0xf
    v_lshrrev_b32 v18, 4, v0
    v_lshlrev_b32 v18, 2, v18
    v_add_u32 v18, 140032, v18
    ds_write_b32 v18, v17
    s_waitcnt lgkmcnt(0)
    s_barrier
    v_lshlrev_b32 v18, 2, v2
    v_add_u32 v18, 140032, v18
    ds_read_b32 v17, v18
    v_max_u32 v14, v80, v81
    v_min_u32 v15, v80, v81
    v_mov_b32 v16, 0
    v_med3_u32 v16, v15, v16, v82
    v_med3_u32 v15, v14, v15, v82
    v_max_u32 v14, v14, v82
    v_med3_u32 v16, v15, v16, v83
    v_med3_u32 v15, v14, v15, v83
    v_max_u32 v14, v14, v83
    v_med3_u32 v16, v15, v16, v84
    v_med3_u32 v15, v14, v15, v84
    v_max_u32 v14, v14, v84
    v_med3_u32 v16, v15, v16, v85
    v_med3_u32 v15, v14, v15, v85
    v_max_u32 v14, v14, v85
    v_med3_u32 v16, v15, v16, v86
    v_med3_u32 v15, v14, v15, v86
    v_max_u32 v14, v14, v86
    v_med3_u32 v16, v15, v16, v87
    v_med3_u32 v15, v14, v15, v87
    v_max_u32 v14, v14, v87
    v_mov_b32 v19, 0
    s_waitcnt lgkmcnt(0)
    v_sub_co_u32_dpp v20, vcc, v17, v17 row_ror:1 row_mask:0xf bank_mask:0xf
    v_addc_co_u32 v19, vcc, 0, v19, vcc
    v_sub_co_u32_dpp v20, vcc, v17, v17 row_ror:2 row_mask:0xf bank_mask:0xf
    v_addc_co_u32 v19, vcc, 0, v19, vcc
    v_sub_co_u32_dpp v20, vcc, v17, v17 row_ror:3 row_mask:0xf bank_mask:0xf
    v_addc_co_u32 v19, vcc, 0, v19, vcc
    v_sub_co_u32_dpp v20, vcc, v17, v17 row_ror:4 row_mask:0xf bank_mask:0xf
    v_addc_co_u32 v19, vcc, 0, v19, vcc
    v_sub_co_u32_dpp v20, vcc, v17, v17 row_ror:5 row_mask:0xf bank_mask:0xf
    v_addc_co_u32 v19, vcc, 0, v19, vcc
    v_sub_co_u32_dpp v20, vcc, v17, v17 row_ror:6 row_mask:0xf bank_mask:0xf
    v_addc_co_u32 v19, vcc, 0, v19, vcc
    v_sub_co_u32_dpp v20, vcc, v17, v17 row_ror:7 row_mask:0xf bank_mask:0xf
    v_addc_co_u32 v19, vcc, 0, v19, vcc
    v_sub_co_u32_dpp v20, vcc, v17, v17 row_ror:8 row_mask:0xf bank_mask:0xf
    v_addc_co_u32 v19, vcc, 0, v19, vcc
    v_sub_co_u32_dpp v20, vcc, v17, v17 row_ror:9 row_mask:0xf bank_mask:0xf
    v_addc_co_u32 v19, vcc, 0, v19, vcc
    v_sub_co_u32_dpp v20, vcc, v17, v17 row_ror:10 row_mask:0xf bank_mask:0xf
    v_addc_co_u32 v19, vcc, 0, v19, vcc
    v_sub_co_u32_dpp v20, vcc, v17, v17 row_ror:11 row_mask:0xf bank_mask:0xf
    v_addc_co_u32 v19, vcc, 0, v19, vcc
    v_sub_co_u32_dpp v20, vcc, v17, v17 row_ror:12 row_mask:0xf bank_mask:0xf
    v_addc_co_u32 v19, vcc, 0, v19, vcc
    v_sub_co_u32_dpp v20, vcc, v17, v17 row_ror:13 row_mask:0xf bank_mask:0xf
    v_addc_co_u32 v19, vcc, 0, v19, vcc
    v_sub_co_u32_dpp v20, vcc, v17, v17 row_ror:14 row_mask:0xf bank_mask:0xf
    v_addc_co_u32 v19, vcc, 0, v19, vcc
    v_sub_co_u32_dpp v20, vcc, v17, v17 row_ror:15 row_mask:0xf bank_mask:0xf
    v_addc_co_u32 v19, vcc, 0, v19, vcc
    v_cmp_eq_u32 vcc, 8, v19
    s_ff1_i32_b64 s46, vcc
    v_readlane_b32 s46, v17, s46
    v_mov_b32 v18, 139520
    v_mov_b32 v19, 1
    v_cmp_le_u32 s[48:49], s46, v14
    v_cmp_le_u32 s[50:51], s46, v15
    v_cmp_le_u32 s[52:53], s46, v16
    s_mov_b64 exec, s[48:49]
    ds_add_rtn_u32 v20, v18, v19
    s_mov_b64 exec, s[50:51]
    ds_add_rtn_u32 v21, v18, v19
    s_mov_b64 exec, s[52:53]
    ds_write_b32 v18, v19 offset:4
    s_mov_b64 exec, -1
    s_waitcnt lgkmcnt(0)
    v_min_u32 v20, 32, v20
    v_lshlrev_b32 v20, 2, v20
    v_add_u32 v20, 139328, v20
    v_min_u32 v21, 32, v21
    v_lshlrev_b32 v21, 2, v21
    v_add_u32 v21, 139328, v21
    s_mov_b64 exec, s[48:49]
    ds_write_b32 v20, v14
    s_mov_b64 exec, s[50:51]
    ds_write_b32 v21, v15
    s_mov_b64 exec, -1
    s_waitcnt lgkmcnt(0)
L_aux_b2:
    s_barrier
    v_and_b32 v14, 31, v1
    v_lshlrev_b32 v14, 2, v14
    v_add_u32 v14, 139328, v14
    v_lshrrev_b32 v15, 5, v1
    v_lshlrev_b32 v15, 6, v15
    v_add_u32 v15, 139328, v15
    v_mov_b32 v16, 139520
    ds_read_b64 v[18:19], v16
    ds_read_b32 v17, v14
    ds_read_b128 v[64:67], v15 offset:0
    ds_read_b128 v[68:71], v15 offset:16
    ds_read_b128 v[72:75], v15 offset:32
    ds_read_b128 v[76:79], v15 offset:48
    s_lshl_b32 s47, s31, 5
    s_add_u32 s47, s47, 139776
    v_mov_b32 v20, 0
    s_waitcnt lgkmcnt(5)
    v_readfirstlane_b32 s48, v18
    v_readfirstlane_b32 s49, v19
    s_cmp_gt_u32 s48, 32
    s_cselect_b32 s49, 1, s49
    s_cmp_lg_u32 s49, 0
    s_cbranch_scc1 L_aux_slow
    s_waitcnt lgkmcnt(3)
    v_cmp_gt_u32 vcc, v64, v17
    v_addc_co_u32 v20, vcc, 0, v20, vcc
    v_cmp_gt_u32 vcc, v65, v17
    v_addc_co_u32 v20, vcc, 0, v20, vcc
    v_cmp_gt_u32 vcc, v66, v17
    v_addc_co_u32 v20, vcc, 0, v20, vcc
    v_cmp_gt_u32 vcc, v67, v17
    v_addc_co_u32 v20, vcc, 0, v20, vcc
    s_waitcnt lgkmcnt(2)
    v_cmp_gt_u32 vcc, v68, v17
    v_addc_co_u32 v20, vcc, 0, v20, vcc
    v_cmp_gt_u32 vcc, v69, v17
    v_addc_co_u32 v20, vcc, 0, v20, vcc
    v_cmp_gt_u32 vcc, v70, v17
    v_addc_co_u32 v20, vcc, 0, v20, vcc
    v_cmp_gt_u32 vcc, v71, v17
    v_addc_co_u32 v20, vcc, 0, v20, vcc
    s_waitcnt lgkmcnt(1)
    v_cmp_gt_u32 vcc, v72, v17
    v_addc_co_u32 v20, vcc, 0, v20, vcc
    v_cmp_gt_u32 vcc, v73, v17
    v_addc_co_u32 v20, vcc, 0, v20, vcc
    v_cmp_gt_u32 vcc, v74, v17
    v_addc_co_u32 v20, vcc, 0, v20, vcc
    v_cmp_gt_u32 vcc, v75, v17
    v_addc_co_u32 v20, vcc, 0, v20, vcc
    s_waitcnt lgkmcnt(0)
    v_cmp_gt_u32 vcc, v76, v17
    v_addc_co_u32 v20, vcc, 0, v20, vcc
    v_cmp_gt_u32 vcc, v77, v17
    v_addc_co_u32 v20, vcc, 0, v20, vcc
    v_cmp_gt_u32 vcc, v78, v17
    v_addc_co_u32 v20, vcc, 0, v20, vcc
    v_cmp_gt_u32 vcc, v79, v17
    v_addc_co_u32 v20, vcc, 0, v20, vcc
    v_mov_b32 v21, v20
    s_nop 1
    v_permlane32_swap_b32 v20, v21
    v_add_u32 v20, v20, v21
    v_cmp_gt_u32 vcc, 8, v20
    v_lshl_add_u32 v20, v20, 2, s47
    s_mov_b64 exec, vcc
    ds_write_b32 v20, v17
    s_mov_b64 exec, -1
L_aux_sel:
    v_and_b32 v14, 7, v1
    v_lshl_add_u32 v14, v14, 2, s47
    ds_read_b32 v13, v14
    s_waitcnt lgkmcnt(0)
    v_and_b32 v12, 0x7ff, v13
    v_sub_u32 v12, 0x7ff, v12
    s_cmp_ge_u32 s30, 112
    s_cbranch_scc1 L_aux_noffn
    v_lshlrev_b32 v10, 11, v12
    v_lshl_add_u32 v10, v3, 4, v10
    v_lshl_add_u32 v10, v29, 8, v10
    s_mov_b32 exec_lo, 0x00ff00ff
    s_mov_b32 exec_hi, 0x00ff00ff
    buffer_load_dwordx4 v[32:35], v10, s[4:7], 0 offen offset:0
    buffer_load_dwordx4 v[36:39], v10, s[4:7], 0 offen offset:64
    buffer_load_dwordx4 v[40:43], v10, s[4:7], 0 offen offset:128
    buffer_load_dwordx4 v[44:47], v10, s[4:7], 0 offen offset:192
    s_mov_b64 exec, -1
    v_bfe_u32 v14, v12, 1, 1
    v_lshrrev_b32 v15, 2, v12
    v_lshl_add_u32 v14, v14, 9, v15
    v_lshlrev_b32 v14, 4, v14
    v_add_u32 v14, 4096, v14
    buffer_load_dwordx2 v[24:25], v14, s[12:15], 0 offen sc1
    v_bfe_u32 v14, v1, 2, 4
    v_lshlrev_b32 v14, 6, v14
    v_and_b32 v15, 3, v1
    v_lshl_add_u32 v14, v15, 3, v14
    v_lshl_add_u32 v14, v29, 14, v14
    v_and_b32 v15, 1, v3
    v_lshlrev_b32 v15, 5, v15
    v_add_u32 v16, v14, v15
    v_xor_b32 v15, 32, v15
    v_add_u32 v17, v14, v15
    s_waitcnt vmcnt(5)
    s_barrier
    ds_read_b64_tr_b16 v[64:65], v16 offset:0
    ds_read_b64_tr_b16 v[66:67], v16 offset:1024
    ds_read_b64_tr_b16 v[68:69], v17 offset:0
    ds_read_b64_tr_b16 v[70:71], v17 offset:1024
    ds_read_b64_tr_b16 v[72:73], v16 offset:8192
    ds_read_b64_tr_b16 v[74:75], v16 offset:9216
    ds_read_b64_tr_b16 v[76:77], v17 offset:8192
    ds_read_b64_tr_b16 v[78:79], v17 offset:9216
    ds_read_b64_tr_b16 v[80:81], v16 offset:2048
    ds_read_b64_tr_b16 v[82:83], v16 offset:3072
    ds_read_b64_tr_b16 v[84:85], v17 offset:2048
    ds_read_b64_tr_b16 v[86:87], v17 offset:3072
    ds_read_b64_tr_b16 v[88:89], v16 offset:10240
    ds_read_b64_tr_b16 v[90:91], v16 offset:11264
    ds_read_b64_tr_b16 v[92:93], v17 offset:10240
    ds_read_b64_tr_b16 v[94:95], v17 offset:11264
    ds_read_b64_tr_b16 v[96:97], v16 offset:4096
    ds_read_b64_tr_b16 v[98:99], v16 offset:5120
    ds_read_b64_tr_b16 v[100:101], v17 offset:4096
    ds_read_b64_tr_b16 v[102:103], v17 offset:5120
    ds_read_b64_tr_b16 v[104:105], v16 offset:12288
    ds_read_b64_tr_b16 v[106:107], v16 offset:13312
    ds_read_b64_tr_b16 v[108:109], v17 offset:12288
    ds_read_b64_tr_b16 v[110:111], v17 offset:13312
    ds_read_b64_tr_b16 v[112:113], v16 offset:6144
    ds_read_b64_tr_b16 v[114:115], v16 offset:7168
    ds_read_b64_tr_b16 v[116:117], v17 offset:6144
    ds_read_b64_tr_b16 v[118:119], v17 offset:7168
    ds_read_b64_tr_b16 v[120:121], v16 offset:14336
    ds_read_b64_tr_b16 v[122:123], v16 offset:15360
    ds_read_b64_tr_b16 v[124:125], v17 offset:14336
    ds_read_b64_tr_b16 v[126:127], v17 offset:15360
    v_mul_u32_u24 v18, 16400, v29
    v_lshl_add_u32 v18, v2, 6, v18
    v_lshl_add_u32 v18, v3, 4, v18
    v_lshrrev_b32 v19, 3, v1
    v_mul_u32_u24 v19, 16400, v19
    s_lshr_b32 s48, s31, 2
    s_lshl_b32 s48, s48, 10
    s_and_b32 s49, s31, 3
    s_lshl_b32 s49, s49, 4
    s_add_u32 s48, s48, s49
    v_add_u32 v19, s48, v19
    v_and_b32 v20, 7, v1
    v_lshl_add_u32 v20, v20, 6, v19
    s_waitcnt vmcnt(4)
    s_waitcnt lgkmcnt(15)
    v_mfma_f32_16x16x32_bf16 v[128:131], v[64:67], v[32:35], 0
    v_mfma_f32_16x16x32_bf16 v[132:135], v[68:71], v[32:35], 0
    v_mfma_f32_16x16x32_bf16 v[136:139], v[72:75], v[32:35], 0
    v_mfma_f32_16x16x32_bf16 v[140:143], v[76:79], v[32:35], 0
    s_waitcnt vmcnt(3)
    v_mfma_f32_16x16x32_bf16 v[128:131], v[80:83], v[36:39], v[128:131]
    v_mfma_f32_16x16x32_bf16 v[132:135], v[84:87], v[36:39], v[132:135]
    v_mfma_f32_16x16x32_bf16 v[136:139], v[88:91], v[36:39], v[136:139]
    v_mfma_f32_16x16x32_bf16 v[140:143], v[92:95], v[36:39], v[140:143]
    s_waitcnt vmcnt(2)
    s_waitcnt lgkmcnt(8)
    v_mfma_f32_16x16x32_bf16 v[128:131], v[96:99], v[40:43], v[128:131]
    v_mfma_f32_16x16x32_bf16 v[132:135], v[100:103], v[40:43], v[132:135]
    v_mfma_f32_16x16x32_bf16 v[136:139], v[104:107], v[40:43], v[136:139]
    v_mfma_f32_16x16x32_bf16 v[140:143], v[108:111], v[40:43], v[140:143]
    s_waitcnt vmcnt(1)
    s_waitcnt lgkmcnt(0)
    v_mfma_f32_16x16x32_bf16 v[128:131], v[112:115], v[44:47], v[128:131]
    v_mfma_f32_16x16x32_bf16 v[132:135], v[116:119], v[44:47], v[132:135]
    v_mfma_f32_16x16x32_bf16 v[136:139], v[120:123], v[44:47], v[136:139]
    v_mfma_f32_16x16x32_bf16 v[140:143], v[124:127], v[44:47], v[140:143]
    s_nop 4
    ds_write_b128 v18, v[128:131] offset:0
    ds_write_b128 v18, v[132:135] offset:1024
    ds_write_b128 v18, v[136:139] offset:2048
    ds_write_b128 v18, v[140:143] offset:3072
    s_waitcnt vmcnt(0)
    v_and_b32 v14, 1, v12
    v_cmp_eq_u32 vcc, 1, v14
    s_nop 1
    v_cndmask_b32 v24, v24, v25, vcc
    v_lshlrev_b32 v26, 16, v24
    v_and_b32 v27, 0xffff0000, v24
    v_rcp_f32 v27, v27
    s_waitcnt lgkmcnt(0)
    s_barrier
    ds_read_b128 v[64:67], v20
    ds_read_b128 v[72:75], v19 offset:512
    ds_read_b128 v[68:71], v20 offset:2048
    ds_read_b128 v[76:79], v19 offset:2560
    s_lshl_b32 s48, s30, 3
    s_add_u32 s48, s48, s31
    s_lshl_b32 s48, s48, 7
    s_add_u32 s48, s48, 32768
    v_lshl_add_u32 v21, v1, 4, s48
    s_waitcnt lgkmcnt(0)
    v_pk_fma_f32 v[64:65], v[72:73], v[26:27], v[64:65] op_sel:[0,0,0] op_sel_hi:[1,0,1] neg_lo:[1,0,0] neg_hi:[1,0,0]
    v_pk_fma_f32 v[66:67], v[74:75], v[26:27], v[66:67] op_sel:[0,0,0] op_sel_hi:[1,0,1] neg_lo:[1,0,0] neg_hi:[1,0,0]
    v_pk_fma_f32 v[68:69], v[76:77], v[26:27], v[68:69] op_sel:[0,0,0] op_sel_hi:[1,0,1] neg_lo:[1,0,0] neg_hi:[1,0,0]
    v_pk_fma_f32 v[70:71], v[78:79], v[26:27], v[70:71] op_sel:[0,0,0] op_sel_hi:[1,0,1] neg_lo:[1,0,0] neg_hi:[1,0,0]
    v_add_f32_dpp v64, v64, v64 row_ror:8 row_mask:0xf bank_mask:0xf
    v_add_f32_dpp v65, v65, v65 row_ror:8 row_mask:0xf bank_mask:0xf
    v_add_f32_dpp v66, v66, v66 row_ror:8 row_mask:0xf bank_mask:0xf
    v_add_f32_dpp v67, v67, v67 row_ror:8 row_mask:0xf bank_mask:0xf
    v_add_f32_dpp v68, v68, v68 row_ror:8 row_mask:0xf bank_mask:0xf
    v_add_f32_dpp v69, v69, v69 row_ror:8 row_mask:0xf bank_mask:0xf
    v_add_f32_dpp v70, v70, v70 row_ror:8 row_mask:0xf bank_mask:0xf
    v_add_f32_dpp v71, v71, v71 row_ror:8 row_mask:0xf bank_mask:0xf
    v_mov_b32 v72, v64
    v_mov_b32 v73, v65
    v_mov_b32 v74, v66
    v_mov_b32 v75, v67
    v_mov_b32 v76, v68
    v_mov_b32 v77, v69
    v_mov_b32 v78, v70
    v_mov_b32 v79, v71
    v_permlane16_swap_b32 v64, v72
    v_permlane16_swap_b32 v65, v73
    v_permlane16_swap_b32 v66, v74
    v_permlane16_swap_b32 v67, v75
    v_permlane16_swap_b32 v68, v76
    v_permlane16_swap_b32 v69, v77
    v_permlane16_swap_b32 v70, v78
    v_permlane16_swap_b32 v71, v79
    v_pk_add_f32 v[64:65], v[64:65], v[72:73]
    v_pk_add_f32 v[66:67], v[66:67], v[74:75]
    v_pk_add_f32 v[68:69], v[68:69], v[76:77]
    v_pk_add_f32 v[70:71], v[70:71], v[78:79]
    v_mov_b32 v72, v64
    v_mov_b32 v73, v65
    v_mov_b32 v74, v66
    v_mov_b32 v75, v67
    v_mov_b32 v76, v68
    v_mov_b32 v77, v69
    v_mov_b32 v78, v70
    v_mov_b32 v79, v71
    v_permlane32_swap_b32 v64, v72
    v_permlane32_swap_b32 v65, v73
    v_permlane32_swap_b32 v66, v74
    v_permlane32_swap_b32 v67, v75
    v_permlane32_swap_b32 v68, v76
    v_permlane32_swap_b32 v69, v77
    v_permlane32_swap_b32 v70, v78
    v_permlane32_swap_b32 v71, v79
    v_pk_add_f32 v[64:65], v[64:65], v[72:73]
    v_pk_add_f32 v[66:67], v[66:67], v[74:75]
    v_pk_add_f32 v[68:69], v[68:69], v[76:77]
    v_pk_add_f32 v[70:71], v[70:71], v[78:79]
    v_pk_mul_f32 v[64:65], v[64:65], v[26:27] op_sel:[0,1] op_sel_hi:[1,1]
    v_pk_mul_f32 v[66:67], v[66:67], v[26:27] op_sel:[0,1] op_sel_hi:[1,1]
    v_pk_mul_f32 v[68:69], v[68:69], v[26:27] op_sel:[0,1] op_sel_hi:[1,1]
    v_pk_mul_f32 v[70:71], v[70:71], v[26:27] op_sel:[0,1] op_sel_hi:[1,1]
    v_mul_f32 v72, 0xbfb8aa3b, v64
    v_mul_f32 v73, 0xbfb8aa3b, v65
    v_mul_f32 v74, 0xbfb8aa3b, v66
    v_mul_f32 v75, 0xbfb8aa3b, v67
    v_exp_f32 v72, v72
    v_exp_f32 v73, v73
    v_exp_f32 v74, v74
    v_exp_f32 v75, v75
    v_pk_mul_f32 v[64:65], v[64:65], v[68:69]
    v_pk_mul_f32 v[66:67], v[66:67], v[70:71]
    v_add_f32 v72, 1.0, v72
    v_add_f32 v73, 1.0, v73
    v_add_f32 v74, 1.0, v74
    v_add_f32 v75, 1.0, v75
    v_rcp_f32 v72, v72
    v_rcp_f32 v73, v73
    v_rcp_f32 v74, v74
    v_rcp_f32 v75, v75
    v_mov_b32 v62, s29
    v_mov_b32 v63, s29
    v_pk_mul_f32 v[64:65], v[64:65], v[72:73]
    v_pk_mul_f32 v[66:67], v[66:67], v[74:75]
    v_cvt_pk_bf16_f32 v60, v64, v65
    v_cvt_pk_bf16_f32 v61, v66, v67
    s_mov_b64 exec, 0xff
    buffer_store_dwordx4 v[60:63], v21, s[12:15], 0 offen sc1
    s_mov_b64 exec, -1
    s_branch L_aux_done
L_aux_noffn:
    s_lshl_b32 s48, s30, 3
    s_add_u32 s48, s48, s31
    s_cmp_eq_u32 s48, 1008
    s_cbranch_scc1 L_aux_epoch
    s_cmp_lg_u32 s48, 1016
    s_cbranch_scc1 L_aux_done
    v_and_b32 v14, 0xffff0000, v13
    v_ashrrev_i32 v15, 31, v14
    v_not_b32 v15, v15
    v_or_b32 v15, 0x80000000, v15
    v_xor_b32 v14, v14, v15
    v_and_b32 v14, 0xffff0000, v14
    v_mul_f32 v14, 0xbfb8aa3b, v14
    v_exp_f32 v14, v14
    s_nop 0
    v_add_f32 v14, 1.0, v14
    v_rcp_f32 v14, v14
    s_nop 0
    v_cvt_pk_bf16_f32 v14, v14, v14
    v_and_b32 v61, 0xffff0000, v14
    v_mov_b32 v60, v12
    v_mov_b32 v62, s29
    v_mov_b32 v63, s29
    v_lshlrev_b32 v21, 4, v1
    v_add_u32 v21, 147456, v21
    s_mov_b64 exec, 0xff
    buffer_store_dwordx4 v[60:63], v21, s[12:15], 0 offen sc1
    s_mov_b64 exec, -1
    s_branch L_aux_done
L_aux_epoch:
    v_lshlrev_b32 v21, 3, v1
    v_add_u32 v21, 2048, v21
    s_mov_b32 s43, 0
L_poll_ack:
    buffer_load_dwordx2 v[60:61], v21, s[12:15], 0 offen sc1
    s_waitcnt vmcnt(0)
    v_xor_b32 v14, s29, v60
    v_bitop3_b32 v14, v14, v61, s29 bitop3:0xf6
    v_cmp_ne_u32 vcc, 0, v14
    s_cbranch_vccz L_polled_ack
    s_add_u32 s43, s43, 1
    s_cmp_ge_u32 s43, 65536
    s_cbranch_scc1 L_polled_ack
    s_sleep 4
    s_branch L_poll_ack
L_polled_ack:
    v_mov_b32 v5, s29
    v_mov_b32 v4, 0
    s_mov_b64 exec, 1
    buffer_store_dword v5, v4, s[12:15], 0 offen sc1
L_aux_done:
    s_endpgm
L_aux_slow:
    s_waitcnt lgkmcnt(0)
    s_cmp_ge_u32 s31, 4
    s_cbranch_scc1 L_aux_slow1
    v_lshlrev_b32 v14, 5, v0
    v_add_u32 v14, 131072, v14
    ds_write_b128 v14, v[80:83]
    ds_write_b128 v14, v[84:87] offset:16
    s_waitcnt lgkmcnt(0)
L_aux_slow1:
    s_barrier
    v_lshlrev_b32 v14, 4, v1
    v_add_u32 v14, 131072, v14
    ds_read_b128 v[128:131], v14 offset:0
    ds_read_b128 v[132:135], v14 offset:1024
    ds_read_b128 v[136:139], v14 offset:2048
    ds_read_b128 v[140:143], v14 offset:3072
    ds_read_b128 v[144:147], v14 offset:4096
    ds_read_b128 v[148:151], v14 offset:5120
    ds_read_b128 v[152:155], v14 offset:6144
    ds_read_b128 v[156:159], v14 offset:7168
    s_waitcnt lgkmcnt(0)
    s_mov_b32 s48, 0
    v_mov_b32 v16, s47
L_aux_slow2:
    v_max3_u32 v14, v128, v129, v130
    v_max3_u32 v14, v14, v131, v132
    v_max3_u32 v14, v14, v133, v134
    v_max3_u32 v14, v14, v135, v136
    v_max3_u32 v14, v14, v137, v138
    v_max3_u32 v14, v14, v139, v140
    v_max3_u32 v14, v14, v141, v142
    v_max3_u32 v14, v14, v143, v144
    v_max3_u32 v14, v14, v145, v146
    v_max3_u32 v14, v14, v147, v148
    v_max3_u32 v14, v14, v149, v150
    v_max3_u32 v14, v14, v151, v152
    v_max3_u32 v14, v14, v153, v154
    v_max3_u32 v14, v14, v155, v156
    v_max3_u32 v14, v14, v157, v158
    v_max_u32 v14, v14, v159
    s_nop 1
    v_max_u32_dpp v14, v14, v14 row_ror:8 row_mask:0xf bank_mask:0xf
    s_nop 1
    v_max_u32_dpp v14, v14, v14 row_ror:4 row_mask:0xf bank_mask:0xf
    s_nop 1
    v_max_u32_dpp v14, v14, v14 row_ror:2 row_mask:0xf bank_mask:0xf
    s_nop 1
    v_max_u32_dpp v14, v14, v14 row_ror:1 row_mask:0xf bank_mask:0xf
    v_mov_b32 v15, v14
    s_nop 1
    v_permlane16_swap_b32 v14, v15
    v_max_u32 v14, v14, v15
    v_mov_b32 v15, v14
    s_nop 1
    v_permlane32_swap_b32 v14, v15
    v_max_u32 v14, v14, v15
    ds_write_b32 v16, v14
    v_add_u32 v16, 4, v16
    v_cmp_ne_u32 vcc, v14, v128
    s_nop 1
    v_cndmask_b32 v128, 0, v128, vcc
    v_cmp_ne_u32 vcc, v14, v129
    s_nop 1
    v_cndmask_b32 v129, 0, v129, vcc
    v_cmp_ne_u32 vcc, v14, v130
    s_nop 1
    v_cndmask_b32 v130, 0, v130, vcc
    v_cmp_ne_u32 vcc, v14, v131
    s_nop 1
    v_cndmask_b32 v131, 0, v131, vcc
    v_cmp_ne_u32 vcc, v14, v132
    s_nop 1
    v_cndmask_b32 v132, 0, v132, vcc
    v_cmp_ne_u32 vcc, v14, v133
    s_nop 1
    v_cndmask_b32 v133, 0, v133, vcc
    v_cmp_ne_u32 vcc, v14, v134
    s_nop 1
    v_cndmask_b32 v134, 0, v134, vcc
    v_cmp_ne_u32 vcc, v14, v135
    s_nop 1
    v_cndmask_b32 v135, 0, v135, vcc
    v_cmp_ne_u32 vcc, v14, v136
    s_nop 1
    v_cndmask_b32 v136, 0, v136, vcc
    v_cmp_ne_u32 vcc, v14, v137
    s_nop 1
    v_cndmask_b32 v137, 0, v137, vcc
    v_cmp_ne_u32 vcc, v14, v138
    s_nop 1
    v_cndmask_b32 v138, 0, v138, vcc
    v_cmp_ne_u32 vcc, v14, v139
    s_nop 1
    v_cndmask_b32 v139, 0, v139, vcc
    v_cmp_ne_u32 vcc, v14, v140
    s_nop 1
    v_cndmask_b32 v140, 0, v140, vcc
    v_cmp_ne_u32 vcc, v14, v141
    s_nop 1
    v_cndmask_b32 v141, 0, v141, vcc
    v_cmp_ne_u32 vcc, v14, v142
    s_nop 1
    v_cndmask_b32 v142, 0, v142, vcc
    v_cmp_ne_u32 vcc, v14, v143
    s_nop 1
    v_cndmask_b32 v143, 0, v143, vcc
    v_cmp_ne_u32 vcc, v14, v144
    s_nop 1
    v_cndmask_b32 v144, 0, v144, vcc
    v_cmp_ne_u32 vcc, v14, v145
    s_nop 1
    v_cndmask_b32 v145, 0, v145, vcc
    v_cmp_ne_u32 vcc, v14, v146
    s_nop 1
    v_cndmask_b32 v146, 0, v146, vcc
    v_cmp_ne_u32 vcc, v14, v147
    s_nop 1
    v_cndmask_b32 v147, 0, v147, vcc
    v_cmp_ne_u32 vcc, v14, v148
    s_nop 1
    v_cndmask_b32 v148, 0, v148, vcc
    v_cmp_ne_u32 vcc, v14, v149
    s_nop 1
    v_cndmask_b32 v149, 0, v149, vcc
    v_cmp_ne_u32 vcc, v14, v150
    s_nop 1
    v_cndmask_b32 v150, 0, v150, vcc
    v_cmp_ne_u32 vcc, v14, v151
    s_nop 1
    v_cndmask_b32 v151, 0, v151, vcc
    v_cmp_ne_u32 vcc, v14, v152
    s_nop 1
    v_cndmask_b32 v152, 0, v152, vcc
    v_cmp_ne_u32 vcc, v14, v153
    s_nop 1
    v_cndmask_b32 v153, 0, v153, vcc
    v_cmp_ne_u32 vcc, v14, v154
    s_nop 1
    v_cndmask_b32 v154, 0, v154, vcc
    v_cmp_ne_u32 vcc, v14, v155
    s_nop 1
    v_cndmask_b32 v155, 0, v155, vcc
    v_cmp_ne_u32 vcc, v14, v156
    s_nop 1
    v_cndmask_b32 v156, 0, v156, vcc
    v_cmp_ne_u32 vcc, v14, v157
    s_nop 1
    v_cndmask_b32 v157, 0, v157, vcc
    v_cmp_ne_u32 vcc, v14, v158
    s_nop 1
    v_cndmask_b32 v158, 0, v158, vcc
    v_cmp_ne_u32 vcc, v14, v159
    s_nop 1
    v_cndmask_b32 v159, 0, v159, vcc
    s_add_u32 s48, s48, 1
    s_cmp_lt_u32 s48, 8
    s_cbranch_scc1 L_aux_slow2
    s_branch L_aux_sel
L_exit:
    s_endpgm
.p2align 6
L_conv:
    s_load_dwordx2 s[4:5], s[0:1], 0
    s_load_dwordx2 s[8:9], s[0:1], 8
    s_load_dwordx2 s[12:13], s[0:1], 16
    s_load_dwordx2 s[16:17], s[0:1], 24
    s_load_dwordx2 s[20:21], s[0:1], 32
    s_load_dwordx2 s[24:25], s[0:1], 40
    s_load_dwordx2 s[28:29], s[0:1], 48
    s_load_dwordx2 s[32:33], s[0:1], 96
    s_load_dwordx2 s[36:37], s[0:1], 112
    s_load_dwordx2 s[56:57], s[0:1], 88
    s_and_b32 s44, s2, 7
    s_lshl_b32 s44, s44, 4
    s_add_u32 s44, s44, s3
    s_sub_u32 s44, s44, 16
    v_and_b32 v1, 63, v0
    v_and_b32 v2, 15, v0
    v_bfe_u32 v3, v0, 4, 2
    v_lshrrev_b32 v4, 6, v0
    s_nop 0
    v_readfirstlane_b32 s45, v4
    s_mov_b32 s40, 0x3fb8aa3b
    s_mov_b32 s41, 0x32a57060
    s_lshl_b32 s46, s44, 3
    s_add_u32 s46, s46, s45
    s_lshl_b32 s47, s46, 8
    s_lshl_b32 s48, s46, 1
    s_lshl_b32 s49, s44, 4
    v_lshl_add_u32 v4, v1, 2, s47
    v_mov_b32 v5, s48
    v_mov_b32 v6, s49
    v_lshlrev_b32 v7, 13, v0
    v_add_u32 v7, s49, v7
    s_mov_b32 s53, 4096
    s_waitcnt lgkmcnt(0)
    s_load_dword s50, s[36:37], 0
    s_mov_b32 s26, 2048
    s_mov_b32 s27, 0x00020000
    s_mov_b32 s10, 262144
    s_mov_b32 s11, 0x00020000
    s_mov_b32 s14, 262144
    s_mov_b32 s15, 0x00020000
    s_mov_b32 s18, 262144
    s_mov_b32 s19, 0x00020000
    s_mov_b32 s22, 262144
    s_mov_b32 s23, 0x00020000
    buffer_load_ushort v15, v5, s[24:27], 0 offen
    buffer_load_dword v16, v4, s[8:11], 0 offen
    buffer_load_dword v17, v4, s[12:15], 0 offen
    buffer_load_dword v18, v4, s[16:19], 0 offen
    buffer_load_dword v19, v4, s[20:23], 0 offen
    s_mov_b32 s6, 4194304
    s_mov_b32 s7, 0x00020000
    s_mov_b32 s30, 2048
    s_mov_b32 s31, 0x00020000
    s_mov_b32 s34, 4194304
    s_mov_b32 s35, 0x00020000
    s_mov_b32 s58, 7340032
    s_mov_b32 s59, 0x00020000
    s_mov_b32 s38, 147584
    s_mov_b32 s39, 0x00020000
    buffer_load_dwordx4 v[144:147], v6, s[28:31], 0 offen
    buffer_load_dwordx4 v[240:243], v7, s[4:7], 0 offen offset:0
    buffer_load_dwordx4 v[244:247], v7, s[4:7], 0 offen offset:2048
    buffer_load_dwordx4 v[248:251], v7, s[4:7], s53 offen offset:0
    buffer_load_dwordx4 v[252:255], v7, s[4:7], s53 offen offset:2048
    v_lshlrev_b32 v4, 3, v3
    v_sub_u32 v4, v4, v2
    v_add_u32 v4, 15, v4
    v_min_u32 v4, 31, v4
    s_mov_b32 s43, 0x3e00000
    v_lshrrev_b32 v5, v4, s43
    v_bfe_i32 v6, v5, 0, 1
    v_bfe_i32 v7, v5, 1, 1
    v_and_b32 v6, 0x3f80, v6
    v_and_b32 v7, 0x3f800000, v7
    v_or_b32 v128, v6, v7
    v_bfe_i32 v6, v5, 2, 1
    v_bfe_i32 v7, v5, 3, 1
    v_and_b32 v6, 0x3f80, v6
    v_and_b32 v7, 0x3f800000, v7
    v_or_b32 v129, v6, v7
    v_bfe_i32 v6, v5, 4, 1
    v_bfe_i32 v7, v5, 5, 1
    v_and_b32 v6, 0x3f80, v6
    v_and_b32 v7, 0x3f800000, v7
    v_or_b32 v130, v6, v7
    v_bfe_i32 v6, v5, 6, 1
    v_bfe_i32 v7, v5, 7, 1
    v_and_b32 v6, 0x3f80, v6
    v_and_b32 v7, 0x3f800000, v7
    v_or_b32 v131, v6, v7
    s_mov_b32 s43, 0x1c0000
    v_lshrrev_b32 v5, v4, s43
    v_bfe_i32 v6, v5, 0, 1
    v_bfe_i32 v7, v5, 1, 1
    v_and_b32 v6, 0x3f80, v6
    v_and_b32 v7, 0x3f800000, v7
    v_or_b32 v132, v6, v7
    v_bfe_i32 v6, v5, 2, 1
    v_bfe_i32 v7, v5, 3, 1
    v_and_b32 v6, 0x3f80, v6
    v_and_b32 v7, 0x3f800000, v7
    v_or_b32 v133, v6, v7
    v_bfe_i32 v6, v5, 4, 1
    v_bfe_i32 v7, v5, 5, 1
    v_and_b32 v6, 0x3f80, v6
    v_and_b32 v7, 0x3f800000, v7
    v_or_b32 v134, v6, v7
    v_bfe_i32 v6, v5, 6, 1
    v_bfe_i32 v7, v5, 7, 1
    v_and_b32 v6, 0x3f80, v6
    v_and_b32 v7, 0x3f800000, v7
    v_or_b32 v135, v6, v7
    s_mov_b32 s43, 0xff80000
    v_lshrrev_b32 v5, v4, s43
    v_bfe_i32 v6, v5, 0, 1
    v_bfe_i32 v7, v5, 1, 1
    v_and_b32 v6, 0x3f80, v6
    v_and_b32 v7, 0x3f800000, v7
    v_or_b32 v136, v6, v7
    v_bfe_i32 v6, v5, 2, 1
    v_bfe_i32 v7, v5, 3, 1
    v_and_b32 v6, 0x3f80, v6
    v_and_b32 v7, 0x3f800000, v7
    v_or_b32 v137, v6, v7
    v_bfe_i32 v6, v5, 4, 1
    v_bfe_i32 v7, v5, 5, 1
    v_and_b32 v6, 0x3f80, v6
    v_and_b32 v7, 0x3f800000, v7
    v_or_b32 v138, v6, v7
    v_bfe_i32 v6, v5, 6, 1
    v_bfe_i32 v7, v5, 7, 1
    v_and_b32 v6, 0x3f80, v6
    v_and_b32 v7, 0x3f800000, v7
    v_or_b32 v139, v6, v7
    s_mov_b32 s43, 0x7f00000
    v_lshrrev_b32 v5, v4, s43
    v_bfe_i32 v6, v5, 0, 1
    v_bfe_i32 v7, v5, 1, 1
    v_and_b32 v6, 0x3f80, v6
    v_and_b32 v7, 0x3f800000, v7
    v_or_b32 v140, v6, v7
    v_bfe_i32 v6, v5, 2, 1
    v_bfe_i32 v7, v5, 3, 1
    v_and_b32 v6, 0x3f80, v6
    v_and_b32 v7, 0x3f800000, v7
    v_or_b32 v141, v6, v7
    v_bfe_i32 v6, v5, 4, 1
    v_bfe_i32 v7, v5, 5, 1
    v_and_b32 v6, 0x3f80, v6
    v_and_b32 v7, 0x3f800000, v7
    v_or_b32 v142, v6, v7
    v_bfe_i32 v6, v5, 6, 1
    v_bfe_i32 v7, v5, 7, 1
    v_and_b32 v6, 0x3f80, v6
    v_and_b32 v7, 0x3f800000, v7
    v_or_b32 v143, v6, v7
    s_mov_b32 s43, 0x18000000
    v_lshrrev_b32 v5, v4, s43
    v_bfe_i32 v6, v5, 0, 1
    v_bfe_i32 v7, v5, 1, 1
    v_and_b32 v6, 0xffff, v6
    v_and_b32 v7, 0xffff0000, v7
    v_or_b32 v124, v6, v7
    v_bfe_i32 v6, v5, 2, 1
    v_bfe_i32 v7, v5, 3, 1
    v_and_b32 v6, 0xffff, v6
    v_and_b32 v7, 0xffff0000, v7
    v_or_b32 v125, v6, v7
    v_bfe_i32 v6, v5, 4, 1
    v_bfe_i32 v7, v5, 5, 1
    v_and_b32 v6, 0xffff, v6
    v_and_b32 v7, 0xffff0000, v7
    v_or_b32 v126, v6, v7
    v_bfe_i32 v6, v5, 6, 1
    v_bfe_i32 v7, v5, 7, 1
    v_and_b32 v6, 0xffff, v6
    v_and_b32 v7, 0xffff0000, v7
    v_or_b32 v127, v6, v7
    s_waitcnt lgkmcnt(0)
    s_mul_i32 s52, s50, 0x9e3779b1
    s_add_u32 s52, s52, 0x7f4a7c15
    s_cmp_lg_u32 s45, 0
    s_cbranch_scc1 L_conv_noack
    s_lshl_b32 s50, s44, 2
    s_add_u32 s50, s50, 2048
    v_mov_b32 v10, s50
    v_mov_b32 v11, s52
    s_mov_b64 exec, 1
    buffer_store_dword v11, v10, s[36:39], 0 offen sc1
    s_mov_b64 exec, -1
L_conv_noack:
    s_mul_i32 s50, s45, 8448
    v_mov_b32 v4, s50
    v_lshl_add_u32 v5, v1, 3, s50
    v_mul_u32_u24 v6, 528, v2
    v_and_b32 v10, 1, v3
    v_lshl_add_u32 v6, v10, 8, v6
    v_lshrrev_b32 v10, 1, v3
    v_lshl_add_u32 v6, v10, 4, v6
    v_add_u32 v6, s50, v6
    s_mul_i32 s51, s45, 4608
    v_lshlrev_b32 v10, 5, v2
    v_lshl_add_u32 v7, v3, 4, v10
    v_add3_u32 v7, v7, s51, 32
    s_mul_i32 s54, s45, 4160
    s_add_u32 s54, s54, 36864
    v_lshl_add_u32 v8, v3, 3, v10
    v_add_u32 v8, s54, v8
    s_mul_i32 s54, s45, 917504
    s_add_u32 s54, s54, s49
    v_lshlrev_b32 v9, 11, v1
    v_add_u32 v9, s54, v9
    s_mul_i32 s55, s45, 7168
    s_add_u32 s55, s55, 70144
    s_waitcnt vmcnt(5)
    v_lshlrev_b32 v15, 16, v15
    v_mul_f32 v64, s40, v15
    v_fma_f32 v65, v15, s40, -v64
    v_fma_f32 v65, v15, s41, v65
    v_exp_f32 v76, v64
    v_mul_f32 v65, 0x3f317218, v65
    v_fma_f32 v76, v76, v65, v76
    v_cvt_pk_bf16_f32 v76, v76, v76
    v_and_b32 v76, 0xffff0000, v76
    v_lshlrev_b32 v66, 16, v16
    v_mul_f32 v64, s40, v66
    v_fma_f32 v65, v66, s40, -v64
    v_fma_f32 v65, v66, s41, v65
    v_exp_f32 v72, v64
    v_mul_f32 v65, 0x3f317218, v65
    v_fma_f32 v72, v72, v65, v72
    v_lshlrev_b32 v74, 16, v17
    v_lshlrev_b32 v32, 16, v18
    v_lshlrev_b32 v33, 16, v19
    v_and_b32 v66, 0xffff0000, v16
    v_mul_f32 v64, s40, v66
    v_fma_f32 v65, v66, s40, -v64
    v_fma_f32 v65, v66, s41, v65
    v_exp_f32 v73, v64
    v_mul_f32 v65, 0x3f317218, v65
    v_fma_f32 v73, v73, v65, v73
    v_and_b32 v75, 0xffff0000, v17
    v_and_b32 v34, 0xffff0000, v18
    v_and_b32 v35, 0xffff0000, v19
    v_cvt_pk_bf16_f32 v64, v72, v73
    v_lshlrev_b32 v72, 16, v64
    v_and_b32 v73, 0xffff0000, v64
    v_add_f32 v77, v76, v76
    v_mul_f32 v72, v72, v76
    v_mul_f32 v74, v74, v76
    v_pk_mul_f32 v[32:33], v[32:33], v[76:77] op_sel:[0,1] op_sel_hi:[1,1]
    v_mul_f32 v72, 0xbfb8aa3b, v72
    v_mul_f32 v74, 0.15915494, v74
    v_mul_f32 v73, v73, v76
    v_mul_f32 v75, v75, v76
    v_pk_mul_f32 v[34:35], v[34:35], v[76:77] op_sel:[0,1] op_sel_hi:[1,1]
    v_mul_f32 v73, 0xbfb8aa3b, v73
    v_mul_f32 v75, 0.15915494, v75
    v_mul_f32 v64, 0x3f800000, v72
    v_mul_f32 v65, 0x3f800000, v74
    v_exp_f32 v64, v64
    v_fract_f32 v65, v65
    v_cos_f32 v20, v65
    v_sin_f32 v21, v65
    s_nop 0
    v_pk_mul_f32 v[20:21], v[20:21], v[64:65] op_sel:[0,0] op_sel_hi:[1,0]
    v_mul_f32 v68, 0x3f800000, v73
    v_mul_f32 v69, 0x3f800000, v75
    v_exp_f32 v68, v68
    v_fract_f32 v69, v69
    v_cos_f32 v22, v69
    v_sin_f32 v23, v69
    s_nop 0
    v_pk_mul_f32 v[22:23], v[22:23], v[68:69] op_sel:[0,0] op_sel_hi:[1,0]
    v_mul_f32 v64, 0x41000000, v72
    v_mul_f32 v65, 0x41000000, v74
    v_exp_f32 v64, v64
    v_fract_f32 v65, v65
    v_cos_f32 v24, v65
    v_sin_f32 v25, v65
    s_nop 0
    v_pk_mul_f32 v[24:25], v[24:25], v[64:65] op_sel:[0,0] op_sel_hi:[1,0] neg_hi:[1,0]
    v_mul_f32 v68, 0x41000000, v73
    v_mul_f32 v69, 0x41000000, v75
    v_exp_f32 v68, v68
    v_fract_f32 v69, v69
    v_cos_f32 v26, v69
    v_sin_f32 v27, v69
    s_nop 0
    v_pk_mul_f32 v[26:27], v[26:27], v[68:69] op_sel:[0,0] op_sel_hi:[1,0] neg_hi:[1,0]
    v_mul_f32 v64, 0x43000000, v72
    v_mul_f32 v65, 0x43000000, v74
    v_exp_f32 v64, v64
    v_fract_f32 v65, v65
    v_cos_f32 v28, v65
    v_sin_f32 v29, v65
    s_nop 0
    v_pk_mul_f32 v[28:29], v[28:29], v[64:65] op_sel:[0,0] op_sel_hi:[1,0]
    v_mul_f32 v68, 0x43000000, v73
    v_mul_f32 v69, 0x43000000, v75
    v_exp_f32 v68, v68
    v_fract_f32 v69, v69
    v_cos_f32 v30, v69
    v_sin_f32 v31, v69
    s_nop 0
    v_pk_mul_f32 v[30:31], v[30:31], v[68:69] op_sel:[0,0] op_sel_hi:[1,0]
    v_mov_b32 v68, 0x3f80
    s_mov_b32 s54, 0
    s_add_u32 m0, s55, 0
    s_nop 0
    buffer_load_dwordx4 v9, s[56:59], s54 offen lds
    v_mov_b32 v69, 0x3f80
    ds_write_b64 v5, v[68:69] offset:0
    v_cvt_pk_bf16_f32 v70, v24, v25
    v_cvt_pk_bf16_f32 v71, v26, v27
    ds_write_b64 v5, v[70:71] offset:528
    v_pk_mul_f32 v[64:65], v[24:25], v[24:25] op_sel:[1,1] op_sel_hi:[1,0] neg_lo:[1,0]
    v_pk_mul_f32 v[66:67], v[26:27], v[26:27] op_sel:[1,1] op_sel_hi:[1,0] neg_lo:[1,0]
    v_pk_fma_f32 v[12:13], v[24:25], v[24:25], v[64:65] op_sel:[0,0,0] op_sel_hi:[0,1,1]
    v_pk_fma_f32 v[14:15], v[26:27], v[26:27], v[66:67] op_sel:[0,0,0] op_sel_hi:[0,1,1]
    v_cvt_pk_bf16_f32 v68, v12, v13
    v_cvt_pk_bf16_f32 v69, v14, v15
    ds_write_b64 v5, v[68:69] offset:1056
    v_pk_mul_f32 v[64:65], v[12:13], v[24:25] op_sel:[1,1] op_sel_hi:[1,0] neg_lo:[1,0]
    v_pk_mul_f32 v[66:67], v[14:15], v[26:27] op_sel:[1,1] op_sel_hi:[1,0] neg_lo:[1,0]
    v_pk_fma_f32 v[12:13], v[12:13], v[24:25], v[64:65] op_sel:[0,0,0] op_sel_hi:[0,1,1]
    v_pk_fma_f32 v[14:15], v[14:15], v[26:27], v[66:67] op_sel:[0,0,0] op_sel_hi:[0,1,1]
    v_cvt_pk_bf16_f32 v70, v12, v13
    v_cvt_pk_bf16_f32 v71, v14, v15
    ds_write_b64 v5, v[70:71] offset:1584
    v_pk_mul_f32 v[64:65], v[12:13], v[24:25] op_sel:[1,1] op_sel_hi:[1,0] neg_lo:[1,0]
    v_pk_mul_f32 v[66:67], v[14:15], v[26:27] op_sel:[1,1] op_sel_hi:[1,0] neg_lo:[1,0]
    v_pk_fma_f32 v[12:13], v[12:13], v[24:25], v[64:65] op_sel:[0,0,0] op_sel_hi:[0,1,1]
    v_pk_fma_f32 v[14:15], v[14:15], v[26:27], v[66:67] op_sel:[0,0,0] op_sel_hi:[0,1,1]
    v_cvt_pk_bf16_f32 v68, v12, v13
    v_cvt_pk_bf16_f32 v69, v14, v15
    ds_write_b64 v5, v[68:69] offset:2112
    v_pk_mul_f32 v[64:65], v[12:13], v[24:25] op_sel:[1,1] op_sel_hi:[1,0] neg_lo:[1,0]
    v_pk_mul_f32 v[66:67], v[14:15], v[26:27] op_sel:[1,1] op_sel_hi:[1,0] neg_lo:[1,0]
    v_pk_fma_f32 v[12:13], v[12:13], v[24:25], v[64:65] op_sel:[0,0,0] op_sel_hi:[0,1,1]
    v_pk_fma_f32 v[14:15], v[14:15], v[26:27], v[66:67] op_sel:[0,0,0] op_sel_hi:[0,1,1]
    v_cvt_pk_bf16_f32 v70, v12, v13
    v_cvt_pk_bf16_f32 v71, v14, v15
    ds_write_b64 v5, v[70:71] offset:2640
    v_pk_mul_f32 v[64:65], v[12:13], v[24:25] op_sel:[1,1] op_sel_hi:[1,0] neg_lo:[1,0]
    v_pk_mul_f32 v[66:67], v[14:15], v[26:27] op_sel:[1,1] op_sel_hi:[1,0] neg_lo:[1,0]
    v_pk_fma_f32 v[12:13], v[12:13], v[24:25], v[64:65] op_sel:[0,0,0] op_sel_hi:[0,1,1]
    v_pk_fma_f32 v[14:15], v[14:15], v[26:27], v[66:67] op_sel:[0,0,0] op_sel_hi:[0,1,1]
    v_cvt_pk_bf16_f32 v68, v12, v13
    v_cvt_pk_bf16_f32 v69, v14, v15
    ds_write_b64 v5, v[68:69] offset:3168
    v_pk_mul_f32 v[64:65], v[12:13], v[24:25] op_sel:[1,1] op_sel_hi:[1,0] neg_lo:[1,0]
    v_pk_mul_f32 v[66:67], v[14:15], v[26:27] op_sel:[1,1] op_sel_hi:[1,0] neg_lo:[1,0]
    v_pk_fma_f32 v[12:13], v[12:13], v[24:25], v[64:65] op_sel:[0,0,0] op_sel_hi:[0,1,1]
    v_pk_fma_f32 v[14:15], v[14:15], v[26:27], v[66:67] op_sel:[0,0,0] op_sel_hi:[0,1,1]
    v_cvt_pk_bf16_f32 v70, v12, v13
    v_cvt_pk_bf16_f32 v71, v14, v15
    ds_write_b64 v5, v[70:71] offset:3696
    v_pk_mul_f32 v[64:65], v[12:13], v[24:25] op_sel:[1,1] op_sel_hi:[1,0] neg_lo:[1,0]
    v_pk_mul_f32 v[66:67], v[14:15], v[26:27] op_sel:[1,1] op_sel_hi:[1,0] neg_lo:[1,0]
    v_pk_fma_f32 v[12:13], v[12:13], v[24:25], v[64:65] op_sel:[0,0,0] op_sel_hi:[0,1,1]
    v_pk_fma_f32 v[14:15], v[14:15], v[26:27], v[66:67] op_sel:[0,0,0] op_sel_hi:[0,1,1]
    v_cvt_pk_bf16_f32 v68, v12, v13
    v_cvt_pk_bf16_f32 v69, v14, v15
    ds_write_b64 v5, v[68:69] offset:4224
    v_pk_mul_f32 v[64:65], v[12:13], v[24:25] op_sel:[1,1] op_sel_hi:[1,0] neg_lo:[1,0]
    v_pk_mul_f32 v[66:67], v[14:15], v[26:27] op_sel:[1,1] op_sel_hi:[1,0] neg_lo:[1,0]
    v_pk_fma_f32 v[12:13], v[12:13], v[24:25], v[64:65] op_sel:[0,0,0] op_sel_hi:[0,1,1]
    v_pk_fma_f32 v[14:15], v[14:15], v[26:27], v[66:67] op_sel:[0,0,0] op_sel_hi:[0,1,1]
    v_cvt_pk_bf16_f32 v70, v12, v13
    v_cvt_pk_bf16_f32 v71, v14, v15
    ds_write_b64 v5, v[70:71] offset:4752
    v_pk_mul_f32 v[64:65], v[12:13], v[24:25] op_sel:[1,1] op_sel_hi:[1,0] neg_lo:[1,0]
    v_pk_mul_f32 v[66:67], v[14:15], v[26:27] op_sel:[1,1] op_sel_hi:[1,0] neg_lo:[1,0]
    v_pk_fma_f32 v[12:13], v[12:13], v[24:25], v[64:65] op_sel:[0,0,0] op_sel_hi:[0,1,1]
    v_pk_fma_f32 v[14:15], v[14:15], v[26:27], v[66:67] op_sel:[0,0,0] op_sel_hi:[0,1,1]
    v_cvt_pk_bf16_f32 v68, v12, v13
    v_cvt_pk_bf16_f32 v69, v14, v15
    ds_write_b64 v5, v[68:69] offset:5280
    v_pk_mul_f32 v[64:65], v[12:13], v[24:25] op_sel:[1,1] op_sel_hi:[1,0] neg_lo:[1,0]
    v_pk_mul_f32 v[66:67], v[14:15], v[26:27] op_sel:[1,1] op_sel_hi:[1,0] neg_lo:[1,0]
    v_pk_fma_f32 v[12:13], v[12:13], v[24:25], v[64:65] op_sel:[0,0,0] op_sel_hi:[0,1,1]
    v_pk_fma_f32 v[14:15], v[14:15], v[26:27], v[66:67] op_sel:[0,0,0] op_sel_hi:[0,1,1]
    v_cvt_pk_bf16_f32 v70, v12, v13
    v_cvt_pk_bf16_f32 v71, v14, v15
    ds_write_b64 v5, v[70:71] offset:5808
    v_pk_mul_f32 v[64:65], v[12:13], v[24:25] op_sel:[1,1] op_sel_hi:[1,0] neg_lo:[1,0]
    v_pk_mul_f32 v[66:67], v[14:15], v[26:27] op_sel:[1,1] op_sel_hi:[1,0] neg_lo:[1,0]
    v_pk_fma_f32 v[12:13], v[12:13], v[24:25], v[64:65] op_sel:[0,0,0] op_sel_hi:[0,1,1]
    v_pk_fma_f32 v[14:15], v[14:15], v[26:27], v[66:67] op_sel:[0,0,0] op_sel_hi:[0,1,1]
    v_cvt_pk_bf16_f32 v68, v12, v13
    v_cvt_pk_bf16_f32 v69, v14, v15
    ds_write_b64 v5, v[68:69] offset:6336
    v_pk_mul_f32 v[64:65], v[12:13], v[24:25] op_sel:[1,1] op_sel_hi:[1,0] neg_lo:[1,0]
    v_pk_mul_f32 v[66:67], v[14:15], v[26:27] op_sel:[1,1] op_sel_hi:[1,0] neg_lo:[1,0]
    v_pk_fma_f32 v[12:13], v[12:13], v[24:25], v[64:65] op_sel:[0,0,0] op_sel_hi:[0,1,1]
    v_pk_fma_f32 v[14:15], v[14:15], v[26:27], v[66:67] op_sel:[0,0,0] op_sel_hi:[0,1,1]
    s_mov_b32 s54, 131072
    s_add_u32 m0, s55, 1024
    s_nop 0
    buffer_load_dwordx4 v9, s[56:59], s54 offen lds
    v_cvt_pk_bf16_f32 v70, v12, v13
    v_cvt_pk_bf16_f32 v71, v14, v15
    ds_write_b64 v5, v[70:71] offset:6864
    v_pk_mul_f32 v[64:65], v[12:13], v[24:25] op_sel:[1,1] op_sel_hi:[1,0] neg_lo:[1,0]
    v_pk_mul_f32 v[66:67], v[14:15], v[26:27] op_sel:[1,1] op_sel_hi:[1,0] neg_lo:[1,0]
    v_pk_fma_f32 v[12:13], v[12:13], v[24:25], v[64:65] op_sel:[0,0,0] op_sel_hi:[0,1,1]
    v_pk_fma_f32 v[14:15], v[14:15], v[26:27], v[66:67] op_sel:[0,0,0] op_sel_hi:[0,1,1]
    v_cvt_pk_bf16_f32 v68, v12, v13
    v_cvt_pk_bf16_f32 v69, v14, v15
    ds_write_b64 v5, v[68:69] offset:7392
    v_pk_mul_f32 v[64:65], v[12:13], v[24:25] op_sel:[1,1] op_sel_hi:[1,0] neg_lo:[1,0]
    v_pk_mul_f32 v[66:67], v[14:15], v[26:27] op_sel:[1,1] op_sel_hi:[1,0] neg_lo:[1,0]
    v_pk_fma_f32 v[12:13], v[12:13], v[24:25], v[64:65] op_sel:[0,0,0] op_sel_hi:[0,1,1]
    v_pk_fma_f32 v[14:15], v[14:15], v[26:27], v[66:67] op_sel:[0,0,0] op_sel_hi:[0,1,1]
    v_cvt_pk_bf16_f32 v70, v12, v13
    v_cvt_pk_bf16_f32 v71, v14, v15
    ds_write_b64 v5, v[70:71] offset:7920
    ds_read_b128 v[80:83], v6 offset:0
    ds_read_b128 v[84:87], v6 offset:32
    ds_read_b128 v[88:91], v6 offset:64
    ds_read_b128 v[92:95], v6 offset:96
    ds_read_b128 v[96:99], v6 offset:128
    ds_read_b128 v[100:103], v6 offset:160
    ds_read_b128 v[104:107], v6 offset:192
    ds_read_b128 v[108:111], v6 offset:224
    v_cvt_pk_bf16_f32 v68, v32, v33
    v_cvt_pk_bf16_f32 v69, v34, v35
    ds_write_b64 v5, v[68:69] offset:0
    v_pk_mul_f32 v[64:65], v[32:33], v[20:21] op_sel:[1,1] op_sel_hi:[1,0] neg_lo:[1,0]
    v_pk_mul_f32 v[66:67], v[34:35], v[22:23] op_sel:[1,1] op_sel_hi:[1,0] neg_lo:[1,0]
    v_pk_fma_f32 v[36:37], v[32:33], v[20:21], v[64:65] op_sel:[0,0,0] op_sel_hi:[0,1,1]
    v_pk_fma_f32 v[38:39], v[34:35], v[22:23], v[66:67] op_sel:[0,0,0] op_sel_hi:[0,1,1]
    v_cvt_pk_bf16_f32 v70, v36, v37
    v_cvt_pk_bf16_f32 v71, v38, v39
    ds_write_b64 v5, v[70:71] offset:528
    v_pk_mul_f32 v[64:65], v[36:37], v[20:21] op_sel:[1,1] op_sel_hi:[1,0] neg_lo:[1,0]
    v_pk_mul_f32 v[66:67], v[38:39], v[22:23] op_sel:[1,1] op_sel_hi:[1,0] neg_lo:[1,0]
    v_pk_fma_f32 v[40:41], v[36:37], v[20:21], v[64:65] op_sel:[0,0,0] op_sel_hi:[0,1,1]
    v_pk_fma_f32 v[42:43], v[38:39], v[22:23], v[66:67] op_sel:[0,0,0] op_sel_hi:[0,1,1]
    v_cvt_pk_bf16_f32 v68, v40, v41
    v_cvt_pk_bf16_f32 v69, v42, v43
    ds_write_b64 v5, v[68:69] offset:1056
    v_pk_mul_f32 v[64:65], v[40:41], v[20:21] op_sel:[1,1] op_sel_hi:[1,0] neg_lo:[1,0]
    v_pk_mul_f32 v[66:67], v[42:43], v[22:23] op_sel:[1,1] op_sel_hi:[1,0] neg_lo:[1,0]
    v_pk_fma_f32 v[44:45], v[40:41], v[20:21], v[64:65] op_sel:[0,0,0] op_sel_hi:[0,1,1]
    v_pk_fma_f32 v[46:47], v[42:43], v[22:23], v[66:67] op_sel:[0,0,0] op_sel_hi:[0,1,1]
    v_cvt_pk_bf16_f32 v70, v44, v45
    v_cvt_pk_bf16_f32 v71, v46, v47
    ds_write_b64 v5, v[70:71] offset:1584
    v_pk_mul_f32 v[64:65], v[44:45], v[20:21] op_sel:[1,1] op_sel_hi:[1,0] neg_lo:[1,0]
    v_pk_mul_f32 v[66:67], v[46:47], v[22:23] op_sel:[1,1] op_sel_hi:[1,0] neg_lo:[1,0]
    v_pk_fma_f32 v[48:49], v[44:45], v[20:21], v[64:65] op_sel:[0,0,0] op_sel_hi:[0,1,1]
    v_pk_fma_f32 v[50:51], v[46:47], v[22:23], v[66:67] op_sel:[0,0,0] op_sel_hi:[0,1,1]
    v_cvt_pk_bf16_f32 v68, v48, v49
    v_cvt_pk_bf16_f32 v69, v50, v51
    ds_write_b64 v5, v[68:69] offset:2112
    v_pk_mul_f32 v[64:65], v[48:49], v[20:21] op_sel:[1,1] op_sel_hi:[1,0] neg_lo:[1,0]
    v_pk_mul_f32 v[66:67], v[50:51], v[22:23] op_sel:[1,1] op_sel_hi:[1,0] neg_lo:[1,0]
    v_pk_fma_f32 v[52:53], v[48:49], v[20:21], v[64:65] op_sel:[0,0,0] op_sel_hi:[0,1,1]
    v_pk_fma_f32 v[54:55], v[50:51], v[22:23], v[66:67] op_sel:[0,0,0] op_sel_hi:[0,1,1]
    v_cvt_pk_bf16_f32 v70, v52, v53
    v_cvt_pk_bf16_f32 v71, v54, v55
    ds_write_b64 v5, v[70:71] offset:2640
    v_pk_mul_f32 v[64:65], v[52:53], v[20:21] op_sel:[1,1] op_sel_hi:[1,0] neg_lo:[1,0]
    v_pk_mul_f32 v[66:67], v[54:55], v[22:23] op_sel:[1,1] op_sel_hi:[1,0] neg_lo:[1,0]
    v_pk_fma_f32 v[56:57], v[52:53], v[20:21], v[64:65] op_sel:[0,0,0] op_sel_hi:[0,1,1]
    v_pk_fma_f32 v[58:59], v[54:55], v[22:23], v[66:67] op_sel:[0,0,0] op_sel_hi:[0,1,1]
    v_cvt_pk_bf16_f32 v68, v56, v57
    v_cvt_pk_bf16_f32 v69, v58, v59
    ds_write_b64 v5, v[68:69] offset:3168
    v_pk_mul_f32 v[64:65], v[56:57], v[20:21] op_sel:[1,1] op_sel_hi:[1,0] neg_lo:[1,0]
    v_pk_mul_f32 v[66:67], v[58:59], v[22:23] op_sel:[1,1] op_sel_hi:[1,0] neg_lo:[1,0]
    v_pk_fma_f32 v[60:61], v[56:57], v[20:21], v[64:65] op_sel:[0,0,0] op_sel_hi:[0,1,1]
    v_pk_fma_f32 v[62:63], v[58:59], v[22:23], v[66:67] op_sel:[0,0,0] op_sel_hi:[0,1,1]
    v_cvt_pk_bf16_f32 v70, v60, v61
    v_cvt_pk_bf16_f32 v71, v62, v63
    ds_write_b64 v5, v[70:71] offset:3696
    v_pk_mul_f32 v[64:65], v[32:33], v[28:29] op_sel:[1,1] op_sel_hi:[1,0] neg_lo:[1,0]
    v_pk_mul_f32 v[66:67], v[34:35], v[30:31] op_sel:[1,1] op_sel_hi:[1,0] neg_lo:[1,0]
    v_pk_fma_f32 v[32:33], v[32:33], v[28:29], v[64:65] op_sel:[0,0,0] op_sel_hi:[0,1,1]
    v_pk_fma_f32 v[34:35], v[34:35], v[30:31], v[66:67] op_sel:[0,0,0] op_sel_hi:[0,1,1]
    v_cvt_pk_bf16_f32 v68, v32, v33
    v_cvt_pk_bf16_f32 v69, v34, v35
    ds_write_b64 v5, v[68:69] offset:4224
    v_pk_mul_f32 v[64:65], v[36:37], v[28:29] op_sel:[1,1] op_sel_hi:[1,0] neg_lo:[1,0]
    v_pk_mul_f32 v[66:67], v[38:39], v[30:31] op_sel:[1,1] op_sel_hi:[1,0] neg_lo:[1,0]
    s_mov_b32 s54, 262144
    s_add_u32 m0, s55, 2048
    s_nop 0
    buffer_load_dwordx4 v9, s[56:59], s54 offen lds
    v_pk_fma_f32 v[36:37], v[36:37], v[28:29], v[64:65] op_sel:[0,0,0] op_sel_hi:[0,1,1]
    v_pk_fma_f32 v[38:39], v[38:39], v[30:31], v[66:67] op_sel:[0,0,0] op_sel_hi:[0,1,1]
    v_cvt_pk_bf16_f32 v70, v36, v37
    v_cvt_pk_bf16_f32 v71, v38, v39
    ds_write_b64 v5, v[70:71] offset:4752
    v_pk_mul_f32 v[64:65], v[40:41], v[28:29] op_sel:[1,1] op_sel_hi:[1,0] neg_lo:[1,0]
    v_pk_mul_f32 v[66:67], v[42:43], v[30:31] op_sel:[1,1] op_sel_hi:[1,0] neg_lo:[1,0]
    v_pk_fma_f32 v[40:41], v[40:41], v[28:29], v[64:65] op_sel:[0,0,0] op_sel_hi:[0,1,1]
    v_pk_fma_f32 v[42:43], v[42:43], v[30:31], v[66:67] op_sel:[0,0,0] op_sel_hi:[0,1,1]
    v_cvt_pk_bf16_f32 v68, v40, v41
    v_cvt_pk_bf16_f32 v69, v42, v43
    ds_write_b64 v5, v[68:69] offset:5280
    v_pk_mul_f32 v[64:65], v[44:45], v[28:29] op_sel:[1,1] op_sel_hi:[1,0] neg_lo:[1,0]
    v_pk_mul_f32 v[66:67], v[46:47], v[30:31] op_sel:[1,1] op_sel_hi:[1,0] neg_lo:[1,0]
    v_pk_fma_f32 v[44:45], v[44:45], v[28:29], v[64:65] op_sel:[0,0,0] op_sel_hi:[0,1,1]
    v_pk_fma_f32 v[46:47], v[46:47], v[30:31], v[66:67] op_sel:[0,0,0] op_sel_hi:[0,1,1]
    v_cvt_pk_bf16_f32 v70, v44, v45
    v_cvt_pk_bf16_f32 v71, v46, v47
    ds_write_b64 v5, v[70:71] offset:5808
    v_pk_mul_f32 v[64:65], v[48:49], v[28:29] op_sel:[1,1] op_sel_hi:[1,0] neg_lo:[1,0]
    v_pk_mul_f32 v[66:67], v[50:51], v[30:31] op_sel:[1,1] op_sel_hi:[1,0] neg_lo:[1,0]
    v_pk_fma_f32 v[48:49], v[48:49], v[28:29], v[64:65] op_sel:[0,0,0] op_sel_hi:[0,1,1]
    v_pk_fma_f32 v[50:51], v[50:51], v[30:31], v[66:67] op_sel:[0,0,0] op_sel_hi:[0,1,1]
    v_cvt_pk_bf16_f32 v68, v48, v49
    v_cvt_pk_bf16_f32 v69, v50, v51
    ds_write_b64 v5, v[68:69] offset:6336
    v_pk_mul_f32 v[64:65], v[52:53], v[28:29] op_sel:[1,1] op_sel_hi:[1,0] neg_lo:[1,0]
    v_pk_mul_f32 v[66:67], v[54:55], v[30:31] op_sel:[1,1] op_sel_hi:[1,0] neg_lo:[1,0]
    v_pk_fma_f32 v[52:53], v[52:53], v[28:29], v[64:65] op_sel:[0,0,0] op_sel_hi:[0,1,1]
    v_pk_fma_f32 v[54:55], v[54:55], v[30:31], v[66:67] op_sel:[0,0,0] op_sel_hi:[0,1,1]
    v_cvt_pk_bf16_f32 v70, v52, v53
    v_cvt_pk_bf16_f32 v71, v54, v55
    ds_write_b64 v5, v[70:71] offset:6864
    v_pk_mul_f32 v[64:65], v[56:57], v[28:29] op_sel:[1,1] op_sel_hi:[1,0] neg_lo:[1,0]
    v_pk_mul_f32 v[66:67], v[58:59], v[30:31] op_sel:[1,1] op_sel_hi:[1,0] neg_lo:[1,0]
    v_pk_fma_f32 v[56:57], v[56:57], v[28:29], v[64:65] op_sel:[0,0,0] op_sel_hi:[0,1,1]
    v_pk_fma_f32 v[58:59], v[58:59], v[30:31], v[66:67] op_sel:[0,0,0] op_sel_hi:[0,1,1]
    v_cvt_pk_bf16_f32 v68, v56, v57
    v_cvt_pk_bf16_f32 v69, v58, v59
    ds_write_b64 v5, v[68:69] offset:7392
    v_pk_mul_f32 v[64:65], v[60:61], v[28:29] op_sel:[1,1] op_sel_hi:[1,0] neg_lo:[1,0]
    v_pk_mul_f32 v[66:67], v[62:63], v[30:31] op_sel:[1,1] op_sel_hi:[1,0] neg_lo:[1,0]
    v_pk_fma_f32 v[60:61], v[60:61], v[28:29], v[64:65] op_sel:[0,0,0] op_sel_hi:[0,1,1]
    v_pk_fma_f32 v[62:63], v[62:63], v[30:31], v[66:67] op_sel:[0,0,0] op_sel_hi:[0,1,1]
    v_cvt_pk_bf16_f32 v70, v60, v61
    v_cvt_pk_bf16_f32 v71, v62, v63
    ds_write_b64 v5, v[70:71] offset:7920
    ds_read_b128 v[176:179], v6 offset:0
    ds_read_b128 v[180:183], v6 offset:32
    ds_read_b128 v[184:187], v6 offset:64
    ds_read_b128 v[188:191], v6 offset:96
    ds_read_b128 v[192:195], v6 offset:128
    ds_read_b128 v[196:199], v6 offset:160
    ds_read_b128 v[200:203], v6 offset:192
    ds_read_b128 v[204:207], v6 offset:224
    v_pk_mul_f32 v[64:65], v[32:33], v[28:29] op_sel:[1,1] op_sel_hi:[1,0] neg_lo:[1,0]
    v_pk_mul_f32 v[66:67], v[34:35], v[30:31] op_sel:[1,1] op_sel_hi:[1,0] neg_lo:[1,0]
    v_pk_fma_f32 v[32:33], v[32:33], v[28:29], v[64:65] op_sel:[0,0,0] op_sel_hi:[0,1,1]
    v_pk_fma_f32 v[34:35], v[34:35], v[30:31], v[66:67] op_sel:[0,0,0] op_sel_hi:[0,1,1]
    v_cvt_pk_bf16_f32 v68, v32, v33
    v_cvt_pk_bf16_f32 v69, v34, v35
    ds_write_b64 v5, v[68:69] offset:0
    v_pk_mul_f32 v[64:65], v[40:41], v[28:29] op_sel:[1,1] op_sel_hi:[1,0] neg_lo:[1,0]
    v_pk_mul_f32 v[66:67], v[42:43], v[30:31] op_sel:[1,1] op_sel_hi:[1,0] neg_lo:[1,0]
    v_pk_fma_f32 v[40:41], v[40:41], v[28:29], v[64:65] op_sel:[0,0,0] op_sel_hi:[0,1,1]
    v_pk_fma_f32 v[42:43], v[42:43], v[30:31], v[66:67] op_sel:[0,0,0] op_sel_hi:[0,1,1]
    v_cvt_pk_bf16_f32 v70, v40, v41
    v_cvt_pk_bf16_f32 v71, v42, v43
    ds_write_b64 v5, v[70:71] offset:528
    v_pk_mul_f32 v[64:65], v[48:49], v[28:29] op_sel:[1,1] op_sel_hi:[1,0] neg_lo:[1,0]
    v_pk_mul_f32 v[66:67], v[50:51], v[30:31] op_sel:[1,1] op_sel_hi:[1,0] neg_lo:[1,0]
    v_pk_fma_f32 v[48:49], v[48:49], v[28:29], v[64:65] op_sel:[0,0,0] op_sel_hi:[0,1,1]
    v_pk_fma_f32 v[50:51], v[50:51], v[30:31], v[66:67] op_sel:[0,0,0] op_sel_hi:[0,1,1]
    v_cvt_pk_bf16_f32 v68, v48, v49
    v_cvt_pk_bf16_f32 v69, v50, v51
    ds_write_b64 v5, v[68:69] offset:1056
    v_pk_mul_f32 v[64:65], v[56:57], v[28:29] op_sel:[1,1] op_sel_hi:[1,0] neg_lo:[1,0]
    v_pk_mul_f32 v[66:67], v[58:59], v[30:31] op_sel:[1,1] op_sel_hi:[1,0] neg_lo:[1,0]
    v_pk_fma_f32 v[56:57], v[56:57], v[28:29], v[64:65] op_sel:[0,0,0] op_sel_hi:[0,1,1]
    v_pk_fma_f32 v[58:59], v[58:59], v[30:31], v[66:67] op_sel:[0,0,0] op_sel_hi:[0,1,1]
    v_cvt_pk_bf16_f32 v70, v56, v57
    v_cvt_pk_bf16_f32 v71, v58, v59
    ds_write_b64 v5, v[70:71] offset:1584
    s_waitcnt lgkmcnt(11)
    v_mfma_f32_16x16x32_bf16 v[208:211], v[176:179], v[80:83], 0
    s_waitcnt lgkmcnt(10)
    s_mov_b32 s54, 393216
    s_add_u32 m0, s55, 3072
    s_nop 0
    buffer_load_dwordx4 v9, s[56:59], s54 offen lds
    v_mfma_f32_16x16x32_bf16 v[208:211], v[180:183], v[84:87], v[208:211]
    s_waitcnt lgkmcnt(9)
    v_mfma_f32_16x16x32_bf16 v[208:211], v[184:187], v[88:91], v[208:211]
    s_waitcnt lgkmcnt(8)
    v_mfma_f32_16x16x32_bf16 v[208:211], v[188:191], v[92:95], v[208:211]
    s_waitcnt lgkmcnt(7)
    v_mfma_f32_16x16x32_bf16 v[208:211], v[192:195], v[96:99], v[208:211]
    s_waitcnt lgkmcnt(6)
    v_mfma_f32_16x16x32_bf16 v[208:211], v[196:199], v[100:103], v[208:211]
    s_waitcnt lgkmcnt(5)
    v_mfma_f32_16x16x32_bf16 v[208:211], v[200:203], v[104:107], v[208:211]
    s_waitcnt lgkmcnt(4)
    v_mfma_f32_16x16x32_bf16 v[208:211], v[204:207], v[108:111], v[208:211]
    v_pk_mul_f32 v[64:65], v[32:33], v[28:29] op_sel:[1,1] op_sel_hi:[1,0] neg_lo:[1,0]
    v_pk_mul_f32 v[66:67], v[34:35], v[30:31] op_sel:[1,1] op_sel_hi:[1,0] neg_lo:[1,0]
    v_pk_fma_f32 v[32:33], v[32:33], v[28:29], v[64:65] op_sel:[0,0,0] op_sel_hi:[0,1,1]
    v_pk_fma_f32 v[34:35], v[34:35], v[30:31], v[66:67] op_sel:[0,0,0] op_sel_hi:[0,1,1]
    v_cvt_pk_bf16_f32 v68, v32, v33
    v_cvt_pk_bf16_f32 v69, v34, v35
    ds_write_b64 v5, v[68:69] offset:2112
    v_pk_mul_f32 v[64:65], v[40:41], v[28:29] op_sel:[1,1] op_sel_hi:[1,0] neg_lo:[1,0]
    v_pk_mul_f32 v[66:67], v[42:43], v[30:31] op_sel:[1,1] op_sel_hi:[1,0] neg_lo:[1,0]
    v_pk_fma_f32 v[40:41], v[40:41], v[28:29], v[64:65] op_sel:[0,0,0] op_sel_hi:[0,1,1]
    v_pk_fma_f32 v[42:43], v[42:43], v[30:31], v[66:67] op_sel:[0,0,0] op_sel_hi:[0,1,1]
    v_cvt_pk_bf16_f32 v70, v40, v41
    v_cvt_pk_bf16_f32 v71, v42, v43
    ds_write_b64 v5, v[70:71] offset:2640
    v_pk_mul_f32 v[64:65], v[48:49], v[28:29] op_sel:[1,1] op_sel_hi:[1,0] neg_lo:[1,0]
    v_pk_mul_f32 v[66:67], v[50:51], v[30:31] op_sel:[1,1] op_sel_hi:[1,0] neg_lo:[1,0]
    v_pk_fma_f32 v[48:49], v[48:49], v[28:29], v[64:65] op_sel:[0,0,0] op_sel_hi:[0,1,1]
    v_pk_fma_f32 v[50:51], v[50:51], v[30:31], v[66:67] op_sel:[0,0,0] op_sel_hi:[0,1,1]
    v_cvt_pk_bf16_f32 v68, v48, v49
    v_cvt_pk_bf16_f32 v69, v50, v51
    ds_write_b64 v5, v[68:69] offset:3168
    v_pk_mul_f32 v[64:65], v[56:57], v[28:29] op_sel:[1,1] op_sel_hi:[1,0] neg_lo:[1,0]
    v_pk_mul_f32 v[66:67], v[58:59], v[30:31] op_sel:[1,1] op_sel_hi:[1,0] neg_lo:[1,0]
    v_pk_fma_f32 v[56:57], v[56:57], v[28:29], v[64:65] op_sel:[0,0,0] op_sel_hi:[0,1,1]
    v_pk_fma_f32 v[58:59], v[58:59], v[30:31], v[66:67] op_sel:[0,0,0] op_sel_hi:[0,1,1]
    v_cvt_pk_bf16_f32 v70, v56, v57
    v_cvt_pk_bf16_f32 v71, v58, v59
    ds_write_b64 v5, v[70:71] offset:3696
    v_pk_mul_f32 v[64:65], v[32:33], v[28:29] op_sel:[1,1] op_sel_hi:[1,0] neg_lo:[1,0]
    v_pk_mul_f32 v[66:67], v[34:35], v[30:31] op_sel:[1,1] op_sel_hi:[1,0] neg_lo:[1,0]
    v_pk_fma_f32 v[32:33], v[32:33], v[28:29], v[64:65] op_sel:[0,0,0] op_sel_hi:[0,1,1]
    v_pk_fma_f32 v[34:35], v[34:35], v[30:31], v[66:67] op_sel:[0,0,0] op_sel_hi:[0,1,1]
    v_cvt_pk_bf16_f32 v68, v32, v33
    v_cvt_pk_bf16_f32 v69, v34, v35
    ds_write_b64 v5, v[68:69] offset:4224
    v_pk_mul_f32 v[64:65], v[48:49], v[28:29] op_sel:[1,1] op_sel_hi:[1,0] neg_lo:[1,0]
    v_pk_mul_f32 v[66:67], v[50:51], v[30:31] op_sel:[1,1] op_sel_hi:[1,0] neg_lo:[1,0]
    v_pk_fma_f32 v[48:49], v[48:49], v[28:29], v[64:65] op_sel:[0,0,0] op_sel_hi:[0,1,1]
    v_pk_fma_f32 v[50:51], v[50:51], v[30:31], v[66:67] op_sel:[0,0,0] op_sel_hi:[0,1,1]
    v_cvt_pk_bf16_f32 v70, v48, v49
    v_cvt_pk_bf16_f32 v71, v50, v51
    ds_write_b64 v5, v[70:71] offset:4752
    v_pk_mul_f32 v[64:65], v[32:33], v[28:29] op_sel:[1,1] op_sel_hi:[1,0] neg_lo:[1,0]
    v_pk_mul_f32 v[66:67], v[34:35], v[30:31] op_sel:[1,1] op_sel_hi:[1,0] neg_lo:[1,0]
    v_pk_fma_f32 v[32:33], v[32:33], v[28:29], v[64:65] op_sel:[0,0,0] op_sel_hi:[0,1,1]
    v_pk_fma_f32 v[34:35], v[34:35], v[30:31], v[66:67] op_sel:[0,0,0] op_sel_hi:[0,1,1]
    v_cvt_pk_bf16_f32 v68, v32, v33
    v_cvt_pk_bf16_f32 v69, v34, v35
    ds_write_b64 v5, v[68:69] offset:5280
    v_pk_mul_f32 v[64:65], v[48:49], v[28:29] op_sel:[1,1] op_sel_hi:[1,0] neg_lo:[1,0]
    v_pk_mul_f32 v[66:67], v[50:51], v[30:31] op_sel:[1,1] op_sel_hi:[1,0] neg_lo:[1,0]
    v_pk_fma_f32 v[48:49], v[48:49], v[28:29], v[64:65] op_sel:[0,0,0] op_sel_hi:[0,1,1]
    v_pk_fma_f32 v[50:51], v[50:51], v[30:31], v[66:67] op_sel:[0,0,0] op_sel_hi:[0,1,1]
    v_cvt_pk_bf16_f32 v70, v48, v49
    v_cvt_pk_bf16_f32 v71, v50, v51
    ds_write_b64 v5, v[70:71] offset:5808
    v_pk_mul_f32 v[64:65], v[32:33], v[28:29] op_sel:[1,1] op_sel_hi:[1,0] neg_lo:[1,0]
    v_pk_mul_f32 v[66:67], v[34:35], v[30:31] op_sel:[1,1] op_sel_hi:[1,0] neg_lo:[1,0]
    v_pk_fma_f32 v[32:33], v[32:33], v[28:29], v[64:65] op_sel:[0,0,0] op_sel_hi:[0,1,1]
    v_pk_fma_f32 v[34:35], v[34:35], v[30:31], v[66:67] op_sel:[0,0,0] op_sel_hi:[0,1,1]
    v_cvt_pk_bf16_f32 v68, v32, v33
    v_cvt_pk_bf16_f32 v69, v34, v35
    ds_write_b64 v5, v[68:69] offset:6336
    v_pk_mul_f32 v[64:65], v[48:49], v[28:29] op_sel:[1,1] op_sel_hi:[1,0] neg_lo:[1,0]
    v_pk_mul_f32 v[66:67], v[50:51], v[30:31] op_sel:[1,1] op_sel_hi:[1,0] neg_lo:[1,0]
    v_pk_fma_f32 v[48:49], v[48:49], v[28:29], v[64:65] op_sel:[0,0,0] op_sel_hi:[0,1,1]
    v_pk_fma_f32 v[50:51], v[50:51], v[30:31], v[66:67] op_sel:[0,0,0] op_sel_hi:[0,1,1]
    v_cvt_pk_bf16_f32 v70, v48, v49
    v_cvt_pk_bf16_f32 v71, v50, v51
    ds_write_b64 v5, v[70:71] offset:6864
    v_pk_mul_f32 v[64:65], v[32:33], v[28:29] op_sel:[1,1] op_sel_hi:[1,0] neg_lo:[1,0]
    v_pk_mul_f32 v[66:67], v[34:35], v[30:31] op_sel:[1,1] op_sel_hi:[1,0] neg_lo:[1,0]
    v_pk_fma_f32 v[32:33], v[32:33], v[28:29], v[64:65] op_sel:[0,0,0] op_sel_hi:[0,1,1]
    s_mov_b32 s54, 524288
    s_add_u32 m0, s55, 4096
    s_nop 0
    buffer_load_dwordx4 v9, s[56:59], s54 offen lds
    v_pk_fma_f32 v[34:35], v[34:35], v[30:31], v[66:67] op_sel:[0,0,0] op_sel_hi:[0,1,1]
    v_cvt_pk_bf16_f32 v68, v32, v33
    v_cvt_pk_bf16_f32 v69, v34, v35
    ds_write_b64 v5, v[68:69] offset:7392
    v_pk_mul_f32 v[64:65], v[48:49], v[28:29] op_sel:[1,1] op_sel_hi:[1,0] neg_lo:[1,0]
    v_pk_mul_f32 v[66:67], v[50:51], v[30:31] op_sel:[1,1] op_sel_hi:[1,0] neg_lo:[1,0]
    v_pk_fma_f32 v[48:49], v[48:49], v[28:29], v[64:65] op_sel:[0,0,0] op_sel_hi:[0,1,1]
    v_pk_fma_f32 v[50:51], v[50:51], v[30:31], v[66:67] op_sel:[0,0,0] op_sel_hi:[0,1,1]
    v_cvt_pk_bf16_f32 v70, v48, v49
    v_cvt_pk_bf16_f32 v71, v50, v51
    ds_write_b64 v5, v[70:71] offset:7920
    ds_read_b128 v[176:179], v6 offset:0
    ds_read_b128 v[180:183], v6 offset:32
    ds_read_b128 v[184:187], v6 offset:64
    ds_read_b128 v[188:191], v6 offset:96
    ds_read_b128 v[192:195], v6 offset:128
    ds_read_b128 v[196:199], v6 offset:160
    ds_read_b128 v[200:203], v6 offset:192
    ds_read_b128 v[204:207], v6 offset:224
    v_pk_mul_f32 v[64:65], v[32:33], v[28:29] op_sel:[1,1] op_sel_hi:[1,0] neg_lo:[1,0]
    v_pk_mul_f32 v[66:67], v[34:35], v[30:31] op_sel:[1,1] op_sel_hi:[1,0] neg_lo:[1,0]
    v_pk_fma_f32 v[32:33], v[32:33], v[28:29], v[64:65] op_sel:[0,0,0] op_sel_hi:[0,1,1]
    v_pk_fma_f32 v[34:35], v[34:35], v[30:31], v[66:67] op_sel:[0,0,0] op_sel_hi:[0,1,1]
    v_cvt_pk_bf16_f32 v68, v32, v33
    v_cvt_pk_bf16_f32 v69, v34, v35
    ds_write_b64 v5, v[68:69] offset:0
    v_pk_mul_f32 v[64:65], v[32:33], v[28:29] op_sel:[1,1] op_sel_hi:[1,0] neg_lo:[1,0]
    v_pk_mul_f32 v[66:67], v[34:35], v[30:31] op_sel:[1,1] op_sel_hi:[1,0] neg_lo:[1,0]
    v_pk_fma_f32 v[32:33], v[32:33], v[28:29], v[64:65] op_sel:[0,0,0] op_sel_hi:[0,1,1]
    v_pk_fma_f32 v[34:35], v[34:35], v[30:31], v[66:67] op_sel:[0,0,0] op_sel_hi:[0,1,1]
    v_cvt_pk_bf16_f32 v70, v32, v33
    v_cvt_pk_bf16_f32 v71, v34, v35
    ds_write_b64 v5, v[70:71] offset:528
    v_pk_mul_f32 v[64:65], v[32:33], v[28:29] op_sel:[1,1] op_sel_hi:[1,0] neg_lo:[1,0]
    v_pk_mul_f32 v[66:67], v[34:35], v[30:31] op_sel:[1,1] op_sel_hi:[1,0] neg_lo:[1,0]
    v_pk_fma_f32 v[32:33], v[32:33], v[28:29], v[64:65] op_sel:[0,0,0] op_sel_hi:[0,1,1]
    v_pk_fma_f32 v[34:35], v[34:35], v[30:31], v[66:67] op_sel:[0,0,0] op_sel_hi:[0,1,1]
    v_cvt_pk_bf16_f32 v68, v32, v33
    v_cvt_pk_bf16_f32 v69, v34, v35
    ds_write_b64 v5, v[68:69] offset:1056
    v_pk_mul_f32 v[64:65], v[32:33], v[28:29] op_sel:[1,1] op_sel_hi:[1,0] neg_lo:[1,0]
    v_pk_mul_f32 v[66:67], v[34:35], v[30:31] op_sel:[1,1] op_sel_hi:[1,0] neg_lo:[1,0]
    v_pk_fma_f32 v[32:33], v[32:33], v[28:29], v[64:65] op_sel:[0,0,0] op_sel_hi:[0,1,1]
    v_pk_fma_f32 v[34:35], v[34:35], v[30:31], v[66:67] op_sel:[0,0,0] op_sel_hi:[0,1,1]
    v_cvt_pk_bf16_f32 v70, v32, v33
    v_cvt_pk_bf16_f32 v71, v34, v35
    ds_write_b64 v5, v[70:71] offset:1584
    s_waitcnt lgkmcnt(11)
    v_mfma_f32_16x16x32_bf16 v[212:215], v[176:179], v[80:83], 0
    s_waitcnt lgkmcnt(10)
    v_mfma_f32_16x16x32_bf16 v[212:215], v[180:183], v[84:87], v[212:215]
    s_waitcnt lgkmcnt(9)
    v_mfma_f32_16x16x32_bf16 v[212:215], v[184:187], v[88:91], v[212:215]
    s_waitcnt lgkmcnt(8)
    v_mfma_f32_16x16x32_bf16 v[212:215], v[188:191], v[92:95], v[212:215]
    s_waitcnt lgkmcnt(7)
    v_mfma_f32_16x16x32_bf16 v[212:215], v[192:195], v[96:99], v[212:215]
    s_waitcnt lgkmcnt(6)
    v_mfma_f32_16x16x32_bf16 v[212:215], v[196:199], v[100:103], v[212:215]
    s_waitcnt lgkmcnt(5)
    v_mfma_f32_16x16x32_bf16 v[212:215], v[200:203], v[104:107], v[212:215]
    s_waitcnt lgkmcnt(4)
    v_mfma_f32_16x16x32_bf16 v[212:215], v[204:207], v[108:111], v[212:215]
    v_pk_mul_f32 v[64:65], v[32:33], v[28:29] op_sel:[1,1] op_sel_hi:[1,0] neg_lo:[1,0]
    v_pk_mul_f32 v[66:67], v[34:35], v[30:31] op_sel:[1,1] op_sel_hi:[1,0] neg_lo:[1,0]
    v_pk_fma_f32 v[32:33], v[32:33], v[28:29], v[64:65] op_sel:[0,0,0] op_sel_hi:[0,1,1]
    v_pk_fma_f32 v[34:35], v[34:35], v[30:31], v[66:67] op_sel:[0,0,0] op_sel_hi:[0,1,1]
    v_cvt_pk_bf16_f32 v68, v32, v33
    v_cvt_pk_bf16_f32 v69, v34, v35
    ds_write_b64 v5, v[68:69] offset:2112
    v_pk_mul_f32 v[64:65], v[32:33], v[28:29] op_sel:[1,1] op_sel_hi:[1,0] neg_lo:[1,0]
    v_pk_mul_f32 v[66:67], v[34:35], v[30:31] op_sel:[1,1] op_sel_hi:[1,0] neg_lo:[1,0]
    v_pk_fma_f32 v[32:33], v[32:33], v[28:29], v[64:65] op_sel:[0,0,0] op_sel_hi:[0,1,1]
    v_pk_fma_f32 v[34:35], v[34:35], v[30:31], v[66:67] op_sel:[0,0,0] op_sel_hi:[0,1,1]
    v_cvt_pk_bf16_f32 v70, v32, v33
    v_cvt_pk_bf16_f32 v71, v34, v35
    ds_write_b64 v5, v[70:71] offset:2640
    v_pk_mul_f32 v[64:65], v[32:33], v[28:29] op_sel:[1,1] op_sel_hi:[1,0] neg_lo:[1,0]
    v_pk_mul_f32 v[66:67], v[34:35], v[30:31] op_sel:[1,1] op_sel_hi:[1,0] neg_lo:[1,0]
    v_pk_fma_f32 v[32:33], v[32:33], v[28:29], v[64:65] op_sel:[0,0,0] op_sel_hi:[0,1,1]
    v_pk_fma_f32 v[34:35], v[34:35], v[30:31], v[66:67] op_sel:[0,0,0] op_sel_hi:[0,1,1]
    v_cvt_pk_bf16_f32 v68, v32, v33
    v_cvt_pk_bf16_f32 v69, v34, v35
    ds_write_b64 v5, v[68:69] offset:3168
    v_pk_mul_f32 v[64:65], v[32:33], v[28:29] op_sel:[1,1] op_sel_hi:[1,0] neg_lo:[1,0]
    v_pk_mul_f32 v[66:67], v[34:35], v[30:31] op_sel:[1,1] op_sel_hi:[1,0] neg_lo:[1,0]
    s_mov_b32 s54, 655360
    s_add_u32 m0, s55, 5120
    s_nop 0
    buffer_load_dwordx4 v9, s[56:59], s54 offen lds
    v_pk_fma_f32 v[32:33], v[32:33], v[28:29], v[64:65] op_sel:[0,0,0] op_sel_hi:[0,1,1]
    v_pk_fma_f32 v[34:35], v[34:35], v[30:31], v[66:67] op_sel:[0,0,0] op_sel_hi:[0,1,1]
    v_cvt_pk_bf16_f32 v70, v32, v33
    v_cvt_pk_bf16_f32 v71, v34, v35
    ds_write_b64 v5, v[70:71] offset:3696
    v_pk_mul_f32 v[64:65], v[32:33], v[28:29] op_sel:[1,1] op_sel_hi:[1,0] neg_lo:[1,0]
    v_pk_mul_f32 v[66:67], v[34:35], v[30:31] op_sel:[1,1] op_sel_hi:[1,0] neg_lo:[1,0]
    v_pk_fma_f32 v[32:33], v[32:33], v[28:29], v[64:65] op_sel:[0,0,0] op_sel_hi:[0,1,1]
    v_pk_fma_f32 v[34:35], v[34:35], v[30:31], v[66:67] op_sel:[0,0,0] op_sel_hi:[0,1,1]
    v_cvt_pk_bf16_f32 v68, v32, v33
    v_cvt_pk_bf16_f32 v69, v34, v35
    ds_write_b64 v5, v[68:69] offset:4224
    ds_read_b128 v[176:179], v6 offset:0
    ds_read_b128 v[180:183], v6 offset:32
    ds_read_b128 v[184:187], v6 offset:64
    ds_read_b128 v[188:191], v6 offset:96
    ds_read_b128 v[192:195], v6 offset:128
    ds_read_b128 v[196:199], v6 offset:160
    ds_read_b128 v[200:203], v6 offset:192
    ds_read_b128 v[204:207], v6 offset:224
    s_waitcnt lgkmcnt(7)
    v_mfma_f32_16x16x32_bf16 v[216:219], v[176:179], v[80:83], 0
    s_waitcnt lgkmcnt(6)
    v_mfma_f32_16x16x32_bf16 v[216:219], v[180:183], v[84:87], v[216:219]
    s_waitcnt lgkmcnt(5)
    v_mfma_f32_16x16x32_bf16 v[216:219], v[184:187], v[88:91], v[216:219]
    s_waitcnt lgkmcnt(4)
    v_mfma_f32_16x16x32_bf16 v[216:219], v[188:191], v[92:95], v[216:219]
    s_waitcnt lgkmcnt(3)
    v_mfma_f32_16x16x32_bf16 v[216:219], v[192:195], v[96:99], v[216:219]
    s_waitcnt lgkmcnt(2)
    v_mfma_f32_16x16x32_bf16 v[216:219], v[196:199], v[100:103], v[216:219]
    s_waitcnt lgkmcnt(1)
    v_mfma_f32_16x16x32_bf16 v[216:219], v[200:203], v[104:107], v[216:219]
    s_waitcnt lgkmcnt(0)
    v_mfma_f32_16x16x32_bf16 v[216:219], v[204:207], v[108:111], v[216:219]
    v_mov_b32 v64, 0
    v_mov_b32 v65, 0
    v_mov_b32 v66, 0
    v_mov_b32 v67, 0
    v_lshl_add_u32 v12, v1, 4, v4
    ds_write_b128 v12, v[64:67] offset:0
    ds_write_b128 v12, v[64:67] offset:1024
    ds_write_b128 v12, v[64:67] offset:2048
    ds_write_b128 v12, v[64:67] offset:3072
    v_cmp_eq_u32 vcc, 32, v1
    v_lshlrev_b32 v12, 5, v2
    v_lshl_add_u32 v12, v3, 9, v12
    v_add_u32 v12, v12, v4
    v_add_u32 v12, 1084, v12
    v_cndmask_b32 v72, v213, v212, vcc
    v_cndmask_b32 v73, v214, v213, vcc
    v_cndmask_b32 v74, v215, v64, vcc
    v_cvt_pk_bf16_f32 v76, v212, v213
    v_cvt_pk_bf16_f32 v77, v214, v215
    v_cndmask_b32 v76, v76, v64, vcc
    v_cvt_pk_bf16_f32 v64, v212, v212
    v_cvt_pk_bf16_f32 v65, v212, v212
    v_cvt_pk_bf16_f32 v66, v72, v212
    v_cvt_pk_bf16_f32 v67, v73, v72
    v_cvt_pk_bf16_f32 v68, v73, v73
    v_cvt_pk_bf16_f32 v69, v73, v73
    v_cvt_pk_bf16_f32 v70, v74, v73
    v_cvt_pk_bf16_f32 v71, v74, v74
    s_mov_b32 exec_hi, 1
    ds_write_b128 v12, v[64:67] offset:4
    ds_write_b128 v12, v[68:71] offset:20
    ds_write_b16 v12, v64
    s_mov_b32 exec_hi, -1
    v_and_b32 v13, 1, v3
    v_lshrrev_b32 v14, 1, v3
    v_lshlrev_b32 v12, 5, v2
    v_lshl_add_u32 v12, v13, 4, v12
    v_lshl_add_u32 v12, v14, 9, v12
    v_add3_u32 v12, v12, v4, 64
    v_cvt_pk_bf16_f32 v64, v208, v211
    v_cvt_pk_bf16_f32 v65, v209, v208
    v_cvt_pk_bf16_f32 v66, v210, v209
    v_cvt_pk_bf16_f32 v67, v211, v210
    ds_write_b16 v12, v64
    ds_write2_b32 v12, v65, v66 offset0:1 offset1:2
    ds_write_b32 v12, v67 offset:12
    ds_write_b16_d16_hi v12, v64 offset:18
    v_and_b32 v13, 1, v2
    v_lshrrev_b32 v14, 1, v2
    v_lshlrev_b32 v12, 2, v14
    s_mov_b32 s54, 786432
    s_add_u32 m0, s55, 6144
    s_nop 0
    buffer_load_dwordx4 v9, s[56:59], s54 offen lds
    v_lshl_add_u32 v12, v3, 6, v12
    v_mul_u32_u24 v14, 260, v13
    v_add3_u32 v12, v12, v14, v4
    v_add_u32 v12, 2172, v12
    s_mov_b32 exec_lo, 0
    ds_write2_b32 v12, v76, v77 offset0:0 offset1:8
    s_mov_b32 exec_lo, -1
    v_lshlrev_b32 v12, 1, v2
    v_lshl_add_u32 v12, v3, 7, v12
    v_lshl_add_u32 v12, v13, 2, v12
    v_add_u32 v12, v12, v4
    v_add_u32 v12, 2812, v12
    v_add_u32 v14, 2428, v4
    v_cmp_eq_u32 vcc, 0, v1
    v_cvt_pk_bf16_f32 v64, v216, v217
    v_cvt_pk_bf16_f32 v65, v218, v219
    v_cvt_pk_bf16_f32 v66, v216, v216
    v_cndmask_b32 v14, v12, v14, vcc
    ds_write_b16 v14, v64
    ds_write_b16_d16_hi v12, v64 offset:32
    ds_write_b16 v12, v65 offset:64
    ds_write_b16_d16_hi v12, v65 offset:96
    v_readlane_b32 s42, v66, 0
    v_lshlrev_b32 v12, 2, v2
    v_add_u32 v12, v12, v4
    v_lshlrev_b32 v13, 5, v3
    v_sub_u32 v13, v12, v13
    v_add_u32 v13, 104, v13
    v_add_u32 v14, 1024, v13
    v_add_u32 v15, 2048, v13
    v_lshlrev_b32 v64, 4, v3
    v_sub_u32 v12, v12, v64
    v_add_u32 v12, 2292, v12
    v_and_b32 v124, s42, v124
    v_and_b32 v125, s42, v125
    v_and_b32 v126, s42, v126
    v_and_b32 v127, s42, v127
    ds_read2_b32 v[16:17], v13 offset0:6 offset1:4
    ds_read2_b32 v[18:19], v13 offset0:2 offset1:0
    ds_read2_b32 v[20:21], v13 offset0:38 offset1:36
    ds_read2_b32 v[22:23], v13 offset0:34 offset1:32
    ds_read2_b32 v[24:25], v13 offset0:70 offset1:68
    ds_read2_b32 v[26:27], v13 offset0:66 offset1:64
    ds_read2_b32 v[28:29], v13 offset0:102 offset1:100
    ds_read2_b32 v[30:31], v13 offset0:98 offset1:96
    ds_read2_b32 v[32:33], v13 offset0:134 offset1:132
    ds_read2_b32 v[34:35], v13 offset0:130 offset1:128
    ds_read2_b32 v[36:37], v13 offset0:166 offset1:164
    ds_read2_b32 v[38:39], v13 offset0:162 offset1:160
    ds_read2_b32 v[40:41], v13 offset0:198 offset1:196
    ds_read2_b32 v[42:43], v13 offset0:194 offset1:192
    ds_read2_b32 v[44:45], v13 offset0:230 offset1:228
    ds_read2_b32 v[46:47], v13 offset0:226 offset1:224
    ds_read2_b32 v[48:49], v14 offset0:6 offset1:4
    ds_read2_b32 v[50:51], v14 offset0:2 offset1:0
    ds_read2_b32 v[52:53], v14 offset0:38 offset1:36
    ds_read2_b32 v[54:55], v14 offset0:34 offset1:32
    ds_read2_b32 v[56:57], v14 offset0:70 offset1:68
    ds_read2_b32 v[58:59], v14 offset0:66 offset1:64
    ds_read2_b32 v[60:61], v14 offset0:102 offset1:100
    ds_read2_b32 v[62:63], v14 offset0:98 offset1:96
    ds_read2_b32 v[64:65], v14 offset0:134 offset1:132
    ds_read2_b32 v[66:67], v14 offset0:130 offset1:128
    ds_read2_b32 v[68:69], v14 offset0:166 offset1:164
    ds_read2_b32 v[70:71], v14 offset0:162 offset1:160
    ds_read2_b32 v[72:73], v14 offset0:198 offset1:196
    ds_read2_b32 v[74:75], v14 offset0:194 offset1:192
    ds_read2_b32 v[76:77], v14 offset0:230 offset1:228
    ds_read2_b32 v[78:79], v14 offset0:226 offset1:224
    ds_read2_b32 v[80:81], v15 offset0:6 offset1:4
    ds_read2_b32 v[82:83], v15 offset0:2 offset1:0
    ds_read2_b32 v[84:85], v12 offset0:3 offset1:2
    ds_read2_b32 v[86:87], v12 offset0:1 offset1:0
    ds_read2_b32 v[88:89], v12 offset0:19 offset1:18
    ds_read2_b32 v[90:91], v12 offset0:17 offset1:16
    ds_read2_b32 v[92:93], v12 offset0:35 offset1:34
    ds_read2_b32 v[94:95], v12 offset0:33 offset1:32
    ds_read2_b32 v[96:97], v12 offset0:67 offset1:66
    ds_read2_b32 v[98:99], v12 offset0:65 offset1:64
    ds_read2_b32 v[100:101], v12 offset0:83 offset1:82
    ds_read2_b32 v[102:103], v12 offset0:81 offset1:80
    ds_read2_b32 v[104:105], v12 offset0:99 offset1:98
    ds_read2_b32 v[106:107], v12 offset0:97 offset1:96
    ds_read2_b32 v[108:109], v12 offset0:131 offset1:130
    ds_read2_b32 v[110:111], v12 offset0:129 offset1:128
    ds_read2_b32 v[112:113], v12 offset0:147 offset1:146
    ds_read2_b32 v[114:115], v12 offset0:145 offset1:144
    ds_read2_b32 v[116:117], v12 offset0:163 offset1:162
    ds_read2_b32 v[118:119], v12 offset0:161 offset1:160
    ds_read2_b32 v[120:121], v12 offset0:179 offset1:178
    ds_read2_b32 v[122:123], v12 offset0:177 offset1:176
    s_waitcnt vmcnt(7)
    v_lshlrev_b32 v176, 16, v240
    v_lshlrev_b32 v177, 16, v244
    v_lshlrev_b32 v178, 16, v248
    v_lshlrev_b32 v179, 16, v252
    v_and_b32 v180, 0xffff0000, v240
    v_and_b32 v181, 0xffff0000, v244
    v_and_b32 v182, 0xffff0000, v248
    v_and_b32 v183, 0xffff0000, v252
    v_lshlrev_b32 v184, 16, v241
    v_lshlrev_b32 v185, 16, v245
    v_lshlrev_b32 v186, 16, v249
    v_lshlrev_b32 v187, 16, v253
    v_and_b32 v188, 0xffff0000, v241
    v_and_b32 v189, 0xffff0000, v245
    v_and_b32 v190, 0xffff0000, v249
    v_and_b32 v191, 0xffff0000, v253
    v_lshlrev_b32 v192, 16, v242
    v_lshlrev_b32 v193, 16, v246
    v_lshlrev_b32 v194, 16, v250
    v_lshlrev_b32 v195, 16, v254
    v_and_b32 v196, 0xffff0000, v242
    v_and_b32 v197, 0xffff0000, v246
    v_and_b32 v198, 0xffff0000, v250
    v_and_b32 v199, 0xffff0000, v254
    v_lshlrev_b32 v200, 16, v243
    v_lshlrev_b32 v201, 16, v247
    v_lshlrev_b32 v202, 16, v251
    v_lshlrev_b32 v203, 16, v255
    v_and_b32 v204, 0xffff0000, v243
    v_and_b32 v205, 0xffff0000, v247
    v_and_b32 v206, 0xffff0000, v251
    v_and_b32 v207, 0xffff0000, v255
    v_lshlrev_b32 v232, 16, v144
    v_and_b32 v233, 0xffff0000, v144
    v_lshlrev_b32 v234, 16, v145
    v_and_b32 v235, 0xffff0000, v145
    v_lshlrev_b32 v236, 16, v146
    v_and_b32 v237, 0xffff0000, v146
    v_lshlrev_b32 v238, 16, v147
    v_and_b32 v239, 0xffff0000, v147
    v_add_f32 v232, 1.0, v232
    v_add_f32 v233, 1.0, v233
    v_add_f32 v234, 1.0, v234
    v_add_f32 v235, 1.0, v235
    v_add_f32 v236, 1.0, v236
    v_add_f32 v237, 1.0, v237
    v_add_f32 v238, 1.0, v238
    v_add_f32 v239, 1.0, v239
    v_lshlrev_b32 v4, 3, v0
    v_add_u32 v5, 36864, v4
    v_lshlrev_b32 v6, 4, v0
    v_add_u32 v6, 4096, v6
    v_mov_b32 v12, 0
    v_mov_b32 v13, 0
    v_lshl_add_u32 v10, v1, 3, s51
    s_mov_b32 s53, 8192
    s_waitcnt lgkmcnt(0)
    s_barrier
    ds_write_b64 v10, v[12:13]
    s_mov_b32 s43, 0
L_poll_conv:
    buffer_load_dwordx4 v[144:147], v6, s[36:39], 0 offen sc1
    buffer_load_dwordx4 v[148:151], v6, s[36:39], s53 offen sc1
    s_waitcnt vmcnt(0)
    v_xor_b32 v10, s52, v147
    v_bitop3_b32 v10, v10, v151, s52 bitop3:0xf6
    v_cmp_ne_u32 vcc, 0, v10
    s_cbranch_vccz L_polled_conv
    s_add_u32 s43, s43, 1
    s_cmp_ge_u32 s43, 65536
    s_cbranch_scc1 L_polled_conv
    s_sleep 2
    s_branch L_poll_conv
L_polled_conv:
    v_and_b32 v160, 0xffff0000, v144
    v_lshlrev_b32 v164, 16, v144
    v_rcp_f32 v160, v160
    v_and_b32 v161, 0xffff0000, v145
    v_lshlrev_b32 v165, 16, v145
    v_rcp_f32 v161, v161
    v_and_b32 v162, 0xffff0000, v148
    v_lshlrev_b32 v166, 16, v148
    v_rcp_f32 v162, v162
    v_and_b32 v163, 0xffff0000, v149
    v_lshlrev_b32 v167, 16, v149
    v_rcp_f32 v163, v163
    v_pk_mul_f32 v[164:165], v[164:165], v[160:161] neg_lo:[1,0] neg_hi:[1,0]
    v_pk_mul_f32 v[166:167], v[166:167], v[162:163] neg_lo:[1,0] neg_hi:[1,0]
    v_pk_fma_f32 v[168:169], v[176:177], v[160:161], v[164:165]
    v_pk_fma_f32 v[170:171], v[178:179], v[162:163], v[166:167]
    v_pk_fma_f32 v[172:173], v[180:181], v[160:161], v[164:165]
    v_pk_fma_f32 v[174:175], v[182:183], v[162:163], v[166:167]
    v_cvt_pk_bf16_f32 v216, v168, v169
    v_pk_fma_f32 v[168:169], v[168:169], v[232:233], v[176:177] op_sel:[0,0,0] op_sel_hi:[1,0,1]
    v_cvt_pk_bf16_f32 v217, v170, v171
    v_pk_fma_f32 v[170:171], v[170:171], v[232:233], v[178:179] op_sel:[0,0,0] op_sel_hi:[1,0,1]
    ds_write_b64 v4, v[216:217] offset:512
    v_cvt_pk_bf16_f32 v218, v172, v173
    v_pk_fma_f32 v[172:173], v[172:173], v[232:233], v[180:181] op_sel:[0,1,0] op_sel_hi:[1,1,1]
    v_cvt_pk_bf16_f32 v219, v174, v175
    v_pk_fma_f32 v[174:175], v[174:175], v[232:233], v[182:183] op_sel:[0,1,0] op_sel_hi:[1,1,1]
    ds_write_b64 v4, v[218:219] offset:5120
    v_cvt_pk_bf16_f32 v220, v168, v169
    v_cvt_pk_bf16_f32 v221, v170, v171
    ds_write_b64 v5, v[220:221] offset:0
    v_cvt_pk_bf16_f32 v222, v172, v173
    v_cvt_pk_bf16_f32 v223, v174, v175
    ds_write_b64 v5, v[222:223] offset:4160
    v_pk_fma_f32 v[168:169], v[184:185], v[160:161], v[164:165]
    v_pk_fma_f32 v[170:171], v[186:187], v[162:163], v[166:167]
    v_pk_fma_f32 v[172:173], v[188:189], v[160:161], v[164:165]
    v_pk_fma_f32 v[174:175], v[190:191], v[162:163], v[166:167]
    v_cvt_pk_bf16_f32 v224, v168, v169
    v_pk_fma_f32 v[168:169], v[168:169], v[234:235], v[184:185] op_sel:[0,0,0] op_sel_hi:[1,0,1]
    v_cvt_pk_bf16_f32 v225, v170, v171
    v_pk_fma_f32 v[170:171], v[170:171], v[234:235], v[186:187] op_sel:[0,0,0] op_sel_hi:[1,0,1]
    ds_write_b64 v4, v[224:225] offset:9728
    v_cvt_pk_bf16_f32 v226, v172, v173
    v_pk_fma_f32 v[172:173], v[172:173], v[234:235], v[188:189] op_sel:[0,1,0] op_sel_hi:[1,1,1]
    v_cvt_pk_bf16_f32 v227, v174, v175
    v_pk_fma_f32 v[174:175], v[174:175], v[234:235], v[190:191] op_sel:[0,1,0] op_sel_hi:[1,1,1]
    ds_write_b64 v4, v[226:227] offset:14336
    v_cvt_pk_bf16_f32 v228, v168, v169
    v_cvt_pk_bf16_f32 v229, v170, v171
    ds_write_b64 v5, v[228:229] offset:8320
    v_cvt_pk_bf16_f32 v230, v172, v173
    v_cvt_pk_bf16_f32 v231, v174, v175
    ds_write_b64 v5, v[230:231] offset:12480
    v_pk_fma_f32 v[168:169], v[192:193], v[160:161], v[164:165]
    v_pk_fma_f32 v[170:171], v[194:195], v[162:163], v[166:167]
    v_pk_fma_f32 v[172:173], v[196:197], v[160:161], v[164:165]
    v_pk_fma_f32 v[174:175], v[198:199], v[162:163], v[166:167]
    v_cvt_pk_bf16_f32 v216, v168, v169
    v_pk_fma_f32 v[168:169], v[168:169], v[236:237], v[192:193] op_sel:[0,0,0] op_sel_hi:[1,0,1]
    v_cvt_pk_bf16_f32 v217, v170, v171
    v_pk_fma_f32 v[170:171], v[170:171], v[236:237], v[194:195] op_sel:[0,0,0] op_sel_hi:[1,0,1]
    ds_write_b64 v4, v[216:217] offset:18944
    v_cvt_pk_bf16_f32 v218, v172, v173
    v_pk_fma_f32 v[172:173], v[172:173], v[236:237], v[196:197] op_sel:[0,1,0] op_sel_hi:[1,1,1]
    v_cvt_pk_bf16_f32 v219, v174, v175
    v_pk_fma_f32 v[174:175], v[174:175], v[236:237], v[198:199] op_sel:[0,1,0] op_sel_hi:[1,1,1]
    ds_write_b64 v4, v[218:219] offset:23552
    v_cvt_pk_bf16_f32 v220, v168, v169
    v_cvt_pk_bf16_f32 v221, v170, v171
    ds_write_b64 v5, v[220:221] offset:16640
    v_cvt_pk_bf16_f32 v222, v172, v173
    v_cvt_pk_bf16_f32 v223, v174, v175
    ds_write_b64 v5, v[222:223] offset:20800
    v_pk_fma_f32 v[168:169], v[200:201], v[160:161], v[164:165]
    v_pk_fma_f32 v[170:171], v[202:203], v[162:163], v[166:167]
    v_pk_fma_f32 v[172:173], v[204:205], v[160:161], v[164:165]
    v_pk_fma_f32 v[174:175], v[206:207], v[162:163], v[166:167]
    v_cvt_pk_bf16_f32 v224, v168, v169
    v_pk_fma_f32 v[168:169], v[168:169], v[238:239], v[200:201] op_sel:[0,0,0] op_sel_hi:[1,0,1]
    v_cvt_pk_bf16_f32 v225, v170, v171
    v_pk_fma_f32 v[170:171], v[170:171], v[238:239], v[202:203] op_sel:[0,0,0] op_sel_hi:[1,0,1]
    ds_write_b64 v4, v[224:225] offset:28160
    v_cvt_pk_bf16_f32 v226, v172, v173
    v_pk_fma_f32 v[172:173], v[172:173], v[238:239], v[204:205] op_sel:[0,1,0] op_sel_hi:[1,1,1]
    v_cvt_pk_bf16_f32 v227, v174, v175
    v_pk_fma_f32 v[174:175], v[174:175], v[238:239], v[206:207] op_sel:[0,1,0] op_sel_hi:[1,1,1]
    ds_write_b64 v4, v[226:227] offset:32768
    v_cvt_pk_bf16_f32 v228, v168, v169
    v_cvt_pk_bf16_f32 v229, v170, v171
    ds_write_b64 v5, v[228:229] offset:24960
    v_cvt_pk_bf16_f32 v230, v172, v173
    v_cvt_pk_bf16_f32 v231, v174, v175
    ds_write_b64 v5, v[230:231] offset:29120
    v_bfe_u32 v10, v0, 2, 2
    v_mul_u32_u24 v10, 4160, v10
    v_lshrrev_b32 v11, 4, v0
    v_lshl_add_u32 v10, v11, 5, v10
    v_and_b32 v11, 3, v0
    v_lshl_add_u32 v10, v11, 3, v10
    v_add_u32 v234, 36864, v10
    v_lshlrev_b32 v11, 11, v0
    v_add_u32 v235, s49, v11
    s_mov_b32 s54, 0x100000
    s_mov_b32 s55, 0x200000
    s_waitcnt lgkmcnt(0)
    s_barrier
    v_mov_b32 v0, v234
    v_mov_b32 v1, v235
    v_lshl_add_u32 v9, v3, 4, v2
    v_lshlrev_b32 v9, 4, v9
    s_mul_i32 s46, s45, 14336
    s_add_u32 s46, s46, 32768
    v_add_u32 v9, s46, v9
    s_mov_b32 s46, 4096
    s_mov_b32 s47, 8192
    s_mov_b32 s48, 12288
    v_lshrrev_b32 v10, 3, v2
    v_lshl_add_u32 v10, v3, 1, v10
    v_lshlrev_b32 v10, 4, v10
    v_add_u32 v3, 147456, v10
    v_mov_b32 v2, v7
    ds_read_b128 v[176:179], v2 offset:0
    ds_read_b128 v[180:183], v2 offset:64
    ds_read_b128 v[184:187], v2 offset:128
    ds_read_b128 v[188:191], v2 offset:192
    ds_read_b64 v[204:205], v8 offset:0
    s_waitcnt lgkmcnt(0)
    v_lshlrev_b32 v144, 16, v204
    v_and_b32 v145, 0xffff0000, v204
    v_lshlrev_b32 v146, 16, v205
    v_and_b32 v147, 0xffff0000, v205
    ds_read_b64 v[206:207], v8 offset:512
    s_waitcnt lgkmcnt(0)
    v_lshlrev_b32 v148, 16, v206
    v_and_b32 v149, 0xffff0000, v206
    v_lshlrev_b32 v150, 16, v207
    v_and_b32 v151, 0xffff0000, v207
    v_mfma_f32_16x16x32_bf16 v[144:147], v[44:47], v[176:179], v[144:147]
    ds_read_b128 v[192:195], v2 offset:256
    ds_read_b128 v[196:199], v2 offset:320
    v_mfma_f32_16x16x32_bf16 v[148:151], v[76:79], v[176:179], v[148:151]
    ds_read_b128 v[176:179], v2 offset:384
    ds_read_b64 v[208:209], v8 offset:1024
    v_mfma_f32_16x16x32_bf16 v[144:147], v[40:43], v[180:183], v[144:147]
    ds_read_b64 v[210:211], v8 offset:1536
    ds_read_b64 v[212:213], v8 offset:2048
    v_mfma_f32_16x16x32_bf16 v[148:151], v[72:75], v[180:183], v[148:151]
    ds_read_b128 v[180:183], v2 offset:448
    ds_read_b64 v[214:215], v8 offset:2560
    v_mfma_f32_16x16x32_bf16 v[144:147], v[36:39], v[184:187], v[144:147]
    ds_read_b64 v[216:217], v8 offset:3072
    ds_read_b64 v[218:219], v8 offset:3584
    v_mfma_f32_16x16x32_bf16 v[148:151], v[68:71], v[184:187], v[148:151]
    ds_read_b128 v[200:203], v2 offset:432
    s_waitcnt lgkmcnt(7)
    v_lshlrev_b32 v152, 16, v208
    v_mfma_f32_16x16x32_bf16 v[144:147], v[32:35], v[188:191], v[144:147]
    v_and_b32 v153, 0xffff0000, v208
    v_lshlrev_b32 v154, 16, v209
    v_mfma_f32_16x16x32_bf16 v[148:151], v[64:67], v[188:191], v[148:151]
    v_and_b32 v155, 0xffff0000, v209
    s_waitcnt lgkmcnt(6)
    v_lshlrev_b32 v156, 16, v210
    v_mfma_f32_16x16x32_bf16 v[144:147], v[28:31], v[192:195], v[144:147]
    v_and_b32 v157, 0xffff0000, v210
    v_lshlrev_b32 v158, 16, v211
    v_mfma_f32_16x16x32_bf16 v[148:151], v[60:63], v[192:195], v[148:151]
    v_and_b32 v159, 0xffff0000, v211
    s_waitcnt lgkmcnt(5)
    v_lshlrev_b32 v160, 16, v212
    v_mfma_f32_16x16x32_bf16 v[144:147], v[24:27], v[196:199], v[144:147]
    v_and_b32 v161, 0xffff0000, v212
    v_lshlrev_b32 v162, 16, v213
    v_mfma_f32_16x16x32_bf16 v[148:151], v[56:59], v[196:199], v[148:151]
    v_and_b32 v163, 0xffff0000, v213
    s_waitcnt lgkmcnt(3)
    v_lshlrev_b32 v164, 16, v214
    v_mfma_f32_16x16x32_bf16 v[144:147], v[20:23], v[176:179], v[144:147]
    v_and_b32 v165, 0xffff0000, v214
    v_lshlrev_b32 v166, 16, v215
    v_mfma_f32_16x16x32_bf16 v[148:151], v[52:55], v[176:179], v[148:151]
    v_and_b32 v167, 0xffff0000, v215
    s_waitcnt lgkmcnt(2)
    v_lshlrev_b32 v168, 16, v216
    v_mfma_f32_16x16x32_bf16 v[144:147], v[16:19], v[180:183], v[144:147]
    v_and_b32 v169, 0xffff0000, v216
    v_lshlrev_b32 v170, 16, v217
    v_mfma_f32_16x16x32_bf16 v[148:151], v[48:51], v[180:183], v[148:151]
    v_and_b32 v171, 0xffff0000, v217
    s_waitcnt lgkmcnt(1)
    v_lshlrev_b32 v172, 16, v218
    v_and_b32 v173, 0xffff0000, v218
    v_lshlrev_b32 v174, 16, v219
    v_and_b32 v175, 0xffff0000, v219
    v_mfma_f32_16x16x32_bf16 v[152:155], v[80:83], v[180:183], v[152:155]
    ds_read_b128 v[184:187], v2 offset:512
    ds_read_b128 v[188:191], v2 offset:576
    v_mfma_f32_16x16x32_bf16 v[212:215], v[180:183], v[128:131], 0
    ds_read_b128 v[192:195], v2 offset:640
    ds_read_b128 v[196:199], v2 offset:704
    v_mfma_f32_16x16x32_bf16 v[216:219], v[180:183], v[132:135], 0
    v_cvt_pk_bf16_f32 v10, v144, v145
    v_cvt_pk_bf16_f32 v11, v146, v147
    v_mfma_f32_16x16x32_bf16 v[224:227], v[180:183], v[140:143], 0
    ds_write_b64 v8, v[10:11] offset:0
    ds_read_b128 v[176:179], v2 offset:768
    v_mfma_f32_16x16x32_bf16 v[160:163], v[124:127], v[180:183], v[160:163]
    ds_read_b128 v[180:183], v2 offset:832
    s_waitcnt lgkmcnt(7)
    v_mfma_f32_16x16x32_bf16 v[204:207], v[200:203], v[128:131], 0
    v_cvt_pk_bf16_f32 v232, v212, v216
    v_cvt_pk_bf16_f32 v233, v213, v217
    v_mfma_f32_16x16x32_bf16 v[208:211], v[200:203], v[132:135], 0
    v_cvt_pk_bf16_f32 v234, v214, v218
    v_cvt_pk_bf16_f32 v235, v215, v219
    v_mfma_f32_16x16x32_bf16 v[220:223], v[200:203], v[136:139], 0
    ds_read_b128 v[200:203], v2 offset:944
    s_waitcnt lgkmcnt(7)
    v_mfma_f32_16x16x32_bf16 v[148:151], v[44:47], v[184:187], v[148:151]
    v_mfma_f32_16x16x32_bf16 v[152:155], v[76:79], v[184:187], v[152:155]
    s_nop 0
    v_cvt_pk_bf16_f32 v228, v204, v208
    v_cvt_pk_bf16_f32 v229, v205, v209
    s_waitcnt lgkmcnt(6)
    v_mfma_f32_16x16x32_bf16 v[148:151], v[40:43], v[188:191], v[148:151]
    v_cvt_pk_bf16_f32 v230, v206, v210
    v_cvt_pk_bf16_f32 v231, v207, v211
    v_mfma_f32_16x16x32_bf16 v[152:155], v[72:75], v[188:191], v[152:155]
    v_cvt_pk_bf16_f32 v236, v220, v224
    v_cvt_pk_bf16_f32 v237, v221, v225
    v_mfma_f32_16x16x32_bf16 v[152:155], v[232:235], v[96:99], v[152:155]
    v_cvt_pk_bf16_f32 v238, v222, v226
    v_cvt_pk_bf16_f32 v239, v223, v227
    v_mfma_f32_16x16x32_bf16 v[156:159], v[232:235], v[100:103], v[156:159]
    ds_read_b128 v[184:187], v2 offset:896
    ds_read_b128 v[188:191], v2 offset:960
    v_mfma_f32_16x16x32_bf16 v[160:163], v[232:235], v[104:107], v[160:163]
    s_waitcnt lgkmcnt(7)
    v_mfma_f32_16x16x32_bf16 v[148:151], v[36:39], v[192:195], v[148:151]
    v_mfma_f32_16x16x32_bf16 v[152:155], v[68:71], v[192:195], v[152:155]
    ds_read_b128 v[192:195], v2 offset:1024
    v_mfma_f32_16x16x32_bf16 v[152:155], v[228:231], v[84:87], v[152:155]
    v_mfma_f32_16x16x32_bf16 v[156:159], v[228:231], v[88:91], v[156:159]
    v_mfma_f32_16x16x32_bf16 v[160:163], v[228:231], v[92:95], v[160:163]
    s_waitcnt lgkmcnt(7)
    v_mfma_f32_16x16x32_bf16 v[148:151], v[32:35], v[196:199], v[148:151]
    v_mfma_f32_16x16x32_bf16 v[152:155], v[64:67], v[196:199], v[152:155]
    ds_read_b128 v[196:199], v2 offset:1088
    v_mfma_f32_16x16x32_bf16 v[160:163], v[236:239], v[108:111], v[160:163]
    v_mfma_f32_16x16x32_bf16 v[164:167], v[236:239], v[112:115], v[164:167]
    v_mfma_f32_16x16x32_bf16 v[168:171], v[236:239], v[116:119], v[168:171]
    v_mfma_f32_16x16x32_bf16 v[172:175], v[236:239], v[120:123], v[172:175]
    s_waitcnt lgkmcnt(6)
    v_mfma_f32_16x16x32_bf16 v[148:151], v[28:31], v[176:179], v[148:151]
    v_mfma_f32_16x16x32_bf16 v[152:155], v[60:63], v[176:179], v[152:155]
    ds_read_b128 v[176:179], v2 offset:1152
    s_waitcnt lgkmcnt(6)
    v_mfma_f32_16x16x32_bf16 v[148:151], v[24:27], v[180:183], v[148:151]
    v_mfma_f32_16x16x32_bf16 v[152:155], v[56:59], v[180:183], v[152:155]
    ds_read_b128 v[180:183], v2 offset:1216
    s_waitcnt lgkmcnt(5)
    v_mfma_f32_16x16x32_bf16 v[148:151], v[20:23], v[184:187], v[148:151]
    v_mfma_f32_16x16x32_bf16 v[152:155], v[52:55], v[184:187], v[152:155]
    ds_read_b128 v[184:187], v2 offset:1280
    s_waitcnt lgkmcnt(5)
    v_mfma_f32_16x16x32_bf16 v[148:151], v[16:19], v[188:191], v[148:151]
    v_mfma_f32_16x16x32_bf16 v[152:155], v[48:51], v[188:191], v[152:155]
    v_mfma_f32_16x16x32_bf16 v[156:159], v[80:83], v[188:191], v[156:159]
    v_mfma_f32_16x16x32_bf16 v[212:215], v[188:191], v[128:131], 0
    v_mfma_f32_16x16x32_bf16 v[216:219], v[188:191], v[132:135], 0
    s_nop 3
    v_cvt_pk_bf16_f32 v10, v148, v149
    v_cvt_pk_bf16_f32 v11, v150, v151
    v_mfma_f32_16x16x32_bf16 v[224:227], v[188:191], v[140:143], 0
    ds_write_b64 v8, v[10:11] offset:512
    v_mfma_f32_16x16x32_bf16 v[164:167], v[124:127], v[188:191], v[164:167]
    ds_read_b128 v[188:191], v2 offset:1344
    v_mfma_f32_16x16x32_bf16 v[204:207], v[200:203], v[128:131], 0
    v_cvt_pk_bf16_f32 v232, v212, v216
    v_cvt_pk_bf16_f32 v233, v213, v217
    v_mfma_f32_16x16x32_bf16 v[208:211], v[200:203], v[132:135], 0
    v_cvt_pk_bf16_f32 v234, v214, v218
    v_cvt_pk_bf16_f32 v235, v215, v219
    v_mfma_f32_16x16x32_bf16 v[220:223], v[200:203], v[136:139], 0
    s_waitcnt lgkmcnt(1)
    s_barrier
    ds_read_b64_tr_b16 v[12:13], v0 offset:0
    v_mfma_f32_16x16x32_bf16 v[152:155], v[44:47], v[192:195], v[152:155]
    ds_read_b64_tr_b16 v[14:15], v0 offset:16640
    ds_read_b128 v[200:203], v2 offset:1456
    v_mfma_f32_16x16x32_bf16 v[156:159], v[76:79], v[192:195], v[156:159]
    v_cvt_pk_bf16_f32 v228, v204, v208
    v_cvt_pk_bf16_f32 v229, v205, v209
    v_mfma_f32_16x16x32_bf16 v[152:155], v[40:43], v[196:199], v[152:155]
    v_cvt_pk_bf16_f32 v230, v206, v210
    v_cvt_pk_bf16_f32 v231, v207, v211
    v_mfma_f32_16x16x32_bf16 v[156:159], v[72:75], v[196:199], v[156:159]
    v_cvt_pk_bf16_f32 v236, v220, v224
    v_cvt_pk_bf16_f32 v237, v221, v225
    v_mfma_f32_16x16x32_bf16 v[156:159], v[232:235], v[96:99], v[156:159]
    v_cvt_pk_bf16_f32 v238, v222, v226
    v_cvt_pk_bf16_f32 v239, v223, v227
    v_mfma_f32_16x16x32_bf16 v[160:163], v[232:235], v[100:103], v[160:163]
    s_waitcnt lgkmcnt(1)
    buffer_store_dwordx4 v[12:15], v1, s[32:35], 0 offen
    ds_read_b128 v[192:195], v2 offset:1408
    v_mfma_f32_16x16x32_bf16 v[164:167], v[232:235], v[104:107], v[164:167]
    ds_read_b128 v[196:199], v2 offset:1472
    v_mfma_f32_16x16x32_bf16 v[152:155], v[36:39], v[176:179], v[152:155]
    v_mfma_f32_16x16x32_bf16 v[156:159], v[68:71], v[176:179], v[156:159]
    ds_read_b128 v[176:179], v2 offset:1536
    v_mfma_f32_16x16x32_bf16 v[156:159], v[228:231], v[84:87], v[156:159]
    v_mfma_f32_16x16x32_bf16 v[160:163], v[228:231], v[88:91], v[160:163]
    v_mfma_f32_16x16x32_bf16 v[164:167], v[228:231], v[92:95], v[164:167]
    v_mfma_f32_16x16x32_bf16 v[152:155], v[32:35], v[180:183], v[152:155]
    v_mfma_f32_16x16x32_bf16 v[156:159], v[64:67], v[180:183], v[156:159]
    ds_read_b128 v[180:183], v2 offset:1600
    v_mfma_f32_16x16x32_bf16 v[164:167], v[236:239], v[108:111], v[164:167]
    v_mfma_f32_16x16x32_bf16 v[168:171], v[236:239], v[112:115], v[168:171]
    v_mfma_f32_16x16x32_bf16 v[172:175], v[236:239], v[116:119], v[172:175]
    v_mfma_f32_16x16x32_bf16 v[152:155], v[28:31], v[184:187], v[152:155]
    v_mfma_f32_16x16x32_bf16 v[156:159], v[60:63], v[184:187], v[156:159]
    ds_read_b128 v[184:187], v2 offset:1664
    v_mfma_f32_16x16x32_bf16 v[152:155], v[24:27], v[188:191], v[152:155]
    v_mfma_f32_16x16x32_bf16 v[156:159], v[56:59], v[188:191], v[156:159]
    ds_read_b128 v[188:191], v2 offset:1728
    s_waitcnt lgkmcnt(5)
    v_mfma_f32_16x16x32_bf16 v[152:155], v[20:23], v[192:195], v[152:155]
    v_mfma_f32_16x16x32_bf16 v[156:159], v[52:55], v[192:195], v[156:159]
    ds_read_b128 v[192:195], v2 offset:1792
    s_waitcnt lgkmcnt(5)
    v_mfma_f32_16x16x32_bf16 v[152:155], v[16:19], v[196:199], v[152:155]
    v_mfma_f32_16x16x32_bf16 v[156:159], v[48:51], v[196:199], v[156:159]
    v_mfma_f32_16x16x32_bf16 v[160:163], v[80:83], v[196:199], v[160:163]
    v_mfma_f32_16x16x32_bf16 v[212:215], v[196:199], v[128:131], 0
    v_mfma_f32_16x16x32_bf16 v[216:219], v[196:199], v[132:135], 0
    s_nop 3
    v_cvt_pk_bf16_f32 v10, v152, v153
    v_cvt_pk_bf16_f32 v11, v154, v155
    v_mfma_f32_16x16x32_bf16 v[224:227], v[196:199], v[140:143], 0
    ds_write_b64 v8, v[10:11] offset:1024
    v_mfma_f32_16x16x32_bf16 v[168:171], v[124:127], v[196:199], v[168:171]
    ds_read_b128 v[196:199], v2 offset:1856
    v_mfma_f32_16x16x32_bf16 v[204:207], v[200:203], v[128:131], 0
    v_cvt_pk_bf16_f32 v232, v212, v216
    v_cvt_pk_bf16_f32 v233, v213, v217
    v_mfma_f32_16x16x32_bf16 v[208:211], v[200:203], v[132:135], 0
    v_cvt_pk_bf16_f32 v234, v214, v218
    v_cvt_pk_bf16_f32 v235, v215, v219
    v_mfma_f32_16x16x32_bf16 v[220:223], v[200:203], v[136:139], 0
    ds_read_b128 v[200:203], v2 offset:1968
    s_waitcnt lgkmcnt(7)
    v_mfma_f32_16x16x32_bf16 v[156:159], v[44:47], v[176:179], v[156:159]
    v_mfma_f32_16x16x32_bf16 v[160:163], v[76:79], v[176:179], v[160:163]
    s_nop 0
    v_cvt_pk_bf16_f32 v228, v204, v208
    v_cvt_pk_bf16_f32 v229, v205, v209
    s_waitcnt lgkmcnt(6)
    v_mfma_f32_16x16x32_bf16 v[156:159], v[40:43], v[180:183], v[156:159]
    v_cvt_pk_bf16_f32 v230, v206, v210
    v_cvt_pk_bf16_f32 v231, v207, v211
    v_mfma_f32_16x16x32_bf16 v[160:163], v[72:75], v[180:183], v[160:163]
    v_cvt_pk_bf16_f32 v236, v220, v224
    v_cvt_pk_bf16_f32 v237, v221, v225
    v_mfma_f32_16x16x32_bf16 v[160:163], v[232:235], v[96:99], v[160:163]
    v_cvt_pk_bf16_f32 v238, v222, v226
    v_cvt_pk_bf16_f32 v239, v223, v227
    v_mfma_f32_16x16x32_bf16 v[164:167], v[232:235], v[100:103], v[164:167]
    ds_read_b128 v[176:179], v2 offset:1920
    ds_read_b128 v[180:183], v2 offset:1984
    v_mfma_f32_16x16x32_bf16 v[168:171], v[232:235], v[104:107], v[168:171]
    s_waitcnt lgkmcnt(7)
    v_mfma_f32_16x16x32_bf16 v[156:159], v[36:39], v[184:187], v[156:159]
    v_mfma_f32_16x16x32_bf16 v[160:163], v[68:71], v[184:187], v[160:163]
    ds_read_b128 v[184:187], v2 offset:2048
    v_mfma_f32_16x16x32_bf16 v[160:163], v[228:231], v[84:87], v[160:163]
    v_mfma_f32_16x16x32_bf16 v[164:167], v[228:231], v[88:91], v[164:167]
    v_mfma_f32_16x16x32_bf16 v[168:171], v[228:231], v[92:95], v[168:171]
    s_waitcnt lgkmcnt(7)
    v_mfma_f32_16x16x32_bf16 v[156:159], v[32:35], v[188:191], v[156:159]
    v_mfma_f32_16x16x32_bf16 v[160:163], v[64:67], v[188:191], v[160:163]
    ds_read_b128 v[188:191], v2 offset:2112
    v_mfma_f32_16x16x32_bf16 v[168:171], v[236:239], v[108:111], v[168:171]
    v_mfma_f32_16x16x32_bf16 v[172:175], v[236:239], v[112:115], v[172:175]
    s_waitcnt lgkmcnt(7)
    v_mfma_f32_16x16x32_bf16 v[156:159], v[28:31], v[192:195], v[156:159]
    v_mfma_f32_16x16x32_bf16 v[160:163], v[60:63], v[192:195], v[160:163]
    ds_read_b128 v[192:195], v2 offset:2176
    s_waitcnt lgkmcnt(6)
    v_mfma_f32_16x16x32_bf16 v[156:159], v[24:27], v[196:199], v[156:159]
    v_mfma_f32_16x16x32_bf16 v[160:163], v[56:59], v[196:199], v[160:163]
    ds_read_b128 v[196:199], v2 offset:2240
    s_waitcnt lgkmcnt(5)
    v_mfma_f32_16x16x32_bf16 v[156:159], v[20:23], v[176:179], v[156:159]
    v_mfma_f32_16x16x32_bf16 v[160:163], v[52:55], v[176:179], v[160:163]
    ds_read_b128 v[176:179], v2 offset:2304
    s_waitcnt lgkmcnt(5)
    v_mfma_f32_16x16x32_bf16 v[156:159], v[16:19], v[180:183], v[156:159]
    v_mfma_f32_16x16x32_bf16 v[160:163], v[48:51], v[180:183], v[160:163]
    v_mfma_f32_16x16x32_bf16 v[164:167], v[80:83], v[180:183], v[164:167]
    v_mfma_f32_16x16x32_bf16 v[212:215], v[180:183], v[128:131], 0
    v_mfma_f32_16x16x32_bf16 v[216:219], v[180:183], v[132:135], 0
    s_nop 3
    v_cvt_pk_bf16_f32 v10, v156, v157
    v_cvt_pk_bf16_f32 v11, v158, v159
    v_mfma_f32_16x16x32_bf16 v[224:227], v[180:183], v[140:143], 0
    ds_write_b64 v8, v[10:11] offset:1536
    v_mfma_f32_16x16x32_bf16 v[172:175], v[124:127], v[180:183], v[172:175]
    ds_read_b128 v[180:183], v2 offset:2368
    v_mfma_f32_16x16x32_bf16 v[204:207], v[200:203], v[128:131], 0
    v_cvt_pk_bf16_f32 v232, v212, v216
    v_cvt_pk_bf16_f32 v233, v213, v217
    v_mfma_f32_16x16x32_bf16 v[208:211], v[200:203], v[132:135], 0
    v_cvt_pk_bf16_f32 v234, v214, v218
    v_cvt_pk_bf16_f32 v235, v215, v219
    v_mfma_f32_16x16x32_bf16 v[220:223], v[200:203], v[136:139], 0
    s_waitcnt lgkmcnt(1)
    s_barrier
    ds_read_b64_tr_b16 v[12:13], v0 offset:1024
    v_mfma_f32_16x16x32_bf16 v[160:163], v[44:47], v[184:187], v[160:163]
    ds_read_b64_tr_b16 v[14:15], v0 offset:17664
    ds_read_b128 v[200:203], v2 offset:2480
    v_mfma_f32_16x16x32_bf16 v[164:167], v[76:79], v[184:187], v[164:167]
    v_cvt_pk_bf16_f32 v228, v204, v208
    v_cvt_pk_bf16_f32 v229, v205, v209
    v_mfma_f32_16x16x32_bf16 v[160:163], v[40:43], v[188:191], v[160:163]
    v_cvt_pk_bf16_f32 v230, v206, v210
    v_cvt_pk_bf16_f32 v231, v207, v211
    v_mfma_f32_16x16x32_bf16 v[164:167], v[72:75], v[188:191], v[164:167]
    ds_read_b128 v[184:187], v2 offset:2432
    v_cvt_pk_bf16_f32 v236, v220, v224
    v_mfma_f32_16x16x32_bf16 v[164:167], v[232:235], v[96:99], v[164:167]
    v_cvt_pk_bf16_f32 v237, v221, v225
    v_cvt_pk_bf16_f32 v238, v222, v226
    v_mfma_f32_16x16x32_bf16 v[168:171], v[232:235], v[100:103], v[168:171]
    v_cvt_pk_bf16_f32 v239, v223, v227
    s_waitcnt lgkmcnt(2)
    buffer_store_dwordx4 v[12:15], v1, s[32:35], s54 offen
    v_mfma_f32_16x16x32_bf16 v[172:175], v[232:235], v[104:107], v[172:175]
    ds_read_b128 v[188:191], v2 offset:2496
    v_mfma_f32_16x16x32_bf16 v[160:163], v[36:39], v[192:195], v[160:163]
    v_mfma_f32_16x16x32_bf16 v[164:167], v[68:71], v[192:195], v[164:167]
    ds_read_b128 v[192:195], v2 offset:2560
    v_mfma_f32_16x16x32_bf16 v[164:167], v[228:231], v[84:87], v[164:167]
    v_mfma_f32_16x16x32_bf16 v[168:171], v[228:231], v[88:91], v[168:171]
    v_mfma_f32_16x16x32_bf16 v[172:175], v[228:231], v[92:95], v[172:175]
    v_mfma_f32_16x16x32_bf16 v[160:163], v[32:35], v[196:199], v[160:163]
    v_mfma_f32_16x16x32_bf16 v[164:167], v[64:67], v[196:199], v[164:167]
    ds_read_b128 v[196:199], v2 offset:2624
    v_mfma_f32_16x16x32_bf16 v[172:175], v[236:239], v[108:111], v[172:175]
    v_mfma_f32_16x16x32_bf16 v[160:163], v[28:31], v[176:179], v[160:163]
    buffer_load_dwordx4 v[4:7], v3, s[36:39], 0 offen sc1
    v_mfma_f32_16x16x32_bf16 v[164:167], v[60:63], v[176:179], v[164:167]
    buffer_load_dwordx4 v[108:111], v9, s[36:39], 0 offen offset:0 sc1
    ds_read_b128 v[176:179], v2 offset:2688
    v_mfma_f32_16x16x32_bf16 v[160:163], v[24:27], v[180:183], v[160:163]
    buffer_load_dwordx4 v[112:115], v9, s[36:39], 0 offen offset:1024 sc1
    v_mfma_f32_16x16x32_bf16 v[164:167], v[56:59], v[180:183], v[164:167]
    buffer_load_dwordx4 v[116:119], v9, s[36:39], 0 offen offset:2048 sc1
    ds_read_b128 v[180:183], v2 offset:2752
    s_waitcnt lgkmcnt(5)
    v_mfma_f32_16x16x32_bf16 v[160:163], v[20:23], v[184:187], v[160:163]
    buffer_load_dwordx4 v[120:123], v9, s[36:39], 0 offen offset:3072 sc1
    v_mfma_f32_16x16x32_bf16 v[164:167], v[52:55], v[184:187], v[164:167]
    buffer_load_dwordx4 v[124:127], v9, s[36:39], s46 offen offset:0 sc1
    ds_read_b128 v[184:187], v2 offset:2816
    s_waitcnt lgkmcnt(5)
    v_mfma_f32_16x16x32_bf16 v[160:163], v[16:19], v[188:191], v[160:163]
    buffer_load_dwordx4 v[136:139], v9, s[36:39], s46 offen offset:1024 sc1
    v_mfma_f32_16x16x32_bf16 v[164:167], v[48:51], v[188:191], v[164:167]
    buffer_load_dwordx4 v[140:143], v9, s[36:39], s46 offen offset:2048 sc1
    v_mfma_f32_16x16x32_bf16 v[168:171], v[80:83], v[188:191], v[168:171]
    buffer_load_dwordx4 v[240:243], v9, s[36:39], s46 offen offset:3072 sc1
    v_mfma_f32_16x16x32_bf16 v[212:215], v[188:191], v[128:131], 0
    buffer_load_dwordx4 v[244:247], v9, s[36:39], s47 offen offset:0 sc1
    v_mfma_f32_16x16x32_bf16 v[216:219], v[188:191], v[132:135], 0
    buffer_load_dwordx4 v[248:251], v9, s[36:39], s47 offen offset:1024 sc1
    v_cvt_pk_bf16_f32 v10, v160, v161
    v_mfma_f32_16x16x32_bf16 v[204:207], v[200:203], v[128:131], 0
    buffer_load_dwordx4 v[252:255], v9, s[36:39], s47 offen offset:2048 sc1
    v_cvt_pk_bf16_f32 v11, v162, v163
    v_mfma_f32_16x16x32_bf16 v[208:211], v[200:203], v[132:135], 0
    buffer_load_dwordx4 v[220:223], v9, s[36:39], s47 offen offset:3072 sc1
    ds_write_b64 v8, v[10:11] offset:2048
    s_waitcnt lgkmcnt(5)
    v_mfma_f32_16x16x32_bf16 v[164:167], v[44:47], v[192:195], v[164:167]
    v_cvt_pk_bf16_f32 v232, v212, v216
    v_cvt_pk_bf16_f32 v233, v213, v217
    v_mfma_f32_16x16x32_bf16 v[168:171], v[76:79], v[192:195], v[168:171]
    v_cvt_pk_bf16_f32 v234, v214, v218
    v_cvt_pk_bf16_f32 v235, v215, v219
    s_waitcnt lgkmcnt(4)
    v_mfma_f32_16x16x32_bf16 v[164:167], v[40:43], v[196:199], v[164:167]
    buffer_load_dwordx4 v[224:227], v9, s[36:39], s48 offen offset:0 sc1
    buffer_load_dwordx4 v[236:239], v9, s[36:39], s48 offen offset:1024 sc1
    v_mfma_f32_16x16x32_bf16 v[168:171], v[72:75], v[196:199], v[168:171]
    v_cvt_pk_bf16_f32 v228, v204, v208
    v_cvt_pk_bf16_f32 v229, v205, v209
    v_mfma_f32_16x16x32_bf16 v[168:171], v[232:235], v[96:99], v[168:171]
    v_cvt_pk_bf16_f32 v230, v206, v210
    v_cvt_pk_bf16_f32 v231, v207, v211
    v_mfma_f32_16x16x32_bf16 v[172:175], v[232:235], v[100:103], v[172:175]
    ds_read_b128 v[188:191], v2 offset:2880
    ds_read_b128 v[192:195], v2 offset:2944
    s_waitcnt lgkmcnt(5)
    v_mfma_f32_16x16x32_bf16 v[164:167], v[36:39], v[176:179], v[164:167]
    ds_read_b128 v[196:199], v2 offset:3008
    ds_read_b128 v[200:203], v2 offset:2992
    v_mfma_f32_16x16x32_bf16 v[168:171], v[68:71], v[176:179], v[168:171]
    ds_read_b128 v[176:179], v2 offset:3072
    v_mfma_f32_16x16x32_bf16 v[168:171], v[228:231], v[84:87], v[168:171]
    v_mfma_f32_16x16x32_bf16 v[172:175], v[228:231], v[88:91], v[172:175]
    s_waitcnt lgkmcnt(7)
    v_mfma_f32_16x16x32_bf16 v[164:167], v[32:35], v[180:183], v[164:167]
    v_mfma_f32_16x16x32_bf16 v[168:171], v[64:67], v[180:183], v[168:171]
    ds_read_b128 v[180:183], v2 offset:3136
    s_waitcnt lgkmcnt(7)
    v_mfma_f32_16x16x32_bf16 v[164:167], v[28:31], v[184:187], v[164:167]
    v_mfma_f32_16x16x32_bf16 v[168:171], v[60:63], v[184:187], v[168:171]
    ds_read_b128 v[184:187], v2 offset:3200
    s_waitcnt lgkmcnt(6)
    v_mfma_f32_16x16x32_bf16 v[164:167], v[24:27], v[188:191], v[164:167]
    v_mfma_f32_16x16x32_bf16 v[168:171], v[56:59], v[188:191], v[168:171]
    ds_read_b128 v[188:191], v2 offset:3264
    s_waitcnt lgkmcnt(6)
    v_mfma_f32_16x16x32_bf16 v[164:167], v[20:23], v[192:195], v[164:167]
    v_mfma_f32_16x16x32_bf16 v[168:171], v[52:55], v[192:195], v[168:171]
    ds_read_b128 v[192:195], v2 offset:3328
    s_waitcnt lgkmcnt(6)
    v_mfma_f32_16x16x32_bf16 v[164:167], v[16:19], v[196:199], v[164:167]
    v_mfma_f32_16x16x32_bf16 v[168:171], v[48:51], v[196:199], v[168:171]
    v_mfma_f32_16x16x32_bf16 v[172:175], v[80:83], v[196:199], v[172:175]
    v_mfma_f32_16x16x32_bf16 v[212:215], v[196:199], v[128:131], 0
    v_mfma_f32_16x16x32_bf16 v[216:219], v[196:199], v[132:135], 0
    s_nop 3
    v_cvt_pk_bf16_f32 v10, v164, v165
    v_cvt_pk_bf16_f32 v11, v166, v167
    s_waitcnt lgkmcnt(5)
    v_mfma_f32_16x16x32_bf16 v[204:207], v[200:203], v[128:131], 0
    ds_read_b128 v[196:199], v2 offset:3392
    ds_write_b64 v8, v[10:11] offset:2560
    v_mfma_f32_16x16x32_bf16 v[208:211], v[200:203], v[132:135], 0
    s_waitcnt lgkmcnt(6)
    v_mfma_f32_16x16x32_bf16 v[168:171], v[44:47], v[176:179], v[168:171]
    v_cvt_pk_bf16_f32 v232, v212, v216
    v_cvt_pk_bf16_f32 v233, v213, v217
    v_mfma_f32_16x16x32_bf16 v[172:175], v[76:79], v[176:179], v[172:175]
    v_cvt_pk_bf16_f32 v234, v214, v218
    v_cvt_pk_bf16_f32 v235, v215, v219
    s_waitcnt lgkmcnt(5)
    v_mfma_f32_16x16x32_bf16 v[168:171], v[40:43], v[180:183], v[168:171]
    v_cvt_pk_bf16_f32 v228, v204, v208
    v_cvt_pk_bf16_f32 v229, v205, v209
    v_mfma_f32_16x16x32_bf16 v[172:175], v[72:75], v[180:183], v[172:175]
    v_cvt_pk_bf16_f32 v230, v206, v210
    v_cvt_pk_bf16_f32 v231, v207, v211
    v_mfma_f32_16x16x32_bf16 v[172:175], v[232:235], v[96:99], v[172:175]
    ds_read_b128 v[176:179], v2 offset:3456
    s_waitcnt lgkmcnt(1)
    s_barrier
    v_mfma_f32_16x16x32_bf16 v[168:171], v[36:39], v[184:187], v[168:171]
    ds_read_b128 v[180:183], v2 offset:3520
    ds_read_b64_tr_b16 v[12:13], v0 offset:2048
    v_mfma_f32_16x16x32_bf16 v[172:175], v[68:71], v[184:187], v[172:175]
    ds_read_b64_tr_b16 v[14:15], v0 offset:18688
    ds_read_b128 v[184:187], v2 offset:3584
    v_mfma_f32_16x16x32_bf16 v[172:175], v[228:231], v[84:87], v[172:175]
    s_waitcnt lgkmcnt(1)
    buffer_store_dwordx4 v[12:15], v1, s[32:35], s55 offen
    v_mfma_f32_16x16x32_bf16 v[168:171], v[32:35], v[188:191], v[168:171]
    v_mfma_f32_16x16x32_bf16 v[172:175], v[64:67], v[188:191], v[172:175]
    ds_read_b128 v[188:191], v2 offset:3648
    v_mfma_f32_16x16x32_bf16 v[168:171], v[28:31], v[192:195], v[168:171]
    v_mfma_f32_16x16x32_bf16 v[172:175], v[60:63], v[192:195], v[172:175]
    ds_read_b128 v[192:195], v2 offset:3712
    v_mfma_f32_16x16x32_bf16 v[168:171], v[24:27], v[196:199], v[168:171]
    v_mfma_f32_16x16x32_bf16 v[172:175], v[56:59], v[196:199], v[172:175]
    ds_read_b128 v[196:199], v2 offset:3776
    v_mfma_f32_16x16x32_bf16 v[168:171], v[20:23], v[176:179], v[168:171]
    v_mfma_f32_16x16x32_bf16 v[172:175], v[52:55], v[176:179], v[172:175]
    ds_read_b128 v[176:179], v2 offset:3840
    v_mfma_f32_16x16x32_bf16 v[168:171], v[16:19], v[180:183], v[168:171]
    v_mfma_f32_16x16x32_bf16 v[172:175], v[48:51], v[180:183], v[172:175]
    ds_read_b128 v[180:183], v2 offset:3904
    s_waitcnt lgkmcnt(5)
    v_mfma_f32_16x16x32_bf16 v[172:175], v[44:47], v[184:187], v[172:175]
    ds_read_b128 v[184:187], v2 offset:3968
    s_waitcnt lgkmcnt(5)
    v_mfma_f32_16x16x32_bf16 v[172:175], v[40:43], v[188:191], v[172:175]
    ds_read_b128 v[188:191], v2 offset:4032
    s_waitcnt lgkmcnt(5)
    v_mfma_f32_16x16x32_bf16 v[172:175], v[36:39], v[192:195], v[172:175]
    v_cvt_pk_bf16_f32 v10, v168, v169
    v_cvt_pk_bf16_f32 v11, v170, v171
    s_waitcnt lgkmcnt(4)
    v_mfma_f32_16x16x32_bf16 v[172:175], v[32:35], v[196:199], v[172:175]
    ds_write_b64 v8, v[10:11] offset:3072
    s_waitcnt lgkmcnt(4)
    v_mfma_f32_16x16x32_bf16 v[172:175], v[28:31], v[176:179], v[172:175]
    s_waitcnt lgkmcnt(3)
    v_mfma_f32_16x16x32_bf16 v[172:175], v[24:27], v[180:183], v[172:175]
    s_waitcnt lgkmcnt(2)
    v_mfma_f32_16x16x32_bf16 v[172:175], v[20:23], v[184:187], v[172:175]
    s_waitcnt lgkmcnt(1)
    v_mfma_f32_16x16x32_bf16 v[172:175], v[16:19], v[188:191], v[172:175]
    s_nop 7
    v_cvt_pk_bf16_f32 v10, v172, v173
    v_cvt_pk_bf16_f32 v11, v174, v175
    ds_write_b64 v8, v[10:11] offset:3584
    s_waitcnt lgkmcnt(0)
    s_barrier
    ds_read_b64_tr_b16 v[12:13], v0 offset:3072
    ds_read_b64_tr_b16 v[14:15], v0 offset:19712
    v_mbcnt_lo_u32_b32 v2, -1, 0
    v_mbcnt_hi_u32_b32 v2, -1, v2
    v_lshrrev_b32 v10, 4, v2
    v_lshlrev_b32 v10, 7, v10
    v_bfe_u32 v11, v2, 1, 1
    v_lshl_add_u32 v10, v11, 6, v10
    v_bfe_u32 v11, v2, 2, 2
    v_lshl_add_u32 v10, v11, 4, v10
    v_and_b32 v11, 1, v2
    v_lshl_add_u32 v10, v11, 3, v10
    s_mul_i32 s55, s45, 7168
    s_add_u32 s55, s55, 70144
    v_add_u32 v10, s55, v10
    ds_read_b64_tr_b16 v[16:17], v10 offset:0
    ds_read_b64_tr_b16 v[18:19], v10 offset:512
    ds_read_b64_tr_b16 v[20:21], v10 offset:1024
    ds_read_b64_tr_b16 v[22:23], v10 offset:1536
    ds_read_b64_tr_b16 v[24:25], v10 offset:2048
    ds_read_b64_tr_b16 v[26:27], v10 offset:2560
    ds_read_b64_tr_b16 v[28:29], v10 offset:3072
    ds_read_b64_tr_b16 v[30:31], v10 offset:3584
    ds_read_b64_tr_b16 v[32:33], v10 offset:4096
    ds_read_b64_tr_b16 v[34:35], v10 offset:4608
    ds_read_b64_tr_b16 v[36:37], v10 offset:5120
    ds_read_b64_tr_b16 v[38:39], v10 offset:5632
    ds_read_b64_tr_b16 v[40:41], v10 offset:6144
    ds_read_b64_tr_b16 v[42:43], v10 offset:6656
    s_waitcnt vmcnt(1)
    v_xor_b32 v11, s52, v7
    v_bitop3_b32 v11, v11, v111, s52 bitop3:0xf6
    v_bitop3_b32 v11, v11, v115, s52 bitop3:0xf6
    v_bitop3_b32 v11, v11, v119, s52 bitop3:0xf6
    v_bitop3_b32 v11, v11, v123, s52 bitop3:0xf6
    v_bitop3_b32 v11, v11, v127, s52 bitop3:0xf6
    v_bitop3_b32 v11, v11, v139, s52 bitop3:0xf6
    v_bitop3_b32 v11, v11, v143, s52 bitop3:0xf6
    v_bitop3_b32 v11, v11, v243, s52 bitop3:0xf6
    v_bitop3_b32 v11, v11, v247, s52 bitop3:0xf6
    v_bitop3_b32 v11, v11, v251, s52 bitop3:0xf6
    v_bitop3_b32 v11, v11, v255, s52 bitop3:0xf6
    v_bitop3_b32 v11, v11, v223, s52 bitop3:0xf6
    v_bitop3_b32 v11, v11, v227, s52 bitop3:0xf6
    v_bitop3_b32 v11, v11, v239, s52 bitop3:0xf6
    v_cmp_ne_u32 vcc, 0, v11
    s_cbranch_vccz L_conv_hok
    s_mov_b32 s43, 0
L_poll_h:
    buffer_load_dwordx4 v[4:7], v3, s[36:39], 0 offen sc1
    buffer_load_dwordx4 v[108:111], v9, s[36:39], 0 offen offset:0 sc1
    buffer_load_dwordx4 v[112:115], v9, s[36:39], 0 offen offset:1024 sc1
    buffer_load_dwordx4 v[116:119], v9, s[36:39], 0 offen offset:2048 sc1
    buffer_load_dwordx4 v[120:123], v9, s[36:39], 0 offen offset:3072 sc1
    buffer_load_dwordx4 v[124:127], v9, s[36:39], s46 offen offset:0 sc1
    buffer_load_dwordx4 v[136:139], v9, s[36:39], s46 offen offset:1024 sc1
    buffer_load_dwordx4 v[140:143], v9, s[36:39], s46 offen offset:2048 sc1
    buffer_load_dwordx4 v[240:243], v9, s[36:39], s46 offen offset:3072 sc1
    buffer_load_dwordx4 v[244:247], v9, s[36:39], s47 offen offset:0 sc1
    buffer_load_dwordx4 v[248:251], v9, s[36:39], s47 offen offset:1024 sc1
    buffer_load_dwordx4 v[252:255], v9, s[36:39], s47 offen offset:2048 sc1
    buffer_load_dwordx4 v[220:223], v9, s[36:39], s47 offen offset:3072 sc1
    buffer_load_dwordx4 v[224:227], v9, s[36:39], s48 offen offset:0 sc1
    buffer_load_dwordx4 v[236:239], v9, s[36:39], s48 offen offset:1024 sc1
    s_waitcnt vmcnt(0)
    v_xor_b32 v11, s52, v7
    v_bitop3_b32 v11, v11, v111, s52 bitop3:0xf6
    v_bitop3_b32 v11, v11, v115, s52 bitop3:0xf6
    v_bitop3_b32 v11, v11, v119, s52 bitop3:0xf6
    v_bitop3_b32 v11, v11, v123, s52 bitop3:0xf6
    v_bitop3_b32 v11, v11, v127, s52 bitop3:0xf6
    v_bitop3_b32 v11, v11, v139, s52 bitop3:0xf6
    v_bitop3_b32 v11, v11, v143, s52 bitop3:0xf6
    v_bitop3_b32 v11, v11, v243, s52 bitop3:0xf6
    v_bitop3_b32 v11, v11, v247, s52 bitop3:0xf6
    v_bitop3_b32 v11, v11, v251, s52 bitop3:0xf6
    v_bitop3_b32 v11, v11, v255, s52 bitop3:0xf6
    v_bitop3_b32 v11, v11, v223, s52 bitop3:0xf6
    v_bitop3_b32 v11, v11, v227, s52 bitop3:0xf6
    v_bitop3_b32 v11, v11, v239, s52 bitop3:0xf6
    v_cmp_ne_u32 vcc, 0, v11
    s_cbranch_vccz L_polled_h
    s_add_u32 s43, s43, 1
    s_cmp_ge_u32 s43, 65536
    s_cbranch_scc1 L_polled_h
    s_sleep 2
    s_branch L_poll_h
L_polled_h:
L_conv_hok:
    v_readlane_b32 s4, v4, 0
    v_readlane_b32 s5, v4, 8
    v_readlane_b32 s6, v4, 16
    v_readlane_b32 s7, v4, 24
    v_readlane_b32 s8, v4, 32
    v_readlane_b32 s9, v4, 40
    v_readlane_b32 s10, v4, 48
    v_readlane_b32 s11, v4, 56
    s_lshl_b32 s43, s45, 6
    s_add_u32 s43, s43, 1536
    v_add_u32 v11, s43, v2
    s_mov_b32 s43, 0x300000
    v_cmpx_ne_u32 vcc, s4, v11
    s_nop 4
    v_cmpx_ne_u32 vcc, s5, v11
    s_nop 4
    v_cmpx_ne_u32 vcc, s6, v11
    s_nop 4
    v_cmpx_ne_u32 vcc, s7, v11
    s_nop 4
    v_cmpx_ne_u32 vcc, s8, v11
    s_nop 4
    v_cmpx_ne_u32 vcc, s9, v11
    s_nop 4
    v_cmpx_ne_u32 vcc, s10, v11
    s_nop 4
    v_cmpx_ne_u32 vcc, s11, v11
    s_waitcnt lgkmcnt(14)
    s_nop 3
    buffer_store_dwordx4 v[12:15], v1, s[32:35], s43 offen
    s_mov_b64 exec, -1
    s_waitcnt lgkmcnt(13)
    v_mfma_f32_16x16x16_bf16 v[48:51], v[16:17], v[108:109], 0
    s_waitcnt lgkmcnt(12)
    v_mfma_f32_16x16x16_bf16 v[48:51], v[18:19], v[112:113], v[48:51]
    s_waitcnt lgkmcnt(11)
    v_mfma_f32_16x16x16_bf16 v[48:51], v[20:21], v[116:117], v[48:51]
    s_waitcnt lgkmcnt(10)
    v_mfma_f32_16x16x16_bf16 v[48:51], v[22:23], v[120:121], v[48:51]
    s_waitcnt lgkmcnt(9)
    v_mfma_f32_16x16x16_bf16 v[48:51], v[24:25], v[124:125], v[48:51]
    s_waitcnt lgkmcnt(8)
    v_mfma_f32_16x16x16_bf16 v[48:51], v[26:27], v[136:137], v[48:51]
    s_waitcnt lgkmcnt(7)
    v_mfma_f32_16x16x16_bf16 v[48:51], v[28:29], v[140:141], v[48:51]
    s_waitcnt lgkmcnt(6)
    v_mfma_f32_16x16x16_bf16 v[48:51], v[30:31], v[240:241], v[48:51]
    s_waitcnt lgkmcnt(5)
    v_mfma_f32_16x16x16_bf16 v[48:51], v[32:33], v[244:245], v[48:51]
    s_waitcnt lgkmcnt(4)
    v_mfma_f32_16x16x16_bf16 v[48:51], v[34:35], v[248:249], v[48:51]
    s_waitcnt lgkmcnt(3)
    v_mfma_f32_16x16x16_bf16 v[48:51], v[36:37], v[252:253], v[48:51]
    s_waitcnt lgkmcnt(2)
    v_mfma_f32_16x16x16_bf16 v[48:51], v[38:39], v[220:221], v[48:51]
    s_waitcnt lgkmcnt(1)
    v_mfma_f32_16x16x16_bf16 v[48:51], v[40:41], v[224:225], v[48:51]
    s_waitcnt lgkmcnt(0)
    v_mfma_f32_16x16x16_bf16 v[48:51], v[42:43], v[236:237], v[48:51]
    v_lshrrev_b32 v10, 5, v2
    v_lshlrev_b32 v10, 8, v10
    v_bfe_u32 v11, v2, 4, 1
    v_lshl_add_u32 v10, v11, 7, v10
    v_and_b32 v11, 7, v2
    v_lshl_add_u32 v10, v11, 4, v10
    s_lshl_b32 s43, s45, 9
    s_add_u32 s43, s43, 127488
    v_add_u32 v10, s43, v10
    s_mov_b32 exec_lo, 0x00ff00ff
    s_mov_b32 exec_hi, 0xff00ff00
    ds_write_b128 v10, v[48:51]
    s_mov_b64 exec, -1
    s_waitcnt vmcnt(1)
    s_waitcnt lgkmcnt(0)
    s_barrier
    s_cmp_lg_u32 s45, 0
    s_cbranch_scc1 L_conv_end
    v_bfe_u32 v10, v2, 2, 1
    v_lshlrev_b32 v10, 7, v10
    v_lshrrev_b32 v11, 3, v2
    v_lshl_add_u32 v10, v11, 4, v10
    v_and_b32 v11, 3, v2
    v_lshl_add_u32 v10, v11, 2, v10
    v_add_u32 v10, 127488, v10
    ds_read2st64_b32 v[16:17], v10 offset0:0 offset1:1
    ds_read2st64_b32 v[18:19], v10 offset0:2 offset1:3
    ds_read2st64_b32 v[20:21], v10 offset0:4 offset1:5
    ds_read2st64_b32 v[22:23], v10 offset0:6 offset1:7
    ds_read2st64_b32 v[24:25], v10 offset0:8 offset1:9
    ds_read2st64_b32 v[26:27], v10 offset0:10 offset1:11
    ds_read2st64_b32 v[28:29], v10 offset0:12 offset1:13
    ds_read2st64_b32 v[30:31], v10 offset0:14 offset1:15
    v_and_b32 v11, 7, v2
    v_mul_u32_u24 v12, 4160, v11
    v_lshl_add_u32 v12, v4, 1, v12
    v_add_u32 v12, 36864, v12
    ds_read_u16 v13, v12
    v_lshlrev_b32 v12, 11, v4
    v_lshl_add_u32 v12, v11, 1, v12
    v_add_u32 v12, s49, v12
    s_waitcnt lgkmcnt(0)
    v_pk_add_f32 v[16:17], v[16:17], v[24:25]
    v_pk_add_f32 v[18:19], v[18:19], v[26:27]
    v_pk_add_f32 v[20:21], v[20:21], v[28:29]
    v_pk_add_f32 v[22:23], v[22:23], v[30:31]
    v_pk_add_f32 v[16:17], v[16:17], v[20:21]
    v_pk_add_f32 v[18:19], v[18:19], v[22:23]
    v_pk_add_f32 v[16:17], v[16:17], v[18:19]
    v_lshlrev_b32 v13, 16, v13
    v_add_f32 v16, v16, v17
    v_fma_f32 v16, v16, v5, v13
    v_cvt_pk_bf16_f32 v16, v16, v16
    buffer_store_short v16, v12, s[32:35], 0 offen
L_conv_end:
    s_endpgm
.section .rodata,"a"
.p2align 6
.amdhsa_kernel parallel_sum__ssm_conv_s4d__moe_arch_mod__prompt_kernel
  .amdhsa_next_free_vgpr 256
  .amdhsa_next_free_sgpr 96
  .amdhsa_accum_offset 256
  .amdhsa_group_segment_fixed_size 0
  .amdhsa_kernarg_size 120
  .amdhsa_user_sgpr_count 2
  .amdhsa_user_sgpr_kernarg_segment_ptr 1
  .amdhsa_system_sgpr_workgroup_id_x 1
.end_amdhsa_kernel
```

```asm
; @launch grid=(256,1,1) block=(512,1,1) lds=149136
.amdgcn_target "amdgcn-amd-amdhsa--gfx950"
.text
.globl parallel_sum__ssm_conv_s4d__moe_arch_mod__prompt_kernel
.p2align 8
.type parallel_sum__ssm_conv_s4d__moe_arch_mod__prompt_kernel,@function
parallel_sum__ssm_conv_s4d__moe_arch_mod__prompt_kernel:
    s_cmp_ge_u32 s2, 256
    s_cbranch_scc1 L_exit
    s_bfe_u32 s3, s2, 0x40003
    s_bitcmp1_b32 s2, 7
    s_cbranch_scc0 L_auxk
    s_load_dwordx2 s[8:9], s[0:1], 8
    s_load_dwordx2 s[12:13], s[0:1], 16
    s_load_dwordx2 s[16:17], s[0:1], 24
    s_load_dwordx2 s[20:21], s[0:1], 32
    s_load_dwordx2 s[24:25], s[0:1], 40
    s_load_dwordx2 s[28:29], s[0:1], 48
    s_load_dwordx2 s[4:5], s[0:1], 0
    s_load_dwordx2 s[32:33], s[0:1], 96
    s_load_dwordx2 s[36:37], s[0:1], 112
    s_branch L_conv
L_auxk:
    s_load_dwordx2 s[4:5], s[0:1], 0
    s_load_dwordx2 s[8:9], s[0:1], 64
    s_load_dwordx2 s[12:13], s[0:1], 112
    s_load_dwordx2 s[16:17], s[0:1], 72
    s_load_dwordx2 s[20:21], s[0:1], 80
    s_load_dwordx2 s[24:25], s[0:1], 88
L_aux_code:
    s_and_b32 s50, s2, 7
    s_lshl_b32 s30, s50, 4
    s_add_u32 s30, s30, s3
    s_and_b32 s44, s3, 1
    s_cmp_ge_u32 s3, 3
    s_addc_u32 s38, s3, 0
    s_cmp_ge_u32 s3, 10
    s_addc_u32 s38, s38, 0
    s_cmp_eq_u32 s3, 14
    s_cselect_b32 s38, 3, s38
    s_cmp_eq_u32 s3, 15
    s_cselect_b32 s38, 11, s38
    v_and_b32 v1, 63, v0
    v_and_b32 v2, 15, v0
    v_bfe_u32 v3, v0, 4, 2
    v_lshrrev_b32 v29, 6, v0
    s_nop 0
    v_readfirstlane_b32 s31, v29
    v_lshlrev_b32 v28, 4, v1
    s_lshl_b32 s32, s30, 15
    v_lshlrev_b32 v30, 13, v29
    v_add3_u32 v30, v30, v28, s32
    v_mov_b32 v22, 148624
    v_mov_b32 v23, 1
    s_cmp_ge_u32 s31, 4
    s_cbranch_scc1 L_aux_sinit
    s_setprio 2
    s_mov_b32 s33, 4096
    s_waitcnt lgkmcnt(0)
    s_load_dword s28, s[12:13], 0
    s_mov_b32 s6, 4194304
    s_mov_b32 s7, 0x00020000
    s_mov_b32 s10, 2048
    s_mov_b32 s11, 0x00020000
    buffer_load_dwordx4 v[32:35], v30, s[4:7], 0 offen offset:0 nt
    buffer_load_dwordx4 v[36:39], v30, s[4:7], 0 offen offset:1024 nt
    buffer_load_dwordx4 v[40:43], v30, s[4:7], 0 offen offset:2048 nt
    buffer_load_dwordx4 v[44:47], v30, s[4:7], 0 offen offset:3072 nt
    buffer_load_dwordx4 v[48:51], v30, s[4:7], s33 offen offset:0 nt
    buffer_load_dwordx4 v[52:55], v30, s[4:7], s33 offen offset:1024 nt
    buffer_load_dwordx4 v[56:59], v30, s[4:7], s33 offen offset:2048 nt
    buffer_load_dwordx4 v[60:63], v30, s[4:7], s33 offen offset:3072 nt
    buffer_load_dwordx4 v[64:67], v28, s[8:11], 0 offen offset:0
    buffer_load_dwordx4 v[68:71], v28, s[8:11], 0 offen offset:1024
    s_mov_b32 s14, 753664
    s_mov_b32 s15, 0x00020000
    s_mov_b32 s26, 7340032
    s_mov_b32 s27, 0x00020000
    s_barrier
    v_lshlrev_b32 v12, 4, v0
    v_add_u32 v12, 4096, v12
    v_lshlrev_b32 v13, 2, v0
    v_sub_u32 v13, 0x800, v13
    v_subrev_u32 v88, 0, v13
    v_subrev_u32 v89, 1, v13
    v_subrev_u32 v90, 1024, v13
    v_subrev_u32 v91, 1025, v13
    v_subrev_u32 v92, 2, v13
    v_subrev_u32 v93, 3, v13
    v_subrev_u32 v94, 1026, v13
    v_subrev_u32 v95, 1027, v13
    s_mov_b32 s40, 4096
    s_mov_b32 s41, 8192
    s_mov_b32 s42, 12288
    s_mov_b32 s45, 0xffff0000
    v_lshrrev_b32 v24, 4, v0
    v_lshl_add_u32 v24, v24, 2, v22
    v_lshl_add_u32 v25, v2, 2, v22
    v_and_b32 v26, 31, v1
    v_lshl_add_u32 v26, v26, 2, v22
    v_lshrrev_b32 v27, 5, v1
    v_lshl_add_u32 v27, v27, 6, v22
    s_lshl_b32 s47, s31, 5
    s_add_u32 s47, s47, 148688
    v_lshl_add_u32 v31, v1, 2, s47
    s_lshl_b32 s32, s30, 6
    s_add_u32 s32, s32, 4096
    v_bfe_u32 v11, v1, 2, 1
    v_lshlrev_b32 v11, 13, v11
    v_and_b32 v10, 3, v1
    v_lshl_add_u32 v11, v10, 4, v11
    v_add_u32 v11, s32, v11
    s_lshl_b32 s32, s31, 4
    s_add_u32 s32, s32, 148944
    v_lshlrev_b32 v10, 6, v3
    v_add_u32 v10, s32, v10
    v_lshl_add_u32 v9, v1, 4, v22
    s_mov_b32 s33, 0x3f803f80
    s_waitcnt vmcnt(2)
    v_dot2_f32_bf16 v72, s33, v32, 0
    v_dot2_f32_bf16 v76, v32, v32, 0
    v_dot2_f32_bf16 v73, s33, v40, 0
    v_dot2_f32_bf16 v77, v40, v40, 0
    v_dot2_f32_bf16 v74, s33, v48, 0
    v_dot2_f32_bf16 v78, v48, v48, 0
    v_dot2_f32_bf16 v75, s33, v56, 0
    v_dot2_f32_bf16 v79, v56, v56, 0
    v_dot2c_f32_bf16 v72, s33, v33
    v_dot2c_f32_bf16 v76, v33, v33
    v_dot2c_f32_bf16 v73, s33, v41
    v_dot2c_f32_bf16 v77, v41, v41
    v_dot2c_f32_bf16 v74, s33, v49
    v_dot2c_f32_bf16 v78, v49, v49
    v_dot2c_f32_bf16 v75, s33, v57
    v_dot2c_f32_bf16 v79, v57, v57
    v_dot2c_f32_bf16 v72, s33, v34
    v_dot2c_f32_bf16 v76, v34, v34
    v_dot2c_f32_bf16 v73, s33, v42
    v_dot2c_f32_bf16 v77, v42, v42
    v_dot2c_f32_bf16 v74, s33, v50
    v_dot2c_f32_bf16 v78, v50, v50
    v_dot2c_f32_bf16 v75, s33, v58
    v_dot2c_f32_bf16 v79, v58, v58
    v_dot2c_f32_bf16 v72, s33, v35
    v_dot2c_f32_bf16 v76, v35, v35
    v_dot2c_f32_bf16 v73, s33, v43
    v_dot2c_f32_bf16 v77, v43, v43
    v_dot2c_f32_bf16 v74, s33, v51
    v_dot2c_f32_bf16 v78, v51, v51
    v_dot2c_f32_bf16 v75, s33, v59
    v_dot2c_f32_bf16 v79, v59, v59
    v_dot2c_f32_bf16 v72, s33, v36
    v_dot2c_f32_bf16 v76, v36, v36
    v_dot2c_f32_bf16 v73, s33, v44
    v_dot2c_f32_bf16 v77, v44, v44
    v_dot2c_f32_bf16 v74, s33, v52
    v_dot2c_f32_bf16 v78, v52, v52
    v_dot2c_f32_bf16 v75, s33, v60
    v_dot2c_f32_bf16 v79, v60, v60
    v_dot2c_f32_bf16 v72, s33, v37
    v_dot2c_f32_bf16 v76, v37, v37
    v_dot2c_f32_bf16 v73, s33, v45
    v_dot2c_f32_bf16 v77, v45, v45
    v_dot2c_f32_bf16 v74, s33, v53
    v_dot2c_f32_bf16 v78, v53, v53
    v_dot2c_f32_bf16 v75, s33, v61
    v_dot2c_f32_bf16 v79, v61, v61
    v_dot2c_f32_bf16 v72, s33, v38
    v_dot2c_f32_bf16 v76, v38, v38
    v_dot2c_f32_bf16 v73, s33, v46
    v_dot2c_f32_bf16 v77, v46, v46
    v_dot2c_f32_bf16 v74, s33, v54
    v_dot2c_f32_bf16 v78, v54, v54
    v_dot2c_f32_bf16 v75, s33, v62
    v_dot2c_f32_bf16 v79, v62, v62
    v_dot2c_f32_bf16 v72, s33, v39
    v_dot2c_f32_bf16 v76, v39, v39
    v_dot2c_f32_bf16 v73, s33, v47
    v_dot2c_f32_bf16 v77, v47, v47
    v_dot2c_f32_bf16 v74, s33, v55
    v_dot2c_f32_bf16 v78, v55, v55
    v_dot2c_f32_bf16 v75, s33, v63
    v_dot2c_f32_bf16 v79, v63, v63
    s_waitcnt vmcnt(0)
    v_dot2_f32_bf16 v80, v64, v32, 0
    v_dot2_f32_bf16 v81, v64, v40, 0
    v_dot2_f32_bf16 v82, v64, v48, 0
    v_dot2_f32_bf16 v83, v64, v56, 0
    v_dot2_f32_bf16 v84, s33, v64, 0
    v_dot2c_f32_bf16 v80, v65, v33
    v_dot2c_f32_bf16 v81, v65, v41
    v_dot2c_f32_bf16 v82, v65, v49
    v_dot2c_f32_bf16 v83, v65, v57
    v_dot2c_f32_bf16 v84, s33, v65
    v_dot2c_f32_bf16 v80, v66, v34
    v_dot2c_f32_bf16 v81, v66, v42
    v_dot2c_f32_bf16 v82, v66, v50
    v_dot2c_f32_bf16 v83, v66, v58
    v_dot2c_f32_bf16 v84, s33, v66
    v_dot2c_f32_bf16 v80, v67, v35
    v_dot2c_f32_bf16 v81, v67, v43
    v_dot2c_f32_bf16 v82, v67, v51
    v_dot2c_f32_bf16 v83, v67, v59
    v_dot2c_f32_bf16 v84, s33, v67
    v_dot2c_f32_bf16 v80, v68, v36
    v_dot2c_f32_bf16 v81, v68, v44
    v_dot2c_f32_bf16 v82, v68, v52
    v_dot2c_f32_bf16 v83, v68, v60
    v_dot2c_f32_bf16 v84, s33, v68
    v_dot2c_f32_bf16 v80, v69, v37
    v_dot2c_f32_bf16 v81, v69, v45
    v_dot2c_f32_bf16 v82, v69, v53
    v_dot2c_f32_bf16 v83, v69, v61
    v_dot2c_f32_bf16 v84, s33, v69
    v_dot2c_f32_bf16 v80, v70, v38
    v_dot2c_f32_bf16 v81, v70, v46
    v_dot2c_f32_bf16 v82, v70, v54
    v_dot2c_f32_bf16 v83, v70, v62
    v_dot2c_f32_bf16 v84, s33, v70
    v_dot2c_f32_bf16 v80, v71, v39
    v_dot2c_f32_bf16 v81, v71, v47
    v_dot2c_f32_bf16 v82, v71, v55
    v_dot2c_f32_bf16 v83, v71, v63
    v_dot2c_f32_bf16 v84, s33, v71
    s_nop 2
    v_mov_b32 v85, v84
    v_permlane32_swap_b32 v72, v73
    v_permlane32_swap_b32 v74, v75
    v_permlane32_swap_b32 v76, v77
    v_permlane32_swap_b32 v78, v79
    v_permlane32_swap_b32 v80, v81
    v_permlane32_swap_b32 v82, v83
    v_permlane32_swap_b32 v84, v85
    v_add_f32 v72, v72, v73
    v_add_f32 v74, v74, v75
    v_add_f32 v76, v76, v77
    v_add_f32 v78, v78, v79
    v_add_f32 v80, v80, v81
    v_add_f32 v82, v82, v83
    v_add_f32 v84, v84, v85
    v_mov_b32 v86, v84
    v_permlane16_swap_b32 v72, v74
    v_permlane16_swap_b32 v76, v78
    v_permlane16_swap_b32 v80, v82
    v_permlane16_swap_b32 v84, v86
    v_add_f32 v72, v72, v74
    v_add_f32 v76, v76, v78
    v_add_f32 v80, v80, v82
    v_add_f32 v84, v84, v86
    v_add_f32_dpp v72, v72, v72 row_ror:8 row_mask:0xf bank_mask:0xf
    v_add_f32_dpp v76, v76, v76 row_ror:8 row_mask:0xf bank_mask:0xf
    v_add_f32_dpp v80, v80, v80 row_ror:8 row_mask:0xf bank_mask:0xf
    v_add_f32_dpp v84, v84, v84 row_ror:8 row_mask:0xf bank_mask:0xf
    v_add_f32_dpp v72, v72, v72 row_ror:4 row_mask:0xf bank_mask:0xf
    v_add_f32_dpp v76, v76, v76 row_ror:4 row_mask:0xf bank_mask:0xf
    v_add_f32_dpp v80, v80, v80 row_ror:4 row_mask:0xf bank_mask:0xf
    v_add_f32_dpp v84, v84, v84 row_ror:4 row_mask:0xf bank_mask:0xf
    v_add_f32_dpp v72, v72, v72 row_ror:2 row_mask:0xf bank_mask:0xf
    v_add_f32_dpp v76, v76, v76 row_ror:2 row_mask:0xf bank_mask:0xf
    v_add_f32_dpp v80, v80, v80 row_ror:2 row_mask:0xf bank_mask:0xf
    v_add_f32_dpp v84, v84, v84 row_ror:2 row_mask:0xf bank_mask:0xf
    v_add_f32_dpp v72, v72, v72 row_ror:1 row_mask:0xf bank_mask:0xf
    v_add_f32_dpp v76, v76, v76 row_ror:1 row_mask:0xf bank_mask:0xf
    v_add_f32_dpp v80, v80, v80 row_ror:1 row_mask:0xf bank_mask:0xf
    v_add_f32_dpp v84, v84, v84 row_ror:1 row_mask:0xf bank_mask:0xf
    v_mul_f32 v42, 0x3a800000, v72
    v_mul_f32 v43, 0x3a800000, v76
    v_fma_f32 v43, -v42, v42, v43
    v_max_f32 v43, 0, v43
    v_cvt_pk_bf16_f32 v42, v42, v43
    v_and_b32 v43, 0xffff0000, v42
    v_lshlrev_b32 v45, 16, v42
    v_add_f32 v43, 0x3727c5ac, v43
    v_cvt_pk_bf16_f32 v43, v43, v43
    v_and_b32 v43, 0xffff0000, v43
    v_sqrt_f32 v43, v43
    v_fma_f32 v44, -v45, v84, v80
    v_cvt_pk_bf16_f32 v60, v45, v43
    v_and_b32 v43, 0xffff0000, v60
    v_rcp_f32 v46, v43
    v_mov_b32 v61, v60
    s_waitcnt lgkmcnt(0)
    s_mul_i32 s29, s28, 0x9e3779b1
    s_add_u32 s29, s29, 0x7f4a7c15
    v_mul_f32 v44, v44, v46
    v_cvt_pk_bf16_f32 v64, v44, v44
    v_ashrrev_i32 v65, 31, v64
    v_or_b32 v65, 0x80000000, v65
    v_xor_b32 v64, v64, v65
    v_permlane32_swap_b32 v60, v61
    v_lshrrev_b32 v64, 16, v64
    v_mov_b32 v63, s29
    v_mov_b32 v65, v64
    s_nop 1
    v_permlane32_swap_b32 v64, v65
    v_lshl_or_b32 v62, v65, 16, v64
    s_mov_b64 exec, 0x10001
    ds_write_b128 v10, v[60:63]
    s_mov_b64 exec, 1
    ds_add_rtn_u32 v13, v22, v23 offset:264
    s_mov_b64 exec, 0xff
    ds_read_b128 v[60:63], v9 offset:320
    s_waitcnt lgkmcnt(0)
    v_readfirstlane_b32 s32, v13
    s_cmp_lg_u32 s32, 3
    s_cbranch_scc1 L_aux_nopub
    buffer_store_dwordx4 v[60:63], v11, s[12:15], 0 offen sc1
L_aux_nopub:
    s_mov_b64 exec, -1
    s_sleep 40
    buffer_load_dwordx4 v[64:67], v12, s[12:15], 0 offen sc1
    buffer_load_dwordx4 v[68:71], v12, s[12:15], s40 offen sc1
    buffer_load_dwordx4 v[72:75], v12, s[12:15], s41 offen sc1
    buffer_load_dwordx4 v[76:79], v12, s[12:15], s42 offen sc1
    s_mov_b32 s43, 0
L_poll_aux:
    s_waitcnt vmcnt(0)
    v_cmp_ne_u32 s[52:53], s29, v67
    v_cmp_ne_u32 s[54:55], s29, v71
    v_cmp_ne_u32 s[56:57], s29, v75
    v_cmp_ne_u32 s[58:59], s29, v79
    s_or_b64 vcc, s[52:53], s[54:55]
    s_or_b64 vcc, vcc, s[56:57]
    s_or_b64 vcc, vcc, s[58:59]
    s_cbranch_scc0 L_polled_aux
    s_add_u32 s43, s43, 1
    s_cmp_ge_u32 s43, 65536
    s_cbranch_scc1 L_polled_aux
    s_sleep 2
    s_mov_b64 exec, s[52:53]
    s_cbranch_execz L_ps_aux_0
    buffer_load_dwordx4 v[64:67], v12, s[12:15], 0 offen sc1
L_ps_aux_0:
    s_mov_b64 exec, s[54:55]
    s_cbranch_execz L_ps_aux_1
    buffer_load_dwordx4 v[68:71], v12, s[12:15], s40 offen sc1
L_ps_aux_1:
    s_mov_b64 exec, s[56:57]
    s_cbranch_execz L_ps_aux_2
    buffer_load_dwordx4 v[72:75], v12, s[12:15], s41 offen sc1
L_ps_aux_2:
    s_mov_b64 exec, s[58:59]
    s_cbranch_execz L_ps_aux_3
    buffer_load_dwordx4 v[76:79], v12, s[12:15], s42 offen sc1
L_ps_aux_3:
    s_mov_b64 exec, -1
    s_branch L_poll_aux
L_polled_aux:
    v_lshl_or_b32 v80, v66, 16, v88
    v_and_or_b32 v81, v66, s45, v89
    v_lshl_or_b32 v82, v70, 16, v90
    v_and_or_b32 v83, v70, s45, v91
    v_lshl_or_b32 v84, v74, 16, v92
    v_and_or_b32 v85, v74, s45, v93
    v_lshl_or_b32 v86, v78, 16, v94
    v_and_or_b32 v87, v78, s45, v95
    v_max3_u32 v17, v80, v81, v82
    v_max3_u32 v18, v83, v84, v85
    v_max3_u32 v17, v17, v86, v87
    v_max_u32 v17, v17, v18
    v_max_u32 v14, v80, v81
    v_min_u32 v15, v80, v81
    v_max_u32_dpp v17, v17, v17 row_ror:8 row_mask:0xf bank_mask:0xf
    v_mov_b32 v16, 0
    v_med3_u32 v16, v15, v16, v82
    v_max_u32_dpp v17, v17, v17 row_ror:4 row_mask:0xf bank_mask:0xf
    v_med3_u32 v15, v14, v15, v82
    v_max_u32 v14, v14, v82
    v_max_u32_dpp v17, v17, v17 row_ror:2 row_mask:0xf bank_mask:0xf
    v_med3_u32 v16, v15, v16, v83
    v_med3_u32 v15, v14, v15, v83
    v_max_u32_dpp v17, v17, v17 row_ror:1 row_mask:0xf bank_mask:0xf
    ds_write_b32 v24, v17
    ds_read_b32 v17, v25
    v_max_u32 v14, v14, v83
    v_med3_u32 v16, v15, v16, v84
    v_med3_u32 v15, v14, v15, v84
    v_max_u32 v14, v14, v84
    v_med3_u32 v16, v15, v16, v85
    v_med3_u32 v15, v14, v15, v85
    v_max_u32 v14, v14, v85
    v_med3_u32 v16, v15, v16, v86
    v_med3_u32 v15, v14, v15, v86
    v_max_u32 v14, v14, v86
    v_med3_u32 v16, v15, v16, v87
    v_med3_u32 v15, v14, v15, v87
    v_max_u32 v14, v14, v87
    v_mov_b32 v19, 0
    s_mov_b32 s43, 0
L_aux_gm:
    s_waitcnt lgkmcnt(0)
    v_cmp_eq_u32 vcc, 0, v17
    s_cbranch_vccz L_aux_gmok
    ds_read_b32 v17, v25
    s_add_u32 s43, s43, 1
    s_cmp_ge_u32 s43, 524288
    s_cbranch_scc1 L_aux_gmok
    s_branch L_aux_gm
L_aux_gmok:
    s_waitcnt lgkmcnt(0)
    v_sub_co_u32_dpp v20, vcc, v17, v17 row_ror:1 row_mask:0xf bank_mask:0xf
    v_addc_co_u32 v19, vcc, 0, v19, vcc
    v_sub_co_u32_dpp v20, vcc, v17, v17 row_ror:2 row_mask:0xf bank_mask:0xf
    v_addc_co_u32 v19, vcc, 0, v19, vcc
    v_sub_co_u32_dpp v20, vcc, v17, v17 row_ror:3 row_mask:0xf bank_mask:0xf
    v_addc_co_u32 v19, vcc, 0, v19, vcc
    v_sub_co_u32_dpp v20, vcc, v17, v17 row_ror:4 row_mask:0xf bank_mask:0xf
    v_addc_co_u32 v19, vcc, 0, v19, vcc
    v_sub_co_u32_dpp v20, vcc, v17, v17 row_ror:5 row_mask:0xf bank_mask:0xf
    v_addc_co_u32 v19, vcc, 0, v19, vcc
    v_sub_co_u32_dpp v20, vcc, v17, v17 row_ror:6 row_mask:0xf bank_mask:0xf
    v_addc_co_u32 v19, vcc, 0, v19, vcc
    v_sub_co_u32_dpp v20, vcc, v17, v17 row_ror:7 row_mask:0xf bank_mask:0xf
    v_addc_co_u32 v19, vcc, 0, v19, vcc
    v_sub_co_u32_dpp v20, vcc, v17, v17 row_ror:8 row_mask:0xf bank_mask:0xf
    v_addc_co_u32 v19, vcc, 0, v19, vcc
    v_sub_co_u32_dpp v20, vcc, v17, v17 row_ror:9 row_mask:0xf bank_mask:0xf
    v_addc_co_u32 v19, vcc, 0, v19, vcc
    v_sub_co_u32_dpp v20, vcc, v17, v17 row_ror:10 row_mask:0xf bank_mask:0xf
    v_addc_co_u32 v19, vcc, 0, v19, vcc
    v_sub_co_u32_dpp v20, vcc, v17, v17 row_ror:11 row_mask:0xf bank_mask:0xf
    v_addc_co_u32 v19, vcc, 0, v19, vcc
    v_sub_co_u32_dpp v20, vcc, v17, v17 row_ror:12 row_mask:0xf bank_mask:0xf
    v_addc_co_u32 v19, vcc, 0, v19, vcc
    v_sub_co_u32_dpp v20, vcc, v17, v17 row_ror:13 row_mask:0xf bank_mask:0xf
    v_addc_co_u32 v19, vcc, 0, v19, vcc
    v_sub_co_u32_dpp v20, vcc, v17, v17 row_ror:14 row_mask:0xf bank_mask:0xf
    v_addc_co_u32 v19, vcc, 0, v19, vcc
    v_sub_co_u32_dpp v20, vcc, v17, v17 row_ror:15 row_mask:0xf bank_mask:0xf
    v_addc_co_u32 v19, vcc, 0, v19, vcc
    v_cmp_eq_u32 vcc, 8, v19
    s_ff1_i32_b64 s46, vcc
    v_readlane_b32 s46, v17, s46
    v_mov_b32 v18, 1
    s_nop 0
    v_cmp_le_u32 s[48:49], s46, v14
    v_cmp_le_u32 s[52:53], s46, v15
    v_cmp_le_u32 s[54:55], s46, v16
    s_bcnt1_i32_b64 s46, s[48:49]
    s_bcnt1_i32_b64 s56, s[52:53]
    v_mbcnt_lo_u32_b32 v20, s48, 0
    v_mbcnt_lo_u32_b32 v21, s52, 0
    v_mbcnt_hi_u32_b32 v20, s49, v20
    v_mbcnt_hi_u32_b32 v21, s53, v21
    s_add_u32 s56, s56, s46
    s_lshl_b32 s46, s46, 2
    s_add_u32 s46, s46, s47
    v_lshl_add_u32 v20, v20, 2, s47
    v_lshl_add_u32 v21, v21, 2, s46
    s_cmp_lg_u64 s[54:55], 0
    s_cselect_b32 s56, 9, s56
    s_cmp_gt_u32 s56, 8
    s_cbranch_scc0 L_aux_fit
    s_mov_b64 s[48:49], 0
    s_mov_b64 s[52:53], 0
    s_mov_b32 s56, 0
    v_mov_b32 v18, 2
L_aux_fit:
    s_lshl_b32 s56, 0xff, s56
    s_and_b32 s56, s56, 0xff
    s_mov_b32 s57, 0
    s_mov_b64 exec, s[48:49]
    ds_write_b32 v20, v14
    s_mov_b64 exec, s[52:53]
    ds_write_b32 v21, v15
    s_mov_b64 exec, s[56:57]
    ds_write_b32 v31, v18
    s_mov_b64 exec, -1
    s_mov_b32 s43, 0
    v_mov_b32 v20, 0
L_aux_ls:
    ds_read_b32 v17, v26 offset:64
    ds_read_b128 v[64:67], v27 offset:64
    ds_read_b128 v[68:71], v27 offset:80
    ds_read_b128 v[72:75], v27 offset:96
    ds_read_b128 v[76:79], v27 offset:112
    s_waitcnt lgkmcnt(4)
    v_cmp_eq_u32 vcc, 0, v17
    s_cbranch_vccz L_aux_lsok
    s_waitcnt lgkmcnt(0)
    s_add_u32 s43, s43, 1
    s_cmp_ge_u32 s43, 524288
    s_cbranch_scc1 L_aux_lsok
    s_branch L_aux_ls
L_aux_lsok:
    v_cmp_eq_u32 vcc, 2, v17
    s_cbranch_vccnz L_aux_slow
    s_waitcnt lgkmcnt(3)
    v_cmp_gt_u32 vcc, v64, v17
    v_addc_co_u32 v20, vcc, 0, v20, vcc
    v_cmp_gt_u32 vcc, v65, v17
    v_addc_co_u32 v20, vcc, 0, v20, vcc
    v_cmp_gt_u32 vcc, v66, v17
    v_addc_co_u32 v20, vcc, 0, v20, vcc
    v_cmp_gt_u32 vcc, v67, v17
    v_addc_co_u32 v20, vcc, 0, v20, vcc
    s_waitcnt lgkmcnt(2)
    v_cmp_gt_u32 vcc, v68, v17
    v_addc_co_u32 v20, vcc, 0, v20, vcc
    v_cmp_gt_u32 vcc, v69, v17
    v_addc_co_u32 v20, vcc, 0, v20, vcc
    v_cmp_gt_u32 vcc, v70, v17
    v_addc_co_u32 v20, vcc, 0, v20, vcc
    v_cmp_gt_u32 vcc, v71, v17
    v_addc_co_u32 v20, vcc, 0, v20, vcc
    s_waitcnt lgkmcnt(1)
    v_cmp_gt_u32 vcc, v72, v17
    v_addc_co_u32 v20, vcc, 0, v20, vcc
    v_cmp_gt_u32 vcc, v73, v17
    v_addc_co_u32 v20, vcc, 0, v20, vcc
    v_cmp_gt_u32 vcc, v74, v17
    v_addc_co_u32 v20, vcc, 0, v20, vcc
    v_cmp_gt_u32 vcc, v75, v17
    v_addc_co_u32 v20, vcc, 0, v20, vcc
    s_waitcnt lgkmcnt(0)
    v_cmp_gt_u32 vcc, v76, v17
    v_addc_co_u32 v20, vcc, 0, v20, vcc
    v_cmp_gt_u32 vcc, v77, v17
    v_addc_co_u32 v20, vcc, 0, v20, vcc
    v_cmp_gt_u32 vcc, v78, v17
    v_addc_co_u32 v20, vcc, 0, v20, vcc
    v_cmp_gt_u32 vcc, v79, v17
    v_addc_co_u32 v20, vcc, 0, v20, vcc
    s_lshl_b32 s46, s31, 1
    s_add_u32 s47, s46, 1
    v_mov_b32 v21, v20
    s_nop 1
    v_permlane32_swap_b32 v20, v21
    v_add_u32 v20, v20, v21
    v_cmp_eq_u32 s[48:49], s46, v20
    v_cmp_eq_u32 s[52:53], s47, v20
    s_ff1_i32_b64 s48, s[48:49]
    s_ff1_i32_b64 s49, s[52:53]
    s_nop 0
    v_readlane_b32 s48, v17, s48
    v_readlane_b32 s49, v17, s49
L_aux_sel:
    s_and_b32 s52, s48, 0xfff
    s_sub_u32 s52, 0x800, s52
    s_and_b32 s53, s49, 0xfff
    s_sub_u32 s53, 0x800, s53
    s_mul_i32 s46, s31, 2080
    s_add_u32 s46, s46, 131072
    s_lshl_b32 s47, s44, 10
    v_mov_b32 v12, s52
    v_writelane_b32 v12, s53, 1
    s_cmp_ge_u32 s3, 14
    s_cbranch_scc1 L_aux_nox
    s_lshl_b32 s52, s52, 11
    s_add_u32 s52, s52, s47
    s_add_u32 m0, s46, 0
    s_nop 0
    buffer_load_dwordx4 v28, s[4:7], s52 offen lds
    s_lshl_b32 s53, s53, 11
    s_add_u32 s53, s53, s47
    s_add_u32 m0, s46, 1040
    s_nop 0
    buffer_load_dwordx4 v28, s[4:7], s53 offen lds
    v_bfe_u32 v14, v12, 1, 1
    v_lshrrev_b32 v15, 2, v12
    v_lshl_add_u32 v14, v14, 9, v15
    v_lshlrev_b32 v14, 4, v14
    v_add_u32 v14, 4096, v14
    s_mov_b64 exec, 3
    buffer_load_dwordx2 v[26:27], v14, s[12:15], 0 offen sc1
    s_mov_b64 exec, -1
    v_and_b32 v14, 1, v12
    v_cmp_eq_u32 vcc, 1, v14
    s_lshl_b32 s46, s31, 3
    s_add_u32 s46, s46, 148816
    v_lshl_add_u32 v15, v1, 2, s46
    s_waitcnt vmcnt(0)
    v_cndmask_b32 v26, v26, v27, vcc
    s_mov_b64 exec, 3
    ds_write_b32 v15, v26
    s_mov_b64 exec, -1
    s_waitcnt lgkmcnt(0)
    s_branch L_aux_b3
L_aux_nox:
    s_cmp_lg_u32 s30, 127
    s_cbranch_scc1 L_aux_b3
    v_mov_b32 v13, s48
    v_writelane_b32 v13, s49, 1
    v_and_b32 v14, 0xffff0000, v13
    v_ashrrev_i32 v15, 31, v14
    v_not_b32 v15, v15
    v_or_b32 v15, 0x80000000, v15
    v_xor_b32 v14, v14, v15
    v_and_b32 v14, 0xffff0000, v14
    v_mul_f32 v14, 0xbfb8aa3b, v14
    v_exp_f32 v14, v14
    s_nop 0
    v_add_f32 v14, 1.0, v14
    v_rcp_f32 v14, v14
    s_nop 0
    v_cvt_pk_bf16_f32 v14, v14, v14
    v_and_b32 v61, 0xffff0000, v14
    v_mov_b32 v60, v12
    v_mov_b32 v62, s29
    v_mov_b32 v63, s29
    s_lshl_b32 s46, s31, 5
    s_add_u32 s46, s46, 24576
    v_lshl_add_u32 v21, v1, 4, s46
    s_mov_b64 exec, 3
    buffer_store_dwordx4 v[60:63], v21, s[12:15], 0 offen sc1
    s_mov_b64 exec, -1
L_aux_b3:
    s_mul_i32 s46, s50, 448
    s_mul_i32 s47, s31, 112
    s_add_u32 s46, s46, s47
    v_lshrrev_b32 v14, 3, v1
    v_add_u32 v14, s46, v14
    v_lshlrev_b32 v14, 11, v14
    v_and_b32 v15, 7, v1
    v_lshl_add_u32 v14, v15, 4, v14
    s_lshl_b32 s46, s38, 7
    v_add_u32 v14, s46, v14
    s_setprio 0
    s_barrier
    s_mov_b32 s46, 0
    buffer_load_dwordx4 v[128:131], v14, s[24:27], s46 offen nt
    s_mov_b32 s46, 16384
    buffer_load_dwordx4 v[132:135], v14, s[24:27], s46 offen nt
    s_mov_b32 s46, 32768
    buffer_load_dwordx4 v[136:139], v14, s[24:27], s46 offen nt
    s_mov_b32 s46, 49152
    buffer_load_dwordx4 v[140:143], v14, s[24:27], s46 offen nt
    s_mov_b32 s46, 65536
    buffer_load_dwordx4 v[144:147], v14, s[24:27], s46 offen nt
    s_mov_b32 s46, 81920
    buffer_load_dwordx4 v[148:151], v14, s[24:27], s46 offen nt
    s_mov_b32 s46, 98304
    buffer_load_dwordx4 v[152:155], v14, s[24:27], s46 offen nt
    s_mov_b32 s46, 114688
    buffer_load_dwordx4 v[156:159], v14, s[24:27], s46 offen nt
    s_mov_b32 s46, 131072
    buffer_load_dwordx4 v[160:163], v14, s[24:27], s46 offen nt
    s_mov_b32 s46, 147456
    buffer_load_dwordx4 v[164:167], v14, s[24:27], s46 offen nt
    s_mov_b32 s46, 163840
    buffer_load_dwordx4 v[168:171], v14, s[24:27], s46 offen nt
    s_mov_b32 s46, 180224
    buffer_load_dwordx4 v[172:175], v14, s[24:27], s46 offen nt
    s_mov_b32 s46, 196608
    buffer_load_dwordx4 v[176:179], v14, s[24:27], s46 offen nt
    s_mov_b32 s46, 212992
    buffer_load_dwordx4 v[180:183], v14, s[24:27], s46 offen nt
    s_branch L_aux_b4
L_aux_sinit:
    v_mov_b32 v96, 0
    v_mov_b32 v97, 0
    v_lshl_add_u32 v98, v1, 3, v22
    ds_write_b64 v98, v[96:97]
    v_mov_b32 v96, 0x3f803f80
    v_and_b32 v98, 255, v0
    v_lshlrev_b32 v98, 2, v98
    v_add_u32 v98, 139392, v98
    ds_write_b32 v98, v96
    v_bfe_u32 v96, v1, 3, 2
    v_lshrrev_b32 v97, 5, v1
    v_lshl_add_u32 v96, v97, 3, v96
    v_mul_u32_u24 v96, 7168, v96
    v_lshlrev_b32 v98, 1, v3
    v_and_b32 v94, 7, v1
    v_xor_b32 v98, v98, v94
    s_mul_i32 s51, s50, 896
    s_lshr_b32 s33, s3, 1
    s_add_u32 s37, s33, 1
    s_cmp_eq_u32 s37, 7
    s_cselect_b32 s37, 0, s37
    s_lshl_b32 s33, s33, 7
    s_lshl_b32 s37, s37, 7
    s_add_u32 s33, s33, s51
    s_add_u32 s37, s37, s51
    v_lshl_add_u32 v96, v98, 4, v96
    v_add_u32 v97, s37, v96
    v_add_u32 v96, s33, v96
    s_sub_u32 s36, s31, 4
    s_lshl_b32 s34, s44, 2
    s_add_u32 s34, s34, s36
    s_mul_i32 s34, s34, 917504
    s_lshl_b32 s36, s36, 15
    s_waitcnt lgkmcnt(0)
    s_load_dword s28, s[12:13], 0
    s_mov_b32 s14, 753664
    s_mov_b32 s15, 0x00020000
    s_mov_b32 s18, 7340032
    s_mov_b32 s19, 0x00020000
    s_mov_b32 s22, 7340032
    s_mov_b32 s23, 0x00020000
    s_barrier
    s_cmp_lg_u32 s31, 7
    s_cbranch_scc1 L_aux_nocp
    s_cmp_gt_u32 s3, 1
    s_cbranch_scc1 L_aux_nocp
    s_getpc_b64 s[52:53]
L_pc_aux:
    s_sub_u32 s52, s52, L_pc_aux-L_aux_code
    s_subb_u32 s53, s53, 0
    s_mov_b32 s54, L_code_end-L_aux_code
    s_mov_b32 s55, 0x00020000
    v_lshlrev_b32 v100, 7, v1
    buffer_load_dword v101, v100, s[52:55], 0 offen
    v_add_u32 v100, 8192, v100
    buffer_load_dword v101, v100, s[52:55], 0 offen
L_aux_nocp:
    s_waitcnt lgkmcnt(0)
    s_mul_i32 s29, s28, 0x9e3779b1
    s_add_u32 s29, s29, 0x7f4a7c15
    s_cmp_ge_u32 s3, 14
    s_cbranch_scc1 L_aux_idle
    s_add_u32 s35, s34, 0
    s_add_u32 m0, s36, 0
    s_nop 0
    buffer_load_dwordx4 v96, s[16:19], s35 offen nt lds
    s_add_u32 s35, s34, 114688
    s_add_u32 m0, s36, 1024
    s_nop 0
    buffer_load_dwordx4 v96, s[16:19], s35 offen nt lds
    s_add_u32 s35, s34, 28672
    s_add_u32 m0, s36, 2048
    s_nop 0
    buffer_load_dwordx4 v96, s[16:19], s35 offen nt lds
    s_add_u32 s35, s34, 143360
    s_add_u32 m0, s36, 3072
    s_nop 0
    buffer_load_dwordx4 v96, s[16:19], s35 offen nt lds
    s_add_u32 s35, s34, 0
    s_add_u32 m0, s36, 16384
    s_nop 0
    buffer_load_dwordx4 v97, s[20:23], s35 offen nt lds
    s_add_u32 s35, s34, 114688
    s_add_u32 m0, s36, 17408
    s_nop 0
    buffer_load_dwordx4 v97, s[20:23], s35 offen nt lds
    s_add_u32 s35, s34, 28672
    s_add_u32 m0, s36, 18432
    s_nop 0
    buffer_load_dwordx4 v97, s[20:23], s35 offen nt lds
    s_add_u32 s35, s34, 143360
    s_add_u32 m0, s36, 19456
    s_nop 0
    buffer_load_dwordx4 v97, s[20:23], s35 offen nt lds
    s_add_u32 s35, s34, 229376
    s_add_u32 m0, s36, 4096
    s_nop 0
    buffer_load_dwordx4 v96, s[16:19], s35 offen nt lds
    s_add_u32 s35, s34, 344064
    s_add_u32 m0, s36, 5120
    s_nop 0
    buffer_load_dwordx4 v96, s[16:19], s35 offen nt lds
    s_add_u32 s35, s34, 258048
    s_add_u32 m0, s36, 6144
    s_nop 0
    buffer_load_dwordx4 v96, s[16:19], s35 offen nt lds
    s_add_u32 s35, s34, 372736
    s_add_u32 m0, s36, 7168
    s_nop 0
    buffer_load_dwordx4 v96, s[16:19], s35 offen nt lds
    s_add_u32 s35, s34, 229376
    s_add_u32 m0, s36, 20480
    s_nop 0
    buffer_load_dwordx4 v97, s[20:23], s35 offen nt lds
    s_add_u32 s35, s34, 344064
    s_add_u32 m0, s36, 21504
    s_nop 0
    buffer_load_dwordx4 v97, s[20:23], s35 offen nt lds
    s_add_u32 s35, s34, 258048
    s_add_u32 m0, s36, 22528
    s_nop 0
    buffer_load_dwordx4 v97, s[20:23], s35 offen nt lds
    s_add_u32 s35, s34, 372736
    s_add_u32 m0, s36, 23552
    s_nop 0
    buffer_load_dwordx4 v97, s[20:23], s35 offen nt lds
    s_add_u32 s35, s34, 458752
    s_add_u32 m0, s36, 8192
    s_nop 0
    buffer_load_dwordx4 v96, s[16:19], s35 offen nt lds
    s_add_u32 s35, s34, 573440
    s_add_u32 m0, s36, 9216
    s_nop 0
    buffer_load_dwordx4 v96, s[16:19], s35 offen nt lds
    s_add_u32 s35, s34, 487424
    s_add_u32 m0, s36, 10240
    s_nop 0
    buffer_load_dwordx4 v96, s[16:19], s35 offen nt lds
    s_add_u32 s35, s34, 602112
    s_add_u32 m0, s36, 11264
    s_nop 0
    buffer_load_dwordx4 v96, s[16:19], s35 offen nt lds
    s_add_u32 s35, s34, 458752
    s_add_u32 m0, s36, 24576
    s_nop 0
    buffer_load_dwordx4 v97, s[20:23], s35 offen nt lds
    s_add_u32 s35, s34, 573440
    s_add_u32 m0, s36, 25600
    s_nop 0
    buffer_load_dwordx4 v97, s[20:23], s35 offen nt lds
    s_add_u32 s35, s34, 487424
    s_add_u32 m0, s36, 26624
    s_nop 0
    buffer_load_dwordx4 v97, s[20:23], s35 offen nt lds
    s_add_u32 s35, s34, 602112
    s_add_u32 m0, s36, 27648
    s_nop 0
    buffer_load_dwordx4 v97, s[20:23], s35 offen nt lds
    s_add_u32 s35, s34, 688128
    s_add_u32 m0, s36, 12288
    s_nop 0
    buffer_load_dwordx4 v96, s[16:19], s35 offen nt lds
    s_add_u32 s35, s34, 802816
    s_add_u32 m0, s36, 13312
    s_nop 0
    buffer_load_dwordx4 v96, s[16:19], s35 offen nt lds
    s_add_u32 s35, s34, 716800
    s_add_u32 m0, s36, 14336
    s_nop 0
    buffer_load_dwordx4 v96, s[16:19], s35 offen nt lds
    s_add_u32 s35, s34, 831488
    s_add_u32 m0, s36, 15360
    s_nop 0
    buffer_load_dwordx4 v96, s[16:19], s35 offen nt lds
    s_add_u32 s35, s34, 688128
    s_add_u32 m0, s36, 28672
    s_nop 0
    buffer_load_dwordx4 v97, s[20:23], s35 offen nt lds
    s_add_u32 s35, s34, 802816
    s_add_u32 m0, s36, 29696
    s_nop 0
    buffer_load_dwordx4 v97, s[20:23], s35 offen nt lds
    s_add_u32 s35, s34, 716800
    s_add_u32 m0, s36, 30720
    s_nop 0
    buffer_load_dwordx4 v97, s[20:23], s35 offen nt lds
    s_add_u32 s35, s34, 831488
    s_add_u32 m0, s36, 31744
    s_nop 0
    buffer_load_dwordx4 v97, s[20:23], s35 offen nt lds
    v_bfe_u32 v14, v1, 2, 3
    v_lshrrev_b32 v15, 1, v14
    v_lshlrev_b32 v14, 7, v14
    v_lshrrev_b32 v13, 5, v1
    v_lshl_add_u32 v14, v13, 10, v14
    v_and_b32 v13, 3, v1
    v_lshl_add_u32 v14, v13, 3, v14
    v_add_u32 v14, s36, v14
    v_xor_b32 v13, 0, v15
    v_lshl_add_u32 v24, v13, 5, v14
    v_xor_b32 v13, 1, v15
    v_lshl_add_u32 v25, v13, 5, v14
    v_xor_b32 v13, 2, v15
    v_lshl_add_u32 v26, v13, 5, v14
    v_xor_b32 v13, 3, v15
    v_lshl_add_u32 v27, v13, 5, v14
    v_min_u32 v20, 8, v2
    v_mul_u32_u24 v20, 1040, v20
    v_lshl_add_u32 v20, v3, 4, v20
    s_lshr_b32 s35, s36, 7
    s_add_u32 s35, s35, 131072
    v_add_u32 v20, s35, v20
    v_lshlrev_b32 v19, 6, v2
    v_lshl_add_u32 v19, v3, 4, v19
    s_lshr_b32 s35, s36, 11
    s_add_u32 s35, s35, s36
    s_add_u32 s35, s35, 24512
    v_add_u32 v19, s35, v19
    s_waitcnt vmcnt(24)
    ds_read_b64_tr_b16 v[64:65], v24 offset:0
    ds_read_b64_tr_b16 v[66:67], v24 offset:2048
    ds_read_b64_tr_b16 v[68:69], v25 offset:0
    ds_read_b64_tr_b16 v[70:71], v25 offset:2048
    ds_read_b64_tr_b16 v[72:73], v26 offset:0
    ds_read_b64_tr_b16 v[74:75], v26 offset:2048
    ds_read_b64_tr_b16 v[76:77], v27 offset:0
    ds_read_b64_tr_b16 v[78:79], v27 offset:2048
    ds_read_b64_tr_b16 v[80:81], v24 offset:16384
    ds_read_b64_tr_b16 v[82:83], v24 offset:18432
    ds_read_b64_tr_b16 v[84:85], v25 offset:16384
    ds_read_b64_tr_b16 v[86:87], v25 offset:18432
    ds_read_b64_tr_b16 v[88:89], v26 offset:16384
    ds_read_b64_tr_b16 v[90:91], v26 offset:18432
    ds_read_b64_tr_b16 v[92:93], v27 offset:16384
    ds_read_b64_tr_b16 v[94:95], v27 offset:18432
    s_waitcnt vmcnt(16)
    ds_read_b64_tr_b16 v[96:97], v24 offset:4096
    ds_read_b64_tr_b16 v[98:99], v24 offset:6144
    ds_read_b64_tr_b16 v[100:101], v25 offset:4096
    ds_read_b64_tr_b16 v[102:103], v25 offset:6144
    ds_read_b64_tr_b16 v[104:105], v26 offset:4096
    ds_read_b64_tr_b16 v[106:107], v26 offset:6144
    ds_read_b64_tr_b16 v[108:109], v27 offset:4096
    ds_read_b64_tr_b16 v[110:111], v27 offset:6144
    ds_read_b64_tr_b16 v[112:113], v24 offset:20480
    ds_read_b64_tr_b16 v[114:115], v24 offset:22528
    ds_read_b64_tr_b16 v[116:117], v25 offset:20480
    ds_read_b64_tr_b16 v[118:119], v25 offset:22528
    ds_read_b64_tr_b16 v[120:121], v26 offset:20480
    ds_read_b64_tr_b16 v[122:123], v26 offset:22528
    ds_read_b64_tr_b16 v[124:125], v27 offset:20480
    ds_read_b64_tr_b16 v[126:127], v27 offset:22528
    s_waitcnt vmcnt(8)
    ds_read_b64_tr_b16 v[128:129], v24 offset:8192
    ds_read_b64_tr_b16 v[130:131], v24 offset:10240
    ds_read_b64_tr_b16 v[132:133], v25 offset:8192
    ds_read_b64_tr_b16 v[134:135], v25 offset:10240
    ds_read_b64_tr_b16 v[136:137], v26 offset:8192
    ds_read_b64_tr_b16 v[138:139], v26 offset:10240
    ds_read_b64_tr_b16 v[140:141], v27 offset:8192
    ds_read_b64_tr_b16 v[142:143], v27 offset:10240
    ds_read_b64_tr_b16 v[144:145], v24 offset:24576
    ds_read_b64_tr_b16 v[146:147], v24 offset:26624
    ds_read_b64_tr_b16 v[148:149], v25 offset:24576
    ds_read_b64_tr_b16 v[150:151], v25 offset:26624
    ds_read_b64_tr_b16 v[152:153], v26 offset:24576
    ds_read_b64_tr_b16 v[154:155], v26 offset:26624
    ds_read_b64_tr_b16 v[156:157], v27 offset:24576
    ds_read_b64_tr_b16 v[158:159], v27 offset:26624
    s_waitcnt vmcnt(0)
    ds_read_b64_tr_b16 v[160:161], v24 offset:12288
    ds_read_b64_tr_b16 v[162:163], v24 offset:14336
    ds_read_b64_tr_b16 v[164:165], v25 offset:12288
    ds_read_b64_tr_b16 v[166:167], v25 offset:14336
    ds_read_b64_tr_b16 v[168:169], v26 offset:12288
    ds_read_b64_tr_b16 v[170:171], v26 offset:14336
    ds_read_b64_tr_b16 v[172:173], v27 offset:12288
    ds_read_b64_tr_b16 v[174:175], v27 offset:14336
    ds_read_b64_tr_b16 v[176:177], v24 offset:28672
    ds_read_b64_tr_b16 v[178:179], v24 offset:30720
    ds_read_b64_tr_b16 v[180:181], v25 offset:28672
    ds_read_b64_tr_b16 v[182:183], v25 offset:30720
    ds_read_b64_tr_b16 v[184:185], v26 offset:28672
    ds_read_b64_tr_b16 v[186:187], v26 offset:30720
    ds_read_b64_tr_b16 v[188:189], v27 offset:28672
    ds_read_b64_tr_b16 v[190:191], v27 offset:30720
    s_barrier
    ds_read_b128 v[32:35], v20 offset:0
    ds_read_b128 v[36:39], v20 offset:64
    ds_read_b128 v[40:43], v20 offset:128
    ds_read_b128 v[44:47], v20 offset:192
    s_waitcnt lgkmcnt(3)
    v_mfma_f32_16x16x32_bf16 v[192:195], v[64:67], v[32:35], 0
    v_mfma_f32_16x16x32_bf16 v[196:199], v[68:71], v[32:35], 0
    v_mfma_f32_16x16x32_bf16 v[200:203], v[72:75], v[32:35], 0
    v_mfma_f32_16x16x32_bf16 v[204:207], v[76:79], v[32:35], 0
    v_mfma_f32_16x16x32_bf16 v[208:211], v[80:83], v[32:35], 0
    v_mfma_f32_16x16x32_bf16 v[212:215], v[84:87], v[32:35], 0
    v_mfma_f32_16x16x32_bf16 v[216:219], v[88:91], v[32:35], 0
    v_mfma_f32_16x16x32_bf16 v[220:223], v[92:95], v[32:35], 0
    s_waitcnt lgkmcnt(2)
    v_mfma_f32_16x16x32_bf16 v[192:195], v[96:99], v[36:39], v[192:195]
    v_mfma_f32_16x16x32_bf16 v[196:199], v[100:103], v[36:39], v[196:199]
    v_mfma_f32_16x16x32_bf16 v[200:203], v[104:107], v[36:39], v[200:203]
    v_mfma_f32_16x16x32_bf16 v[204:207], v[108:111], v[36:39], v[204:207]
    v_mfma_f32_16x16x32_bf16 v[208:211], v[112:115], v[36:39], v[208:211]
    v_mfma_f32_16x16x32_bf16 v[212:215], v[116:119], v[36:39], v[212:215]
    v_mfma_f32_16x16x32_bf16 v[216:219], v[120:123], v[36:39], v[216:219]
    v_mfma_f32_16x16x32_bf16 v[220:223], v[124:127], v[36:39], v[220:223]
    s_waitcnt lgkmcnt(1)
    v_mfma_f32_16x16x32_bf16 v[192:195], v[128:131], v[40:43], v[192:195]
    v_mfma_f32_16x16x32_bf16 v[196:199], v[132:135], v[40:43], v[196:199]
    v_mfma_f32_16x16x32_bf16 v[200:203], v[136:139], v[40:43], v[200:203]
    v_mfma_f32_16x16x32_bf16 v[204:207], v[140:143], v[40:43], v[204:207]
    v_mfma_f32_16x16x32_bf16 v[208:211], v[144:147], v[40:43], v[208:211]
    v_mfma_f32_16x16x32_bf16 v[212:215], v[148:151], v[40:43], v[212:215]
    v_mfma_f32_16x16x32_bf16 v[216:219], v[152:155], v[40:43], v[216:219]
    v_mfma_f32_16x16x32_bf16 v[220:223], v[156:159], v[40:43], v[220:223]
    s_waitcnt lgkmcnt(0)
    v_mfma_f32_16x16x32_bf16 v[192:195], v[160:163], v[44:47], v[192:195]
    v_mfma_f32_16x16x32_bf16 v[196:199], v[164:167], v[44:47], v[196:199]
    v_mfma_f32_16x16x32_bf16 v[200:203], v[168:171], v[44:47], v[200:203]
    v_mfma_f32_16x16x32_bf16 v[204:207], v[172:175], v[44:47], v[204:207]
    v_mfma_f32_16x16x32_bf16 v[208:211], v[176:179], v[44:47], v[208:211]
    v_mfma_f32_16x16x32_bf16 v[212:215], v[180:183], v[44:47], v[212:215]
    v_mfma_f32_16x16x32_bf16 v[216:219], v[184:187], v[44:47], v[216:219]
    v_mfma_f32_16x16x32_bf16 v[220:223], v[188:191], v[44:47], v[220:223]
    s_nop 0
    ds_write_b128 v19, v[192:195] offset:0
    ds_write_b128 v19, v[196:199] offset:1024
    ds_write_b128 v19, v[200:203] offset:2048
    ds_write_b128 v19, v[204:207] offset:3072
    ds_write_b128 v19, v[208:211] offset:4096
    ds_write_b128 v19, v[212:215] offset:5120
    ds_write_b128 v19, v[216:219] offset:6144
    ds_write_b128 v19, v[220:223] offset:7168
    s_waitcnt lgkmcnt(0)
    s_branch L_aux_b4
L_aux_idle:
    s_barrier
L_aux_b4:
    v_and_b32 v20, 7, v1
    v_lshlrev_b32 v21, 2, v20
    v_add_u32 v21, 148816, v21
    v_bfe_u32 v19, v1, 3, 2
    v_mul_u32_u24 v19, 32784, v19
    v_lshrrev_b32 v18, 5, v1
    v_lshl_add_u32 v19, v18, 12, v19
    s_lshr_b32 s48, s31, 2
    s_lshl_b32 s48, s48, 10
    s_and_b32 s49, s31, 3
    s_lshl_b32 s49, s49, 4
    s_add_u32 s48, s48, s49
    s_add_u32 s48, s48, 24512
    v_add_u32 v19, s48, v19
    s_lshr_b32 s49, s3, 1
    s_cmp_eq_u32 s49, 6
    s_movk_i32 s48, 2048
    s_cselect_b32 s49, s48, 16384
    v_mul_u32_u24 v22, s49, v18
    v_lshl_add_u32 v22, v20, 4, v22
    v_bfe_u32 v18, v1, 3, 1
    v_lshl_add_u32 v22, v18, 10, v22
    s_mul_i32 s56, s50, 57344
    s_add_u32 s56, s56, 32768
    s_mul_i32 s48, s44, 28672
    s_lshr_b32 s49, s3, 1
    s_lshl_b32 s49, s49, 11
    s_add_u32 s48, s48, s49
    s_lshl_b32 s49, s31, 7
    s_add_u32 s48, s48, s49
    s_add_u32 s48, s48, s56
    v_add_u32 v22, s48, v22
    v_lshl_add_u32 v20, v20, 6, v19
    s_bfe_u32 s52, s29, 0x80000
    s_bfe_u32 s53, s29, 0x80008
    s_bfe_u32 s54, s29, 0x80010
    s_bfe_u32 s55, s29, 0x80018
    v_mov_b32 v23, 0xffffff00
    v_cmp_eq_u32 s[58:59], 1, v18
    s_barrier
    s_cmp_ge_u32 s3, 14
    s_cbranch_scc1 L_aux_noh
    ds_read_b32 v24, v21
    ds_read_b128 v[64:67], v20
    ds_read_b128 v[72:75], v19 offset:512
    ds_read_b128 v[68:71], v20 offset:2048
    ds_read_b128 v[76:79], v19 offset:2560
    s_waitcnt lgkmcnt(0)
    v_and_b32 v25, 0xffff0000, v24
    v_lshlrev_b32 v24, 16, v24
    v_rcp_f32 v25, v25
    s_nop 0
    v_pk_fma_f32 v[64:65], v[72:73], v[24:25], v[64:65] op_sel:[0,0,0] op_sel_hi:[1,0,1] neg_lo:[1,0,0] neg_hi:[1,0,0]
    v_pk_fma_f32 v[66:67], v[74:75], v[24:25], v[66:67] op_sel:[0,0,0] op_sel_hi:[1,0,1] neg_lo:[1,0,0] neg_hi:[1,0,0]
    v_pk_fma_f32 v[68:69], v[76:77], v[24:25], v[68:69] op_sel:[0,0,0] op_sel_hi:[1,0,1] neg_lo:[1,0,0] neg_hi:[1,0,0]
    v_pk_fma_f32 v[70:71], v[78:79], v[24:25], v[70:71] op_sel:[0,0,0] op_sel_hi:[1,0,1] neg_lo:[1,0,0] neg_hi:[1,0,0]
    v_cndmask_b32 v72, v68, v64, s[58:59]
    v_cndmask_b32 v73, v69, v65, s[58:59]
    v_cndmask_b32 v74, v70, v66, s[58:59]
    v_cndmask_b32 v75, v71, v67, s[58:59]
    v_cndmask_b32 v64, v64, v68, s[58:59]
    v_cndmask_b32 v65, v65, v69, s[58:59]
    v_cndmask_b32 v66, v66, v70, s[58:59]
    v_cndmask_b32 v67, v67, v71, s[58:59]
    v_add_f32_dpp v64, v72, v64 row_ror:8 row_mask:0xf bank_mask:0xf
    v_add_f32_dpp v65, v73, v65 row_ror:8 row_mask:0xf bank_mask:0xf
    v_add_f32_dpp v66, v74, v66 row_ror:8 row_mask:0xf bank_mask:0xf
    v_add_f32_dpp v67, v75, v67 row_ror:8 row_mask:0xf bank_mask:0xf
    v_mov_b32 v68, v64
    v_mov_b32 v69, v65
    v_mov_b32 v70, v66
    v_mov_b32 v71, v67
    v_permlane16_swap_b32 v64, v68
    v_permlane16_swap_b32 v65, v69
    v_permlane16_swap_b32 v66, v70
    v_permlane16_swap_b32 v67, v71
    v_pk_add_f32 v[64:65], v[64:65], v[68:69]
    v_pk_add_f32 v[66:67], v[66:67], v[70:71]
    v_pk_mul_f32 v[64:65], v[64:65], v[24:25] op_sel:[0,1] op_sel_hi:[1,1]
    v_pk_mul_f32 v[66:67], v[66:67], v[24:25] op_sel:[0,1] op_sel_hi:[1,1]
    v_and_or_b32 v64, v64, v23, s52
    v_and_or_b32 v65, v65, v23, s53
    v_and_or_b32 v66, v66, v23, s54
    v_and_or_b32 v67, v67, v23, s55
    s_mov_b32 exec_lo, 0xffff
    s_mov_b32 exec_hi, 0xffff
    buffer_store_dwordx4 v[64:67], v22, s[12:15], 0 offen sc1
    s_mov_b64 exec, -1
L_aux_noh:
    s_cmp_ge_u32 s31, 4
    s_cbranch_scc1 L_aux_nowd
    v_and_b32 v14, 7, v1
    v_mul_u32_u24 v15, 86, v14
    v_lshrrev_b32 v15, 8, v15
    v_mul_u32_u24 v14, 7184, v14
    v_mul_u32_u24 v15, 11216, v15
    v_add_u32 v14, v14, v15
    v_lshrrev_b32 v15, 3, v1
    v_lshl_add_u32 v14, v15, 4, v14
    s_mul_i32 s46, s31, 1792
    v_add_u32 v14, s46, v14
    s_waitcnt vmcnt(1)
    s_cmp_lt_u32 s3, 14
    s_cbranch_scc1 L_aux_wd1
    s_waitcnt vmcnt(0)
L_aux_wd1:
    ds_write_b128 v14, v[128:131] offset:0
    ds_write_b128 v14, v[132:135] offset:128
    ds_write_b128 v14, v[136:139] offset:256
    ds_write_b128 v14, v[140:143] offset:384
    ds_write_b128 v14, v[144:147] offset:512
    ds_write_b128 v14, v[148:151] offset:640
    ds_write_b128 v14, v[152:155] offset:768
    ds_write_b128 v14, v[156:159] offset:896
    ds_write_b128 v14, v[160:163] offset:1024
    ds_write_b128 v14, v[164:167] offset:1152
    ds_write_b128 v14, v[168:171] offset:1280
    ds_write_b128 v14, v[172:175] offset:1408
    ds_write_b128 v14, v[176:179] offset:1536
    ds_write_b128 v14, v[180:183] offset:1664
    s_waitcnt lgkmcnt(0)
L_aux_nowd:
    v_lshlrev_b32 v10, 7, v3
    v_bfe_u32 v11, v1, 1, 1
    v_lshl_add_u32 v10, v11, 6, v10
    v_bfe_u32 v11, v1, 2, 2
    v_lshl_add_u32 v10, v11, 4, v10
    v_and_b32 v11, 1, v1
    v_lshl_add_u32 v10, v11, 3, v10
    s_mul_i32 s46, s31, 86
    s_lshr_b32 s46, s46, 8
    s_mul_i32 s46, s46, 11216
    s_mul_i32 s47, s31, 7184
    s_add_u32 s46, s46, s47
    v_add_u32 v10, s46, v10
    v_lshl_add_u32 v14, v0, 4, s56
    v_lshlrev_b32 v15, 3, v1
    v_add_u32 v15, 131072, v15
    s_lshl_b32 s47, s31, 9
    v_add_u32 v16, s47, v15
    s_mov_b32 s60, 7168
    s_mov_b32 s61, 14336
    s_mov_b32 s62, 21504
    s_mov_b32 s63, 28672
    s_mov_b32 s64, 35840
    s_mov_b32 s65, 43008
    s_mov_b32 s66, 50176
    s_mov_b32 s58, 0xbfb8aa3b
    s_mov_b32 s43, 0
    v_mov_b32 v17, 0xff
    s_barrier
    ds_read_b64_tr_b16 v[64:65], v10 offset:0
    ds_read_b64_tr_b16 v[66:67], v10 offset:512
    ds_read_b64_tr_b16 v[68:69], v10 offset:1024
    ds_read_b64_tr_b16 v[70:71], v10 offset:1536
    ds_read_b64_tr_b16 v[72:73], v10 offset:2048
    ds_read_b64_tr_b16 v[74:75], v10 offset:2560
    ds_read_b64_tr_b16 v[76:77], v10 offset:3072
    ds_read_b64_tr_b16 v[78:79], v10 offset:3584
    ds_read_b64_tr_b16 v[80:81], v10 offset:4096
    ds_read_b64_tr_b16 v[82:83], v10 offset:4608
    ds_read_b64_tr_b16 v[84:85], v10 offset:5120
    ds_read_b64_tr_b16 v[86:87], v10 offset:5632
    ds_read_b64_tr_b16 v[88:89], v10 offset:6144
    ds_read_b64_tr_b16 v[90:91], v10 offset:6656
    s_cmp_eq_u32 s31, 7
    s_cbranch_scc1 L_aux_nohp
    buffer_load_dwordx4 v[128:131], v14, s[12:15], 0 offen sc1
    buffer_load_dwordx4 v[132:135], v14, s[12:15], s60 offen sc1
    buffer_load_dwordx4 v[136:139], v14, s[12:15], s61 offen sc1
    buffer_load_dwordx4 v[140:143], v14, s[12:15], s62 offen sc1
    buffer_load_dwordx4 v[144:147], v14, s[12:15], s63 offen sc1
    buffer_load_dwordx4 v[148:151], v14, s[12:15], s64 offen sc1
    buffer_load_dwordx4 v[152:155], v14, s[12:15], s65 offen sc1
    buffer_load_dwordx4 v[156:159], v14, s[12:15], s66 offen sc1
L_aux_gp:
    s_waitcnt vmcnt(0)
    v_bitop3_b32 v32, v128, v132, s52 bitop3:0x7e
    v_bitop3_b32 v36, v136, v140, s52 bitop3:0x7e
    v_bitop3_b32 v40, v144, v148, s52 bitop3:0x7e
    v_bitop3_b32 v44, v152, v156, s52 bitop3:0x7e
    v_bitop3_b32 v33, v129, v133, s53 bitop3:0x7e
    v_bitop3_b32 v37, v137, v141, s53 bitop3:0x7e
    v_bitop3_b32 v41, v145, v149, s53 bitop3:0x7e
    v_bitop3_b32 v45, v153, v157, s53 bitop3:0x7e
    v_bitop3_b32 v34, v130, v134, s54 bitop3:0x7e
    v_bitop3_b32 v38, v138, v142, s54 bitop3:0x7e
    v_bitop3_b32 v42, v146, v150, s54 bitop3:0x7e
    v_bitop3_b32 v46, v154, v158, s54 bitop3:0x7e
    v_bitop3_b32 v35, v131, v135, s55 bitop3:0x7e
    v_bitop3_b32 v39, v139, v143, s55 bitop3:0x7e
    v_bitop3_b32 v43, v147, v151, s55 bitop3:0x7e
    v_bitop3_b32 v47, v155, v159, s55 bitop3:0x7e
    v_or3_b32 v32, v32, v33, v34
    v_or3_b32 v36, v36, v37, v38
    v_or3_b32 v40, v40, v41, v42
    v_or3_b32 v44, v44, v45, v46
    v_bitop3_b32 v32, v32, v35, v17 bitop3:0xa8
    v_bitop3_b32 v36, v36, v39, v17 bitop3:0xa8
    v_bitop3_b32 v40, v40, v43, v17 bitop3:0xa8
    v_bitop3_b32 v44, v44, v47, v17 bitop3:0xa8
    v_cmp_ne_u32 s[4:5], 0, v32
    v_cmp_ne_u32 s[6:7], 0, v36
    v_cmp_ne_u32 s[8:9], 0, v40
    v_cmp_ne_u32 s[10:11], 0, v44
    s_or_b64 vcc, s[4:5], s[6:7]
    s_or_b64 s[32:33], s[8:9], s[10:11]
    s_or_b64 vcc, vcc, s[32:33]
    s_cbranch_scc0 L_aux_gok
    s_add_u32 s43, s43, 1
    s_cmp_ge_u32 s43, 65536
    s_cbranch_scc1 L_aux_gok
    s_sleep 2
    s_mov_b64 exec, s[4:5]
    s_cbranch_execz L_aux_gs0
    buffer_load_dwordx4 v[128:131], v14, s[12:15], 0 offen sc1
    buffer_load_dwordx4 v[132:135], v14, s[12:15], s60 offen sc1
L_aux_gs0:
    s_mov_b64 exec, s[6:7]
    s_cbranch_execz L_aux_gs1
    buffer_load_dwordx4 v[136:139], v14, s[12:15], s61 offen sc1
    buffer_load_dwordx4 v[140:143], v14, s[12:15], s62 offen sc1
L_aux_gs1:
    s_mov_b64 exec, s[8:9]
    s_cbranch_execz L_aux_gs2
    buffer_load_dwordx4 v[144:147], v14, s[12:15], s63 offen sc1
    buffer_load_dwordx4 v[148:151], v14, s[12:15], s64 offen sc1
L_aux_gs2:
    s_mov_b64 exec, s[10:11]
    s_cbranch_execz L_aux_gs3
    buffer_load_dwordx4 v[152:155], v14, s[12:15], s65 offen sc1
    buffer_load_dwordx4 v[156:159], v14, s[12:15], s66 offen sc1
L_aux_gs3:
    s_mov_b64 exec, -1
    s_branch L_aux_gp
L_aux_gok:
    v_pk_add_f32 v[128:129], v[128:129], v[144:145]
    v_pk_add_f32 v[130:131], v[130:131], v[146:147]
    v_pk_add_f32 v[136:137], v[136:137], v[152:153]
    v_pk_add_f32 v[138:139], v[138:139], v[154:155]
    v_pk_add_f32 v[132:133], v[132:133], v[148:149]
    v_pk_add_f32 v[134:135], v[134:135], v[150:151]
    v_pk_add_f32 v[140:141], v[140:141], v[156:157]
    v_pk_add_f32 v[142:143], v[142:143], v[158:159]
    v_pk_mul_f32 v[144:145], v[128:129], s[58:59] op_sel_hi:[1,0]
    v_pk_mul_f32 v[146:147], v[130:131], s[58:59] op_sel_hi:[1,0]
    v_pk_mul_f32 v[148:149], v[132:133], s[58:59] op_sel_hi:[1,0]
    v_pk_mul_f32 v[150:151], v[134:135], s[58:59] op_sel_hi:[1,0]
    v_exp_f32 v144, v144
    v_exp_f32 v145, v145
    v_exp_f32 v146, v146
    v_exp_f32 v147, v147
    v_pk_mul_f32 v[128:129], v[128:129], v[136:137]
    v_pk_mul_f32 v[130:131], v[130:131], v[138:139]
    v_exp_f32 v148, v148
    v_exp_f32 v149, v149
    v_exp_f32 v150, v150
    v_exp_f32 v151, v151
    v_pk_mul_f32 v[132:133], v[132:133], v[140:141]
    v_pk_mul_f32 v[134:135], v[134:135], v[142:143]
    v_pk_add_f32 v[144:145], v[144:145], 1.0 op_sel_hi:[1,0]
    v_pk_add_f32 v[146:147], v[146:147], 1.0 op_sel_hi:[1,0]
    v_pk_add_f32 v[148:149], v[148:149], 1.0 op_sel_hi:[1,0]
    v_pk_add_f32 v[150:151], v[150:151], 1.0 op_sel_hi:[1,0]
    v_rcp_f32 v144, v144
    v_rcp_f32 v145, v145
    v_rcp_f32 v146, v146
    v_rcp_f32 v147, v147
    v_rcp_f32 v148, v148
    v_rcp_f32 v149, v149
    v_rcp_f32 v150, v150
    v_rcp_f32 v151, v151
    v_pk_mul_f32 v[128:129], v[128:129], v[144:145]
    v_pk_mul_f32 v[130:131], v[130:131], v[146:147]
    v_cvt_pk_bf16_f32 v136, v128, v129
    v_cvt_pk_bf16_f32 v137, v130, v131
    ds_write_b64 v16, v[136:137] offset:0
    v_pk_mul_f32 v[132:133], v[132:133], v[148:149]
    v_pk_mul_f32 v[134:135], v[134:135], v[150:151]
    v_cvt_pk_bf16_f32 v140, v132, v133
    v_cvt_pk_bf16_f32 v141, v134, v135
    ds_write_b64 v16, v[140:141] offset:3584
L_aux_nohp:
    s_waitcnt lgkmcnt(0)
    s_barrier
    ds_read_b64 v[96:97], v15 offset:0
    ds_read_b64 v[98:99], v15 offset:512
    ds_read_b64 v[100:101], v15 offset:1024
    ds_read_b64 v[102:103], v15 offset:1536
    ds_read_b64 v[104:105], v15 offset:2048
    ds_read_b64 v[106:107], v15 offset:2560
    ds_read_b64 v[108:109], v15 offset:3072
    ds_read_b64 v[110:111], v15 offset:3584
    ds_read_b64 v[112:113], v15 offset:4096
    ds_read_b64 v[114:115], v15 offset:4608
    ds_read_b64 v[116:117], v15 offset:5120
    ds_read_b64 v[118:119], v15 offset:5632
    ds_read_b64 v[120:121], v15 offset:6144
    ds_read_b64 v[122:123], v15 offset:6656
    s_lshl_b32 s46, s38, 3
    s_add_u32 s46, s46, s31
    s_lshl_b32 s46, s46, 3
    s_add_u32 s46, s46, s50
    s_lshl_b32 s46, s46, 8
    s_add_u32 s46, s46, 491520
    v_lshlrev_b32 v14, 7, v3
    v_lshl_add_u32 v14, v2, 4, v14
    v_add_u32 v14, s46, v14
    s_waitcnt lgkmcnt(13)
    v_mfma_f32_16x16x16_bf16 v[32:35], v[64:65], v[96:97], 0
    s_waitcnt lgkmcnt(12)
    v_mfma_f32_16x16x16_bf16 v[32:35], v[66:67], v[98:99], v[32:35]
    s_waitcnt lgkmcnt(11)
    v_mfma_f32_16x16x16_bf16 v[32:35], v[68:69], v[100:101], v[32:35]
    s_waitcnt lgkmcnt(10)
    v_mfma_f32_16x16x16_bf16 v[32:35], v[70:71], v[102:103], v[32:35]
    s_waitcnt lgkmcnt(9)
    v_mfma_f32_16x16x16_bf16 v[32:35], v[72:73], v[104:105], v[32:35]
    s_waitcnt lgkmcnt(8)
    v_mfma_f32_16x16x16_bf16 v[32:35], v[74:75], v[106:107], v[32:35]
    s_waitcnt lgkmcnt(7)
    v_mfma_f32_16x16x16_bf16 v[32:35], v[76:77], v[108:109], v[32:35]
    s_waitcnt lgkmcnt(6)
    v_mfma_f32_16x16x16_bf16 v[32:35], v[78:79], v[110:111], v[32:35]
    s_waitcnt lgkmcnt(5)
    v_mfma_f32_16x16x16_bf16 v[32:35], v[80:81], v[112:113], v[32:35]
    s_waitcnt lgkmcnt(4)
    v_mfma_f32_16x16x16_bf16 v[32:35], v[82:83], v[114:115], v[32:35]
    s_waitcnt lgkmcnt(3)
    v_mfma_f32_16x16x16_bf16 v[32:35], v[84:85], v[116:117], v[32:35]
    s_waitcnt lgkmcnt(2)
    v_mfma_f32_16x16x16_bf16 v[32:35], v[86:87], v[118:119], v[32:35]
    s_waitcnt lgkmcnt(1)
    v_mfma_f32_16x16x16_bf16 v[32:35], v[88:89], v[120:121], v[32:35]
    s_waitcnt lgkmcnt(0)
    v_mfma_f32_16x16x16_bf16 v[32:35], v[90:91], v[122:123], v[32:35]
    s_nop 7
    v_mov_b32_dpp v36, v32 row_ror:8 row_mask:0xf bank_mask:0xf
    v_mov_b32_dpp v37, v33 row_ror:8 row_mask:0xf bank_mask:0xf
    v_mov_b32_dpp v38, v34 row_ror:8 row_mask:0xf bank_mask:0xf
    v_mov_b32_dpp v39, v35 row_ror:8 row_mask:0xf bank_mask:0xf
    v_permlane32_swap_b32 v36, v40
    v_permlane32_swap_b32 v37, v41
    v_permlane32_swap_b32 v38, v42
    v_permlane32_swap_b32 v39, v43
    v_pk_add_f32 v[32:33], v[32:33], v[40:41]
    v_pk_add_f32 v[34:35], v[34:35], v[42:43]
    v_and_or_b32 v32, v32, v23, s52
    v_and_or_b32 v33, v33, v23, s53
    v_and_or_b32 v34, v34, v23, s54
    v_and_or_b32 v35, v35, v23, s55
    s_mov_b64 exec, 0x00ff00ff
    buffer_store_dwordx4 v[32:35], v14, s[12:15], 0 offen sc1
    s_mov_b64 exec, -1
    s_lshl_b32 s48, s30, 3
    s_add_u32 s48, s48, s31
    s_cmp_lg_u32 s48, 1008
    s_cbranch_scc1 L_aux_done
    v_lshlrev_b32 v21, 3, v1
    v_add_u32 v21, 2048, v21
    s_mov_b32 s43, 0
L_poll_ack:
    buffer_load_dwordx2 v[60:61], v21, s[12:15], 0 offen sc1
    s_waitcnt vmcnt(0)
    v_xor_b32 v14, s29, v60
    v_bitop3_b32 v14, v14, v61, s29 bitop3:0xf6
    v_cmp_ne_u32 vcc, 0, v14
    s_cbranch_vccz L_polled_ack
    s_add_u32 s43, s43, 1
    s_cmp_ge_u32 s43, 65536
    s_cbranch_scc1 L_polled_ack
    s_sleep 4
    s_branch L_poll_ack
L_polled_ack:
    v_mov_b32 v5, s29
    v_mov_b32 v4, 0
    s_mov_b64 exec, 1
    buffer_store_dword v5, v4, s[12:15], 0 offen sc1
L_aux_done:
    s_endpgm
L_aux_slow:
    s_waitcnt lgkmcnt(0)
    v_lshlrev_b32 v14, 5, v0
    v_add_u32 v14, 140432, v14
    ds_write_b128 v14, v[80:83]
    ds_write_b128 v14, v[84:87] offset:16
    s_waitcnt lgkmcnt(0)
    s_mov_b64 exec, 1
    ds_add_u32 v22, v23 offset:256
    s_mov_b64 exec, -1
    s_mov_b32 s43, 0
L_lw_slow:
    ds_read_b32 v18, v22 offset:256
    s_add_u32 s43, s43, 1
    s_cmp_ge_u32 s43, 524288
    s_cbranch_scc1 L_lwx_slow
    s_waitcnt lgkmcnt(0)
    v_readfirstlane_b32 s46, v18
    s_cmp_ge_u32 s46, 4
    s_cbranch_scc1 L_lwx_slow
    s_branch L_lw_slow
L_lwx_slow:
    s_waitcnt lgkmcnt(0)
    v_lshlrev_b32 v14, 4, v1
    v_add_u32 v14, 140432, v14
    ds_read_b128 v[128:131], v14 offset:0
    ds_read_b128 v[132:135], v14 offset:1024
    ds_read_b128 v[136:139], v14 offset:2048
    ds_read_b128 v[140:143], v14 offset:3072
    ds_read_b128 v[144:147], v14 offset:4096
    ds_read_b128 v[148:151], v14 offset:5120
    ds_read_b128 v[152:155], v14 offset:6144
    ds_read_b128 v[156:159], v14 offset:7168
    s_waitcnt lgkmcnt(0)
    s_lshl_b32 s46, s31, 1
    s_add_u32 s46, s46, 2
    s_mov_b32 s49, 0
L_aux_slow2:
    v_max3_u32 v14, v128, v129, v130
    v_max3_u32 v14, v14, v131, v132
    v_max3_u32 v14, v14, v133, v134
    v_max3_u32 v14, v14, v135, v136
    v_max3_u32 v14, v14, v137, v138
    v_max3_u32 v14, v14, v139, v140
    v_max3_u32 v14, v14, v141, v142
    v_max3_u32 v14, v14, v143, v144
    v_max3_u32 v14, v14, v145, v146
    v_max3_u32 v14, v14, v147, v148
    v_max3_u32 v14, v14, v149, v150
    v_max3_u32 v14, v14, v151, v152
    v_max3_u32 v14, v14, v153, v154
    v_max3_u32 v14, v14, v155, v156
    v_max3_u32 v14, v14, v157, v158
    v_max_u32 v14, v14, v159
    s_nop 1
    v_max_u32_dpp v14, v14, v14 row_ror:8 row_mask:0xf bank_mask:0xf
    s_nop 1
    v_max_u32_dpp v14, v14, v14 row_ror:4 row_mask:0xf bank_mask:0xf
    s_nop 1
    v_max_u32_dpp v14, v14, v14 row_ror:2 row_mask:0xf bank_mask:0xf
    s_nop 1
    v_max_u32_dpp v14, v14, v14 row_ror:1 row_mask:0xf bank_mask:0xf
    v_mov_b32 v15, v14
    s_nop 1
    v_permlane16_swap_b32 v14, v15
    v_max_u32 v14, v14, v15
    v_mov_b32 v15, v14
    s_nop 1
    v_permlane32_swap_b32 v14, v15
    v_max_u32 v14, v14, v15
    s_mov_b32 s48, s49
    v_readfirstlane_b32 s49, v14
    v_cmp_ne_u32 vcc, v14, v128
    s_nop 1
    v_cndmask_b32 v128, 0, v128, vcc
    v_cmp_ne_u32 vcc, v14, v129
    s_nop 1
    v_cndmask_b32 v129, 0, v129, vcc
    v_cmp_ne_u32 vcc, v14, v130
    s_nop 1
    v_cndmask_b32 v130, 0, v130, vcc
    v_cmp_ne_u32 vcc, v14, v131
    s_nop 1
    v_cndmask_b32 v131, 0, v131, vcc
    v_cmp_ne_u32 vcc, v14, v132
    s_nop 1
    v_cndmask_b32 v132, 0, v132, vcc
    v_cmp_ne_u32 vcc, v14, v133
    s_nop 1
    v_cndmask_b32 v133, 0, v133, vcc
    v_cmp_ne_u32 vcc, v14, v134
    s_nop 1
    v_cndmask_b32 v134, 0, v134, vcc
    v_cmp_ne_u32 vcc, v14, v135
    s_nop 1
    v_cndmask_b32 v135, 0, v135, vcc
    v_cmp_ne_u32 vcc, v14, v136
    s_nop 1
    v_cndmask_b32 v136, 0, v136, vcc
    v_cmp_ne_u32 vcc, v14, v137
    s_nop 1
    v_cndmask_b32 v137, 0, v137, vcc
    v_cmp_ne_u32 vcc, v14, v138
    s_nop 1
    v_cndmask_b32 v138, 0, v138, vcc
    v_cmp_ne_u32 vcc, v14, v139
    s_nop 1
    v_cndmask_b32 v139, 0, v139, vcc
    v_cmp_ne_u32 vcc, v14, v140
    s_nop 1
    v_cndmask_b32 v140, 0, v140, vcc
    v_cmp_ne_u32 vcc, v14, v141
    s_nop 1
    v_cndmask_b32 v141, 0, v141, vcc
    v_cmp_ne_u32 vcc, v14, v142
    s_nop 1
    v_cndmask_b32 v142, 0, v142, vcc
    v_cmp_ne_u32 vcc, v14, v143
    s_nop 1
    v_cndmask_b32 v143, 0, v143, vcc
    v_cmp_ne_u32 vcc, v14, v144
    s_nop 1
    v_cndmask_b32 v144, 0, v144, vcc
    v_cmp_ne_u32 vcc, v14, v145
    s_nop 1
    v_cndmask_b32 v145, 0, v145, vcc
    v_cmp_ne_u32 vcc, v14, v146
    s_nop 1
    v_cndmask_b32 v146, 0, v146, vcc
    v_cmp_ne_u32 vcc, v14, v147
    s_nop 1
    v_cndmask_b32 v147, 0, v147, vcc
    v_cmp_ne_u32 vcc, v14, v148
    s_nop 1
    v_cndmask_b32 v148, 0, v148, vcc
    v_cmp_ne_u32 vcc, v14, v149
    s_nop 1
    v_cndmask_b32 v149, 0, v149, vcc
    v_cmp_ne_u32 vcc, v14, v150
    s_nop 1
    v_cndmask_b32 v150, 0, v150, vcc
    v_cmp_ne_u32 vcc, v14, v151
    s_nop 1
    v_cndmask_b32 v151, 0, v151, vcc
    v_cmp_ne_u32 vcc, v14, v152
    s_nop 1
    v_cndmask_b32 v152, 0, v152, vcc
    v_cmp_ne_u32 vcc, v14, v153
    s_nop 1
    v_cndmask_b32 v153, 0, v153, vcc
    v_cmp_ne_u32 vcc, v14, v154
    s_nop 1
    v_cndmask_b32 v154, 0, v154, vcc
    v_cmp_ne_u32 vcc, v14, v155
    s_nop 1
    v_cndmask_b32 v155, 0, v155, vcc
    v_cmp_ne_u32 vcc, v14, v156
    s_nop 1
    v_cndmask_b32 v156, 0, v156, vcc
    v_cmp_ne_u32 vcc, v14, v157
    s_nop 1
    v_cndmask_b32 v157, 0, v157, vcc
    v_cmp_ne_u32 vcc, v14, v158
    s_nop 1
    v_cndmask_b32 v158, 0, v158, vcc
    v_cmp_ne_u32 vcc, v14, v159
    s_nop 1
    v_cndmask_b32 v159, 0, v159, vcc
    s_sub_u32 s46, s46, 1
    s_cmp_lg_u32 s46, 0
    s_cbranch_scc1 L_aux_slow2
    s_branch L_aux_sel
L_exit:
    s_endpgm
.p2align 6
L_conv:
    s_and_b32 s56, s2, 7
    s_lshl_b32 s44, s56, 4
    s_add_u32 s44, s44, s3
    v_and_b32 v1, 63, v0
    v_and_b32 v2, 15, v0
    v_bfe_u32 v3, v0, 4, 2
    v_lshrrev_b32 v4, 6, v0
    s_nop 0
    v_readfirstlane_b32 s45, v4
    s_mov_b32 s40, 0x3fb8aa3b
    s_mov_b32 s41, 0x32a57060
    s_lshl_b32 s46, s44, 3
    s_add_u32 s46, s46, s45
    s_lshl_b32 s47, s46, 8
    s_lshl_b32 s48, s46, 1
    s_lshl_b32 s49, s44, 4
    v_lshl_add_u32 v4, v1, 2, s47
    v_mov_b32 v5, s48
    s_waitcnt lgkmcnt(0)
    s_load_dword s50, s[36:37], 0
    s_mov_b32 s26, 2048
    s_mov_b32 s27, 0x00020000
    s_mov_b32 s10, 262144
    s_mov_b32 s11, 0x00020000
    s_mov_b32 s14, 262144
    s_mov_b32 s15, 0x00020000
    s_mov_b32 s18, 262144
    s_mov_b32 s19, 0x00020000
    s_mov_b32 s22, 262144
    s_mov_b32 s23, 0x00020000
    s_mov_b32 s30, 2048
    s_mov_b32 s31, 0x00020000
    buffer_load_ushort v15, v5, s[24:27], 0 offen
    buffer_load_dword v16, v4, s[8:11], 0 offen nt
    buffer_load_dword v17, v4, s[12:15], 0 offen nt
    buffer_load_dword v18, v4, s[16:19], 0 offen nt
    buffer_load_dword v19, v4, s[20:23], 0 offen nt
    buffer_load_ushort v14, v5, s[28:31], 0 offen
    s_mov_b32 s6, 4194304
    s_mov_b32 s7, 0x00020000
    s_mov_b32 s34, 4194304
    s_mov_b32 s35, 0x00020000
    s_mov_b32 s38, 753664
    s_mov_b32 s39, 0x00020000
    v_lshlrev_b32 v9, 13, v0
    v_add_u32 v9, s49, v9
    s_lshl_b32 s57, s3, 7
    s_lshl_b32 s58, s45, 4
    s_add_u32 s57, s57, s58
    s_lshl_b32 s57, s57, 11
    s_lshl_b32 s58, s56, 8
    s_add_u32 s57, s57, s58
    v_lshrrev_b32 v11, 1, v1
    v_lshlrev_b32 v11, 11, v11
    v_and_b32 v10, 1, v1
    v_lshl_add_u32 v11, v10, 7, v11
    v_add_u32 v11, s57, v11
    s_mov_b32 s53, 4096
    s_cmp_lg_u32 s45, 7
    s_cbranch_scc1 L_conv_nocp
    s_cmp_gt_u32 s3, 1
    s_cbranch_scc1 L_conv_nocp
    s_getpc_b64 s[60:61]
L_pc_conv:
    s_add_u32 s60, s60, L_conv_kg-L_pc_conv
    s_addc_u32 s61, s61, 0
    s_mov_b32 s62, L_code_end-L_conv_kg
    s_mov_b32 s63, 0x00020000
    v_lshlrev_b32 v149, 7, v1
    buffer_load_dword v150, v149, s[60:63], 0 offen
    v_add_u32 v149, 8192, v149
    buffer_load_dword v150, v149, s[60:63], 0 offen
L_conv_nocp:
    s_mul_i32 s57, s45, 4096
    s_add_u32 s57, s57, 71680
    v_mov_b32 v64, 0
    v_mov_b32 v65, 0
    v_mov_b32 v66, 0
    v_mov_b32 v67, 0
    v_lshl_add_u32 v10, v1, 4, s57
    ds_write_b128 v10, v[64:67] offset:0
    ds_write_b128 v10, v[64:67] offset:1024
    ds_write_b128 v10, v[64:67] offset:2048
    ds_write_b128 v10, v[64:67] offset:3072
    v_lshlrev_b32 v4, 3, v3
    v_sub_u32 v4, v4, v2
    v_add_u32 v4, 15, v4
    v_min_u32 v4, 31, v4
    s_mov_b32 s43, 0x3e00000
    v_lshrrev_b32 v5, v4, s43
    v_bfe_i32 v6, v5, 0, 1
    v_bfe_i32 v7, v5, 1, 1
    v_and_b32 v6, 0x3f80, v6
    v_and_b32 v7, 0x3f800000, v7
    v_or_b32 v128, v6, v7
    v_bfe_i32 v6, v5, 2, 1
    v_bfe_i32 v7, v5, 3, 1
    v_and_b32 v6, 0x3f80, v6
    v_and_b32 v7, 0x3f800000, v7
    v_or_b32 v129, v6, v7
    v_bfe_i32 v6, v5, 4, 1
    v_bfe_i32 v7, v5, 5, 1
    v_and_b32 v6, 0x3f80, v6
    v_and_b32 v7, 0x3f800000, v7
    v_or_b32 v130, v6, v7
    v_bfe_i32 v6, v5, 6, 1
    v_bfe_i32 v7, v5, 7, 1
    v_and_b32 v6, 0x3f80, v6
    v_and_b32 v7, 0x3f800000, v7
    v_or_b32 v131, v6, v7
    s_mov_b32 s43, 0x1c0000
    v_lshrrev_b32 v5, v4, s43
    v_bfe_i32 v6, v5, 0, 1
    v_bfe_i32 v7, v5, 1, 1
    v_and_b32 v6, 0x3f80, v6
    v_and_b32 v7, 0x3f800000, v7
    v_or_b32 v132, v6, v7
    v_bfe_i32 v6, v5, 2, 1
    v_bfe_i32 v7, v5, 3, 1
    v_and_b32 v6, 0x3f80, v6
    v_and_b32 v7, 0x3f800000, v7
    v_or_b32 v133, v6, v7
    v_bfe_i32 v6, v5, 4, 1
    v_bfe_i32 v7, v5, 5, 1
    v_and_b32 v6, 0x3f80, v6
    v_and_b32 v7, 0x3f800000, v7
    v_or_b32 v134, v6, v7
    v_bfe_i32 v6, v5, 6, 1
    v_bfe_i32 v7, v5, 7, 1
    v_and_b32 v6, 0x3f80, v6
    v_and_b32 v7, 0x3f800000, v7
    v_or_b32 v135, v6, v7
    s_mov_b32 s43, 0xff80000
    v_lshrrev_b32 v5, v4, s43
    v_bfe_i32 v6, v5, 0, 1
    v_bfe_i32 v7, v5, 1, 1
    v_and_b32 v6, 0x3f80, v6
    v_and_b32 v7, 0x3f800000, v7
    v_or_b32 v136, v6, v7
    v_bfe_i32 v6, v5, 2, 1
    v_bfe_i32 v7, v5, 3, 1
    v_and_b32 v6, 0x3f80, v6
    v_and_b32 v7, 0x3f800000, v7
    v_or_b32 v137, v6, v7
    v_bfe_i32 v6, v5, 4, 1
    v_bfe_i32 v7, v5, 5, 1
    v_and_b32 v6, 0x3f80, v6
    v_and_b32 v7, 0x3f800000, v7
    v_or_b32 v138, v6, v7
    v_bfe_i32 v6, v5, 6, 1
    v_bfe_i32 v7, v5, 7, 1
    v_and_b32 v6, 0x3f80, v6
    v_and_b32 v7, 0x3f800000, v7
    v_or_b32 v139, v6, v7
    s_mov_b32 s43, 0x7f00000
    v_lshrrev_b32 v5, v4, s43
    v_bfe_i32 v6, v5, 0, 1
    v_bfe_i32 v7, v5, 1, 1
    v_and_b32 v6, 0x3f80, v6
    v_and_b32 v7, 0x3f800000, v7
    v_or_b32 v140, v6, v7
    v_bfe_i32 v6, v5, 2, 1
    v_bfe_i32 v7, v5, 3, 1
    v_and_b32 v6, 0x3f80, v6
    v_and_b32 v7, 0x3f800000, v7
    v_or_b32 v141, v6, v7
    v_bfe_i32 v6, v5, 4, 1
    v_bfe_i32 v7, v5, 5, 1
    v_and_b32 v6, 0x3f80, v6
    v_and_b32 v7, 0x3f800000, v7
    v_or_b32 v142, v6, v7
    v_bfe_i32 v6, v5, 6, 1
    v_bfe_i32 v7, v5, 7, 1
    v_and_b32 v6, 0x3f80, v6
    v_and_b32 v7, 0x3f800000, v7
    v_or_b32 v143, v6, v7
    s_mov_b32 s43, 0x18000000
    v_lshrrev_b32 v5, v4, s43
    v_bfe_i32 v6, v5, 0, 1
    v_bfe_i32 v7, v5, 1, 1
    v_and_b32 v6, 0xffff, v6
    v_and_b32 v7, 0xffff0000, v7
    v_or_b32 v124, v6, v7
    v_bfe_i32 v6, v5, 2, 1
    v_bfe_i32 v7, v5, 3, 1
    v_and_b32 v6, 0xffff, v6
    v_and_b32 v7, 0xffff0000, v7
    v_or_b32 v125, v6, v7
    v_bfe_i32 v6, v5, 4, 1
    v_bfe_i32 v7, v5, 5, 1
    v_and_b32 v6, 0xffff, v6
    v_and_b32 v7, 0xffff0000, v7
    v_or_b32 v126, v6, v7
    v_bfe_i32 v6, v5, 6, 1
    v_bfe_i32 v7, v5, 7, 1
    v_and_b32 v6, 0xffff, v6
    v_and_b32 v7, 0xffff0000, v7
    v_or_b32 v127, v6, v7
    v_lshlrev_b32 v10, 5, v2
    v_lshl_add_u32 v220, v3, 9, v10
    v_add_u32 v220, s57, v220
    v_add_u32 v220, 1084, v220
    v_and_b32 v12, 1, v3
    v_lshl_add_u32 v221, v12, 4, v10
    v_lshrrev_b32 v12, 1, v3
    v_lshl_add_u32 v221, v12, 9, v221
    v_add3_u32 v221, v221, s57, 64
    v_and_b32 v12, 1, v2
    v_lshrrev_b32 v13, 1, v2
    v_lshlrev_b32 v222, 2, v13
    v_lshl_add_u32 v222, v3, 6, v222
    v_mul_u32_u24 v13, 260, v12
    v_add3_u32 v222, v222, v13, s57
    v_add_u32 v222, 2172, v222
    v_lshlrev_b32 v223, 1, v2
    v_lshl_add_u32 v223, v3, 7, v223
    v_lshl_add_u32 v223, v12, 2, v223
    v_add_u32 v223, s57, v223
    v_add_u32 v223, 2812, v223
    v_mov_b32 v224, v223
    s_add_u32 s43, s57, 2428
    v_writelane_b32 v224, s43, 0
    v_lshl_add_u32 v10, v2, 2, s57
    v_lshlrev_b32 v12, 5, v3
    v_sub_u32 v225, v10, v12
    v_add_u32 v225, 104, v225
    v_add_u32 v226, 1024, v225
    v_add_u32 v227, 2048, v225
    v_lshlrev_b32 v12, 4, v3
    v_sub_u32 v228, v10, v12
    v_add_u32 v228, 2292, v228
    v_mov_b32 v229, 0
    v_writelane_b32 v229, -1, 0
    s_mov_b32 s58, 0
    s_mov_b32 s59, 1
    s_mul_i32 s54, s45, 8448
    s_mov_b32 m0, s54
    v_lshl_add_u32 v5, v1, 3, s54
    v_mul_u32_u24 v6, 528, v2
    v_and_b32 v10, 1, v3
    v_lshl_add_u32 v6, v10, 8, v6
    v_lshrrev_b32 v10, 1, v3
    v_lshl_add_u32 v6, v10, 4, v6
    v_add_u32 v6, s54, v6
    s_mul_i32 s51, s45, 4608
    v_lshlrev_b32 v10, 5, v2
    v_lshl_add_u32 v7, v3, 4, v10
    v_add3_u32 v7, v7, s51, 32
    s_mul_i32 s54, s45, 4160
    s_add_u32 s54, s54, 36864
    v_lshl_add_u32 v8, v3, 3, v10
    v_add_u32 v8, s54, v8
    s_waitcnt lgkmcnt(0)
    s_mul_i32 s52, s50, 0x9e3779b1
    s_add_u32 s52, s52, 0x7f4a7c15
    s_cmp_lg_u32 s45, 7
    s_cbranch_scc1 L_conv_w1
    s_cmp_gt_u32 s3, 1
    s_cbranch_scc1 L_conv_w1
    s_waitcnt vmcnt(2)
    s_branch L_conv_kg
L_conv_w1:
    s_waitcnt vmcnt(0)
L_conv_kg:
    s_mov_b32 exec_hi, 0
    buffer_load_dword v148, v11, s[4:7], 0 offen nt
    s_mov_b32 exec_hi, -1
    s_cmp_lg_u32 s45, 0
    s_cbranch_scc1 L_conv_noack
    s_lshl_b32 s50, s44, 2
    s_add_u32 s50, s50, 2048
    v_mov_b32 v10, s50
    v_mov_b32 v12, s52
    s_mov_b64 exec, 1
    buffer_store_dword v12, v10, s[36:39], 0 offen sc1
    s_mov_b64 exec, -1
L_conv_noack:
    v_lshlrev_b32 v15, 16, v15
    v_lshlrev_b32 v14, 16, v14
    v_mul_f32 v64, s40, v15
    v_fma_f32 v65, v15, s40, -v64
    v_fma_f32 v65, v15, s41, v65
    v_exp_f32 v76, v64
    v_mul_f32 v65, 0x3f317218, v65
    v_fma_f32 v76, v76, v65, v76
    v_add_f32 v14, 1.0, v14
    v_cvt_pk_bf16_f32 v76, v76, v76
    v_and_b32 v229, v229, v14
    v_and_b32 v76, 0xffff0000, v76
    v_lshlrev_b32 v66, 16, v16
    v_mul_f32 v64, s40, v66
    v_fma_f32 v65, v66, s40, -v64
    v_fma_f32 v65, v66, s41, v65
    v_exp_f32 v72, v64
    v_mul_f32 v65, 0x3f317218, v65
    v_fma_f32 v72, v72, v65, v72
    v_lshlrev_b32 v74, 16, v17
    v_lshlrev_b32 v32, 16, v18
    v_lshlrev_b32 v33, 16, v19
    v_and_b32 v66, 0xffff0000, v16
    v_mul_f32 v64, s40, v66
    v_fma_f32 v65, v66, s40, -v64
    v_fma_f32 v65, v66, s41, v65
    v_exp_f32 v73, v64
    v_mul_f32 v65, 0x3f317218, v65
    v_fma_f32 v73, v73, v65, v73
    v_and_b32 v75, 0xffff0000, v17
    v_and_b32 v34, 0xffff0000, v18
    v_and_b32 v35, 0xffff0000, v19
    v_cvt_pk_bf16_f32 v64, v72, v73
    v_add_f32 v77, v76, v76
    v_lshlrev_b32 v72, 16, v64
    v_and_b32 v73, 0xffff0000, v64
    v_pk_mul_f32 v[74:75], v[74:75], v[76:77] op_sel_hi:[1,0]
    v_pk_mul_f32 v[72:73], v[72:73], v[76:77] op_sel_hi:[1,0]
    v_pk_mul_f32 v[32:33], v[32:33], v[76:77] op_sel:[0,1] op_sel_hi:[1,1]
    v_mul_f32 v74, 0.15915494, v74
    v_mul_f32 v72, 0xbfb8aa3b, v72
    v_pk_mul_f32 v[34:35], v[34:35], v[76:77] op_sel:[0,1] op_sel_hi:[1,1]
    v_mul_f32 v75, 0.15915494, v75
    v_mul_f32 v73, 0xbfb8aa3b, v73
    v_mul_f32 v64, 0x41000000, v72
    v_mul_f32 v65, 0x41000000, v74
    v_exp_f32 v64, v64
    v_fract_f32 v65, v65
    v_cos_f32 v24, v65
    v_sin_f32 v25, v65
    v_mul_f32 v68, 0x41000000, v73
    v_mul_f32 v69, 0x41000000, v75
    v_exp_f32 v68, v68
    v_fract_f32 v69, v69
    v_cos_f32 v26, v69
    v_sin_f32 v27, v69
    v_pk_mul_f32 v[24:25], v[24:25], v[64:65] op_sel:[0,0] op_sel_hi:[1,0] neg_hi:[1,0]
    v_pk_mul_f32 v[26:27], v[26:27], v[68:69] op_sel:[0,0] op_sel_hi:[1,0] neg_hi:[1,0]
    v_exp_f32 v64, v72
    v_fract_f32 v65, v74
    v_cos_f32 v20, v65
    v_sin_f32 v21, v65
    v_exp_f32 v68, v73
    v_fract_f32 v69, v75
    v_cos_f32 v22, v69
    v_sin_f32 v23, v69
    v_pk_mul_f32 v[20:21], v[20:21], v[64:65] op_sel:[0,0] op_sel_hi:[1,0]
    v_pk_mul_f32 v[22:23], v[22:23], v[68:69] op_sel:[0,0] op_sel_hi:[1,0]
    v_mul_f32 v64, 0x43000000, v72
    v_mul_f32 v65, 0x43000000, v74
    v_exp_f32 v64, v64
    v_fract_f32 v65, v65
    v_cos_f32 v28, v65
    v_sin_f32 v29, v65
    v_mul_f32 v68, 0x43000000, v73
    v_mul_f32 v69, 0x43000000, v75
    v_exp_f32 v68, v68
    v_fract_f32 v69, v69
    v_cos_f32 v30, v69
    v_sin_f32 v31, v69
    v_pk_mul_f32 v[28:29], v[28:29], v[64:65] op_sel:[0,0] op_sel_hi:[1,0]
    v_pk_mul_f32 v[30:31], v[30:31], v[68:69] op_sel:[0,0] op_sel_hi:[1,0]
    v_mov_b32 v68, 0x3f80
    v_mov_b32 v69, 0x3f80
    ds_write_addtid_b32 v68 offset:0
    ds_write_addtid_b32 v69 offset:256
    v_cvt_pk_bf16_f32 v70, v24, v25
    v_cvt_pk_bf16_f32 v71, v26, v27
    ds_write_addtid_b32 v70 offset:528
    ds_write_addtid_b32 v71 offset:784
    v_pk_mul_f32 v[64:65], v[24:25], v[24:25] op_sel:[1,1] op_sel_hi:[1,0] neg_lo:[1,0]
    v_pk_mul_f32 v[66:67], v[26:27], v[26:27] op_sel:[1,1] op_sel_hi:[1,0] neg_lo:[1,0]
    v_pk_fma_f32 v[12:13], v[24:25], v[24:25], v[64:65] op_sel:[0,0,0] op_sel_hi:[0,1,1]
    v_pk_fma_f32 v[14:15], v[26:27], v[26:27], v[66:67] op_sel:[0,0,0] op_sel_hi:[0,1,1]
    v_cvt_pk_bf16_f32 v68, v12, v13
    v_cvt_pk_bf16_f32 v69, v14, v15
    ds_write_addtid_b32 v68 offset:1056
    ds_write_addtid_b32 v69 offset:1312
    v_pk_mul_f32 v[64:65], v[12:13], v[24:25] op_sel:[1,1] op_sel_hi:[1,0] neg_lo:[1,0]
    v_pk_mul_f32 v[66:67], v[14:15], v[26:27] op_sel:[1,1] op_sel_hi:[1,0] neg_lo:[1,0]
    v_pk_fma_f32 v[12:13], v[12:13], v[24:25], v[64:65] op_sel:[0,0,0] op_sel_hi:[0,1,1]
    v_pk_fma_f32 v[14:15], v[14:15], v[26:27], v[66:67] op_sel:[0,0,0] op_sel_hi:[0,1,1]
    v_cvt_pk_bf16_f32 v70, v12, v13
    v_cvt_pk_bf16_f32 v71, v14, v15
    ds_write_addtid_b32 v70 offset:1584
    ds_write_addtid_b32 v71 offset:1840
    v_pk_mul_f32 v[64:65], v[12:13], v[24:25] op_sel:[1,1] op_sel_hi:[1,0] neg_lo:[1,0]
    v_pk_mul_f32 v[66:67], v[14:15], v[26:27] op_sel:[1,1] op_sel_hi:[1,0] neg_lo:[1,0]
    v_pk_fma_f32 v[12:13], v[12:13], v[24:25], v[64:65] op_sel:[0,0,0] op_sel_hi:[0,1,1]
    v_pk_fma_f32 v[14:15], v[14:15], v[26:27], v[66:67] op_sel:[0,0,0] op_sel_hi:[0,1,1]
    v_cvt_pk_bf16_f32 v68, v12, v13
    v_cvt_pk_bf16_f32 v69, v14, v15
    ds_write_addtid_b32 v68 offset:2112
    ds_write_addtid_b32 v69 offset:2368
    v_pk_mul_f32 v[64:65], v[12:13], v[24:25] op_sel:[1,1] op_sel_hi:[1,0] neg_lo:[1,0]
    v_pk_mul_f32 v[66:67], v[14:15], v[26:27] op_sel:[1,1] op_sel_hi:[1,0] neg_lo:[1,0]
    v_pk_fma_f32 v[12:13], v[12:13], v[24:25], v[64:65] op_sel:[0,0,0] op_sel_hi:[0,1,1]
    v_pk_fma_f32 v[14:15], v[14:15], v[26:27], v[66:67] op_sel:[0,0,0] op_sel_hi:[0,1,1]
    v_cvt_pk_bf16_f32 v70, v12, v13
    v_cvt_pk_bf16_f32 v71, v14, v15
    ds_write_addtid_b32 v70 offset:2640
    ds_write_addtid_b32 v71 offset:2896
    v_pk_mul_f32 v[64:65], v[12:13], v[24:25] op_sel:[1,1] op_sel_hi:[1,0] neg_lo:[1,0]
    v_pk_mul_f32 v[66:67], v[14:15], v[26:27] op_sel:[1,1] op_sel_hi:[1,0] neg_lo:[1,0]
    v_pk_fma_f32 v[12:13], v[12:13], v[24:25], v[64:65] op_sel:[0,0,0] op_sel_hi:[0,1,1]
    v_pk_fma_f32 v[14:15], v[14:15], v[26:27], v[66:67] op_sel:[0,0,0] op_sel_hi:[0,1,1]
    v_cvt_pk_bf16_f32 v68, v12, v13
    v_cvt_pk_bf16_f32 v69, v14, v15
    ds_write_addtid_b32 v68 offset:3168
    ds_write_addtid_b32 v69 offset:3424
    v_pk_mul_f32 v[64:65], v[12:13], v[24:25] op_sel:[1,1] op_sel_hi:[1,0] neg_lo:[1,0]
    v_pk_mul_f32 v[66:67], v[14:15], v[26:27] op_sel:[1,1] op_sel_hi:[1,0] neg_lo:[1,0]
    v_pk_fma_f32 v[12:13], v[12:13], v[24:25], v[64:65] op_sel:[0,0,0] op_sel_hi:[0,1,1]
    v_pk_fma_f32 v[14:15], v[14:15], v[26:27], v[66:67] op_sel:[0,0,0] op_sel_hi:[0,1,1]
    v_cvt_pk_bf16_f32 v70, v12, v13
    v_cvt_pk_bf16_f32 v71, v14, v15
    ds_write_addtid_b32 v70 offset:3696
    ds_write_addtid_b32 v71 offset:3952
    v_pk_mul_f32 v[64:65], v[12:13], v[24:25] op_sel:[1,1] op_sel_hi:[1,0] neg_lo:[1,0]
    v_pk_mul_f32 v[66:67], v[14:15], v[26:27] op_sel:[1,1] op_sel_hi:[1,0] neg_lo:[1,0]
    v_pk_fma_f32 v[12:13], v[12:13], v[24:25], v[64:65] op_sel:[0,0,0] op_sel_hi:[0,1,1]
    v_pk_fma_f32 v[14:15], v[14:15], v[26:27], v[66:67] op_sel:[0,0,0] op_sel_hi:[0,1,1]
    v_cvt_pk_bf16_f32 v68, v12, v13
    v_cvt_pk_bf16_f32 v69, v14, v15
    ds_write_addtid_b32 v68 offset:4224
    ds_write_addtid_b32 v69 offset:4480
    v_pk_mul_f32 v[64:65], v[12:13], v[24:25] op_sel:[1,1] op_sel_hi:[1,0] neg_lo:[1,0]
    v_pk_mul_f32 v[66:67], v[14:15], v[26:27] op_sel:[1,1] op_sel_hi:[1,0] neg_lo:[1,0]
    v_pk_fma_f32 v[12:13], v[12:13], v[24:25], v[64:65] op_sel:[0,0,0] op_sel_hi:[0,1,1]
    v_pk_fma_f32 v[14:15], v[14:15], v[26:27], v[66:67] op_sel:[0,0,0] op_sel_hi:[0,1,1]
    v_cvt_pk_bf16_f32 v70, v12, v13
    v_cvt_pk_bf16_f32 v71, v14, v15
    ds_write_addtid_b32 v70 offset:4752
    ds_write_addtid_b32 v71 offset:5008
    v_pk_mul_f32 v[64:65], v[12:13], v[24:25] op_sel:[1,1] op_sel_hi:[1,0] neg_lo:[1,0]
    v_pk_mul_f32 v[66:67], v[14:15], v[26:27] op_sel:[1,1] op_sel_hi:[1,0] neg_lo:[1,0]
    v_pk_fma_f32 v[12:13], v[12:13], v[24:25], v[64:65] op_sel:[0,0,0] op_sel_hi:[0,1,1]
    v_pk_fma_f32 v[14:15], v[14:15], v[26:27], v[66:67] op_sel:[0,0,0] op_sel_hi:[0,1,1]
    v_cvt_pk_bf16_f32 v68, v12, v13
    v_cvt_pk_bf16_f32 v69, v14, v15
    ds_write_addtid_b32 v68 offset:5280
    ds_write_addtid_b32 v69 offset:5536
    v_pk_mul_f32 v[64:65], v[12:13], v[24:25] op_sel:[1,1] op_sel_hi:[1,0] neg_lo:[1,0]
    v_pk_mul_f32 v[66:67], v[14:15], v[26:27] op_sel:[1,1] op_sel_hi:[1,0] neg_lo:[1,0]
    v_pk_fma_f32 v[12:13], v[12:13], v[24:25], v[64:65] op_sel:[0,0,0] op_sel_hi:[0,1,1]
    v_pk_fma_f32 v[14:15], v[14:15], v[26:27], v[66:67] op_sel:[0,0,0] op_sel_hi:[0,1,1]
    v_cvt_pk_bf16_f32 v70, v12, v13
    v_cvt_pk_bf16_f32 v71, v14, v15
    ds_write_addtid_b32 v70 offset:5808
    ds_write_addtid_b32 v71 offset:6064
    v_pk_mul_f32 v[64:65], v[12:13], v[24:25] op_sel:[1,1] op_sel_hi:[1,0] neg_lo:[1,0]
    v_pk_mul_f32 v[66:67], v[14:15], v[26:27] op_sel:[1,1] op_sel_hi:[1,0] neg_lo:[1,0]
    s_waitcnt vmcnt(0)
    buffer_load_dwordx4 v[240:243], v9, s[4:7], 0 offen offset:0
    v_pk_fma_f32 v[12:13], v[12:13], v[24:25], v[64:65] op_sel:[0,0,0] op_sel_hi:[0,1,1]
    v_pk_fma_f32 v[14:15], v[14:15], v[26:27], v[66:67] op_sel:[0,0,0] op_sel_hi:[0,1,1]
    v_cvt_pk_bf16_f32 v68, v12, v13
    v_cvt_pk_bf16_f32 v69, v14, v15
    ds_write_addtid_b32 v68 offset:6336
    ds_write_addtid_b32 v69 offset:6592
    v_pk_mul_f32 v[64:65], v[12:13], v[24:25] op_sel:[1,1] op_sel_hi:[1,0] neg_lo:[1,0]
    v_pk_mul_f32 v[66:67], v[14:15], v[26:27] op_sel:[1,1] op_sel_hi:[1,0] neg_lo:[1,0]
    v_pk_fma_f32 v[12:13], v[12:13], v[24:25], v[64:65] op_sel:[0,0,0] op_sel_hi:[0,1,1]
    v_pk_fma_f32 v[14:15], v[14:15], v[26:27], v[66:67] op_sel:[0,0,0] op_sel_hi:[0,1,1]
    v_cvt_pk_bf16_f32 v70, v12, v13
    v_cvt_pk_bf16_f32 v71, v14, v15
    ds_write_addtid_b32 v70 offset:6864
    ds_write_addtid_b32 v71 offset:7120
    v_pk_mul_f32 v[64:65], v[12:13], v[24:25] op_sel:[1,1] op_sel_hi:[1,0] neg_lo:[1,0]
    v_pk_mul_f32 v[66:67], v[14:15], v[26:27] op_sel:[1,1] op_sel_hi:[1,0] neg_lo:[1,0]
    v_pk_fma_f32 v[12:13], v[12:13], v[24:25], v[64:65] op_sel:[0,0,0] op_sel_hi:[0,1,1]
    v_pk_fma_f32 v[14:15], v[14:15], v[26:27], v[66:67] op_sel:[0,0,0] op_sel_hi:[0,1,1]
    v_cvt_pk_bf16_f32 v68, v12, v13
    v_cvt_pk_bf16_f32 v69, v14, v15
    ds_write_addtid_b32 v68 offset:7392
    ds_write_addtid_b32 v69 offset:7648
    v_pk_mul_f32 v[64:65], v[12:13], v[24:25] op_sel:[1,1] op_sel_hi:[1,0] neg_lo:[1,0]
    v_pk_mul_f32 v[66:67], v[14:15], v[26:27] op_sel:[1,1] op_sel_hi:[1,0] neg_lo:[1,0]
    v_pk_fma_f32 v[12:13], v[12:13], v[24:25], v[64:65] op_sel:[0,0,0] op_sel_hi:[0,1,1]
    v_pk_fma_f32 v[14:15], v[14:15], v[26:27], v[66:67] op_sel:[0,0,0] op_sel_hi:[0,1,1]
    v_cvt_pk_bf16_f32 v70, v12, v13
    v_cvt_pk_bf16_f32 v71, v14, v15
    ds_write_addtid_b32 v70 offset:7920
    ds_write_addtid_b32 v71 offset:8176
    ds_read_b128 v[80:83], v6 offset:0
    ds_read_b128 v[84:87], v6 offset:32
    ds_read_b128 v[88:91], v6 offset:64
    ds_read_b128 v[92:95], v6 offset:96
    ds_read_b128 v[96:99], v6 offset:128
    ds_read_b128 v[100:103], v6 offset:160
    ds_read_b128 v[104:107], v6 offset:192
    ds_read_b128 v[108:111], v6 offset:224
    v_cvt_pk_bf16_f32 v68, v32, v33
    v_cvt_pk_bf16_f32 v69, v34, v35
    ds_write_addtid_b32 v68 offset:0
    ds_write_addtid_b32 v69 offset:256
    v_pk_mul_f32 v[64:65], v[32:33], v[20:21] op_sel:[1,1] op_sel_hi:[1,0] neg_lo:[1,0]
    v_pk_mul_f32 v[66:67], v[34:35], v[22:23] op_sel:[1,1] op_sel_hi:[1,0] neg_lo:[1,0]
    v_pk_fma_f32 v[36:37], v[32:33], v[20:21], v[64:65] op_sel:[0,0,0] op_sel_hi:[0,1,1]
    v_pk_fma_f32 v[38:39], v[34:35], v[22:23], v[66:67] op_sel:[0,0,0] op_sel_hi:[0,1,1]
    v_cvt_pk_bf16_f32 v70, v36, v37
    v_cvt_pk_bf16_f32 v71, v38, v39
    ds_write_addtid_b32 v70 offset:528
    ds_write_addtid_b32 v71 offset:784
    v_pk_mul_f32 v[64:65], v[36:37], v[20:21] op_sel:[1,1] op_sel_hi:[1,0] neg_lo:[1,0]
    v_pk_mul_f32 v[66:67], v[38:39], v[22:23] op_sel:[1,1] op_sel_hi:[1,0] neg_lo:[1,0]
    v_pk_fma_f32 v[40:41], v[36:37], v[20:21], v[64:65] op_sel:[0,0,0] op_sel_hi:[0,1,1]
    v_pk_fma_f32 v[42:43], v[38:39], v[22:23], v[66:67] op_sel:[0,0,0] op_sel_hi:[0,1,1]
    v_cvt_pk_bf16_f32 v68, v40, v41
    v_cvt_pk_bf16_f32 v69, v42, v43
    ds_write_addtid_b32 v68 offset:1056
    ds_write_addtid_b32 v69 offset:1312
    v_pk_mul_f32 v[64:65], v[40:41], v[20:21] op_sel:[1,1] op_sel_hi:[1,0] neg_lo:[1,0]
    v_pk_mul_f32 v[66:67], v[42:43], v[22:23] op_sel:[1,1] op_sel_hi:[1,0] neg_lo:[1,0]
    v_pk_fma_f32 v[44:45], v[40:41], v[20:21], v[64:65] op_sel:[0,0,0] op_sel_hi:[0,1,1]
    v_pk_fma_f32 v[46:47], v[42:43], v[22:23], v[66:67] op_sel:[0,0,0] op_sel_hi:[0,1,1]
    v_cvt_pk_bf16_f32 v70, v44, v45
    v_cvt_pk_bf16_f32 v71, v46, v47
    ds_write_addtid_b32 v70 offset:1584
    ds_write_addtid_b32 v71 offset:1840
    v_pk_mul_f32 v[64:65], v[44:45], v[20:21] op_sel:[1,1] op_sel_hi:[1,0] neg_lo:[1,0]
    v_pk_mul_f32 v[66:67], v[46:47], v[22:23] op_sel:[1,1] op_sel_hi:[1,0] neg_lo:[1,0]
    v_pk_fma_f32 v[48:49], v[44:45], v[20:21], v[64:65] op_sel:[0,0,0] op_sel_hi:[0,1,1]
    v_pk_fma_f32 v[50:51], v[46:47], v[22:23], v[66:67] op_sel:[0,0,0] op_sel_hi:[0,1,1]
    v_cvt_pk_bf16_f32 v68, v48, v49
    v_cvt_pk_bf16_f32 v69, v50, v51
    ds_write_addtid_b32 v68 offset:2112
    ds_write_addtid_b32 v69 offset:2368
    v_pk_mul_f32 v[64:65], v[48:49], v[20:21] op_sel:[1,1] op_sel_hi:[1,0] neg_lo:[1,0]
    v_pk_mul_f32 v[66:67], v[50:51], v[22:23] op_sel:[1,1] op_sel_hi:[1,0] neg_lo:[1,0]
    v_pk_fma_f32 v[52:53], v[48:49], v[20:21], v[64:65] op_sel:[0,0,0] op_sel_hi:[0,1,1]
    v_pk_fma_f32 v[54:55], v[50:51], v[22:23], v[66:67] op_sel:[0,0,0] op_sel_hi:[0,1,1]
    v_cvt_pk_bf16_f32 v70, v52, v53
    v_cvt_pk_bf16_f32 v71, v54, v55
    ds_write_addtid_b32 v70 offset:2640
    ds_write_addtid_b32 v71 offset:2896
    v_pk_mul_f32 v[64:65], v[52:53], v[20:21] op_sel:[1,1] op_sel_hi:[1,0] neg_lo:[1,0]
    v_pk_mul_f32 v[66:67], v[54:55], v[22:23] op_sel:[1,1] op_sel_hi:[1,0] neg_lo:[1,0]
    v_pk_fma_f32 v[56:57], v[52:53], v[20:21], v[64:65] op_sel:[0,0,0] op_sel_hi:[0,1,1]
    v_pk_fma_f32 v[58:59], v[54:55], v[22:23], v[66:67] op_sel:[0,0,0] op_sel_hi:[0,1,1]
    buffer_load_dwordx4 v[244:247], v9, s[4:7], 0 offen offset:2048
    v_cvt_pk_bf16_f32 v68, v56, v57
    v_cvt_pk_bf16_f32 v69, v58, v59
    ds_write_addtid_b32 v68 offset:3168
    ds_write_addtid_b32 v69 offset:3424
    v_pk_mul_f32 v[64:65], v[56:57], v[20:21] op_sel:[1,1] op_sel_hi:[1,0] neg_lo:[1,0]
    v_pk_mul_f32 v[66:67], v[58:59], v[22:23] op_sel:[1,1] op_sel_hi:[1,0] neg_lo:[1,0]
    v_pk_fma_f32 v[60:61], v[56:57], v[20:21], v[64:65] op_sel:[0,0,0] op_sel_hi:[0,1,1]
    v_pk_fma_f32 v[62:63], v[58:59], v[22:23], v[66:67] op_sel:[0,0,0] op_sel_hi:[0,1,1]
    v_cvt_pk_bf16_f32 v70, v60, v61
    v_cvt_pk_bf16_f32 v71, v62, v63
    ds_write_addtid_b32 v70 offset:3696
    ds_write_addtid_b32 v71 offset:3952
    v_pk_mul_f32 v[64:65], v[32:33], v[28:29] op_sel:[1,1] op_sel_hi:[1,0] neg_lo:[1,0]
    v_pk_mul_f32 v[66:67], v[34:35], v[30:31] op_sel:[1,1] op_sel_hi:[1,0] neg_lo:[1,0]
    v_pk_fma_f32 v[32:33], v[32:33], v[28:29], v[64:65] op_sel:[0,0,0] op_sel_hi:[0,1,1]
    v_pk_fma_f32 v[34:35], v[34:35], v[30:31], v[66:67] op_sel:[0,0,0] op_sel_hi:[0,1,1]
    v_cvt_pk_bf16_f32 v68, v32, v33
    v_cvt_pk_bf16_f32 v69, v34, v35
    ds_write_addtid_b32 v68 offset:4224
    ds_write_addtid_b32 v69 offset:4480
    v_pk_mul_f32 v[64:65], v[36:37], v[28:29] op_sel:[1,1] op_sel_hi:[1,0] neg_lo:[1,0]
    v_pk_mul_f32 v[66:67], v[38:39], v[30:31] op_sel:[1,1] op_sel_hi:[1,0] neg_lo:[1,0]
    v_pk_fma_f32 v[36:37], v[36:37], v[28:29], v[64:65] op_sel:[0,0,0] op_sel_hi:[0,1,1]
    v_pk_fma_f32 v[38:39], v[38:39], v[30:31], v[66:67] op_sel:[0,0,0] op_sel_hi:[0,1,1]
    v_cvt_pk_bf16_f32 v70, v36, v37
    v_cvt_pk_bf16_f32 v71, v38, v39
    ds_write_addtid_b32 v70 offset:4752
    ds_write_addtid_b32 v71 offset:5008
    v_pk_mul_f32 v[64:65], v[40:41], v[28:29] op_sel:[1,1] op_sel_hi:[1,0] neg_lo:[1,0]
    v_pk_mul_f32 v[66:67], v[42:43], v[30:31] op_sel:[1,1] op_sel_hi:[1,0] neg_lo:[1,0]
    v_pk_fma_f32 v[40:41], v[40:41], v[28:29], v[64:65] op_sel:[0,0,0] op_sel_hi:[0,1,1]
    v_pk_fma_f32 v[42:43], v[42:43], v[30:31], v[66:67] op_sel:[0,0,0] op_sel_hi:[0,1,1]
    v_cvt_pk_bf16_f32 v68, v40, v41
    v_cvt_pk_bf16_f32 v69, v42, v43
    ds_write_addtid_b32 v68 offset:5280
    ds_write_addtid_b32 v69 offset:5536
    v_pk_mul_f32 v[64:65], v[44:45], v[28:29] op_sel:[1,1] op_sel_hi:[1,0] neg_lo:[1,0]
    v_pk_mul_f32 v[66:67], v[46:47], v[30:31] op_sel:[1,1] op_sel_hi:[1,0] neg_lo:[1,0]
    v_pk_fma_f32 v[44:45], v[44:45], v[28:29], v[64:65] op_sel:[0,0,0] op_sel_hi:[0,1,1]
    v_pk_fma_f32 v[46:47], v[46:47], v[30:31], v[66:67] op_sel:[0,0,0] op_sel_hi:[0,1,1]
    v_cvt_pk_bf16_f32 v70, v44, v45
    v_cvt_pk_bf16_f32 v71, v46, v47
    ds_write_addtid_b32 v70 offset:5808
    ds_write_addtid_b32 v71 offset:6064
    v_pk_mul_f32 v[64:65], v[48:49], v[28:29] op_sel:[1,1] op_sel_hi:[1,0] neg_lo:[1,0]
    v_pk_mul_f32 v[66:67], v[50:51], v[30:31] op_sel:[1,1] op_sel_hi:[1,0] neg_lo:[1,0]
    v_pk_fma_f32 v[48:49], v[48:49], v[28:29], v[64:65] op_sel:[0,0,0] op_sel_hi:[0,1,1]
    v_pk_fma_f32 v[50:51], v[50:51], v[30:31], v[66:67] op_sel:[0,0,0] op_sel_hi:[0,1,1]
    v_cvt_pk_bf16_f32 v68, v48, v49
    v_cvt_pk_bf16_f32 v69, v50, v51
    ds_write_addtid_b32 v68 offset:6336
    ds_write_addtid_b32 v69 offset:6592
    v_pk_mul_f32 v[64:65], v[52:53], v[28:29] op_sel:[1,1] op_sel_hi:[1,0] neg_lo:[1,0]
    v_pk_mul_f32 v[66:67], v[54:55], v[30:31] op_sel:[1,1] op_sel_hi:[1,0] neg_lo:[1,0]
    v_pk_fma_f32 v[52:53], v[52:53], v[28:29], v[64:65] op_sel:[0,0,0] op_sel_hi:[0,1,1]
    v_pk_fma_f32 v[54:55], v[54:55], v[30:31], v[66:67] op_sel:[0,0,0] op_sel_hi:[0,1,1]
    v_cvt_pk_bf16_f32 v70, v52, v53
    v_cvt_pk_bf16_f32 v71, v54, v55
    ds_write_addtid_b32 v70 offset:6864
    ds_write_addtid_b32 v71 offset:7120
    v_pk_mul_f32 v[64:65], v[56:57], v[28:29] op_sel:[1,1] op_sel_hi:[1,0] neg_lo:[1,0]
    v_pk_mul_f32 v[66:67], v[58:59], v[30:31] op_sel:[1,1] op_sel_hi:[1,0] neg_lo:[1,0]
    v_pk_fma_f32 v[56:57], v[56:57], v[28:29], v[64:65] op_sel:[0,0,0] op_sel_hi:[0,1,1]
    v_pk_fma_f32 v[58:59], v[58:59], v[30:31], v[66:67] op_sel:[0,0,0] op_sel_hi:[0,1,1]
    v_cvt_pk_bf16_f32 v68, v56, v57
    v_cvt_pk_bf16_f32 v69, v58, v59
    ds_write_addtid_b32 v68 offset:7392
    ds_write_addtid_b32 v69 offset:7648
    v_pk_mul_f32 v[64:65], v[60:61], v[28:29] op_sel:[1,1] op_sel_hi:[1,0] neg_lo:[1,0]
    v_pk_mul_f32 v[66:67], v[62:63], v[30:31] op_sel:[1,1] op_sel_hi:[1,0] neg_lo:[1,0]
    v_pk_fma_f32 v[60:61], v[60:61], v[28:29], v[64:65] op_sel:[0,0,0] op_sel_hi:[0,1,1]
    v_pk_fma_f32 v[62:63], v[62:63], v[30:31], v[66:67] op_sel:[0,0,0] op_sel_hi:[0,1,1]
    v_cvt_pk_bf16_f32 v70, v60, v61
    v_cvt_pk_bf16_f32 v71, v62, v63
    ds_write_addtid_b32 v70 offset:7920
    ds_write_addtid_b32 v71 offset:8176
    ds_read_b128 v[176:179], v6 offset:0
    ds_read_b128 v[180:183], v6 offset:32
    ds_read_b128 v[184:187], v6 offset:64
    ds_read_b128 v[188:191], v6 offset:96
    ds_read_b128 v[192:195], v6 offset:128
    ds_read_b128 v[196:199], v6 offset:160
    ds_read_b128 v[200:203], v6 offset:192
    ds_read_b128 v[204:207], v6 offset:224
    v_pk_mul_f32 v[64:65], v[32:33], v[28:29] op_sel:[1,1] op_sel_hi:[1,0] neg_lo:[1,0]
    v_pk_mul_f32 v[66:67], v[34:35], v[30:31] op_sel:[1,1] op_sel_hi:[1,0] neg_lo:[1,0]
    buffer_load_dwordx4 v[248:251], v9, s[4:7], s53 offen offset:0
    v_pk_fma_f32 v[32:33], v[32:33], v[28:29], v[64:65] op_sel:[0,0,0] op_sel_hi:[0,1,1]
    v_pk_fma_f32 v[34:35], v[34:35], v[30:31], v[66:67] op_sel:[0,0,0] op_sel_hi:[0,1,1]
    v_cvt_pk_bf16_f32 v68, v32, v33
    v_cvt_pk_bf16_f32 v69, v34, v35
    ds_write_addtid_b32 v68 offset:0
    ds_write_addtid_b32 v69 offset:256
    v_pk_mul_f32 v[64:65], v[40:41], v[28:29] op_sel:[1,1] op_sel_hi:[1,0] neg_lo:[1,0]
    v_pk_mul_f32 v[66:67], v[42:43], v[30:31] op_sel:[1,1] op_sel_hi:[1,0] neg_lo:[1,0]
    v_pk_fma_f32 v[40:41], v[40:41], v[28:29], v[64:65] op_sel:[0,0,0] op_sel_hi:[0,1,1]
    v_pk_fma_f32 v[42:43], v[42:43], v[30:31], v[66:67] op_sel:[0,0,0] op_sel_hi:[0,1,1]
    v_cvt_pk_bf16_f32 v70, v40, v41
    v_cvt_pk_bf16_f32 v71, v42, v43
    ds_write_addtid_b32 v70 offset:528
    ds_write_addtid_b32 v71 offset:784
    v_pk_mul_f32 v[64:65], v[48:49], v[28:29] op_sel:[1,1] op_sel_hi:[1,0] neg_lo:[1,0]
    v_pk_mul_f32 v[66:67], v[50:51], v[30:31] op_sel:[1,1] op_sel_hi:[1,0] neg_lo:[1,0]
    v_pk_fma_f32 v[48:49], v[48:49], v[28:29], v[64:65] op_sel:[0,0,0] op_sel_hi:[0,1,1]
    v_pk_fma_f32 v[50:51], v[50:51], v[30:31], v[66:67] op_sel:[0,0,0] op_sel_hi:[0,1,1]
    v_cvt_pk_bf16_f32 v68, v48, v49
    v_cvt_pk_bf16_f32 v69, v50, v51
    ds_write_addtid_b32 v68 offset:1056
    ds_write_addtid_b32 v69 offset:1312
    v_pk_mul_f32 v[64:65], v[56:57], v[28:29] op_sel:[1,1] op_sel_hi:[1,0] neg_lo:[1,0]
    v_pk_mul_f32 v[66:67], v[58:59], v[30:31] op_sel:[1,1] op_sel_hi:[1,0] neg_lo:[1,0]
    v_pk_fma_f32 v[56:57], v[56:57], v[28:29], v[64:65] op_sel:[0,0,0] op_sel_hi:[0,1,1]
    v_pk_fma_f32 v[58:59], v[58:59], v[30:31], v[66:67] op_sel:[0,0,0] op_sel_hi:[0,1,1]
    v_cvt_pk_bf16_f32 v70, v56, v57
    v_cvt_pk_bf16_f32 v71, v58, v59
    ds_write_addtid_b32 v70 offset:1584
    ds_write_addtid_b32 v71 offset:1840
    s_waitcnt lgkmcnt(15)
    v_mfma_f32_16x16x32_bf16 v[208:211], v[176:179], v[80:83], 0
    v_pk_mul_f32 v[64:65], v[32:33], v[28:29] op_sel:[1,1] op_sel_hi:[1,0] neg_lo:[1,0]
    v_pk_mul_f32 v[66:67], v[34:35], v[30:31] op_sel:[1,1] op_sel_hi:[1,0] neg_lo:[1,0]
    v_pk_fma_f32 v[32:33], v[32:33], v[28:29], v[64:65] op_sel:[0,0,0] op_sel_hi:[0,1,1]
    v_pk_fma_f32 v[34:35], v[34:35], v[30:31], v[66:67] op_sel:[0,0,0] op_sel_hi:[0,1,1]
    v_cvt_pk_bf16_f32 v68, v32, v33
    v_cvt_pk_bf16_f32 v69, v34, v35
    ds_write_addtid_b32 v68 offset:2112
    ds_write_addtid_b32 v69 offset:2368
    s_waitcnt lgkmcnt(15)
    v_mfma_f32_16x16x32_bf16 v[208:211], v[180:183], v[84:87], v[208:211]
    v_pk_mul_f32 v[64:65], v[40:41], v[28:29] op_sel:[1,1] op_sel_hi:[1,0] neg_lo:[1,0]
    v_pk_mul_f32 v[66:67], v[42:43], v[30:31] op_sel:[1,1] op_sel_hi:[1,0] neg_lo:[1,0]
    v_pk_fma_f32 v[40:41], v[40:41], v[28:29], v[64:65] op_sel:[0,0,0] op_sel_hi:[0,1,1]
    v_pk_fma_f32 v[42:43], v[42:43], v[30:31], v[66:67] op_sel:[0,0,0] op_sel_hi:[0,1,1]
    v_cvt_pk_bf16_f32 v70, v40, v41
    v_cvt_pk_bf16_f32 v71, v42, v43
    ds_write_addtid_b32 v70 offset:2640
    ds_write_addtid_b32 v71 offset:2896
    v_mfma_f32_16x16x32_bf16 v[208:211], v[184:187], v[88:91], v[208:211]
    v_pk_mul_f32 v[64:65], v[48:49], v[28:29] op_sel:[1,1] op_sel_hi:[1,0] neg_lo:[1,0]
    v_pk_mul_f32 v[66:67], v[50:51], v[30:31] op_sel:[1,1] op_sel_hi:[1,0] neg_lo:[1,0]
    v_pk_fma_f32 v[48:49], v[48:49], v[28:29], v[64:65] op_sel:[0,0,0] op_sel_hi:[0,1,1]
    v_pk_fma_f32 v[50:51], v[50:51], v[30:31], v[66:67] op_sel:[0,0,0] op_sel_hi:[0,1,1]
    v_cvt_pk_bf16_f32 v68, v48, v49
    v_cvt_pk_bf16_f32 v69, v50, v51
    ds_write_addtid_b32 v68 offset:3168
    ds_write_addtid_b32 v69 offset:3424
    s_waitcnt lgkmcnt(15)
    v_mfma_f32_16x16x32_bf16 v[208:211], v[188:191], v[92:95], v[208:211]
    v_pk_mul_f32 v[64:65], v[56:57], v[28:29] op_sel:[1,1] op_sel_hi:[1,0] neg_lo:[1,0]
    v_pk_mul_f32 v[66:67], v[58:59], v[30:31] op_sel:[1,1] op_sel_hi:[1,0] neg_lo:[1,0]
    v_pk_fma_f32 v[56:57], v[56:57], v[28:29], v[64:65] op_sel:[0,0,0] op_sel_hi:[0,1,1]
    v_pk_fma_f32 v[58:59], v[58:59], v[30:31], v[66:67] op_sel:[0,0,0] op_sel_hi:[0,1,1]
    v_cvt_pk_bf16_f32 v70, v56, v57
    v_cvt_pk_bf16_f32 v71, v58, v59
    ds_write_addtid_b32 v70 offset:3696
    ds_write_addtid_b32 v71 offset:3952
    v_mfma_f32_16x16x32_bf16 v[208:211], v[192:195], v[96:99], v[208:211]
    v_pk_mul_f32 v[64:65], v[32:33], v[28:29] op_sel:[1,1] op_sel_hi:[1,0] neg_lo:[1,0]
    v_pk_mul_f32 v[66:67], v[34:35], v[30:31] op_sel:[1,1] op_sel_hi:[1,0] neg_lo:[1,0]
    v_pk_fma_f32 v[32:33], v[32:33], v[28:29], v[64:65] op_sel:[0,0,0] op_sel_hi:[0,1,1]
    v_pk_fma_f32 v[34:35], v[34:35], v[30:31], v[66:67] op_sel:[0,0,0] op_sel_hi:[0,1,1]
    v_cvt_pk_bf16_f32 v68, v32, v33
    v_cvt_pk_bf16_f32 v69, v34, v35
    ds_write_addtid_b32 v68 offset:4224
    ds_write_addtid_b32 v69 offset:4480
    v_mfma_f32_16x16x32_bf16 v[208:211], v[196:199], v[100:103], v[208:211]
    v_pk_mul_f32 v[64:65], v[48:49], v[28:29] op_sel:[1,1] op_sel_hi:[1,0] neg_lo:[1,0]
    v_pk_mul_f32 v[66:67], v[50:51], v[30:31] op_sel:[1,1] op_sel_hi:[1,0] neg_lo:[1,0]
    v_pk_fma_f32 v[48:49], v[48:49], v[28:29], v[64:65] op_sel:[0,0,0] op_sel_hi:[0,1,1]
    v_pk_fma_f32 v[50:51], v[50:51], v[30:31], v[66:67] op_sel:[0,0,0] op_sel_hi:[0,1,1]
    v_cvt_pk_bf16_f32 v70, v48, v49
    v_cvt_pk_bf16_f32 v71, v50, v51
    ds_write_addtid_b32 v70 offset:4752
    buffer_load_dwordx4 v[252:255], v9, s[4:7], s53 offen offset:2048
    ds_write_addtid_b32 v71 offset:5008
    v_mfma_f32_16x16x32_bf16 v[208:211], v[200:203], v[104:107], v[208:211]
    v_pk_mul_f32 v[64:65], v[32:33], v[28:29] op_sel:[1,1] op_sel_hi:[1,0] neg_lo:[1,0]
    v_pk_mul_f32 v[66:67], v[34:35], v[30:31] op_sel:[1,1] op_sel_hi:[1,0] neg_lo:[1,0]
    v_pk_fma_f32 v[32:33], v[32:33], v[28:29], v[64:65] op_sel:[0,0,0] op_sel_hi:[0,1,1]
    v_pk_fma_f32 v[34:35], v[34:35], v[30:31], v[66:67] op_sel:[0,0,0] op_sel_hi:[0,1,1]
    v_cvt_pk_bf16_f32 v68, v32, v33
    v_cvt_pk_bf16_f32 v69, v34, v35
    ds_write_addtid_b32 v68 offset:5280
    ds_write_addtid_b32 v69 offset:5536
    s_waitcnt lgkmcnt(15)
    v_mfma_f32_16x16x32_bf16 v[208:211], v[204:207], v[108:111], v[208:211]
    v_pk_mul_f32 v[64:65], v[48:49], v[28:29] op_sel:[1,1] op_sel_hi:[1,0] neg_lo:[1,0]
    v_pk_mul_f32 v[66:67], v[50:51], v[30:31] op_sel:[1,1] op_sel_hi:[1,0] neg_lo:[1,0]
    v_pk_fma_f32 v[48:49], v[48:49], v[28:29], v[64:65] op_sel:[0,0,0] op_sel_hi:[0,1,1]
    v_pk_fma_f32 v[50:51], v[50:51], v[30:31], v[66:67] op_sel:[0,0,0] op_sel_hi:[0,1,1]
    v_cvt_pk_bf16_f32 v70, v48, v49
    v_cvt_pk_bf16_f32 v71, v50, v51
    ds_write_addtid_b32 v70 offset:5808
    ds_write_addtid_b32 v71 offset:6064
    v_pk_mul_f32 v[64:65], v[32:33], v[28:29] op_sel:[1,1] op_sel_hi:[1,0] neg_lo:[1,0]
    v_pk_mul_f32 v[66:67], v[34:35], v[30:31] op_sel:[1,1] op_sel_hi:[1,0] neg_lo:[1,0]
    v_pk_fma_f32 v[32:33], v[32:33], v[28:29], v[64:65] op_sel:[0,0,0] op_sel_hi:[0,1,1]
    v_pk_fma_f32 v[34:35], v[34:35], v[30:31], v[66:67] op_sel:[0,0,0] op_sel_hi:[0,1,1]
    v_cvt_pk_bf16_f32 v68, v32, v33
    v_cvt_pk_bf16_f32 v69, v34, v35
    ds_write_addtid_b32 v68 offset:6336
    ds_write_addtid_b32 v69 offset:6592
    v_pk_mul_f32 v[64:65], v[48:49], v[28:29] op_sel:[1,1] op_sel_hi:[1,0] neg_lo:[1,0]
    v_pk_mul_f32 v[66:67], v[50:51], v[30:31] op_sel:[1,1] op_sel_hi:[1,0] neg_lo:[1,0]
    v_pk_fma_f32 v[48:49], v[48:49], v[28:29], v[64:65] op_sel:[0,0,0] op_sel_hi:[0,1,1]
    v_pk_fma_f32 v[50:51], v[50:51], v[30:31], v[66:67] op_sel:[0,0,0] op_sel_hi:[0,1,1]
    v_cvt_pk_bf16_f32 v70, v48, v49
    v_cvt_pk_bf16_f32 v71, v50, v51
    ds_write_addtid_b32 v70 offset:6864
    ds_write_addtid_b32 v71 offset:7120
    v_pk_mul_f32 v[64:65], v[32:33], v[28:29] op_sel:[1,1] op_sel_hi:[1,0] neg_lo:[1,0]
    v_pk_mul_f32 v[66:67], v[34:35], v[30:31] op_sel:[1,1] op_sel_hi:[1,0] neg_lo:[1,0]
    v_pk_fma_f32 v[32:33], v[32:33], v[28:29], v[64:65] op_sel:[0,0,0] op_sel_hi:[0,1,1]
    v_pk_fma_f32 v[34:35], v[34:35], v[30:31], v[66:67] op_sel:[0,0,0] op_sel_hi:[0,1,1]
    v_cvt_pk_bf16_f32 v68, v32, v33
    v_cvt_pk_bf16_f32 v69, v34, v35
    ds_write_addtid_b32 v68 offset:7392
    ds_write_addtid_b32 v69 offset:7648
    v_pk_mul_f32 v[64:65], v[48:49], v[28:29] op_sel:[1,1] op_sel_hi:[1,0] neg_lo:[1,0]
    v_pk_mul_f32 v[66:67], v[50:51], v[30:31] op_sel:[1,1] op_sel_hi:[1,0] neg_lo:[1,0]
    v_pk_fma_f32 v[48:49], v[48:49], v[28:29], v[64:65] op_sel:[0,0,0] op_sel_hi:[0,1,1]
    v_pk_fma_f32 v[50:51], v[50:51], v[30:31], v[66:67] op_sel:[0,0,0] op_sel_hi:[0,1,1]
    v_cvt_pk_bf16_f32 v70, v48, v49
    v_cvt_pk_bf16_f32 v71, v50, v51
    ds_write_addtid_b32 v70 offset:7920
    ds_write_addtid_b32 v71 offset:8176
    ds_read_b128 v[176:179], v6 offset:0
    ds_read_b128 v[180:183], v6 offset:32
    ds_read_b128 v[184:187], v6 offset:64
    ds_read_b128 v[188:191], v6 offset:96
    ds_read_b128 v[192:195], v6 offset:128
    ds_read_b128 v[196:199], v6 offset:160
    ds_read_b128 v[200:203], v6 offset:192
    ds_read_b128 v[204:207], v6 offset:224
    v_pk_mul_f32 v[64:65], v[32:33], v[28:29] op_sel:[1,1] op_sel_hi:[1,0] neg_lo:[1,0]
    v_pk_mul_f32 v[66:67], v[34:35], v[30:31] op_sel:[1,1] op_sel_hi:[1,0] neg_lo:[1,0]
    v_pk_fma_f32 v[32:33], v[32:33], v[28:29], v[64:65] op_sel:[0,0,0] op_sel_hi:[0,1,1]
    v_pk_fma_f32 v[34:35], v[34:35], v[30:31], v[66:67] op_sel:[0,0,0] op_sel_hi:[0,1,1]
    v_cvt_pk_bf16_f32 v68, v32, v33
    v_cvt_pk_bf16_f32 v69, v34, v35
    ds_write_addtid_b32 v68 offset:0
    ds_write_addtid_b32 v69 offset:256
    v_pk_mul_f32 v[64:65], v[32:33], v[28:29] op_sel:[1,1] op_sel_hi:[1,0] neg_lo:[1,0]
    v_pk_mul_f32 v[66:67], v[34:35], v[30:31] op_sel:[1,1] op_sel_hi:[1,0] neg_lo:[1,0]
    v_pk_fma_f32 v[32:33], v[32:33], v[28:29], v[64:65] op_sel:[0,0,0] op_sel_hi:[0,1,1]
    v_pk_fma_f32 v[34:35], v[34:35], v[30:31], v[66:67] op_sel:[0,0,0] op_sel_hi:[0,1,1]
    v_cvt_pk_bf16_f32 v70, v32, v33
    v_cvt_pk_bf16_f32 v71, v34, v35
    ds_write_addtid_b32 v70 offset:528
    ds_write_addtid_b32 v71 offset:784
    v_pk_mul_f32 v[64:65], v[32:33], v[28:29] op_sel:[1,1] op_sel_hi:[1,0] neg_lo:[1,0]
    v_pk_mul_f32 v[66:67], v[34:35], v[30:31] op_sel:[1,1] op_sel_hi:[1,0] neg_lo:[1,0]
    v_pk_fma_f32 v[32:33], v[32:33], v[28:29], v[64:65] op_sel:[0,0,0] op_sel_hi:[0,1,1]
    v_pk_fma_f32 v[34:35], v[34:35], v[30:31], v[66:67] op_sel:[0,0,0] op_sel_hi:[0,1,1]
    v_cvt_pk_bf16_f32 v68, v32, v33
    v_cvt_pk_bf16_f32 v69, v34, v35
    ds_write_addtid_b32 v68 offset:1056
    ds_write_addtid_b32 v69 offset:1312
    s_waitcnt lgkmcnt(13)
    v_mfma_f32_16x16x32_bf16 v[212:215], v[176:179], v[80:83], 0
    v_pk_mul_f32 v[64:65], v[32:33], v[28:29] op_sel:[1,1] op_sel_hi:[1,0] neg_lo:[1,0]
    v_pk_mul_f32 v[66:67], v[34:35], v[30:31] op_sel:[1,1] op_sel_hi:[1,0] neg_lo:[1,0]
    v_pk_fma_f32 v[32:33], v[32:33], v[28:29], v[64:65] op_sel:[0,0,0] op_sel_hi:[0,1,1]
    v_pk_fma_f32 v[34:35], v[34:35], v[30:31], v[66:67] op_sel:[0,0,0] op_sel_hi:[0,1,1]
    v_cvt_pk_bf16_f32 v70, v32, v33
    v_cvt_pk_bf16_f32 v71, v34, v35
    ds_write_addtid_b32 v70 offset:1584
    ds_write_addtid_b32 v71 offset:1840
    s_waitcnt lgkmcnt(14)
    v_mfma_f32_16x16x32_bf16 v[212:215], v[180:183], v[84:87], v[212:215]
    v_pk_mul_f32 v[64:65], v[32:33], v[28:29] op_sel:[1,1] op_sel_hi:[1,0] neg_lo:[1,0]
    v_pk_mul_f32 v[66:67], v[34:35], v[30:31] op_sel:[1,1] op_sel_hi:[1,0] neg_lo:[1,0]
    v_pk_fma_f32 v[32:33], v[32:33], v[28:29], v[64:65] op_sel:[0,0,0] op_sel_hi:[0,1,1]
    v_pk_fma_f32 v[34:35], v[34:35], v[30:31], v[66:67] op_sel:[0,0,0] op_sel_hi:[0,1,1]
    v_cvt_pk_bf16_f32 v68, v32, v33
    v_cvt_pk_bf16_f32 v69, v34, v35
    ds_write_addtid_b32 v68 offset:2112
    ds_write_addtid_b32 v69 offset:2368
    s_waitcnt lgkmcnt(15)
    v_mfma_f32_16x16x32_bf16 v[212:215], v[184:187], v[88:91], v[212:215]
    v_pk_mul_f32 v[64:65], v[32:33], v[28:29] op_sel:[1,1] op_sel_hi:[1,0] neg_lo:[1,0]
    v_pk_mul_f32 v[66:67], v[34:35], v[30:31] op_sel:[1,1] op_sel_hi:[1,0] neg_lo:[1,0]
    v_pk_fma_f32 v[32:33], v[32:33], v[28:29], v[64:65] op_sel:[0,0,0] op_sel_hi:[0,1,1]
    v_pk_fma_f32 v[34:35], v[34:35], v[30:31], v[66:67] op_sel:[0,0,0] op_sel_hi:[0,1,1]
    v_cvt_pk_bf16_f32 v70, v32, v33
    v_cvt_pk_bf16_f32 v71, v34, v35
    ds_write_addtid_b32 v70 offset:2640
    ds_write_addtid_b32 v71 offset:2896
    s_waitcnt lgkmcnt(15)
    v_mfma_f32_16x16x32_bf16 v[212:215], v[188:191], v[92:95], v[212:215]
    v_pk_mul_f32 v[64:65], v[32:33], v[28:29] op_sel:[1,1] op_sel_hi:[1,0] neg_lo:[1,0]
    v_pk_mul_f32 v[66:67], v[34:35], v[30:31] op_sel:[1,1] op_sel_hi:[1,0] neg_lo:[1,0]
    v_pk_fma_f32 v[32:33], v[32:33], v[28:29], v[64:65] op_sel:[0,0,0] op_sel_hi:[0,1,1]
    v_pk_fma_f32 v[34:35], v[34:35], v[30:31], v[66:67] op_sel:[0,0,0] op_sel_hi:[0,1,1]
    v_cvt_pk_bf16_f32 v68, v32, v33
    v_cvt_pk_bf16_f32 v69, v34, v35
    ds_write_addtid_b32 v68 offset:3168
    ds_write_addtid_b32 v69 offset:3424
    v_mfma_f32_16x16x32_bf16 v[212:215], v[192:195], v[96:99], v[212:215]
    v_pk_mul_f32 v[64:65], v[32:33], v[28:29] op_sel:[1,1] op_sel_hi:[1,0] neg_lo:[1,0]
    v_pk_mul_f32 v[66:67], v[34:35], v[30:31] op_sel:[1,1] op_sel_hi:[1,0] neg_lo:[1,0]
    v_pk_fma_f32 v[32:33], v[32:33], v[28:29], v[64:65] op_sel:[0,0,0] op_sel_hi:[0,1,1]
    v_pk_fma_f32 v[34:35], v[34:35], v[30:31], v[66:67] op_sel:[0,0,0] op_sel_hi:[0,1,1]
    v_cvt_pk_bf16_f32 v70, v32, v33
    v_cvt_pk_bf16_f32 v71, v34, v35
    ds_write_addtid_b32 v70 offset:3696
    ds_write_addtid_b32 v71 offset:3952
    s_waitcnt lgkmcnt(15)
    v_mfma_f32_16x16x32_bf16 v[212:215], v[196:199], v[100:103], v[212:215]
    v_pk_mul_f32 v[64:65], v[32:33], v[28:29] op_sel:[1,1] op_sel_hi:[1,0] neg_lo:[1,0]
    v_pk_mul_f32 v[66:67], v[34:35], v[30:31] op_sel:[1,1] op_sel_hi:[1,0] neg_lo:[1,0]
    v_pk_fma_f32 v[32:33], v[32:33], v[28:29], v[64:65] op_sel:[0,0,0] op_sel_hi:[0,1,1]
    v_pk_fma_f32 v[34:35], v[34:35], v[30:31], v[66:67] op_sel:[0,0,0] op_sel_hi:[0,1,1]
    v_cvt_pk_bf16_f32 v68, v32, v33
    v_cvt_pk_bf16_f32 v69, v34, v35
    ds_write_addtid_b32 v68 offset:4224
    ds_write_addtid_b32 v69 offset:4480
    v_mfma_f32_16x16x32_bf16 v[212:215], v[200:203], v[104:107], v[212:215]
    v_mfma_f32_16x16x32_bf16 v[212:215], v[204:207], v[108:111], v[212:215]
    ds_read_b128 v[176:179], v6 offset:0
    ds_read_b128 v[180:183], v6 offset:32
    ds_read_b128 v[184:187], v6 offset:64
    ds_read_b128 v[188:191], v6 offset:96
    ds_read_b128 v[192:195], v6 offset:128
    ds_read_b128 v[196:199], v6 offset:160
    ds_read_b128 v[200:203], v6 offset:192
    ds_read_b128 v[204:207], v6 offset:224
    v_add_f32 v208, v208, v229
    v_cndmask_b32 v72, v213, v212, s[58:59]
    v_cndmask_b32 v73, v214, v213, s[58:59]
    v_cndmask_b32 v74, v215, 0, s[58:59]
    v_cvt_pk_bf16_f32 v76, v212, v213
    v_cvt_pk_bf16_f32 v77, v214, v215
    s_waitcnt lgkmcnt(7)
    v_mfma_f32_16x16x32_bf16 v[216:219], v[176:179], v[80:83], 0
    s_waitcnt lgkmcnt(6)
    v_mfma_f32_16x16x32_bf16 v[216:219], v[180:183], v[84:87], v[216:219]
    v_cvt_pk_bf16_f32 v64, v212, v212
    v_cvt_pk_bf16_f32 v65, v212, v212
    v_cvt_pk_bf16_f32 v66, v72, v212
    v_cvt_pk_bf16_f32 v67, v73, v72
    s_waitcnt lgkmcnt(5)
    v_mfma_f32_16x16x32_bf16 v[216:219], v[184:187], v[88:91], v[216:219]
    s_waitcnt lgkmcnt(4)
    v_mfma_f32_16x16x32_bf16 v[216:219], v[188:191], v[92:95], v[216:219]
    v_cvt_pk_bf16_f32 v68, v73, v73
    v_cvt_pk_bf16_f32 v69, v73, v73
    v_cvt_pk_bf16_f32 v70, v74, v73
    v_cvt_pk_bf16_f32 v71, v74, v74
    s_waitcnt lgkmcnt(3)
    v_mfma_f32_16x16x32_bf16 v[216:219], v[192:195], v[96:99], v[216:219]
    s_waitcnt lgkmcnt(2)
    v_mfma_f32_16x16x32_bf16 v[216:219], v[196:199], v[100:103], v[216:219]
    v_cndmask_b32 v76, v76, 0, s[58:59]
    s_mov_b32 exec_hi, 1
    ds_write_b128 v220, v[64:67] offset:4
    ds_write_b128 v220, v[68:71] offset:20
    ds_write_b16 v220, v64
    s_mov_b32 exec_hi, -1
    s_waitcnt lgkmcnt(4)
    v_mfma_f32_16x16x32_bf16 v[216:219], v[200:203], v[104:107], v[216:219]
    s_waitcnt lgkmcnt(3)
    v_mfma_f32_16x16x32_bf16 v[216:219], v[204:207], v[108:111], v[216:219]
    v_cvt_pk_bf16_f32 v72, v208, v211
    v_cvt_pk_bf16_f32 v73, v209, v208
    v_cvt_pk_bf16_f32 v74, v210, v209
    v_cvt_pk_bf16_f32 v75, v211, v210
    ds_write_b16 v221, v72
    ds_write2_b32 v221, v73, v74 offset0:1 offset1:2
    ds_write_b32 v221, v75 offset:12
    ds_write_b16_d16_hi v221, v72 offset:18
    s_mov_b32 exec_lo, 0
    ds_write2_b32 v222, v76, v77 offset0:0 offset1:8
    s_mov_b32 exec_lo, -1
    ds_read2_b32 v[16:17], v225 offset0:6 offset1:4
    ds_read2_b32 v[18:19], v225 offset0:2 offset1:0
    ds_read2_b32 v[20:21], v225 offset0:38 offset1:36
    ds_read2_b32 v[22:23], v225 offset0:34 offset1:32
    ds_read2_b32 v[24:25], v225 offset0:70 offset1:68
    ds_read2_b32 v[26:27], v225 offset0:66 offset1:64
    ds_read2_b32 v[28:29], v225 offset0:102 offset1:100
    ds_read2_b32 v[30:31], v225 offset0:98 offset1:96
    v_cvt_pk_bf16_f32 v100, v216, v217
    v_cvt_pk_bf16_f32 v101, v218, v219
    v_cvt_pk_bf16_f32 v102, v216, v216
    ds_write_b16 v224, v100
    ds_write_b16_d16_hi v223, v100 offset:32
    ds_write_b16 v223, v101 offset:64
    ds_write_b16_d16_hi v223, v101 offset:96
    v_readlane_b32 s42, v102, 0
    ds_read2_b32 v[32:33], v225 offset0:134 offset1:132
    ds_read2_b32 v[34:35], v225 offset0:130 offset1:128
    ds_read2_b32 v[36:37], v225 offset0:166 offset1:164
    ds_read2_b32 v[38:39], v225 offset0:162 offset1:160
    ds_read2_b32 v[40:41], v225 offset0:198 offset1:196
    ds_read2_b32 v[42:43], v225 offset0:194 offset1:192
    ds_read2_b32 v[44:45], v225 offset0:230 offset1:228
    ds_read2_b32 v[46:47], v225 offset0:226 offset1:224
    ds_read2_b32 v[48:49], v226 offset0:6 offset1:4
    ds_read2_b32 v[50:51], v226 offset0:2 offset1:0
    ds_read2_b32 v[52:53], v226 offset0:38 offset1:36
    ds_read2_b32 v[54:55], v226 offset0:34 offset1:32
    ds_read2_b32 v[56:57], v226 offset0:70 offset1:68
    ds_read2_b32 v[58:59], v226 offset0:66 offset1:64
    ds_read2_b32 v[60:61], v226 offset0:102 offset1:100
    ds_read2_b32 v[62:63], v226 offset0:98 offset1:96
    ds_read2_b32 v[64:65], v226 offset0:134 offset1:132
    ds_read2_b32 v[66:67], v226 offset0:130 offset1:128
    ds_read2_b32 v[68:69], v226 offset0:166 offset1:164
    ds_read2_b32 v[70:71], v226 offset0:162 offset1:160
    ds_read2_b32 v[72:73], v226 offset0:198 offset1:196
    ds_read2_b32 v[74:75], v226 offset0:194 offset1:192
    ds_read2_b32 v[76:77], v226 offset0:230 offset1:228
    ds_read2_b32 v[78:79], v226 offset0:226 offset1:224
    ds_read2_b32 v[80:81], v227 offset0:6 offset1:4
    ds_read2_b32 v[82:83], v227 offset0:2 offset1:0
    v_and_b32 v124, s42, v124
    v_and_b32 v125, s42, v125
    v_and_b32 v126, s42, v126
    v_and_b32 v127, s42, v127
    ds_read2_b32 v[84:85], v228 offset0:3 offset1:2
    ds_read2_b32 v[86:87], v228 offset0:1 offset1:0
    ds_read2_b32 v[88:89], v228 offset0:19 offset1:18
    ds_read2_b32 v[90:91], v228 offset0:17 offset1:16
    ds_read2_b32 v[92:93], v228 offset0:35 offset1:34
    ds_read2_b32 v[94:95], v228 offset0:33 offset1:32
    ds_read2_b32 v[96:97], v228 offset0:67 offset1:66
    ds_read2_b32 v[98:99], v228 offset0:65 offset1:64
    ds_read2_b32 v[100:101], v228 offset0:83 offset1:82
    ds_read2_b32 v[102:103], v228 offset0:81 offset1:80
    ds_read2_b32 v[104:105], v228 offset0:99 offset1:98
    ds_read2_b32 v[106:107], v228 offset0:97 offset1:96
    ds_read2_b32 v[108:109], v228 offset0:131 offset1:130
    ds_read2_b32 v[110:111], v228 offset0:129 offset1:128
    ds_read2_b32 v[112:113], v228 offset0:147 offset1:146
    ds_read2_b32 v[114:115], v228 offset0:145 offset1:144
    ds_read2_b32 v[116:117], v228 offset0:163 offset1:162
    ds_read2_b32 v[118:119], v228 offset0:161 offset1:160
    ds_read2_b32 v[120:121], v228 offset0:179 offset1:178
    ds_read2_b32 v[122:123], v228 offset0:177 offset1:176
    s_mov_b32 s46, 0x05040100
    s_mov_b32 s47, 0x07060302
    v_lshlrev_b32 v4, 3, v0
    v_add_u32 v5, 36864, v4
    v_lshlrev_b32 v6, 4, v0
    v_add_u32 v6, 4096, v6
    v_mov_b32 v12, 0
    v_mov_b32 v13, 0
    v_lshl_add_u32 v10, v1, 3, s51
    s_mov_b32 s53, 8192
    s_waitcnt vmcnt(0)
    buffer_load_dwordx4 v[144:147], v6, s[36:39], 0 offen sc1
    buffer_load_dwordx4 v[148:151], v6, s[36:39], s53 offen sc1
    v_perm_b32 v208, v244, v240, s46
    v_perm_b32 v209, v252, v248, s46
    v_perm_b32 v210, v244, v240, s47
    v_perm_b32 v211, v252, v248, s47
    v_perm_b32 v212, v245, v241, s46
    v_perm_b32 v213, v253, v249, s46
    v_perm_b32 v214, v245, v241, s47
    v_perm_b32 v215, v253, v249, s47
    v_perm_b32 v216, v246, v242, s46
    v_perm_b32 v217, v254, v250, s46
    v_perm_b32 v218, v246, v242, s47
    v_perm_b32 v219, v254, v250, s47
    v_perm_b32 v220, v247, v243, s46
    v_perm_b32 v221, v255, v251, s46
    v_perm_b32 v222, v247, v243, s47
    v_perm_b32 v223, v255, v251, s47
    s_waitcnt lgkmcnt(0)
    s_barrier
    ds_write_b64 v10, v[12:13]
    ds_write_b64 v5, v[208:209] offset:0
    ds_write_b64 v5, v[210:211] offset:4160
    ds_write_b64 v5, v[212:213] offset:8320
    ds_write_b64 v5, v[214:215] offset:12480
    ds_write_b64 v5, v[216:217] offset:16640
    ds_write_b64 v5, v[218:219] offset:20800
    ds_write_b64 v5, v[220:221] offset:24960
    ds_write_b64 v5, v[222:223] offset:29120
    v_lshlrev_b32 v176, 16, v240
    v_lshlrev_b32 v177, 16, v244
    v_lshlrev_b32 v178, 16, v248
    v_lshlrev_b32 v179, 16, v252
    v_and_b32 v180, 0xffff0000, v240
    v_and_b32 v181, 0xffff0000, v244
    v_and_b32 v182, 0xffff0000, v248
    v_and_b32 v183, 0xffff0000, v252
    v_lshlrev_b32 v184, 16, v241
    v_lshlrev_b32 v185, 16, v245
    v_lshlrev_b32 v186, 16, v249
    v_lshlrev_b32 v187, 16, v253
    v_and_b32 v188, 0xffff0000, v241
    v_and_b32 v189, 0xffff0000, v245
    v_and_b32 v190, 0xffff0000, v249
    v_and_b32 v191, 0xffff0000, v253
    v_lshlrev_b32 v192, 16, v242
    v_lshlrev_b32 v193, 16, v246
    v_lshlrev_b32 v194, 16, v250
    v_lshlrev_b32 v195, 16, v254
    v_and_b32 v196, 0xffff0000, v242
    v_and_b32 v197, 0xffff0000, v246
    v_and_b32 v198, 0xffff0000, v250
    v_and_b32 v199, 0xffff0000, v254
    v_lshlrev_b32 v200, 16, v243
    v_lshlrev_b32 v201, 16, v247
    v_lshlrev_b32 v202, 16, v251
    v_lshlrev_b32 v203, 16, v255
    v_and_b32 v204, 0xffff0000, v243
    v_and_b32 v205, 0xffff0000, v247
    v_and_b32 v206, 0xffff0000, v251
    v_and_b32 v207, 0xffff0000, v255
    v_bfe_u32 v10, v0, 2, 2
    v_mul_u32_u24 v10, 4160, v10
    v_lshrrev_b32 v11, 4, v0
    v_lshl_add_u32 v10, v11, 5, v10
    v_and_b32 v11, 3, v0
    v_lshl_add_u32 v10, v11, 3, v10
    v_add_u32 v240, 36864, v10
    v_lshlrev_b32 v11, 11, v0
    v_add_u32 v241, s49, v11
    s_mov_b32 s54, 0x100000
    s_mov_b32 s55, 0x200000
    v_and_b32 v10, 7, v1
    v_lshlrev_b32 v10, 4, v10
    v_add_u32 v242, 24576, v10
    s_lshr_b32 s57, s45, 2
    s_mov_b32 s43, 0
L_poll_conv:
    s_waitcnt vmcnt(0)
    v_cmp_ne_u32 s[8:9], s52, v147
    v_cmp_ne_u32 s[10:11], s52, v151
    s_or_b64 vcc, s[8:9], s[10:11]
    s_cbranch_scc0 L_polled_conv
    s_add_u32 s43, s43, 1
    s_cmp_ge_u32 s43, 65536
    s_cbranch_scc1 L_polled_conv
    s_sleep 2
    s_mov_b64 exec, s[8:9]
    s_cbranch_execz L_ps_conv_0
    buffer_load_dwordx4 v[144:147], v6, s[36:39], 0 offen sc1
L_ps_conv_0:
    s_mov_b64 exec, s[10:11]
    s_cbranch_execz L_ps_conv_1
    buffer_load_dwordx4 v[148:151], v6, s[36:39], s53 offen sc1
L_ps_conv_1:
    s_mov_b64 exec, -1
    s_branch L_poll_conv
L_polled_conv:
    v_and_b32 v160, 0xffff0000, v144
    v_and_b32 v161, 0xffff0000, v145
    v_and_b32 v162, 0xffff0000, v148
    v_and_b32 v163, 0xffff0000, v149
    v_rcp_f32 v160, v160
    v_rcp_f32 v161, v161
    v_rcp_f32 v162, v162
    v_rcp_f32 v163, v163
    v_lshlrev_b32 v164, 16, v144
    v_lshlrev_b32 v165, 16, v145
    v_lshlrev_b32 v166, 16, v148
    v_lshlrev_b32 v167, 16, v149
    v_pk_mul_f32 v[164:165], v[164:165], v[160:161] neg_lo:[1,0] neg_hi:[1,0]
    v_pk_mul_f32 v[166:167], v[166:167], v[162:163] neg_lo:[1,0] neg_hi:[1,0]
    v_pk_fma_f32 v[168:169], v[176:177], v[160:161], v[164:165]
    v_pk_fma_f32 v[170:171], v[178:179], v[162:163], v[166:167]
    v_cvt_pk_bf16_f32 v208, v168, v169
    v_cvt_pk_bf16_f32 v209, v170, v171
    ds_write_b64 v4, v[208:209] offset:512
    v_pk_fma_f32 v[172:173], v[180:181], v[160:161], v[164:165]
    v_pk_fma_f32 v[174:175], v[182:183], v[162:163], v[166:167]
    v_cvt_pk_bf16_f32 v210, v172, v173
    v_cvt_pk_bf16_f32 v211, v174, v175
    ds_write_b64 v4, v[210:211] offset:5120
    v_pk_fma_f32 v[168:169], v[184:185], v[160:161], v[164:165]
    v_pk_fma_f32 v[170:171], v[186:187], v[162:163], v[166:167]
    v_cvt_pk_bf16_f32 v212, v168, v169
    v_cvt_pk_bf16_f32 v213, v170, v171
    ds_write_b64 v4, v[212:213] offset:9728
    v_pk_fma_f32 v[172:173], v[188:189], v[160:161], v[164:165]
    v_pk_fma_f32 v[174:175], v[190:191], v[162:163], v[166:167]
    v_cvt_pk_bf16_f32 v214, v172, v173
    v_cvt_pk_bf16_f32 v215, v174, v175
    ds_write_b64 v4, v[214:215] offset:14336
    v_pk_fma_f32 v[168:169], v[192:193], v[160:161], v[164:165]
    v_pk_fma_f32 v[170:171], v[194:195], v[162:163], v[166:167]
    v_cvt_pk_bf16_f32 v216, v168, v169
    v_cvt_pk_bf16_f32 v217, v170, v171
    ds_write_b64 v4, v[216:217] offset:18944
    v_pk_fma_f32 v[172:173], v[196:197], v[160:161], v[164:165]
    v_pk_fma_f32 v[174:175], v[198:199], v[162:163], v[166:167]
    v_cvt_pk_bf16_f32 v218, v172, v173
    v_cvt_pk_bf16_f32 v219, v174, v175
    ds_write_b64 v4, v[218:219] offset:23552
    v_pk_fma_f32 v[168:169], v[200:201], v[160:161], v[164:165]
    v_pk_fma_f32 v[170:171], v[202:203], v[162:163], v[166:167]
    v_cvt_pk_bf16_f32 v220, v168, v169
    v_cvt_pk_bf16_f32 v221, v170, v171
    ds_write_b64 v4, v[220:221] offset:28160
    v_pk_fma_f32 v[172:173], v[204:205], v[160:161], v[164:165]
    v_pk_fma_f32 v[174:175], v[206:207], v[162:163], v[166:167]
    v_cvt_pk_bf16_f32 v222, v172, v173
    v_cvt_pk_bf16_f32 v223, v174, v175
    ds_write_b64 v4, v[222:223] offset:32768
    s_waitcnt lgkmcnt(0)
    s_barrier
    ds_read_b128 v[176:179], v7 offset:0
    ds_read_b128 v[180:183], v7 offset:64
    ds_read_b128 v[184:187], v7 offset:128
    ds_read_b128 v[188:191], v7 offset:192
    ds_read_b64 v[204:205], v8 offset:0
    s_waitcnt lgkmcnt(0)
    v_lshlrev_b32 v144, 16, v204
    v_and_b32 v145, 0xffff0000, v204
    v_lshlrev_b32 v146, 16, v205
    v_and_b32 v147, 0xffff0000, v205
    ds_read_b64 v[206:207], v8 offset:512
    s_waitcnt lgkmcnt(0)
    v_lshlrev_b32 v148, 16, v206
    v_and_b32 v149, 0xffff0000, v206
    v_lshlrev_b32 v150, 16, v207
    v_and_b32 v151, 0xffff0000, v207
    v_mfma_f32_16x16x32_bf16 v[144:147], v[44:47], v[176:179], v[144:147]
    ds_read_b128 v[192:195], v7 offset:256
    ds_read_b128 v[196:199], v7 offset:320
    v_mfma_f32_16x16x32_bf16 v[148:151], v[76:79], v[176:179], v[148:151]
    ds_read_b128 v[176:179], v7 offset:384
    ds_read_b64 v[208:209], v8 offset:1024
    v_mfma_f32_16x16x32_bf16 v[144:147], v[40:43], v[180:183], v[144:147]
    ds_read_b64 v[210:211], v8 offset:1536
    ds_read_b64 v[212:213], v8 offset:2048
    v_mfma_f32_16x16x32_bf16 v[148:151], v[72:75], v[180:183], v[148:151]
    ds_read_b128 v[180:183], v7 offset:448
    ds_read_b64 v[214:215], v8 offset:2560
    v_mfma_f32_16x16x32_bf16 v[144:147], v[36:39], v[184:187], v[144:147]
    ds_read_b64 v[216:217], v8 offset:3072
    ds_read_b64 v[218:219], v8 offset:3584
    v_mfma_f32_16x16x32_bf16 v[148:151], v[68:71], v[184:187], v[148:151]
    ds_read_b128 v[200:203], v7 offset:432
    s_waitcnt lgkmcnt(7)
    v_lshlrev_b32 v152, 16, v208
    v_mfma_f32_16x16x32_bf16 v[144:147], v[32:35], v[188:191], v[144:147]
    v_and_b32 v153, 0xffff0000, v208
    v_lshlrev_b32 v154, 16, v209
    v_mfma_f32_16x16x32_bf16 v[148:151], v[64:67], v[188:191], v[148:151]
    v_and_b32 v155, 0xffff0000, v209
    s_waitcnt lgkmcnt(6)
    v_lshlrev_b32 v156, 16, v210
    v_mfma_f32_16x16x32_bf16 v[144:147], v[28:31], v[192:195], v[144:147]
    v_and_b32 v157, 0xffff0000, v210
    v_lshlrev_b32 v158, 16, v211
    v_mfma_f32_16x16x32_bf16 v[148:151], v[60:63], v[192:195], v[148:151]
    v_and_b32 v159, 0xffff0000, v211
    s_waitcnt lgkmcnt(5)
    v_lshlrev_b32 v160, 16, v212
    v_mfma_f32_16x16x32_bf16 v[144:147], v[24:27], v[196:199], v[144:147]
    v_and_b32 v161, 0xffff0000, v212
    v_lshlrev_b32 v162, 16, v213
    v_mfma_f32_16x16x32_bf16 v[148:151], v[56:59], v[196:199], v[148:151]
    v_and_b32 v163, 0xffff0000, v213
    s_waitcnt lgkmcnt(3)
    v_lshlrev_b32 v164, 16, v214
    v_mfma_f32_16x16x32_bf16 v[144:147], v[20:23], v[176:179], v[144:147]
    v_and_b32 v165, 0xffff0000, v214
    v_lshlrev_b32 v166, 16, v215
    v_mfma_f32_16x16x32_bf16 v[148:151], v[52:55], v[176:179], v[148:151]
    v_and_b32 v167, 0xffff0000, v215
    s_waitcnt lgkmcnt(2)
    v_lshlrev_b32 v168, 16, v216
    v_mfma_f32_16x16x32_bf16 v[144:147], v[16:19], v[180:183], v[144:147]
    v_and_b32 v169, 0xffff0000, v216
    v_lshlrev_b32 v170, 16, v217
    v_mfma_f32_16x16x32_bf16 v[148:151], v[48:51], v[180:183], v[148:151]
    v_and_b32 v171, 0xffff0000, v217
    s_waitcnt lgkmcnt(1)
    v_lshlrev_b32 v172, 16, v218
    v_and_b32 v173, 0xffff0000, v218
    v_lshlrev_b32 v174, 16, v219
    v_and_b32 v175, 0xffff0000, v219
    v_mfma_f32_16x16x32_bf16 v[152:155], v[80:83], v[180:183], v[152:155]
    ds_read_b128 v[184:187], v7 offset:512
    ds_read_b128 v[188:191], v7 offset:576
    v_mfma_f32_16x16x32_bf16 v[212:215], v[180:183], v[128:131], 0
    ds_read_b128 v[192:195], v7 offset:640
    ds_read_b128 v[196:199], v7 offset:704
    v_mfma_f32_16x16x32_bf16 v[216:219], v[180:183], v[132:135], 0
    v_cvt_pk_bf16_f32 v10, v144, v145
    v_cvt_pk_bf16_f32 v11, v146, v147
    v_mfma_f32_16x16x32_bf16 v[224:227], v[180:183], v[140:143], 0
    ds_write_b64 v8, v[10:11] offset:0
    ds_read_b128 v[176:179], v7 offset:768
    v_mfma_f32_16x16x32_bf16 v[160:163], v[124:127], v[180:183], v[160:163]
    ds_read_b128 v[180:183], v7 offset:832
    s_waitcnt lgkmcnt(7)
    v_mfma_f32_16x16x32_bf16 v[204:207], v[200:203], v[128:131], 0
    v_cvt_pk_bf16_f32 v232, v212, v216
    v_cvt_pk_bf16_f32 v233, v213, v217
    v_mfma_f32_16x16x32_bf16 v[208:211], v[200:203], v[132:135], 0
    v_cvt_pk_bf16_f32 v234, v214, v218
    v_cvt_pk_bf16_f32 v235, v215, v219
    v_mfma_f32_16x16x32_bf16 v[220:223], v[200:203], v[136:139], 0
    ds_read_b128 v[200:203], v7 offset:944
    s_waitcnt lgkmcnt(7)
    v_mfma_f32_16x16x32_bf16 v[148:151], v[44:47], v[184:187], v[148:151]
    v_mfma_f32_16x16x32_bf16 v[152:155], v[76:79], v[184:187], v[152:155]
    s_nop 0
    v_cvt_pk_bf16_f32 v228, v204, v208
    v_cvt_pk_bf16_f32 v229, v205, v209
    s_waitcnt lgkmcnt(6)
    v_mfma_f32_16x16x32_bf16 v[148:151], v[40:43], v[188:191], v[148:151]
    v_cvt_pk_bf16_f32 v230, v206, v210
    v_cvt_pk_bf16_f32 v231, v207, v211
    v_mfma_f32_16x16x32_bf16 v[152:155], v[72:75], v[188:191], v[152:155]
    v_cvt_pk_bf16_f32 v236, v220, v224
    v_cvt_pk_bf16_f32 v237, v221, v225
    v_mfma_f32_16x16x32_bf16 v[152:155], v[232:235], v[96:99], v[152:155]
    v_cvt_pk_bf16_f32 v238, v222, v226
    v_cvt_pk_bf16_f32 v239, v223, v227
    v_mfma_f32_16x16x32_bf16 v[156:159], v[232:235], v[100:103], v[156:159]
    ds_read_b128 v[184:187], v7 offset:896
    ds_read_b128 v[188:191], v7 offset:960
    v_mfma_f32_16x16x32_bf16 v[160:163], v[232:235], v[104:107], v[160:163]
    s_waitcnt lgkmcnt(7)
    v_mfma_f32_16x16x32_bf16 v[148:151], v[36:39], v[192:195], v[148:151]
    v_mfma_f32_16x16x32_bf16 v[152:155], v[68:71], v[192:195], v[152:155]
    ds_read_b128 v[192:195], v7 offset:1024
    v_mfma_f32_16x16x32_bf16 v[152:155], v[228:231], v[84:87], v[152:155]
    v_mfma_f32_16x16x32_bf16 v[156:159], v[228:231], v[88:91], v[156:159]
    v_mfma_f32_16x16x32_bf16 v[160:163], v[228:231], v[92:95], v[160:163]
    s_waitcnt lgkmcnt(7)
    v_mfma_f32_16x16x32_bf16 v[148:151], v[32:35], v[196:199], v[148:151]
    v_mfma_f32_16x16x32_bf16 v[152:155], v[64:67], v[196:199], v[152:155]
    ds_read_b128 v[196:199], v7 offset:1088
    v_mfma_f32_16x16x32_bf16 v[160:163], v[236:239], v[108:111], v[160:163]
    v_mfma_f32_16x16x32_bf16 v[164:167], v[236:239], v[112:115], v[164:167]
    v_mfma_f32_16x16x32_bf16 v[168:171], v[236:239], v[116:119], v[168:171]
    v_mfma_f32_16x16x32_bf16 v[172:175], v[236:239], v[120:123], v[172:175]
    s_waitcnt lgkmcnt(6)
    v_mfma_f32_16x16x32_bf16 v[148:151], v[28:31], v[176:179], v[148:151]
    v_mfma_f32_16x16x32_bf16 v[152:155], v[60:63], v[176:179], v[152:155]
    ds_read_b128 v[176:179], v7 offset:1152
    s_waitcnt lgkmcnt(6)
    v_mfma_f32_16x16x32_bf16 v[148:151], v[24:27], v[180:183], v[148:151]
    v_mfma_f32_16x16x32_bf16 v[152:155], v[56:59], v[180:183], v[152:155]
    ds_read_b128 v[180:183], v7 offset:1216
    s_waitcnt lgkmcnt(5)
    v_mfma_f32_16x16x32_bf16 v[148:151], v[20:23], v[184:187], v[148:151]
    v_mfma_f32_16x16x32_bf16 v[152:155], v[52:55], v[184:187], v[152:155]
    ds_read_b128 v[184:187], v7 offset:1280
    s_waitcnt lgkmcnt(5)
    v_mfma_f32_16x16x32_bf16 v[148:151], v[16:19], v[188:191], v[148:151]
    v_mfma_f32_16x16x32_bf16 v[152:155], v[48:51], v[188:191], v[152:155]
    v_mfma_f32_16x16x32_bf16 v[156:159], v[80:83], v[188:191], v[156:159]
    v_mfma_f32_16x16x32_bf16 v[212:215], v[188:191], v[128:131], 0
    v_mfma_f32_16x16x32_bf16 v[216:219], v[188:191], v[132:135], 0
    s_nop 3
    v_cvt_pk_bf16_f32 v10, v148, v149
    v_cvt_pk_bf16_f32 v11, v150, v151
    v_mfma_f32_16x16x32_bf16 v[224:227], v[188:191], v[140:143], 0
    ds_write_b64 v8, v[10:11] offset:512
    v_mfma_f32_16x16x32_bf16 v[164:167], v[124:127], v[188:191], v[164:167]
    ds_read_b128 v[188:191], v7 offset:1344
    v_mfma_f32_16x16x32_bf16 v[204:207], v[200:203], v[128:131], 0
    v_cvt_pk_bf16_f32 v232, v212, v216
    v_cvt_pk_bf16_f32 v233, v213, v217
    v_mfma_f32_16x16x32_bf16 v[208:211], v[200:203], v[132:135], 0
    v_cvt_pk_bf16_f32 v234, v214, v218
    v_cvt_pk_bf16_f32 v235, v215, v219
    v_mfma_f32_16x16x32_bf16 v[220:223], v[200:203], v[136:139], 0
    s_waitcnt lgkmcnt(1)
    s_barrier
    ds_read_b64_tr_b16 v[12:13], v240 offset:0
    v_mfma_f32_16x16x32_bf16 v[152:155], v[44:47], v[192:195], v[152:155]
    ds_read_b64_tr_b16 v[14:15], v240 offset:16640
    ds_read_b128 v[200:203], v7 offset:1456
    v_mfma_f32_16x16x32_bf16 v[156:159], v[76:79], v[192:195], v[156:159]
    v_cvt_pk_bf16_f32 v228, v204, v208
    v_cvt_pk_bf16_f32 v229, v205, v209
    v_mfma_f32_16x16x32_bf16 v[152:155], v[40:43], v[196:199], v[152:155]
    v_cvt_pk_bf16_f32 v230, v206, v210
    v_cvt_pk_bf16_f32 v231, v207, v211
    v_mfma_f32_16x16x32_bf16 v[156:159], v[72:75], v[196:199], v[156:159]
    v_cvt_pk_bf16_f32 v236, v220, v224
    v_cvt_pk_bf16_f32 v237, v221, v225
    v_mfma_f32_16x16x32_bf16 v[156:159], v[232:235], v[96:99], v[156:159]
    s_waitcnt lgkmcnt(1)
    s_cmp_lg_u32 s57, 0
    s_cbranch_scc1 L_nst_0_0
    buffer_store_dwordx4 v[12:15], v241, s[32:35], 0 offen
L_nst_0_0:
    v_cvt_pk_bf16_f32 v238, v222, v226
    v_mfma_f32_16x16x32_bf16 v[160:163], v[232:235], v[100:103], v[160:163]
    v_cvt_pk_bf16_f32 v239, v223, v227
    ds_read_b128 v[192:195], v7 offset:1408
    v_mfma_f32_16x16x32_bf16 v[164:167], v[232:235], v[104:107], v[164:167]
    ds_read_b128 v[196:199], v7 offset:1472
    v_mfma_f32_16x16x32_bf16 v[152:155], v[36:39], v[176:179], v[152:155]
    v_mfma_f32_16x16x32_bf16 v[156:159], v[68:71], v[176:179], v[156:159]
    ds_read_b128 v[176:179], v7 offset:1536
    v_mfma_f32_16x16x32_bf16 v[156:159], v[228:231], v[84:87], v[156:159]
    v_mfma_f32_16x16x32_bf16 v[160:163], v[228:231], v[88:91], v[160:163]
    v_mfma_f32_16x16x32_bf16 v[164:167], v[228:231], v[92:95], v[164:167]
    v_mfma_f32_16x16x32_bf16 v[152:155], v[32:35], v[180:183], v[152:155]
    v_mfma_f32_16x16x32_bf16 v[156:159], v[64:67], v[180:183], v[156:159]
    ds_read_b128 v[180:183], v7 offset:1600
    v_mfma_f32_16x16x32_bf16 v[164:167], v[236:239], v[108:111], v[164:167]
    v_mfma_f32_16x16x32_bf16 v[168:171], v[236:239], v[112:115], v[168:171]
    v_mfma_f32_16x16x32_bf16 v[172:175], v[236:239], v[116:119], v[172:175]
    s_cmp_lg_u32 s57, 1
    s_cbranch_scc1 L_nst_0_1
    buffer_store_dwordx4 v[12:15], v241, s[32:35], 0 offen
L_nst_0_1:
    v_mfma_f32_16x16x32_bf16 v[152:155], v[28:31], v[184:187], v[152:155]
    v_mfma_f32_16x16x32_bf16 v[156:159], v[60:63], v[184:187], v[156:159]
    ds_read_b128 v[184:187], v7 offset:1664
    v_mfma_f32_16x16x32_bf16 v[152:155], v[24:27], v[188:191], v[152:155]
    v_mfma_f32_16x16x32_bf16 v[156:159], v[56:59], v[188:191], v[156:159]
    ds_read_b128 v[188:191], v7 offset:1728
    s_waitcnt lgkmcnt(5)
    v_mfma_f32_16x16x32_bf16 v[152:155], v[20:23], v[192:195], v[152:155]
    v_mfma_f32_16x16x32_bf16 v[156:159], v[52:55], v[192:195], v[156:159]
    ds_read_b128 v[192:195], v7 offset:1792
    s_waitcnt lgkmcnt(5)
    v_mfma_f32_16x16x32_bf16 v[152:155], v[16:19], v[196:199], v[152:155]
    v_mfma_f32_16x16x32_bf16 v[156:159], v[48:51], v[196:199], v[156:159]
    v_mfma_f32_16x16x32_bf16 v[160:163], v[80:83], v[196:199], v[160:163]
    v_mfma_f32_16x16x32_bf16 v[212:215], v[196:199], v[128:131], 0
    v_mfma_f32_16x16x32_bf16 v[216:219], v[196:199], v[132:135], 0
    s_nop 3
    v_cvt_pk_bf16_f32 v10, v152, v153
    v_cvt_pk_bf16_f32 v11, v154, v155
    v_mfma_f32_16x16x32_bf16 v[224:227], v[196:199], v[140:143], 0
    ds_write_b64 v8, v[10:11] offset:1024
    v_mfma_f32_16x16x32_bf16 v[168:171], v[124:127], v[196:199], v[168:171]
    ds_read_b128 v[196:199], v7 offset:1856
    v_mfma_f32_16x16x32_bf16 v[204:207], v[200:203], v[128:131], 0
    v_cvt_pk_bf16_f32 v232, v212, v216
    v_cvt_pk_bf16_f32 v233, v213, v217
    v_mfma_f32_16x16x32_bf16 v[208:211], v[200:203], v[132:135], 0
    v_cvt_pk_bf16_f32 v234, v214, v218
    v_cvt_pk_bf16_f32 v235, v215, v219
    v_mfma_f32_16x16x32_bf16 v[220:223], v[200:203], v[136:139], 0
    ds_read_b128 v[200:203], v7 offset:1968
    s_waitcnt lgkmcnt(7)
    v_mfma_f32_16x16x32_bf16 v[156:159], v[44:47], v[176:179], v[156:159]
    v_mfma_f32_16x16x32_bf16 v[160:163], v[76:79], v[176:179], v[160:163]
    s_nop 0
    v_cvt_pk_bf16_f32 v228, v204, v208
    v_cvt_pk_bf16_f32 v229, v205, v209
    s_waitcnt lgkmcnt(6)
    v_mfma_f32_16x16x32_bf16 v[156:159], v[40:43], v[180:183], v[156:159]
    v_cvt_pk_bf16_f32 v230, v206, v210
    v_cvt_pk_bf16_f32 v231, v207, v211
    v_mfma_f32_16x16x32_bf16 v[160:163], v[72:75], v[180:183], v[160:163]
    v_cvt_pk_bf16_f32 v236, v220, v224
    v_cvt_pk_bf16_f32 v237, v221, v225
    v_mfma_f32_16x16x32_bf16 v[160:163], v[232:235], v[96:99], v[160:163]
    v_cvt_pk_bf16_f32 v238, v222, v226
    v_cvt_pk_bf16_f32 v239, v223, v227
    v_mfma_f32_16x16x32_bf16 v[164:167], v[232:235], v[100:103], v[164:167]
    ds_read_b128 v[176:179], v7 offset:1920
    ds_read_b128 v[180:183], v7 offset:1984
    v_mfma_f32_16x16x32_bf16 v[168:171], v[232:235], v[104:107], v[168:171]
    s_waitcnt lgkmcnt(7)
    v_mfma_f32_16x16x32_bf16 v[156:159], v[36:39], v[184:187], v[156:159]
    v_mfma_f32_16x16x32_bf16 v[160:163], v[68:71], v[184:187], v[160:163]
    ds_read_b128 v[184:187], v7 offset:2048
    v_mfma_f32_16x16x32_bf16 v[160:163], v[228:231], v[84:87], v[160:163]
    v_mfma_f32_16x16x32_bf16 v[164:167], v[228:231], v[88:91], v[164:167]
    v_mfma_f32_16x16x32_bf16 v[168:171], v[228:231], v[92:95], v[168:171]
    s_waitcnt lgkmcnt(7)
    v_mfma_f32_16x16x32_bf16 v[156:159], v[32:35], v[188:191], v[156:159]
    v_mfma_f32_16x16x32_bf16 v[160:163], v[64:67], v[188:191], v[160:163]
    ds_read_b128 v[188:191], v7 offset:2112
    v_mfma_f32_16x16x32_bf16 v[168:171], v[236:239], v[108:111], v[168:171]
    v_mfma_f32_16x16x32_bf16 v[172:175], v[236:239], v[112:115], v[172:175]
    s_waitcnt lgkmcnt(7)
    v_mfma_f32_16x16x32_bf16 v[156:159], v[28:31], v[192:195], v[156:159]
    v_mfma_f32_16x16x32_bf16 v[160:163], v[60:63], v[192:195], v[160:163]
    ds_read_b128 v[192:195], v7 offset:2176
    s_waitcnt lgkmcnt(6)
    v_mfma_f32_16x16x32_bf16 v[156:159], v[24:27], v[196:199], v[156:159]
    v_mfma_f32_16x16x32_bf16 v[160:163], v[56:59], v[196:199], v[160:163]
    ds_read_b128 v[196:199], v7 offset:2240
    s_waitcnt lgkmcnt(5)
    v_mfma_f32_16x16x32_bf16 v[156:159], v[20:23], v[176:179], v[156:159]
    v_mfma_f32_16x16x32_bf16 v[160:163], v[52:55], v[176:179], v[160:163]
    ds_read_b128 v[176:179], v7 offset:2304
    s_waitcnt lgkmcnt(5)
    v_mfma_f32_16x16x32_bf16 v[156:159], v[16:19], v[180:183], v[156:159]
    v_mfma_f32_16x16x32_bf16 v[160:163], v[48:51], v[180:183], v[160:163]
    v_mfma_f32_16x16x32_bf16 v[164:167], v[80:83], v[180:183], v[164:167]
    v_mfma_f32_16x16x32_bf16 v[212:215], v[180:183], v[128:131], 0
    v_mfma_f32_16x16x32_bf16 v[216:219], v[180:183], v[132:135], 0
    s_nop 3
    v_cvt_pk_bf16_f32 v10, v156, v157
    v_cvt_pk_bf16_f32 v11, v158, v159
    v_mfma_f32_16x16x32_bf16 v[224:227], v[180:183], v[140:143], 0
    ds_write_b64 v8, v[10:11] offset:1536
    v_mfma_f32_16x16x32_bf16 v[172:175], v[124:127], v[180:183], v[172:175]
    ds_read_b128 v[180:183], v7 offset:2368
    v_mfma_f32_16x16x32_bf16 v[204:207], v[200:203], v[128:131], 0
    v_cvt_pk_bf16_f32 v232, v212, v216
    v_cvt_pk_bf16_f32 v233, v213, v217
    v_mfma_f32_16x16x32_bf16 v[208:211], v[200:203], v[132:135], 0
    v_cvt_pk_bf16_f32 v234, v214, v218
    v_cvt_pk_bf16_f32 v235, v215, v219
    v_mfma_f32_16x16x32_bf16 v[220:223], v[200:203], v[136:139], 0
    s_waitcnt lgkmcnt(1)
    s_barrier
    ds_read_b64_tr_b16 v[12:13], v240 offset:1024
    v_mfma_f32_16x16x32_bf16 v[160:163], v[44:47], v[184:187], v[160:163]
    ds_read_b64_tr_b16 v[14:15], v240 offset:17664
    ds_read_b128 v[200:203], v7 offset:2480
    v_mfma_f32_16x16x32_bf16 v[164:167], v[76:79], v[184:187], v[164:167]
    v_cvt_pk_bf16_f32 v228, v204, v208
    v_cvt_pk_bf16_f32 v229, v205, v209
    v_mfma_f32_16x16x32_bf16 v[160:163], v[40:43], v[188:191], v[160:163]
    v_cvt_pk_bf16_f32 v230, v206, v210
    v_cvt_pk_bf16_f32 v231, v207, v211
    v_mfma_f32_16x16x32_bf16 v[164:167], v[72:75], v[188:191], v[164:167]
    ds_read_b128 v[184:187], v7 offset:2432
    v_cvt_pk_bf16_f32 v236, v220, v224
    v_mfma_f32_16x16x32_bf16 v[164:167], v[232:235], v[96:99], v[164:167]
    s_waitcnt lgkmcnt(2)
    s_cmp_lg_u32 s57, 0
    s_cbranch_scc1 L_nst_1_0
    buffer_store_dwordx4 v[12:15], v241, s[32:35], s54 offen
L_nst_1_0:
    v_cvt_pk_bf16_f32 v237, v221, v225
    v_mfma_f32_16x16x32_bf16 v[168:171], v[232:235], v[100:103], v[168:171]
    v_cvt_pk_bf16_f32 v238, v222, v226
    v_cvt_pk_bf16_f32 v239, v223, v227
    v_mfma_f32_16x16x32_bf16 v[172:175], v[232:235], v[104:107], v[172:175]
    ds_read_b128 v[188:191], v7 offset:2496
    v_mfma_f32_16x16x32_bf16 v[160:163], v[36:39], v[192:195], v[160:163]
    v_mfma_f32_16x16x32_bf16 v[164:167], v[68:71], v[192:195], v[164:167]
    ds_read_b128 v[192:195], v7 offset:2560
    v_mfma_f32_16x16x32_bf16 v[164:167], v[228:231], v[84:87], v[164:167]
    v_mfma_f32_16x16x32_bf16 v[168:171], v[228:231], v[88:91], v[168:171]
    v_mfma_f32_16x16x32_bf16 v[172:175], v[228:231], v[92:95], v[172:175]
    v_mfma_f32_16x16x32_bf16 v[160:163], v[32:35], v[196:199], v[160:163]
    v_mfma_f32_16x16x32_bf16 v[164:167], v[64:67], v[196:199], v[164:167]
    ds_read_b128 v[196:199], v7 offset:2624
    v_mfma_f32_16x16x32_bf16 v[172:175], v[236:239], v[108:111], v[172:175]
    v_mfma_f32_16x16x32_bf16 v[160:163], v[28:31], v[176:179], v[160:163]
    v_mfma_f32_16x16x32_bf16 v[164:167], v[60:63], v[176:179], v[164:167]
    s_cmp_lg_u32 s57, 1
    s_cbranch_scc1 L_nst_1_1
    buffer_store_dwordx4 v[12:15], v241, s[32:35], s54 offen
L_nst_1_1:
    ds_read_b128 v[176:179], v7 offset:2688
    v_mfma_f32_16x16x32_bf16 v[160:163], v[24:27], v[180:183], v[160:163]
    v_mfma_f32_16x16x32_bf16 v[164:167], v[56:59], v[180:183], v[164:167]
    ds_read_b128 v[180:183], v7 offset:2752
    s_waitcnt lgkmcnt(5)
    v_mfma_f32_16x16x32_bf16 v[160:163], v[20:23], v[184:187], v[160:163]
    v_mfma_f32_16x16x32_bf16 v[164:167], v[52:55], v[184:187], v[164:167]
    ds_read_b128 v[184:187], v7 offset:2816
    s_waitcnt lgkmcnt(5)
    v_mfma_f32_16x16x32_bf16 v[160:163], v[16:19], v[188:191], v[160:163]
    v_mfma_f32_16x16x32_bf16 v[164:167], v[48:51], v[188:191], v[164:167]
    v_mfma_f32_16x16x32_bf16 v[168:171], v[80:83], v[188:191], v[168:171]
    v_mfma_f32_16x16x32_bf16 v[212:215], v[188:191], v[128:131], 0
    v_mfma_f32_16x16x32_bf16 v[216:219], v[188:191], v[132:135], 0
    s_nop 3
    v_cvt_pk_bf16_f32 v10, v160, v161
    v_cvt_pk_bf16_f32 v11, v162, v163
    v_mfma_f32_16x16x32_bf16 v[204:207], v[200:203], v[128:131], 0
    ds_write_b64 v8, v[10:11] offset:2048
    ds_read_b128 v[188:191], v7 offset:2880
    v_mfma_f32_16x16x32_bf16 v[208:211], v[200:203], v[132:135], 0
    ds_read_b128 v[200:203], v7 offset:2992
    s_waitcnt lgkmcnt(7)
    v_mfma_f32_16x16x32_bf16 v[164:167], v[44:47], v[192:195], v[164:167]
    v_cvt_pk_bf16_f32 v232, v212, v216
    v_cvt_pk_bf16_f32 v233, v213, v217
    v_mfma_f32_16x16x32_bf16 v[168:171], v[76:79], v[192:195], v[168:171]
    v_cvt_pk_bf16_f32 v234, v214, v218
    v_cvt_pk_bf16_f32 v235, v215, v219
    s_waitcnt lgkmcnt(6)
    v_mfma_f32_16x16x32_bf16 v[164:167], v[40:43], v[196:199], v[164:167]
    v_cvt_pk_bf16_f32 v228, v204, v208
    v_cvt_pk_bf16_f32 v229, v205, v209
    v_mfma_f32_16x16x32_bf16 v[168:171], v[72:75], v[196:199], v[168:171]
    v_cvt_pk_bf16_f32 v230, v206, v210
    v_cvt_pk_bf16_f32 v231, v207, v211
    v_mfma_f32_16x16x32_bf16 v[168:171], v[232:235], v[96:99], v[168:171]
    ds_read_b128 v[192:195], v7 offset:2944
    ds_read_b128 v[196:199], v7 offset:3008
    v_mfma_f32_16x16x32_bf16 v[172:175], v[232:235], v[100:103], v[172:175]
    s_waitcnt lgkmcnt(7)
    v_mfma_f32_16x16x32_bf16 v[164:167], v[36:39], v[176:179], v[164:167]
    v_mfma_f32_16x16x32_bf16 v[168:171], v[68:71], v[176:179], v[168:171]
    ds_read_b128 v[176:179], v7 offset:3072
    v_mfma_f32_16x16x32_bf16 v[168:171], v[228:231], v[84:87], v[168:171]
    v_mfma_f32_16x16x32_bf16 v[172:175], v[228:231], v[88:91], v[172:175]
    s_waitcnt lgkmcnt(7)
    v_mfma_f32_16x16x32_bf16 v[164:167], v[32:35], v[180:183], v[164:167]
    v_mfma_f32_16x16x32_bf16 v[168:171], v[64:67], v[180:183], v[168:171]
    ds_read_b128 v[180:183], v7 offset:3136
    s_waitcnt lgkmcnt(7)
    v_mfma_f32_16x16x32_bf16 v[164:167], v[28:31], v[184:187], v[164:167]
    v_mfma_f32_16x16x32_bf16 v[168:171], v[60:63], v[184:187], v[168:171]
    ds_read_b128 v[184:187], v7 offset:3200
    s_waitcnt lgkmcnt(6)
    v_mfma_f32_16x16x32_bf16 v[164:167], v[24:27], v[188:191], v[164:167]
    buffer_load_dwordx4 v[244:247], v242, s[36:39], 0 offen sc1
    v_mfma_f32_16x16x32_bf16 v[168:171], v[56:59], v[188:191], v[168:171]
    ds_read_b128 v[188:191], v7 offset:3264
    s_waitcnt lgkmcnt(5)
    v_mfma_f32_16x16x32_bf16 v[164:167], v[20:23], v[192:195], v[164:167]
    v_mfma_f32_16x16x32_bf16 v[168:171], v[52:55], v[192:195], v[168:171]
    ds_read_b128 v[192:195], v7 offset:3328
    s_waitcnt lgkmcnt(5)
    v_mfma_f32_16x16x32_bf16 v[164:167], v[16:19], v[196:199], v[164:167]
    v_mfma_f32_16x16x32_bf16 v[168:171], v[48:51], v[196:199], v[168:171]
    v_mfma_f32_16x16x32_bf16 v[172:175], v[80:83], v[196:199], v[172:175]
    v_mfma_f32_16x16x32_bf16 v[212:215], v[196:199], v[128:131], 0
    v_mfma_f32_16x16x32_bf16 v[216:219], v[196:199], v[132:135], 0
    s_nop 3
    v_cvt_pk_bf16_f32 v10, v164, v165
    v_cvt_pk_bf16_f32 v11, v166, v167
    v_mfma_f32_16x16x32_bf16 v[204:207], v[200:203], v[128:131], 0
    ds_read_b128 v[196:199], v7 offset:3392
    ds_write_b64 v8, v[10:11] offset:2560
    v_mfma_f32_16x16x32_bf16 v[208:211], v[200:203], v[132:135], 0
    s_waitcnt lgkmcnt(6)
    v_mfma_f32_16x16x32_bf16 v[168:171], v[44:47], v[176:179], v[168:171]
    v_cvt_pk_bf16_f32 v232, v212, v216
    v_cvt_pk_bf16_f32 v233, v213, v217
    v_mfma_f32_16x16x32_bf16 v[172:175], v[76:79], v[176:179], v[172:175]
    v_cvt_pk_bf16_f32 v234, v214, v218
    v_cvt_pk_bf16_f32 v235, v215, v219
    s_waitcnt lgkmcnt(5)
    v_mfma_f32_16x16x32_bf16 v[168:171], v[40:43], v[180:183], v[168:171]
    v_cvt_pk_bf16_f32 v228, v204, v208
    v_cvt_pk_bf16_f32 v229, v205, v209
    v_mfma_f32_16x16x32_bf16 v[172:175], v[72:75], v[180:183], v[172:175]
    v_cvt_pk_bf16_f32 v230, v206, v210
    v_cvt_pk_bf16_f32 v231, v207, v211
    v_mfma_f32_16x16x32_bf16 v[172:175], v[232:235], v[96:99], v[172:175]
    ds_read_b128 v[176:179], v7 offset:3456
    s_waitcnt lgkmcnt(1)
    s_barrier
    v_mfma_f32_16x16x32_bf16 v[168:171], v[36:39], v[184:187], v[168:171]
    ds_read_b128 v[180:183], v7 offset:3520
    ds_read_b64_tr_b16 v[12:13], v240 offset:2048
    v_mfma_f32_16x16x32_bf16 v[172:175], v[68:71], v[184:187], v[172:175]
    ds_read_b64_tr_b16 v[14:15], v240 offset:18688
    ds_read_b128 v[184:187], v7 offset:3584
    v_mfma_f32_16x16x32_bf16 v[172:175], v[228:231], v[84:87], v[172:175]
    s_waitcnt lgkmcnt(1)
    s_cmp_lg_u32 s57, 0
    s_cbranch_scc1 L_nst_2_0
    buffer_store_dwordx4 v[12:15], v241, s[32:35], s55 offen
L_nst_2_0:
    v_mfma_f32_16x16x32_bf16 v[168:171], v[32:35], v[188:191], v[168:171]
    v_mfma_f32_16x16x32_bf16 v[172:175], v[64:67], v[188:191], v[172:175]
    ds_read_b128 v[188:191], v7 offset:3648
    v_mfma_f32_16x16x32_bf16 v[168:171], v[28:31], v[192:195], v[168:171]
    v_mfma_f32_16x16x32_bf16 v[172:175], v[60:63], v[192:195], v[172:175]
    ds_read_b128 v[192:195], v7 offset:3712
    v_mfma_f32_16x16x32_bf16 v[168:171], v[24:27], v[196:199], v[168:171]
    v_mfma_f32_16x16x32_bf16 v[172:175], v[56:59], v[196:199], v[172:175]
    ds_read_b128 v[196:199], v7 offset:3776
    v_mfma_f32_16x16x32_bf16 v[168:171], v[20:23], v[176:179], v[168:171]
    v_mfma_f32_16x16x32_bf16 v[172:175], v[52:55], v[176:179], v[172:175]
    ds_read_b128 v[176:179], v7 offset:3840
    v_mfma_f32_16x16x32_bf16 v[168:171], v[16:19], v[180:183], v[168:171]
    v_mfma_f32_16x16x32_bf16 v[172:175], v[48:51], v[180:183], v[172:175]
    ds_read_b128 v[180:183], v7 offset:3904
    s_waitcnt lgkmcnt(5)
    v_mfma_f32_16x16x32_bf16 v[172:175], v[44:47], v[184:187], v[172:175]
    ds_read_b128 v[184:187], v7 offset:3968
    s_waitcnt lgkmcnt(5)
    v_mfma_f32_16x16x32_bf16 v[172:175], v[40:43], v[188:191], v[172:175]
    ds_read_b128 v[188:191], v7 offset:4032
    s_cmp_lg_u32 s57, 1
    s_cbranch_scc1 L_nst_2_1
    buffer_store_dwordx4 v[12:15], v241, s[32:35], s55 offen
L_nst_2_1:
    s_waitcnt lgkmcnt(5)
    v_mfma_f32_16x16x32_bf16 v[172:175], v[36:39], v[192:195], v[172:175]
    v_cvt_pk_bf16_f32 v10, v168, v169
    v_cvt_pk_bf16_f32 v11, v170, v171
    s_waitcnt lgkmcnt(4)
    v_mfma_f32_16x16x32_bf16 v[172:175], v[32:35], v[196:199], v[172:175]
    ds_write_b64 v8, v[10:11] offset:3072
    s_waitcnt lgkmcnt(4)
    v_mfma_f32_16x16x32_bf16 v[172:175], v[28:31], v[176:179], v[172:175]
    s_waitcnt lgkmcnt(3)
    v_mfma_f32_16x16x32_bf16 v[172:175], v[24:27], v[180:183], v[172:175]
    s_waitcnt lgkmcnt(2)
    v_mfma_f32_16x16x32_bf16 v[172:175], v[20:23], v[184:187], v[172:175]
    s_waitcnt lgkmcnt(1)
    v_mfma_f32_16x16x32_bf16 v[172:175], v[16:19], v[188:191], v[172:175]
    s_nop 7
    v_cvt_pk_bf16_f32 v10, v172, v173
    v_cvt_pk_bf16_f32 v11, v174, v175
    ds_write_b64 v8, v[10:11] offset:3584
    s_waitcnt lgkmcnt(0)
    s_waitcnt vmcnt(1)
    s_barrier
    ds_read_b64_tr_b16 v[12:13], v240 offset:3072
    ds_read_b64_tr_b16 v[14:15], v240 offset:19712
    s_lshl_b32 s43, s44, 11
    s_add_u32 s43, s43, 491520
    v_lshl_add_u32 v9, v1, 4, s43
    v_cmp_ne_u32 vcc, s52, v247
    s_cbranch_vccz L_conv_selok
    s_mov_b32 s43, 0
L_poll_sel:
    buffer_load_dwordx4 v[244:247], v242, s[36:39], 0 offen sc1
    s_waitcnt vmcnt(0)
    v_xor_b32 v11, s52, v247
    v_cmp_ne_u32 vcc, 0, v11
    s_cbranch_vccz L_polled_sel
    s_add_u32 s43, s43, 1
    s_cmp_ge_u32 s43, 65536
    s_cbranch_scc1 L_polled_sel
    s_sleep 2
    s_branch L_poll_sel
L_polled_sel:
L_conv_selok:
    s_cmp_lg_u32 s45, 0
    s_cbranch_scc1 L_conv_noy
    buffer_load_dwordx4 v[16:19], v9, s[36:39], 0 offen offset:0 sc1
    buffer_load_dwordx4 v[20:23], v9, s[36:39], 0 offen offset:1024 sc1
L_conv_noy:
    v_readlane_b32 s4, v244, 0
    v_readlane_b32 s5, v244, 1
    v_readlane_b32 s6, v244, 2
    v_readlane_b32 s7, v244, 3
    v_readlane_b32 s8, v244, 4
    v_readlane_b32 s9, v244, 5
    v_readlane_b32 s10, v244, 6
    v_readlane_b32 s11, v244, 7
    v_add_u32 v11, 1536, v0
    s_mov_b32 s43, 0x300000
    v_cmpx_ne_u32 vcc, s4, v11
    s_nop 4
    v_cmpx_ne_u32 vcc, s5, v11
    s_nop 4
    v_cmpx_ne_u32 vcc, s6, v11
    s_nop 4
    v_cmpx_ne_u32 vcc, s7, v11
    s_nop 4
    v_cmpx_ne_u32 vcc, s8, v11
    s_nop 4
    v_cmpx_ne_u32 vcc, s9, v11
    s_nop 4
    v_cmpx_ne_u32 vcc, s10, v11
    s_nop 4
    v_cmpx_ne_u32 vcc, s11, v11
    s_waitcnt lgkmcnt(0)
    s_nop 3
    buffer_store_dwordx4 v[12:15], v241, s[32:35], s43 offen
    s_mov_b64 exec, -1
    s_cmp_eq_u32 s45, 0
    s_cbranch_scc1 L_conv_fin
    s_waitcnt vmcnt(1)
    s_barrier
    s_branch L_conv_end
L_conv_fin:
    v_bfe_u32 v10, v1, 3, 1
    v_mul_u32_u24 v11, 16640, v10
    v_lshl_add_u32 v11, v244, 1, v11
    v_add_u32 v11, 36864, v11
    ds_read_u16 v32, v11 offset:0
    ds_read_u16 v33, v11 offset:4160
    ds_read_u16 v34, v11 offset:8320
    ds_read_u16 v35, v11 offset:12480
    v_lshlrev_b32 v12, 11, v244
    v_lshl_add_u32 v12, v10, 3, v12
    v_add_u32 v12, s49, v12
    s_mov_b32 s12, 0x0c0c0400
    s_mov_b32 s13, 0x05040100
    s_mov_b32 s43, 0
    s_waitcnt vmcnt(1)
L_conv_y:
    v_perm_b32 v13, v17, v16, s12
    v_perm_b32 v14, v19, v18, s12
    v_perm_b32 v24, v14, v13, s13
    v_perm_b32 v13, v21, v20, s12
    v_perm_b32 v14, v23, v22, s12
    v_perm_b32 v25, v14, v13, s13
    v_xor_b32 v24, s52, v24
    v_bitop3_b32 v24, v24, v25, s52 bitop3:0xf6
    v_cmp_ne_u32 vcc, 0, v24
    s_cbranch_vccz L_conv_yok
    s_add_u32 s43, s43, 1
    s_cmp_ge_u32 s43, 65536
    s_cbranch_scc1 L_conv_yok
    buffer_load_dwordx4 v[16:19], v9, s[36:39], 0 offen offset:0 sc1
    buffer_load_dwordx4 v[20:23], v9, s[36:39], 0 offen offset:1024 sc1
    s_waitcnt vmcnt(0)
    s_branch L_conv_y
L_conv_yok:
    v_pk_add_f32 v[16:17], v[16:17], v[20:21]
    v_pk_add_f32 v[18:19], v[18:19], v[22:23]
    v_mov_b32 v20, v16
    v_mov_b32 v21, v17
    v_mov_b32 v22, v18
    v_mov_b32 v23, v19
    v_permlane16_swap_b32 v16, v20
    v_permlane16_swap_b32 v17, v21
    v_permlane16_swap_b32 v18, v22
    v_permlane16_swap_b32 v19, v23
    v_pk_add_f32 v[16:17], v[16:17], v[20:21]
    v_pk_add_f32 v[18:19], v[18:19], v[22:23]
    v_mov_b32 v20, v16
    v_mov_b32 v21, v17
    v_mov_b32 v22, v18
    v_mov_b32 v23, v19
    v_permlane32_swap_b32 v16, v20
    v_permlane32_swap_b32 v17, v21
    v_permlane32_swap_b32 v18, v22
    v_permlane32_swap_b32 v19, v23
    v_pk_add_f32 v[16:17], v[16:17], v[20:21]
    v_pk_add_f32 v[18:19], v[18:19], v[22:23]
    s_waitcnt lgkmcnt(0)
    v_lshlrev_b32 v32, 16, v32
    v_lshlrev_b32 v33, 16, v33
    v_lshlrev_b32 v34, 16, v34
    v_lshlrev_b32 v35, 16, v35
    v_fma_f32 v16, v16, v245, v32
    v_fma_f32 v17, v17, v245, v33
    v_fma_f32 v18, v18, v245, v34
    v_fma_f32 v19, v19, v245, v35
    v_cvt_pk_bf16_f32 v16, v16, v17
    v_cvt_pk_bf16_f32 v17, v18, v19
    s_barrier
    s_mov_b64 exec, 0xffff
    buffer_store_dwordx2 v[16:17], v12, s[32:35], 0 offen
L_conv_end:
    s_endpgm
L_code_end:
.section .rodata,"a"
.p2align 6
.amdhsa_kernel parallel_sum__ssm_conv_s4d__moe_arch_mod__prompt_kernel
  .amdhsa_next_free_vgpr 256
  .amdhsa_next_free_sgpr 96
  .amdhsa_accum_offset 256
  .amdhsa_group_segment_fixed_size 0
  .amdhsa_kernarg_size 120
  .amdhsa_user_sgpr_count 2
  .amdhsa_user_sgpr_kernarg_segment_ptr 1
  .amdhsa_system_sgpr_workgroup_id_x 1
.end_amdhsa_kernel
```

```asm
; @launch grid=(256,1,1) block=(512,1,1) lds=161856
.amdgcn_target "amdgcn-amd-amdhsa--gfx950"
.text
.globl parallel_sum__ssm_conv_s4d__moe_arch_mod__prompt_kernel
.p2align 8
.type parallel_sum__ssm_conv_s4d__moe_arch_mod__prompt_kernel,@function
parallel_sum__ssm_conv_s4d__moe_arch_mod__prompt_kernel:
    s_cmp_ge_u32 s2, 256
    s_cbranch_scc1 L_exit
    s_bfe_u32 s3, s2, 0x40003
    v_readfirstlane_b32 s4, v0
    s_cmp_ge_u32 s3, 2
    s_cbranch_scc1 L_nocp
    s_cmp_lt_u32 s4, 448
    s_cbranch_scc1 L_nocp
    v_and_b32 v1, 63, v0
    s_getpc_b64 s[4:5]
L_pc_all:
    s_add_u32 s4, s4, L_auxk-L_pc_all
    s_addc_u32 s5, s5, 0
    s_mov_b32 s6, L_code_end-L_auxk
    s_mov_b32 s7, 0x00020000
    v_lshlrev_b32 v172, 7, v1
    buffer_load_dword v173, v172, s[4:7], 0 offen
    v_add_u32 v172, 8192, v172
    buffer_load_dword v173, v172, s[4:7], 0 offen
    v_add_u32 v172, 8192, v172
    buffer_load_dword v173, v172, s[4:7], 0 offen
L_nocp:
    s_bitcmp1_b32 s2, 7
    s_cbranch_scc0 L_auxk
    s_load_dwordx2 s[8:9], s[0:1], 8
    s_load_dwordx2 s[12:13], s[0:1], 16
    s_load_dwordx2 s[16:17], s[0:1], 24
    s_load_dwordx2 s[20:21], s[0:1], 32
    s_load_dwordx2 s[24:25], s[0:1], 40
    s_load_dwordx2 s[28:29], s[0:1], 48
    s_load_dwordx2 s[4:5], s[0:1], 0
    s_load_dwordx2 s[32:33], s[0:1], 96
    s_load_dwordx2 s[36:37], s[0:1], 112
    s_branch L_conv
L_auxk:
    s_load_dwordx2 s[4:5], s[0:1], 0
    s_load_dwordx2 s[8:9], s[0:1], 64
    s_load_dwordx2 s[12:13], s[0:1], 112
    s_load_dwordx2 s[16:17], s[0:1], 72
    s_load_dwordx2 s[20:21], s[0:1], 80
    s_load_dwordx2 s[24:25], s[0:1], 88
L_aux_code:
    s_and_b32 s50, s2, 7
    s_lshl_b32 s30, s50, 4
    s_add_u32 s30, s30, s3
    s_and_b32 s44, s3, 1
    s_cmp_ge_u32 s3, 3
    s_addc_u32 s38, s3, 0
    s_cmp_ge_u32 s3, 10
    s_addc_u32 s38, s38, 0
    s_cmp_eq_u32 s3, 14
    s_cselect_b32 s38, 3, s38
    s_cmp_eq_u32 s3, 15
    s_cselect_b32 s38, 11, s38
    v_and_b32 v1, 63, v0
    v_and_b32 v2, 15, v0
    v_bfe_u32 v3, v0, 4, 2
    v_lshrrev_b32 v29, 6, v0
    s_nop 0
    v_readfirstlane_b32 s31, v29
    v_lshlrev_b32 v28, 4, v1
    s_lshl_b32 s32, s30, 15
    v_lshlrev_b32 v30, 13, v29
    v_add3_u32 v30, v30, v28, s32
    v_mov_b32 v22, 148624
    v_mov_b32 v23, 1
    s_cmp_ge_u32 s31, 4
    s_cbranch_scc1 L_aux_sinit
    s_setprio 2
    s_mov_b32 s33, 4096
    s_waitcnt lgkmcnt(0)
    s_load_dword s28, s[12:13], 0
    s_mov_b32 s6, 4194304
    s_mov_b32 s7, 0x00020000
    s_mov_b32 s10, 2048
    s_mov_b32 s11, 0x00020000
    buffer_load_dwordx4 v[32:35], v30, s[4:7], 0 offen offset:0 nt
    buffer_load_dwordx4 v[36:39], v30, s[4:7], 0 offen offset:1024 nt
    buffer_load_dwordx4 v[40:43], v30, s[4:7], 0 offen offset:2048 nt
    buffer_load_dwordx4 v[44:47], v30, s[4:7], 0 offen offset:3072 nt
    buffer_load_dwordx4 v[48:51], v30, s[4:7], s33 offen offset:0 nt
    buffer_load_dwordx4 v[52:55], v30, s[4:7], s33 offen offset:1024 nt
    buffer_load_dwordx4 v[56:59], v30, s[4:7], s33 offen offset:2048 nt
    buffer_load_dwordx4 v[60:63], v30, s[4:7], s33 offen offset:3072 nt
    buffer_load_dwordx4 v[64:67], v28, s[8:11], 0 offen offset:0
    buffer_load_dwordx4 v[68:71], v28, s[8:11], 0 offen offset:1024
    s_mov_b32 s14, 753664
    s_mov_b32 s15, 0x00020000
    s_mov_b32 s26, 7340032
    s_mov_b32 s27, 0x00020000
    s_barrier
    v_lshlrev_b32 v12, 4, v0
    v_add_u32 v12, 4096, v12
    v_lshlrev_b32 v13, 3, v0
    v_sub_u32 v13, 0x800, v13
    v_subrev_u32 v88, 0, v13
    v_subrev_u32 v89, 1, v13
    v_subrev_u32 v90, 2, v13
    v_subrev_u32 v91, 3, v13
    v_subrev_u32 v92, 4, v13
    v_subrev_u32 v93, 5, v13
    v_subrev_u32 v94, 6, v13
    v_subrev_u32 v95, 7, v13
    s_mov_b32 s40, 4096
    s_mov_b32 s41, 8192
    s_mov_b32 s42, 12288
    s_mov_b32 s45, 0xffff0000
    v_lshrrev_b32 v24, 4, v0
    v_lshl_add_u32 v24, v24, 2, v22
    v_lshl_add_u32 v25, v2, 2, v22
    v_and_b32 v26, 31, v1
    v_lshl_add_u32 v26, v26, 2, v22
    v_lshrrev_b32 v27, 5, v1
    v_lshl_add_u32 v27, v27, 6, v22
    s_lshl_b32 s47, s31, 5
    s_add_u32 s47, s47, 148688
    v_lshl_add_u32 v31, v1, 2, s47
    s_lshl_b32 s32, s30, 5
    s_add_u32 s32, s32, 4096
    v_bfe_u32 v11, v1, 1, 2
    v_lshlrev_b32 v11, 12, v11
    v_and_b32 v10, 1, v1
    v_lshl_add_u32 v11, v10, 4, v11
    v_add_u32 v11, s32, v11
    s_and_b32 s32, s31, 1
    s_lshl_b32 s32, s32, 6
    s_lshr_b32 s33, s31, 1
    s_lshl_b32 s33, s33, 4
    s_add_u32 s32, s32, s33
    s_add_u32 s32, s32, 148944
    v_lshlrev_b32 v10, 5, v3
    v_add_u32 v10, s32, v10
    v_lshl_add_u32 v9, v1, 4, v22
    s_mov_b32 s33, 0x3f803f80
    s_waitcnt vmcnt(2)
    v_dot2_f32_bf16 v72, s33, v32, 0
    v_dot2_f32_bf16 v76, v32, v32, 0
    v_dot2_f32_bf16 v73, s33, v40, 0
    v_dot2_f32_bf16 v77, v40, v40, 0
    v_dot2_f32_bf16 v74, s33, v48, 0
    v_dot2_f32_bf16 v78, v48, v48, 0
    v_dot2_f32_bf16 v75, s33, v56, 0
    v_dot2_f32_bf16 v79, v56, v56, 0
    v_dot2c_f32_bf16 v72, s33, v33
    v_dot2c_f32_bf16 v76, v33, v33
    v_dot2c_f32_bf16 v73, s33, v41
    v_dot2c_f32_bf16 v77, v41, v41
    v_dot2c_f32_bf16 v74, s33, v49
    v_dot2c_f32_bf16 v78, v49, v49
    v_dot2c_f32_bf16 v75, s33, v57
    v_dot2c_f32_bf16 v79, v57, v57
    v_dot2c_f32_bf16 v72, s33, v34
    v_dot2c_f32_bf16 v76, v34, v34
    v_dot2c_f32_bf16 v73, s33, v42
    v_dot2c_f32_bf16 v77, v42, v42
    v_dot2c_f32_bf16 v74, s33, v50
    v_dot2c_f32_bf16 v78, v50, v50
    v_dot2c_f32_bf16 v75, s33, v58
    v_dot2c_f32_bf16 v79, v58, v58
    v_dot2c_f32_bf16 v72, s33, v35
    v_dot2c_f32_bf16 v76, v35, v35
    v_dot2c_f32_bf16 v73, s33, v43
    v_dot2c_f32_bf16 v77, v43, v43
    v_dot2c_f32_bf16 v74, s33, v51
    v_dot2c_f32_bf16 v78, v51, v51
    v_dot2c_f32_bf16 v75, s33, v59
    v_dot2c_f32_bf16 v79, v59, v59
    v_dot2c_f32_bf16 v72, s33, v36
    v_dot2c_f32_bf16 v76, v36, v36
    v_dot2c_f32_bf16 v73, s33, v44
    v_dot2c_f32_bf16 v77, v44, v44
    v_dot2c_f32_bf16 v74, s33, v52
    v_dot2c_f32_bf16 v78, v52, v52
    v_dot2c_f32_bf16 v75, s33, v60
    v_dot2c_f32_bf16 v79, v60, v60
    v_dot2c_f32_bf16 v72, s33, v37
    v_dot2c_f32_bf16 v76, v37, v37
    v_dot2c_f32_bf16 v73, s33, v45
    v_dot2c_f32_bf16 v77, v45, v45
    v_dot2c_f32_bf16 v74, s33, v53
    v_dot2c_f32_bf16 v78, v53, v53
    v_dot2c_f32_bf16 v75, s33, v61
    v_dot2c_f32_bf16 v79, v61, v61
    v_dot2c_f32_bf16 v72, s33, v38
    v_dot2c_f32_bf16 v76, v38, v38
    v_dot2c_f32_bf16 v73, s33, v46
    v_dot2c_f32_bf16 v77, v46, v46
    v_dot2c_f32_bf16 v74, s33, v54
    v_dot2c_f32_bf16 v78, v54, v54
    v_dot2c_f32_bf16 v75, s33, v62
    v_dot2c_f32_bf16 v79, v62, v62
    v_dot2c_f32_bf16 v72, s33, v39
    v_dot2c_f32_bf16 v76, v39, v39
    v_dot2c_f32_bf16 v73, s33, v47
    v_dot2c_f32_bf16 v77, v47, v47
    v_dot2c_f32_bf16 v74, s33, v55
    v_dot2c_f32_bf16 v78, v55, v55
    v_dot2c_f32_bf16 v75, s33, v63
    v_dot2c_f32_bf16 v79, v63, v63
    s_waitcnt vmcnt(0)
    v_dot2_f32_bf16 v80, v64, v32, 0
    v_dot2_f32_bf16 v81, v64, v40, 0
    v_dot2_f32_bf16 v82, v64, v48, 0
    v_dot2_f32_bf16 v83, v64, v56, 0
    v_dot2_f32_bf16 v84, s33, v64, 0
    v_dot2c_f32_bf16 v80, v65, v33
    v_dot2c_f32_bf16 v81, v65, v41
    v_dot2c_f32_bf16 v82, v65, v49
    v_dot2c_f32_bf16 v83, v65, v57
    v_dot2c_f32_bf16 v84, s33, v65
    v_dot2c_f32_bf16 v80, v66, v34
    v_dot2c_f32_bf16 v81, v66, v42
    v_dot2c_f32_bf16 v82, v66, v50
    v_dot2c_f32_bf16 v83, v66, v58
    v_dot2c_f32_bf16 v84, s33, v66
    v_dot2c_f32_bf16 v80, v67, v35
    v_dot2c_f32_bf16 v81, v67, v43
    v_dot2c_f32_bf16 v82, v67, v51
    v_dot2c_f32_bf16 v83, v67, v59
    v_dot2c_f32_bf16 v84, s33, v67
    v_dot2c_f32_bf16 v80, v68, v36
    v_dot2c_f32_bf16 v81, v68, v44
    v_dot2c_f32_bf16 v82, v68, v52
    v_dot2c_f32_bf16 v83, v68, v60
    v_dot2c_f32_bf16 v84, s33, v68
    v_dot2c_f32_bf16 v80, v69, v37
    v_dot2c_f32_bf16 v81, v69, v45
    v_dot2c_f32_bf16 v82, v69, v53
    v_dot2c_f32_bf16 v83, v69, v61
    v_dot2c_f32_bf16 v84, s33, v69
    v_dot2c_f32_bf16 v80, v70, v38
    v_dot2c_f32_bf16 v81, v70, v46
    v_dot2c_f32_bf16 v82, v70, v54
    v_dot2c_f32_bf16 v83, v70, v62
    v_dot2c_f32_bf16 v84, s33, v70
    v_dot2c_f32_bf16 v80, v71, v39
    v_dot2c_f32_bf16 v81, v71, v47
    v_dot2c_f32_bf16 v82, v71, v55
    v_dot2c_f32_bf16 v83, v71, v63
    v_dot2c_f32_bf16 v84, s33, v71
    s_nop 2
    v_mov_b32 v85, v84
    v_permlane32_swap_b32 v72, v73
    v_permlane32_swap_b32 v74, v75
    v_permlane32_swap_b32 v76, v77
    v_permlane32_swap_b32 v78, v79
    v_permlane32_swap_b32 v80, v81
    v_permlane32_swap_b32 v82, v83
    v_permlane32_swap_b32 v84, v85
    v_add_f32 v72, v72, v73
    v_add_f32 v74, v74, v75
    v_add_f32 v76, v76, v77
    v_add_f32 v78, v78, v79
    v_add_f32 v80, v80, v81
    v_add_f32 v82, v82, v83
    v_add_f32 v84, v84, v85
    v_mov_b32 v86, v84
    v_permlane16_swap_b32 v72, v74
    v_permlane16_swap_b32 v76, v78
    v_permlane16_swap_b32 v80, v82
    v_permlane16_swap_b32 v84, v86
    v_add_f32 v72, v72, v74
    v_add_f32 v76, v76, v78
    v_add_f32 v80, v80, v82
    v_add_f32 v84, v84, v86
    v_add_f32_dpp v72, v72, v72 row_ror:8 row_mask:0xf bank_mask:0xf
    v_add_f32_dpp v76, v76, v76 row_ror:8 row_mask:0xf bank_mask:0xf
    v_add_f32_dpp v80, v80, v80 row_ror:8 row_mask:0xf bank_mask:0xf
    v_add_f32_dpp v84, v84, v84 row_ror:8 row_mask:0xf bank_mask:0xf
    v_add_f32_dpp v72, v72, v72 row_ror:4 row_mask:0xf bank_mask:0xf
    v_add_f32_dpp v76, v76, v76 row_ror:4 row_mask:0xf bank_mask:0xf
    v_add_f32_dpp v80, v80, v80 row_ror:4 row_mask:0xf bank_mask:0xf
    v_add_f32_dpp v84, v84, v84 row_ror:4 row_mask:0xf bank_mask:0xf
    v_add_f32_dpp v72, v72, v72 row_ror:2 row_mask:0xf bank_mask:0xf
    v_add_f32_dpp v76, v76, v76 row_ror:2 row_mask:0xf bank_mask:0xf
    v_add_f32_dpp v80, v80, v80 row_ror:2 row_mask:0xf bank_mask:0xf
    v_add_f32_dpp v84, v84, v84 row_ror:2 row_mask:0xf bank_mask:0xf
    v_add_f32_dpp v72, v72, v72 row_ror:1 row_mask:0xf bank_mask:0xf
    v_add_f32_dpp v76, v76, v76 row_ror:1 row_mask:0xf bank_mask:0xf
    v_add_f32_dpp v80, v80, v80 row_ror:1 row_mask:0xf bank_mask:0xf
    v_add_f32_dpp v84, v84, v84 row_ror:1 row_mask:0xf bank_mask:0xf
    v_mul_f32 v42, 0x3a800000, v72
    v_mul_f32 v43, 0x3a800000, v76
    v_fma_f32 v43, -v42, v42, v43
    v_max_f32 v43, 0, v43
    v_cvt_pk_bf16_f32 v42, v42, v43
    v_and_b32 v43, 0xffff0000, v42
    v_lshlrev_b32 v45, 16, v42
    v_add_f32 v43, 0x3727c5ac, v43
    v_cvt_pk_bf16_f32 v43, v43, v43
    v_and_b32 v43, 0xffff0000, v43
    v_sqrt_f32 v43, v43
    v_fma_f32 v44, -v45, v84, v80
    v_cvt_pk_bf16_f32 v60, v45, v43
    v_and_b32 v43, 0xffff0000, v60
    v_rcp_f32 v46, v43
    v_mov_b32 v61, v60
    s_waitcnt lgkmcnt(0)
    s_mul_i32 s29, s28, 0x9e3779b1
    s_add_u32 s29, s29, 0x7f4a7c15
    v_mul_f32 v44, v44, v46
    v_cvt_pk_bf16_f32 v64, v44, v44
    v_ashrrev_i32 v65, 31, v64
    v_or_b32 v65, 0x80000000, v65
    v_xor_b32 v64, v64, v65
    v_permlane32_swap_b32 v60, v61
    v_lshrrev_b32 v64, 16, v64
    v_mov_b32 v63, s29
    v_mov_b32 v65, v64
    s_nop 1
    v_permlane32_swap_b32 v64, v65
    v_lshl_or_b32 v62, v65, 16, v64
    s_mov_b64 exec, 0x10001
    ds_write_b128 v10, v[60:63]
    s_mov_b64 exec, 1
    ds_add_rtn_u32 v13, v22, v23 offset:264
    s_mov_b64 exec, 0xff
    ds_read_b128 v[60:63], v9 offset:320
    s_waitcnt lgkmcnt(0)
    v_readfirstlane_b32 s32, v13
    s_cmp_lg_u32 s32, 3
    s_cbranch_scc1 L_aux_nopub
    buffer_store_dwordx4 v[60:63], v11, s[12:15], 0 offen sc1
    v_mov_b32 v13, 4
    ds_write_b32 v22, v13 offset:260
L_aux_nopub:
    s_mov_b64 exec, -1
    v_and_b32 v242, 7, v1
    v_lshlrev_b32 v243, 2, v242
    v_add_u32 v243, 148816, v243
    v_bfe_u32 v241, v1, 3, 2
    v_mul_u32_u24 v241, 32784, v241
    v_lshrrev_b32 v240, 5, v1
    v_lshl_add_u32 v241, v240, 12, v241
    s_lshr_b32 s48, s31, 2
    s_lshl_b32 s48, s48, 10
    s_and_b32 s49, s31, 3
    s_lshl_b32 s49, s49, 4
    s_add_u32 s48, s48, s49
    s_add_u32 s48, s48, 24512
    v_add_u32 v241, s48, v241
    s_lshr_b32 s49, s3, 1
    s_cmp_eq_u32 s49, 6
    s_movk_i32 s48, 2048
    s_cselect_b32 s49, s48, 16384
    v_mul_u32_u24 v244, s49, v240
    v_lshl_add_u32 v244, v242, 4, v244
    v_bfe_u32 v240, v1, 3, 1
    v_lshl_add_u32 v244, v240, 10, v244
    s_mul_i32 s88, s50, 57344
    s_add_u32 s88, s88, 32768
    s_mul_i32 s48, s44, 28672
    s_lshr_b32 s49, s3, 1
    s_lshl_b32 s49, s49, 11
    s_add_u32 s48, s48, s49
    s_lshl_b32 s49, s31, 7
    s_add_u32 s48, s48, s49
    s_add_u32 s48, s48, s88
    v_add_u32 v244, s48, v244
    v_lshl_add_u32 v242, v242, 6, v241
    s_bfe_u32 s84, s29, 0x80000
    s_bfe_u32 s85, s29, 0x80008
    s_bfe_u32 s86, s29, 0x80010
    s_bfe_u32 s87, s29, 0x80018
    v_mov_b32 v245, 0xffffff00
    v_cmp_eq_u32 s[90:91], 1, v240
    s_lshl_b32 s39, s50, 7
    s_add_u32 s39, s39, 24576
    s_cmp_lg_u32 s3, 14
    s_cbranch_scc1 L_aux_cons
    v_lshlrev_b32 v9, 5, v0
    s_sleep 12
    buffer_load_dwordx4 v[64:67], v12, s[12:15], 0 offen sc1
    buffer_load_dwordx4 v[68:71], v12, s[12:15], s40 offen sc1
    buffer_load_dwordx4 v[72:75], v12, s[12:15], s41 offen sc1
    buffer_load_dwordx4 v[76:79], v12, s[12:15], s42 offen sc1
    s_mov_b32 s43, 0
L_poll_aux:
    s_waitcnt vmcnt(0)
    v_cmp_ne_u32 s[52:53], s29, v67
    v_cmp_ne_u32 s[54:55], s29, v71
    v_cmp_ne_u32 s[56:57], s29, v75
    v_cmp_ne_u32 s[58:59], s29, v79
    s_or_b64 vcc, s[52:53], s[54:55]
    s_or_b64 vcc, vcc, s[56:57]
    s_or_b64 vcc, vcc, s[58:59]
    s_cbranch_scc0 L_polled_aux
    s_add_u32 s43, s43, 1
    s_cmp_ge_u32 s43, 65536
    s_cbranch_scc1 L_polled_aux
    s_sleep 2
    s_mov_b64 exec, s[52:53]
    s_cbranch_execz L_ps_aux_0
    buffer_load_dwordx4 v[64:67], v12, s[12:15], 0 offen sc1
L_ps_aux_0:
    s_mov_b64 exec, s[54:55]
    s_cbranch_execz L_ps_aux_1
    buffer_load_dwordx4 v[68:71], v12, s[12:15], s40 offen sc1
L_ps_aux_1:
    s_mov_b64 exec, s[56:57]
    s_cbranch_execz L_ps_aux_2
    buffer_load_dwordx4 v[72:75], v12, s[12:15], s41 offen sc1
L_ps_aux_2:
    s_mov_b64 exec, s[58:59]
    s_cbranch_execz L_ps_aux_3
    buffer_load_dwordx4 v[76:79], v12, s[12:15], s42 offen sc1
L_ps_aux_3:
    s_mov_b64 exec, -1
    s_branch L_poll_aux
L_polled_aux:
    ds_write_b64 v9, v[64:65] offset:0
    ds_write_b64 v9, v[68:69] offset:8
    ds_write_b64 v9, v[72:73] offset:16
    ds_write_b64 v9, v[76:77] offset:24
    v_lshl_or_b32 v80, v66, 16, v88
    v_and_or_b32 v81, v66, s45, v89
    v_lshl_or_b32 v82, v70, 16, v90
    v_and_or_b32 v83, v70, s45, v91
    v_lshl_or_b32 v84, v74, 16, v92
    v_and_or_b32 v85, v74, s45, v93
    v_lshl_or_b32 v86, v78, 16, v94
    v_and_or_b32 v87, v78, s45, v95
    v_max3_u32 v17, v80, v81, v82
    v_max3_u32 v18, v83, v84, v85
    v_max3_u32 v17, v17, v86, v87
    v_max_u32 v17, v17, v18
    v_max_u32 v14, v80, v81
    v_min_u32 v15, v80, v81
    v_max_u32_dpp v17, v17, v17 row_ror:8 row_mask:0xf bank_mask:0xf
    v_mov_b32 v16, 0
    v_med3_u32 v16, v15, v16, v82
    v_max_u32_dpp v17, v17, v17 row_ror:4 row_mask:0xf bank_mask:0xf
    v_med3_u32 v15, v14, v15, v82
    v_max_u32 v14, v14, v82
    v_max_u32_dpp v17, v17, v17 row_ror:2 row_mask:0xf bank_mask:0xf
    v_med3_u32 v16, v15, v16, v83
    v_med3_u32 v15, v14, v15, v83
    v_max_u32_dpp v17, v17, v17 row_ror:1 row_mask:0xf bank_mask:0xf
    ds_write_b32 v24, v17
    ds_read_b32 v17, v25
    v_max_u32 v14, v14, v83
    v_med3_u32 v16, v15, v16, v84
    v_med3_u32 v15, v14, v15, v84
    v_max_u32 v14, v14, v84
    v_med3_u32 v16, v15, v16, v85
    v_med3_u32 v15, v14, v15, v85
    v_max_u32 v14, v14, v85
    v_med3_u32 v16, v15, v16, v86
    v_med3_u32 v15, v14, v15, v86
    v_max_u32 v14, v14, v86
    v_med3_u32 v16, v15, v16, v87
    v_med3_u32 v15, v14, v15, v87
    v_max_u32 v14, v14, v87
    v_mov_b32 v19, 0
    s_mov_b32 s43, 0
L_aux_gm:
    s_waitcnt lgkmcnt(0)
    v_cmp_eq_u32 vcc, 0, v17
    s_cbranch_vccz L_aux_gmok
    ds_read_b32 v17, v25
    s_add_u32 s43, s43, 1
    s_cmp_ge_u32 s43, 524288
    s_cbranch_scc1 L_aux_gmok
    s_branch L_aux_gm
L_aux_gmok:
    s_waitcnt lgkmcnt(0)
    v_sub_co_u32_dpp v20, vcc, v17, v17 row_ror:1 row_mask:0xf bank_mask:0xf
    v_addc_co_u32 v19, vcc, 0, v19, vcc
    v_sub_co_u32_dpp v20, vcc, v17, v17 row_ror:2 row_mask:0xf bank_mask:0xf
    v_addc_co_u32 v19, vcc, 0, v19, vcc
    v_sub_co_u32_dpp v20, vcc, v17, v17 row_ror:3 row_mask:0xf bank_mask:0xf
    v_addc_co_u32 v19, vcc, 0, v19, vcc
    v_sub_co_u32_dpp v20, vcc, v17, v17 row_ror:4 row_mask:0xf bank_mask:0xf
    v_addc_co_u32 v19, vcc, 0, v19, vcc
    v_sub_co_u32_dpp v20, vcc, v17, v17 row_ror:5 row_mask:0xf bank_mask:0xf
    v_addc_co_u32 v19, vcc, 0, v19, vcc
    v_sub_co_u32_dpp v20, vcc, v17, v17 row_ror:6 row_mask:0xf bank_mask:0xf
    v_addc_co_u32 v19, vcc, 0, v19, vcc
    v_sub_co_u32_dpp v20, vcc, v17, v17 row_ror:7 row_mask:0xf bank_mask:0xf
    v_addc_co_u32 v19, vcc, 0, v19, vcc
    v_sub_co_u32_dpp v20, vcc, v17, v17 row_ror:8 row_mask:0xf bank_mask:0xf
    v_addc_co_u32 v19, vcc, 0, v19, vcc
    v_sub_co_u32_dpp v20, vcc, v17, v17 row_ror:9 row_mask:0xf bank_mask:0xf
    v_addc_co_u32 v19, vcc, 0, v19, vcc
    v_sub_co_u32_dpp v20, vcc, v17, v17 row_ror:10 row_mask:0xf bank_mask:0xf
    v_addc_co_u32 v19, vcc, 0, v19, vcc
    v_sub_co_u32_dpp v20, vcc, v17, v17 row_ror:11 row_mask:0xf bank_mask:0xf
    v_addc_co_u32 v19, vcc, 0, v19, vcc
    v_sub_co_u32_dpp v20, vcc, v17, v17 row_ror:12 row_mask:0xf bank_mask:0xf
    v_addc_co_u32 v19, vcc, 0, v19, vcc
    v_sub_co_u32_dpp v20, vcc, v17, v17 row_ror:13 row_mask:0xf bank_mask:0xf
    v_addc_co_u32 v19, vcc, 0, v19, vcc
    v_sub_co_u32_dpp v20, vcc, v17, v17 row_ror:14 row_mask:0xf bank_mask:0xf
    v_addc_co_u32 v19, vcc, 0, v19, vcc
    v_sub_co_u32_dpp v20, vcc, v17, v17 row_ror:15 row_mask:0xf bank_mask:0xf
    v_addc_co_u32 v19, vcc, 0, v19, vcc
    v_cmp_eq_u32 vcc, 8, v19
    s_ff1_i32_b64 s46, vcc
    v_readlane_b32 s46, v17, s46
    v_mov_b32 v18, 1
    s_nop 0
    v_cmp_le_u32 s[48:49], s46, v14
    v_cmp_le_u32 s[52:53], s46, v15
    v_cmp_le_u32 s[54:55], s46, v16
    s_bcnt1_i32_b64 s46, s[48:49]
    s_bcnt1_i32_b64 s56, s[52:53]
    v_mbcnt_lo_u32_b32 v20, s48, 0
    v_mbcnt_lo_u32_b32 v21, s52, 0
    v_mbcnt_hi_u32_b32 v20, s49, v20
    v_mbcnt_hi_u32_b32 v21, s53, v21
    s_add_u32 s56, s56, s46
    s_lshl_b32 s46, s46, 2
    s_add_u32 s46, s46, s47
    v_lshl_add_u32 v20, v20, 2, s47
    v_lshl_add_u32 v21, v21, 2, s46
    s_cmp_lg_u64 s[54:55], 0
    s_cselect_b32 s56, 9, s56
    s_cmp_gt_u32 s56, 8
    s_cbranch_scc0 L_aux_fit
    s_mov_b64 s[48:49], 0
    s_mov_b64 s[52:53], 0
    s_mov_b32 s56, 0
    v_mov_b32 v18, 2
L_aux_fit:
    s_lshl_b32 s56, 0xff, s56
    s_and_b32 s56, s56, 0xff
    s_mov_b32 s57, 0
    s_mov_b64 exec, s[48:49]
    ds_write_b32 v20, v14
    s_mov_b64 exec, s[52:53]
    ds_write_b32 v21, v15
    s_mov_b64 exec, s[56:57]
    ds_write_b32 v31, v18
    s_mov_b64 exec, -1
    s_mov_b32 s43, 0
    v_mov_b32 v20, 0
L_aux_ls:
    ds_read_b32 v17, v26 offset:64
    ds_read_b128 v[64:67], v27 offset:64
    ds_read_b128 v[68:71], v27 offset:80
    ds_read_b128 v[72:75], v27 offset:96
    ds_read_b128 v[76:79], v27 offset:112
    s_waitcnt lgkmcnt(4)
    v_cmp_eq_u32 vcc, 0, v17
    s_cbranch_vccz L_aux_lsok
    s_waitcnt lgkmcnt(0)
    s_add_u32 s43, s43, 1
    s_cmp_ge_u32 s43, 524288
    s_cbranch_scc1 L_aux_lsok
    s_branch L_aux_ls
L_aux_lsok:
    v_cmp_eq_u32 vcc, 2, v17
    s_cbranch_vccnz L_aux_slow
    s_cmp_ge_u32 s31, 2
    s_cbranch_scc1 L_aux_wd
    s_waitcnt lgkmcnt(3)
    v_cmp_gt_u32 vcc, v64, v17
    v_addc_co_u32 v20, vcc, 0, v20, vcc
    v_cmp_gt_u32 vcc, v65, v17
    v_addc_co_u32 v20, vcc, 0, v20, vcc
    v_cmp_gt_u32 vcc, v66, v17
    v_addc_co_u32 v20, vcc, 0, v20, vcc
    v_cmp_gt_u32 vcc, v67, v17
    v_addc_co_u32 v20, vcc, 0, v20, vcc
    s_waitcnt lgkmcnt(2)
    v_cmp_gt_u32 vcc, v68, v17
    v_addc_co_u32 v20, vcc, 0, v20, vcc
    v_cmp_gt_u32 vcc, v69, v17
    v_addc_co_u32 v20, vcc, 0, v20, vcc
    v_cmp_gt_u32 vcc, v70, v17
    v_addc_co_u32 v20, vcc, 0, v20, vcc
    v_cmp_gt_u32 vcc, v71, v17
    v_addc_co_u32 v20, vcc, 0, v20, vcc
    s_waitcnt lgkmcnt(1)
    v_cmp_gt_u32 vcc, v72, v17
    v_addc_co_u32 v20, vcc, 0, v20, vcc
    v_cmp_gt_u32 vcc, v73, v17
    v_addc_co_u32 v20, vcc, 0, v20, vcc
    v_cmp_gt_u32 vcc, v74, v17
    v_addc_co_u32 v20, vcc, 0, v20, vcc
    v_cmp_gt_u32 vcc, v75, v17
    v_addc_co_u32 v20, vcc, 0, v20, vcc
    s_waitcnt lgkmcnt(0)
    v_cmp_gt_u32 vcc, v76, v17
    v_addc_co_u32 v20, vcc, 0, v20, vcc
    v_cmp_gt_u32 vcc, v77, v17
    v_addc_co_u32 v20, vcc, 0, v20, vcc
    v_cmp_gt_u32 vcc, v78, v17
    v_addc_co_u32 v20, vcc, 0, v20, vcc
    v_cmp_gt_u32 vcc, v79, v17
    v_addc_co_u32 v20, vcc, 0, v20, vcc
    v_mov_b32 v21, v20
    s_nop 1
    v_permlane32_swap_b32 v20, v21
    v_add_u32 v20, v20, v21
L_aux_sel:
    v_and_b32 v60, 0xfff, v17
    v_sub_u32 v60, 0x800, v60
    v_cmp_gt_u32 vcc, 8, v20
    s_mov_b32 vcc_hi, 0
    s_cmp_eq_u32 s31, 1
    s_cbranch_scc1 L_aux_pf
    v_lshlrev_b32 v15, 2, v60
    v_min_u32 v15, 8188, v15
    ds_read_b32 v62, v15
    v_and_b32 v14, 0xffff0000, v17
    v_ashrrev_i32 v15, 31, v14
    v_not_b32 v15, v15
    v_or_b32 v15, 0x80000000, v15
    v_xor_b32 v14, v14, v15
    v_and_b32 v14, 0xffff0000, v14
    v_mul_f32 v14, 0xbfb8aa3b, v14
    v_exp_f32 v14, v14
    v_mov_b32 v63, s29
    v_add_f32 v14, 1.0, v14
    v_rcp_f32 v14, v14
    v_lshl_add_u32 v21, v20, 4, s39
    v_cvt_pk_bf16_f32 v14, v14, v14
    v_and_b32 v61, 0xffff0000, v14
    s_mov_b64 exec, vcc
    s_waitcnt lgkmcnt(0)
    buffer_store_dwordx4 v[60:63], v21, s[12:15], 0 offen sc1
    s_mov_b64 exec, 1
    ds_add_u32 v22, v23 offset:268
    s_mov_b64 exec, -1
    s_branch L_aux_b4
L_aux_pf:
    v_lshl_add_u32 v21, v20, 2, v22
    s_mov_b64 exec, vcc
    ds_write_b32 v21, v60 offset:224
    s_mov_b64 exec, -1
    v_lshl_add_u32 v21, v3, 2, v22
    ds_read2_b32 v[14:15], v21 offset0:56 offset1:60
    v_lshlrev_b32 v21, 7, v2
    s_waitcnt lgkmcnt(0)
    v_lshl_add_u32 v14, v14, 11, v21
    v_lshl_add_u32 v15, v15, 11, v21
    buffer_load_dword v16, v14, s[4:7], 0 offen
    buffer_load_dword v16, v15, s[4:7], 0 offen
    s_mov_b64 exec, 1
    ds_add_u32 v22, v23 offset:268
    s_mov_b64 exec, -1
    s_waitcnt vmcnt(0)
    s_branch L_aux_b4
L_aux_cons:
    s_cmp_ge_u32 s31, 2
    s_cbranch_scc1 L_aux_wd
    s_cmp_ge_u32 s3, 14
    s_cbranch_scc1 L_aux_nox
    v_and_b32 v14, 7, v1
    v_lshl_add_u32 v21, v14, 4, s39
    v_lshl_add_u32 v15, v14, 2, v22
    s_mul_i32 s46, s31, 4160
    s_add_u32 s46, s46, 131072
    s_lshl_b32 s47, s44, 10
    s_lshl_b32 s49, s31, 2
    s_sleep 70
    s_mov_b64 exec, 0xff
    s_mov_b32 s43, 0
L_aux_sp:
    buffer_load_dwordx4 v[60:63], v21, s[12:15], 0 offen sc1
    s_waitcnt vmcnt(0)
    v_cmp_ne_u32 vcc, s29, v63
    s_cbranch_vccz L_aux_spok
    s_add_u32 s43, s43, 1
    s_cmp_ge_u32 s43, 65536
    s_cbranch_scc1 L_aux_spok
    s_sleep 2
    s_branch L_aux_sp
L_aux_spok:
    ds_write_b32 v15, v62 offset:192
    s_mov_b64 exec, -1
    v_readlane_b32 s52, v60, s49
    s_add_u32 s49, s49, 1
    v_readlane_b32 s53, v60, s49
    s_add_u32 s49, s49, 1
    v_readlane_b32 s54, v60, s49
    s_add_u32 s49, s49, 1
    v_readlane_b32 s55, v60, s49
    s_lshl_b32 s48, s52, 11
    s_add_u32 s48, s48, s47
    s_add_u32 m0, s46, 0
    s_nop 0
    buffer_load_dwordx4 v28, s[4:7], s48 offen lds
    s_lshl_b32 s48, s53, 11
    s_add_u32 s48, s48, s47
    s_add_u32 m0, s46, 1040
    s_nop 0
    buffer_load_dwordx4 v28, s[4:7], s48 offen lds
    s_lshl_b32 s48, s54, 11
    s_add_u32 s48, s48, s47
    s_add_u32 m0, s46, 2080
    s_nop 0
    buffer_load_dwordx4 v28, s[4:7], s48 offen lds
    s_lshl_b32 s48, s55, 11
    s_add_u32 s48, s48, s47
    s_add_u32 m0, s46, 3120
    s_nop 0
    buffer_load_dwordx4 v28, s[4:7], s48 offen lds
    s_mov_b64 exec, 1
    ds_add_u32 v22, v23 offset:268
    s_waitcnt vmcnt(0)
    ds_add_u32 v22, v23 offset:272
    s_mov_b64 exec, -1
    s_branch L_aux_b4
L_aux_nox:
    s_mov_b64 exec, 1
    ds_add_u32 v22, v23 offset:268
    s_mov_b64 exec, -1
    s_branch L_aux_b4
L_aux_wd:
    s_mul_i32 s46, s50, 448
    s_mul_i32 s47, s31, 224
    s_add_u32 s46, s46, s47
    s_sub_u32 s46, s46, 448
    v_lshrrev_b32 v14, 3, v1
    v_add_u32 v14, s46, v14
    v_lshlrev_b32 v14, 11, v14
    v_and_b32 v15, 7, v1
    v_lshl_add_u32 v14, v15, 4, v14
    s_lshl_b32 s46, s38, 7
    v_add_u32 v14, s46, v14
    s_setprio 0
    s_mov_b32 s43, 0
L_lw_wd:
    ds_read_b32 v18, v22 offset:268
    s_add_u32 s43, s43, 1
    s_cmp_ge_u32 s43, 524288
    s_cbranch_scc1 L_lwx_wd
    s_waitcnt lgkmcnt(0)
    v_readfirstlane_b32 s46, v18
    s_cmp_ge_u32 s46, 2
    s_cbranch_scc1 L_lwx_wd
    s_branch L_lw_wd
L_lwx_wd:
    s_waitcnt lgkmcnt(0)
    v_mov_b32 v246, v14
    s_mov_b32 s46, 0
    buffer_load_dwordx4 v[128:131], v14, s[24:27], s46 offen nt
    s_mov_b32 s46, 16384
    buffer_load_dwordx4 v[132:135], v14, s[24:27], s46 offen nt
    s_mov_b32 s46, 32768
    buffer_load_dwordx4 v[136:139], v14, s[24:27], s46 offen nt
    s_mov_b32 s46, 49152
    buffer_load_dwordx4 v[140:143], v14, s[24:27], s46 offen nt
    s_mov_b32 s46, 65536
    buffer_load_dwordx4 v[144:147], v14, s[24:27], s46 offen nt
    s_mov_b32 s46, 81920
    buffer_load_dwordx4 v[148:151], v14, s[24:27], s46 offen nt
    s_mov_b32 s46, 98304
    buffer_load_dwordx4 v[152:155], v14, s[24:27], s46 offen nt
    s_mov_b32 s46, 114688
    buffer_load_dwordx4 v[156:159], v14, s[24:27], s46 offen nt
    s_mov_b32 s46, 131072
    buffer_load_dwordx4 v[160:163], v14, s[24:27], s46 offen nt
    s_mov_b32 s46, 147456
    buffer_load_dwordx4 v[164:167], v14, s[24:27], s46 offen nt
    s_mov_b32 s46, 163840
    buffer_load_dwordx4 v[168:171], v14, s[24:27], s46 offen nt
    s_mov_b32 s46, 180224
    buffer_load_dwordx4 v[172:175], v14, s[24:27], s46 offen nt
    s_mov_b32 s46, 196608
    buffer_load_dwordx4 v[176:179], v14, s[24:27], s46 offen nt
    s_mov_b32 s46, 212992
    buffer_load_dwordx4 v[180:183], v14, s[24:27], s46 offen nt
    s_mov_b32 s46, 229376
    buffer_load_dwordx4 v[184:187], v14, s[24:27], s46 offen nt
    s_mov_b32 s46, 245760
    buffer_load_dwordx4 v[188:191], v14, s[24:27], s46 offen nt
    s_mov_b32 s46, 262144
    buffer_load_dwordx4 v[192:195], v14, s[24:27], s46 offen nt
    s_mov_b32 s46, 278528
    buffer_load_dwordx4 v[196:199], v14, s[24:27], s46 offen nt
    s_mov_b32 s46, 294912
    buffer_load_dwordx4 v[200:203], v14, s[24:27], s46 offen nt
    s_mov_b32 s46, 311296
    buffer_load_dwordx4 v[204:207], v14, s[24:27], s46 offen nt
    s_mov_b32 s46, 327680
    buffer_load_dwordx4 v[208:211], v14, s[24:27], s46 offen nt
    s_mov_b32 s46, 344064
    buffer_load_dwordx4 v[212:215], v14, s[24:27], s46 offen nt
    s_mov_b32 s46, 360448
    buffer_load_dwordx4 v[216:219], v14, s[24:27], s46 offen nt
    s_mov_b32 s46, 376832
    buffer_load_dwordx4 v[220:223], v14, s[24:27], s46 offen nt
    s_mov_b32 s46, 393216
    buffer_load_dwordx4 v[224:227], v14, s[24:27], s46 offen nt
    s_mov_b32 s46, 409600
    buffer_load_dwordx4 v[228:231], v14, s[24:27], s46 offen nt
    s_mov_b32 s46, 425984
    buffer_load_dwordx4 v[232:235], v14, s[24:27], s46 offen nt
    s_mov_b32 s46, 442368
    buffer_load_dwordx4 v[236:239], v14, s[24:27], s46 offen nt
    s_branch L_aux_b4
L_aux_sinit:
    v_mov_b32 v96, 0
    v_mov_b32 v97, 0
    v_lshl_add_u32 v98, v1, 3, v22
    ds_write_b64 v98, v[96:97]
    v_mov_b32 v96, 0x3f803f80
    v_and_b32 v98, 255, v0
    v_lshlrev_b32 v98, 2, v98
    v_add_u32 v98, 139392, v98
    ds_write_b32 v98, v96
    v_bfe_u32 v96, v1, 3, 2
    v_lshrrev_b32 v97, 5, v1
    v_lshl_add_u32 v96, v97, 3, v96
    v_mul_u32_u24 v96, 7168, v96
    v_lshlrev_b32 v98, 1, v3
    v_and_b32 v94, 7, v1
    v_xor_b32 v98, v98, v94
    s_mul_i32 s51, s50, 896
    s_lshr_b32 s33, s3, 1
    s_add_u32 s37, s33, 1
    s_cmp_eq_u32 s37, 7
    s_cselect_b32 s37, 0, s37
    s_lshl_b32 s33, s33, 7
    s_lshl_b32 s37, s37, 7
    s_add_u32 s33, s33, s51
    s_add_u32 s37, s37, s51
    v_lshl_add_u32 v96, v98, 4, v96
    v_add_u32 v97, s37, v96
    v_add_u32 v96, s33, v96
    s_sub_u32 s36, s31, 4
    s_lshl_b32 s34, s44, 2
    s_add_u32 s34, s34, s36
    s_mul_i32 s34, s34, 917504
    s_lshl_b32 s36, s36, 15
    s_waitcnt lgkmcnt(0)
    s_load_dword s28, s[12:13], 0
    s_mov_b32 s14, 753664
    s_mov_b32 s15, 0x00020000
    s_mov_b32 s18, 7340032
    s_mov_b32 s19, 0x00020000
    s_mov_b32 s22, 7340032
    s_mov_b32 s23, 0x00020000
    s_barrier
    s_waitcnt lgkmcnt(0)
    s_mul_i32 s29, s28, 0x9e3779b1
    s_add_u32 s29, s29, 0x7f4a7c15
    s_cmp_ge_u32 s3, 14
    s_cbranch_scc1 L_aux_idle
    s_add_u32 s35, s34, 0
    s_add_u32 m0, s36, 0
    s_nop 0
    buffer_load_dwordx4 v96, s[16:19], s35 offen nt lds
    s_add_u32 s35, s34, 114688
    s_add_u32 m0, s36, 1024
    s_nop 0
    buffer_load_dwordx4 v96, s[16:19], s35 offen nt lds
    s_add_u32 s35, s34, 28672
    s_add_u32 m0, s36, 2048
    s_nop 0
    buffer_load_dwordx4 v96, s[16:19], s35 offen nt lds
    s_add_u32 s35, s34, 143360
    s_add_u32 m0, s36, 3072
    s_nop 0
    buffer_load_dwordx4 v96, s[16:19], s35 offen nt lds
    s_add_u32 s35, s34, 0
    s_add_u32 m0, s36, 16384
    s_nop 0
    buffer_load_dwordx4 v97, s[20:23], s35 offen nt lds
    s_add_u32 s35, s34, 114688
    s_add_u32 m0, s36, 17408
    s_nop 0
    buffer_load_dwordx4 v97, s[20:23], s35 offen nt lds
    s_mov_b32 s43, 0
L_lw_st:
    ds_read_b32 v18, v22 offset:260
    s_add_u32 s43, s43, 1
    s_cmp_ge_u32 s43, 524288
    s_cbranch_scc1 L_lwx_st
    s_waitcnt lgkmcnt(0)
    v_readfirstlane_b32 s46, v18
    s_cmp_ge_u32 s46, 4
    s_cbranch_scc1 L_lwx_st
    s_sleep 1
    s_branch L_lw_st
L_lwx_st:
    s_waitcnt lgkmcnt(0)
    s_add_u32 s35, s34, 28672
    s_add_u32 m0, s36, 18432
    s_nop 0
    buffer_load_dwordx4 v97, s[20:23], s35 offen nt lds
    s_add_u32 s35, s34, 143360
    s_add_u32 m0, s36, 19456
    s_nop 0
    buffer_load_dwordx4 v97, s[20:23], s35 offen nt lds
    s_add_u32 s35, s34, 229376
    s_add_u32 m0, s36, 4096
    s_nop 0
    buffer_load_dwordx4 v96, s[16:19], s35 offen nt lds
    s_add_u32 s35, s34, 344064
    s_add_u32 m0, s36, 5120
    s_nop 0
    buffer_load_dwordx4 v96, s[16:19], s35 offen nt lds
    s_add_u32 s35, s34, 258048
    s_add_u32 m0, s36, 6144
    s_nop 0
    buffer_load_dwordx4 v96, s[16:19], s35 offen nt lds
    s_add_u32 s35, s34, 372736
    s_add_u32 m0, s36, 7168
    s_nop 0
    buffer_load_dwordx4 v96, s[16:19], s35 offen nt lds
    s_add_u32 s35, s34, 229376
    s_add_u32 m0, s36, 20480
    s_nop 0
    buffer_load_dwordx4 v97, s[20:23], s35 offen nt lds
    s_add_u32 s35, s34, 344064
    s_add_u32 m0, s36, 21504
    s_nop 0
    buffer_load_dwordx4 v97, s[20:23], s35 offen nt lds
    s_add_u32 s35, s34, 258048
    s_add_u32 m0, s36, 22528
    s_nop 0
    buffer_load_dwordx4 v97, s[20:23], s35 offen nt lds
    s_add_u32 s35, s34, 372736
    s_add_u32 m0, s36, 23552
    s_nop 0
    buffer_load_dwordx4 v97, s[20:23], s35 offen nt lds
    s_add_u32 s35, s34, 458752
    s_add_u32 m0, s36, 8192
    s_nop 0
    buffer_load_dwordx4 v96, s[16:19], s35 offen nt lds
    s_add_u32 s35, s34, 573440
    s_add_u32 m0, s36, 9216
    s_nop 0
    buffer_load_dwordx4 v96, s[16:19], s35 offen nt lds
    s_add_u32 s35, s34, 487424
    s_add_u32 m0, s36, 10240
    s_nop 0
    buffer_load_dwordx4 v96, s[16:19], s35 offen nt lds
    s_add_u32 s35, s34, 602112
    s_add_u32 m0, s36, 11264
    s_nop 0
    buffer_load_dwordx4 v96, s[16:19], s35 offen nt lds
    s_add_u32 s35, s34, 458752
    s_add_u32 m0, s36, 24576
    s_nop 0
    buffer_load_dwordx4 v97, s[20:23], s35 offen nt lds
    s_add_u32 s35, s34, 573440
    s_add_u32 m0, s36, 25600
    s_nop 0
    buffer_load_dwordx4 v97, s[20:23], s35 offen nt lds
    s_add_u32 s35, s34, 487424
    s_add_u32 m0, s36, 26624
    s_nop 0
    buffer_load_dwordx4 v97, s[20:23], s35 offen nt lds
    s_add_u32 s35, s34, 602112
    s_add_u32 m0, s36, 27648
    s_nop 0
    buffer_load_dwordx4 v97, s[20:23], s35 offen nt lds
    s_add_u32 s35, s34, 688128
    s_add_u32 m0, s36, 12288
    s_nop 0
    buffer_load_dwordx4 v96, s[16:19], s35 offen nt lds
    s_add_u32 s35, s34, 802816
    s_add_u32 m0, s36, 13312
    s_nop 0
    buffer_load_dwordx4 v96, s[16:19], s35 offen nt lds
    s_add_u32 s35, s34, 716800
    s_add_u32 m0, s36, 14336
    s_nop 0
    buffer_load_dwordx4 v96, s[16:19], s35 offen nt lds
    s_add_u32 s35, s34, 831488
    s_add_u32 m0, s36, 15360
    s_nop 0
    buffer_load_dwordx4 v96, s[16:19], s35 offen nt lds
    s_add_u32 s35, s34, 688128
    s_add_u32 m0, s36, 28672
    s_nop 0
    buffer_load_dwordx4 v97, s[20:23], s35 offen nt lds
    s_add_u32 s35, s34, 802816
    s_add_u32 m0, s36, 29696
    s_nop 0
    buffer_load_dwordx4 v97, s[20:23], s35 offen nt lds
    s_add_u32 s35, s34, 716800
    s_add_u32 m0, s36, 30720
    s_nop 0
    buffer_load_dwordx4 v97, s[20:23], s35 offen nt lds
    s_add_u32 s35, s34, 831488
    s_add_u32 m0, s36, 31744
    s_nop 0
    buffer_load_dwordx4 v97, s[20:23], s35 offen nt lds
    v_bfe_u32 v14, v1, 2, 3
    v_lshrrev_b32 v15, 1, v14
    v_lshlrev_b32 v14, 7, v14
    v_lshrrev_b32 v13, 5, v1
    v_lshl_add_u32 v14, v13, 10, v14
    v_and_b32 v13, 3, v1
    v_lshl_add_u32 v14, v13, 3, v14
    v_add_u32 v14, s36, v14
    v_xor_b32 v13, 0, v15
    v_lshl_add_u32 v24, v13, 5, v14
    v_xor_b32 v13, 1, v15
    v_lshl_add_u32 v25, v13, 5, v14
    v_xor_b32 v13, 2, v15
    v_lshl_add_u32 v26, v13, 5, v14
    v_xor_b32 v13, 3, v15
    v_lshl_add_u32 v27, v13, 5, v14
    v_min_u32 v20, 8, v2
    v_mul_u32_u24 v20, 1040, v20
    v_lshl_add_u32 v20, v3, 4, v20
    s_lshr_b32 s35, s36, 7
    s_add_u32 s35, s35, 131072
    v_add_u32 v20, s35, v20
    v_lshlrev_b32 v19, 6, v2
    v_lshl_add_u32 v19, v3, 4, v19
    s_lshr_b32 s35, s36, 11
    s_add_u32 s35, s35, s36
    s_add_u32 s35, s35, 24512
    v_add_u32 v19, s35, v19
    v_and_b32 v242, 7, v1
    v_lshlrev_b32 v243, 2, v242
    v_add_u32 v243, 148816, v243
    v_bfe_u32 v241, v1, 3, 2
    v_mul_u32_u24 v241, 32784, v241
    v_lshrrev_b32 v240, 5, v1
    v_lshl_add_u32 v241, v240, 12, v241
    s_lshr_b32 s48, s31, 2
    s_lshl_b32 s48, s48, 10
    s_and_b32 s49, s31, 3
    s_lshl_b32 s49, s49, 4
    s_add_u32 s48, s48, s49
    s_add_u32 s48, s48, 24512
    v_add_u32 v241, s48, v241
    s_lshr_b32 s49, s3, 1
    s_cmp_eq_u32 s49, 6
    s_movk_i32 s48, 2048
    s_cselect_b32 s49, s48, 16384
    v_mul_u32_u24 v244, s49, v240
    v_lshl_add_u32 v244, v242, 4, v244
    v_bfe_u32 v240, v1, 3, 1
    v_lshl_add_u32 v244, v240, 10, v244
    s_mul_i32 s88, s50, 57344
    s_add_u32 s88, s88, 32768
    s_mul_i32 s48, s44, 28672
    s_lshr_b32 s49, s3, 1
    s_lshl_b32 s49, s49, 11
    s_add_u32 s48, s48, s49
    s_lshl_b32 s49, s31, 7
    s_add_u32 s48, s48, s49
    s_add_u32 s48, s48, s88
    v_add_u32 v244, s48, v244
    v_lshl_add_u32 v242, v242, 6, v241
    s_bfe_u32 s84, s29, 0x80000
    s_bfe_u32 s85, s29, 0x80008
    s_bfe_u32 s86, s29, 0x80010
    s_bfe_u32 s87, s29, 0x80018
    v_mov_b32 v245, 0xffffff00
    v_cmp_eq_u32 s[90:91], 1, v240
    s_waitcnt vmcnt(24)
    ds_read_b64_tr_b16 v[64:65], v24 offset:0
    ds_read_b64_tr_b16 v[66:67], v24 offset:2048
    ds_read_b64_tr_b16 v[68:69], v25 offset:0
    ds_read_b64_tr_b16 v[70:71], v25 offset:2048
    ds_read_b64_tr_b16 v[72:73], v26 offset:0
    ds_read_b64_tr_b16 v[74:75], v26 offset:2048
    ds_read_b64_tr_b16 v[76:77], v27 offset:0
    ds_read_b64_tr_b16 v[78:79], v27 offset:2048
    ds_read_b64_tr_b16 v[80:81], v24 offset:16384
    ds_read_b64_tr_b16 v[82:83], v24 offset:18432
    ds_read_b64_tr_b16 v[84:85], v25 offset:16384
    ds_read_b64_tr_b16 v[86:87], v25 offset:18432
    ds_read_b64_tr_b16 v[88:89], v26 offset:16384
    ds_read_b64_tr_b16 v[90:91], v26 offset:18432
    ds_read_b64_tr_b16 v[92:93], v27 offset:16384
    ds_read_b64_tr_b16 v[94:95], v27 offset:18432
    s_waitcnt vmcnt(16)
    ds_read_b64_tr_b16 v[96:97], v24 offset:4096
    ds_read_b64_tr_b16 v[98:99], v24 offset:6144
    ds_read_b64_tr_b16 v[100:101], v25 offset:4096
    ds_read_b64_tr_b16 v[102:103], v25 offset:6144
    ds_read_b64_tr_b16 v[104:105], v26 offset:4096
    ds_read_b64_tr_b16 v[106:107], v26 offset:6144
    ds_read_b64_tr_b16 v[108:109], v27 offset:4096
    ds_read_b64_tr_b16 v[110:111], v27 offset:6144
    ds_read_b64_tr_b16 v[112:113], v24 offset:20480
    ds_read_b64_tr_b16 v[114:115], v24 offset:22528
    ds_read_b64_tr_b16 v[116:117], v25 offset:20480
    ds_read_b64_tr_b16 v[118:119], v25 offset:22528
    ds_read_b64_tr_b16 v[120:121], v26 offset:20480
    ds_read_b64_tr_b16 v[122:123], v26 offset:22528
    ds_read_b64_tr_b16 v[124:125], v27 offset:20480
    ds_read_b64_tr_b16 v[126:127], v27 offset:22528
    s_waitcnt vmcnt(8)
    ds_read_b64_tr_b16 v[128:129], v24 offset:8192
    ds_read_b64_tr_b16 v[130:131], v24 offset:10240
    ds_read_b64_tr_b16 v[132:133], v25 offset:8192
    ds_read_b64_tr_b16 v[134:135], v25 offset:10240
    ds_read_b64_tr_b16 v[136:137], v26 offset:8192
    ds_read_b64_tr_b16 v[138:139], v26 offset:10240
    ds_read_b64_tr_b16 v[140:141], v27 offset:8192
    ds_read_b64_tr_b16 v[142:143], v27 offset:10240
    ds_read_b64_tr_b16 v[144:145], v24 offset:24576
    ds_read_b64_tr_b16 v[146:147], v24 offset:26624
    ds_read_b64_tr_b16 v[148:149], v25 offset:24576
    ds_read_b64_tr_b16 v[150:151], v25 offset:26624
    ds_read_b64_tr_b16 v[152:153], v26 offset:24576
    ds_read_b64_tr_b16 v[154:155], v26 offset:26624
    ds_read_b64_tr_b16 v[156:157], v27 offset:24576
    ds_read_b64_tr_b16 v[158:159], v27 offset:26624
    s_waitcnt vmcnt(0)
    ds_read_b64_tr_b16 v[160:161], v24 offset:12288
    ds_read_b64_tr_b16 v[162:163], v24 offset:14336
    ds_read_b64_tr_b16 v[164:165], v25 offset:12288
    ds_read_b64_tr_b16 v[166:167], v25 offset:14336
    ds_read_b64_tr_b16 v[168:169], v26 offset:12288
    ds_read_b64_tr_b16 v[170:171], v26 offset:14336
    ds_read_b64_tr_b16 v[172:173], v27 offset:12288
    ds_read_b64_tr_b16 v[174:175], v27 offset:14336
    ds_read_b64_tr_b16 v[176:177], v24 offset:28672
    ds_read_b64_tr_b16 v[178:179], v24 offset:30720
    ds_read_b64_tr_b16 v[180:181], v25 offset:28672
    ds_read_b64_tr_b16 v[182:183], v25 offset:30720
    ds_read_b64_tr_b16 v[184:185], v26 offset:28672
    ds_read_b64_tr_b16 v[186:187], v26 offset:30720
    ds_read_b64_tr_b16 v[188:189], v27 offset:28672
    ds_read_b64_tr_b16 v[190:191], v27 offset:30720
    s_mov_b32 s43, 0
L_lw_xs:
    ds_read_b32 v18, v22 offset:272
    s_add_u32 s43, s43, 1
    s_cmp_ge_u32 s43, 524288
    s_cbranch_scc1 L_lwx_xs
    s_waitcnt lgkmcnt(0)
    v_readfirstlane_b32 s46, v18
    s_cmp_ge_u32 s46, 2
    s_cbranch_scc1 L_lwx_xs
    s_branch L_lw_xs
L_lwx_xs:
    s_waitcnt lgkmcnt(0)
    ds_read_b128 v[32:35], v20 offset:0
    ds_read_b128 v[36:39], v20 offset:64
    ds_read_b128 v[40:43], v20 offset:128
    ds_read_b128 v[44:47], v20 offset:192
    s_waitcnt lgkmcnt(3)
    v_mfma_f32_16x16x32_bf16 v[192:195], v[64:67], v[32:35], 0
    s_waitcnt lgkmcnt(2)
    v_mfma_f32_16x16x32_bf16 v[192:195], v[96:99], v[36:39], v[192:195]
    s_waitcnt lgkmcnt(1)
    v_mfma_f32_16x16x32_bf16 v[192:195], v[128:131], v[40:43], v[192:195]
    s_waitcnt lgkmcnt(0)
    v_mfma_f32_16x16x32_bf16 v[192:195], v[160:163], v[44:47], v[192:195]
    v_mfma_f32_16x16x32_bf16 v[196:199], v[68:71], v[32:35], 0
    v_mfma_f32_16x16x32_bf16 v[196:199], v[100:103], v[36:39], v[196:199]
    v_mfma_f32_16x16x32_bf16 v[196:199], v[132:135], v[40:43], v[196:199]
    v_mfma_f32_16x16x32_bf16 v[196:199], v[164:167], v[44:47], v[196:199]
    v_mfma_f32_16x16x32_bf16 v[200:203], v[72:75], v[32:35], 0
    v_mfma_f32_16x16x32_bf16 v[200:203], v[104:107], v[36:39], v[200:203]
    v_mfma_f32_16x16x32_bf16 v[200:203], v[136:139], v[40:43], v[200:203]
    v_mfma_f32_16x16x32_bf16 v[200:203], v[168:171], v[44:47], v[200:203]
    ds_write_b128 v19, v[192:195] offset:0
    v_mfma_f32_16x16x32_bf16 v[204:207], v[76:79], v[32:35], 0
    v_mfma_f32_16x16x32_bf16 v[204:207], v[108:111], v[36:39], v[204:207]
    v_mfma_f32_16x16x32_bf16 v[204:207], v[140:143], v[40:43], v[204:207]
    v_mfma_f32_16x16x32_bf16 v[204:207], v[172:175], v[44:47], v[204:207]
    ds_write_b128 v19, v[196:199] offset:1024
    v_mfma_f32_16x16x32_bf16 v[208:211], v[80:83], v[32:35], 0
    v_mfma_f32_16x16x32_bf16 v[208:211], v[112:115], v[36:39], v[208:211]
    v_mfma_f32_16x16x32_bf16 v[208:211], v[144:147], v[40:43], v[208:211]
    v_mfma_f32_16x16x32_bf16 v[208:211], v[176:179], v[44:47], v[208:211]
    ds_write_b128 v19, v[200:203] offset:2048
    v_mfma_f32_16x16x32_bf16 v[212:215], v[84:87], v[32:35], 0
    v_mfma_f32_16x16x32_bf16 v[212:215], v[116:119], v[36:39], v[212:215]
    v_mfma_f32_16x16x32_bf16 v[212:215], v[148:151], v[40:43], v[212:215]
    v_mfma_f32_16x16x32_bf16 v[212:215], v[180:183], v[44:47], v[212:215]
    ds_write_b128 v19, v[204:207] offset:3072
    v_mfma_f32_16x16x32_bf16 v[216:219], v[88:91], v[32:35], 0
    v_mfma_f32_16x16x32_bf16 v[216:219], v[120:123], v[36:39], v[216:219]
    v_mfma_f32_16x16x32_bf16 v[216:219], v[152:155], v[40:43], v[216:219]
    v_mfma_f32_16x16x32_bf16 v[216:219], v[184:187], v[44:47], v[216:219]
    ds_write_b128 v19, v[208:211] offset:4096
    v_mfma_f32_16x16x32_bf16 v[220:223], v[92:95], v[32:35], 0
    v_mfma_f32_16x16x32_bf16 v[220:223], v[124:127], v[36:39], v[220:223]
    v_mfma_f32_16x16x32_bf16 v[220:223], v[156:159], v[40:43], v[220:223]
    v_mfma_f32_16x16x32_bf16 v[220:223], v[188:191], v[44:47], v[220:223]
    ds_write_b128 v19, v[212:215] offset:5120
    s_nop 1
    ds_write_b128 v19, v[216:219] offset:6144
    s_nop 3
    ds_write_b128 v19, v[220:223] offset:7168
    s_waitcnt lgkmcnt(0)
    s_branch L_aux_b4
L_aux_idle:
    v_and_b32 v242, 7, v1
    v_lshlrev_b32 v243, 2, v242
    v_add_u32 v243, 148816, v243
    v_bfe_u32 v241, v1, 3, 2
    v_mul_u32_u24 v241, 32784, v241
    v_lshrrev_b32 v240, 5, v1
    v_lshl_add_u32 v241, v240, 12, v241
    s_lshr_b32 s48, s31, 2
    s_lshl_b32 s48, s48, 10
    s_and_b32 s49, s31, 3
    s_lshl_b32 s49, s49, 4
    s_add_u32 s48, s48, s49
    s_add_u32 s48, s48, 24512
    v_add_u32 v241, s48, v241
    s_lshr_b32 s49, s3, 1
    s_cmp_eq_u32 s49, 6
    s_movk_i32 s48, 2048
    s_cselect_b32 s49, s48, 16384
    v_mul_u32_u24 v244, s49, v240
    v_lshl_add_u32 v244, v242, 4, v244
    v_bfe_u32 v240, v1, 3, 1
    v_lshl_add_u32 v244, v240, 10, v244
    s_mul_i32 s88, s50, 57344
    s_add_u32 s88, s88, 32768
    s_mul_i32 s48, s44, 28672
    s_lshr_b32 s49, s3, 1
    s_lshl_b32 s49, s49, 11
    s_add_u32 s48, s48, s49
    s_lshl_b32 s49, s31, 7
    s_add_u32 s48, s48, s49
    s_add_u32 s48, s48, s88
    v_add_u32 v244, s48, v244
    v_lshl_add_u32 v242, v242, 6, v241
    s_bfe_u32 s84, s29, 0x80000
    s_bfe_u32 s85, s29, 0x80008
    s_bfe_u32 s86, s29, 0x80010
    s_bfe_u32 s87, s29, 0x80018
    v_mov_b32 v245, 0xffffff00
    v_cmp_eq_u32 s[90:91], 1, v240
L_aux_b4:
    s_barrier
    s_cmp_ge_u32 s3, 14
    s_cbranch_scc1 L_aux_noh
    ds_read_b32 v24, v243
    ds_read_b128 v[64:67], v242
    ds_read_b128 v[72:75], v241 offset:512
    ds_read_b128 v[68:71], v242 offset:2048
    ds_read_b128 v[76:79], v241 offset:2560
    s_waitcnt lgkmcnt(0)
    v_and_b32 v25, 0xffff0000, v24
    v_lshlrev_b32 v24, 16, v24
    v_rcp_f32 v25, v25
    s_nop 0
    v_pk_fma_f32 v[64:65], v[72:73], v[24:25], v[64:65] op_sel:[0,0,0] op_sel_hi:[1,0,1] neg_lo:[1,0,0] neg_hi:[1,0,0]
    v_pk_fma_f32 v[66:67], v[74:75], v[24:25], v[66:67] op_sel:[0,0,0] op_sel_hi:[1,0,1] neg_lo:[1,0,0] neg_hi:[1,0,0]
    v_pk_fma_f32 v[68:69], v[76:77], v[24:25], v[68:69] op_sel:[0,0,0] op_sel_hi:[1,0,1] neg_lo:[1,0,0] neg_hi:[1,0,0]
    v_pk_fma_f32 v[70:71], v[78:79], v[24:25], v[70:71] op_sel:[0,0,0] op_sel_hi:[1,0,1] neg_lo:[1,0,0] neg_hi:[1,0,0]
    v_cndmask_b32 v72, v68, v64, s[90:91]
    v_cndmask_b32 v73, v69, v65, s[90:91]
    v_cndmask_b32 v74, v70, v66, s[90:91]
    v_cndmask_b32 v75, v71, v67, s[90:91]
    v_cndmask_b32 v64, v64, v68, s[90:91]
    v_cndmask_b32 v65, v65, v69, s[90:91]
    v_cndmask_b32 v66, v66, v70, s[90:91]
    v_cndmask_b32 v67, v67, v71, s[90:91]
    v_add_f32_dpp v64, v72, v64 row_ror:8 row_mask:0xf bank_mask:0xf
    v_add_f32_dpp v65, v73, v65 row_ror:8 row_mask:0xf bank_mask:0xf
    v_add_f32_dpp v66, v74, v66 row_ror:8 row_mask:0xf bank_mask:0xf
    v_add_f32_dpp v67, v75, v67 row_ror:8 row_mask:0xf bank_mask:0xf
    v_mov_b32 v68, v64
    v_mov_b32 v69, v65
    v_mov_b32 v70, v66
    v_mov_b32 v71, v67
    v_permlane16_swap_b32 v64, v68
    v_permlane16_swap_b32 v65, v69
    v_permlane16_swap_b32 v66, v70
    v_permlane16_swap_b32 v67, v71
    v_pk_add_f32 v[64:65], v[64:65], v[68:69]
    v_pk_add_f32 v[66:67], v[66:67], v[70:71]
    v_pk_mul_f32 v[64:65], v[64:65], v[24:25] op_sel:[0,1] op_sel_hi:[1,1]
    v_pk_mul_f32 v[66:67], v[66:67], v[24:25] op_sel:[0,1] op_sel_hi:[1,1]
    v_and_or_b32 v64, v64, v245, s84
    v_and_or_b32 v65, v65, v245, s85
    v_and_or_b32 v66, v66, v245, s86
    v_and_or_b32 v67, v67, v245, s87
    s_mov_b32 exec_lo, 0xffff
    s_mov_b32 exec_hi, 0xffff
    buffer_store_dwordx4 v[64:67], v244, s[12:15], 0 offen sc1
    s_mov_b64 exec, -1
L_aux_noh:
    s_sub_u32 s47, s31, 2
    s_cmp_ge_u32 s47, 2
    s_cbranch_scc1 L_aux_nowd
    v_and_b32 v14, 7, v1
    v_mul_u32_u24 v15, 86, v14
    v_lshrrev_b32 v15, 8, v15
    v_mul_u32_u24 v14, 7184, v14
    v_mul_u32_u24 v15, 11216, v15
    v_add_u32 v14, v14, v15
    v_lshrrev_b32 v15, 3, v1
    v_lshl_add_u32 v14, v15, 4, v14
    s_mul_i32 s46, s47, 3584
    v_add_u32 v14, s46, v14
    s_waitcnt vmcnt(1)
    s_cmp_lt_u32 s3, 14
    s_cbranch_scc1 L_aux_wd1
    s_waitcnt vmcnt(0)
L_aux_wd1:
    ds_write_b128 v14, v[128:131] offset:0
    ds_write_b128 v14, v[132:135] offset:128
    ds_write_b128 v14, v[136:139] offset:256
    ds_write_b128 v14, v[140:143] offset:384
    ds_write_b128 v14, v[144:147] offset:512
    ds_write_b128 v14, v[148:151] offset:640
    ds_write_b128 v14, v[152:155] offset:768
    ds_write_b128 v14, v[156:159] offset:896
    ds_write_b128 v14, v[160:163] offset:1024
    ds_write_b128 v14, v[164:167] offset:1152
    ds_write_b128 v14, v[168:171] offset:1280
    ds_write_b128 v14, v[172:175] offset:1408
    ds_write_b128 v14, v[176:179] offset:1536
    ds_write_b128 v14, v[180:183] offset:1664
    ds_write_b128 v14, v[184:187] offset:1792
    ds_write_b128 v14, v[188:191] offset:1920
    ds_write_b128 v14, v[192:195] offset:2048
    ds_write_b128 v14, v[196:199] offset:2176
    ds_write_b128 v14, v[200:203] offset:2304
    ds_write_b128 v14, v[204:207] offset:2432
    ds_write_b128 v14, v[208:211] offset:2560
    ds_write_b128 v14, v[212:215] offset:2688
    ds_write_b128 v14, v[216:219] offset:2816
    ds_write_b128 v14, v[220:223] offset:2944
    ds_write_b128 v14, v[224:227] offset:3072
    ds_write_b128 v14, v[228:231] offset:3200
    ds_write_b128 v14, v[232:235] offset:3328
    ds_write_b128 v14, v[236:239] offset:3456
    s_waitcnt lgkmcnt(0)
L_aux_nowd:
    v_lshlrev_b32 v10, 7, v3
    v_bfe_u32 v11, v1, 1, 1
    v_lshl_add_u32 v10, v11, 6, v10
    v_bfe_u32 v11, v1, 2, 2
    v_lshl_add_u32 v10, v11, 4, v10
    v_and_b32 v11, 1, v1
    v_lshl_add_u32 v10, v11, 3, v10
    s_mul_i32 s46, s31, 86
    s_lshr_b32 s46, s46, 8
    s_mul_i32 s46, s46, 11216
    s_mul_i32 s47, s31, 7184
    s_add_u32 s46, s46, s47
    v_add_u32 v10, s46, v10
    v_lshl_add_u32 v14, v0, 4, s88
    v_lshlrev_b32 v15, 3, v1
    v_add_u32 v15, 131072, v15
    s_lshl_b32 s47, s31, 9
    v_add_u32 v16, s47, v15
    s_mov_b32 s60, 7168
    s_mov_b32 s61, 14336
    s_mov_b32 s62, 21504
    s_mov_b32 s63, 28672
    s_mov_b32 s64, 35840
    s_mov_b32 s65, 43008
    s_mov_b32 s66, 50176
    s_mov_b32 s58, 0xbfb8aa3b
    s_mov_b32 s43, 0
    v_mov_b32 v17, 0xff
    s_barrier
    ds_read_b64_tr_b16 v[64:65], v10 offset:0
    ds_read_b64_tr_b16 v[66:67], v10 offset:512
    ds_read_b64_tr_b16 v[68:69], v10 offset:1024
    ds_read_b64_tr_b16 v[70:71], v10 offset:1536
    ds_read_b64_tr_b16 v[72:73], v10 offset:2048
    ds_read_b64_tr_b16 v[74:75], v10 offset:2560
    ds_read_b64_tr_b16 v[76:77], v10 offset:3072
    ds_read_b64_tr_b16 v[78:79], v10 offset:3584
    ds_read_b64_tr_b16 v[80:81], v10 offset:4096
    ds_read_b64_tr_b16 v[82:83], v10 offset:4608
    ds_read_b64_tr_b16 v[84:85], v10 offset:5120
    ds_read_b64_tr_b16 v[86:87], v10 offset:5632
    ds_read_b64_tr_b16 v[88:89], v10 offset:6144
    ds_read_b64_tr_b16 v[90:91], v10 offset:6656
    s_cmp_eq_u32 s31, 7
    s_cbranch_scc1 L_aux_nohp
    buffer_load_dwordx4 v[128:131], v14, s[12:15], 0 offen sc1
    buffer_load_dwordx4 v[132:135], v14, s[12:15], s60 offen sc1
    buffer_load_dwordx4 v[136:139], v14, s[12:15], s61 offen sc1
    buffer_load_dwordx4 v[140:143], v14, s[12:15], s62 offen sc1
    buffer_load_dwordx4 v[144:147], v14, s[12:15], s63 offen sc1
    buffer_load_dwordx4 v[148:151], v14, s[12:15], s64 offen sc1
    buffer_load_dwordx4 v[152:155], v14, s[12:15], s65 offen sc1
    buffer_load_dwordx4 v[156:159], v14, s[12:15], s66 offen sc1
L_aux_gp:
    s_waitcnt vmcnt(0)
    v_bitop3_b32 v32, v128, v132, s84 bitop3:0x7e
    v_bitop3_b32 v36, v136, v140, s84 bitop3:0x7e
    v_bitop3_b32 v40, v144, v148, s84 bitop3:0x7e
    v_bitop3_b32 v44, v152, v156, s84 bitop3:0x7e
    v_bitop3_b32 v33, v129, v133, s85 bitop3:0x7e
    v_bitop3_b32 v37, v137, v141, s85 bitop3:0x7e
    v_bitop3_b32 v41, v145, v149, s85 bitop3:0x7e
    v_bitop3_b32 v45, v153, v157, s85 bitop3:0x7e
    v_bitop3_b32 v34, v130, v134, s86 bitop3:0x7e
    v_bitop3_b32 v38, v138, v142, s86 bitop3:0x7e
    v_bitop3_b32 v42, v146, v150, s86 bitop3:0x7e
    v_bitop3_b32 v46, v154, v158, s86 bitop3:0x7e
    v_bitop3_b32 v35, v131, v135, s87 bitop3:0x7e
    v_bitop3_b32 v39, v139, v143, s87 bitop3:0x7e
    v_bitop3_b32 v43, v147, v151, s87 bitop3:0x7e
    v_bitop3_b32 v47, v155, v159, s87 bitop3:0x7e
    v_or3_b32 v32, v32, v33, v34
    v_or3_b32 v36, v36, v37, v38
    v_or3_b32 v40, v40, v41, v42
    v_or3_b32 v44, v44, v45, v46
    v_bitop3_b32 v32, v32, v35, v17 bitop3:0xa8
    v_bitop3_b32 v36, v36, v39, v17 bitop3:0xa8
    v_bitop3_b32 v40, v40, v43, v17 bitop3:0xa8
    v_bitop3_b32 v44, v44, v47, v17 bitop3:0xa8
    v_cmp_ne_u32 s[4:5], 0, v32
    v_cmp_ne_u32 s[6:7], 0, v36
    v_cmp_ne_u32 s[8:9], 0, v40
    v_cmp_ne_u32 s[10:11], 0, v44
    s_or_b64 vcc, s[4:5], s[6:7]
    s_or_b64 s[32:33], s[8:9], s[10:11]
    s_or_b64 vcc, vcc, s[32:33]
    s_cbranch_scc0 L_aux_gok
    s_add_u32 s43, s43, 1
    s_cmp_ge_u32 s43, 65536
    s_cbranch_scc1 L_aux_gok
    s_sleep 2
    s_mov_b64 exec, s[4:5]
    s_cbranch_execz L_aux_gs0
    buffer_load_dwordx4 v[128:131], v14, s[12:15], 0 offen sc1
    buffer_load_dwordx4 v[132:135], v14, s[12:15], s60 offen sc1
L_aux_gs0:
    s_mov_b64 exec, s[6:7]
    s_cbranch_execz L_aux_gs1
    buffer_load_dwordx4 v[136:139], v14, s[12:15], s61 offen sc1
    buffer_load_dwordx4 v[140:143], v14, s[12:15], s62 offen sc1
L_aux_gs1:
    s_mov_b64 exec, s[8:9]
    s_cbranch_execz L_aux_gs2
    buffer_load_dwordx4 v[144:147], v14, s[12:15], s63 offen sc1
    buffer_load_dwordx4 v[148:151], v14, s[12:15], s64 offen sc1
L_aux_gs2:
    s_mov_b64 exec, s[10:11]
    s_cbranch_execz L_aux_gs3
    buffer_load_dwordx4 v[152:155], v14, s[12:15], s65 offen sc1
    buffer_load_dwordx4 v[156:159], v14, s[12:15], s66 offen sc1
L_aux_gs3:
    s_mov_b64 exec, -1
    s_branch L_aux_gp
L_aux_gok:
    v_pk_add_f32 v[128:129], v[128:129], v[144:145]
    v_pk_add_f32 v[130:131], v[130:131], v[146:147]
    v_pk_add_f32 v[136:137], v[136:137], v[152:153]
    v_pk_add_f32 v[138:139], v[138:139], v[154:155]
    v_pk_add_f32 v[132:133], v[132:133], v[148:149]
    v_pk_add_f32 v[134:135], v[134:135], v[150:151]
    v_pk_add_f32 v[140:141], v[140:141], v[156:157]
    v_pk_add_f32 v[142:143], v[142:143], v[158:159]
    v_pk_mul_f32 v[144:145], v[128:129], s[58:59] op_sel_hi:[1,0]
    v_pk_mul_f32 v[146:147], v[130:131], s[58:59] op_sel_hi:[1,0]
    v_pk_mul_f32 v[148:149], v[132:133], s[58:59] op_sel_hi:[1,0]
    v_pk_mul_f32 v[150:151], v[134:135], s[58:59] op_sel_hi:[1,0]
    v_exp_f32 v144, v144
    v_exp_f32 v145, v145
    v_exp_f32 v146, v146
    v_exp_f32 v147, v147
    v_pk_mul_f32 v[128:129], v[128:129], v[136:137]
    v_pk_mul_f32 v[130:131], v[130:131], v[138:139]
    v_exp_f32 v148, v148
    v_exp_f32 v149, v149
    v_exp_f32 v150, v150
    v_exp_f32 v151, v151
    v_pk_mul_f32 v[132:133], v[132:133], v[140:141]
    v_pk_mul_f32 v[134:135], v[134:135], v[142:143]
    v_pk_add_f32 v[144:145], v[144:145], 1.0 op_sel_hi:[1,0]
    v_pk_add_f32 v[146:147], v[146:147], 1.0 op_sel_hi:[1,0]
    v_pk_add_f32 v[148:149], v[148:149], 1.0 op_sel_hi:[1,0]
    v_pk_add_f32 v[150:151], v[150:151], 1.0 op_sel_hi:[1,0]
    v_rcp_f32 v144, v144
    v_rcp_f32 v145, v145
    v_rcp_f32 v146, v146
    v_rcp_f32 v147, v147
    v_rcp_f32 v148, v148
    v_rcp_f32 v149, v149
    v_rcp_f32 v150, v150
    v_rcp_f32 v151, v151
    v_pk_mul_f32 v[128:129], v[128:129], v[144:145]
    v_pk_mul_f32 v[130:131], v[130:131], v[146:147]
    v_cvt_pk_bf16_f32 v136, v128, v129
    v_cvt_pk_bf16_f32 v137, v130, v131
    ds_write_b64 v16, v[136:137] offset:0
    v_pk_mul_f32 v[132:133], v[132:133], v[148:149]
    v_pk_mul_f32 v[134:135], v[134:135], v[150:151]
    v_cvt_pk_bf16_f32 v140, v132, v133
    v_cvt_pk_bf16_f32 v141, v134, v135
    ds_write_b64 v16, v[140:141] offset:3584
L_aux_nohp:
    s_waitcnt lgkmcnt(0)
    s_barrier
    ds_read_b64 v[96:97], v15 offset:0
    ds_read_b64 v[98:99], v15 offset:512
    ds_read_b64 v[100:101], v15 offset:1024
    ds_read_b64 v[102:103], v15 offset:1536
    ds_read_b64 v[104:105], v15 offset:2048
    ds_read_b64 v[106:107], v15 offset:2560
    ds_read_b64 v[108:109], v15 offset:3072
    ds_read_b64 v[110:111], v15 offset:3584
    ds_read_b64 v[112:113], v15 offset:4096
    ds_read_b64 v[114:115], v15 offset:4608
    ds_read_b64 v[116:117], v15 offset:5120
    ds_read_b64 v[118:119], v15 offset:5632
    ds_read_b64 v[120:121], v15 offset:6144
    ds_read_b64 v[122:123], v15 offset:6656
    s_lshl_b32 s46, s38, 3
    s_add_u32 s46, s46, s31
    s_lshl_b32 s46, s46, 3
    s_add_u32 s46, s46, s50
    s_lshl_b32 s46, s46, 8
    s_add_u32 s46, s46, 491520
    v_lshlrev_b32 v14, 7, v3
    v_lshl_add_u32 v14, v2, 4, v14
    v_add_u32 v14, s46, v14
    s_waitcnt lgkmcnt(12)
    v_mfma_f32_16x16x32_bf16 v[32:35], v[64:67], v[96:99], 0
    s_waitcnt lgkmcnt(10)
    v_mfma_f32_16x16x32_bf16 v[32:35], v[68:71], v[100:103], v[32:35]
    s_waitcnt lgkmcnt(8)
    v_mfma_f32_16x16x32_bf16 v[32:35], v[72:75], v[104:107], v[32:35]
    s_waitcnt lgkmcnt(6)
    v_mfma_f32_16x16x32_bf16 v[32:35], v[76:79], v[108:111], v[32:35]
    s_waitcnt lgkmcnt(4)
    v_mfma_f32_16x16x32_bf16 v[32:35], v[80:83], v[112:115], v[32:35]
    s_waitcnt lgkmcnt(2)
    v_mfma_f32_16x16x32_bf16 v[32:35], v[84:87], v[116:119], v[32:35]
    s_waitcnt lgkmcnt(0)
    v_mfma_f32_16x16x32_bf16 v[32:35], v[88:91], v[120:123], v[32:35]
    s_nop 7
    v_mov_b32_dpp v36, v32 row_ror:8 row_mask:0xf bank_mask:0xf
    v_mov_b32_dpp v37, v33 row_ror:8 row_mask:0xf bank_mask:0xf
    v_mov_b32_dpp v38, v34 row_ror:8 row_mask:0xf bank_mask:0xf
    v_mov_b32_dpp v39, v35 row_ror:8 row_mask:0xf bank_mask:0xf
    v_permlane32_swap_b32 v36, v40
    v_permlane32_swap_b32 v37, v41
    v_permlane32_swap_b32 v38, v42
    v_permlane32_swap_b32 v39, v43
    v_pk_add_f32 v[32:33], v[32:33], v[40:41]
    v_pk_add_f32 v[34:35], v[34:35], v[42:43]
    v_and_or_b32 v32, v32, v245, s84
    v_and_or_b32 v33, v33, v245, s85
    v_and_or_b32 v34, v34, v245, s86
    v_and_or_b32 v35, v35, v245, s87
    s_mov_b64 exec, 0x00ff00ff
    buffer_store_dwordx4 v[32:35], v14, s[12:15], 0 offen sc1
    s_mov_b64 exec, -1
    s_lshl_b32 s48, s30, 3
    s_add_u32 s48, s48, s31
    s_cmp_lg_u32 s48, 1016
    s_cbranch_scc1 L_aux_done
    v_lshlrev_b32 v21, 3, v1
    v_add_u32 v21, 2048, v21
    s_mov_b32 s43, 0
L_poll_ack:
    buffer_load_dwordx2 v[60:61], v21, s[12:15], 0 offen sc1
    s_waitcnt vmcnt(0)
    v_xor_b32 v14, s29, v60
    v_bitop3_b32 v14, v14, v61, s29 bitop3:0xf6
    v_cmp_ne_u32 vcc, 0, v14
    s_cbranch_vccz L_polled_ack
    s_add_u32 s43, s43, 1
    s_cmp_ge_u32 s43, 65536
    s_cbranch_scc1 L_polled_ack
    s_sleep 4
    s_branch L_poll_ack
L_polled_ack:
    v_mov_b32 v5, s29
    v_mov_b32 v4, 0
    s_mov_b64 exec, 1
    buffer_store_dword v5, v4, s[12:15], 0 offen sc1
L_aux_done:
    s_endpgm
L_aux_slow:
    s_waitcnt lgkmcnt(0)
    v_lshlrev_b32 v14, 5, v0
    v_add_u32 v14, 140432, v14
    ds_write_b128 v14, v[80:83]
    ds_write_b128 v14, v[84:87] offset:16
    s_waitcnt lgkmcnt(0)
    s_mov_b64 exec, 1
    ds_add_u32 v22, v23 offset:256
    s_mov_b64 exec, -1
    s_mov_b32 s43, 0
L_lw_slow:
    ds_read_b32 v18, v22 offset:256
    s_add_u32 s43, s43, 1
    s_cmp_ge_u32 s43, 524288
    s_cbranch_scc1 L_lwx_slow
    s_waitcnt lgkmcnt(0)
    v_readfirstlane_b32 s46, v18
    s_cmp_ge_u32 s46, 4
    s_cbranch_scc1 L_lwx_slow
    s_branch L_lw_slow
L_lwx_slow:
    s_waitcnt lgkmcnt(0)
    v_lshlrev_b32 v14, 4, v1
    v_add_u32 v14, 140432, v14
    ds_read_b128 v[128:131], v14 offset:0
    ds_read_b128 v[132:135], v14 offset:1024
    ds_read_b128 v[136:139], v14 offset:2048
    ds_read_b128 v[140:143], v14 offset:3072
    ds_read_b128 v[144:147], v14 offset:4096
    ds_read_b128 v[148:151], v14 offset:5120
    ds_read_b128 v[152:155], v14 offset:6144
    ds_read_b128 v[156:159], v14 offset:7168
    s_waitcnt lgkmcnt(0)
    s_cmp_ge_u32 s31, 2
    s_cbranch_scc1 L_aux_wd
    s_mov_b32 s46, 0
    v_mov_b32 v20, v1
    v_mov_b32 v17, 0
L_aux_slow2:
    v_max3_u32 v14, v128, v129, v130
    v_max3_u32 v14, v14, v131, v132
    v_max3_u32 v14, v14, v133, v134
    v_max3_u32 v14, v14, v135, v136
    v_max3_u32 v14, v14, v137, v138
    v_max3_u32 v14, v14, v139, v140
    v_max3_u32 v14, v14, v141, v142
    v_max3_u32 v14, v14, v143, v144
    v_max3_u32 v14, v14, v145, v146
    v_max3_u32 v14, v14, v147, v148
    v_max3_u32 v14, v14, v149, v150
    v_max3_u32 v14, v14, v151, v152
    v_max3_u32 v14, v14, v153, v154
    v_max3_u32 v14, v14, v155, v156
    v_max3_u32 v14, v14, v157, v158
    v_max_u32 v14, v14, v159
    s_nop 1
    v_max_u32_dpp v14, v14, v14 row_ror:8 row_mask:0xf bank_mask:0xf
    s_nop 1
    v_max_u32_dpp v14, v14, v14 row_ror:4 row_mask:0xf bank_mask:0xf
    s_nop 1
    v_max_u32_dpp v14, v14, v14 row_ror:2 row_mask:0xf bank_mask:0xf
    s_nop 1
    v_max_u32_dpp v14, v14, v14 row_ror:1 row_mask:0xf bank_mask:0xf
    v_mov_b32 v15, v14
    s_nop 1
    v_permlane16_swap_b32 v14, v15
    v_max_u32 v14, v14, v15
    v_mov_b32 v15, v14
    s_nop 1
    v_permlane32_swap_b32 v14, v15
    v_max_u32 v14, v14, v15
    v_cmp_eq_u32 vcc, s46, v20
    s_nop 1
    v_cndmask_b32 v17, v17, v14, vcc
    v_cmp_ne_u32 vcc, v14, v128
    s_nop 1
    v_cndmask_b32 v128, 0, v128, vcc
    v_cmp_ne_u32 vcc, v14, v129
    s_nop 1
    v_cndmask_b32 v129, 0, v129, vcc
    v_cmp_ne_u32 vcc, v14, v130
    s_nop 1
    v_cndmask_b32 v130, 0, v130, vcc
    v_cmp_ne_u32 vcc, v14, v131
    s_nop 1
    v_cndmask_b32 v131, 0, v131, vcc
    v_cmp_ne_u32 vcc, v14, v132
    s_nop 1
    v_cndmask_b32 v132, 0, v132, vcc
    v_cmp_ne_u32 vcc, v14, v133
    s_nop 1
    v_cndmask_b32 v133, 0, v133, vcc
    v_cmp_ne_u32 vcc, v14, v134
    s_nop 1
    v_cndmask_b32 v134, 0, v134, vcc
    v_cmp_ne_u32 vcc, v14, v135
    s_nop 1
    v_cndmask_b32 v135, 0, v135, vcc
    v_cmp_ne_u32 vcc, v14, v136
    s_nop 1
    v_cndmask_b32 v136, 0, v136, vcc
    v_cmp_ne_u32 vcc, v14, v137
    s_nop 1
    v_cndmask_b32 v137, 0, v137, vcc
    v_cmp_ne_u32 vcc, v14, v138
    s_nop 1
    v_cndmask_b32 v138, 0, v138, vcc
    v_cmp_ne_u32 vcc, v14, v139
    s_nop 1
    v_cndmask_b32 v139, 0, v139, vcc
    v_cmp_ne_u32 vcc, v14, v140
    s_nop 1
    v_cndmask_b32 v140, 0, v140, vcc
    v_cmp_ne_u32 vcc, v14, v141
    s_nop 1
    v_cndmask_b32 v141, 0, v141, vcc
    v_cmp_ne_u32 vcc, v14, v142
    s_nop 1
    v_cndmask_b32 v142, 0, v142, vcc
    v_cmp_ne_u32 vcc, v14, v143
    s_nop 1
    v_cndmask_b32 v143, 0, v143, vcc
    v_cmp_ne_u32 vcc, v14, v144
    s_nop 1
    v_cndmask_b32 v144, 0, v144, vcc
    v_cmp_ne_u32 vcc, v14, v145
    s_nop 1
    v_cndmask_b32 v145, 0, v145, vcc
    v_cmp_ne_u32 vcc, v14, v146
    s_nop 1
    v_cndmask_b32 v146, 0, v146, vcc
    v_cmp_ne_u32 vcc, v14, v147
    s_nop 1
    v_cndmask_b32 v147, 0, v147, vcc
    v_cmp_ne_u32 vcc, v14, v148
    s_nop 1
    v_cndmask_b32 v148, 0, v148, vcc
    v_cmp_ne_u32 vcc, v14, v149
    s_nop 1
    v_cndmask_b32 v149, 0, v149, vcc
    v_cmp_ne_u32 vcc, v14, v150
    s_nop 1
    v_cndmask_b32 v150, 0, v150, vcc
    v_cmp_ne_u32 vcc, v14, v151
    s_nop 1
    v_cndmask_b32 v151, 0, v151, vcc
    v_cmp_ne_u32 vcc, v14, v152
    s_nop 1
    v_cndmask_b32 v152, 0, v152, vcc
    v_cmp_ne_u32 vcc, v14, v153
    s_nop 1
    v_cndmask_b32 v153, 0, v153, vcc
    v_cmp_ne_u32 vcc, v14, v154
    s_nop 1
    v_cndmask_b32 v154, 0, v154, vcc
    v_cmp_ne_u32 vcc, v14, v155
    s_nop 1
    v_cndmask_b32 v155, 0, v155, vcc
    v_cmp_ne_u32 vcc, v14, v156
    s_nop 1
    v_cndmask_b32 v156, 0, v156, vcc
    v_cmp_ne_u32 vcc, v14, v157
    s_nop 1
    v_cndmask_b32 v157, 0, v157, vcc
    v_cmp_ne_u32 vcc, v14, v158
    s_nop 1
    v_cndmask_b32 v158, 0, v158, vcc
    v_cmp_ne_u32 vcc, v14, v159
    s_nop 1
    v_cndmask_b32 v159, 0, v159, vcc
    s_add_u32 s46, s46, 1
    s_cmp_lt_u32 s46, 8
    s_cbranch_scc1 L_aux_slow2
    s_branch L_aux_sel
L_exit:
    s_endpgm
.p2align 6
L_conv:
    s_and_b32 s56, s2, 7
    s_lshl_b32 s44, s56, 4
    s_add_u32 s44, s44, s3
    v_and_b32 v1, 63, v0
    v_and_b32 v2, 15, v0
    v_bfe_u32 v3, v0, 4, 2
    v_lshrrev_b32 v4, 6, v0
    s_nop 0
    v_readfirstlane_b32 s45, v4
    s_mov_b32 s40, 0x3fb8aa3b
    s_mov_b32 s41, 0x32a57060
    s_lshl_b32 s46, s44, 3
    s_add_u32 s46, s46, s45
    s_lshl_b32 s47, s46, 8
    s_lshl_b32 s48, s46, 1
    s_lshl_b32 s49, s44, 4
    v_lshl_add_u32 v4, v1, 2, s47
    v_mov_b32 v5, s48
    s_waitcnt lgkmcnt(0)
    s_load_dword s50, s[36:37], 0
    s_mov_b32 s26, 2048
    s_mov_b32 s27, 0x00020000
    s_mov_b32 s10, 262144
    s_mov_b32 s11, 0x00020000
    s_mov_b32 s14, 262144
    s_mov_b32 s15, 0x00020000
    s_mov_b32 s18, 262144
    s_mov_b32 s19, 0x00020000
    s_mov_b32 s22, 262144
    s_mov_b32 s23, 0x00020000
    s_mov_b32 s30, 2048
    s_mov_b32 s31, 0x00020000
    buffer_load_ushort v15, v5, s[24:27], 0 offen
    buffer_load_dword v16, v4, s[8:11], 0 offen nt
    buffer_load_dword v17, v4, s[12:15], 0 offen nt
    buffer_load_dword v18, v4, s[16:19], 0 offen nt
    buffer_load_dword v19, v4, s[20:23], 0 offen nt
    buffer_load_ushort v14, v5, s[28:31], 0 offen
    s_mov_b32 s6, 4194304
    s_mov_b32 s7, 0x00020000
    s_mov_b32 s34, 4194304
    s_mov_b32 s35, 0x00020000
    s_mov_b32 s38, 753664
    s_mov_b32 s39, 0x00020000
    s_cmp_lt_u32 s45, 4
    s_cbranch_scc1 L_conv_p
    s_setprio 1
L_conv_p:
    v_xor_b32 v9, v1, v3
    s_lshl_b32 s57, s45, 19
    s_add_u32 s57, s57, s49
    v_lshl_add_u32 v9, v9, 11, s57
    s_lshl_b32 s57, s3, 7
    s_lshl_b32 s58, s45, 4
    s_add_u32 s57, s57, s58
    s_lshl_b32 s57, s57, 11
    s_lshl_b32 s58, s56, 8
    s_add_u32 s57, s57, s58
    v_lshrrev_b32 v11, 1, v1
    v_lshlrev_b32 v11, 11, v11
    v_and_b32 v10, 1, v1
    v_lshl_add_u32 v11, v10, 7, v11
    v_add_u32 v11, s57, v11
    s_mov_b32 s53, 4096
    s_mov_b32 s54, 8192
    s_mov_b32 s55, 12288
    s_mul_i32 s57, s45, 3072
    s_add_u32 s57, s57, 67584
    s_mul_i32 s51, s45, 4608
    s_add_u32 s51, s51, 92160
    v_mov_b32 v64, 0
    v_mov_b32 v65, 0
    v_mov_b32 v66, 0
    v_mov_b32 v67, 0
    v_lshl_add_u32 v10, v1, 4, s57
    ds_write_b128 v10, v[64:67] offset:0
    ds_write_b128 v10, v[64:67] offset:1024
    ds_write_b128 v10, v[64:67] offset:2048
    v_lshl_add_u32 v10, v1, 3, s51
    ds_write_b64 v10, v[64:65]
    v_lshlrev_b32 v4, 3, v3
    v_sub_u32 v4, v4, v2
    v_add_u32 v4, 15, v4
    v_min_u32 v4, 31, v4
    s_mov_b32 s43, 0x3e00000
    v_lshrrev_b32 v5, v4, s43
    v_bfe_i32 v6, v5, 0, 1
    v_bfe_i32 v7, v5, 1, 1
    v_and_b32 v6, 0x3f80, v6
    v_and_b32 v7, 0x3f800000, v7
    v_or_b32 v128, v6, v7
    v_bfe_i32 v6, v5, 2, 1
    v_bfe_i32 v7, v5, 3, 1
    v_and_b32 v6, 0x3f80, v6
    v_and_b32 v7, 0x3f800000, v7
    v_or_b32 v129, v6, v7
    v_bfe_i32 v6, v5, 4, 1
    v_bfe_i32 v7, v5, 5, 1
    v_and_b32 v6, 0x3f80, v6
    v_and_b32 v7, 0x3f800000, v7
    v_or_b32 v130, v6, v7
    v_bfe_i32 v6, v5, 6, 1
    v_bfe_i32 v7, v5, 7, 1
    v_and_b32 v6, 0x3f80, v6
    v_and_b32 v7, 0x3f800000, v7
    v_or_b32 v131, v6, v7
    s_mov_b32 s43, 0x1c0000
    v_lshrrev_b32 v5, v4, s43
    v_bfe_i32 v6, v5, 0, 1
    v_bfe_i32 v7, v5, 1, 1
    v_and_b32 v6, 0x3f80, v6
    v_and_b32 v7, 0x3f800000, v7
    v_or_b32 v132, v6, v7
    v_bfe_i32 v6, v5, 2, 1
    v_bfe_i32 v7, v5, 3, 1
    v_and_b32 v6, 0x3f80, v6
    v_and_b32 v7, 0x3f800000, v7
    v_or_b32 v133, v6, v7
    v_bfe_i32 v6, v5, 4, 1
    v_bfe_i32 v7, v5, 5, 1
    v_and_b32 v6, 0x3f80, v6
    v_and_b32 v7, 0x3f800000, v7
    v_or_b32 v134, v6, v7
    v_bfe_i32 v6, v5, 6, 1
    v_bfe_i32 v7, v5, 7, 1
    v_and_b32 v6, 0x3f80, v6
    v_and_b32 v7, 0x3f800000, v7
    v_or_b32 v135, v6, v7
    s_mov_b32 s43, 0xff80000
    v_lshrrev_b32 v5, v4, s43
    v_bfe_i32 v6, v5, 0, 1
    v_bfe_i32 v7, v5, 1, 1
    v_and_b32 v6, 0x3f80, v6
    v_and_b32 v7, 0x3f800000, v7
    v_or_b32 v136, v6, v7
    v_bfe_i32 v6, v5, 2, 1
    v_bfe_i32 v7, v5, 3, 1
    v_and_b32 v6, 0x3f80, v6
    v_and_b32 v7, 0x3f800000, v7
    v_or_b32 v137, v6, v7
    v_bfe_i32 v6, v5, 4, 1
    v_bfe_i32 v7, v5, 5, 1
    v_and_b32 v6, 0x3f80, v6
    v_and_b32 v7, 0x3f800000, v7
    v_or_b32 v138, v6, v7
    v_bfe_i32 v6, v5, 6, 1
    v_bfe_i32 v7, v5, 7, 1
    v_and_b32 v6, 0x3f80, v6
    v_and_b32 v7, 0x3f800000, v7
    v_or_b32 v139, v6, v7
    s_mov_b32 s43, 0x7f00000
    v_lshrrev_b32 v5, v4, s43
    v_bfe_i32 v6, v5, 0, 1
    v_bfe_i32 v7, v5, 1, 1
    v_and_b32 v6, 0x3f80, v6
    v_and_b32 v7, 0x3f800000, v7
    v_or_b32 v140, v6, v7
    v_bfe_i32 v6, v5, 2, 1
    v_bfe_i32 v7, v5, 3, 1
    v_and_b32 v6, 0x3f80, v6
    v_and_b32 v7, 0x3f800000, v7
    v_or_b32 v141, v6, v7
    v_bfe_i32 v6, v5, 4, 1
    v_bfe_i32 v7, v5, 5, 1
    v_and_b32 v6, 0x3f80, v6
    v_and_b32 v7, 0x3f800000, v7
    v_or_b32 v142, v6, v7
    v_bfe_i32 v6, v5, 6, 1
    v_bfe_i32 v7, v5, 7, 1
    v_and_b32 v6, 0x3f80, v6
    v_and_b32 v7, 0x3f800000, v7
    v_or_b32 v143, v6, v7
    s_mov_b32 s43, 0x18000000
    v_lshrrev_b32 v5, v4, s43
    v_bfe_i32 v6, v5, 0, 1
    v_bfe_i32 v7, v5, 1, 1
    v_and_b32 v6, 0xffff, v6
    v_and_b32 v7, 0xffff0000, v7
    v_or_b32 v124, v6, v7
    v_bfe_i32 v6, v5, 2, 1
    v_bfe_i32 v7, v5, 3, 1
    v_and_b32 v6, 0xffff, v6
    v_and_b32 v7, 0xffff0000, v7
    v_or_b32 v125, v6, v7
    v_bfe_i32 v6, v5, 4, 1
    v_bfe_i32 v7, v5, 5, 1
    v_and_b32 v6, 0xffff, v6
    v_and_b32 v7, 0xffff0000, v7
    v_or_b32 v126, v6, v7
    v_bfe_i32 v6, v5, 6, 1
    v_bfe_i32 v7, v5, 7, 1
    v_and_b32 v6, 0xffff, v6
    v_and_b32 v7, 0xffff0000, v7
    v_or_b32 v127, v6, v7
    v_lshlrev_b32 v10, 5, v2
    v_lshl_add_u32 v160, v3, 9, v10
    v_add_u32 v160, s57, v160
    v_add_u32 v160, 1084, v160
    v_and_b32 v12, 1, v3
    v_lshl_add_u32 v161, v12, 4, v10
    v_lshrrev_b32 v12, 1, v3
    v_lshl_add_u32 v161, v12, 9, v161
    v_add3_u32 v161, v161, s57, 64
    v_and_b32 v12, 1, v2
    v_lshrrev_b32 v13, 1, v2
    v_lshlrev_b32 v162, 2, v13
    v_lshl_add_u32 v162, v3, 6, v162
    v_mul_u32_u24 v13, 260, v12
    v_add3_u32 v162, v162, v13, s57
    v_add_u32 v162, 2172, v162
    v_lshlrev_b32 v163, 1, v2
    v_lshl_add_u32 v163, v3, 7, v163
    v_lshl_add_u32 v163, v12, 2, v163
    v_add_u32 v163, s57, v163
    v_add_u32 v163, 2812, v163
    v_mov_b32 v164, v163
    s_add_u32 s43, s57, 2428
    v_writelane_b32 v164, s43, 0
    v_lshl_add_u32 v10, v2, 2, s57
    v_lshlrev_b32 v12, 5, v3
    v_sub_u32 v165, v10, v12
    v_add_u32 v165, 104, v165
    v_add_u32 v166, 1024, v165
    v_add_u32 v167, 2048, v165
    v_lshlrev_b32 v12, 4, v3
    v_sub_u32 v168, v10, v12
    v_add_u32 v168, 2292, v168
    v_mov_b32 v169, 0
    v_writelane_b32 v169, -1, 0
    s_mov_b32 s58, 0
    s_mov_b32 s59, 1
    s_mul_i32 s42, s45, 8448
    s_mov_b32 m0, s42
    s_mov_b32 s60, s42
    s_lshl_b32 s61, s45, 12
    s_add_u32 s61, s61, 129024
    v_lshl_add_u32 v5, v1, 3, s42
    v_mul_u32_u24 v6, 528, v2
    v_and_b32 v10, 1, v3
    v_lshl_add_u32 v6, v10, 8, v6
    v_lshrrev_b32 v10, 1, v3
    v_lshl_add_u32 v6, v10, 4, v6
    v_add_u32 v6, s42, v6
    v_lshlrev_b32 v10, 5, v2
    v_lshl_add_u32 v7, v3, 4, v10
    v_add3_u32 v7, v7, s51, 32
    s_mul_i32 s42, s45, 8512
    s_add_u32 s42, s42, 0
    v_lshl_add_u32 v8, v3, 3, v10
    v_add_u32 v8, s42, v8
    s_waitcnt lgkmcnt(0)
    s_mul_i32 s52, s50, 0x9e3779b1
    s_add_u32 s52, s52, 0x7f4a7c15
    s_waitcnt vmcnt(0)
L_conv_kg:
    s_mov_b32 exec_hi, 0
    buffer_load_dword v170, v11, s[4:7], 0 offen nt
    s_mov_b32 exec_hi, -1
    s_cmp_lg_u32 s45, 4
    s_cbranch_scc1 L_conv_noack
    s_lshl_b32 s50, s44, 2
    s_add_u32 s50, s50, 2048
    v_mov_b32 v10, s50
    v_mov_b32 v12, s52
    s_mov_b64 exec, 1
    buffer_store_dword v12, v10, s[36:39], 0 offen sc1
    s_mov_b64 exec, -1
L_conv_noack:
    v_lshlrev_b32 v15, 16, v15
    v_lshlrev_b32 v116, 16, v16
    v_and_b32 v117, 0xffff0000, v16
    v_mul_f32 v112, s40, v15
    v_mul_f32 v114, s40, v116
    v_mul_f32 v118, s40, v117
    v_fma_f32 v113, v15, s40, -v112
    v_fma_f32 v115, v116, s40, -v114
    v_fma_f32 v119, v117, s40, -v118
    v_fma_f32 v113, v15, s41, v113
    v_fma_f32 v115, v116, s41, v115
    v_fma_f32 v119, v117, s41, v119
    v_exp_f32 v76, v112
    v_exp_f32 v72, v114
    v_exp_f32 v73, v118
    v_mul_f32 v113, 0x3f317218, v113
    v_mul_f32 v115, 0x3f317218, v115
    v_mul_f32 v119, 0x3f317218, v119
    v_fma_f32 v76, v76, v113, v76
    v_fma_f32 v72, v72, v115, v72
    v_fma_f32 v73, v73, v119, v73
    v_lshlrev_b32 v74, 16, v17
    v_and_b32 v75, 0xffff0000, v17
    v_cvt_pk_bf16_f32 v76, v76, v76
    v_cvt_pk_bf16_f32 v64, v72, v73
    v_and_b32 v76, 0xffff0000, v76
    v_lshlrev_b32 v72, 16, v64
    v_and_b32 v73, 0xffff0000, v64
    v_pk_mul_f32 v[74:75], v[74:75], v[76:77] op_sel_hi:[1,0]
    v_pk_mul_f32 v[72:73], v[72:73], v[76:77] op_sel_hi:[1,0]
    v_mul_f32 v74, 0.15915494, v74
    v_mul_f32 v72, 0xbfb8aa3b, v72
    v_mul_f32 v75, 0.15915494, v75
    v_mul_f32 v73, 0xbfb8aa3b, v73
    v_mul_f32 v112, 0x41000000, v72
    v_mul_f32 v113, 0x41000000, v74
    v_mul_f32 v114, 0x41000000, v73
    v_mul_f32 v115, 0x41000000, v75
    v_exp_f32 v112, v112
    v_fract_f32 v113, v113
    v_exp_f32 v114, v114
    v_fract_f32 v115, v115
    v_cos_f32 v24, v113
    v_sin_f32 v25, v113
    v_cos_f32 v26, v115
    v_sin_f32 v27, v115
    v_pk_mul_f32 v[24:25], v[24:25], v[112:113] op_sel:[0,0] op_sel_hi:[1,0] neg_hi:[1,0]
    v_pk_mul_f32 v[26:27], v[26:27], v[114:115] op_sel:[0,0] op_sel_hi:[1,0] neg_hi:[1,0]
    v_lshlrev_b32 v120, 16, v14
    v_mov_b32 v68, 0x3f80
    v_mov_b32 v69, 0x3f80
    ds_write_addtid_b32 v68 offset:0
    ds_write_addtid_b32 v69 offset:256
    v_cvt_pk_bf16_f32 v70, v24, v25
    v_cvt_pk_bf16_f32 v71, v26, v27
    ds_write_addtid_b32 v70 offset:528
    ds_write_addtid_b32 v71 offset:784
    v_pk_mul_f32 v[64:65], v[24:25], v[24:25] op_sel:[1,1] op_sel_hi:[1,0] neg_lo:[1,0]
    v_pk_mul_f32 v[66:67], v[26:27], v[26:27] op_sel:[1,1] op_sel_hi:[1,0] neg_lo:[1,0]
    v_pk_fma_f32 v[12:13], v[24:25], v[24:25], v[64:65] op_sel:[0,0,0] op_sel_hi:[0,1,1]
    v_pk_fma_f32 v[14:15], v[26:27], v[26:27], v[66:67] op_sel:[0,0,0] op_sel_hi:[0,1,1]
    v_cvt_pk_bf16_f32 v68, v12, v13
    v_cvt_pk_bf16_f32 v69, v14, v15
    ds_write_addtid_b32 v68 offset:1056
    ds_write_addtid_b32 v69 offset:1312
    v_pk_mul_f32 v[64:65], v[12:13], v[24:25] op_sel:[1,1] op_sel_hi:[1,0] neg_lo:[1,0]
    v_pk_mul_f32 v[66:67], v[14:15], v[26:27] op_sel:[1,1] op_sel_hi:[1,0] neg_lo:[1,0]
    v_pk_fma_f32 v[12:13], v[12:13], v[24:25], v[64:65] op_sel:[0,0,0] op_sel_hi:[0,1,1]
    v_pk_fma_f32 v[14:15], v[14:15], v[26:27], v[66:67] op_sel:[0,0,0] op_sel_hi:[0,1,1]
    v_cvt_pk_bf16_f32 v70, v12, v13
    v_cvt_pk_bf16_f32 v71, v14, v15
    ds_write_addtid_b32 v70 offset:1584
    ds_write_addtid_b32 v71 offset:1840
    v_add_f32 v77, v76, v76
    v_add_f32 v120, 1.0, v120
    v_lshlrev_b32 v32, 16, v18
    v_pk_mul_f32 v[64:65], v[12:13], v[24:25] op_sel:[1,1] op_sel_hi:[1,0] neg_lo:[1,0]
    v_pk_mul_f32 v[66:67], v[14:15], v[26:27] op_sel:[1,1] op_sel_hi:[1,0] neg_lo:[1,0]
    v_pk_fma_f32 v[12:13], v[12:13], v[24:25], v[64:65] op_sel:[0,0,0] op_sel_hi:[0,1,1]
    v_pk_fma_f32 v[14:15], v[14:15], v[26:27], v[66:67] op_sel:[0,0,0] op_sel_hi:[0,1,1]
    v_cvt_pk_bf16_f32 v68, v12, v13
    v_cvt_pk_bf16_f32 v69, v14, v15
    ds_write_addtid_b32 v68 offset:2112
    ds_write_addtid_b32 v69 offset:2368
    v_lshlrev_b32 v33, 16, v19
    v_and_b32 v34, 0xffff0000, v18
    v_and_b32 v35, 0xffff0000, v19
    v_pk_mul_f32 v[64:65], v[12:13], v[24:25] op_sel:[1,1] op_sel_hi:[1,0] neg_lo:[1,0]
    v_pk_mul_f32 v[66:67], v[14:15], v[26:27] op_sel:[1,1] op_sel_hi:[1,0] neg_lo:[1,0]
    v_pk_fma_f32 v[12:13], v[12:13], v[24:25], v[64:65] op_sel:[0,0,0] op_sel_hi:[0,1,1]
    v_pk_fma_f32 v[14:15], v[14:15], v[26:27], v[66:67] op_sel:[0,0,0] op_sel_hi:[0,1,1]
    v_cvt_pk_bf16_f32 v70, v12, v13
    v_cvt_pk_bf16_f32 v71, v14, v15
    ds_write_addtid_b32 v70 offset:2640
    ds_write_addtid_b32 v71 offset:2896
    v_and_b32 v169, v169, v120
    v_pk_mul_f32 v[32:33], v[32:33], v[76:77] op_sel:[0,1] op_sel_hi:[1,1]
    v_pk_mul_f32 v[34:35], v[34:35], v[76:77] op_sel:[0,1] op_sel_hi:[1,1]
    v_pk_mul_f32 v[64:65], v[12:13], v[24:25] op_sel:[1,1] op_sel_hi:[1,0] neg_lo:[1,0]
    v_pk_mul_f32 v[66:67], v[14:15], v[26:27] op_sel:[1,1] op_sel_hi:[1,0] neg_lo:[1,0]
    v_pk_fma_f32 v[12:13], v[12:13], v[24:25], v[64:65] op_sel:[0,0,0] op_sel_hi:[0,1,1]
    v_pk_fma_f32 v[14:15], v[14:15], v[26:27], v[66:67] op_sel:[0,0,0] op_sel_hi:[0,1,1]
    v_cvt_pk_bf16_f32 v68, v12, v13
    v_cvt_pk_bf16_f32 v69, v14, v15
    ds_write_addtid_b32 v68 offset:3168
    ds_write_addtid_b32 v69 offset:3424
    v_exp_f32 v112, v72
    v_fract_f32 v113, v74
    v_exp_f32 v114, v73
    v_pk_mul_f32 v[64:65], v[12:13], v[24:25] op_sel:[1,1] op_sel_hi:[1,0] neg_lo:[1,0]
    v_pk_mul_f32 v[66:67], v[14:15], v[26:27] op_sel:[1,1] op_sel_hi:[1,0] neg_lo:[1,0]
    v_pk_fma_f32 v[12:13], v[12:13], v[24:25], v[64:65] op_sel:[0,0,0] op_sel_hi:[0,1,1]
    v_pk_fma_f32 v[14:15], v[14:15], v[26:27], v[66:67] op_sel:[0,0,0] op_sel_hi:[0,1,1]
    v_cvt_pk_bf16_f32 v70, v12, v13
    v_cvt_pk_bf16_f32 v71, v14, v15
    ds_write_addtid_b32 v70 offset:3696
    ds_write_addtid_b32 v71 offset:3952
    v_fract_f32 v115, v75
    v_cos_f32 v20, v113
    v_sin_f32 v21, v113
    v_pk_mul_f32 v[64:65], v[12:13], v[24:25] op_sel:[1,1] op_sel_hi:[1,0] neg_lo:[1,0]
    v_pk_mul_f32 v[66:67], v[14:15], v[26:27] op_sel:[1,1] op_sel_hi:[1,0] neg_lo:[1,0]
    v_pk_fma_f32 v[12:13], v[12:13], v[24:25], v[64:65] op_sel:[0,0,0] op_sel_hi:[0,1,1]
    v_pk_fma_f32 v[14:15], v[14:15], v[26:27], v[66:67] op_sel:[0,0,0] op_sel_hi:[0,1,1]
    v_cvt_pk_bf16_f32 v68, v12, v13
    v_cvt_pk_bf16_f32 v69, v14, v15
    ds_write_addtid_b32 v68 offset:4224
    ds_write_addtid_b32 v69 offset:4480
    v_cos_f32 v22, v115
    v_sin_f32 v23, v115
    v_pk_mul_f32 v[20:21], v[20:21], v[112:113] op_sel:[0,0] op_sel_hi:[1,0]
    v_pk_mul_f32 v[64:65], v[12:13], v[24:25] op_sel:[1,1] op_sel_hi:[1,0] neg_lo:[1,0]
    v_pk_mul_f32 v[66:67], v[14:15], v[26:27] op_sel:[1,1] op_sel_hi:[1,0] neg_lo:[1,0]
    v_pk_fma_f32 v[12:13], v[12:13], v[24:25], v[64:65] op_sel:[0,0,0] op_sel_hi:[0,1,1]
    v_pk_fma_f32 v[14:15], v[14:15], v[26:27], v[66:67] op_sel:[0,0,0] op_sel_hi:[0,1,1]
    v_cvt_pk_bf16_f32 v70, v12, v13
    v_cvt_pk_bf16_f32 v71, v14, v15
    ds_write_addtid_b32 v70 offset:4752
    ds_write_addtid_b32 v71 offset:5008
    v_pk_mul_f32 v[22:23], v[22:23], v[114:115] op_sel:[0,0] op_sel_hi:[1,0]
    v_mul_f32 v112, 0x43000000, v72
    v_mul_f32 v113, 0x43000000, v74
    v_pk_mul_f32 v[64:65], v[12:13], v[24:25] op_sel:[1,1] op_sel_hi:[1,0] neg_lo:[1,0]
    v_pk_mul_f32 v[66:67], v[14:15], v[26:27] op_sel:[1,1] op_sel_hi:[1,0] neg_lo:[1,0]
    v_pk_fma_f32 v[12:13], v[12:13], v[24:25], v[64:65] op_sel:[0,0,0] op_sel_hi:[0,1,1]
    v_pk_fma_f32 v[14:15], v[14:15], v[26:27], v[66:67] op_sel:[0,0,0] op_sel_hi:[0,1,1]
    v_cvt_pk_bf16_f32 v68, v12, v13
    v_cvt_pk_bf16_f32 v69, v14, v15
    ds_write_addtid_b32 v68 offset:5280
    ds_write_addtid_b32 v69 offset:5536
    v_mul_f32 v114, 0x43000000, v73
    v_mul_f32 v115, 0x43000000, v75
    v_exp_f32 v112, v112
    v_pk_mul_f32 v[64:65], v[12:13], v[24:25] op_sel:[1,1] op_sel_hi:[1,0] neg_lo:[1,0]
    v_pk_mul_f32 v[66:67], v[14:15], v[26:27] op_sel:[1,1] op_sel_hi:[1,0] neg_lo:[1,0]
    v_pk_fma_f32 v[12:13], v[12:13], v[24:25], v[64:65] op_sel:[0,0,0] op_sel_hi:[0,1,1]
    v_pk_fma_f32 v[14:15], v[14:15], v[26:27], v[66:67] op_sel:[0,0,0] op_sel_hi:[0,1,1]
    v_cvt_pk_bf16_f32 v70, v12, v13
    v_cvt_pk_bf16_f32 v71, v14, v15
    ds_write_addtid_b32 v70 offset:5808
    s_waitcnt vmcnt(0)
    s_mov_b32 s43, 0
    s_add_u32 m0, s61, 0
    s_nop 0
    buffer_load_dwordx4 v9, s[4:7], s43 offen lds
    s_mov_b32 m0, s60
    s_nop 0
    ds_write_addtid_b32 v71 offset:6064
    v_fract_f32 v113, v113
    v_exp_f32 v114, v114
    v_fract_f32 v115, v115
    v_pk_mul_f32 v[64:65], v[12:13], v[24:25] op_sel:[1,1] op_sel_hi:[1,0] neg_lo:[1,0]
    v_pk_mul_f32 v[66:67], v[14:15], v[26:27] op_sel:[1,1] op_sel_hi:[1,0] neg_lo:[1,0]
    v_pk_fma_f32 v[12:13], v[12:13], v[24:25], v[64:65] op_sel:[0,0,0] op_sel_hi:[0,1,1]
    v_pk_fma_f32 v[14:15], v[14:15], v[26:27], v[66:67] op_sel:[0,0,0] op_sel_hi:[0,1,1]
    v_cvt_pk_bf16_f32 v68, v12, v13
    v_cvt_pk_bf16_f32 v69, v14, v15
    ds_write_addtid_b32 v68 offset:6336
    ds_write_addtid_b32 v69 offset:6592
    v_cos_f32 v28, v113
    v_sin_f32 v29, v113
    v_cos_f32 v30, v115
    v_pk_mul_f32 v[64:65], v[12:13], v[24:25] op_sel:[1,1] op_sel_hi:[1,0] neg_lo:[1,0]
    v_pk_mul_f32 v[66:67], v[14:15], v[26:27] op_sel:[1,1] op_sel_hi:[1,0] neg_lo:[1,0]
    v_pk_fma_f32 v[12:13], v[12:13], v[24:25], v[64:65] op_sel:[0,0,0] op_sel_hi:[0,1,1]
    v_pk_fma_f32 v[14:15], v[14:15], v[26:27], v[66:67] op_sel:[0,0,0] op_sel_hi:[0,1,1]
    v_cvt_pk_bf16_f32 v70, v12, v13
    v_cvt_pk_bf16_f32 v71, v14, v15
    ds_write_addtid_b32 v70 offset:6864
    ds_write_addtid_b32 v71 offset:7120
    v_sin_f32 v31, v115
    v_pk_mul_f32 v[28:29], v[28:29], v[112:113] op_sel:[0,0] op_sel_hi:[1,0]
    v_pk_mul_f32 v[30:31], v[30:31], v[114:115] op_sel:[0,0] op_sel_hi:[1,0]
    v_pk_mul_f32 v[64:65], v[12:13], v[24:25] op_sel:[1,1] op_sel_hi:[1,0] neg_lo:[1,0]
    v_pk_mul_f32 v[66:67], v[14:15], v[26:27] op_sel:[1,1] op_sel_hi:[1,0] neg_lo:[1,0]
    v_pk_fma_f32 v[12:13], v[12:13], v[24:25], v[64:65] op_sel:[0,0,0] op_sel_hi:[0,1,1]
    v_pk_fma_f32 v[14:15], v[14:15], v[26:27], v[66:67] op_sel:[0,0,0] op_sel_hi:[0,1,1]
    v_cvt_pk_bf16_f32 v68, v12, v13
    v_cvt_pk_bf16_f32 v69, v14, v15
    ds_write_addtid_b32 v68 offset:7392
    ds_write_addtid_b32 v69 offset:7648
    v_pk_mul_f32 v[64:65], v[12:13], v[24:25] op_sel:[1,1] op_sel_hi:[1,0] neg_lo:[1,0]
    v_pk_mul_f32 v[66:67], v[14:15], v[26:27] op_sel:[1,1] op_sel_hi:[1,0] neg_lo:[1,0]
    v_pk_fma_f32 v[12:13], v[12:13], v[24:25], v[64:65] op_sel:[0,0,0] op_sel_hi:[0,1,1]
    v_pk_fma_f32 v[14:15], v[14:15], v[26:27], v[66:67] op_sel:[0,0,0] op_sel_hi:[0,1,1]
    v_cvt_pk_bf16_f32 v70, v12, v13
    v_cvt_pk_bf16_f32 v71, v14, v15
    ds_write_addtid_b32 v70 offset:7920
    ds_write_addtid_b32 v71 offset:8176
    ds_read_b128 v[80:83], v6 offset:0
    ds_read_b128 v[84:87], v6 offset:32
    ds_read_b128 v[88:91], v6 offset:64
    ds_read_b128 v[92:95], v6 offset:96
    ds_read_b128 v[96:99], v6 offset:128
    ds_read_b128 v[100:103], v6 offset:160
    ds_read_b128 v[104:107], v6 offset:192
    ds_read_b128 v[108:111], v6 offset:224
    v_cvt_pk_bf16_f32 v68, v32, v33
    v_cvt_pk_bf16_f32 v69, v34, v35
    ds_write_addtid_b32 v68 offset:0
    ds_write_addtid_b32 v69 offset:256
    v_pk_mul_f32 v[64:65], v[32:33], v[20:21] op_sel:[1,1] op_sel_hi:[1,0] neg_lo:[1,0]
    v_pk_mul_f32 v[66:67], v[34:35], v[22:23] op_sel:[1,1] op_sel_hi:[1,0] neg_lo:[1,0]
    v_pk_fma_f32 v[36:37], v[32:33], v[20:21], v[64:65] op_sel:[0,0,0] op_sel_hi:[0,1,1]
    v_pk_fma_f32 v[38:39], v[34:35], v[22:23], v[66:67] op_sel:[0,0,0] op_sel_hi:[0,1,1]
    v_cvt_pk_bf16_f32 v70, v36, v37
    v_cvt_pk_bf16_f32 v71, v38, v39
    ds_write_addtid_b32 v70 offset:528
    ds_write_addtid_b32 v71 offset:784
    v_pk_mul_f32 v[64:65], v[36:37], v[20:21] op_sel:[1,1] op_sel_hi:[1,0] neg_lo:[1,0]
    v_pk_mul_f32 v[66:67], v[38:39], v[22:23] op_sel:[1,1] op_sel_hi:[1,0] neg_lo:[1,0]
    v_pk_fma_f32 v[40:41], v[36:37], v[20:21], v[64:65] op_sel:[0,0,0] op_sel_hi:[0,1,1]
    v_pk_fma_f32 v[42:43], v[38:39], v[22:23], v[66:67] op_sel:[0,0,0] op_sel_hi:[0,1,1]
    v_cvt_pk_bf16_f32 v68, v40, v41
    v_cvt_pk_bf16_f32 v69, v42, v43
    ds_write_addtid_b32 v68 offset:1056
    ds_write_addtid_b32 v69 offset:1312
    v_pk_mul_f32 v[64:65], v[40:41], v[20:21] op_sel:[1,1] op_sel_hi:[1,0] neg_lo:[1,0]
    v_pk_mul_f32 v[66:67], v[42:43], v[22:23] op_sel:[1,1] op_sel_hi:[1,0] neg_lo:[1,0]
    v_pk_fma_f32 v[44:45], v[40:41], v[20:21], v[64:65] op_sel:[0,0,0] op_sel_hi:[0,1,1]
    v_pk_fma_f32 v[46:47], v[42:43], v[22:23], v[66:67] op_sel:[0,0,0] op_sel_hi:[0,1,1]
    v_cvt_pk_bf16_f32 v70, v44, v45
    v_cvt_pk_bf16_f32 v71, v46, v47
    ds_write_addtid_b32 v70 offset:1584
    ds_write_addtid_b32 v71 offset:1840
    v_pk_mul_f32 v[64:65], v[44:45], v[20:21] op_sel:[1,1] op_sel_hi:[1,0] neg_lo:[1,0]
    v_pk_mul_f32 v[66:67], v[46:47], v[22:23] op_sel:[1,1] op_sel_hi:[1,0] neg_lo:[1,0]
    s_mov_b32 s43, 131072
    s_add_u32 m0, s61, 1024
    s_nop 0
    buffer_load_dwordx4 v9, s[4:7], s43 offen lds
    s_mov_b32 m0, s60
    v_pk_fma_f32 v[48:49], v[44:45], v[20:21], v[64:65] op_sel:[0,0,0] op_sel_hi:[0,1,1]
    v_pk_fma_f32 v[50:51], v[46:47], v[22:23], v[66:67] op_sel:[0,0,0] op_sel_hi:[0,1,1]
    v_cvt_pk_bf16_f32 v68, v48, v49
    v_cvt_pk_bf16_f32 v69, v50, v51
    ds_write_addtid_b32 v68 offset:2112
    ds_write_addtid_b32 v69 offset:2368
    v_pk_mul_f32 v[64:65], v[48:49], v[20:21] op_sel:[1,1] op_sel_hi:[1,0] neg_lo:[1,0]
    v_pk_mul_f32 v[66:67], v[50:51], v[22:23] op_sel:[1,1] op_sel_hi:[1,0] neg_lo:[1,0]
    v_pk_fma_f32 v[52:53], v[48:49], v[20:21], v[64:65] op_sel:[0,0,0] op_sel_hi:[0,1,1]
    v_pk_fma_f32 v[54:55], v[50:51], v[22:23], v[66:67] op_sel:[0,0,0] op_sel_hi:[0,1,1]
    v_cvt_pk_bf16_f32 v70, v52, v53
    v_cvt_pk_bf16_f32 v71, v54, v55
    ds_write_addtid_b32 v70 offset:2640
    ds_write_addtid_b32 v71 offset:2896
    v_pk_mul_f32 v[64:65], v[52:53], v[20:21] op_sel:[1,1] op_sel_hi:[1,0] neg_lo:[1,0]
    v_pk_mul_f32 v[66:67], v[54:55], v[22:23] op_sel:[1,1] op_sel_hi:[1,0] neg_lo:[1,0]
    v_pk_fma_f32 v[56:57], v[52:53], v[20:21], v[64:65] op_sel:[0,0,0] op_sel_hi:[0,1,1]
    v_pk_fma_f32 v[58:59], v[54:55], v[22:23], v[66:67] op_sel:[0,0,0] op_sel_hi:[0,1,1]
    v_cvt_pk_bf16_f32 v68, v56, v57
    v_cvt_pk_bf16_f32 v69, v58, v59
    ds_write_addtid_b32 v68 offset:3168
    ds_write_addtid_b32 v69 offset:3424
    v_pk_mul_f32 v[64:65], v[56:57], v[20:21] op_sel:[1,1] op_sel_hi:[1,0] neg_lo:[1,0]
    v_pk_mul_f32 v[66:67], v[58:59], v[22:23] op_sel:[1,1] op_sel_hi:[1,0] neg_lo:[1,0]
    v_pk_fma_f32 v[60:61], v[56:57], v[20:21], v[64:65] op_sel:[0,0,0] op_sel_hi:[0,1,1]
    v_pk_fma_f32 v[62:63], v[58:59], v[22:23], v[66:67] op_sel:[0,0,0] op_sel_hi:[0,1,1]
    v_cvt_pk_bf16_f32 v70, v60, v61
    v_cvt_pk_bf16_f32 v71, v62, v63
    ds_write_addtid_b32 v70 offset:3696
    ds_write_addtid_b32 v71 offset:3952
    v_pk_mul_f32 v[64:65], v[32:33], v[28:29] op_sel:[1,1] op_sel_hi:[1,0] neg_lo:[1,0]
    v_pk_mul_f32 v[66:67], v[34:35], v[30:31] op_sel:[1,1] op_sel_hi:[1,0] neg_lo:[1,0]
    v_pk_fma_f32 v[32:33], v[32:33], v[28:29], v[64:65] op_sel:[0,0,0] op_sel_hi:[0,1,1]
    v_pk_fma_f32 v[34:35], v[34:35], v[30:31], v[66:67] op_sel:[0,0,0] op_sel_hi:[0,1,1]
    v_cvt_pk_bf16_f32 v68, v32, v33
    v_cvt_pk_bf16_f32 v69, v34, v35
    ds_write_addtid_b32 v68 offset:4224
    ds_write_addtid_b32 v69 offset:4480
    v_pk_mul_f32 v[64:65], v[36:37], v[28:29] op_sel:[1,1] op_sel_hi:[1,0] neg_lo:[1,0]
    v_pk_mul_f32 v[66:67], v[38:39], v[30:31] op_sel:[1,1] op_sel_hi:[1,0] neg_lo:[1,0]
    v_pk_fma_f32 v[36:37], v[36:37], v[28:29], v[64:65] op_sel:[0,0,0] op_sel_hi:[0,1,1]
    v_pk_fma_f32 v[38:39], v[38:39], v[30:31], v[66:67] op_sel:[0,0,0] op_sel_hi:[0,1,1]
    v_cvt_pk_bf16_f32 v70, v36, v37
    v_cvt_pk_bf16_f32 v71, v38, v39
    ds_write_addtid_b32 v70 offset:4752
    ds_write_addtid_b32 v71 offset:5008
    v_pk_mul_f32 v[64:65], v[40:41], v[28:29] op_sel:[1,1] op_sel_hi:[1,0] neg_lo:[1,0]
    v_pk_mul_f32 v[66:67], v[42:43], v[30:31] op_sel:[1,1] op_sel_hi:[1,0] neg_lo:[1,0]
    v_pk_fma_f32 v[40:41], v[40:41], v[28:29], v[64:65] op_sel:[0,0,0] op_sel_hi:[0,1,1]
    v_pk_fma_f32 v[42:43], v[42:43], v[30:31], v[66:67] op_sel:[0,0,0] op_sel_hi:[0,1,1]
    v_cvt_pk_bf16_f32 v68, v40, v41
    v_cvt_pk_bf16_f32 v69, v42, v43
    ds_write_addtid_b32 v68 offset:5280
    ds_write_addtid_b32 v69 offset:5536
    v_pk_mul_f32 v[64:65], v[44:45], v[28:29] op_sel:[1,1] op_sel_hi:[1,0] neg_lo:[1,0]
    v_pk_mul_f32 v[66:67], v[46:47], v[30:31] op_sel:[1,1] op_sel_hi:[1,0] neg_lo:[1,0]
    v_pk_fma_f32 v[44:45], v[44:45], v[28:29], v[64:65] op_sel:[0,0,0] op_sel_hi:[0,1,1]
    v_pk_fma_f32 v[46:47], v[46:47], v[30:31], v[66:67] op_sel:[0,0,0] op_sel_hi:[0,1,1]
    v_cvt_pk_bf16_f32 v70, v44, v45
    v_cvt_pk_bf16_f32 v71, v46, v47
    ds_write_addtid_b32 v70 offset:5808
    ds_write_addtid_b32 v71 offset:6064
    v_pk_mul_f32 v[64:65], v[48:49], v[28:29] op_sel:[1,1] op_sel_hi:[1,0] neg_lo:[1,0]
    v_pk_mul_f32 v[66:67], v[50:51], v[30:31] op_sel:[1,1] op_sel_hi:[1,0] neg_lo:[1,0]
    v_pk_fma_f32 v[48:49], v[48:49], v[28:29], v[64:65] op_sel:[0,0,0] op_sel_hi:[0,1,1]
    v_pk_fma_f32 v[50:51], v[50:51], v[30:31], v[66:67] op_sel:[0,0,0] op_sel_hi:[0,1,1]
    v_cvt_pk_bf16_f32 v68, v48, v49
    v_cvt_pk_bf16_f32 v69, v50, v51
    ds_write_addtid_b32 v68 offset:6336
    ds_write_addtid_b32 v69 offset:6592
    v_pk_mul_f32 v[64:65], v[52:53], v[28:29] op_sel:[1,1] op_sel_hi:[1,0] neg_lo:[1,0]
    v_pk_mul_f32 v[66:67], v[54:55], v[30:31] op_sel:[1,1] op_sel_hi:[1,0] neg_lo:[1,0]
    v_pk_fma_f32 v[52:53], v[52:53], v[28:29], v[64:65] op_sel:[0,0,0] op_sel_hi:[0,1,1]
    v_pk_fma_f32 v[54:55], v[54:55], v[30:31], v[66:67] op_sel:[0,0,0] op_sel_hi:[0,1,1]
    v_cvt_pk_bf16_f32 v70, v52, v53
    v_cvt_pk_bf16_f32 v71, v54, v55
    ds_write_addtid_b32 v70 offset:6864
    ds_write_addtid_b32 v71 offset:7120
    v_pk_mul_f32 v[64:65], v[56:57], v[28:29] op_sel:[1,1] op_sel_hi:[1,0] neg_lo:[1,0]
    v_pk_mul_f32 v[66:67], v[58:59], v[30:31] op_sel:[1,1] op_sel_hi:[1,0] neg_lo:[1,0]
    s_mov_b32 s43, 262144
    s_add_u32 m0, s61, 2048
    s_nop 0
    buffer_load_dwordx4 v9, s[4:7], s43 offen lds
    s_mov_b32 m0, s60
    v_pk_fma_f32 v[56:57], v[56:57], v[28:29], v[64:65] op_sel:[0,0,0] op_sel_hi:[0,1,1]
    v_pk_fma_f32 v[58:59], v[58:59], v[30:31], v[66:67] op_sel:[0,0,0] op_sel_hi:[0,1,1]
    v_cvt_pk_bf16_f32 v68, v56, v57
    v_cvt_pk_bf16_f32 v69, v58, v59
    ds_write_addtid_b32 v68 offset:7392
    ds_write_addtid_b32 v69 offset:7648
    v_pk_mul_f32 v[64:65], v[60:61], v[28:29] op_sel:[1,1] op_sel_hi:[1,0] neg_lo:[1,0]
    v_pk_mul_f32 v[66:67], v[62:63], v[30:31] op_sel:[1,1] op_sel_hi:[1,0] neg_lo:[1,0]
    v_pk_fma_f32 v[60:61], v[60:61], v[28:29], v[64:65] op_sel:[0,0,0] op_sel_hi:[0,1,1]
    v_pk_fma_f32 v[62:63], v[62:63], v[30:31], v[66:67] op_sel:[0,0,0] op_sel_hi:[0,1,1]
    v_cvt_pk_bf16_f32 v70, v60, v61
    v_cvt_pk_bf16_f32 v71, v62, v63
    ds_write_addtid_b32 v70 offset:7920
    ds_write_addtid_b32 v71 offset:8176
    ds_read_b128 v[176:179], v6 offset:0
    ds_read_b128 v[180:183], v6 offset:32
    ds_read_b128 v[184:187], v6 offset:64
    ds_read_b128 v[188:191], v6 offset:96
    ds_read_b128 v[192:195], v6 offset:128
    ds_read_b128 v[196:199], v6 offset:160
    ds_read_b128 v[200:203], v6 offset:192
    ds_read_b128 v[204:207], v6 offset:224
    v_pk_mul_f32 v[64:65], v[32:33], v[28:29] op_sel:[1,1] op_sel_hi:[1,0] neg_lo:[1,0]
    v_pk_mul_f32 v[66:67], v[34:35], v[30:31] op_sel:[1,1] op_sel_hi:[1,0] neg_lo:[1,0]
    v_pk_fma_f32 v[32:33], v[32:33], v[28:29], v[64:65] op_sel:[0,0,0] op_sel_hi:[0,1,1]
    v_pk_fma_f32 v[34:35], v[34:35], v[30:31], v[66:67] op_sel:[0,0,0] op_sel_hi:[0,1,1]
    v_cvt_pk_bf16_f32 v68, v32, v33
    v_cvt_pk_bf16_f32 v69, v34, v35
    ds_write_addtid_b32 v68 offset:0
    ds_write_addtid_b32 v69 offset:256
    v_pk_mul_f32 v[64:65], v[40:41], v[28:29] op_sel:[1,1] op_sel_hi:[1,0] neg_lo:[1,0]
    v_pk_mul_f32 v[66:67], v[42:43], v[30:31] op_sel:[1,1] op_sel_hi:[1,0] neg_lo:[1,0]
    v_pk_fma_f32 v[40:41], v[40:41], v[28:29], v[64:65] op_sel:[0,0,0] op_sel_hi:[0,1,1]
    v_pk_fma_f32 v[42:43], v[42:43], v[30:31], v[66:67] op_sel:[0,0,0] op_sel_hi:[0,1,1]
    v_cvt_pk_bf16_f32 v70, v40, v41
    v_cvt_pk_bf16_f32 v71, v42, v43
    ds_write_addtid_b32 v70 offset:528
    ds_write_addtid_b32 v71 offset:784
    v_pk_mul_f32 v[64:65], v[48:49], v[28:29] op_sel:[1,1] op_sel_hi:[1,0] neg_lo:[1,0]
    v_pk_mul_f32 v[66:67], v[50:51], v[30:31] op_sel:[1,1] op_sel_hi:[1,0] neg_lo:[1,0]
    v_pk_fma_f32 v[48:49], v[48:49], v[28:29], v[64:65] op_sel:[0,0,0] op_sel_hi:[0,1,1]
    v_pk_fma_f32 v[50:51], v[50:51], v[30:31], v[66:67] op_sel:[0,0,0] op_sel_hi:[0,1,1]
    v_cvt_pk_bf16_f32 v68, v48, v49
    v_cvt_pk_bf16_f32 v69, v50, v51
    ds_write_addtid_b32 v68 offset:1056
    ds_write_addtid_b32 v69 offset:1312
    v_pk_mul_f32 v[64:65], v[56:57], v[28:29] op_sel:[1,1] op_sel_hi:[1,0] neg_lo:[1,0]
    v_pk_mul_f32 v[66:67], v[58:59], v[30:31] op_sel:[1,1] op_sel_hi:[1,0] neg_lo:[1,0]
    v_pk_fma_f32 v[56:57], v[56:57], v[28:29], v[64:65] op_sel:[0,0,0] op_sel_hi:[0,1,1]
    v_pk_fma_f32 v[58:59], v[58:59], v[30:31], v[66:67] op_sel:[0,0,0] op_sel_hi:[0,1,1]
    v_cvt_pk_bf16_f32 v70, v56, v57
    v_cvt_pk_bf16_f32 v71, v58, v59
    ds_write_addtid_b32 v70 offset:1584
    ds_write_addtid_b32 v71 offset:1840
    s_waitcnt lgkmcnt(15)
    v_mfma_f32_16x16x32_bf16 v[208:211], v[176:179], v[80:83], 0
    v_pk_mul_f32 v[64:65], v[32:33], v[28:29] op_sel:[1,1] op_sel_hi:[1,0] neg_lo:[1,0]
    v_pk_mul_f32 v[66:67], v[34:35], v[30:31] op_sel:[1,1] op_sel_hi:[1,0] neg_lo:[1,0]
    v_pk_fma_f32 v[32:33], v[32:33], v[28:29], v[64:65] op_sel:[0,0,0] op_sel_hi:[0,1,1]
    v_pk_fma_f32 v[34:35], v[34:35], v[30:31], v[66:67] op_sel:[0,0,0] op_sel_hi:[0,1,1]
    v_cvt_pk_bf16_f32 v68, v32, v33
    v_cvt_pk_bf16_f32 v69, v34, v35
    ds_write_addtid_b32 v68 offset:2112
    ds_write_addtid_b32 v69 offset:2368
    s_waitcnt lgkmcnt(15)
    v_mfma_f32_16x16x32_bf16 v[208:211], v[180:183], v[84:87], v[208:211]
    v_pk_mul_f32 v[64:65], v[40:41], v[28:29] op_sel:[1,1] op_sel_hi:[1,0] neg_lo:[1,0]
    v_pk_mul_f32 v[66:67], v[42:43], v[30:31] op_sel:[1,1] op_sel_hi:[1,0] neg_lo:[1,0]
    v_pk_fma_f32 v[40:41], v[40:41], v[28:29], v[64:65] op_sel:[0,0,0] op_sel_hi:[0,1,1]
    v_pk_fma_f32 v[42:43], v[42:43], v[30:31], v[66:67] op_sel:[0,0,0] op_sel_hi:[0,1,1]
    v_cvt_pk_bf16_f32 v70, v40, v41
    v_cvt_pk_bf16_f32 v71, v42, v43
    ds_write_addtid_b32 v70 offset:2640
    ds_write_addtid_b32 v71 offset:2896
    v_mfma_f32_16x16x32_bf16 v[208:211], v[184:187], v[88:91], v[208:211]
    v_pk_mul_f32 v[64:65], v[48:49], v[28:29] op_sel:[1,1] op_sel_hi:[1,0] neg_lo:[1,0]
    v_pk_mul_f32 v[66:67], v[50:51], v[30:31] op_sel:[1,1] op_sel_hi:[1,0] neg_lo:[1,0]
    v_pk_fma_f32 v[48:49], v[48:49], v[28:29], v[64:65] op_sel:[0,0,0] op_sel_hi:[0,1,1]
    v_pk_fma_f32 v[50:51], v[50:51], v[30:31], v[66:67] op_sel:[0,0,0] op_sel_hi:[0,1,1]
    v_cvt_pk_bf16_f32 v68, v48, v49
    s_mov_b32 s43, 393216
    s_add_u32 m0, s61, 3072
    s_nop 0
    buffer_load_dwordx4 v9, s[4:7], s43 offen lds
    s_mov_b32 m0, s60
    v_cvt_pk_bf16_f32 v69, v50, v51
    ds_write_addtid_b32 v68 offset:3168
    ds_write_addtid_b32 v69 offset:3424
    s_waitcnt lgkmcnt(15)
    v_mfma_f32_16x16x32_bf16 v[208:211], v[188:191], v[92:95], v[208:211]
    v_pk_mul_f32 v[64:65], v[56:57], v[28:29] op_sel:[1,1] op_sel_hi:[1,0] neg_lo:[1,0]
    v_pk_mul_f32 v[66:67], v[58:59], v[30:31] op_sel:[1,1] op_sel_hi:[1,0] neg_lo:[1,0]
    v_pk_fma_f32 v[56:57], v[56:57], v[28:29], v[64:65] op_sel:[0,0,0] op_sel_hi:[0,1,1]
    v_pk_fma_f32 v[58:59], v[58:59], v[30:31], v[66:67] op_sel:[0,0,0] op_sel_hi:[0,1,1]
    v_cvt_pk_bf16_f32 v70, v56, v57
    v_cvt_pk_bf16_f32 v71, v58, v59
    ds_write_addtid_b32 v70 offset:3696
    ds_write_addtid_b32 v71 offset:3952
    v_mfma_f32_16x16x32_bf16 v[208:211], v[192:195], v[96:99], v[208:211]
    v_pk_mul_f32 v[64:65], v[32:33], v[28:29] op_sel:[1,1] op_sel_hi:[1,0] neg_lo:[1,0]
    v_pk_mul_f32 v[66:67], v[34:35], v[30:31] op_sel:[1,1] op_sel_hi:[1,0] neg_lo:[1,0]
    v_pk_fma_f32 v[32:33], v[32:33], v[28:29], v[64:65] op_sel:[0,0,0] op_sel_hi:[0,1,1]
    v_pk_fma_f32 v[34:35], v[34:35], v[30:31], v[66:67] op_sel:[0,0,0] op_sel_hi:[0,1,1]
    v_cvt_pk_bf16_f32 v68, v32, v33
    v_cvt_pk_bf16_f32 v69, v34, v35
    ds_write_addtid_b32 v68 offset:4224
    ds_write_addtid_b32 v69 offset:4480
    v_mfma_f32_16x16x32_bf16 v[208:211], v[196:199], v[100:103], v[208:211]
    v_pk_mul_f32 v[64:65], v[48:49], v[28:29] op_sel:[1,1] op_sel_hi:[1,0] neg_lo:[1,0]
    v_pk_mul_f32 v[66:67], v[50:51], v[30:31] op_sel:[1,1] op_sel_hi:[1,0] neg_lo:[1,0]
    v_pk_fma_f32 v[48:49], v[48:49], v[28:29], v[64:65] op_sel:[0,0,0] op_sel_hi:[0,1,1]
    v_pk_fma_f32 v[50:51], v[50:51], v[30:31], v[66:67] op_sel:[0,0,0] op_sel_hi:[0,1,1]
    v_cvt_pk_bf16_f32 v70, v48, v49
    v_cvt_pk_bf16_f32 v71, v50, v51
    ds_write_addtid_b32 v70 offset:4752
    ds_write_addtid_b32 v71 offset:5008
    v_mfma_f32_16x16x32_bf16 v[208:211], v[200:203], v[104:107], v[208:211]
    v_pk_mul_f32 v[64:65], v[32:33], v[28:29] op_sel:[1,1] op_sel_hi:[1,0] neg_lo:[1,0]
    v_pk_mul_f32 v[66:67], v[34:35], v[30:31] op_sel:[1,1] op_sel_hi:[1,0] neg_lo:[1,0]
    v_pk_fma_f32 v[32:33], v[32:33], v[28:29], v[64:65] op_sel:[0,0,0] op_sel_hi:[0,1,1]
    v_pk_fma_f32 v[34:35], v[34:35], v[30:31], v[66:67] op_sel:[0,0,0] op_sel_hi:[0,1,1]
    v_cvt_pk_bf16_f32 v68, v32, v33
    v_cvt_pk_bf16_f32 v69, v34, v35
    ds_write_addtid_b32 v68 offset:5280
    ds_write_addtid_b32 v69 offset:5536
    s_waitcnt lgkmcnt(15)
    v_mfma_f32_16x16x32_bf16 v[208:211], v[204:207], v[108:111], v[208:211]
    v_pk_mul_f32 v[64:65], v[48:49], v[28:29] op_sel:[1,1] op_sel_hi:[1,0] neg_lo:[1,0]
    v_pk_mul_f32 v[66:67], v[50:51], v[30:31] op_sel:[1,1] op_sel_hi:[1,0] neg_lo:[1,0]
    v_pk_fma_f32 v[48:49], v[48:49], v[28:29], v[64:65] op_sel:[0,0,0] op_sel_hi:[0,1,1]
    v_pk_fma_f32 v[50:51], v[50:51], v[30:31], v[66:67] op_sel:[0,0,0] op_sel_hi:[0,1,1]
    v_cvt_pk_bf16_f32 v70, v48, v49
    v_cvt_pk_bf16_f32 v71, v50, v51
    ds_write_addtid_b32 v70 offset:5808
    ds_write_addtid_b32 v71 offset:6064
    v_pk_mul_f32 v[64:65], v[32:33], v[28:29] op_sel:[1,1] op_sel_hi:[1,0] neg_lo:[1,0]
    v_pk_mul_f32 v[66:67], v[34:35], v[30:31] op_sel:[1,1] op_sel_hi:[1,0] neg_lo:[1,0]
    v_pk_fma_f32 v[32:33], v[32:33], v[28:29], v[64:65] op_sel:[0,0,0] op_sel_hi:[0,1,1]
    v_pk_fma_f32 v[34:35], v[34:35], v[30:31], v[66:67] op_sel:[0,0,0] op_sel_hi:[0,1,1]
    v_cvt_pk_bf16_f32 v68, v32, v33
    v_cvt_pk_bf16_f32 v69, v34, v35
    ds_write_addtid_b32 v68 offset:6336
    ds_write_addtid_b32 v69 offset:6592
    v_pk_mul_f32 v[64:65], v[48:49], v[28:29] op_sel:[1,1] op_sel_hi:[1,0] neg_lo:[1,0]
    v_pk_mul_f32 v[66:67], v[50:51], v[30:31] op_sel:[1,1] op_sel_hi:[1,0] neg_lo:[1,0]
    v_pk_fma_f32 v[48:49], v[48:49], v[28:29], v[64:65] op_sel:[0,0,0] op_sel_hi:[0,1,1]
    v_pk_fma_f32 v[50:51], v[50:51], v[30:31], v[66:67] op_sel:[0,0,0] op_sel_hi:[0,1,1]
    v_cvt_pk_bf16_f32 v70, v48, v49
    v_cvt_pk_bf16_f32 v71, v50, v51
    ds_write_addtid_b32 v70 offset:6864
    ds_write_addtid_b32 v71 offset:7120
    v_pk_mul_f32 v[64:65], v[32:33], v[28:29] op_sel:[1,1] op_sel_hi:[1,0] neg_lo:[1,0]
    v_pk_mul_f32 v[66:67], v[34:35], v[30:31] op_sel:[1,1] op_sel_hi:[1,0] neg_lo:[1,0]
    v_pk_fma_f32 v[32:33], v[32:33], v[28:29], v[64:65] op_sel:[0,0,0] op_sel_hi:[0,1,1]
    v_pk_fma_f32 v[34:35], v[34:35], v[30:31], v[66:67] op_sel:[0,0,0] op_sel_hi:[0,1,1]
    v_cvt_pk_bf16_f32 v68, v32, v33
    v_cvt_pk_bf16_f32 v69, v34, v35
    ds_write_addtid_b32 v68 offset:7392
    ds_write_addtid_b32 v69 offset:7648
    v_pk_mul_f32 v[64:65], v[48:49], v[28:29] op_sel:[1,1] op_sel_hi:[1,0] neg_lo:[1,0]
    v_pk_mul_f32 v[66:67], v[50:51], v[30:31] op_sel:[1,1] op_sel_hi:[1,0] neg_lo:[1,0]
    v_pk_fma_f32 v[48:49], v[48:49], v[28:29], v[64:65] op_sel:[0,0,0] op_sel_hi:[0,1,1]
    v_pk_fma_f32 v[50:51], v[50:51], v[30:31], v[66:67] op_sel:[0,0,0] op_sel_hi:[0,1,1]
    v_cvt_pk_bf16_f32 v70, v48, v49
    v_cvt_pk_bf16_f32 v71, v50, v51
    ds_write_addtid_b32 v70 offset:7920
    ds_write_addtid_b32 v71 offset:8176
    ds_read_b128 v[176:179], v6 offset:0
    ds_read_b128 v[180:183], v6 offset:32
    ds_read_b128 v[184:187], v6 offset:64
    ds_read_b128 v[188:191], v6 offset:96
    ds_read_b128 v[192:195], v6 offset:128
    ds_read_b128 v[196:199], v6 offset:160
    ds_read_b128 v[200:203], v6 offset:192
    ds_read_b128 v[204:207], v6 offset:224
    v_pk_mul_f32 v[64:65], v[32:33], v[28:29] op_sel:[1,1] op_sel_hi:[1,0] neg_lo:[1,0]
    v_pk_mul_f32 v[66:67], v[34:35], v[30:31] op_sel:[1,1] op_sel_hi:[1,0] neg_lo:[1,0]
    v_pk_fma_f32 v[32:33], v[32:33], v[28:29], v[64:65] op_sel:[0,0,0] op_sel_hi:[0,1,1]
    v_pk_fma_f32 v[34:35], v[34:35], v[30:31], v[66:67] op_sel:[0,0,0] op_sel_hi:[0,1,1]
    v_cvt_pk_bf16_f32 v68, v32, v33
    v_cvt_pk_bf16_f32 v69, v34, v35
    ds_write_addtid_b32 v68 offset:0
    ds_write_addtid_b32 v69 offset:256
    v_pk_mul_f32 v[64:65], v[32:33], v[28:29] op_sel:[1,1] op_sel_hi:[1,0] neg_lo:[1,0]
    v_pk_mul_f32 v[66:67], v[34:35], v[30:31] op_sel:[1,1] op_sel_hi:[1,0] neg_lo:[1,0]
    v_pk_fma_f32 v[32:33], v[32:33], v[28:29], v[64:65] op_sel:[0,0,0] op_sel_hi:[0,1,1]
    v_pk_fma_f32 v[34:35], v[34:35], v[30:31], v[66:67] op_sel:[0,0,0] op_sel_hi:[0,1,1]
    v_cvt_pk_bf16_f32 v70, v32, v33
    v_cvt_pk_bf16_f32 v71, v34, v35
    ds_write_addtid_b32 v70 offset:528
    ds_write_addtid_b32 v71 offset:784
    v_pk_mul_f32 v[64:65], v[32:33], v[28:29] op_sel:[1,1] op_sel_hi:[1,0] neg_lo:[1,0]
    v_pk_mul_f32 v[66:67], v[34:35], v[30:31] op_sel:[1,1] op_sel_hi:[1,0] neg_lo:[1,0]
    v_pk_fma_f32 v[32:33], v[32:33], v[28:29], v[64:65] op_sel:[0,0,0] op_sel_hi:[0,1,1]
    v_pk_fma_f32 v[34:35], v[34:35], v[30:31], v[66:67] op_sel:[0,0,0] op_sel_hi:[0,1,1]
    v_cvt_pk_bf16_f32 v68, v32, v33
    v_cvt_pk_bf16_f32 v69, v34, v35
    ds_write_addtid_b32 v68 offset:1056
    ds_write_addtid_b32 v69 offset:1312
    s_waitcnt lgkmcnt(13)
    v_mfma_f32_16x16x32_bf16 v[212:215], v[176:179], v[80:83], 0
    v_pk_mul_f32 v[64:65], v[32:33], v[28:29] op_sel:[1,1] op_sel_hi:[1,0] neg_lo:[1,0]
    v_pk_mul_f32 v[66:67], v[34:35], v[30:31] op_sel:[1,1] op_sel_hi:[1,0] neg_lo:[1,0]
    v_pk_fma_f32 v[32:33], v[32:33], v[28:29], v[64:65] op_sel:[0,0,0] op_sel_hi:[0,1,1]
    v_pk_fma_f32 v[34:35], v[34:35], v[30:31], v[66:67] op_sel:[0,0,0] op_sel_hi:[0,1,1]
    v_cvt_pk_bf16_f32 v70, v32, v33
    v_cvt_pk_bf16_f32 v71, v34, v35
    ds_write_addtid_b32 v70 offset:1584
    ds_write_addtid_b32 v71 offset:1840
    s_waitcnt lgkmcnt(14)
    v_mfma_f32_16x16x32_bf16 v[212:215], v[180:183], v[84:87], v[212:215]
    v_pk_mul_f32 v[64:65], v[32:33], v[28:29] op_sel:[1,1] op_sel_hi:[1,0] neg_lo:[1,0]
    v_pk_mul_f32 v[66:67], v[34:35], v[30:31] op_sel:[1,1] op_sel_hi:[1,0] neg_lo:[1,0]
    v_pk_fma_f32 v[32:33], v[32:33], v[28:29], v[64:65] op_sel:[0,0,0] op_sel_hi:[0,1,1]
    v_pk_fma_f32 v[34:35], v[34:35], v[30:31], v[66:67] op_sel:[0,0,0] op_sel_hi:[0,1,1]
    v_cvt_pk_bf16_f32 v68, v32, v33
    v_cvt_pk_bf16_f32 v69, v34, v35
    ds_write_addtid_b32 v68 offset:2112
    ds_write_addtid_b32 v69 offset:2368
    s_waitcnt lgkmcnt(15)
    v_mfma_f32_16x16x32_bf16 v[212:215], v[184:187], v[88:91], v[212:215]
    v_pk_mul_f32 v[64:65], v[32:33], v[28:29] op_sel:[1,1] op_sel_hi:[1,0] neg_lo:[1,0]
    v_pk_mul_f32 v[66:67], v[34:35], v[30:31] op_sel:[1,1] op_sel_hi:[1,0] neg_lo:[1,0]
    v_pk_fma_f32 v[32:33], v[32:33], v[28:29], v[64:65] op_sel:[0,0,0] op_sel_hi:[0,1,1]
    v_pk_fma_f32 v[34:35], v[34:35], v[30:31], v[66:67] op_sel:[0,0,0] op_sel_hi:[0,1,1]
    v_cvt_pk_bf16_f32 v70, v32, v33
    v_cvt_pk_bf16_f32 v71, v34, v35
    ds_write_addtid_b32 v70 offset:2640
    ds_write_addtid_b32 v71 offset:2896
    s_waitcnt lgkmcnt(15)
    v_mfma_f32_16x16x32_bf16 v[212:215], v[188:191], v[92:95], v[212:215]
    v_pk_mul_f32 v[64:65], v[32:33], v[28:29] op_sel:[1,1] op_sel_hi:[1,0] neg_lo:[1,0]
    v_pk_mul_f32 v[66:67], v[34:35], v[30:31] op_sel:[1,1] op_sel_hi:[1,0] neg_lo:[1,0]
    v_pk_fma_f32 v[32:33], v[32:33], v[28:29], v[64:65] op_sel:[0,0,0] op_sel_hi:[0,1,1]
    v_pk_fma_f32 v[34:35], v[34:35], v[30:31], v[66:67] op_sel:[0,0,0] op_sel_hi:[0,1,1]
    v_cvt_pk_bf16_f32 v68, v32, v33
    v_cvt_pk_bf16_f32 v69, v34, v35
    ds_write_addtid_b32 v68 offset:3168
    ds_write_addtid_b32 v69 offset:3424
    v_mfma_f32_16x16x32_bf16 v[212:215], v[192:195], v[96:99], v[212:215]
    v_pk_mul_f32 v[64:65], v[32:33], v[28:29] op_sel:[1,1] op_sel_hi:[1,0] neg_lo:[1,0]
    v_pk_mul_f32 v[66:67], v[34:35], v[30:31] op_sel:[1,1] op_sel_hi:[1,0] neg_lo:[1,0]
    v_pk_fma_f32 v[32:33], v[32:33], v[28:29], v[64:65] op_sel:[0,0,0] op_sel_hi:[0,1,1]
    v_pk_fma_f32 v[34:35], v[34:35], v[30:31], v[66:67] op_sel:[0,0,0] op_sel_hi:[0,1,1]
    v_cvt_pk_bf16_f32 v70, v32, v33
    v_cvt_pk_bf16_f32 v71, v34, v35
    ds_write_addtid_b32 v70 offset:3696
    ds_write_addtid_b32 v71 offset:3952
    s_waitcnt lgkmcnt(15)
    v_mfma_f32_16x16x32_bf16 v[212:215], v[196:199], v[100:103], v[212:215]
    v_pk_mul_f32 v[64:65], v[32:33], v[28:29] op_sel:[1,1] op_sel_hi:[1,0] neg_lo:[1,0]
    v_pk_mul_f32 v[66:67], v[34:35], v[30:31] op_sel:[1,1] op_sel_hi:[1,0] neg_lo:[1,0]
    v_pk_fma_f32 v[32:33], v[32:33], v[28:29], v[64:65] op_sel:[0,0,0] op_sel_hi:[0,1,1]
    v_pk_fma_f32 v[34:35], v[34:35], v[30:31], v[66:67] op_sel:[0,0,0] op_sel_hi:[0,1,1]
    v_cvt_pk_bf16_f32 v68, v32, v33
    v_cvt_pk_bf16_f32 v69, v34, v35
    ds_write_addtid_b32 v68 offset:4224
    ds_write_addtid_b32 v69 offset:4480
    v_mfma_f32_16x16x32_bf16 v[212:215], v[200:203], v[104:107], v[212:215]
    v_mfma_f32_16x16x32_bf16 v[212:215], v[204:207], v[108:111], v[212:215]
    ds_read_b128 v[176:179], v6 offset:0
    ds_read_b128 v[180:183], v6 offset:32
    ds_read_b128 v[184:187], v6 offset:64
    ds_read_b128 v[188:191], v6 offset:96
    ds_read_b128 v[192:195], v6 offset:128
    ds_read_b128 v[196:199], v6 offset:160
    ds_read_b128 v[200:203], v6 offset:192
    ds_read_b128 v[204:207], v6 offset:224
    v_add_f32 v208, v208, v169
    v_cndmask_b32 v72, v213, v212, s[58:59]
    v_cndmask_b32 v73, v214, v213, s[58:59]
    v_cndmask_b32 v74, v215, 0, s[58:59]
    v_cvt_pk_bf16_f32 v76, v212, v213
    v_cvt_pk_bf16_f32 v77, v214, v215
    s_waitcnt lgkmcnt(7)
    v_mfma_f32_16x16x32_bf16 v[216:219], v[176:179], v[80:83], 0
    s_waitcnt lgkmcnt(6)
    v_mfma_f32_16x16x32_bf16 v[216:219], v[180:183], v[84:87], v[216:219]
    v_cvt_pk_bf16_f32 v64, v212, v212
    v_cvt_pk_bf16_f32 v65, v212, v212
    v_cvt_pk_bf16_f32 v66, v72, v212
    v_cvt_pk_bf16_f32 v67, v73, v72
    s_waitcnt lgkmcnt(5)
    v_mfma_f32_16x16x32_bf16 v[216:219], v[184:187], v[88:91], v[216:219]
    s_waitcnt lgkmcnt(4)
    v_mfma_f32_16x16x32_bf16 v[216:219], v[188:191], v[92:95], v[216:219]
    v_cvt_pk_bf16_f32 v68, v73, v73
    v_cvt_pk_bf16_f32 v69, v73, v73
    v_cvt_pk_bf16_f32 v70, v74, v73
    v_cvt_pk_bf16_f32 v71, v74, v74
    s_waitcnt lgkmcnt(3)
    v_mfma_f32_16x16x32_bf16 v[216:219], v[192:195], v[96:99], v[216:219]
    s_waitcnt lgkmcnt(2)
    v_mfma_f32_16x16x32_bf16 v[216:219], v[196:199], v[100:103], v[216:219]
    v_cndmask_b32 v76, v76, 0, s[58:59]
    s_mov_b32 exec_hi, 1
    ds_write_b128 v160, v[64:67] offset:4
    ds_write_b128 v160, v[68:71] offset:20
    ds_write_b16 v160, v64
    s_mov_b32 exec_hi, -1
    s_waitcnt lgkmcnt(4)
    v_mfma_f32_16x16x32_bf16 v[216:219], v[200:203], v[104:107], v[216:219]
    s_waitcnt lgkmcnt(3)
    v_mfma_f32_16x16x32_bf16 v[216:219], v[204:207], v[108:111], v[216:219]
    v_cvt_pk_bf16_f32 v72, v208, v211
    v_cvt_pk_bf16_f32 v73, v209, v208
    v_cvt_pk_bf16_f32 v74, v210, v209
    v_cvt_pk_bf16_f32 v75, v211, v210
    ds_write_b16 v161, v72
    ds_write2_b32 v161, v73, v74 offset0:1 offset1:2
    ds_write_b32 v161, v75 offset:12
    ds_write_b16_d16_hi v161, v72 offset:18
    s_mov_b32 exec_lo, 0
    ds_write2_b32 v162, v76, v77 offset0:0 offset1:8
    s_mov_b32 exec_lo, -1
    v_cvt_pk_bf16_f32 v100, v216, v217
    v_cvt_pk_bf16_f32 v101, v218, v219
    v_cvt_pk_bf16_f32 v102, v216, v216
    s_mov_b32 exec_hi, 1
    ds_write_b16 v164, v100
    s_mov_b32 exec_hi, 0
    ds_write_b16_d16_hi v163, v100 offset:32
    ds_write_b16 v163, v101 offset:64
    ds_write_b16_d16_hi v163, v101 offset:96
    s_mov_b32 exec_hi, -1
    v_readlane_b32 s42, v102, 0
    s_nop 1
    v_and_b32 v124, s42, v124
    v_and_b32 v125, s42, v125
    v_and_b32 v126, s42, v126
    v_and_b32 v127, s42, v127
    v_lshlrev_b32 v6, 3, v0
    v_add_u32 v6, 92672, v6
    v_and_b32 v12, 1, v0
    v_lshlrev_b32 v12, 13, v12
    v_lshrrev_b32 v13, 1, v0
    v_lshl_add_u32 v12, v13, 4, v12
    v_add_u32 v9, 4096, v12
    v_bfe_u32 v13, v0, 2, 2
    v_lshlrev_b32 v13, 4, v13
    v_lshl_add_u32 v12, v0, 6, v13
    v_add_u32 v12, 129024, v12
    s_waitcnt vmcnt(0)
    buffer_load_dwordx4 v[144:147], v9, s[36:39], 0 offen sc1
    buffer_load_dwordx4 v[148:151], v9, s[36:39], s53 offen sc1
    ds_read_b128 v[224:227], v12
    v_xor_b32 v13, 16, v12
    ds_read_b128 v[228:231], v13
    v_xor_b32 v13, 32, v12
    ds_read_b128 v[232:235], v13
    v_xor_b32 v13, 48, v12
    ds_read_b128 v[236:239], v13
    v_bfe_u32 v10, v0, 2, 2
    v_mul_u32_u24 v10, 8512, v10
    v_lshrrev_b32 v11, 4, v0
    v_lshl_add_u32 v10, v11, 5, v10
    v_and_b32 v11, 3, v0
    v_lshl_add_u32 v4, v11, 3, v10
    v_lshlrev_b32 v11, 11, v0
    v_add_u32 v5, s49, v11
    s_mov_b32 s54, 0x100000
    s_mov_b32 s55, 0x200000
    v_and_b32 v10, 7, v1
    v_lshlrev_b32 v10, 4, v10
    s_lshl_b32 s43, s56, 7
    s_add_u32 s43, s43, 24576
    v_add_u32 v254, s43, v10
    v_xor_b32 v10, v0, v3
    v_lshlrev_b32 v10, 4, v10
    v_add_u32 v255, 129024, v10
    v_mov_b32 v12, v165
    v_mov_b32 v13, v166
    v_mov_b32 v14, v167
    v_mov_b32 v15, v168
    s_waitcnt lgkmcnt(0)
    v_lshlrev_b32 v176, 16, v224
    v_and_b32 v180, 0xffff0000, v224
    v_lshlrev_b32 v184, 16, v225
    v_and_b32 v188, 0xffff0000, v225
    ds_read2_b32 v[96:97], v15 offset0:67 offset1:66
    v_lshlrev_b32 v192, 16, v226
    v_and_b32 v196, 0xffff0000, v226
    v_lshlrev_b32 v200, 16, v227
    v_and_b32 v204, 0xffff0000, v227
    ds_read2_b32 v[98:99], v15 offset0:65 offset1:64
    v_lshlrev_b32 v177, 16, v228
    v_and_b32 v181, 0xffff0000, v228
    v_lshlrev_b32 v185, 16, v229
    v_and_b32 v189, 0xffff0000, v229
    ds_read2_b32 v[100:101], v15 offset0:83 offset1:82
    v_lshlrev_b32 v193, 16, v230
    v_and_b32 v197, 0xffff0000, v230
    v_lshlrev_b32 v201, 16, v231
    v_and_b32 v205, 0xffff0000, v231
    ds_read2_b32 v[102:103], v15 offset0:81 offset1:80
    v_lshlrev_b32 v178, 16, v232
    v_and_b32 v182, 0xffff0000, v232
    v_lshlrev_b32 v186, 16, v233
    v_and_b32 v190, 0xffff0000, v233
    ds_read2_b32 v[104:105], v15 offset0:99 offset1:98
    v_lshlrev_b32 v194, 16, v234
    v_and_b32 v198, 0xffff0000, v234
    v_lshlrev_b32 v202, 16, v235
    v_and_b32 v206, 0xffff0000, v235
    ds_read2_b32 v[106:107], v15 offset0:97 offset1:96
    v_lshlrev_b32 v179, 16, v236
    v_and_b32 v183, 0xffff0000, v236
    v_lshlrev_b32 v187, 16, v237
    v_and_b32 v191, 0xffff0000, v237
    ds_read2_b32 v[84:85], v15 offset0:3 offset1:2
    v_lshlrev_b32 v195, 16, v238
    v_and_b32 v199, 0xffff0000, v238
    v_lshlrev_b32 v203, 16, v239
    v_and_b32 v207, 0xffff0000, v239
    ds_read2_b32 v[86:87], v15 offset0:1 offset1:0
    s_mov_b32 s43, 0
L_poll_conv:
    s_waitcnt vmcnt(0)
    v_cmp_ne_u32 s[8:9], s52, v147
    v_cmp_ne_u32 s[10:11], s52, v151
    s_or_b64 vcc, s[8:9], s[10:11]
    s_cbranch_scc0 L_polled_conv
    s_add_u32 s43, s43, 1
    s_cmp_ge_u32 s43, 65536
    s_cbranch_scc1 L_polled_conv
    s_sleep 2
    s_mov_b64 exec, s[8:9]
    s_cbranch_execz L_ps_conv_0
    buffer_load_dwordx4 v[144:147], v9, s[36:39], 0 offen sc1
L_ps_conv_0:
    s_mov_b64 exec, s[10:11]
    s_cbranch_execz L_ps_conv_1
    buffer_load_dwordx4 v[148:151], v9, s[36:39], s53 offen sc1
L_ps_conv_1:
    s_mov_b64 exec, -1
    s_branch L_poll_conv
L_polled_conv:
    v_and_b32 v160, 0xffff0000, v144
    v_and_b32 v161, 0xffff0000, v145
    v_and_b32 v162, 0xffff0000, v148
    v_and_b32 v163, 0xffff0000, v149
    v_rcp_f32 v160, v160
    ds_read2_b32 v[88:89], v15 offset0:19 offset1:18
    v_rcp_f32 v161, v161
    ds_read2_b32 v[90:91], v15 offset0:17 offset1:16
    v_rcp_f32 v162, v162
    ds_read2_b32 v[92:93], v15 offset0:35 offset1:34
    v_rcp_f32 v163, v163
    ds_read2_b32 v[94:95], v15 offset0:33 offset1:32
    v_lshlrev_b32 v164, 16, v144
    v_lshlrev_b32 v165, 16, v145
    v_lshlrev_b32 v166, 16, v148
    v_lshlrev_b32 v167, 16, v149
    v_pk_mul_f32 v[164:165], v[164:165], v[160:161] neg_lo:[1,0] neg_hi:[1,0]
    v_pk_mul_f32 v[166:167], v[166:167], v[162:163] neg_lo:[1,0] neg_hi:[1,0]
    v_pk_fma_f32 v[176:177], v[176:177], v[160:161], v[164:165]
    v_pk_fma_f32 v[178:179], v[178:179], v[162:163], v[166:167]
    v_cvt_pk_bf16_f32 v208, v176, v177
    v_cvt_pk_bf16_f32 v209, v178, v179
    ds_write_b64 v6, v[208:209] offset:0
    v_pk_fma_f32 v[180:181], v[180:181], v[160:161], v[164:165]
    v_pk_fma_f32 v[182:183], v[182:183], v[162:163], v[166:167]
    v_cvt_pk_bf16_f32 v210, v180, v181
    v_cvt_pk_bf16_f32 v211, v182, v183
    ds_write_b64 v6, v[210:211] offset:4608
    v_pk_fma_f32 v[184:185], v[184:185], v[160:161], v[164:165]
    v_pk_fma_f32 v[186:187], v[186:187], v[162:163], v[166:167]
    v_cvt_pk_bf16_f32 v212, v184, v185
    v_cvt_pk_bf16_f32 v213, v186, v187
    ds_write_b64 v6, v[212:213] offset:9216
    v_pk_fma_f32 v[188:189], v[188:189], v[160:161], v[164:165]
    v_pk_fma_f32 v[190:191], v[190:191], v[162:163], v[166:167]
    v_cvt_pk_bf16_f32 v214, v188, v189
    v_cvt_pk_bf16_f32 v215, v190, v191
    ds_write_b64 v6, v[214:215] offset:13824
    v_pk_fma_f32 v[192:193], v[192:193], v[160:161], v[164:165]
    v_pk_fma_f32 v[194:195], v[194:195], v[162:163], v[166:167]
    v_cvt_pk_bf16_f32 v216, v192, v193
    v_cvt_pk_bf16_f32 v217, v194, v195
    ds_write_b64 v6, v[216:217] offset:18432
    v_pk_fma_f32 v[196:197], v[196:197], v[160:161], v[164:165]
    v_pk_fma_f32 v[198:199], v[198:199], v[162:163], v[166:167]
    v_cvt_pk_bf16_f32 v218, v196, v197
    v_cvt_pk_bf16_f32 v219, v198, v199
    ds_write_b64 v6, v[218:219] offset:23040
    v_pk_fma_f32 v[200:201], v[200:201], v[160:161], v[164:165]
    v_pk_fma_f32 v[202:203], v[202:203], v[162:163], v[166:167]
    v_cvt_pk_bf16_f32 v220, v200, v201
    v_cvt_pk_bf16_f32 v221, v202, v203
    ds_write_b64 v6, v[220:221] offset:27648
    v_pk_fma_f32 v[204:205], v[204:205], v[160:161], v[164:165]
    v_pk_fma_f32 v[206:207], v[206:207], v[162:163], v[166:167]
    v_cvt_pk_bf16_f32 v222, v204, v205
    v_cvt_pk_bf16_f32 v223, v206, v207
    ds_write_b64 v6, v[222:223] offset:32256
    s_waitcnt lgkmcnt(0)
    s_barrier
    ds_read_b128 v[176:179], v7 offset:448
    ds_read_b128 v[180:183], v7 offset:432
    s_waitcnt lgkmcnt(1)
    v_mfma_f32_16x16x32_bf16 v[212:215], v[176:179], v[128:131], 0
    ds_read_b128 v[184:187], v7 offset:960
    ds_read_b128 v[188:191], v7 offset:944
    v_mfma_f32_16x16x32_bf16 v[216:219], v[176:179], v[132:135], 0
    ds_read2_b32 v[108:109], v15 offset0:131 offset1:130
    s_waitcnt lgkmcnt(3)
    v_mfma_f32_16x16x32_bf16 v[204:207], v[180:183], v[128:131], 0
    ds_read2_b32 v[110:111], v15 offset0:129 offset1:128
    ds_read2_b32 v[112:113], v15 offset0:147 offset1:146
    v_mfma_f32_16x16x32_bf16 v[208:211], v[180:183], v[132:135], 0
    ds_read2_b32 v[114:115], v15 offset0:145 offset1:144
    ds_read2_b32 v[116:117], v15 offset0:163 offset1:162
    v_mfma_f32_16x16x32_bf16 v[160:163], v[124:127], v[176:179], 0
    ds_read2_b32 v[118:119], v15 offset0:161 offset1:160
    ds_read2_b32 v[120:121], v15 offset0:179 offset1:178
    v_mfma_f32_16x16x32_bf16 v[224:227], v[176:179], v[140:143], 0
    ds_read2_b32 v[122:123], v15 offset0:177 offset1:176
    ds_read2_b32 v[44:45], v12 offset0:230 offset1:228
    v_mfma_f32_16x16x32_bf16 v[220:223], v[180:183], v[136:139], 0
    v_cvt_pk_bf16_f32 v232, v212, v216
    v_cvt_pk_bf16_f32 v233, v213, v217
    v_cvt_pk_bf16_f32 v234, v214, v218
    v_cvt_pk_bf16_f32 v235, v215, v219
    s_waitcnt lgkmcnt(8)
    v_mfma_f32_16x16x32_bf16 v[212:215], v[184:187], v[128:131], 0
    ds_read_b128 v[176:179], v7 offset:1472
    ds_read_b128 v[180:183], v7 offset:1456
    v_mfma_f32_16x16x32_bf16 v[216:219], v[184:187], v[132:135], 0
    v_cvt_pk_bf16_f32 v228, v204, v208
    v_cvt_pk_bf16_f32 v229, v205, v209
    v_cvt_pk_bf16_f32 v230, v206, v210
    v_cvt_pk_bf16_f32 v231, v207, v211
    v_mfma_f32_16x16x32_bf16 v[204:207], v[188:191], v[128:131], 0
    ds_read2_b32 v[46:47], v12 offset0:226 offset1:224
    ds_read2_b32 v[76:77], v13 offset0:230 offset1:228
    v_mfma_f32_16x16x32_bf16 v[208:211], v[188:191], v[132:135], 0
    ds_read2_b32 v[78:79], v13 offset0:226 offset1:224
    ds_read2_b32 v[40:41], v12 offset0:198 offset1:196
    v_mfma_f32_16x16x32_bf16 v[164:167], v[124:127], v[184:187], 0
    v_cvt_pk_bf16_f32 v236, v220, v224
    v_cvt_pk_bf16_f32 v237, v221, v225
    v_cvt_pk_bf16_f32 v238, v222, v226
    v_cvt_pk_bf16_f32 v239, v223, v227
    v_mfma_f32_16x16x32_bf16 v[224:227], v[184:187], v[140:143], 0
    ds_read2_b32 v[42:43], v12 offset0:194 offset1:192
    ds_read2_b32 v[72:73], v13 offset0:198 offset1:196
    v_mfma_f32_16x16x32_bf16 v[220:223], v[188:191], v[136:139], 0
    ds_read_b128 v[184:187], v7 offset:1984
    ds_read_b128 v[188:191], v7 offset:1968
    v_mfma_f32_16x16x32_bf16 v[152:155], v[232:235], v[96:99], 0
    ds_read2_b32 v[74:75], v13 offset0:194 offset1:192
    ds_read2_b32 v[36:37], v12 offset0:166 offset1:164
    v_mfma_f32_16x16x32_bf16 v[156:159], v[232:235], v[100:103], 0
    ds_read2_b32 v[38:39], v12 offset0:162 offset1:160
    ds_read2_b32 v[68:69], v13 offset0:166 offset1:164
    v_mfma_f32_16x16x32_bf16 v[160:163], v[232:235], v[104:107], v[160:163]
    v_cvt_pk_bf16_f32 v232, v212, v216
    v_cvt_pk_bf16_f32 v233, v213, v217
    v_mfma_f32_16x16x32_bf16 v[152:155], v[228:231], v[84:87], v[152:155]
    v_cvt_pk_bf16_f32 v234, v214, v218
    v_cvt_pk_bf16_f32 v235, v215, v219
    v_mfma_f32_16x16x32_bf16 v[156:159], v[228:231], v[88:91], v[156:159]
    ds_read2_b32 v[70:71], v13 offset0:162 offset1:160
    ds_read2_b32 v[32:33], v12 offset0:134 offset1:132
    v_mfma_f32_16x16x32_bf16 v[160:163], v[228:231], v[92:95], v[160:163]
    v_cvt_pk_bf16_f32 v228, v204, v208
    s_waitcnt lgkmcnt(4)
    v_mfma_f32_16x16x32_bf16 v[160:163], v[236:239], v[108:111], v[160:163]
    v_cvt_pk_bf16_f32 v229, v205, v209
    v_cvt_pk_bf16_f32 v230, v206, v210
    v_mfma_f32_16x16x32_bf16 v[164:167], v[236:239], v[112:115], v[164:167]
    v_cvt_pk_bf16_f32 v231, v207, v211
    ds_read2_b32 v[34:35], v12 offset0:130 offset1:128
    v_mfma_f32_16x16x32_bf16 v[168:171], v[236:239], v[116:119], 0
    ds_read2_b32 v[64:65], v13 offset0:134 offset1:132
    ds_read2_b32 v[66:67], v13 offset0:130 offset1:128
    v_mfma_f32_16x16x32_bf16 v[172:175], v[236:239], v[120:123], 0
    v_cvt_pk_bf16_f32 v236, v220, v224
    v_cvt_pk_bf16_f32 v237, v221, v225
    v_mfma_f32_16x16x32_bf16 v[212:215], v[176:179], v[128:131], 0
    v_cvt_pk_bf16_f32 v238, v222, v226
    v_cvt_pk_bf16_f32 v239, v223, v227
    v_mfma_f32_16x16x32_bf16 v[216:219], v[176:179], v[132:135], 0
    ds_read2_b32 v[28:29], v12 offset0:102 offset1:100
    ds_read2_b32 v[30:31], v12 offset0:98 offset1:96
    v_mfma_f32_16x16x32_bf16 v[204:207], v[180:183], v[128:131], 0
    ds_read2_b32 v[60:61], v13 offset0:102 offset1:100
    ds_read2_b32 v[62:63], v13 offset0:98 offset1:96
    v_mfma_f32_16x16x32_bf16 v[208:211], v[180:183], v[132:135], 0
    ds_read2_b32 v[24:25], v12 offset0:70 offset1:68
    ds_read2_b32 v[26:27], v12 offset0:66 offset1:64
    v_mfma_f32_16x16x32_bf16 v[168:171], v[124:127], v[176:179], v[168:171]
    ds_read2_b32 v[56:57], v13 offset0:70 offset1:68
    ds_read2_b32 v[58:59], v13 offset0:66 offset1:64
    v_mfma_f32_16x16x32_bf16 v[224:227], v[176:179], v[140:143], 0
    ds_read2_b32 v[20:21], v12 offset0:38 offset1:36
    ds_read2_b32 v[22:23], v12 offset0:34 offset1:32
    v_mfma_f32_16x16x32_bf16 v[220:223], v[180:183], v[136:139], 0
    ds_read_b128 v[176:179], v7 offset:2496
    ds_read_b128 v[180:183], v7 offset:2480
    v_mfma_f32_16x16x32_bf16 v[156:159], v[232:235], v[96:99], v[156:159]
    ds_read2_b32 v[52:53], v13 offset0:38 offset1:36
    ds_read2_b32 v[54:55], v13 offset0:34 offset1:32
    v_mfma_f32_16x16x32_bf16 v[160:163], v[232:235], v[100:103], v[160:163]
    ds_read2_b32 v[16:17], v12 offset0:6 offset1:4
    ds_read2_b32 v[18:19], v12 offset0:2 offset1:0
    v_mfma_f32_16x16x32_bf16 v[164:167], v[232:235], v[104:107], v[164:167]
    v_cvt_pk_bf16_f32 v232, v212, v216
    v_cvt_pk_bf16_f32 v233, v213, v217
    v_mfma_f32_16x16x32_bf16 v[156:159], v[228:231], v[84:87], v[156:159]
    v_cvt_pk_bf16_f32 v234, v214, v218
    v_cvt_pk_bf16_f32 v235, v215, v219
    v_mfma_f32_16x16x32_bf16 v[160:163], v[228:231], v[88:91], v[160:163]
    ds_read2_b32 v[48:49], v13 offset0:6 offset1:4
    ds_read2_b32 v[50:51], v13 offset0:2 offset1:0
    v_mfma_f32_16x16x32_bf16 v[164:167], v[228:231], v[92:95], v[164:167]
    v_cvt_pk_bf16_f32 v228, v204, v208
    v_cvt_pk_bf16_f32 v229, v205, v209
    v_mfma_f32_16x16x32_bf16 v[164:167], v[236:239], v[108:111], v[164:167]
    v_cvt_pk_bf16_f32 v230, v206, v210
    v_cvt_pk_bf16_f32 v231, v207, v211
    v_mfma_f32_16x16x32_bf16 v[168:171], v[236:239], v[112:115], v[168:171]
    ds_read2_b32 v[80:81], v14 offset0:6 offset1:4
    ds_read2_b32 v[82:83], v14 offset0:2 offset1:0
    v_mfma_f32_16x16x32_bf16 v[172:175], v[236:239], v[116:119], v[172:175]
    v_cvt_pk_bf16_f32 v236, v220, v224
    v_cvt_pk_bf16_f32 v237, v221, v225
    v_mfma_f32_16x16x32_bf16 v[212:215], v[184:187], v[128:131], 0
    v_cvt_pk_bf16_f32 v238, v222, v226
    v_cvt_pk_bf16_f32 v239, v223, v227
    v_mfma_f32_16x16x32_bf16 v[216:219], v[184:187], v[132:135], 0
    v_mfma_f32_16x16x32_bf16 v[204:207], v[188:191], v[128:131], 0
    v_mfma_f32_16x16x32_bf16 v[208:211], v[188:191], v[132:135], 0
    v_mfma_f32_16x16x32_bf16 v[172:175], v[124:127], v[184:187], v[172:175]
    v_mfma_f32_16x16x32_bf16 v[224:227], v[184:187], v[140:143], 0
    v_mfma_f32_16x16x32_bf16 v[220:223], v[188:191], v[136:139], 0
    ds_read_b128 v[184:187], v7 offset:3008
    ds_read_b128 v[188:191], v7 offset:2992
    v_mfma_f32_16x16x32_bf16 v[160:163], v[232:235], v[96:99], v[160:163]
    v_mfma_f32_16x16x32_bf16 v[164:167], v[232:235], v[100:103], v[164:167]
    v_mfma_f32_16x16x32_bf16 v[168:171], v[232:235], v[104:107], v[168:171]
    v_cvt_pk_bf16_f32 v232, v212, v216
    v_cvt_pk_bf16_f32 v233, v213, v217
    v_mfma_f32_16x16x32_bf16 v[160:163], v[228:231], v[84:87], v[160:163]
    v_cvt_pk_bf16_f32 v234, v214, v218
    v_cvt_pk_bf16_f32 v235, v215, v219
    v_mfma_f32_16x16x32_bf16 v[164:167], v[228:231], v[88:91], v[164:167]
    v_mfma_f32_16x16x32_bf16 v[168:171], v[228:231], v[92:95], v[168:171]
    v_cvt_pk_bf16_f32 v228, v204, v208
    v_cvt_pk_bf16_f32 v229, v205, v209
    v_mfma_f32_16x16x32_bf16 v[168:171], v[236:239], v[108:111], v[168:171]
    v_cvt_pk_bf16_f32 v230, v206, v210
    v_cvt_pk_bf16_f32 v231, v207, v211
    v_mfma_f32_16x16x32_bf16 v[172:175], v[236:239], v[112:115], v[172:175]
    v_cvt_pk_bf16_f32 v236, v220, v224
    s_waitcnt lgkmcnt(0)
    v_mfma_f32_16x16x32_bf16 v[212:215], v[176:179], v[128:131], 0
    v_cvt_pk_bf16_f32 v237, v221, v225
    v_cvt_pk_bf16_f32 v238, v222, v226
    v_mfma_f32_16x16x32_bf16 v[216:219], v[176:179], v[132:135], 0
    v_cvt_pk_bf16_f32 v239, v223, v227
    v_mfma_f32_16x16x32_bf16 v[204:207], v[180:183], v[128:131], 0
    v_mfma_f32_16x16x32_bf16 v[208:211], v[180:183], v[132:135], 0
    ds_read_b128 v[176:179], v7 offset:0
    ds_read_b128 v[180:183], v7 offset:64
    v_mfma_f32_16x16x32_bf16 v[164:167], v[232:235], v[96:99], v[164:167]
    v_mfma_f32_16x16x32_bf16 v[168:171], v[232:235], v[100:103], v[168:171]
    v_mfma_f32_16x16x32_bf16 v[172:175], v[232:235], v[104:107], v[172:175]
    v_mfma_f32_16x16x32_bf16 v[164:167], v[228:231], v[84:87], v[164:167]
    v_mfma_f32_16x16x32_bf16 v[168:171], v[228:231], v[88:91], v[168:171]
    v_cvt_pk_bf16_f32 v232, v212, v216
    v_cvt_pk_bf16_f32 v233, v213, v217
    v_mfma_f32_16x16x32_bf16 v[172:175], v[228:231], v[92:95], v[172:175]
    v_cvt_pk_bf16_f32 v234, v214, v218
    v_cvt_pk_bf16_f32 v235, v215, v219
    v_mfma_f32_16x16x32_bf16 v[172:175], v[236:239], v[108:111], v[172:175]
    v_cvt_pk_bf16_f32 v228, v204, v208
    v_cvt_pk_bf16_f32 v229, v205, v209
    v_mfma_f32_16x16x32_bf16 v[212:215], v[184:187], v[128:131], 0
    v_cvt_pk_bf16_f32 v230, v206, v210
    v_cvt_pk_bf16_f32 v231, v207, v211
    v_mfma_f32_16x16x32_bf16 v[216:219], v[184:187], v[132:135], 0
    v_mfma_f32_16x16x32_bf16 v[204:207], v[188:191], v[128:131], 0
    ds_read_b128 v[240:243], v255 offset:0
    v_mfma_f32_16x16x32_bf16 v[208:211], v[188:191], v[132:135], 0
    ds_read_b128 v[184:187], v7 offset:128
    ds_read_b128 v[188:191], v7 offset:192
    v_mfma_f32_16x16x32_bf16 v[168:171], v[232:235], v[96:99], v[168:171]
    ds_read_b128 v[192:195], v7 offset:256
    ds_read_b128 v[196:199], v7 offset:320
    v_mfma_f32_16x16x32_bf16 v[172:175], v[232:235], v[100:103], v[172:175]
    v_mfma_f32_16x16x32_bf16 v[168:171], v[228:231], v[84:87], v[168:171]
    v_cvt_pk_bf16_f32 v232, v212, v216
    v_cvt_pk_bf16_f32 v233, v213, v217
    v_cvt_pk_bf16_f32 v234, v214, v218
    v_cvt_pk_bf16_f32 v235, v215, v219
    v_mfma_f32_16x16x32_bf16 v[172:175], v[228:231], v[88:91], v[172:175]
    v_cvt_pk_bf16_f32 v228, v204, v208
    v_cvt_pk_bf16_f32 v229, v205, v209
    v_cvt_pk_bf16_f32 v230, v206, v210
    v_cvt_pk_bf16_f32 v231, v207, v211
    v_mfma_f32_16x16x32_bf16 v[172:175], v[232:235], v[96:99], v[172:175]
    s_waitcnt lgkmcnt(4)
    v_lshlrev_b32 v244, 16, v240
    v_mfma_f32_16x16x32_bf16 v[172:175], v[228:231], v[84:87], v[172:175]
    v_and_b32 v245, 0xffff0000, v240
    v_lshlrev_b32 v246, 16, v241
    v_mfma_f32_16x16x32_bf16 v[144:147], v[44:47], v[176:179], 0
    v_and_b32 v247, 0xffff0000, v241
    v_lshlrev_b32 v248, 16, v242
    v_mfma_f32_16x16x32_bf16 v[148:151], v[76:79], v[176:179], 0
    ds_read_b128 v[176:179], v7 offset:384
    v_and_b32 v249, 0xffff0000, v242
    v_mfma_f32_16x16x32_bf16 v[144:147], v[40:43], v[180:183], v[144:147]
    v_lshlrev_b32 v250, 16, v243
    v_and_b32 v251, 0xffff0000, v243
    v_mfma_f32_16x16x32_bf16 v[148:151], v[72:75], v[180:183], v[148:151]
    ds_read_b128 v[180:183], v7 offset:448
    s_waitcnt lgkmcnt(2)
    v_mfma_f32_16x16x32_bf16 v[144:147], v[36:39], v[184:187], v[144:147]
    v_mfma_f32_16x16x32_bf16 v[148:151], v[68:71], v[184:187], v[148:151]
    ds_read_b128 v[184:187], v7 offset:512
    v_mfma_f32_16x16x32_bf16 v[144:147], v[32:35], v[188:191], v[144:147]
    v_mfma_f32_16x16x32_bf16 v[148:151], v[64:67], v[188:191], v[148:151]
    ds_read_b128 v[188:191], v7 offset:576
    v_mfma_f32_16x16x32_bf16 v[144:147], v[28:31], v[192:195], v[144:147]
    v_mfma_f32_16x16x32_bf16 v[148:151], v[60:63], v[192:195], v[148:151]
    ds_read_b128 v[192:195], v7 offset:640
    v_mfma_f32_16x16x32_bf16 v[144:147], v[24:27], v[196:199], v[144:147]
    v_mfma_f32_16x16x32_bf16 v[148:151], v[56:59], v[196:199], v[148:151]
    ds_read_b128 v[196:199], v7 offset:704
    s_waitcnt lgkmcnt(3)
    v_mfma_f32_16x16x32_bf16 v[144:147], v[20:23], v[176:179], v[144:147]
    v_mfma_f32_16x16x32_bf16 v[148:151], v[52:55], v[176:179], v[148:151]
    ds_read_b128 v[176:179], v7 offset:768
    v_mfma_f32_16x16x32_bf16 v[144:147], v[16:19], v[180:183], v[144:147]
    v_mfma_f32_16x16x32_bf16 v[148:151], v[48:51], v[180:183], v[148:151]
    v_mfma_f32_16x16x32_bf16 v[152:155], v[80:83], v[180:183], v[152:155]
    ds_read_b128 v[180:183], v7 offset:832
    v_mfma_f32_16x16x32_bf16 v[148:151], v[44:47], v[184:187], v[148:151]
    v_mfma_f32_16x16x32_bf16 v[152:155], v[76:79], v[184:187], v[152:155]
    ds_read_b128 v[184:187], v7 offset:896
    s_waitcnt lgkmcnt(2)
    v_mfma_f32_16x16x32_bf16 v[148:151], v[40:43], v[188:191], v[148:151]
    v_mfma_f32_16x16x32_bf16 v[152:155], v[72:75], v[188:191], v[152:155]
    ds_read_b128 v[188:191], v7 offset:960
    v_mfma_f32_16x16x32_bf16 v[148:151], v[36:39], v[192:195], v[148:151]
    v_cvt_pk_bf16_f32 v10, v144, v145
    v_cvt_pk_bf16_f32 v11, v146, v147
    v_mfma_f32_16x16x32_bf16 v[152:155], v[68:71], v[192:195], v[152:155]
    ds_read_b128 v[192:195], v7 offset:1024
    ds_write_b64 v8, v[10:11] offset:0
    v_mfma_f32_16x16x32_bf16 v[148:151], v[32:35], v[196:199], v[148:151]
    v_mfma_f32_16x16x32_bf16 v[152:155], v[64:67], v[196:199], v[152:155]
    ds_read_b128 v[196:199], v7 offset:1088
    v_mfma_f32_16x16x32_bf16 v[148:151], v[28:31], v[176:179], v[148:151]
    v_mfma_f32_16x16x32_bf16 v[152:155], v[60:63], v[176:179], v[152:155]
    ds_read_b128 v[176:179], v7 offset:1152
    s_waitcnt lgkmcnt(4)
    v_mfma_f32_16x16x32_bf16 v[148:151], v[24:27], v[180:183], v[148:151]
    v_mfma_f32_16x16x32_bf16 v[152:155], v[56:59], v[180:183], v[152:155]
    ds_read_b128 v[180:183], v7 offset:1216
    v_mfma_f32_16x16x32_bf16 v[148:151], v[20:23], v[184:187], v[148:151]
    v_mfma_f32_16x16x32_bf16 v[152:155], v[52:55], v[184:187], v[152:155]
    ds_read_b128 v[184:187], v7 offset:1280
    v_mfma_f32_16x16x32_bf16 v[148:151], v[16:19], v[188:191], v[148:151]
    v_mfma_f32_16x16x32_bf16 v[152:155], v[48:51], v[188:191], v[152:155]
    v_mfma_f32_16x16x32_bf16 v[156:159], v[80:83], v[188:191], v[156:159]
    ds_read_b128 v[188:191], v7 offset:1344
    s_waitcnt lgkmcnt(2)
    v_mfma_f32_16x16x32_bf16 v[152:155], v[44:47], v[192:195], v[152:155]
    v_mfma_f32_16x16x32_bf16 v[156:159], v[76:79], v[192:195], v[156:159]
    ds_read_b128 v[192:195], v7 offset:1408
    v_mfma_f32_16x16x32_bf16 v[152:155], v[40:43], v[196:199], v[152:155]
    v_mfma_f32_16x16x32_bf16 v[156:159], v[72:75], v[196:199], v[156:159]
    ds_read_b128 v[196:199], v7 offset:1472
    v_mfma_f32_16x16x32_bf16 v[152:155], v[36:39], v[176:179], v[152:155]
    v_cvt_pk_bf16_f32 v10, v148, v149
    v_cvt_pk_bf16_f32 v11, v150, v151
    v_mfma_f32_16x16x32_bf16 v[156:159], v[68:71], v[176:179], v[156:159]
    ds_read_b128 v[176:179], v7 offset:1536
    ds_write_b64 v8, v[10:11] offset:512
    v_mfma_f32_16x16x32_bf16 v[152:155], v[32:35], v[180:183], v[152:155]
    v_mfma_f32_16x16x32_bf16 v[156:159], v[64:67], v[180:183], v[156:159]
    ds_read_b128 v[180:183], v7 offset:1600
    s_waitcnt lgkmcnt(4)
    v_mfma_f32_16x16x32_bf16 v[152:155], v[28:31], v[184:187], v[152:155]
    v_mfma_f32_16x16x32_bf16 v[156:159], v[60:63], v[184:187], v[156:159]
    ds_read_b128 v[184:187], v7 offset:1664
    v_mfma_f32_16x16x32_bf16 v[152:155], v[24:27], v[188:191], v[152:155]
    v_mfma_f32_16x16x32_bf16 v[156:159], v[56:59], v[188:191], v[156:159]
    ds_read_b128 v[188:191], v7 offset:1728
    v_mfma_f32_16x16x32_bf16 v[152:155], v[20:23], v[192:195], v[152:155]
    v_mfma_f32_16x16x32_bf16 v[156:159], v[52:55], v[192:195], v[156:159]
    ds_read_b128 v[192:195], v7 offset:1792
    s_waitcnt lgkmcnt(3)
    v_mfma_f32_16x16x32_bf16 v[152:155], v[16:19], v[196:199], v[152:155]
    s_barrier
    ds_read_b64_tr_b16 v[12:13], v4 offset:0
    v_mfma_f32_16x16x32_bf16 v[156:159], v[48:51], v[196:199], v[156:159]
    ds_read_b64_tr_b16 v[14:15], v4 offset:34048
    v_mfma_f32_16x16x32_bf16 v[160:163], v[80:83], v[196:199], v[160:163]
    ds_read_b128 v[196:199], v7 offset:1856
    v_mfma_f32_16x16x32_bf16 v[156:159], v[44:47], v[176:179], v[156:159]
    v_mfma_f32_16x16x32_bf16 v[160:163], v[76:79], v[176:179], v[160:163]
    ds_read_b128 v[176:179], v7 offset:1920
    v_mfma_f32_16x16x32_bf16 v[156:159], v[40:43], v[180:183], v[156:159]
    v_mfma_f32_16x16x32_bf16 v[160:163], v[72:75], v[180:183], v[160:163]
    ds_read_b128 v[180:183], v7 offset:1984
    s_waitcnt lgkmcnt(3)
    v_mfma_f32_16x16x32_bf16 v[156:159], v[36:39], v[184:187], v[156:159]
    v_cvt_pk_bf16_f32 v10, v152, v153
    v_cvt_pk_bf16_f32 v11, v154, v155
    v_mfma_f32_16x16x32_bf16 v[160:163], v[68:71], v[184:187], v[160:163]
    ds_read_b128 v[184:187], v7 offset:2048
    ds_write_b64 v8, v[10:11] offset:1024
    v_mfma_f32_16x16x32_bf16 v[156:159], v[32:35], v[188:191], v[156:159]
    v_lshlrev_b32 v252, 16, v12
    v_and_b32 v253, 0xffff0000, v12
    v_mfma_f32_16x16x32_bf16 v[160:163], v[64:67], v[188:191], v[160:163]
    ds_read_b128 v[188:191], v7 offset:2112
    v_pk_add_f32 v[244:245], v[244:245], v[252:253]
    v_mfma_f32_16x16x32_bf16 v[156:159], v[28:31], v[192:195], v[156:159]
    v_cvt_pk_bf16_f32 v12, v244, v245
    v_lshlrev_b32 v252, 16, v13
    v_mfma_f32_16x16x32_bf16 v[160:163], v[60:63], v[192:195], v[160:163]
    ds_read_b128 v[192:195], v7 offset:2176
    s_waitcnt lgkmcnt(4)
    v_mfma_f32_16x16x32_bf16 v[156:159], v[24:27], v[196:199], v[156:159]
    v_and_b32 v253, 0xffff0000, v13
    v_pk_add_f32 v[246:247], v[246:247], v[252:253]
    v_mfma_f32_16x16x32_bf16 v[160:163], v[56:59], v[196:199], v[160:163]
    ds_read_b128 v[196:199], v7 offset:2240
    v_cvt_pk_bf16_f32 v13, v246, v247
    v_mfma_f32_16x16x32_bf16 v[156:159], v[20:23], v[176:179], v[156:159]
    v_lshlrev_b32 v252, 16, v14
    v_and_b32 v253, 0xffff0000, v14
    v_mfma_f32_16x16x32_bf16 v[160:163], v[52:55], v[176:179], v[160:163]
    ds_read_b128 v[176:179], v7 offset:2304
    v_pk_add_f32 v[248:249], v[248:249], v[252:253]
    v_mfma_f32_16x16x32_bf16 v[156:159], v[16:19], v[180:183], v[156:159]
    v_cvt_pk_bf16_f32 v14, v248, v249
    v_lshlrev_b32 v252, 16, v15
    v_mfma_f32_16x16x32_bf16 v[160:163], v[48:51], v[180:183], v[160:163]
    v_and_b32 v253, 0xffff0000, v15
    v_pk_add_f32 v[250:251], v[250:251], v[252:253]
    v_mfma_f32_16x16x32_bf16 v[164:167], v[80:83], v[180:183], v[164:167]
    ds_read_b128 v[180:183], v7 offset:2368
    s_waitcnt lgkmcnt(2)
    v_mfma_f32_16x16x32_bf16 v[160:163], v[44:47], v[184:187], v[160:163]
    v_cvt_pk_bf16_f32 v15, v250, v251
    buffer_store_dwordx4 v[12:15], v5, s[32:35], 0 offen
    ds_read_b128 v[240:243], v255 offset:8192
    v_mfma_f32_16x16x32_bf16 v[164:167], v[76:79], v[184:187], v[164:167]
    ds_read_b128 v[184:187], v7 offset:2432
    v_mfma_f32_16x16x32_bf16 v[160:163], v[40:43], v[188:191], v[160:163]
    v_mfma_f32_16x16x32_bf16 v[164:167], v[72:75], v[188:191], v[164:167]
    ds_read_b128 v[188:191], v7 offset:2496
    v_mfma_f32_16x16x32_bf16 v[160:163], v[36:39], v[192:195], v[160:163]
    v_cvt_pk_bf16_f32 v10, v156, v157
    v_cvt_pk_bf16_f32 v11, v158, v159
    v_mfma_f32_16x16x32_bf16 v[164:167], v[68:71], v[192:195], v[164:167]
    s_waitcnt lgkmcnt(2)
    v_lshlrev_b32 v244, 16, v240
    v_mfma_f32_16x16x32_bf16 v[160:163], v[32:35], v[196:199], v[160:163]
    v_and_b32 v245, 0xffff0000, v240
    v_lshlrev_b32 v246, 16, v241
    v_and_b32 v247, 0xffff0000, v241
    v_lshlrev_b32 v248, 16, v242
    v_and_b32 v249, 0xffff0000, v242
    v_lshlrev_b32 v250, 16, v243
    v_and_b32 v251, 0xffff0000, v243
    v_mfma_f32_16x16x32_bf16 v[164:167], v[64:67], v[196:199], v[164:167]
    ds_read_b128 v[192:195], v7 offset:2560
    ds_read_b128 v[196:199], v7 offset:2624
    v_mfma_f32_16x16x32_bf16 v[160:163], v[28:31], v[176:179], v[160:163]
    ds_write_b64 v8, v[10:11] offset:1536
    v_mfma_f32_16x16x32_bf16 v[164:167], v[60:63], v[176:179], v[164:167]
    ds_read_b128 v[176:179], v7 offset:2688
    v_mfma_f32_16x16x32_bf16 v[160:163], v[24:27], v[180:183], v[160:163]
    v_mfma_f32_16x16x32_bf16 v[164:167], v[56:59], v[180:183], v[164:167]
    ds_read_b128 v[180:183], v7 offset:2752
    s_waitcnt lgkmcnt(5)
    v_mfma_f32_16x16x32_bf16 v[160:163], v[20:23], v[184:187], v[160:163]
    v_mfma_f32_16x16x32_bf16 v[164:167], v[52:55], v[184:187], v[164:167]
    ds_read_b128 v[184:187], v7 offset:2816
    v_mfma_f32_16x16x32_bf16 v[160:163], v[16:19], v[188:191], v[160:163]
    s_waitcnt lgkmcnt(3)
    s_barrier
    v_mfma_f32_16x16x32_bf16 v[164:167], v[48:51], v[188:191], v[164:167]
    ds_read_b64_tr_b16 v[12:13], v4 offset:1024
    ds_read_b64_tr_b16 v[14:15], v4 offset:35072
    v_mfma_f32_16x16x32_bf16 v[168:171], v[80:83], v[188:191], v[168:171]
    ds_read_b128 v[188:191], v7 offset:2880
    v_mfma_f32_16x16x32_bf16 v[164:167], v[44:47], v[192:195], v[164:167]
    v_mfma_f32_16x16x32_bf16 v[168:171], v[76:79], v[192:195], v[168:171]
    ds_read_b128 v[192:195], v7 offset:2944
    v_mfma_f32_16x16x32_bf16 v[164:167], v[40:43], v[196:199], v[164:167]
    v_mfma_f32_16x16x32_bf16 v[168:171], v[72:75], v[196:199], v[168:171]
    ds_read_b128 v[196:199], v7 offset:3008
    s_waitcnt lgkmcnt(3)
    v_mfma_f32_16x16x32_bf16 v[164:167], v[36:39], v[176:179], v[164:167]
    v_cvt_pk_bf16_f32 v10, v160, v161
    v_cvt_pk_bf16_f32 v11, v162, v163
    v_mfma_f32_16x16x32_bf16 v[168:171], v[68:71], v[176:179], v[168:171]
    ds_read_b128 v[176:179], v7 offset:3072
    ds_write_b64 v8, v[10:11] offset:2048
    v_mfma_f32_16x16x32_bf16 v[164:167], v[32:35], v[180:183], v[164:167]
    buffer_load_dwordx4 v[108:111], v254, s[36:39], 0 offen sc1
    v_lshlrev_b32 v252, 16, v12
    v_mfma_f32_16x16x32_bf16 v[168:171], v[64:67], v[180:183], v[168:171]
    ds_read_b128 v[180:183], v7 offset:3136
    v_and_b32 v253, 0xffff0000, v12
    v_mfma_f32_16x16x32_bf16 v[164:167], v[28:31], v[184:187], v[164:167]
    v_pk_add_f32 v[244:245], v[244:245], v[252:253]
    v_cvt_pk_bf16_f32 v12, v244, v245
    v_mfma_f32_16x16x32_bf16 v[168:171], v[60:63], v[184:187], v[168:171]
    ds_read_b128 v[184:187], v7 offset:3200
    s_waitcnt lgkmcnt(4)
    v_mfma_f32_16x16x32_bf16 v[164:167], v[24:27], v[188:191], v[164:167]
    v_lshlrev_b32 v252, 16, v13
    v_and_b32 v253, 0xffff0000, v13
    v_mfma_f32_16x16x32_bf16 v[168:171], v[56:59], v[188:191], v[168:171]
    ds_read_b128 v[188:191], v7 offset:3264
    v_pk_add_f32 v[246:247], v[246:247], v[252:253]
    v_mfma_f32_16x16x32_bf16 v[164:167], v[20:23], v[192:195], v[164:167]
    v_cvt_pk_bf16_f32 v13, v246, v247
    v_lshlrev_b32 v252, 16, v14
    v_mfma_f32_16x16x32_bf16 v[168:171], v[52:55], v[192:195], v[168:171]
    ds_read_b128 v[192:195], v7 offset:3328
    v_and_b32 v253, 0xffff0000, v14
    v_mfma_f32_16x16x32_bf16 v[164:167], v[16:19], v[196:199], v[164:167]
    v_pk_add_f32 v[248:249], v[248:249], v[252:253]
    v_cvt_pk_bf16_f32 v14, v248, v249
    v_mfma_f32_16x16x32_bf16 v[168:171], v[48:51], v[196:199], v[168:171]
    v_lshlrev_b32 v252, 16, v15
    v_and_b32 v253, 0xffff0000, v15
    v_mfma_f32_16x16x32_bf16 v[172:175], v[80:83], v[196:199], v[172:175]
    ds_read_b128 v[196:199], v7 offset:3392
    s_waitcnt lgkmcnt(2)
    v_mfma_f32_16x16x32_bf16 v[168:171], v[44:47], v[176:179], v[168:171]
    v_pk_add_f32 v[250:251], v[250:251], v[252:253]
    v_cvt_pk_bf16_f32 v15, v250, v251
    v_mfma_f32_16x16x32_bf16 v[172:175], v[76:79], v[176:179], v[172:175]
    ds_read_b128 v[176:179], v7 offset:3456
    buffer_store_dwordx4 v[12:15], v5, s[32:35], s54 offen
    ds_read_b128 v[240:243], v255 offset:16384
    v_mfma_f32_16x16x32_bf16 v[168:171], v[40:43], v[180:183], v[168:171]
    v_mfma_f32_16x16x32_bf16 v[172:175], v[72:75], v[180:183], v[172:175]
    ds_read_b128 v[180:183], v7 offset:3520
    v_mfma_f32_16x16x32_bf16 v[168:171], v[36:39], v[184:187], v[168:171]
    v_cvt_pk_bf16_f32 v10, v164, v165
    v_cvt_pk_bf16_f32 v11, v166, v167
    v_mfma_f32_16x16x32_bf16 v[172:175], v[68:71], v[184:187], v[172:175]
    ds_read_b128 v[184:187], v7 offset:3584
    ds_write_b64 v8, v[10:11] offset:2560
    v_mfma_f32_16x16x32_bf16 v[168:171], v[32:35], v[188:191], v[168:171]
    s_waitcnt lgkmcnt(3)
    v_lshlrev_b32 v244, 16, v240
    v_and_b32 v245, 0xffff0000, v240
    v_lshlrev_b32 v246, 16, v241
    v_and_b32 v247, 0xffff0000, v241
    v_lshlrev_b32 v248, 16, v242
    v_and_b32 v249, 0xffff0000, v242
    v_lshlrev_b32 v250, 16, v243
    v_and_b32 v251, 0xffff0000, v243
    v_mfma_f32_16x16x32_bf16 v[172:175], v[64:67], v[188:191], v[172:175]
    ds_read_b128 v[188:191], v7 offset:3648
    v_mfma_f32_16x16x32_bf16 v[168:171], v[28:31], v[192:195], v[168:171]
    v_mfma_f32_16x16x32_bf16 v[172:175], v[60:63], v[192:195], v[172:175]
    ds_read_b128 v[192:195], v7 offset:3712
    v_mfma_f32_16x16x32_bf16 v[168:171], v[24:27], v[196:199], v[168:171]
    v_mfma_f32_16x16x32_bf16 v[172:175], v[56:59], v[196:199], v[172:175]
    ds_read_b128 v[196:199], v7 offset:3776
    v_mfma_f32_16x16x32_bf16 v[168:171], v[20:23], v[176:179], v[168:171]
    v_mfma_f32_16x16x32_bf16 v[172:175], v[52:55], v[176:179], v[172:175]
    ds_read_b128 v[176:179], v7 offset:3840
    s_waitcnt lgkmcnt(3)
    v_mfma_f32_16x16x32_bf16 v[168:171], v[16:19], v[180:183], v[168:171]
    s_barrier
    ds_read_b64_tr_b16 v[12:13], v4 offset:2048
    v_mfma_f32_16x16x32_bf16 v[172:175], v[48:51], v[180:183], v[172:175]
    ds_read_b128 v[180:183], v7 offset:3904
    ds_read_b64_tr_b16 v[14:15], v4 offset:36096
    s_waitcnt lgkmcnt(0)
    v_lshlrev_b32 v252, 16, v12
    v_and_b32 v253, 0xffff0000, v12
    v_pk_add_f32 v[244:245], v[244:245], v[252:253]
    v_cvt_pk_bf16_f32 v12, v244, v245
    v_lshlrev_b32 v252, 16, v13
    v_and_b32 v253, 0xffff0000, v13
    v_pk_add_f32 v[246:247], v[246:247], v[252:253]
    v_cvt_pk_bf16_f32 v13, v246, v247
    v_lshlrev_b32 v252, 16, v14
    v_and_b32 v253, 0xffff0000, v14
    v_pk_add_f32 v[248:249], v[248:249], v[252:253]
    v_cvt_pk_bf16_f32 v14, v248, v249
    v_lshlrev_b32 v252, 16, v15
    v_and_b32 v253, 0xffff0000, v15
    v_pk_add_f32 v[250:251], v[250:251], v[252:253]
    v_cvt_pk_bf16_f32 v15, v250, v251
    buffer_store_dwordx4 v[12:15], v5, s[32:35], s55 offen
    v_mfma_f32_16x16x32_bf16 v[172:175], v[44:47], v[184:187], v[172:175]
    ds_read_b128 v[184:187], v7 offset:3968
    ds_read_b128 v[240:243], v255 offset:24576
    v_mfma_f32_16x16x32_bf16 v[172:175], v[40:43], v[188:191], v[172:175]
    ds_read_b128 v[188:191], v7 offset:4032
    v_mfma_f32_16x16x32_bf16 v[172:175], v[36:39], v[192:195], v[172:175]
    v_mfma_f32_16x16x32_bf16 v[172:175], v[32:35], v[196:199], v[172:175]
    v_mfma_f32_16x16x32_bf16 v[172:175], v[28:31], v[176:179], v[172:175]
    v_mfma_f32_16x16x32_bf16 v[172:175], v[24:27], v[180:183], v[172:175]
    v_cvt_pk_bf16_f32 v10, v168, v169
    s_waitcnt lgkmcnt(1)
    v_mfma_f32_16x16x32_bf16 v[172:175], v[20:23], v[184:187], v[172:175]
    v_cvt_pk_bf16_f32 v11, v170, v171
    s_waitcnt lgkmcnt(0)
    v_mfma_f32_16x16x32_bf16 v[172:175], v[16:19], v[188:191], v[172:175]
    ds_write_b64 v8, v[10:11] offset:3072
    v_lshlrev_b32 v244, 16, v240
    v_and_b32 v245, 0xffff0000, v240
    v_lshlrev_b32 v246, 16, v241
    v_and_b32 v247, 0xffff0000, v241
    v_lshlrev_b32 v248, 16, v242
    v_and_b32 v249, 0xffff0000, v242
    v_lshlrev_b32 v250, 16, v243
    v_and_b32 v251, 0xffff0000, v243
    v_cvt_pk_bf16_f32 v10, v172, v173
    v_cvt_pk_bf16_f32 v11, v174, v175
    ds_write_b64 v8, v[10:11] offset:3584
    s_waitcnt lgkmcnt(0)
    s_waitcnt vmcnt(2)
    s_barrier
    ds_read_b64_tr_b16 v[12:13], v4 offset:3072
    ds_read_b64_tr_b16 v[14:15], v4 offset:37120
    s_lshl_b32 s43, s44, 11
    s_add_u32 s43, s43, 491520
    v_lshl_add_u32 v9, v1, 4, s43
    v_cmp_ne_u32 vcc, s52, v111
    s_cbranch_vccz L_conv_selok
    s_mov_b32 s43, 0
L_poll_sel:
    buffer_load_dwordx4 v[108:111], v254, s[36:39], 0 offen sc1
    s_waitcnt vmcnt(0)
    v_xor_b32 v11, s52, v111
    v_cmp_ne_u32 vcc, 0, v11
    s_cbranch_vccz L_polled_sel
    s_add_u32 s43, s43, 1
    s_cmp_ge_u32 s43, 65536
    s_cbranch_scc1 L_polled_sel
    s_sleep 2
    s_branch L_poll_sel
L_polled_sel:
L_conv_selok:
    s_cmp_lg_u32 s45, 0
    s_cbranch_scc1 L_conv_noy
    buffer_load_dwordx4 v[16:19], v9, s[36:39], 0 offen offset:0 sc1
    buffer_load_dwordx4 v[20:23], v9, s[36:39], 0 offen offset:1024 sc1
L_conv_noy:
    v_readlane_b32 s4, v108, 0
    v_readlane_b32 s5, v108, 1
    v_readlane_b32 s6, v108, 2
    v_readlane_b32 s7, v108, 3
    v_readlane_b32 s8, v108, 4
    v_readlane_b32 s9, v108, 5
    v_readlane_b32 s10, v108, 6
    v_readlane_b32 s11, v108, 7
    v_add_u32 v11, 1536, v0
    s_mov_b32 s43, 0x300000
    s_waitcnt lgkmcnt(0)
    v_lshlrev_b32 v252, 16, v12
    v_and_b32 v253, 0xffff0000, v12
    v_pk_add_f32 v[244:245], v[244:245], v[252:253]
    v_cvt_pk_bf16_f32 v12, v244, v245
    v_lshlrev_b32 v252, 16, v13
    v_and_b32 v253, 0xffff0000, v13
    v_pk_add_f32 v[246:247], v[246:247], v[252:253]
    v_cvt_pk_bf16_f32 v13, v246, v247
    v_lshlrev_b32 v252, 16, v14
    v_and_b32 v253, 0xffff0000, v14
    v_pk_add_f32 v[248:249], v[248:249], v[252:253]
    v_cvt_pk_bf16_f32 v14, v248, v249
    v_lshlrev_b32 v252, 16, v15
    v_and_b32 v253, 0xffff0000, v15
    v_pk_add_f32 v[250:251], v[250:251], v[252:253]
    v_cvt_pk_bf16_f32 v15, v250, v251
    v_cmpx_ne_u32 vcc, s4, v11
    s_nop 4
    v_cmpx_ne_u32 vcc, s5, v11
    s_nop 4
    v_cmpx_ne_u32 vcc, s6, v11
    s_nop 4
    v_cmpx_ne_u32 vcc, s7, v11
    s_nop 4
    v_cmpx_ne_u32 vcc, s8, v11
    s_nop 4
    v_cmpx_ne_u32 vcc, s9, v11
    s_nop 4
    v_cmpx_ne_u32 vcc, s10, v11
    s_nop 4
    v_cmpx_ne_u32 vcc, s11, v11
    s_nop 3
    buffer_store_dwordx4 v[12:15], v5, s[32:35], s43 offen
    s_mov_b64 exec, -1
    s_cmp_eq_u32 s45, 0
    s_cbranch_scc1 L_conv_fin
    s_waitcnt vmcnt(1)
    s_barrier
    s_branch L_conv_end
L_conv_fin:
    v_bfe_u32 v10, v1, 3, 1
    v_mul_u32_u24 v11, 34048, v10
    v_lshl_add_u32 v11, v108, 1, v11
    v_add_u32 v11, 0, v11
    ds_read_u16 v36, v11 offset:0
    ds_read_u16 v37, v11 offset:8512
    ds_read_u16 v38, v11 offset:17024
    ds_read_u16 v39, v11 offset:25536
    v_bfe_u32 v11, v108, 4, 2
    v_xor_b32 v11, v11, v108
    v_lshlrev_b32 v11, 4, v11
    v_lshl_add_u32 v11, v10, 3, v11
    v_add_u32 v11, 129024, v11
    ds_read_b64 v[44:45], v11
    v_lshlrev_b32 v12, 11, v108
    v_lshl_add_u32 v12, v10, 3, v12
    v_add_u32 v12, s49, v12
    s_mov_b32 s12, 0x0c0c0400
    s_mov_b32 s13, 0x05040100
    s_mov_b32 s43, 0
    s_waitcnt vmcnt(1)
L_conv_y:
    v_perm_b32 v13, v17, v16, s12
    v_perm_b32 v14, v19, v18, s12
    v_perm_b32 v32, v14, v13, s13
    v_perm_b32 v13, v21, v20, s12
    v_perm_b32 v14, v23, v22, s12
    v_perm_b32 v33, v14, v13, s13
    v_xor_b32 v32, s52, v32
    v_bitop3_b32 v32, v32, v33, s52 bitop3:0xf6
    v_cmp_ne_u32 vcc, 0, v32
    s_cbranch_vccz L_conv_yok
    s_add_u32 s43, s43, 1
    s_cmp_ge_u32 s43, 65536
    s_cbranch_scc1 L_conv_yok
    s_mov_b64 exec, vcc
    buffer_load_dwordx4 v[16:19], v9, s[36:39], 0 offen offset:0 sc1
    buffer_load_dwordx4 v[20:23], v9, s[36:39], 0 offen offset:1024 sc1
    s_mov_b64 exec, -1
    s_waitcnt vmcnt(0)
    s_branch L_conv_y
L_conv_yok:
    v_pk_add_f32 v[16:17], v[16:17], v[20:21]
    v_pk_add_f32 v[18:19], v[18:19], v[22:23]
    v_mov_b32 v20, v16
    v_mov_b32 v21, v17
    v_mov_b32 v22, v18
    v_mov_b32 v23, v19
    v_permlane16_swap_b32 v16, v20
    v_permlane16_swap_b32 v17, v21
    v_permlane16_swap_b32 v18, v22
    v_permlane16_swap_b32 v19, v23
    v_pk_add_f32 v[16:17], v[16:17], v[20:21]
    v_pk_add_f32 v[18:19], v[18:19], v[22:23]
    v_mov_b32 v20, v16
    v_mov_b32 v21, v17
    v_mov_b32 v22, v18
    v_mov_b32 v23, v19
    v_permlane32_swap_b32 v16, v20
    v_permlane32_swap_b32 v17, v21
    v_permlane32_swap_b32 v18, v22
    v_permlane32_swap_b32 v19, v23
    v_pk_add_f32 v[16:17], v[16:17], v[20:21]
    v_pk_add_f32 v[18:19], v[18:19], v[22:23]
    s_waitcnt lgkmcnt(0)
    v_lshlrev_b32 v36, 16, v36
    v_lshlrev_b32 v37, 16, v37
    v_lshlrev_b32 v38, 16, v38
    v_lshlrev_b32 v39, 16, v39
    v_lshlrev_b32 v48, 16, v44
    v_and_b32 v49, 0xffff0000, v44
    v_lshlrev_b32 v50, 16, v45
    v_and_b32 v51, 0xffff0000, v45
    v_pk_add_f32 v[36:37], v[36:37], v[48:49]
    v_pk_add_f32 v[38:39], v[38:39], v[50:51]
    v_fma_f32 v16, v16, v109, v36
    v_fma_f32 v17, v17, v109, v37
    v_fma_f32 v18, v18, v109, v38
    v_fma_f32 v19, v19, v109, v39
    v_cvt_pk_bf16_f32 v16, v16, v17
    v_cvt_pk_bf16_f32 v17, v18, v19
    s_barrier
    s_mov_b64 exec, 0xffff
    buffer_store_dwordx2 v[16:17], v12, s[32:35], 0 offen
L_conv_end:
    s_endpgm
L_code_end:
.section .rodata,"a"
.p2align 6
.amdhsa_kernel parallel_sum__ssm_conv_s4d__moe_arch_mod__prompt_kernel
  .amdhsa_next_free_vgpr 256
  .amdhsa_next_free_sgpr 96
  .amdhsa_accum_offset 256
  .amdhsa_group_segment_fixed_size 0
  .amdhsa_kernarg_size 120
  .amdhsa_user_sgpr_count 2
  .amdhsa_user_sgpr_kernarg_segment_ptr 1
  .amdhsa_system_sgpr_workgroup_id_x 1
.end_amdhsa_kernel
```

```asm
; @launch grid=(256,1,1) block=(512,1,1) lds=161856
.amdgcn_target "amdgcn-amd-amdhsa--gfx950"
.text
.globl parallel_sum__ssm_conv_s4d__moe_arch_mod__prompt_kernel
.p2align 8
.type parallel_sum__ssm_conv_s4d__moe_arch_mod__prompt_kernel,@function
parallel_sum__ssm_conv_s4d__moe_arch_mod__prompt_kernel:
    s_cmp_ge_u32 s2, 256
    s_cbranch_scc1 L_exit
    s_bfe_u32 s3, s2, 0x40003
    v_readfirstlane_b32 s4, v0
    s_cmp_ge_u32 s3, 2
    s_cbranch_scc1 L_nocp
    s_cmp_lt_u32 s4, 448
    s_cbranch_scc1 L_nocp
    v_and_b32 v1, 63, v0
    s_getpc_b64 s[4:5]
L_pc_all:
    s_add_u32 s4, s4, L_auxk-L_pc_all
    s_addc_u32 s5, s5, 0
    s_mov_b32 s6, L_code_end-L_auxk
    s_mov_b32 s7, 0x00020000
    v_lshlrev_b32 v172, 7, v1
    buffer_load_dword v173, v172, s[4:7], 0 offen
    v_add_u32 v172, 8192, v172
    buffer_load_dword v173, v172, s[4:7], 0 offen
    v_add_u32 v172, 8192, v172
    buffer_load_dword v173, v172, s[4:7], 0 offen
L_nocp:
    s_bitcmp1_b32 s2, 7
    s_cbranch_scc0 L_auxk
    s_load_dwordx2 s[8:9], s[0:1], 8
    s_load_dwordx2 s[12:13], s[0:1], 16
    s_load_dwordx2 s[16:17], s[0:1], 24
    s_load_dwordx2 s[20:21], s[0:1], 32
    s_load_dwordx2 s[24:25], s[0:1], 40
    s_load_dwordx2 s[28:29], s[0:1], 48
    s_load_dwordx2 s[4:5], s[0:1], 0
    s_load_dwordx2 s[32:33], s[0:1], 96
    s_load_dwordx2 s[36:37], s[0:1], 112
    s_branch L_conv
L_auxk:
    s_load_dwordx2 s[4:5], s[0:1], 0
    s_load_dwordx2 s[8:9], s[0:1], 64
    s_load_dwordx2 s[12:13], s[0:1], 112
    s_load_dwordx2 s[16:17], s[0:1], 72
    s_load_dwordx2 s[20:21], s[0:1], 80
    s_load_dwordx2 s[24:25], s[0:1], 88
L_aux_code:
    s_and_b32 s50, s2, 7
    s_lshl_b32 s30, s50, 4
    s_add_u32 s30, s30, s3
    s_and_b32 s44, s3, 1
    s_cmp_ge_u32 s3, 3
    s_addc_u32 s38, s3, 0
    s_cmp_ge_u32 s3, 10
    s_addc_u32 s38, s38, 0
    s_cmp_eq_u32 s3, 14
    s_cselect_b32 s38, 3, s38
    s_cmp_eq_u32 s3, 15
    s_cselect_b32 s38, 11, s38
    v_and_b32 v1, 63, v0
    v_and_b32 v2, 15, v0
    v_bfe_u32 v3, v0, 4, 2
    v_lshrrev_b32 v29, 6, v0
    s_nop 0
    v_readfirstlane_b32 s31, v29
    v_lshlrev_b32 v28, 4, v1
    s_lshl_b32 s32, s30, 15
    v_lshlrev_b32 v30, 13, v29
    v_add3_u32 v30, v30, v28, s32
    v_mov_b32 v22, 148624
    v_mov_b32 v23, 1
    s_cmp_ge_u32 s31, 4
    s_cbranch_scc1 L_aux_sinit
    s_setprio 2
    s_mov_b32 s33, 4096
    s_waitcnt lgkmcnt(0)
    s_load_dword s28, s[12:13], 0
    s_mov_b32 s6, 4194304
    s_mov_b32 s7, 0x00020000
    s_mov_b32 s10, 2048
    s_mov_b32 s11, 0x00020000
    buffer_load_dwordx4 v[32:35], v30, s[4:7], 0 offen offset:0
    buffer_load_dwordx4 v[36:39], v30, s[4:7], 0 offen offset:1024
    buffer_load_dwordx4 v[40:43], v30, s[4:7], 0 offen offset:2048
    buffer_load_dwordx4 v[44:47], v30, s[4:7], 0 offen offset:3072
    buffer_load_dwordx4 v[48:51], v30, s[4:7], s33 offen offset:0
    buffer_load_dwordx4 v[52:55], v30, s[4:7], s33 offen offset:1024
    buffer_load_dwordx4 v[56:59], v30, s[4:7], s33 offen offset:2048
    buffer_load_dwordx4 v[60:63], v30, s[4:7], s33 offen offset:3072
    buffer_load_dwordx4 v[64:67], v28, s[8:11], 0 offen offset:0
    buffer_load_dwordx4 v[68:71], v28, s[8:11], 0 offen offset:1024
    s_mov_b32 s14, 753664
    s_mov_b32 s15, 0x00020000
    s_mov_b32 s26, 7340032
    s_mov_b32 s27, 0x00020000
    s_barrier
    v_lshlrev_b32 v12, 4, v0
    v_add_u32 v12, 4096, v12
    v_lshlrev_b32 v13, 3, v0
    v_sub_u32 v13, 0x800, v13
    v_subrev_u32 v88, 0, v13
    v_subrev_u32 v89, 1, v13
    v_subrev_u32 v90, 2, v13
    v_subrev_u32 v91, 3, v13
    v_subrev_u32 v92, 4, v13
    v_subrev_u32 v93, 5, v13
    v_subrev_u32 v94, 6, v13
    v_subrev_u32 v95, 7, v13
    s_mov_b32 s40, 4096
    s_mov_b32 s41, 8192
    s_mov_b32 s42, 12288
    s_mov_b32 s45, 0xffff0000
    v_lshrrev_b32 v24, 4, v0
    v_lshl_add_u32 v24, v24, 2, v22
    v_lshl_add_u32 v25, v2, 2, v22
    v_and_b32 v26, 31, v1
    v_lshl_add_u32 v26, v26, 2, v22
    v_lshrrev_b32 v27, 5, v1
    v_lshl_add_u32 v27, v27, 6, v22
    s_lshl_b32 s47, s31, 5
    s_add_u32 s47, s47, 148688
    v_lshl_add_u32 v31, v1, 2, s47
    s_lshl_b32 s32, s30, 5
    s_add_u32 s32, s32, 4096
    v_bfe_u32 v11, v1, 1, 2
    v_lshlrev_b32 v11, 12, v11
    v_and_b32 v10, 1, v1
    v_lshl_add_u32 v11, v10, 4, v11
    v_add_u32 v11, s32, v11
    s_and_b32 s32, s31, 1
    s_lshl_b32 s32, s32, 6
    s_lshr_b32 s33, s31, 1
    s_lshl_b32 s33, s33, 4
    s_add_u32 s32, s32, s33
    s_add_u32 s32, s32, 148944
    v_lshlrev_b32 v10, 5, v3
    v_add_u32 v10, s32, v10
    v_lshl_add_u32 v9, v1, 4, v22
    s_mov_b32 s33, 0x3f803f80
    s_waitcnt vmcnt(2)
    v_dot2_f32_bf16 v72, s33, v32, 0
    v_dot2_f32_bf16 v76, v32, v32, 0
    v_dot2_f32_bf16 v73, s33, v40, 0
    v_dot2_f32_bf16 v77, v40, v40, 0
    v_dot2_f32_bf16 v74, s33, v48, 0
    v_dot2_f32_bf16 v78, v48, v48, 0
    v_dot2_f32_bf16 v75, s33, v56, 0
    v_dot2_f32_bf16 v79, v56, v56, 0
    v_dot2c_f32_bf16 v72, s33, v33
    v_dot2c_f32_bf16 v76, v33, v33
    v_dot2c_f32_bf16 v73, s33, v41
    v_dot2c_f32_bf16 v77, v41, v41
    v_dot2c_f32_bf16 v74, s33, v49
    v_dot2c_f32_bf16 v78, v49, v49
    v_dot2c_f32_bf16 v75, s33, v57
    v_dot2c_f32_bf16 v79, v57, v57
    v_dot2c_f32_bf16 v72, s33, v34
    v_dot2c_f32_bf16 v76, v34, v34
    v_dot2c_f32_bf16 v73, s33, v42
    v_dot2c_f32_bf16 v77, v42, v42
    v_dot2c_f32_bf16 v74, s33, v50
    v_dot2c_f32_bf16 v78, v50, v50
    v_dot2c_f32_bf16 v75, s33, v58
    v_dot2c_f32_bf16 v79, v58, v58
    v_dot2c_f32_bf16 v72, s33, v35
    v_dot2c_f32_bf16 v76, v35, v35
    v_dot2c_f32_bf16 v73, s33, v43
    v_dot2c_f32_bf16 v77, v43, v43
    v_dot2c_f32_bf16 v74, s33, v51
    v_dot2c_f32_bf16 v78, v51, v51
    v_dot2c_f32_bf16 v75, s33, v59
    v_dot2c_f32_bf16 v79, v59, v59
    v_dot2c_f32_bf16 v72, s33, v36
    v_dot2c_f32_bf16 v76, v36, v36
    v_dot2c_f32_bf16 v73, s33, v44
    v_dot2c_f32_bf16 v77, v44, v44
    v_dot2c_f32_bf16 v74, s33, v52
    v_dot2c_f32_bf16 v78, v52, v52
    v_dot2c_f32_bf16 v75, s33, v60
    v_dot2c_f32_bf16 v79, v60, v60
    v_dot2c_f32_bf16 v72, s33, v37
    v_dot2c_f32_bf16 v76, v37, v37
    v_dot2c_f32_bf16 v73, s33, v45
    v_dot2c_f32_bf16 v77, v45, v45
    v_dot2c_f32_bf16 v74, s33, v53
    v_dot2c_f32_bf16 v78, v53, v53
    v_dot2c_f32_bf16 v75, s33, v61
    v_dot2c_f32_bf16 v79, v61, v61
    v_dot2c_f32_bf16 v72, s33, v38
    v_dot2c_f32_bf16 v76, v38, v38
    v_dot2c_f32_bf16 v73, s33, v46
    v_dot2c_f32_bf16 v77, v46, v46
    v_dot2c_f32_bf16 v74, s33, v54
    v_dot2c_f32_bf16 v78, v54, v54
    v_dot2c_f32_bf16 v75, s33, v62
    v_dot2c_f32_bf16 v79, v62, v62
    v_dot2c_f32_bf16 v72, s33, v39
    v_dot2c_f32_bf16 v76, v39, v39
    v_dot2c_f32_bf16 v73, s33, v47
    v_dot2c_f32_bf16 v77, v47, v47
    v_dot2c_f32_bf16 v74, s33, v55
    v_dot2c_f32_bf16 v78, v55, v55
    v_dot2c_f32_bf16 v75, s33, v63
    v_dot2c_f32_bf16 v79, v63, v63
    s_waitcnt vmcnt(0)
    v_dot2_f32_bf16 v80, v64, v32, 0
    v_dot2_f32_bf16 v81, v64, v40, 0
    v_dot2_f32_bf16 v82, v64, v48, 0
    v_dot2_f32_bf16 v83, v64, v56, 0
    v_dot2_f32_bf16 v84, s33, v64, 0
    v_dot2c_f32_bf16 v80, v65, v33
    v_dot2c_f32_bf16 v81, v65, v41
    v_dot2c_f32_bf16 v82, v65, v49
    v_dot2c_f32_bf16 v83, v65, v57
    v_dot2c_f32_bf16 v84, s33, v65
    v_dot2c_f32_bf16 v80, v66, v34
    v_dot2c_f32_bf16 v81, v66, v42
    v_dot2c_f32_bf16 v82, v66, v50
    v_dot2c_f32_bf16 v83, v66, v58
    v_dot2c_f32_bf16 v84, s33, v66
    v_dot2c_f32_bf16 v80, v67, v35
    v_dot2c_f32_bf16 v81, v67, v43
    v_dot2c_f32_bf16 v82, v67, v51
    v_dot2c_f32_bf16 v83, v67, v59
    v_dot2c_f32_bf16 v84, s33, v67
    v_dot2c_f32_bf16 v80, v68, v36
    v_dot2c_f32_bf16 v81, v68, v44
    v_dot2c_f32_bf16 v82, v68, v52
    v_dot2c_f32_bf16 v83, v68, v60
    v_dot2c_f32_bf16 v84, s33, v68
    v_dot2c_f32_bf16 v80, v69, v37
    v_dot2c_f32_bf16 v81, v69, v45
    v_dot2c_f32_bf16 v82, v69, v53
    v_dot2c_f32_bf16 v83, v69, v61
    v_dot2c_f32_bf16 v84, s33, v69
    v_dot2c_f32_bf16 v80, v70, v38
    v_dot2c_f32_bf16 v81, v70, v46
    v_dot2c_f32_bf16 v82, v70, v54
    v_dot2c_f32_bf16 v83, v70, v62
    v_dot2c_f32_bf16 v84, s33, v70
    v_dot2c_f32_bf16 v80, v71, v39
    v_dot2c_f32_bf16 v81, v71, v47
    v_dot2c_f32_bf16 v82, v71, v55
    v_dot2c_f32_bf16 v83, v71, v63
    v_dot2c_f32_bf16 v84, s33, v71
    s_nop 2
    v_mov_b32 v85, v84
    v_permlane32_swap_b32 v72, v73
    v_permlane32_swap_b32 v74, v75
    v_permlane32_swap_b32 v76, v77
    v_permlane32_swap_b32 v78, v79
    v_permlane32_swap_b32 v80, v81
    v_permlane32_swap_b32 v82, v83
    v_permlane32_swap_b32 v84, v85
    v_add_f32 v72, v72, v73
    v_add_f32 v74, v74, v75
    v_add_f32 v76, v76, v77
    v_add_f32 v78, v78, v79
    v_add_f32 v80, v80, v81
    v_add_f32 v82, v82, v83
    v_add_f32 v84, v84, v85
    v_mov_b32 v86, v84
    v_permlane16_swap_b32 v72, v74
    v_permlane16_swap_b32 v76, v78
    v_permlane16_swap_b32 v80, v82
    v_permlane16_swap_b32 v84, v86
    v_add_f32 v72, v72, v74
    v_add_f32 v76, v76, v78
    v_add_f32 v80, v80, v82
    v_add_f32 v84, v84, v86
    v_add_f32_dpp v72, v72, v72 row_ror:8 row_mask:0xf bank_mask:0xf
    v_add_f32_dpp v76, v76, v76 row_ror:8 row_mask:0xf bank_mask:0xf
    v_add_f32_dpp v80, v80, v80 row_ror:8 row_mask:0xf bank_mask:0xf
    v_add_f32_dpp v84, v84, v84 row_ror:8 row_mask:0xf bank_mask:0xf
    v_add_f32_dpp v72, v72, v72 row_ror:4 row_mask:0xf bank_mask:0xf
    v_add_f32_dpp v76, v76, v76 row_ror:4 row_mask:0xf bank_mask:0xf
    v_add_f32_dpp v80, v80, v80 row_ror:4 row_mask:0xf bank_mask:0xf
    v_add_f32_dpp v84, v84, v84 row_ror:4 row_mask:0xf bank_mask:0xf
    v_add_f32_dpp v72, v72, v72 row_ror:2 row_mask:0xf bank_mask:0xf
    v_add_f32_dpp v76, v76, v76 row_ror:2 row_mask:0xf bank_mask:0xf
    v_add_f32_dpp v80, v80, v80 row_ror:2 row_mask:0xf bank_mask:0xf
    v_add_f32_dpp v84, v84, v84 row_ror:2 row_mask:0xf bank_mask:0xf
    v_add_f32_dpp v72, v72, v72 row_ror:1 row_mask:0xf bank_mask:0xf
    v_add_f32_dpp v76, v76, v76 row_ror:1 row_mask:0xf bank_mask:0xf
    v_add_f32_dpp v80, v80, v80 row_ror:1 row_mask:0xf bank_mask:0xf
    v_add_f32_dpp v84, v84, v84 row_ror:1 row_mask:0xf bank_mask:0xf
    v_mul_f32 v42, 0x3a800000, v72
    v_mul_f32 v43, 0x3a800000, v76
    v_fma_f32 v43, -v42, v42, v43
    v_max_f32 v43, 0, v43
    v_cvt_pk_bf16_f32 v42, v42, v43
    v_and_b32 v43, 0xffff0000, v42
    v_lshlrev_b32 v45, 16, v42
    v_add_f32 v43, 0x3727c5ac, v43
    v_cvt_pk_bf16_f32 v43, v43, v43
    v_and_b32 v43, 0xffff0000, v43
    v_sqrt_f32 v43, v43
    v_fma_f32 v44, -v45, v84, v80
    v_cvt_pk_bf16_f32 v60, v45, v43
    v_and_b32 v43, 0xffff0000, v60
    v_rcp_f32 v46, v43
    v_mov_b32 v61, v60
    s_waitcnt lgkmcnt(0)
    s_mul_i32 s29, s28, 0x9e3779b1
    s_add_u32 s29, s29, 0x7f4a7c15
    v_mul_f32 v44, v44, v46
    v_cvt_pk_bf16_f32 v64, v44, v44
    v_ashrrev_i32 v65, 31, v64
    v_or_b32 v65, 0x80000000, v65
    v_xor_b32 v64, v64, v65
    v_permlane32_swap_b32 v60, v61
    v_lshrrev_b32 v64, 16, v64
    v_mov_b32 v63, s29
    v_mov_b32 v65, v64
    s_nop 1
    v_permlane32_swap_b32 v64, v65
    v_lshl_or_b32 v62, v65, 16, v64
    s_mov_b64 exec, 0x10001
    ds_write_b128 v10, v[60:63]
    s_mov_b64 exec, 1
    ds_add_rtn_u32 v13, v22, v23 offset:264
    s_mov_b64 exec, 0xff
    ds_read_b128 v[60:63], v9 offset:320
    s_waitcnt lgkmcnt(0)
    v_readfirstlane_b32 s32, v13
    s_cmp_lg_u32 s32, 3
    s_cbranch_scc1 L_aux_nopub
    buffer_store_dwordx4 v[60:63], v11, s[12:15], 0 offen sc1
    v_mov_b32 v13, 4
    ds_write_b32 v22, v13 offset:260
L_aux_nopub:
    s_mov_b64 exec, -1
    v_and_b32 v242, 7, v1
    v_lshlrev_b32 v243, 2, v242
    v_add_u32 v243, 148816, v243
    v_bfe_u32 v241, v1, 3, 2
    v_mul_u32_u24 v241, 32784, v241
    v_lshrrev_b32 v240, 5, v1
    v_lshl_add_u32 v241, v240, 12, v241
    s_lshr_b32 s48, s31, 2
    s_lshl_b32 s48, s48, 10
    s_and_b32 s49, s31, 3
    s_lshl_b32 s49, s49, 4
    s_add_u32 s48, s48, s49
    s_add_u32 s48, s48, 24512
    v_add_u32 v241, s48, v241
    s_lshr_b32 s49, s3, 1
    s_cmp_eq_u32 s49, 6
    s_movk_i32 s48, 2048
    s_cselect_b32 s49, s48, 16384
    v_mul_u32_u24 v244, s49, v240
    v_lshl_add_u32 v244, v242, 4, v244
    v_bfe_u32 v240, v1, 3, 1
    v_lshl_add_u32 v244, v240, 10, v244
    s_mul_i32 s88, s50, 57344
    s_add_u32 s88, s88, 32768
    s_mul_i32 s48, s44, 28672
    s_lshr_b32 s49, s3, 1
    s_lshl_b32 s49, s49, 11
    s_add_u32 s48, s48, s49
    s_lshl_b32 s49, s31, 7
    s_add_u32 s48, s48, s49
    s_add_u32 s48, s48, s88
    v_add_u32 v244, s48, v244
    v_lshl_add_u32 v242, v242, 6, v241
    s_bfe_u32 s84, s29, 0x80000
    s_bfe_u32 s85, s29, 0x80008
    s_bfe_u32 s86, s29, 0x80010
    s_bfe_u32 s87, s29, 0x80018
    v_mov_b32 v245, 0xffffff00
    v_cmp_eq_u32 s[90:91], 1, v240
    s_lshl_b32 s39, s50, 7
    s_add_u32 s39, s39, 24576
    s_cmp_lg_u32 s3, 14
    s_cbranch_scc1 L_aux_cons
    v_lshlrev_b32 v9, 5, v0
    s_sleep 12
    buffer_load_dwordx4 v[64:67], v12, s[12:15], 0 offen sc1
    buffer_load_dwordx4 v[68:71], v12, s[12:15], s40 offen sc1
    buffer_load_dwordx4 v[72:75], v12, s[12:15], s41 offen sc1
    buffer_load_dwordx4 v[76:79], v12, s[12:15], s42 offen sc1
    s_mov_b32 s43, 0
L_poll_aux:
    s_waitcnt vmcnt(0)
    v_cmp_ne_u32 s[52:53], s29, v67
    v_cmp_ne_u32 s[54:55], s29, v71
    v_cmp_ne_u32 s[56:57], s29, v75
    v_cmp_ne_u32 s[58:59], s29, v79
    s_or_b64 vcc, s[52:53], s[54:55]
    s_or_b64 vcc, vcc, s[56:57]
    s_or_b64 vcc, vcc, s[58:59]
    s_cbranch_scc0 L_polled_aux
    s_add_u32 s43, s43, 1
    s_cmp_ge_u32 s43, 65536
    s_cbranch_scc1 L_polled_aux
    s_sleep 2
    s_mov_b64 exec, s[52:53]
    s_cbranch_execz L_ps_aux_0
    buffer_load_dwordx4 v[64:67], v12, s[12:15], 0 offen sc1
L_ps_aux_0:
    s_mov_b64 exec, s[54:55]
    s_cbranch_execz L_ps_aux_1
    buffer_load_dwordx4 v[68:71], v12, s[12:15], s40 offen sc1
L_ps_aux_1:
    s_mov_b64 exec, s[56:57]
    s_cbranch_execz L_ps_aux_2
    buffer_load_dwordx4 v[72:75], v12, s[12:15], s41 offen sc1
L_ps_aux_2:
    s_mov_b64 exec, s[58:59]
    s_cbranch_execz L_ps_aux_3
    buffer_load_dwordx4 v[76:79], v12, s[12:15], s42 offen sc1
L_ps_aux_3:
    s_mov_b64 exec, -1
    s_branch L_poll_aux
L_polled_aux:
    ds_write_b64 v9, v[64:65] offset:0
    ds_write_b64 v9, v[68:69] offset:8
    ds_write_b64 v9, v[72:73] offset:16
    ds_write_b64 v9, v[76:77] offset:24
    v_lshl_or_b32 v80, v66, 16, v88
    v_and_or_b32 v81, v66, s45, v89
    v_lshl_or_b32 v82, v70, 16, v90
    v_and_or_b32 v83, v70, s45, v91
    v_lshl_or_b32 v84, v74, 16, v92
    v_and_or_b32 v85, v74, s45, v93
    v_lshl_or_b32 v86, v78, 16, v94
    v_and_or_b32 v87, v78, s45, v95
    v_max3_u32 v17, v80, v81, v82
    v_max3_u32 v18, v83, v84, v85
    v_max3_u32 v17, v17, v86, v87
    v_max_u32 v17, v17, v18
    v_max_u32 v14, v80, v81
    v_min_u32 v15, v80, v81
    v_max_u32_dpp v17, v17, v17 row_ror:8 row_mask:0xf bank_mask:0xf
    v_mov_b32 v16, 0
    v_med3_u32 v16, v15, v16, v82
    v_max_u32_dpp v17, v17, v17 row_ror:4 row_mask:0xf bank_mask:0xf
    v_med3_u32 v15, v14, v15, v82
    v_max_u32 v14, v14, v82
    v_max_u32_dpp v17, v17, v17 row_ror:2 row_mask:0xf bank_mask:0xf
    v_med3_u32 v16, v15, v16, v83
    v_med3_u32 v15, v14, v15, v83
    v_max_u32_dpp v17, v17, v17 row_ror:1 row_mask:0xf bank_mask:0xf
    ds_write_b32 v24, v17
    ds_read_b32 v17, v25
    v_max_u32 v14, v14, v83
    v_med3_u32 v16, v15, v16, v84
    v_med3_u32 v15, v14, v15, v84
    v_max_u32 v14, v14, v84
    v_med3_u32 v16, v15, v16, v85
    v_med3_u32 v15, v14, v15, v85
    v_max_u32 v14, v14, v85
    v_med3_u32 v16, v15, v16, v86
    v_med3_u32 v15, v14, v15, v86
    v_max_u32 v14, v14, v86
    v_med3_u32 v16, v15, v16, v87
    v_med3_u32 v15, v14, v15, v87
    v_max_u32 v14, v14, v87
    v_mov_b32 v19, 0
    s_mov_b32 s43, 0
L_aux_gm:
    s_waitcnt lgkmcnt(0)
    v_cmp_eq_u32 vcc, 0, v17
    s_cbranch_vccz L_aux_gmok
    ds_read_b32 v17, v25
    s_add_u32 s43, s43, 1
    s_cmp_ge_u32 s43, 524288
    s_cbranch_scc1 L_aux_gmok
    s_branch L_aux_gm
L_aux_gmok:
    s_waitcnt lgkmcnt(0)
    v_sub_co_u32_dpp v20, vcc, v17, v17 row_ror:1 row_mask:0xf bank_mask:0xf
    v_addc_co_u32 v19, vcc, 0, v19, vcc
    v_sub_co_u32_dpp v20, vcc, v17, v17 row_ror:2 row_mask:0xf bank_mask:0xf
    v_addc_co_u32 v19, vcc, 0, v19, vcc
    v_sub_co_u32_dpp v20, vcc, v17, v17 row_ror:3 row_mask:0xf bank_mask:0xf
    v_addc_co_u32 v19, vcc, 0, v19, vcc
    v_sub_co_u32_dpp v20, vcc, v17, v17 row_ror:4 row_mask:0xf bank_mask:0xf
    v_addc_co_u32 v19, vcc, 0, v19, vcc
    v_sub_co_u32_dpp v20, vcc, v17, v17 row_ror:5 row_mask:0xf bank_mask:0xf
    v_addc_co_u32 v19, vcc, 0, v19, vcc
    v_sub_co_u32_dpp v20, vcc, v17, v17 row_ror:6 row_mask:0xf bank_mask:0xf
    v_addc_co_u32 v19, vcc, 0, v19, vcc
    v_sub_co_u32_dpp v20, vcc, v17, v17 row_ror:7 row_mask:0xf bank_mask:0xf
    v_addc_co_u32 v19, vcc, 0, v19, vcc
    v_sub_co_u32_dpp v20, vcc, v17, v17 row_ror:8 row_mask:0xf bank_mask:0xf
    v_addc_co_u32 v19, vcc, 0, v19, vcc
    v_sub_co_u32_dpp v20, vcc, v17, v17 row_ror:9 row_mask:0xf bank_mask:0xf
    v_addc_co_u32 v19, vcc, 0, v19, vcc
    v_sub_co_u32_dpp v20, vcc, v17, v17 row_ror:10 row_mask:0xf bank_mask:0xf
    v_addc_co_u32 v19, vcc, 0, v19, vcc
    v_sub_co_u32_dpp v20, vcc, v17, v17 row_ror:11 row_mask:0xf bank_mask:0xf
    v_addc_co_u32 v19, vcc, 0, v19, vcc
    v_sub_co_u32_dpp v20, vcc, v17, v17 row_ror:12 row_mask:0xf bank_mask:0xf
    v_addc_co_u32 v19, vcc, 0, v19, vcc
    v_sub_co_u32_dpp v20, vcc, v17, v17 row_ror:13 row_mask:0xf bank_mask:0xf
    v_addc_co_u32 v19, vcc, 0, v19, vcc
    v_sub_co_u32_dpp v20, vcc, v17, v17 row_ror:14 row_mask:0xf bank_mask:0xf
    v_addc_co_u32 v19, vcc, 0, v19, vcc
    v_sub_co_u32_dpp v20, vcc, v17, v17 row_ror:15 row_mask:0xf bank_mask:0xf
    v_addc_co_u32 v19, vcc, 0, v19, vcc
    v_cmp_eq_u32 vcc, 8, v19
    s_ff1_i32_b64 s46, vcc
    v_readlane_b32 s46, v17, s46
    v_mov_b32 v18, 1
    s_nop 0
    v_cmp_le_u32 s[48:49], s46, v14
    v_cmp_le_u32 s[52:53], s46, v15
    v_cmp_le_u32 s[54:55], s46, v16
    s_bcnt1_i32_b64 s46, s[48:49]
    s_bcnt1_i32_b64 s56, s[52:53]
    v_mbcnt_lo_u32_b32 v20, s48, 0
    v_mbcnt_lo_u32_b32 v21, s52, 0
    v_mbcnt_hi_u32_b32 v20, s49, v20
    v_mbcnt_hi_u32_b32 v21, s53, v21
    s_add_u32 s56, s56, s46
    s_lshl_b32 s46, s46, 2
    s_add_u32 s46, s46, s47
    v_lshl_add_u32 v20, v20, 2, s47
    v_lshl_add_u32 v21, v21, 2, s46
    s_cmp_lg_u64 s[54:55], 0
    s_cselect_b32 s56, 9, s56
    s_cmp_gt_u32 s56, 8
    s_cbranch_scc0 L_aux_fit
    s_mov_b64 s[48:49], 0
    s_mov_b64 s[52:53], 0
    s_mov_b32 s56, 0
    v_mov_b32 v18, 2
L_aux_fit:
    s_lshl_b32 s56, 0xff, s56
    s_and_b32 s56, s56, 0xff
    s_mov_b32 s57, 0
    s_mov_b64 exec, s[48:49]
    ds_write_b32 v20, v14
    s_mov_b64 exec, s[52:53]
    ds_write_b32 v21, v15
    s_mov_b64 exec, s[56:57]
    ds_write_b32 v31, v18
    s_mov_b64 exec, -1
    s_mov_b32 s43, 0
    v_mov_b32 v20, 0
L_aux_ls:
    ds_read_b32 v17, v26 offset:64
    ds_read_b128 v[64:67], v27 offset:64
    ds_read_b128 v[68:71], v27 offset:80
    ds_read_b128 v[72:75], v27 offset:96
    ds_read_b128 v[76:79], v27 offset:112
    s_waitcnt lgkmcnt(4)
    v_cmp_eq_u32 vcc, 0, v17
    s_cbranch_vccz L_aux_lsok
    s_waitcnt lgkmcnt(0)
    s_add_u32 s43, s43, 1
    s_cmp_ge_u32 s43, 524288
    s_cbranch_scc1 L_aux_lsok
    s_branch L_aux_ls
L_aux_lsok:
    v_cmp_eq_u32 vcc, 2, v17
    s_cbranch_vccnz L_aux_slow
    s_cmp_ge_u32 s31, 2
    s_cbranch_scc1 L_aux_wd
    s_waitcnt lgkmcnt(3)
    v_cmp_gt_u32 vcc, v64, v17
    v_addc_co_u32 v20, vcc, 0, v20, vcc
    v_cmp_gt_u32 vcc, v65, v17
    v_addc_co_u32 v20, vcc, 0, v20, vcc
    v_cmp_gt_u32 vcc, v66, v17
    v_addc_co_u32 v20, vcc, 0, v20, vcc
    v_cmp_gt_u32 vcc, v67, v17
    v_addc_co_u32 v20, vcc, 0, v20, vcc
    s_waitcnt lgkmcnt(2)
    v_cmp_gt_u32 vcc, v68, v17
    v_addc_co_u32 v20, vcc, 0, v20, vcc
    v_cmp_gt_u32 vcc, v69, v17
    v_addc_co_u32 v20, vcc, 0, v20, vcc
    v_cmp_gt_u32 vcc, v70, v17
    v_addc_co_u32 v20, vcc, 0, v20, vcc
    v_cmp_gt_u32 vcc, v71, v17
    v_addc_co_u32 v20, vcc, 0, v20, vcc
    s_waitcnt lgkmcnt(1)
    v_cmp_gt_u32 vcc, v72, v17
    v_addc_co_u32 v20, vcc, 0, v20, vcc
    v_cmp_gt_u32 vcc, v73, v17
    v_addc_co_u32 v20, vcc, 0, v20, vcc
    v_cmp_gt_u32 vcc, v74, v17
    v_addc_co_u32 v20, vcc, 0, v20, vcc
    v_cmp_gt_u32 vcc, v75, v17
    v_addc_co_u32 v20, vcc, 0, v20, vcc
    s_waitcnt lgkmcnt(0)
    v_cmp_gt_u32 vcc, v76, v17
    v_addc_co_u32 v20, vcc, 0, v20, vcc
    v_cmp_gt_u32 vcc, v77, v17
    v_addc_co_u32 v20, vcc, 0, v20, vcc
    v_cmp_gt_u32 vcc, v78, v17
    v_addc_co_u32 v20, vcc, 0, v20, vcc
    v_cmp_gt_u32 vcc, v79, v17
    v_addc_co_u32 v20, vcc, 0, v20, vcc
    v_mov_b32 v21, v20
    s_nop 1
    v_permlane32_swap_b32 v20, v21
    v_add_u32 v20, v20, v21
L_aux_sel:
    v_and_b32 v60, 0xfff, v17
    v_sub_u32 v60, 0x800, v60
    v_cmp_gt_u32 vcc, 8, v20
    s_mov_b32 vcc_hi, 0
    s_cmp_eq_u32 s31, 1
    s_cbranch_scc1 L_aux_pf
    v_lshlrev_b32 v15, 2, v60
    v_min_u32 v15, 8188, v15
    ds_read_b32 v62, v15
    v_and_b32 v14, 0xffff0000, v17
    v_ashrrev_i32 v15, 31, v14
    v_not_b32 v15, v15
    v_or_b32 v15, 0x80000000, v15
    v_xor_b32 v14, v14, v15
    v_and_b32 v14, 0xffff0000, v14
    v_mul_f32 v14, 0xbfb8aa3b, v14
    v_exp_f32 v14, v14
    v_mov_b32 v63, s29
    v_add_f32 v14, 1.0, v14
    v_rcp_f32 v14, v14
    v_lshl_add_u32 v21, v20, 4, s39
    v_cvt_pk_bf16_f32 v14, v14, v14
    v_and_b32 v61, 0xffff0000, v14
    s_mov_b64 exec, vcc
    s_waitcnt lgkmcnt(0)
    buffer_store_dwordx4 v[60:63], v21, s[12:15], 0 offen sc1
    s_mov_b64 exec, 1
    ds_add_u32 v22, v23 offset:268
    s_mov_b64 exec, -1
    s_branch L_aux_b4
L_aux_pf:
    v_lshl_add_u32 v21, v20, 2, v22
    s_mov_b64 exec, vcc
    ds_write_b32 v21, v60 offset:224
    s_mov_b64 exec, -1
    v_lshl_add_u32 v21, v3, 2, v22
    ds_read2_b32 v[14:15], v21 offset0:56 offset1:60
    v_lshlrev_b32 v21, 7, v2
    s_waitcnt lgkmcnt(0)
    v_lshl_add_u32 v14, v14, 11, v21
    v_lshl_add_u32 v15, v15, 11, v21
    buffer_load_dword v16, v14, s[4:7], 0 offen
    buffer_load_dword v16, v15, s[4:7], 0 offen
    s_mov_b64 exec, 1
    ds_add_u32 v22, v23 offset:268
    s_mov_b64 exec, -1
    s_waitcnt vmcnt(0)
    s_branch L_aux_b4
L_aux_cons:
    s_cmp_ge_u32 s31, 2
    s_cbranch_scc1 L_aux_wd
    s_cmp_ge_u32 s3, 14
    s_cbranch_scc1 L_aux_nox
    v_and_b32 v14, 7, v1
    v_lshl_add_u32 v21, v14, 4, s39
    v_lshl_add_u32 v15, v14, 2, v22
    s_mul_i32 s46, s31, 4160
    s_add_u32 s46, s46, 131072
    s_lshl_b32 s47, s44, 10
    s_lshl_b32 s49, s31, 2
    s_sleep 70
    s_mov_b64 exec, 0xff
    s_mov_b32 s43, 0
L_aux_sp:
    buffer_load_dwordx4 v[60:63], v21, s[12:15], 0 offen sc1
    s_waitcnt vmcnt(0)
    v_cmp_ne_u32 vcc, s29, v63
    s_cbranch_vccz L_aux_spok
    s_add_u32 s43, s43, 1
    s_cmp_ge_u32 s43, 65536
    s_cbranch_scc1 L_aux_spok
    s_sleep 2
    s_branch L_aux_sp
L_aux_spok:
    ds_write_b32 v15, v62 offset:192
    s_mov_b64 exec, -1
    v_readlane_b32 s52, v60, s49
    s_add_u32 s49, s49, 1
    v_readlane_b32 s53, v60, s49
    s_add_u32 s49, s49, 1
    v_readlane_b32 s54, v60, s49
    s_add_u32 s49, s49, 1
    v_readlane_b32 s55, v60, s49
    s_lshl_b32 s48, s52, 11
    s_add_u32 s48, s48, s47
    s_add_u32 m0, s46, 0
    s_nop 0
    buffer_load_dwordx4 v28, s[4:7], s48 offen lds
    s_lshl_b32 s48, s53, 11
    s_add_u32 s48, s48, s47
    s_add_u32 m0, s46, 1040
    s_nop 0
    buffer_load_dwordx4 v28, s[4:7], s48 offen lds
    s_lshl_b32 s48, s54, 11
    s_add_u32 s48, s48, s47
    s_add_u32 m0, s46, 2080
    s_nop 0
    buffer_load_dwordx4 v28, s[4:7], s48 offen lds
    s_lshl_b32 s48, s55, 11
    s_add_u32 s48, s48, s47
    s_add_u32 m0, s46, 3120
    s_nop 0
    buffer_load_dwordx4 v28, s[4:7], s48 offen lds
    s_mov_b64 exec, 1
    ds_add_u32 v22, v23 offset:268
    s_waitcnt vmcnt(0)
    ds_add_u32 v22, v23 offset:272
    s_mov_b64 exec, -1
    s_branch L_aux_b4
L_aux_nox:
    s_mov_b64 exec, 1
    ds_add_u32 v22, v23 offset:268
    s_mov_b64 exec, -1
    s_branch L_aux_b4
L_aux_wd:
    s_mul_i32 s46, s50, 448
    s_mul_i32 s47, s31, 224
    s_add_u32 s46, s46, s47
    s_sub_u32 s46, s46, 448
    v_lshrrev_b32 v14, 3, v1
    v_add_u32 v14, s46, v14
    v_lshlrev_b32 v14, 11, v14
    v_and_b32 v15, 7, v1
    v_lshl_add_u32 v14, v15, 4, v14
    s_lshl_b32 s46, s38, 7
    v_add_u32 v14, s46, v14
    s_setprio 0
    s_mov_b32 s43, 0
L_lw_wd:
    ds_read_b32 v18, v22 offset:268
    s_add_u32 s43, s43, 1
    s_cmp_ge_u32 s43, 524288
    s_cbranch_scc1 L_lwx_wd
    s_waitcnt lgkmcnt(0)
    v_readfirstlane_b32 s46, v18
    s_cmp_ge_u32 s46, 2
    s_cbranch_scc1 L_lwx_wd
    s_branch L_lw_wd
L_lwx_wd:
    s_waitcnt lgkmcnt(0)
    v_mov_b32 v246, v14
    s_mov_b32 s46, 0
    buffer_load_dwordx4 v[128:131], v14, s[24:27], s46 offen nt
    s_mov_b32 s46, 16384
    buffer_load_dwordx4 v[132:135], v14, s[24:27], s46 offen nt
    s_mov_b32 s46, 32768
    buffer_load_dwordx4 v[136:139], v14, s[24:27], s46 offen nt
    s_mov_b32 s46, 49152
    buffer_load_dwordx4 v[140:143], v14, s[24:27], s46 offen nt
    s_mov_b32 s46, 65536
    buffer_load_dwordx4 v[144:147], v14, s[24:27], s46 offen nt
    s_mov_b32 s46, 81920
    buffer_load_dwordx4 v[148:151], v14, s[24:27], s46 offen nt
    s_mov_b32 s46, 98304
    buffer_load_dwordx4 v[152:155], v14, s[24:27], s46 offen nt
    s_mov_b32 s46, 114688
    buffer_load_dwordx4 v[156:159], v14, s[24:27], s46 offen nt
    s_mov_b32 s46, 131072
    buffer_load_dwordx4 v[160:163], v14, s[24:27], s46 offen nt
    s_mov_b32 s46, 147456
    buffer_load_dwordx4 v[164:167], v14, s[24:27], s46 offen nt
    s_mov_b32 s46, 163840
    buffer_load_dwordx4 v[168:171], v14, s[24:27], s46 offen nt
    s_mov_b32 s46, 180224
    buffer_load_dwordx4 v[172:175], v14, s[24:27], s46 offen nt
    s_mov_b32 s46, 196608
    buffer_load_dwordx4 v[176:179], v14, s[24:27], s46 offen nt
    s_mov_b32 s46, 212992
    buffer_load_dwordx4 v[180:183], v14, s[24:27], s46 offen nt
    s_mov_b32 s46, 229376
    buffer_load_dwordx4 v[184:187], v14, s[24:27], s46 offen nt
    s_mov_b32 s46, 245760
    buffer_load_dwordx4 v[188:191], v14, s[24:27], s46 offen nt
    s_mov_b32 s46, 262144
    buffer_load_dwordx4 v[192:195], v14, s[24:27], s46 offen nt
    s_mov_b32 s46, 278528
    buffer_load_dwordx4 v[196:199], v14, s[24:27], s46 offen nt
    s_mov_b32 s46, 294912
    buffer_load_dwordx4 v[200:203], v14, s[24:27], s46 offen nt
    s_mov_b32 s46, 311296
    buffer_load_dwordx4 v[204:207], v14, s[24:27], s46 offen nt
    s_mov_b32 s46, 327680
    buffer_load_dwordx4 v[208:211], v14, s[24:27], s46 offen nt
    s_mov_b32 s46, 344064
    buffer_load_dwordx4 v[212:215], v14, s[24:27], s46 offen nt
    s_mov_b32 s46, 360448
    buffer_load_dwordx4 v[216:219], v14, s[24:27], s46 offen nt
    s_mov_b32 s46, 376832
    buffer_load_dwordx4 v[220:223], v14, s[24:27], s46 offen nt
    s_mov_b32 s46, 393216
    buffer_load_dwordx4 v[224:227], v14, s[24:27], s46 offen nt
    s_mov_b32 s46, 409600
    buffer_load_dwordx4 v[228:231], v14, s[24:27], s46 offen nt
    s_mov_b32 s46, 425984
    buffer_load_dwordx4 v[232:235], v14, s[24:27], s46 offen nt
    s_mov_b32 s46, 442368
    buffer_load_dwordx4 v[236:239], v14, s[24:27], s46 offen nt
    s_branch L_aux_b4
L_aux_sinit:
    v_mov_b32 v96, 0
    v_mov_b32 v97, 0
    v_lshl_add_u32 v98, v1, 3, v22
    ds_write_b64 v98, v[96:97]
    v_mov_b32 v96, 0x3f803f80
    v_and_b32 v98, 255, v0
    v_lshlrev_b32 v98, 2, v98
    v_add_u32 v98, 139392, v98
    ds_write_b32 v98, v96
    v_bfe_u32 v96, v1, 3, 2
    v_lshrrev_b32 v97, 5, v1
    v_lshl_add_u32 v96, v97, 3, v96
    v_mul_u32_u24 v96, 7168, v96
    v_lshlrev_b32 v98, 1, v3
    v_and_b32 v94, 7, v1
    v_xor_b32 v98, v98, v94
    s_mul_i32 s51, s50, 896
    s_lshr_b32 s33, s3, 1
    s_add_u32 s37, s33, 1
    s_cmp_eq_u32 s37, 7
    s_cselect_b32 s37, 0, s37
    s_lshl_b32 s33, s33, 7
    s_lshl_b32 s37, s37, 7
    s_add_u32 s33, s33, s51
    s_add_u32 s37, s37, s51
    v_lshl_add_u32 v96, v98, 4, v96
    v_add_u32 v97, s37, v96
    v_add_u32 v96, s33, v96
    s_sub_u32 s36, s31, 4
    s_lshl_b32 s34, s44, 2
    s_add_u32 s34, s34, s36
    s_mul_i32 s34, s34, 917504
    s_lshl_b32 s36, s36, 15
    s_waitcnt lgkmcnt(0)
    s_load_dword s28, s[12:13], 0
    s_mov_b32 s14, 753664
    s_mov_b32 s15, 0x00020000
    s_mov_b32 s18, 7340032
    s_mov_b32 s19, 0x00020000
    s_mov_b32 s22, 7340032
    s_mov_b32 s23, 0x00020000
    s_barrier
    s_waitcnt lgkmcnt(0)
    s_mul_i32 s29, s28, 0x9e3779b1
    s_add_u32 s29, s29, 0x7f4a7c15
    s_cmp_ge_u32 s3, 14
    s_cbranch_scc1 L_aux_idle
    s_add_u32 s35, s34, 0
    s_add_u32 m0, s36, 0
    s_nop 0
    buffer_load_dwordx4 v96, s[16:19], s35 offen nt lds
    s_add_u32 s35, s34, 114688
    s_add_u32 m0, s36, 1024
    s_nop 0
    buffer_load_dwordx4 v96, s[16:19], s35 offen nt lds
    s_add_u32 s35, s34, 28672
    s_add_u32 m0, s36, 2048
    s_nop 0
    buffer_load_dwordx4 v96, s[16:19], s35 offen nt lds
    s_add_u32 s35, s34, 143360
    s_add_u32 m0, s36, 3072
    s_nop 0
    buffer_load_dwordx4 v96, s[16:19], s35 offen nt lds
    s_add_u32 s35, s34, 0
    s_add_u32 m0, s36, 16384
    s_nop 0
    buffer_load_dwordx4 v97, s[20:23], s35 offen nt lds
    s_add_u32 s35, s34, 114688
    s_add_u32 m0, s36, 17408
    s_nop 0
    buffer_load_dwordx4 v97, s[20:23], s35 offen nt lds
    s_mov_b32 s43, 0
L_lw_st:
    ds_read_b32 v18, v22 offset:260
    s_add_u32 s43, s43, 1
    s_cmp_ge_u32 s43, 524288
    s_cbranch_scc1 L_lwx_st
    s_waitcnt lgkmcnt(0)
    v_readfirstlane_b32 s46, v18
    s_cmp_ge_u32 s46, 4
    s_cbranch_scc1 L_lwx_st
    s_sleep 1
    s_branch L_lw_st
L_lwx_st:
    s_waitcnt lgkmcnt(0)
    s_add_u32 s35, s34, 28672
    s_add_u32 m0, s36, 18432
    s_nop 0
    buffer_load_dwordx4 v97, s[20:23], s35 offen nt lds
    s_add_u32 s35, s34, 143360
    s_add_u32 m0, s36, 19456
    s_nop 0
    buffer_load_dwordx4 v97, s[20:23], s35 offen nt lds
    s_add_u32 s35, s34, 229376
    s_add_u32 m0, s36, 4096
    s_nop 0
    buffer_load_dwordx4 v96, s[16:19], s35 offen nt lds
    s_add_u32 s35, s34, 344064
    s_add_u32 m0, s36, 5120
    s_nop 0
    buffer_load_dwordx4 v96, s[16:19], s35 offen nt lds
    s_add_u32 s35, s34, 258048
    s_add_u32 m0, s36, 6144
    s_nop 0
    buffer_load_dwordx4 v96, s[16:19], s35 offen nt lds
    s_add_u32 s35, s34, 372736
    s_add_u32 m0, s36, 7168
    s_nop 0
    buffer_load_dwordx4 v96, s[16:19], s35 offen nt lds
    s_add_u32 s35, s34, 229376
    s_add_u32 m0, s36, 20480
    s_nop 0
    buffer_load_dwordx4 v97, s[20:23], s35 offen nt lds
    s_add_u32 s35, s34, 344064
    s_add_u32 m0, s36, 21504
    s_nop 0
    buffer_load_dwordx4 v97, s[20:23], s35 offen nt lds
    s_add_u32 s35, s34, 258048
    s_add_u32 m0, s36, 22528
    s_nop 0
    buffer_load_dwordx4 v97, s[20:23], s35 offen nt lds
    s_add_u32 s35, s34, 372736
    s_add_u32 m0, s36, 23552
    s_nop 0
    buffer_load_dwordx4 v97, s[20:23], s35 offen nt lds
    s_add_u32 s35, s34, 458752
    s_add_u32 m0, s36, 8192
    s_nop 0
    buffer_load_dwordx4 v96, s[16:19], s35 offen nt lds
    s_add_u32 s35, s34, 573440
    s_add_u32 m0, s36, 9216
    s_nop 0
    buffer_load_dwordx4 v96, s[16:19], s35 offen nt lds
    s_add_u32 s35, s34, 487424
    s_add_u32 m0, s36, 10240
    s_nop 0
    buffer_load_dwordx4 v96, s[16:19], s35 offen nt lds
    s_add_u32 s35, s34, 602112
    s_add_u32 m0, s36, 11264
    s_nop 0
    buffer_load_dwordx4 v96, s[16:19], s35 offen nt lds
    s_add_u32 s35, s34, 458752
    s_add_u32 m0, s36, 24576
    s_nop 0
    buffer_load_dwordx4 v97, s[20:23], s35 offen nt lds
    s_add_u32 s35, s34, 573440
    s_add_u32 m0, s36, 25600
    s_nop 0
    buffer_load_dwordx4 v97, s[20:23], s35 offen nt lds
    s_add_u32 s35, s34, 487424
    s_add_u32 m0, s36, 26624
    s_nop 0
    buffer_load_dwordx4 v97, s[20:23], s35 offen nt lds
    s_add_u32 s35, s34, 602112
    s_add_u32 m0, s36, 27648
    s_nop 0
    buffer_load_dwordx4 v97, s[20:23], s35 offen nt lds
    s_add_u32 s35, s34, 688128
    s_add_u32 m0, s36, 12288
    s_nop 0
    buffer_load_dwordx4 v96, s[16:19], s35 offen nt lds
    s_add_u32 s35, s34, 802816
    s_add_u32 m0, s36, 13312
    s_nop 0
    buffer_load_dwordx4 v96, s[16:19], s35 offen nt lds
    s_add_u32 s35, s34, 716800
    s_add_u32 m0, s36, 14336
    s_nop 0
    buffer_load_dwordx4 v96, s[16:19], s35 offen nt lds
    s_add_u32 s35, s34, 831488
    s_add_u32 m0, s36, 15360
    s_nop 0
    buffer_load_dwordx4 v96, s[16:19], s35 offen nt lds
    s_add_u32 s35, s34, 688128
    s_add_u32 m0, s36, 28672
    s_nop 0
    buffer_load_dwordx4 v97, s[20:23], s35 offen nt lds
    s_add_u32 s35, s34, 802816
    s_add_u32 m0, s36, 29696
    s_nop 0
    buffer_load_dwordx4 v97, s[20:23], s35 offen nt lds
    s_add_u32 s35, s34, 716800
    s_add_u32 m0, s36, 30720
    s_nop 0
    buffer_load_dwordx4 v97, s[20:23], s35 offen nt lds
    s_add_u32 s35, s34, 831488
    s_add_u32 m0, s36, 31744
    s_nop 0
    buffer_load_dwordx4 v97, s[20:23], s35 offen nt lds
    v_bfe_u32 v14, v1, 2, 3
    v_lshrrev_b32 v15, 1, v14
    v_lshlrev_b32 v14, 7, v14
    v_lshrrev_b32 v13, 5, v1
    v_lshl_add_u32 v14, v13, 10, v14
    v_and_b32 v13, 3, v1
    v_lshl_add_u32 v14, v13, 3, v14
    v_add_u32 v14, s36, v14
    v_xor_b32 v13, 0, v15
    v_lshl_add_u32 v24, v13, 5, v14
    v_xor_b32 v13, 1, v15
    v_lshl_add_u32 v25, v13, 5, v14
    v_xor_b32 v13, 2, v15
    v_lshl_add_u32 v26, v13, 5, v14
    v_xor_b32 v13, 3, v15
    v_lshl_add_u32 v27, v13, 5, v14
    v_min_u32 v20, 8, v2
    v_mul_u32_u24 v20, 1040, v20
    v_lshl_add_u32 v20, v3, 4, v20
    s_lshr_b32 s35, s36, 7
    s_add_u32 s35, s35, 131072
    v_add_u32 v20, s35, v20
    v_lshlrev_b32 v19, 6, v2
    v_lshl_add_u32 v19, v3, 4, v19
    s_lshr_b32 s35, s36, 11
    s_add_u32 s35, s35, s36
    s_add_u32 s35, s35, 24512
    v_add_u32 v19, s35, v19
    v_and_b32 v242, 7, v1
    v_lshlrev_b32 v243, 2, v242
    v_add_u32 v243, 148816, v243
    v_bfe_u32 v241, v1, 3, 2
    v_mul_u32_u24 v241, 32784, v241
    v_lshrrev_b32 v240, 5, v1
    v_lshl_add_u32 v241, v240, 12, v241
    s_lshr_b32 s48, s31, 2
    s_lshl_b32 s48, s48, 10
    s_and_b32 s49, s31, 3
    s_lshl_b32 s49, s49, 4
    s_add_u32 s48, s48, s49
    s_add_u32 s48, s48, 24512
    v_add_u32 v241, s48, v241
    s_lshr_b32 s49, s3, 1
    s_cmp_eq_u32 s49, 6
    s_movk_i32 s48, 2048
    s_cselect_b32 s49, s48, 16384
    v_mul_u32_u24 v244, s49, v240
    v_lshl_add_u32 v244, v242, 4, v244
    v_bfe_u32 v240, v1, 3, 1
    v_lshl_add_u32 v244, v240, 10, v244
    s_mul_i32 s88, s50, 57344
    s_add_u32 s88, s88, 32768
    s_mul_i32 s48, s44, 28672
    s_lshr_b32 s49, s3, 1
    s_lshl_b32 s49, s49, 11
    s_add_u32 s48, s48, s49
    s_lshl_b32 s49, s31, 7
    s_add_u32 s48, s48, s49
    s_add_u32 s48, s48, s88
    v_add_u32 v244, s48, v244
    v_lshl_add_u32 v242, v242, 6, v241
    s_bfe_u32 s84, s29, 0x80000
    s_bfe_u32 s85, s29, 0x80008
    s_bfe_u32 s86, s29, 0x80010
    s_bfe_u32 s87, s29, 0x80018
    v_mov_b32 v245, 0xffffff00
    v_cmp_eq_u32 s[90:91], 1, v240
    s_waitcnt vmcnt(24)
    ds_read_b64_tr_b16 v[64:65], v24 offset:0
    ds_read_b64_tr_b16 v[66:67], v24 offset:2048
    ds_read_b64_tr_b16 v[68:69], v25 offset:0
    ds_read_b64_tr_b16 v[70:71], v25 offset:2048
    ds_read_b64_tr_b16 v[72:73], v26 offset:0
    ds_read_b64_tr_b16 v[74:75], v26 offset:2048
    ds_read_b64_tr_b16 v[76:77], v27 offset:0
    ds_read_b64_tr_b16 v[78:79], v27 offset:2048
    ds_read_b64_tr_b16 v[80:81], v24 offset:16384
    ds_read_b64_tr_b16 v[82:83], v24 offset:18432
    ds_read_b64_tr_b16 v[84:85], v25 offset:16384
    ds_read_b64_tr_b16 v[86:87], v25 offset:18432
    ds_read_b64_tr_b16 v[88:89], v26 offset:16384
    ds_read_b64_tr_b16 v[90:91], v26 offset:18432
    ds_read_b64_tr_b16 v[92:93], v27 offset:16384
    ds_read_b64_tr_b16 v[94:95], v27 offset:18432
    s_waitcnt vmcnt(16)
    ds_read_b64_tr_b16 v[96:97], v24 offset:4096
    ds_read_b64_tr_b16 v[98:99], v24 offset:6144
    ds_read_b64_tr_b16 v[100:101], v25 offset:4096
    ds_read_b64_tr_b16 v[102:103], v25 offset:6144
    ds_read_b64_tr_b16 v[104:105], v26 offset:4096
    ds_read_b64_tr_b16 v[106:107], v26 offset:6144
    ds_read_b64_tr_b16 v[108:109], v27 offset:4096
    ds_read_b64_tr_b16 v[110:111], v27 offset:6144
    ds_read_b64_tr_b16 v[112:113], v24 offset:20480
    ds_read_b64_tr_b16 v[114:115], v24 offset:22528
    ds_read_b64_tr_b16 v[116:117], v25 offset:20480
    ds_read_b64_tr_b16 v[118:119], v25 offset:22528
    ds_read_b64_tr_b16 v[120:121], v26 offset:20480
    ds_read_b64_tr_b16 v[122:123], v26 offset:22528
    ds_read_b64_tr_b16 v[124:125], v27 offset:20480
    ds_read_b64_tr_b16 v[126:127], v27 offset:22528
    s_waitcnt vmcnt(8)
    ds_read_b64_tr_b16 v[128:129], v24 offset:8192
    ds_read_b64_tr_b16 v[130:131], v24 offset:10240
    ds_read_b64_tr_b16 v[132:133], v25 offset:8192
    ds_read_b64_tr_b16 v[134:135], v25 offset:10240
    ds_read_b64_tr_b16 v[136:137], v26 offset:8192
    ds_read_b64_tr_b16 v[138:139], v26 offset:10240
    ds_read_b64_tr_b16 v[140:141], v27 offset:8192
    ds_read_b64_tr_b16 v[142:143], v27 offset:10240
    ds_read_b64_tr_b16 v[144:145], v24 offset:24576
    ds_read_b64_tr_b16 v[146:147], v24 offset:26624
    ds_read_b64_tr_b16 v[148:149], v25 offset:24576
    ds_read_b64_tr_b16 v[150:151], v25 offset:26624
    ds_read_b64_tr_b16 v[152:153], v26 offset:24576
    ds_read_b64_tr_b16 v[154:155], v26 offset:26624
    ds_read_b64_tr_b16 v[156:157], v27 offset:24576
    ds_read_b64_tr_b16 v[158:159], v27 offset:26624
    s_waitcnt vmcnt(0)
    ds_read_b64_tr_b16 v[160:161], v24 offset:12288
    ds_read_b64_tr_b16 v[162:163], v24 offset:14336
    ds_read_b64_tr_b16 v[164:165], v25 offset:12288
    ds_read_b64_tr_b16 v[166:167], v25 offset:14336
    ds_read_b64_tr_b16 v[168:169], v26 offset:12288
    ds_read_b64_tr_b16 v[170:171], v26 offset:14336
    ds_read_b64_tr_b16 v[172:173], v27 offset:12288
    ds_read_b64_tr_b16 v[174:175], v27 offset:14336
    ds_read_b64_tr_b16 v[176:177], v24 offset:28672
    ds_read_b64_tr_b16 v[178:179], v24 offset:30720
    ds_read_b64_tr_b16 v[180:181], v25 offset:28672
    ds_read_b64_tr_b16 v[182:183], v25 offset:30720
    ds_read_b64_tr_b16 v[184:185], v26 offset:28672
    ds_read_b64_tr_b16 v[186:187], v26 offset:30720
    ds_read_b64_tr_b16 v[188:189], v27 offset:28672
    ds_read_b64_tr_b16 v[190:191], v27 offset:30720
    s_mov_b32 s43, 0
L_lw_xs:
    ds_read_b32 v18, v22 offset:272
    s_add_u32 s43, s43, 1
    s_cmp_ge_u32 s43, 524288
    s_cbranch_scc1 L_lwx_xs
    s_waitcnt lgkmcnt(0)
    v_readfirstlane_b32 s46, v18
    s_cmp_ge_u32 s46, 2
    s_cbranch_scc1 L_lwx_xs
    s_branch L_lw_xs
L_lwx_xs:
    s_waitcnt lgkmcnt(0)
    ds_read_b128 v[32:35], v20 offset:0
    ds_read_b128 v[36:39], v20 offset:64
    ds_read_b128 v[40:43], v20 offset:128
    ds_read_b128 v[44:47], v20 offset:192
    s_waitcnt lgkmcnt(3)
    v_mfma_f32_16x16x32_bf16 v[192:195], v[64:67], v[32:35], 0
    s_waitcnt lgkmcnt(2)
    v_mfma_f32_16x16x32_bf16 v[192:195], v[96:99], v[36:39], v[192:195]
    s_waitcnt lgkmcnt(1)
    v_mfma_f32_16x16x32_bf16 v[192:195], v[128:131], v[40:43], v[192:195]
    s_waitcnt lgkmcnt(0)
    v_mfma_f32_16x16x32_bf16 v[192:195], v[160:163], v[44:47], v[192:195]
    v_mfma_f32_16x16x32_bf16 v[196:199], v[68:71], v[32:35], 0
    v_mfma_f32_16x16x32_bf16 v[196:199], v[100:103], v[36:39], v[196:199]
    v_mfma_f32_16x16x32_bf16 v[196:199], v[132:135], v[40:43], v[196:199]
    v_mfma_f32_16x16x32_bf16 v[196:199], v[164:167], v[44:47], v[196:199]
    v_mfma_f32_16x16x32_bf16 v[200:203], v[72:75], v[32:35], 0
    v_mfma_f32_16x16x32_bf16 v[200:203], v[104:107], v[36:39], v[200:203]
    v_mfma_f32_16x16x32_bf16 v[200:203], v[136:139], v[40:43], v[200:203]
    v_mfma_f32_16x16x32_bf16 v[200:203], v[168:171], v[44:47], v[200:203]
    ds_write_b128 v19, v[192:195] offset:0
    v_mfma_f32_16x16x32_bf16 v[204:207], v[76:79], v[32:35], 0
    v_mfma_f32_16x16x32_bf16 v[204:207], v[108:111], v[36:39], v[204:207]
    v_mfma_f32_16x16x32_bf16 v[204:207], v[140:143], v[40:43], v[204:207]
    v_mfma_f32_16x16x32_bf16 v[204:207], v[172:175], v[44:47], v[204:207]
    ds_write_b128 v19, v[196:199] offset:1024
    v_mfma_f32_16x16x32_bf16 v[208:211], v[80:83], v[32:35], 0
    v_mfma_f32_16x16x32_bf16 v[208:211], v[112:115], v[36:39], v[208:211]
    v_mfma_f32_16x16x32_bf16 v[208:211], v[144:147], v[40:43], v[208:211]
    v_mfma_f32_16x16x32_bf16 v[208:211], v[176:179], v[44:47], v[208:211]
    ds_write_b128 v19, v[200:203] offset:2048
    v_mfma_f32_16x16x32_bf16 v[212:215], v[84:87], v[32:35], 0
    v_mfma_f32_16x16x32_bf16 v[212:215], v[116:119], v[36:39], v[212:215]
    v_mfma_f32_16x16x32_bf16 v[212:215], v[148:151], v[40:43], v[212:215]
    v_mfma_f32_16x16x32_bf16 v[212:215], v[180:183], v[44:47], v[212:215]
    ds_write_b128 v19, v[204:207] offset:3072
    v_mfma_f32_16x16x32_bf16 v[216:219], v[88:91], v[32:35], 0
    v_mfma_f32_16x16x32_bf16 v[216:219], v[120:123], v[36:39], v[216:219]
    v_mfma_f32_16x16x32_bf16 v[216:219], v[152:155], v[40:43], v[216:219]
    v_mfma_f32_16x16x32_bf16 v[216:219], v[184:187], v[44:47], v[216:219]
    ds_write_b128 v19, v[208:211] offset:4096
    v_mfma_f32_16x16x32_bf16 v[220:223], v[92:95], v[32:35], 0
    v_mfma_f32_16x16x32_bf16 v[220:223], v[124:127], v[36:39], v[220:223]
    v_mfma_f32_16x16x32_bf16 v[220:223], v[156:159], v[40:43], v[220:223]
    v_mfma_f32_16x16x32_bf16 v[220:223], v[188:191], v[44:47], v[220:223]
    ds_write_b128 v19, v[212:215] offset:5120
    s_nop 1
    ds_write_b128 v19, v[216:219] offset:6144
    s_nop 3
    ds_write_b128 v19, v[220:223] offset:7168
    s_waitcnt lgkmcnt(0)
    s_branch L_aux_b4
L_aux_idle:
    v_and_b32 v242, 7, v1
    v_lshlrev_b32 v243, 2, v242
    v_add_u32 v243, 148816, v243
    v_bfe_u32 v241, v1, 3, 2
    v_mul_u32_u24 v241, 32784, v241
    v_lshrrev_b32 v240, 5, v1
    v_lshl_add_u32 v241, v240, 12, v241
    s_lshr_b32 s48, s31, 2
    s_lshl_b32 s48, s48, 10
    s_and_b32 s49, s31, 3
    s_lshl_b32 s49, s49, 4
    s_add_u32 s48, s48, s49
    s_add_u32 s48, s48, 24512
    v_add_u32 v241, s48, v241
    s_lshr_b32 s49, s3, 1
    s_cmp_eq_u32 s49, 6
    s_movk_i32 s48, 2048
    s_cselect_b32 s49, s48, 16384
    v_mul_u32_u24 v244, s49, v240
    v_lshl_add_u32 v244, v242, 4, v244
    v_bfe_u32 v240, v1, 3, 1
    v_lshl_add_u32 v244, v240, 10, v244
    s_mul_i32 s88, s50, 57344
    s_add_u32 s88, s88, 32768
    s_mul_i32 s48, s44, 28672
    s_lshr_b32 s49, s3, 1
    s_lshl_b32 s49, s49, 11
    s_add_u32 s48, s48, s49
    s_lshl_b32 s49, s31, 7
    s_add_u32 s48, s48, s49
    s_add_u32 s48, s48, s88
    v_add_u32 v244, s48, v244
    v_lshl_add_u32 v242, v242, 6, v241
    s_bfe_u32 s84, s29, 0x80000
    s_bfe_u32 s85, s29, 0x80008
    s_bfe_u32 s86, s29, 0x80010
    s_bfe_u32 s87, s29, 0x80018
    v_mov_b32 v245, 0xffffff00
    v_cmp_eq_u32 s[90:91], 1, v240
L_aux_b4:
    s_barrier
    s_cmp_ge_u32 s3, 14
    s_cbranch_scc1 L_aux_noh
    ds_read_b32 v24, v243
    ds_read_b128 v[64:67], v242
    ds_read_b128 v[72:75], v241 offset:512
    ds_read_b128 v[68:71], v242 offset:2048
    ds_read_b128 v[76:79], v241 offset:2560
    s_waitcnt lgkmcnt(0)
    v_and_b32 v25, 0xffff0000, v24
    v_lshlrev_b32 v24, 16, v24
    v_rcp_f32 v25, v25
    s_nop 0
    v_pk_fma_f32 v[64:65], v[72:73], v[24:25], v[64:65] op_sel:[0,0,0] op_sel_hi:[1,0,1] neg_lo:[1,0,0] neg_hi:[1,0,0]
    v_pk_fma_f32 v[66:67], v[74:75], v[24:25], v[66:67] op_sel:[0,0,0] op_sel_hi:[1,0,1] neg_lo:[1,0,0] neg_hi:[1,0,0]
    v_pk_fma_f32 v[68:69], v[76:77], v[24:25], v[68:69] op_sel:[0,0,0] op_sel_hi:[1,0,1] neg_lo:[1,0,0] neg_hi:[1,0,0]
    v_pk_fma_f32 v[70:71], v[78:79], v[24:25], v[70:71] op_sel:[0,0,0] op_sel_hi:[1,0,1] neg_lo:[1,0,0] neg_hi:[1,0,0]
    v_cndmask_b32 v72, v68, v64, s[90:91]
    v_cndmask_b32 v73, v69, v65, s[90:91]
    v_cndmask_b32 v74, v70, v66, s[90:91]
    v_cndmask_b32 v75, v71, v67, s[90:91]
    v_cndmask_b32 v64, v64, v68, s[90:91]
    v_cndmask_b32 v65, v65, v69, s[90:91]
    v_cndmask_b32 v66, v66, v70, s[90:91]
    v_cndmask_b32 v67, v67, v71, s[90:91]
    v_add_f32_dpp v64, v72, v64 row_ror:8 row_mask:0xf bank_mask:0xf
    v_add_f32_dpp v65, v73, v65 row_ror:8 row_mask:0xf bank_mask:0xf
    v_add_f32_dpp v66, v74, v66 row_ror:8 row_mask:0xf bank_mask:0xf
    v_add_f32_dpp v67, v75, v67 row_ror:8 row_mask:0xf bank_mask:0xf
    v_mov_b32 v68, v64
    v_mov_b32 v69, v65
    v_mov_b32 v70, v66
    v_mov_b32 v71, v67
    v_permlane16_swap_b32 v64, v68
    v_permlane16_swap_b32 v65, v69
    v_permlane16_swap_b32 v66, v70
    v_permlane16_swap_b32 v67, v71
    v_pk_add_f32 v[64:65], v[64:65], v[68:69]
    v_pk_add_f32 v[66:67], v[66:67], v[70:71]
    v_pk_mul_f32 v[64:65], v[64:65], v[24:25] op_sel:[0,1] op_sel_hi:[1,1]
    v_pk_mul_f32 v[66:67], v[66:67], v[24:25] op_sel:[0,1] op_sel_hi:[1,1]
    v_and_or_b32 v64, v64, v245, s84
    v_and_or_b32 v65, v65, v245, s85
    v_and_or_b32 v66, v66, v245, s86
    v_and_or_b32 v67, v67, v245, s87
    s_mov_b32 exec_lo, 0xffff
    s_mov_b32 exec_hi, 0xffff
    buffer_store_dwordx4 v[64:67], v244, s[12:15], 0 offen sc1
    s_mov_b64 exec, -1
L_aux_noh:
    s_sub_u32 s47, s31, 2
    s_cmp_ge_u32 s47, 2
    s_cbranch_scc1 L_aux_nowd
    v_and_b32 v14, 7, v1
    v_mul_u32_u24 v15, 86, v14
    v_lshrrev_b32 v15, 8, v15
    v_mul_u32_u24 v14, 7184, v14
    v_mul_u32_u24 v15, 11216, v15
    v_add_u32 v14, v14, v15
    v_lshrrev_b32 v15, 3, v1
    v_lshl_add_u32 v14, v15, 4, v14
    s_mul_i32 s46, s47, 3584
    v_add_u32 v14, s46, v14
    s_waitcnt vmcnt(1)
    s_cmp_lt_u32 s3, 14
    s_cbranch_scc1 L_aux_wd1
    s_waitcnt vmcnt(0)
L_aux_wd1:
    ds_write_b128 v14, v[128:131] offset:0
    ds_write_b128 v14, v[132:135] offset:128
    ds_write_b128 v14, v[136:139] offset:256
    ds_write_b128 v14, v[140:143] offset:384
    ds_write_b128 v14, v[144:147] offset:512
    ds_write_b128 v14, v[148:151] offset:640
    ds_write_b128 v14, v[152:155] offset:768
    ds_write_b128 v14, v[156:159] offset:896
    ds_write_b128 v14, v[160:163] offset:1024
    ds_write_b128 v14, v[164:167] offset:1152
    ds_write_b128 v14, v[168:171] offset:1280
    ds_write_b128 v14, v[172:175] offset:1408
    ds_write_b128 v14, v[176:179] offset:1536
    ds_write_b128 v14, v[180:183] offset:1664
    ds_write_b128 v14, v[184:187] offset:1792
    ds_write_b128 v14, v[188:191] offset:1920
    ds_write_b128 v14, v[192:195] offset:2048
    ds_write_b128 v14, v[196:199] offset:2176
    ds_write_b128 v14, v[200:203] offset:2304
    ds_write_b128 v14, v[204:207] offset:2432
    ds_write_b128 v14, v[208:211] offset:2560
    ds_write_b128 v14, v[212:215] offset:2688
    ds_write_b128 v14, v[216:219] offset:2816
    ds_write_b128 v14, v[220:223] offset:2944
    ds_write_b128 v14, v[224:227] offset:3072
    ds_write_b128 v14, v[228:231] offset:3200
    ds_write_b128 v14, v[232:235] offset:3328
    ds_write_b128 v14, v[236:239] offset:3456
    s_waitcnt lgkmcnt(0)
L_aux_nowd:
    v_lshlrev_b32 v10, 7, v3
    v_bfe_u32 v11, v1, 1, 1
    v_lshl_add_u32 v10, v11, 6, v10
    v_bfe_u32 v11, v1, 2, 2
    v_lshl_add_u32 v10, v11, 4, v10
    v_and_b32 v11, 1, v1
    v_lshl_add_u32 v10, v11, 3, v10
    s_mul_i32 s46, s31, 86
    s_lshr_b32 s46, s46, 8
    s_mul_i32 s46, s46, 11216
    s_mul_i32 s47, s31, 7184
    s_add_u32 s46, s46, s47
    v_add_u32 v10, s46, v10
    v_lshl_add_u32 v14, v0, 4, s88
    v_lshlrev_b32 v15, 3, v1
    v_add_u32 v15, 131072, v15
    s_lshl_b32 s47, s31, 9
    v_add_u32 v16, s47, v15
    s_mov_b32 s60, 7168
    s_mov_b32 s61, 14336
    s_mov_b32 s62, 21504
    s_mov_b32 s63, 28672
    s_mov_b32 s64, 35840
    s_mov_b32 s65, 43008
    s_mov_b32 s66, 50176
    s_mov_b32 s58, 0xbfb8aa3b
    s_mov_b32 s43, 0
    v_mov_b32 v17, 0xff
    s_barrier
    ds_read_b64_tr_b16 v[64:65], v10 offset:0
    ds_read_b64_tr_b16 v[66:67], v10 offset:512
    ds_read_b64_tr_b16 v[68:69], v10 offset:1024
    ds_read_b64_tr_b16 v[70:71], v10 offset:1536
    ds_read_b64_tr_b16 v[72:73], v10 offset:2048
    ds_read_b64_tr_b16 v[74:75], v10 offset:2560
    ds_read_b64_tr_b16 v[76:77], v10 offset:3072
    ds_read_b64_tr_b16 v[78:79], v10 offset:3584
    ds_read_b64_tr_b16 v[80:81], v10 offset:4096
    ds_read_b64_tr_b16 v[82:83], v10 offset:4608
    ds_read_b64_tr_b16 v[84:85], v10 offset:5120
    ds_read_b64_tr_b16 v[86:87], v10 offset:5632
    ds_read_b64_tr_b16 v[88:89], v10 offset:6144
    ds_read_b64_tr_b16 v[90:91], v10 offset:6656
    s_cmp_eq_u32 s31, 7
    s_cbranch_scc1 L_aux_nohp
    buffer_load_dwordx4 v[128:131], v14, s[12:15], 0 offen sc1
    buffer_load_dwordx4 v[132:135], v14, s[12:15], s60 offen sc1
    buffer_load_dwordx4 v[136:139], v14, s[12:15], s61 offen sc1
    buffer_load_dwordx4 v[140:143], v14, s[12:15], s62 offen sc1
    buffer_load_dwordx4 v[144:147], v14, s[12:15], s63 offen sc1
    buffer_load_dwordx4 v[148:151], v14, s[12:15], s64 offen sc1
    buffer_load_dwordx4 v[152:155], v14, s[12:15], s65 offen sc1
    buffer_load_dwordx4 v[156:159], v14, s[12:15], s66 offen sc1
L_aux_gp:
    s_waitcnt vmcnt(0)
    v_bitop3_b32 v32, v128, v132, s84 bitop3:0x7e
    v_bitop3_b32 v36, v136, v140, s84 bitop3:0x7e
    v_bitop3_b32 v40, v144, v148, s84 bitop3:0x7e
    v_bitop3_b32 v44, v152, v156, s84 bitop3:0x7e
    v_bitop3_b32 v33, v129, v133, s85 bitop3:0x7e
    v_bitop3_b32 v37, v137, v141, s85 bitop3:0x7e
    v_bitop3_b32 v41, v145, v149, s85 bitop3:0x7e
    v_bitop3_b32 v45, v153, v157, s85 bitop3:0x7e
    v_bitop3_b32 v34, v130, v134, s86 bitop3:0x7e
    v_bitop3_b32 v38, v138, v142, s86 bitop3:0x7e
    v_bitop3_b32 v42, v146, v150, s86 bitop3:0x7e
    v_bitop3_b32 v46, v154, v158, s86 bitop3:0x7e
    v_bitop3_b32 v35, v131, v135, s87 bitop3:0x7e
    v_bitop3_b32 v39, v139, v143, s87 bitop3:0x7e
    v_bitop3_b32 v43, v147, v151, s87 bitop3:0x7e
    v_bitop3_b32 v47, v155, v159, s87 bitop3:0x7e
    v_or3_b32 v32, v32, v33, v34
    v_or3_b32 v36, v36, v37, v38
    v_or3_b32 v40, v40, v41, v42
    v_or3_b32 v44, v44, v45, v46
    v_bitop3_b32 v32, v32, v35, v17 bitop3:0xa8
    v_bitop3_b32 v36, v36, v39, v17 bitop3:0xa8
    v_bitop3_b32 v40, v40, v43, v17 bitop3:0xa8
    v_bitop3_b32 v44, v44, v47, v17 bitop3:0xa8
    v_cmp_ne_u32 s[4:5], 0, v32
    v_cmp_ne_u32 s[6:7], 0, v36
    v_cmp_ne_u32 s[8:9], 0, v40
    v_cmp_ne_u32 s[10:11], 0, v44
    s_or_b64 vcc, s[4:5], s[6:7]
    s_or_b64 s[32:33], s[8:9], s[10:11]
    s_or_b64 vcc, vcc, s[32:33]
    s_cbranch_scc0 L_aux_gok
    s_add_u32 s43, s43, 1
    s_cmp_ge_u32 s43, 65536
    s_cbranch_scc1 L_aux_gok
    s_sleep 2
    s_mov_b64 exec, s[4:5]
    s_cbranch_execz L_aux_gs0
    buffer_load_dwordx4 v[128:131], v14, s[12:15], 0 offen sc1
    buffer_load_dwordx4 v[132:135], v14, s[12:15], s60 offen sc1
L_aux_gs0:
    s_mov_b64 exec, s[6:7]
    s_cbranch_execz L_aux_gs1
    buffer_load_dwordx4 v[136:139], v14, s[12:15], s61 offen sc1
    buffer_load_dwordx4 v[140:143], v14, s[12:15], s62 offen sc1
L_aux_gs1:
    s_mov_b64 exec, s[8:9]
    s_cbranch_execz L_aux_gs2
    buffer_load_dwordx4 v[144:147], v14, s[12:15], s63 offen sc1
    buffer_load_dwordx4 v[148:151], v14, s[12:15], s64 offen sc1
L_aux_gs2:
    s_mov_b64 exec, s[10:11]
    s_cbranch_execz L_aux_gs3
    buffer_load_dwordx4 v[152:155], v14, s[12:15], s65 offen sc1
    buffer_load_dwordx4 v[156:159], v14, s[12:15], s66 offen sc1
L_aux_gs3:
    s_mov_b64 exec, -1
    s_branch L_aux_gp
L_aux_gok:
    v_pk_add_f32 v[128:129], v[128:129], v[144:145]
    v_pk_add_f32 v[130:131], v[130:131], v[146:147]
    v_pk_add_f32 v[136:137], v[136:137], v[152:153]
    v_pk_add_f32 v[138:139], v[138:139], v[154:155]
    v_pk_add_f32 v[132:133], v[132:133], v[148:149]
    v_pk_add_f32 v[134:135], v[134:135], v[150:151]
    v_pk_add_f32 v[140:141], v[140:141], v[156:157]
    v_pk_add_f32 v[142:143], v[142:143], v[158:159]
    v_pk_mul_f32 v[144:145], v[128:129], s[58:59] op_sel_hi:[1,0]
    v_pk_mul_f32 v[146:147], v[130:131], s[58:59] op_sel_hi:[1,0]
    v_pk_mul_f32 v[148:149], v[132:133], s[58:59] op_sel_hi:[1,0]
    v_pk_mul_f32 v[150:151], v[134:135], s[58:59] op_sel_hi:[1,0]
    v_exp_f32 v144, v144
    v_exp_f32 v145, v145
    v_exp_f32 v146, v146
    v_exp_f32 v147, v147
    v_pk_mul_f32 v[128:129], v[128:129], v[136:137]
    v_pk_mul_f32 v[130:131], v[130:131], v[138:139]
    v_exp_f32 v148, v148
    v_exp_f32 v149, v149
    v_exp_f32 v150, v150
    v_exp_f32 v151, v151
    v_pk_mul_f32 v[132:133], v[132:133], v[140:141]
    v_pk_mul_f32 v[134:135], v[134:135], v[142:143]
    v_pk_add_f32 v[144:145], v[144:145], 1.0 op_sel_hi:[1,0]
    v_pk_add_f32 v[146:147], v[146:147], 1.0 op_sel_hi:[1,0]
    v_pk_add_f32 v[148:149], v[148:149], 1.0 op_sel_hi:[1,0]
    v_pk_add_f32 v[150:151], v[150:151], 1.0 op_sel_hi:[1,0]
    v_rcp_f32 v144, v144
    v_rcp_f32 v145, v145
    v_rcp_f32 v146, v146
    v_rcp_f32 v147, v147
    v_rcp_f32 v148, v148
    v_rcp_f32 v149, v149
    v_rcp_f32 v150, v150
    v_rcp_f32 v151, v151
    v_pk_mul_f32 v[128:129], v[128:129], v[144:145]
    v_pk_mul_f32 v[130:131], v[130:131], v[146:147]
    v_cvt_pk_bf16_f32 v136, v128, v129
    v_cvt_pk_bf16_f32 v137, v130, v131
    ds_write_b64 v16, v[136:137] offset:0
    v_pk_mul_f32 v[132:133], v[132:133], v[148:149]
    v_pk_mul_f32 v[134:135], v[134:135], v[150:151]
    v_cvt_pk_bf16_f32 v140, v132, v133
    v_cvt_pk_bf16_f32 v141, v134, v135
    ds_write_b64 v16, v[140:141] offset:3584
L_aux_nohp:
    s_waitcnt lgkmcnt(0)
    s_barrier
    ds_read_b64 v[96:97], v15 offset:0
    ds_read_b64 v[98:99], v15 offset:512
    ds_read_b64 v[100:101], v15 offset:1024
    ds_read_b64 v[102:103], v15 offset:1536
    ds_read_b64 v[104:105], v15 offset:2048
    ds_read_b64 v[106:107], v15 offset:2560
    ds_read_b64 v[108:109], v15 offset:3072
    ds_read_b64 v[110:111], v15 offset:3584
    ds_read_b64 v[112:113], v15 offset:4096
    ds_read_b64 v[114:115], v15 offset:4608
    ds_read_b64 v[116:117], v15 offset:5120
    ds_read_b64 v[118:119], v15 offset:5632
    ds_read_b64 v[120:121], v15 offset:6144
    ds_read_b64 v[122:123], v15 offset:6656
    s_lshl_b32 s46, s38, 3
    s_add_u32 s46, s46, s31
    s_lshl_b32 s46, s46, 3
    s_add_u32 s46, s46, s50
    s_lshl_b32 s46, s46, 8
    s_add_u32 s46, s46, 491520
    v_lshlrev_b32 v14, 7, v3
    v_lshl_add_u32 v14, v2, 4, v14
    v_add_u32 v14, s46, v14
    s_waitcnt lgkmcnt(12)
    v_mfma_f32_16x16x32_bf16 v[32:35], v[64:67], v[96:99], 0
    s_waitcnt lgkmcnt(10)
    v_mfma_f32_16x16x32_bf16 v[32:35], v[68:71], v[100:103], v[32:35]
    s_waitcnt lgkmcnt(8)
    v_mfma_f32_16x16x32_bf16 v[32:35], v[72:75], v[104:107], v[32:35]
    s_waitcnt lgkmcnt(6)
    v_mfma_f32_16x16x32_bf16 v[32:35], v[76:79], v[108:111], v[32:35]
    s_waitcnt lgkmcnt(4)
    v_mfma_f32_16x16x32_bf16 v[32:35], v[80:83], v[112:115], v[32:35]
    s_waitcnt lgkmcnt(2)
    v_mfma_f32_16x16x32_bf16 v[32:35], v[84:87], v[116:119], v[32:35]
    s_waitcnt lgkmcnt(0)
    v_mfma_f32_16x16x32_bf16 v[32:35], v[88:91], v[120:123], v[32:35]
    s_nop 7
    v_mov_b32_dpp v36, v32 row_ror:8 row_mask:0xf bank_mask:0xf
    v_mov_b32_dpp v37, v33 row_ror:8 row_mask:0xf bank_mask:0xf
    v_mov_b32_dpp v38, v34 row_ror:8 row_mask:0xf bank_mask:0xf
    v_mov_b32_dpp v39, v35 row_ror:8 row_mask:0xf bank_mask:0xf
    v_permlane32_swap_b32 v36, v40
    v_permlane32_swap_b32 v37, v41
    v_permlane32_swap_b32 v38, v42
    v_permlane32_swap_b32 v39, v43
    v_pk_add_f32 v[32:33], v[32:33], v[40:41]
    v_pk_add_f32 v[34:35], v[34:35], v[42:43]
    v_and_or_b32 v32, v32, v245, s84
    v_and_or_b32 v33, v33, v245, s85
    v_and_or_b32 v34, v34, v245, s86
    v_and_or_b32 v35, v35, v245, s87
    s_mov_b64 exec, 0x00ff00ff
    buffer_store_dwordx4 v[32:35], v14, s[12:15], 0 offen sc1
    s_mov_b64 exec, -1
    s_lshl_b32 s48, s30, 3
    s_add_u32 s48, s48, s31
    s_cmp_lg_u32 s48, 1016
    s_cbranch_scc1 L_aux_done
    v_lshlrev_b32 v21, 3, v1
    v_add_u32 v21, 2048, v21
    s_mov_b32 s43, 0
L_poll_ack:
    buffer_load_dwordx2 v[60:61], v21, s[12:15], 0 offen sc1
    s_waitcnt vmcnt(0)
    v_xor_b32 v14, s29, v60
    v_bitop3_b32 v14, v14, v61, s29 bitop3:0xf6
    v_cmp_ne_u32 vcc, 0, v14
    s_cbranch_vccz L_polled_ack
    s_add_u32 s43, s43, 1
    s_cmp_ge_u32 s43, 65536
    s_cbranch_scc1 L_polled_ack
    s_sleep 4
    s_branch L_poll_ack
L_polled_ack:
    v_mov_b32 v5, s29
    v_mov_b32 v4, 0
    s_mov_b64 exec, 1
    buffer_store_dword v5, v4, s[12:15], 0 offen sc1
L_aux_done:
    s_endpgm
L_aux_slow:
    s_waitcnt lgkmcnt(0)
    v_lshlrev_b32 v14, 5, v0
    v_add_u32 v14, 140432, v14
    ds_write_b128 v14, v[80:83]
    ds_write_b128 v14, v[84:87] offset:16
    s_waitcnt lgkmcnt(0)
    s_mov_b64 exec, 1
    ds_add_u32 v22, v23 offset:256
    s_mov_b64 exec, -1
    s_mov_b32 s43, 0
L_lw_slow:
    ds_read_b32 v18, v22 offset:256
    s_add_u32 s43, s43, 1
    s_cmp_ge_u32 s43, 524288
    s_cbranch_scc1 L_lwx_slow
    s_waitcnt lgkmcnt(0)
    v_readfirstlane_b32 s46, v18
    s_cmp_ge_u32 s46, 4
    s_cbranch_scc1 L_lwx_slow
    s_branch L_lw_slow
L_lwx_slow:
    s_waitcnt lgkmcnt(0)
    v_lshlrev_b32 v14, 4, v1
    v_add_u32 v14, 140432, v14
    ds_read_b128 v[128:131], v14 offset:0
    ds_read_b128 v[132:135], v14 offset:1024
    ds_read_b128 v[136:139], v14 offset:2048
    ds_read_b128 v[140:143], v14 offset:3072
    ds_read_b128 v[144:147], v14 offset:4096
    ds_read_b128 v[148:151], v14 offset:5120
    ds_read_b128 v[152:155], v14 offset:6144
    ds_read_b128 v[156:159], v14 offset:7168
    s_waitcnt lgkmcnt(0)
    s_cmp_ge_u32 s31, 2
    s_cbranch_scc1 L_aux_wd
    s_mov_b32 s46, 0
    v_mov_b32 v20, v1
    v_mov_b32 v17, 0
L_aux_slow2:
    v_max3_u32 v14, v128, v129, v130
    v_max3_u32 v14, v14, v131, v132
    v_max3_u32 v14, v14, v133, v134
    v_max3_u32 v14, v14, v135, v136
    v_max3_u32 v14, v14, v137, v138
    v_max3_u32 v14, v14, v139, v140
    v_max3_u32 v14, v14, v141, v142
    v_max3_u32 v14, v14, v143, v144
    v_max3_u32 v14, v14, v145, v146
    v_max3_u32 v14, v14, v147, v148
    v_max3_u32 v14, v14, v149, v150
    v_max3_u32 v14, v14, v151, v152
    v_max3_u32 v14, v14, v153, v154
    v_max3_u32 v14, v14, v155, v156
    v_max3_u32 v14, v14, v157, v158
    v_max_u32 v14, v14, v159
    s_nop 1
    v_max_u32_dpp v14, v14, v14 row_ror:8 row_mask:0xf bank_mask:0xf
    s_nop 1
    v_max_u32_dpp v14, v14, v14 row_ror:4 row_mask:0xf bank_mask:0xf
    s_nop 1
    v_max_u32_dpp v14, v14, v14 row_ror:2 row_mask:0xf bank_mask:0xf
    s_nop 1
    v_max_u32_dpp v14, v14, v14 row_ror:1 row_mask:0xf bank_mask:0xf
    v_mov_b32 v15, v14
    s_nop 1
    v_permlane16_swap_b32 v14, v15
    v_max_u32 v14, v14, v15
    v_mov_b32 v15, v14
    s_nop 1
    v_permlane32_swap_b32 v14, v15
    v_max_u32 v14, v14, v15
    v_cmp_eq_u32 vcc, s46, v20
    s_nop 1
    v_cndmask_b32 v17, v17, v14, vcc
    v_cmp_ne_u32 vcc, v14, v128
    s_nop 1
    v_cndmask_b32 v128, 0, v128, vcc
    v_cmp_ne_u32 vcc, v14, v129
    s_nop 1
    v_cndmask_b32 v129, 0, v129, vcc
    v_cmp_ne_u32 vcc, v14, v130
    s_nop 1
    v_cndmask_b32 v130, 0, v130, vcc
    v_cmp_ne_u32 vcc, v14, v131
    s_nop 1
    v_cndmask_b32 v131, 0, v131, vcc
    v_cmp_ne_u32 vcc, v14, v132
    s_nop 1
    v_cndmask_b32 v132, 0, v132, vcc
    v_cmp_ne_u32 vcc, v14, v133
    s_nop 1
    v_cndmask_b32 v133, 0, v133, vcc
    v_cmp_ne_u32 vcc, v14, v134
    s_nop 1
    v_cndmask_b32 v134, 0, v134, vcc
    v_cmp_ne_u32 vcc, v14, v135
    s_nop 1
    v_cndmask_b32 v135, 0, v135, vcc
    v_cmp_ne_u32 vcc, v14, v136
    s_nop 1
    v_cndmask_b32 v136, 0, v136, vcc
    v_cmp_ne_u32 vcc, v14, v137
    s_nop 1
    v_cndmask_b32 v137, 0, v137, vcc
    v_cmp_ne_u32 vcc, v14, v138
    s_nop 1
    v_cndmask_b32 v138, 0, v138, vcc
    v_cmp_ne_u32 vcc, v14, v139
    s_nop 1
    v_cndmask_b32 v139, 0, v139, vcc
    v_cmp_ne_u32 vcc, v14, v140
    s_nop 1
    v_cndmask_b32 v140, 0, v140, vcc
    v_cmp_ne_u32 vcc, v14, v141
    s_nop 1
    v_cndmask_b32 v141, 0, v141, vcc
    v_cmp_ne_u32 vcc, v14, v142
    s_nop 1
    v_cndmask_b32 v142, 0, v142, vcc
    v_cmp_ne_u32 vcc, v14, v143
    s_nop 1
    v_cndmask_b32 v143, 0, v143, vcc
    v_cmp_ne_u32 vcc, v14, v144
    s_nop 1
    v_cndmask_b32 v144, 0, v144, vcc
    v_cmp_ne_u32 vcc, v14, v145
    s_nop 1
    v_cndmask_b32 v145, 0, v145, vcc
    v_cmp_ne_u32 vcc, v14, v146
    s_nop 1
    v_cndmask_b32 v146, 0, v146, vcc
    v_cmp_ne_u32 vcc, v14, v147
    s_nop 1
    v_cndmask_b32 v147, 0, v147, vcc
    v_cmp_ne_u32 vcc, v14, v148
    s_nop 1
    v_cndmask_b32 v148, 0, v148, vcc
    v_cmp_ne_u32 vcc, v14, v149
    s_nop 1
    v_cndmask_b32 v149, 0, v149, vcc
    v_cmp_ne_u32 vcc, v14, v150
    s_nop 1
    v_cndmask_b32 v150, 0, v150, vcc
    v_cmp_ne_u32 vcc, v14, v151
    s_nop 1
    v_cndmask_b32 v151, 0, v151, vcc
    v_cmp_ne_u32 vcc, v14, v152
    s_nop 1
    v_cndmask_b32 v152, 0, v152, vcc
    v_cmp_ne_u32 vcc, v14, v153
    s_nop 1
    v_cndmask_b32 v153, 0, v153, vcc
    v_cmp_ne_u32 vcc, v14, v154
    s_nop 1
    v_cndmask_b32 v154, 0, v154, vcc
    v_cmp_ne_u32 vcc, v14, v155
    s_nop 1
    v_cndmask_b32 v155, 0, v155, vcc
    v_cmp_ne_u32 vcc, v14, v156
    s_nop 1
    v_cndmask_b32 v156, 0, v156, vcc
    v_cmp_ne_u32 vcc, v14, v157
    s_nop 1
    v_cndmask_b32 v157, 0, v157, vcc
    v_cmp_ne_u32 vcc, v14, v158
    s_nop 1
    v_cndmask_b32 v158, 0, v158, vcc
    v_cmp_ne_u32 vcc, v14, v159
    s_nop 1
    v_cndmask_b32 v159, 0, v159, vcc
    s_add_u32 s46, s46, 1
    s_cmp_lt_u32 s46, 8
    s_cbranch_scc1 L_aux_slow2
    s_branch L_aux_sel
L_exit:
    s_endpgm
.p2align 6
L_conv:
    s_and_b32 s56, s2, 7
    s_lshl_b32 s44, s56, 4
    s_add_u32 s44, s44, s3
    v_and_b32 v1, 63, v0
    v_and_b32 v2, 15, v0
    v_bfe_u32 v3, v0, 4, 2
    v_lshrrev_b32 v4, 6, v0
    s_nop 0
    v_readfirstlane_b32 s45, v4
    s_mov_b32 s40, 0x3fb8aa3b
    s_mov_b32 s41, 0x32a57060
    s_lshl_b32 s46, s44, 3
    s_add_u32 s46, s46, s45
    s_lshl_b32 s47, s46, 8
    s_lshl_b32 s48, s46, 1
    s_lshl_b32 s49, s44, 4
    v_lshl_add_u32 v4, v1, 2, s47
    v_mov_b32 v5, s48
    s_waitcnt lgkmcnt(0)
    s_load_dword s50, s[36:37], 0
    s_mov_b32 s26, 2048
    s_mov_b32 s27, 0x00020000
    s_mov_b32 s10, 262144
    s_mov_b32 s11, 0x00020000
    s_mov_b32 s14, 262144
    s_mov_b32 s15, 0x00020000
    s_mov_b32 s18, 262144
    s_mov_b32 s19, 0x00020000
    s_mov_b32 s22, 262144
    s_mov_b32 s23, 0x00020000
    s_mov_b32 s30, 2048
    s_mov_b32 s31, 0x00020000
    buffer_load_ushort v15, v5, s[24:27], 0 offen
    buffer_load_dword v16, v4, s[8:11], 0 offen nt
    buffer_load_dword v17, v4, s[12:15], 0 offen nt
    buffer_load_dword v18, v4, s[16:19], 0 offen nt
    buffer_load_dword v19, v4, s[20:23], 0 offen nt
    buffer_load_ushort v14, v5, s[28:31], 0 offen
    s_mov_b32 s6, 4194304
    s_mov_b32 s7, 0x00020000
    s_mov_b32 s34, 4194304
    s_mov_b32 s35, 0x00020000
    s_mov_b32 s38, 753664
    s_mov_b32 s39, 0x00020000
    s_cmp_lt_u32 s45, 4
    s_cbranch_scc1 L_conv_p
    s_setprio 1
L_conv_p:
    v_xor_b32 v9, v1, v3
    s_lshl_b32 s57, s45, 19
    s_add_u32 s57, s57, s49
    v_lshl_add_u32 v9, v9, 11, s57
    s_lshl_b32 s57, s3, 7
    s_lshl_b32 s58, s45, 4
    s_add_u32 s57, s57, s58
    s_lshl_b32 s57, s57, 11
    s_lshl_b32 s58, s56, 8
    s_add_u32 s57, s57, s58
    v_lshrrev_b32 v11, 1, v1
    v_lshlrev_b32 v11, 11, v11
    v_and_b32 v10, 1, v1
    v_lshl_add_u32 v11, v10, 7, v11
    v_add_u32 v11, s57, v11
    s_mov_b32 s53, 4096
    s_mov_b32 s54, 8192
    s_mov_b32 s55, 12288
    s_mul_i32 s57, s45, 3072
    s_add_u32 s57, s57, 67584
    s_mul_i32 s51, s45, 4608
    s_add_u32 s51, s51, 92160
    v_mov_b32 v64, 0
    v_mov_b32 v65, 0
    v_mov_b32 v66, 0
    v_mov_b32 v67, 0
    v_lshl_add_u32 v10, v1, 4, s57
    ds_write_b128 v10, v[64:67] offset:0
    ds_write_b128 v10, v[64:67] offset:1024
    ds_write_b128 v10, v[64:67] offset:2048
    v_lshl_add_u32 v10, v1, 3, s51
    ds_write_b64 v10, v[64:65]
    v_lshlrev_b32 v4, 3, v3
    v_sub_u32 v4, v4, v2
    v_add_u32 v4, 15, v4
    v_min_u32 v4, 31, v4
    s_mov_b32 s43, 0x3e00000
    v_lshrrev_b32 v5, v4, s43
    v_bfe_i32 v6, v5, 0, 1
    v_bfe_i32 v7, v5, 1, 1
    v_and_b32 v6, 0x3f80, v6
    v_and_b32 v7, 0x3f800000, v7
    v_or_b32 v128, v6, v7
    v_bfe_i32 v6, v5, 2, 1
    v_bfe_i32 v7, v5, 3, 1
    v_and_b32 v6, 0x3f80, v6
    v_and_b32 v7, 0x3f800000, v7
    v_or_b32 v129, v6, v7
    v_bfe_i32 v6, v5, 4, 1
    v_bfe_i32 v7, v5, 5, 1
    v_and_b32 v6, 0x3f80, v6
    v_and_b32 v7, 0x3f800000, v7
    v_or_b32 v130, v6, v7
    v_bfe_i32 v6, v5, 6, 1
    v_bfe_i32 v7, v5, 7, 1
    v_and_b32 v6, 0x3f80, v6
    v_and_b32 v7, 0x3f800000, v7
    v_or_b32 v131, v6, v7
    s_mov_b32 s43, 0x1c0000
    v_lshrrev_b32 v5, v4, s43
    v_bfe_i32 v6, v5, 0, 1
    v_bfe_i32 v7, v5, 1, 1
    v_and_b32 v6, 0x3f80, v6
    v_and_b32 v7, 0x3f800000, v7
    v_or_b32 v132, v6, v7
    v_bfe_i32 v6, v5, 2, 1
    v_bfe_i32 v7, v5, 3, 1
    v_and_b32 v6, 0x3f80, v6
    v_and_b32 v7, 0x3f800000, v7
    v_or_b32 v133, v6, v7
    v_bfe_i32 v6, v5, 4, 1
    v_bfe_i32 v7, v5, 5, 1
    v_and_b32 v6, 0x3f80, v6
    v_and_b32 v7, 0x3f800000, v7
    v_or_b32 v134, v6, v7
    v_bfe_i32 v6, v5, 6, 1
    v_bfe_i32 v7, v5, 7, 1
    v_and_b32 v6, 0x3f80, v6
    v_and_b32 v7, 0x3f800000, v7
    v_or_b32 v135, v6, v7
    s_mov_b32 s43, 0xff80000
    v_lshrrev_b32 v5, v4, s43
    v_bfe_i32 v6, v5, 0, 1
    v_bfe_i32 v7, v5, 1, 1
    v_and_b32 v6, 0x3f80, v6
    v_and_b32 v7, 0x3f800000, v7
    v_or_b32 v136, v6, v7
    v_bfe_i32 v6, v5, 2, 1
    v_bfe_i32 v7, v5, 3, 1
    v_and_b32 v6, 0x3f80, v6
    v_and_b32 v7, 0x3f800000, v7
    v_or_b32 v137, v6, v7
    v_bfe_i32 v6, v5, 4, 1
    v_bfe_i32 v7, v5, 5, 1
    v_and_b32 v6, 0x3f80, v6
    v_and_b32 v7, 0x3f800000, v7
    v_or_b32 v138, v6, v7
    v_bfe_i32 v6, v5, 6, 1
    v_bfe_i32 v7, v5, 7, 1
    v_and_b32 v6, 0x3f80, v6
    v_and_b32 v7, 0x3f800000, v7
    v_or_b32 v139, v6, v7
    s_mov_b32 s43, 0x7f00000
    v_lshrrev_b32 v5, v4, s43
    v_bfe_i32 v6, v5, 0, 1
    v_bfe_i32 v7, v5, 1, 1
    v_and_b32 v6, 0x3f80, v6
    v_and_b32 v7, 0x3f800000, v7
    v_or_b32 v140, v6, v7
    v_bfe_i32 v6, v5, 2, 1
    v_bfe_i32 v7, v5, 3, 1
    v_and_b32 v6, 0x3f80, v6
    v_and_b32 v7, 0x3f800000, v7
    v_or_b32 v141, v6, v7
    v_bfe_i32 v6, v5, 4, 1
    v_bfe_i32 v7, v5, 5, 1
    v_and_b32 v6, 0x3f80, v6
    v_and_b32 v7, 0x3f800000, v7
    v_or_b32 v142, v6, v7
    v_bfe_i32 v6, v5, 6, 1
    v_bfe_i32 v7, v5, 7, 1
    v_and_b32 v6, 0x3f80, v6
    v_and_b32 v7, 0x3f800000, v7
    v_or_b32 v143, v6, v7
    s_mov_b32 s43, 0x18000000
    v_lshrrev_b32 v5, v4, s43
    v_bfe_i32 v6, v5, 0, 1
    v_bfe_i32 v7, v5, 1, 1
    v_and_b32 v6, 0xffff, v6
    v_and_b32 v7, 0xffff0000, v7
    v_or_b32 v124, v6, v7
    v_bfe_i32 v6, v5, 2, 1
    v_bfe_i32 v7, v5, 3, 1
    v_and_b32 v6, 0xffff, v6
    v_and_b32 v7, 0xffff0000, v7
    v_or_b32 v125, v6, v7
    v_bfe_i32 v6, v5, 4, 1
    v_bfe_i32 v7, v5, 5, 1
    v_and_b32 v6, 0xffff, v6
    v_and_b32 v7, 0xffff0000, v7
    v_or_b32 v126, v6, v7
    v_bfe_i32 v6, v5, 6, 1
    v_bfe_i32 v7, v5, 7, 1
    v_and_b32 v6, 0xffff, v6
    v_and_b32 v7, 0xffff0000, v7
    v_or_b32 v127, v6, v7
    v_lshlrev_b32 v10, 5, v2
    v_lshl_add_u32 v160, v3, 9, v10
    v_add_u32 v160, s57, v160
    v_add_u32 v160, 1084, v160
    v_and_b32 v12, 1, v3
    v_lshl_add_u32 v161, v12, 4, v10
    v_lshrrev_b32 v12, 1, v3
    v_lshl_add_u32 v161, v12, 9, v161
    v_add3_u32 v161, v161, s57, 64
    v_and_b32 v12, 1, v2
    v_lshrrev_b32 v13, 1, v2
    v_lshlrev_b32 v162, 2, v13
    v_lshl_add_u32 v162, v3, 6, v162
    v_mul_u32_u24 v13, 260, v12
    v_add3_u32 v162, v162, v13, s57
    v_add_u32 v162, 2172, v162
    v_lshlrev_b32 v163, 1, v2
    v_lshl_add_u32 v163, v3, 7, v163
    v_lshl_add_u32 v163, v12, 2, v163
    v_add_u32 v163, s57, v163
    v_add_u32 v163, 2812, v163
    v_mov_b32 v164, v163
    s_add_u32 s43, s57, 2428
    v_writelane_b32 v164, s43, 0
    v_lshl_add_u32 v10, v2, 2, s57
    v_lshlrev_b32 v12, 5, v3
    v_sub_u32 v165, v10, v12
    v_add_u32 v165, 104, v165
    v_add_u32 v166, 1024, v165
    v_add_u32 v167, 2048, v165
    v_lshlrev_b32 v12, 4, v3
    v_sub_u32 v168, v10, v12
    v_add_u32 v168, 2292, v168
    v_mov_b32 v169, 0
    v_writelane_b32 v169, -1, 0
    s_mov_b32 s58, 0
    s_mov_b32 s59, 1
    s_mul_i32 s42, s45, 8448
    s_mov_b32 m0, s42
    s_mov_b32 s60, s42
    s_lshl_b32 s61, s45, 12
    s_add_u32 s61, s61, 129024
    v_lshl_add_u32 v5, v1, 3, s42
    v_mul_u32_u24 v6, 528, v2
    v_and_b32 v10, 1, v3
    v_lshl_add_u32 v6, v10, 8, v6
    v_lshrrev_b32 v10, 1, v3
    v_lshl_add_u32 v6, v10, 4, v6
    v_add_u32 v6, s42, v6
    v_lshlrev_b32 v10, 5, v2
    v_lshl_add_u32 v7, v3, 4, v10
    v_add3_u32 v7, v7, s51, 32
    s_mul_i32 s42, s45, 8512
    s_add_u32 s42, s42, 0
    v_lshl_add_u32 v8, v3, 3, v10
    v_add_u32 v8, s42, v8
    s_waitcnt lgkmcnt(0)
    s_mul_i32 s52, s50, 0x9e3779b1
    s_add_u32 s52, s52, 0x7f4a7c15
    s_waitcnt vmcnt(0)
L_conv_kg:
    s_mov_b32 exec_hi, 0
    buffer_load_dword v170, v11, s[4:7], 0 offen
    s_mov_b32 exec_hi, -1
    s_cmp_lg_u32 s45, 4
    s_cbranch_scc1 L_conv_noack
    s_lshl_b32 s50, s44, 2
    s_add_u32 s50, s50, 2048
    v_mov_b32 v10, s50
    v_mov_b32 v12, s52
    s_mov_b64 exec, 1
    buffer_store_dword v12, v10, s[36:39], 0 offen sc1
    s_mov_b64 exec, -1
L_conv_noack:
    v_lshlrev_b32 v15, 16, v15
    v_lshlrev_b32 v116, 16, v16
    v_and_b32 v117, 0xffff0000, v16
    v_mul_f32 v112, s40, v15
    v_mul_f32 v114, s40, v116
    v_mul_f32 v118, s40, v117
    v_fma_f32 v113, v15, s40, -v112
    v_fma_f32 v115, v116, s40, -v114
    v_fma_f32 v119, v117, s40, -v118
    v_fma_f32 v113, v15, s41, v113
    v_fma_f32 v115, v116, s41, v115
    v_fma_f32 v119, v117, s41, v119
    v_exp_f32 v76, v112
    v_exp_f32 v72, v114
    v_exp_f32 v73, v118
    v_mul_f32 v113, 0x3f317218, v113
    v_mul_f32 v115, 0x3f317218, v115
    v_mul_f32 v119, 0x3f317218, v119
    v_fma_f32 v76, v76, v113, v76
    v_fma_f32 v72, v72, v115, v72
    v_fma_f32 v73, v73, v119, v73
    v_lshlrev_b32 v74, 16, v17
    v_and_b32 v75, 0xffff0000, v17
    v_cvt_pk_bf16_f32 v76, v76, v76
    v_cvt_pk_bf16_f32 v64, v72, v73
    v_and_b32 v76, 0xffff0000, v76
    v_lshlrev_b32 v72, 16, v64
    v_and_b32 v73, 0xffff0000, v64
    v_pk_mul_f32 v[74:75], v[74:75], v[76:77] op_sel_hi:[1,0]
    v_pk_mul_f32 v[72:73], v[72:73], v[76:77] op_sel_hi:[1,0]
    v_mul_f32 v74, 0.15915494, v74
    v_mul_f32 v72, 0xbfb8aa3b, v72
    v_mul_f32 v75, 0.15915494, v75
    v_mul_f32 v73, 0xbfb8aa3b, v73
    v_mul_f32 v112, 0x41000000, v72
    v_mul_f32 v113, 0x41000000, v74
    v_mul_f32 v114, 0x41000000, v73
    v_mul_f32 v115, 0x41000000, v75
    v_exp_f32 v112, v112
    v_fract_f32 v113, v113
    v_exp_f32 v114, v114
    v_fract_f32 v115, v115
    v_cos_f32 v24, v113
    v_sin_f32 v25, v113
    v_cos_f32 v26, v115
    v_sin_f32 v27, v115
    v_pk_mul_f32 v[24:25], v[24:25], v[112:113] op_sel:[0,0] op_sel_hi:[1,0] neg_hi:[1,0]
    v_pk_mul_f32 v[26:27], v[26:27], v[114:115] op_sel:[0,0] op_sel_hi:[1,0] neg_hi:[1,0]
    v_lshlrev_b32 v120, 16, v14
    v_mov_b32 v68, 0x3f80
    v_mov_b32 v69, 0x3f80
    ds_write_addtid_b32 v68 offset:0
    ds_write_addtid_b32 v69 offset:256
    v_cvt_pk_bf16_f32 v70, v24, v25
    v_cvt_pk_bf16_f32 v71, v26, v27
    ds_write_addtid_b32 v70 offset:528
    ds_write_addtid_b32 v71 offset:784
    v_pk_mul_f32 v[64:65], v[24:25], v[24:25] op_sel:[1,1] op_sel_hi:[1,0] neg_lo:[1,0]
    v_pk_mul_f32 v[66:67], v[26:27], v[26:27] op_sel:[1,1] op_sel_hi:[1,0] neg_lo:[1,0]
    v_pk_fma_f32 v[12:13], v[24:25], v[24:25], v[64:65] op_sel:[0,0,0] op_sel_hi:[0,1,1]
    v_pk_fma_f32 v[14:15], v[26:27], v[26:27], v[66:67] op_sel:[0,0,0] op_sel_hi:[0,1,1]
    v_cvt_pk_bf16_f32 v68, v12, v13
    v_cvt_pk_bf16_f32 v69, v14, v15
    ds_write_addtid_b32 v68 offset:1056
    ds_write_addtid_b32 v69 offset:1312
    v_pk_mul_f32 v[64:65], v[12:13], v[24:25] op_sel:[1,1] op_sel_hi:[1,0] neg_lo:[1,0]
    v_pk_mul_f32 v[66:67], v[14:15], v[26:27] op_sel:[1,1] op_sel_hi:[1,0] neg_lo:[1,0]
    v_pk_fma_f32 v[12:13], v[12:13], v[24:25], v[64:65] op_sel:[0,0,0] op_sel_hi:[0,1,1]
    v_pk_fma_f32 v[14:15], v[14:15], v[26:27], v[66:67] op_sel:[0,0,0] op_sel_hi:[0,1,1]
    v_cvt_pk_bf16_f32 v70, v12, v13
    v_cvt_pk_bf16_f32 v71, v14, v15
    ds_write_addtid_b32 v70 offset:1584
    ds_write_addtid_b32 v71 offset:1840
    v_add_f32 v77, v76, v76
    v_add_f32 v120, 1.0, v120
    v_lshlrev_b32 v32, 16, v18
    v_pk_mul_f32 v[64:65], v[12:13], v[24:25] op_sel:[1,1] op_sel_hi:[1,0] neg_lo:[1,0]
    v_pk_mul_f32 v[66:67], v[14:15], v[26:27] op_sel:[1,1] op_sel_hi:[1,0] neg_lo:[1,0]
    v_pk_fma_f32 v[12:13], v[12:13], v[24:25], v[64:65] op_sel:[0,0,0] op_sel_hi:[0,1,1]
    v_pk_fma_f32 v[14:15], v[14:15], v[26:27], v[66:67] op_sel:[0,0,0] op_sel_hi:[0,1,1]
    v_cvt_pk_bf16_f32 v68, v12, v13
    v_cvt_pk_bf16_f32 v69, v14, v15
    ds_write_addtid_b32 v68 offset:2112
    ds_write_addtid_b32 v69 offset:2368
    v_lshlrev_b32 v33, 16, v19
    v_and_b32 v34, 0xffff0000, v18
    v_and_b32 v35, 0xffff0000, v19
    v_pk_mul_f32 v[64:65], v[12:13], v[24:25] op_sel:[1,1] op_sel_hi:[1,0] neg_lo:[1,0]
    v_pk_mul_f32 v[66:67], v[14:15], v[26:27] op_sel:[1,1] op_sel_hi:[1,0] neg_lo:[1,0]
    v_pk_fma_f32 v[12:13], v[12:13], v[24:25], v[64:65] op_sel:[0,0,0] op_sel_hi:[0,1,1]
    v_pk_fma_f32 v[14:15], v[14:15], v[26:27], v[66:67] op_sel:[0,0,0] op_sel_hi:[0,1,1]
    v_cvt_pk_bf16_f32 v70, v12, v13
    v_cvt_pk_bf16_f32 v71, v14, v15
    ds_write_addtid_b32 v70 offset:2640
    ds_write_addtid_b32 v71 offset:2896
    v_and_b32 v169, v169, v120
    v_pk_mul_f32 v[32:33], v[32:33], v[76:77] op_sel:[0,1] op_sel_hi:[1,1]
    v_pk_mul_f32 v[34:35], v[34:35], v[76:77] op_sel:[0,1] op_sel_hi:[1,1]
    v_pk_mul_f32 v[64:65], v[12:13], v[24:25] op_sel:[1,1] op_sel_hi:[1,0] neg_lo:[1,0]
    v_pk_mul_f32 v[66:67], v[14:15], v[26:27] op_sel:[1,1] op_sel_hi:[1,0] neg_lo:[1,0]
    v_pk_fma_f32 v[12:13], v[12:13], v[24:25], v[64:65] op_sel:[0,0,0] op_sel_hi:[0,1,1]
    v_pk_fma_f32 v[14:15], v[14:15], v[26:27], v[66:67] op_sel:[0,0,0] op_sel_hi:[0,1,1]
    v_cvt_pk_bf16_f32 v68, v12, v13
    v_cvt_pk_bf16_f32 v69, v14, v15
    ds_write_addtid_b32 v68 offset:3168
    ds_write_addtid_b32 v69 offset:3424
    v_exp_f32 v112, v72
    v_fract_f32 v113, v74
    v_exp_f32 v114, v73
    v_pk_mul_f32 v[64:65], v[12:13], v[24:25] op_sel:[1,1] op_sel_hi:[1,0] neg_lo:[1,0]
    v_pk_mul_f32 v[66:67], v[14:15], v[26:27] op_sel:[1,1] op_sel_hi:[1,0] neg_lo:[1,0]
    v_pk_fma_f32 v[12:13], v[12:13], v[24:25], v[64:65] op_sel:[0,0,0] op_sel_hi:[0,1,1]
    v_pk_fma_f32 v[14:15], v[14:15], v[26:27], v[66:67] op_sel:[0,0,0] op_sel_hi:[0,1,1]
    v_cvt_pk_bf16_f32 v70, v12, v13
    v_cvt_pk_bf16_f32 v71, v14, v15
    ds_write_addtid_b32 v70 offset:3696
    ds_write_addtid_b32 v71 offset:3952
    v_fract_f32 v115, v75
    v_cos_f32 v20, v113
    v_sin_f32 v21, v113
    v_pk_mul_f32 v[64:65], v[12:13], v[24:25] op_sel:[1,1] op_sel_hi:[1,0] neg_lo:[1,0]
    v_pk_mul_f32 v[66:67], v[14:15], v[26:27] op_sel:[1,1] op_sel_hi:[1,0] neg_lo:[1,0]
    v_pk_fma_f32 v[12:13], v[12:13], v[24:25], v[64:65] op_sel:[0,0,0] op_sel_hi:[0,1,1]
    v_pk_fma_f32 v[14:15], v[14:15], v[26:27], v[66:67] op_sel:[0,0,0] op_sel_hi:[0,1,1]
    v_cvt_pk_bf16_f32 v68, v12, v13
    v_cvt_pk_bf16_f32 v69, v14, v15
    ds_write_addtid_b32 v68 offset:4224
    ds_write_addtid_b32 v69 offset:4480
    v_cos_f32 v22, v115
    v_sin_f32 v23, v115
    v_pk_mul_f32 v[20:21], v[20:21], v[112:113] op_sel:[0,0] op_sel_hi:[1,0]
    v_pk_mul_f32 v[64:65], v[12:13], v[24:25] op_sel:[1,1] op_sel_hi:[1,0] neg_lo:[1,0]
    v_pk_mul_f32 v[66:67], v[14:15], v[26:27] op_sel:[1,1] op_sel_hi:[1,0] neg_lo:[1,0]
    v_pk_fma_f32 v[12:13], v[12:13], v[24:25], v[64:65] op_sel:[0,0,0] op_sel_hi:[0,1,1]
    v_pk_fma_f32 v[14:15], v[14:15], v[26:27], v[66:67] op_sel:[0,0,0] op_sel_hi:[0,1,1]
    v_cvt_pk_bf16_f32 v70, v12, v13
    v_cvt_pk_bf16_f32 v71, v14, v15
    ds_write_addtid_b32 v70 offset:4752
    ds_write_addtid_b32 v71 offset:5008
    v_pk_mul_f32 v[22:23], v[22:23], v[114:115] op_sel:[0,0] op_sel_hi:[1,0]
    v_mul_f32 v112, 0x43000000, v72
    v_mul_f32 v113, 0x43000000, v74
    v_pk_mul_f32 v[64:65], v[12:13], v[24:25] op_sel:[1,1] op_sel_hi:[1,0] neg_lo:[1,0]
    v_pk_mul_f32 v[66:67], v[14:15], v[26:27] op_sel:[1,1] op_sel_hi:[1,0] neg_lo:[1,0]
    v_pk_fma_f32 v[12:13], v[12:13], v[24:25], v[64:65] op_sel:[0,0,0] op_sel_hi:[0,1,1]
    v_pk_fma_f32 v[14:15], v[14:15], v[26:27], v[66:67] op_sel:[0,0,0] op_sel_hi:[0,1,1]
    v_cvt_pk_bf16_f32 v68, v12, v13
    v_cvt_pk_bf16_f32 v69, v14, v15
    ds_write_addtid_b32 v68 offset:5280
    ds_write_addtid_b32 v69 offset:5536
    v_mul_f32 v114, 0x43000000, v73
    v_mul_f32 v115, 0x43000000, v75
    v_exp_f32 v112, v112
    v_pk_mul_f32 v[64:65], v[12:13], v[24:25] op_sel:[1,1] op_sel_hi:[1,0] neg_lo:[1,0]
    v_pk_mul_f32 v[66:67], v[14:15], v[26:27] op_sel:[1,1] op_sel_hi:[1,0] neg_lo:[1,0]
    v_pk_fma_f32 v[12:13], v[12:13], v[24:25], v[64:65] op_sel:[0,0,0] op_sel_hi:[0,1,1]
    v_pk_fma_f32 v[14:15], v[14:15], v[26:27], v[66:67] op_sel:[0,0,0] op_sel_hi:[0,1,1]
    v_cvt_pk_bf16_f32 v70, v12, v13
    v_cvt_pk_bf16_f32 v71, v14, v15
    ds_write_addtid_b32 v70 offset:5808
    s_waitcnt vmcnt(0)
    s_mov_b32 s43, 0
    s_add_u32 m0, s61, 0
    s_nop 0
    buffer_load_dwordx4 v9, s[4:7], s43 offen lds
    s_mov_b32 m0, s60
    s_nop 0
    ds_write_addtid_b32 v71 offset:6064
    v_fract_f32 v113, v113
    v_exp_f32 v114, v114
    v_fract_f32 v115, v115
    v_pk_mul_f32 v[64:65], v[12:13], v[24:25] op_sel:[1,1] op_sel_hi:[1,0] neg_lo:[1,0]
    v_pk_mul_f32 v[66:67], v[14:15], v[26:27] op_sel:[1,1] op_sel_hi:[1,0] neg_lo:[1,0]
    v_pk_fma_f32 v[12:13], v[12:13], v[24:25], v[64:65] op_sel:[0,0,0] op_sel_hi:[0,1,1]
    v_pk_fma_f32 v[14:15], v[14:15], v[26:27], v[66:67] op_sel:[0,0,0] op_sel_hi:[0,1,1]
    v_cvt_pk_bf16_f32 v68, v12, v13
    v_cvt_pk_bf16_f32 v69, v14, v15
    ds_write_addtid_b32 v68 offset:6336
    ds_write_addtid_b32 v69 offset:6592
    v_cos_f32 v28, v113
    v_sin_f32 v29, v113
    v_cos_f32 v30, v115
    v_pk_mul_f32 v[64:65], v[12:13], v[24:25] op_sel:[1,1] op_sel_hi:[1,0] neg_lo:[1,0]
    v_pk_mul_f32 v[66:67], v[14:15], v[26:27] op_sel:[1,1] op_sel_hi:[1,0] neg_lo:[1,0]
    v_pk_fma_f32 v[12:13], v[12:13], v[24:25], v[64:65] op_sel:[0,0,0] op_sel_hi:[0,1,1]
    v_pk_fma_f32 v[14:15], v[14:15], v[26:27], v[66:67] op_sel:[0,0,0] op_sel_hi:[0,1,1]
    v_cvt_pk_bf16_f32 v70, v12, v13
    v_cvt_pk_bf16_f32 v71, v14, v15
    ds_write_addtid_b32 v70 offset:6864
    ds_write_addtid_b32 v71 offset:7120
    v_sin_f32 v31, v115
    v_pk_mul_f32 v[28:29], v[28:29], v[112:113] op_sel:[0,0] op_sel_hi:[1,0]
    v_pk_mul_f32 v[30:31], v[30:31], v[114:115] op_sel:[0,0] op_sel_hi:[1,0]
    v_pk_mul_f32 v[64:65], v[12:13], v[24:25] op_sel:[1,1] op_sel_hi:[1,0] neg_lo:[1,0]
    v_pk_mul_f32 v[66:67], v[14:15], v[26:27] op_sel:[1,1] op_sel_hi:[1,0] neg_lo:[1,0]
    v_pk_fma_f32 v[12:13], v[12:13], v[24:25], v[64:65] op_sel:[0,0,0] op_sel_hi:[0,1,1]
    v_pk_fma_f32 v[14:15], v[14:15], v[26:27], v[66:67] op_sel:[0,0,0] op_sel_hi:[0,1,1]
    v_cvt_pk_bf16_f32 v68, v12, v13
    v_cvt_pk_bf16_f32 v69, v14, v15
    ds_write_addtid_b32 v68 offset:7392
    ds_write_addtid_b32 v69 offset:7648
    v_pk_mul_f32 v[64:65], v[12:13], v[24:25] op_sel:[1,1] op_sel_hi:[1,0] neg_lo:[1,0]
    v_pk_mul_f32 v[66:67], v[14:15], v[26:27] op_sel:[1,1] op_sel_hi:[1,0] neg_lo:[1,0]
    v_pk_fma_f32 v[12:13], v[12:13], v[24:25], v[64:65] op_sel:[0,0,0] op_sel_hi:[0,1,1]
    v_pk_fma_f32 v[14:15], v[14:15], v[26:27], v[66:67] op_sel:[0,0,0] op_sel_hi:[0,1,1]
    v_cvt_pk_bf16_f32 v70, v12, v13
    v_cvt_pk_bf16_f32 v71, v14, v15
    ds_write_addtid_b32 v70 offset:7920
    ds_write_addtid_b32 v71 offset:8176
    ds_read_b128 v[80:83], v6 offset:0
    ds_read_b128 v[84:87], v6 offset:32
    ds_read_b128 v[88:91], v6 offset:64
    ds_read_b128 v[92:95], v6 offset:96
    ds_read_b128 v[96:99], v6 offset:128
    ds_read_b128 v[100:103], v6 offset:160
    ds_read_b128 v[104:107], v6 offset:192
    ds_read_b128 v[108:111], v6 offset:224
    v_cvt_pk_bf16_f32 v68, v32, v33
    v_cvt_pk_bf16_f32 v69, v34, v35
    ds_write_addtid_b32 v68 offset:0
    ds_write_addtid_b32 v69 offset:256
    v_pk_mul_f32 v[64:65], v[32:33], v[20:21] op_sel:[1,1] op_sel_hi:[1,0] neg_lo:[1,0]
    v_pk_mul_f32 v[66:67], v[34:35], v[22:23] op_sel:[1,1] op_sel_hi:[1,0] neg_lo:[1,0]
    v_pk_fma_f32 v[36:37], v[32:33], v[20:21], v[64:65] op_sel:[0,0,0] op_sel_hi:[0,1,1]
    v_pk_fma_f32 v[38:39], v[34:35], v[22:23], v[66:67] op_sel:[0,0,0] op_sel_hi:[0,1,1]
    v_cvt_pk_bf16_f32 v70, v36, v37
    v_cvt_pk_bf16_f32 v71, v38, v39
    ds_write_addtid_b32 v70 offset:528
    ds_write_addtid_b32 v71 offset:784
    v_pk_mul_f32 v[64:65], v[36:37], v[20:21] op_sel:[1,1] op_sel_hi:[1,0] neg_lo:[1,0]
    v_pk_mul_f32 v[66:67], v[38:39], v[22:23] op_sel:[1,1] op_sel_hi:[1,0] neg_lo:[1,0]
    v_pk_fma_f32 v[40:41], v[36:37], v[20:21], v[64:65] op_sel:[0,0,0] op_sel_hi:[0,1,1]
    v_pk_fma_f32 v[42:43], v[38:39], v[22:23], v[66:67] op_sel:[0,0,0] op_sel_hi:[0,1,1]
    v_cvt_pk_bf16_f32 v68, v40, v41
    v_cvt_pk_bf16_f32 v69, v42, v43
    ds_write_addtid_b32 v68 offset:1056
    ds_write_addtid_b32 v69 offset:1312
    v_pk_mul_f32 v[64:65], v[40:41], v[20:21] op_sel:[1,1] op_sel_hi:[1,0] neg_lo:[1,0]
    v_pk_mul_f32 v[66:67], v[42:43], v[22:23] op_sel:[1,1] op_sel_hi:[1,0] neg_lo:[1,0]
    v_pk_fma_f32 v[44:45], v[40:41], v[20:21], v[64:65] op_sel:[0,0,0] op_sel_hi:[0,1,1]
    v_pk_fma_f32 v[46:47], v[42:43], v[22:23], v[66:67] op_sel:[0,0,0] op_sel_hi:[0,1,1]
    v_cvt_pk_bf16_f32 v70, v44, v45
    v_cvt_pk_bf16_f32 v71, v46, v47
    ds_write_addtid_b32 v70 offset:1584
    ds_write_addtid_b32 v71 offset:1840
    v_pk_mul_f32 v[64:65], v[44:45], v[20:21] op_sel:[1,1] op_sel_hi:[1,0] neg_lo:[1,0]
    v_pk_mul_f32 v[66:67], v[46:47], v[22:23] op_sel:[1,1] op_sel_hi:[1,0] neg_lo:[1,0]
    s_mov_b32 s43, 131072
    s_add_u32 m0, s61, 1024
    s_nop 0
    buffer_load_dwordx4 v9, s[4:7], s43 offen lds
    s_mov_b32 m0, s60
    v_pk_fma_f32 v[48:49], v[44:45], v[20:21], v[64:65] op_sel:[0,0,0] op_sel_hi:[0,1,1]
    v_pk_fma_f32 v[50:51], v[46:47], v[22:23], v[66:67] op_sel:[0,0,0] op_sel_hi:[0,1,1]
    v_cvt_pk_bf16_f32 v68, v48, v49
    v_cvt_pk_bf16_f32 v69, v50, v51
    ds_write_addtid_b32 v68 offset:2112
    ds_write_addtid_b32 v69 offset:2368
    v_pk_mul_f32 v[64:65], v[48:49], v[20:21] op_sel:[1,1] op_sel_hi:[1,0] neg_lo:[1,0]
    v_pk_mul_f32 v[66:67], v[50:51], v[22:23] op_sel:[1,1] op_sel_hi:[1,0] neg_lo:[1,0]
    v_pk_fma_f32 v[52:53], v[48:49], v[20:21], v[64:65] op_sel:[0,0,0] op_sel_hi:[0,1,1]
    v_pk_fma_f32 v[54:55], v[50:51], v[22:23], v[66:67] op_sel:[0,0,0] op_sel_hi:[0,1,1]
    v_cvt_pk_bf16_f32 v70, v52, v53
    v_cvt_pk_bf16_f32 v71, v54, v55
    ds_write_addtid_b32 v70 offset:2640
    ds_write_addtid_b32 v71 offset:2896
    v_pk_mul_f32 v[64:65], v[52:53], v[20:21] op_sel:[1,1] op_sel_hi:[1,0] neg_lo:[1,0]
    v_pk_mul_f32 v[66:67], v[54:55], v[22:23] op_sel:[1,1] op_sel_hi:[1,0] neg_lo:[1,0]
    v_pk_fma_f32 v[56:57], v[52:53], v[20:21], v[64:65] op_sel:[0,0,0] op_sel_hi:[0,1,1]
    v_pk_fma_f32 v[58:59], v[54:55], v[22:23], v[66:67] op_sel:[0,0,0] op_sel_hi:[0,1,1]
    v_cvt_pk_bf16_f32 v68, v56, v57
    v_cvt_pk_bf16_f32 v69, v58, v59
    ds_write_addtid_b32 v68 offset:3168
    ds_write_addtid_b32 v69 offset:3424
    v_pk_mul_f32 v[64:65], v[56:57], v[20:21] op_sel:[1,1] op_sel_hi:[1,0] neg_lo:[1,0]
    v_pk_mul_f32 v[66:67], v[58:59], v[22:23] op_sel:[1,1] op_sel_hi:[1,0] neg_lo:[1,0]
    v_pk_fma_f32 v[60:61], v[56:57], v[20:21], v[64:65] op_sel:[0,0,0] op_sel_hi:[0,1,1]
    v_pk_fma_f32 v[62:63], v[58:59], v[22:23], v[66:67] op_sel:[0,0,0] op_sel_hi:[0,1,1]
    v_cvt_pk_bf16_f32 v70, v60, v61
    v_cvt_pk_bf16_f32 v71, v62, v63
    ds_write_addtid_b32 v70 offset:3696
    ds_write_addtid_b32 v71 offset:3952
    v_pk_mul_f32 v[64:65], v[32:33], v[28:29] op_sel:[1,1] op_sel_hi:[1,0] neg_lo:[1,0]
    v_pk_mul_f32 v[66:67], v[34:35], v[30:31] op_sel:[1,1] op_sel_hi:[1,0] neg_lo:[1,0]
    v_pk_fma_f32 v[32:33], v[32:33], v[28:29], v[64:65] op_sel:[0,0,0] op_sel_hi:[0,1,1]
    v_pk_fma_f32 v[34:35], v[34:35], v[30:31], v[66:67] op_sel:[0,0,0] op_sel_hi:[0,1,1]
    v_cvt_pk_bf16_f32 v68, v32, v33
    v_cvt_pk_bf16_f32 v69, v34, v35
    ds_write_addtid_b32 v68 offset:4224
    ds_write_addtid_b32 v69 offset:4480
    v_pk_mul_f32 v[64:65], v[36:37], v[28:29] op_sel:[1,1] op_sel_hi:[1,0] neg_lo:[1,0]
    v_pk_mul_f32 v[66:67], v[38:39], v[30:31] op_sel:[1,1] op_sel_hi:[1,0] neg_lo:[1,0]
    v_pk_fma_f32 v[36:37], v[36:37], v[28:29], v[64:65] op_sel:[0,0,0] op_sel_hi:[0,1,1]
    v_pk_fma_f32 v[38:39], v[38:39], v[30:31], v[66:67] op_sel:[0,0,0] op_sel_hi:[0,1,1]
    v_cvt_pk_bf16_f32 v70, v36, v37
    v_cvt_pk_bf16_f32 v71, v38, v39
    ds_write_addtid_b32 v70 offset:4752
    ds_write_addtid_b32 v71 offset:5008
    v_pk_mul_f32 v[64:65], v[40:41], v[28:29] op_sel:[1,1] op_sel_hi:[1,0] neg_lo:[1,0]
    v_pk_mul_f32 v[66:67], v[42:43], v[30:31] op_sel:[1,1] op_sel_hi:[1,0] neg_lo:[1,0]
    v_pk_fma_f32 v[40:41], v[40:41], v[28:29], v[64:65] op_sel:[0,0,0] op_sel_hi:[0,1,1]
    v_pk_fma_f32 v[42:43], v[42:43], v[30:31], v[66:67] op_sel:[0,0,0] op_sel_hi:[0,1,1]
    v_cvt_pk_bf16_f32 v68, v40, v41
    v_cvt_pk_bf16_f32 v69, v42, v43
    ds_write_addtid_b32 v68 offset:5280
    ds_write_addtid_b32 v69 offset:5536
    v_pk_mul_f32 v[64:65], v[44:45], v[28:29] op_sel:[1,1] op_sel_hi:[1,0] neg_lo:[1,0]
    v_pk_mul_f32 v[66:67], v[46:47], v[30:31] op_sel:[1,1] op_sel_hi:[1,0] neg_lo:[1,0]
    v_pk_fma_f32 v[44:45], v[44:45], v[28:29], v[64:65] op_sel:[0,0,0] op_sel_hi:[0,1,1]
    v_pk_fma_f32 v[46:47], v[46:47], v[30:31], v[66:67] op_sel:[0,0,0] op_sel_hi:[0,1,1]
    v_cvt_pk_bf16_f32 v70, v44, v45
    v_cvt_pk_bf16_f32 v71, v46, v47
    ds_write_addtid_b32 v70 offset:5808
    ds_write_addtid_b32 v71 offset:6064
    v_pk_mul_f32 v[64:65], v[48:49], v[28:29] op_sel:[1,1] op_sel_hi:[1,0] neg_lo:[1,0]
    v_pk_mul_f32 v[66:67], v[50:51], v[30:31] op_sel:[1,1] op_sel_hi:[1,0] neg_lo:[1,0]
    v_pk_fma_f32 v[48:49], v[48:49], v[28:29], v[64:65] op_sel:[0,0,0] op_sel_hi:[0,1,1]
    v_pk_fma_f32 v[50:51], v[50:51], v[30:31], v[66:67] op_sel:[0,0,0] op_sel_hi:[0,1,1]
    v_cvt_pk_bf16_f32 v68, v48, v49
    v_cvt_pk_bf16_f32 v69, v50, v51
    ds_write_addtid_b32 v68 offset:6336
    ds_write_addtid_b32 v69 offset:6592
    v_pk_mul_f32 v[64:65], v[52:53], v[28:29] op_sel:[1,1] op_sel_hi:[1,0] neg_lo:[1,0]
    v_pk_mul_f32 v[66:67], v[54:55], v[30:31] op_sel:[1,1] op_sel_hi:[1,0] neg_lo:[1,0]
    v_pk_fma_f32 v[52:53], v[52:53], v[28:29], v[64:65] op_sel:[0,0,0] op_sel_hi:[0,1,1]
    v_pk_fma_f32 v[54:55], v[54:55], v[30:31], v[66:67] op_sel:[0,0,0] op_sel_hi:[0,1,1]
    v_cvt_pk_bf16_f32 v70, v52, v53
    v_cvt_pk_bf16_f32 v71, v54, v55
    ds_write_addtid_b32 v70 offset:6864
    ds_write_addtid_b32 v71 offset:7120
    v_pk_mul_f32 v[64:65], v[56:57], v[28:29] op_sel:[1,1] op_sel_hi:[1,0] neg_lo:[1,0]
    v_pk_mul_f32 v[66:67], v[58:59], v[30:31] op_sel:[1,1] op_sel_hi:[1,0] neg_lo:[1,0]
    s_mov_b32 s43, 262144
    s_add_u32 m0, s61, 2048
    s_nop 0
    buffer_load_dwordx4 v9, s[4:7], s43 offen lds
    s_mov_b32 m0, s60
    v_pk_fma_f32 v[56:57], v[56:57], v[28:29], v[64:65] op_sel:[0,0,0] op_sel_hi:[0,1,1]
    v_pk_fma_f32 v[58:59], v[58:59], v[30:31], v[66:67] op_sel:[0,0,0] op_sel_hi:[0,1,1]
    v_cvt_pk_bf16_f32 v68, v56, v57
    v_cvt_pk_bf16_f32 v69, v58, v59
    ds_write_addtid_b32 v68 offset:7392
    ds_write_addtid_b32 v69 offset:7648
    v_pk_mul_f32 v[64:65], v[60:61], v[28:29] op_sel:[1,1] op_sel_hi:[1,0] neg_lo:[1,0]
    v_pk_mul_f32 v[66:67], v[62:63], v[30:31] op_sel:[1,1] op_sel_hi:[1,0] neg_lo:[1,0]
    v_pk_fma_f32 v[60:61], v[60:61], v[28:29], v[64:65] op_sel:[0,0,0] op_sel_hi:[0,1,1]
    v_pk_fma_f32 v[62:63], v[62:63], v[30:31], v[66:67] op_sel:[0,0,0] op_sel_hi:[0,1,1]
    v_cvt_pk_bf16_f32 v70, v60, v61
    v_cvt_pk_bf16_f32 v71, v62, v63
    ds_write_addtid_b32 v70 offset:7920
    ds_write_addtid_b32 v71 offset:8176
    ds_read_b128 v[176:179], v6 offset:0
    ds_read_b128 v[180:183], v6 offset:32
    ds_read_b128 v[184:187], v6 offset:64
    ds_read_b128 v[188:191], v6 offset:96
    ds_read_b128 v[192:195], v6 offset:128
    ds_read_b128 v[196:199], v6 offset:160
    ds_read_b128 v[200:203], v6 offset:192
    ds_read_b128 v[204:207], v6 offset:224
    v_pk_mul_f32 v[64:65], v[32:33], v[28:29] op_sel:[1,1] op_sel_hi:[1,0] neg_lo:[1,0]
    v_pk_mul_f32 v[66:67], v[34:35], v[30:31] op_sel:[1,1] op_sel_hi:[1,0] neg_lo:[1,0]
    v_pk_fma_f32 v[32:33], v[32:33], v[28:29], v[64:65] op_sel:[0,0,0] op_sel_hi:[0,1,1]
    v_pk_fma_f32 v[34:35], v[34:35], v[30:31], v[66:67] op_sel:[0,0,0] op_sel_hi:[0,1,1]
    v_cvt_pk_bf16_f32 v68, v32, v33
    v_cvt_pk_bf16_f32 v69, v34, v35
    ds_write_addtid_b32 v68 offset:0
    ds_write_addtid_b32 v69 offset:256
    v_pk_mul_f32 v[64:65], v[40:41], v[28:29] op_sel:[1,1] op_sel_hi:[1,0] neg_lo:[1,0]
    v_pk_mul_f32 v[66:67], v[42:43], v[30:31] op_sel:[1,1] op_sel_hi:[1,0] neg_lo:[1,0]
    v_pk_fma_f32 v[40:41], v[40:41], v[28:29], v[64:65] op_sel:[0,0,0] op_sel_hi:[0,1,1]
    v_pk_fma_f32 v[42:43], v[42:43], v[30:31], v[66:67] op_sel:[0,0,0] op_sel_hi:[0,1,1]
    v_cvt_pk_bf16_f32 v70, v40, v41
    v_cvt_pk_bf16_f32 v71, v42, v43
    ds_write_addtid_b32 v70 offset:528
    ds_write_addtid_b32 v71 offset:784
    v_pk_mul_f32 v[64:65], v[48:49], v[28:29] op_sel:[1,1] op_sel_hi:[1,0] neg_lo:[1,0]
    v_pk_mul_f32 v[66:67], v[50:51], v[30:31] op_sel:[1,1] op_sel_hi:[1,0] neg_lo:[1,0]
    v_pk_fma_f32 v[48:49], v[48:49], v[28:29], v[64:65] op_sel:[0,0,0] op_sel_hi:[0,1,1]
    v_pk_fma_f32 v[50:51], v[50:51], v[30:31], v[66:67] op_sel:[0,0,0] op_sel_hi:[0,1,1]
    v_cvt_pk_bf16_f32 v68, v48, v49
    v_cvt_pk_bf16_f32 v69, v50, v51
    ds_write_addtid_b32 v68 offset:1056
    ds_write_addtid_b32 v69 offset:1312
    v_pk_mul_f32 v[64:65], v[56:57], v[28:29] op_sel:[1,1] op_sel_hi:[1,0] neg_lo:[1,0]
    v_pk_mul_f32 v[66:67], v[58:59], v[30:31] op_sel:[1,1] op_sel_hi:[1,0] neg_lo:[1,0]
    v_pk_fma_f32 v[56:57], v[56:57], v[28:29], v[64:65] op_sel:[0,0,0] op_sel_hi:[0,1,1]
    v_pk_fma_f32 v[58:59], v[58:59], v[30:31], v[66:67] op_sel:[0,0,0] op_sel_hi:[0,1,1]
    v_cvt_pk_bf16_f32 v70, v56, v57
    v_cvt_pk_bf16_f32 v71, v58, v59
    ds_write_addtid_b32 v70 offset:1584
    ds_write_addtid_b32 v71 offset:1840
    s_waitcnt lgkmcnt(15)
    v_mfma_f32_16x16x32_bf16 v[208:211], v[176:179], v[80:83], 0
    v_pk_mul_f32 v[64:65], v[32:33], v[28:29] op_sel:[1,1] op_sel_hi:[1,0] neg_lo:[1,0]
    v_pk_mul_f32 v[66:67], v[34:35], v[30:31] op_sel:[1,1] op_sel_hi:[1,0] neg_lo:[1,0]
    v_pk_fma_f32 v[32:33], v[32:33], v[28:29], v[64:65] op_sel:[0,0,0] op_sel_hi:[0,1,1]
    v_pk_fma_f32 v[34:35], v[34:35], v[30:31], v[66:67] op_sel:[0,0,0] op_sel_hi:[0,1,1]
    v_cvt_pk_bf16_f32 v68, v32, v33
    v_cvt_pk_bf16_f32 v69, v34, v35
    ds_write_addtid_b32 v68 offset:2112
    ds_write_addtid_b32 v69 offset:2368
    s_waitcnt lgkmcnt(15)
    v_mfma_f32_16x16x32_bf16 v[208:211], v[180:183], v[84:87], v[208:211]
    v_pk_mul_f32 v[64:65], v[40:41], v[28:29] op_sel:[1,1] op_sel_hi:[1,0] neg_lo:[1,0]
    v_pk_mul_f32 v[66:67], v[42:43], v[30:31] op_sel:[1,1] op_sel_hi:[1,0] neg_lo:[1,0]
    v_pk_fma_f32 v[40:41], v[40:41], v[28:29], v[64:65] op_sel:[0,0,0] op_sel_hi:[0,1,1]
    v_pk_fma_f32 v[42:43], v[42:43], v[30:31], v[66:67] op_sel:[0,0,0] op_sel_hi:[0,1,1]
    v_cvt_pk_bf16_f32 v70, v40, v41
    v_cvt_pk_bf16_f32 v71, v42, v43
    ds_write_addtid_b32 v70 offset:2640
    ds_write_addtid_b32 v71 offset:2896
    v_mfma_f32_16x16x32_bf16 v[208:211], v[184:187], v[88:91], v[208:211]
    v_pk_mul_f32 v[64:65], v[48:49], v[28:29] op_sel:[1,1] op_sel_hi:[1,0] neg_lo:[1,0]
    v_pk_mul_f32 v[66:67], v[50:51], v[30:31] op_sel:[1,1] op_sel_hi:[1,0] neg_lo:[1,0]
    v_pk_fma_f32 v[48:49], v[48:49], v[28:29], v[64:65] op_sel:[0,0,0] op_sel_hi:[0,1,1]
    v_pk_fma_f32 v[50:51], v[50:51], v[30:31], v[66:67] op_sel:[0,0,0] op_sel_hi:[0,1,1]
    v_cvt_pk_bf16_f32 v68, v48, v49
    s_mov_b32 s43, 393216
    s_add_u32 m0, s61, 3072
    s_nop 0
    buffer_load_dwordx4 v9, s[4:7], s43 offen lds
    s_mov_b32 m0, s60
    v_cvt_pk_bf16_f32 v69, v50, v51
    ds_write_addtid_b32 v68 offset:3168
    ds_write_addtid_b32 v69 offset:3424
    s_waitcnt lgkmcnt(15)
    v_mfma_f32_16x16x32_bf16 v[208:211], v[188:191], v[92:95], v[208:211]
    v_pk_mul_f32 v[64:65], v[56:57], v[28:29] op_sel:[1,1] op_sel_hi:[1,0] neg_lo:[1,0]
    v_pk_mul_f32 v[66:67], v[58:59], v[30:31] op_sel:[1,1] op_sel_hi:[1,0] neg_lo:[1,0]
    v_pk_fma_f32 v[56:57], v[56:57], v[28:29], v[64:65] op_sel:[0,0,0] op_sel_hi:[0,1,1]
    v_pk_fma_f32 v[58:59], v[58:59], v[30:31], v[66:67] op_sel:[0,0,0] op_sel_hi:[0,1,1]
    v_cvt_pk_bf16_f32 v70, v56, v57
    v_cvt_pk_bf16_f32 v71, v58, v59
    ds_write_addtid_b32 v70 offset:3696
    ds_write_addtid_b32 v71 offset:3952
    v_mfma_f32_16x16x32_bf16 v[208:211], v[192:195], v[96:99], v[208:211]
    v_pk_mul_f32 v[64:65], v[32:33], v[28:29] op_sel:[1,1] op_sel_hi:[1,0] neg_lo:[1,0]
    v_pk_mul_f32 v[66:67], v[34:35], v[30:31] op_sel:[1,1] op_sel_hi:[1,0] neg_lo:[1,0]
    v_pk_fma_f32 v[32:33], v[32:33], v[28:29], v[64:65] op_sel:[0,0,0] op_sel_hi:[0,1,1]
    v_pk_fma_f32 v[34:35], v[34:35], v[30:31], v[66:67] op_sel:[0,0,0] op_sel_hi:[0,1,1]
    v_cvt_pk_bf16_f32 v68, v32, v33
    v_cvt_pk_bf16_f32 v69, v34, v35
    ds_write_addtid_b32 v68 offset:4224
    ds_write_addtid_b32 v69 offset:4480
    v_mfma_f32_16x16x32_bf16 v[208:211], v[196:199], v[100:103], v[208:211]
    v_pk_mul_f32 v[64:65], v[48:49], v[28:29] op_sel:[1,1] op_sel_hi:[1,0] neg_lo:[1,0]
    v_pk_mul_f32 v[66:67], v[50:51], v[30:31] op_sel:[1,1] op_sel_hi:[1,0] neg_lo:[1,0]
    v_pk_fma_f32 v[48:49], v[48:49], v[28:29], v[64:65] op_sel:[0,0,0] op_sel_hi:[0,1,1]
    v_pk_fma_f32 v[50:51], v[50:51], v[30:31], v[66:67] op_sel:[0,0,0] op_sel_hi:[0,1,1]
    v_cvt_pk_bf16_f32 v70, v48, v49
    v_cvt_pk_bf16_f32 v71, v50, v51
    ds_write_addtid_b32 v70 offset:4752
    ds_write_addtid_b32 v71 offset:5008
    v_mfma_f32_16x16x32_bf16 v[208:211], v[200:203], v[104:107], v[208:211]
    v_pk_mul_f32 v[64:65], v[32:33], v[28:29] op_sel:[1,1] op_sel_hi:[1,0] neg_lo:[1,0]
    v_pk_mul_f32 v[66:67], v[34:35], v[30:31] op_sel:[1,1] op_sel_hi:[1,0] neg_lo:[1,0]
    v_pk_fma_f32 v[32:33], v[32:33], v[28:29], v[64:65] op_sel:[0,0,0] op_sel_hi:[0,1,1]
    v_pk_fma_f32 v[34:35], v[34:35], v[30:31], v[66:67] op_sel:[0,0,0] op_sel_hi:[0,1,1]
    v_cvt_pk_bf16_f32 v68, v32, v33
    v_cvt_pk_bf16_f32 v69, v34, v35
    ds_write_addtid_b32 v68 offset:5280
    ds_write_addtid_b32 v69 offset:5536
    s_waitcnt lgkmcnt(15)
    v_mfma_f32_16x16x32_bf16 v[208:211], v[204:207], v[108:111], v[208:211]
    v_pk_mul_f32 v[64:65], v[48:49], v[28:29] op_sel:[1,1] op_sel_hi:[1,0] neg_lo:[1,0]
    v_pk_mul_f32 v[66:67], v[50:51], v[30:31] op_sel:[1,1] op_sel_hi:[1,0] neg_lo:[1,0]
    v_pk_fma_f32 v[48:49], v[48:49], v[28:29], v[64:65] op_sel:[0,0,0] op_sel_hi:[0,1,1]
    v_pk_fma_f32 v[50:51], v[50:51], v[30:31], v[66:67] op_sel:[0,0,0] op_sel_hi:[0,1,1]
    v_cvt_pk_bf16_f32 v70, v48, v49
    v_cvt_pk_bf16_f32 v71, v50, v51
    ds_write_addtid_b32 v70 offset:5808
    ds_write_addtid_b32 v71 offset:6064
    v_pk_mul_f32 v[64:65], v[32:33], v[28:29] op_sel:[1,1] op_sel_hi:[1,0] neg_lo:[1,0]
    v_pk_mul_f32 v[66:67], v[34:35], v[30:31] op_sel:[1,1] op_sel_hi:[1,0] neg_lo:[1,0]
    v_pk_fma_f32 v[32:33], v[32:33], v[28:29], v[64:65] op_sel:[0,0,0] op_sel_hi:[0,1,1]
    v_pk_fma_f32 v[34:35], v[34:35], v[30:31], v[66:67] op_sel:[0,0,0] op_sel_hi:[0,1,1]
    v_cvt_pk_bf16_f32 v68, v32, v33
    v_cvt_pk_bf16_f32 v69, v34, v35
    ds_write_addtid_b32 v68 offset:6336
    ds_write_addtid_b32 v69 offset:6592
    v_pk_mul_f32 v[64:65], v[48:49], v[28:29] op_sel:[1,1] op_sel_hi:[1,0] neg_lo:[1,0]
    v_pk_mul_f32 v[66:67], v[50:51], v[30:31] op_sel:[1,1] op_sel_hi:[1,0] neg_lo:[1,0]
    v_pk_fma_f32 v[48:49], v[48:49], v[28:29], v[64:65] op_sel:[0,0,0] op_sel_hi:[0,1,1]
    v_pk_fma_f32 v[50:51], v[50:51], v[30:31], v[66:67] op_sel:[0,0,0] op_sel_hi:[0,1,1]
    v_cvt_pk_bf16_f32 v70, v48, v49
    v_cvt_pk_bf16_f32 v71, v50, v51
    ds_write_addtid_b32 v70 offset:6864
    ds_write_addtid_b32 v71 offset:7120
    v_pk_mul_f32 v[64:65], v[32:33], v[28:29] op_sel:[1,1] op_sel_hi:[1,0] neg_lo:[1,0]
    v_pk_mul_f32 v[66:67], v[34:35], v[30:31] op_sel:[1,1] op_sel_hi:[1,0] neg_lo:[1,0]
    v_pk_fma_f32 v[32:33], v[32:33], v[28:29], v[64:65] op_sel:[0,0,0] op_sel_hi:[0,1,1]
    v_pk_fma_f32 v[34:35], v[34:35], v[30:31], v[66:67] op_sel:[0,0,0] op_sel_hi:[0,1,1]
    v_cvt_pk_bf16_f32 v68, v32, v33
    v_cvt_pk_bf16_f32 v69, v34, v35
    ds_write_addtid_b32 v68 offset:7392
    ds_write_addtid_b32 v69 offset:7648
    v_pk_mul_f32 v[64:65], v[48:49], v[28:29] op_sel:[1,1] op_sel_hi:[1,0] neg_lo:[1,0]
    v_pk_mul_f32 v[66:67], v[50:51], v[30:31] op_sel:[1,1] op_sel_hi:[1,0] neg_lo:[1,0]
    v_pk_fma_f32 v[48:49], v[48:49], v[28:29], v[64:65] op_sel:[0,0,0] op_sel_hi:[0,1,1]
    v_pk_fma_f32 v[50:51], v[50:51], v[30:31], v[66:67] op_sel:[0,0,0] op_sel_hi:[0,1,1]
    v_cvt_pk_bf16_f32 v70, v48, v49
    v_cvt_pk_bf16_f32 v71, v50, v51
    ds_write_addtid_b32 v70 offset:7920
    ds_write_addtid_b32 v71 offset:8176
    ds_read_b128 v[176:179], v6 offset:0
    ds_read_b128 v[180:183], v6 offset:32
    ds_read_b128 v[184:187], v6 offset:64
    ds_read_b128 v[188:191], v6 offset:96
    ds_read_b128 v[192:195], v6 offset:128
    ds_read_b128 v[196:199], v6 offset:160
    ds_read_b128 v[200:203], v6 offset:192
    ds_read_b128 v[204:207], v6 offset:224
    v_pk_mul_f32 v[64:65], v[32:33], v[28:29] op_sel:[1,1] op_sel_hi:[1,0] neg_lo:[1,0]
    v_pk_mul_f32 v[66:67], v[34:35], v[30:31] op_sel:[1,1] op_sel_hi:[1,0] neg_lo:[1,0]
    v_pk_fma_f32 v[32:33], v[32:33], v[28:29], v[64:65] op_sel:[0,0,0] op_sel_hi:[0,1,1]
    v_pk_fma_f32 v[34:35], v[34:35], v[30:31], v[66:67] op_sel:[0,0,0] op_sel_hi:[0,1,1]
    v_cvt_pk_bf16_f32 v68, v32, v33
    v_cvt_pk_bf16_f32 v69, v34, v35
    ds_write_addtid_b32 v68 offset:0
    ds_write_addtid_b32 v69 offset:256
    v_pk_mul_f32 v[64:65], v[32:33], v[28:29] op_sel:[1,1] op_sel_hi:[1,0] neg_lo:[1,0]
    v_pk_mul_f32 v[66:67], v[34:35], v[30:31] op_sel:[1,1] op_sel_hi:[1,0] neg_lo:[1,0]
    v_pk_fma_f32 v[32:33], v[32:33], v[28:29], v[64:65] op_sel:[0,0,0] op_sel_hi:[0,1,1]
    v_pk_fma_f32 v[34:35], v[34:35], v[30:31], v[66:67] op_sel:[0,0,0] op_sel_hi:[0,1,1]
    v_cvt_pk_bf16_f32 v70, v32, v33
    v_cvt_pk_bf16_f32 v71, v34, v35
    ds_write_addtid_b32 v70 offset:528
    ds_write_addtid_b32 v71 offset:784
    v_pk_mul_f32 v[64:65], v[32:33], v[28:29] op_sel:[1,1] op_sel_hi:[1,0] neg_lo:[1,0]
    v_pk_mul_f32 v[66:67], v[34:35], v[30:31] op_sel:[1,1] op_sel_hi:[1,0] neg_lo:[1,0]
    v_pk_fma_f32 v[32:33], v[32:33], v[28:29], v[64:65] op_sel:[0,0,0] op_sel_hi:[0,1,1]
    v_pk_fma_f32 v[34:35], v[34:35], v[30:31], v[66:67] op_sel:[0,0,0] op_sel_hi:[0,1,1]
    v_cvt_pk_bf16_f32 v68, v32, v33
    v_cvt_pk_bf16_f32 v69, v34, v35
    ds_write_addtid_b32 v68 offset:1056
    ds_write_addtid_b32 v69 offset:1312
    s_waitcnt lgkmcnt(13)
    v_mfma_f32_16x16x32_bf16 v[212:215], v[176:179], v[80:83], 0
    v_pk_mul_f32 v[64:65], v[32:33], v[28:29] op_sel:[1,1] op_sel_hi:[1,0] neg_lo:[1,0]
    v_pk_mul_f32 v[66:67], v[34:35], v[30:31] op_sel:[1,1] op_sel_hi:[1,0] neg_lo:[1,0]
    v_pk_fma_f32 v[32:33], v[32:33], v[28:29], v[64:65] op_sel:[0,0,0] op_sel_hi:[0,1,1]
    v_pk_fma_f32 v[34:35], v[34:35], v[30:31], v[66:67] op_sel:[0,0,0] op_sel_hi:[0,1,1]
    v_cvt_pk_bf16_f32 v70, v32, v33
    v_cvt_pk_bf16_f32 v71, v34, v35
    ds_write_addtid_b32 v70 offset:1584
    ds_write_addtid_b32 v71 offset:1840
    s_waitcnt lgkmcnt(14)
    v_mfma_f32_16x16x32_bf16 v[212:215], v[180:183], v[84:87], v[212:215]
    v_pk_mul_f32 v[64:65], v[32:33], v[28:29] op_sel:[1,1] op_sel_hi:[1,0] neg_lo:[1,0]
    v_pk_mul_f32 v[66:67], v[34:35], v[30:31] op_sel:[1,1] op_sel_hi:[1,0] neg_lo:[1,0]
    v_pk_fma_f32 v[32:33], v[32:33], v[28:29], v[64:65] op_sel:[0,0,0] op_sel_hi:[0,1,1]
    v_pk_fma_f32 v[34:35], v[34:35], v[30:31], v[66:67] op_sel:[0,0,0] op_sel_hi:[0,1,1]
    v_cvt_pk_bf16_f32 v68, v32, v33
    v_cvt_pk_bf16_f32 v69, v34, v35
    ds_write_addtid_b32 v68 offset:2112
    ds_write_addtid_b32 v69 offset:2368
    s_waitcnt lgkmcnt(15)
    v_mfma_f32_16x16x32_bf16 v[212:215], v[184:187], v[88:91], v[212:215]
    v_pk_mul_f32 v[64:65], v[32:33], v[28:29] op_sel:[1,1] op_sel_hi:[1,0] neg_lo:[1,0]
    v_pk_mul_f32 v[66:67], v[34:35], v[30:31] op_sel:[1,1] op_sel_hi:[1,0] neg_lo:[1,0]
    v_pk_fma_f32 v[32:33], v[32:33], v[28:29], v[64:65] op_sel:[0,0,0] op_sel_hi:[0,1,1]
    v_pk_fma_f32 v[34:35], v[34:35], v[30:31], v[66:67] op_sel:[0,0,0] op_sel_hi:[0,1,1]
    v_cvt_pk_bf16_f32 v70, v32, v33
    v_cvt_pk_bf16_f32 v71, v34, v35
    ds_write_addtid_b32 v70 offset:2640
    ds_write_addtid_b32 v71 offset:2896
    s_waitcnt lgkmcnt(15)
    v_mfma_f32_16x16x32_bf16 v[212:215], v[188:191], v[92:95], v[212:215]
    v_pk_mul_f32 v[64:65], v[32:33], v[28:29] op_sel:[1,1] op_sel_hi:[1,0] neg_lo:[1,0]
    v_pk_mul_f32 v[66:67], v[34:35], v[30:31] op_sel:[1,1] op_sel_hi:[1,0] neg_lo:[1,0]
    v_pk_fma_f32 v[32:33], v[32:33], v[28:29], v[64:65] op_sel:[0,0,0] op_sel_hi:[0,1,1]
    v_pk_fma_f32 v[34:35], v[34:35], v[30:31], v[66:67] op_sel:[0,0,0] op_sel_hi:[0,1,1]
    v_cvt_pk_bf16_f32 v68, v32, v33
    v_cvt_pk_bf16_f32 v69, v34, v35
    ds_write_addtid_b32 v68 offset:3168
    ds_write_addtid_b32 v69 offset:3424
    v_mfma_f32_16x16x32_bf16 v[212:215], v[192:195], v[96:99], v[212:215]
    v_pk_mul_f32 v[64:65], v[32:33], v[28:29] op_sel:[1,1] op_sel_hi:[1,0] neg_lo:[1,0]
    v_pk_mul_f32 v[66:67], v[34:35], v[30:31] op_sel:[1,1] op_sel_hi:[1,0] neg_lo:[1,0]
    v_pk_fma_f32 v[32:33], v[32:33], v[28:29], v[64:65] op_sel:[0,0,0] op_sel_hi:[0,1,1]
    v_pk_fma_f32 v[34:35], v[34:35], v[30:31], v[66:67] op_sel:[0,0,0] op_sel_hi:[0,1,1]
    v_cvt_pk_bf16_f32 v70, v32, v33
    v_cvt_pk_bf16_f32 v71, v34, v35
    ds_write_addtid_b32 v70 offset:3696
    ds_write_addtid_b32 v71 offset:3952
    s_waitcnt lgkmcnt(15)
    v_mfma_f32_16x16x32_bf16 v[212:215], v[196:199], v[100:103], v[212:215]
    v_pk_mul_f32 v[64:65], v[32:33], v[28:29] op_sel:[1,1] op_sel_hi:[1,0] neg_lo:[1,0]
    v_pk_mul_f32 v[66:67], v[34:35], v[30:31] op_sel:[1,1] op_sel_hi:[1,0] neg_lo:[1,0]
    v_pk_fma_f32 v[32:33], v[32:33], v[28:29], v[64:65] op_sel:[0,0,0] op_sel_hi:[0,1,1]
    v_pk_fma_f32 v[34:35], v[34:35], v[30:31], v[66:67] op_sel:[0,0,0] op_sel_hi:[0,1,1]
    v_cvt_pk_bf16_f32 v68, v32, v33
    v_cvt_pk_bf16_f32 v69, v34, v35
    ds_write_addtid_b32 v68 offset:4224
    ds_write_addtid_b32 v69 offset:4480
    v_mfma_f32_16x16x32_bf16 v[212:215], v[200:203], v[104:107], v[212:215]
    v_mfma_f32_16x16x32_bf16 v[212:215], v[204:207], v[108:111], v[212:215]
    ds_read_b128 v[176:179], v6 offset:0
    ds_read_b128 v[180:183], v6 offset:32
    ds_read_b128 v[184:187], v6 offset:64
    ds_read_b128 v[188:191], v6 offset:96
    ds_read_b128 v[192:195], v6 offset:128
    ds_read_b128 v[196:199], v6 offset:160
    ds_read_b128 v[200:203], v6 offset:192
    ds_read_b128 v[204:207], v6 offset:224
    v_add_f32 v208, v208, v169
    v_cndmask_b32 v72, v213, v212, s[58:59]
    v_cndmask_b32 v73, v214, v213, s[58:59]
    v_cndmask_b32 v74, v215, 0, s[58:59]
    v_cvt_pk_bf16_f32 v76, v212, v213
    v_cvt_pk_bf16_f32 v77, v214, v215
    s_waitcnt lgkmcnt(7)
    v_mfma_f32_16x16x32_bf16 v[216:219], v[176:179], v[80:83], 0
    s_waitcnt lgkmcnt(6)
    v_mfma_f32_16x16x32_bf16 v[216:219], v[180:183], v[84:87], v[216:219]
    v_cvt_pk_bf16_f32 v64, v212, v212
    v_cvt_pk_bf16_f32 v65, v212, v212
    v_cvt_pk_bf16_f32 v66, v72, v212
    v_cvt_pk_bf16_f32 v67, v73, v72
    s_waitcnt lgkmcnt(5)
    v_mfma_f32_16x16x32_bf16 v[216:219], v[184:187], v[88:91], v[216:219]
    s_waitcnt lgkmcnt(4)
    v_mfma_f32_16x16x32_bf16 v[216:219], v[188:191], v[92:95], v[216:219]
    v_cvt_pk_bf16_f32 v68, v73, v73
    v_cvt_pk_bf16_f32 v69, v73, v73
    v_cvt_pk_bf16_f32 v70, v74, v73
    v_cvt_pk_bf16_f32 v71, v74, v74
    s_waitcnt lgkmcnt(3)
    v_mfma_f32_16x16x32_bf16 v[216:219], v[192:195], v[96:99], v[216:219]
    s_waitcnt lgkmcnt(2)
    v_mfma_f32_16x16x32_bf16 v[216:219], v[196:199], v[100:103], v[216:219]
    v_cndmask_b32 v76, v76, 0, s[58:59]
    s_mov_b32 exec_hi, 1
    ds_write_b128 v160, v[64:67] offset:4
    ds_write_b128 v160, v[68:71] offset:20
    ds_write_b16 v160, v64
    s_mov_b32 exec_hi, -1
    s_waitcnt lgkmcnt(4)
    v_mfma_f32_16x16x32_bf16 v[216:219], v[200:203], v[104:107], v[216:219]
    s_waitcnt lgkmcnt(3)
    v_mfma_f32_16x16x32_bf16 v[216:219], v[204:207], v[108:111], v[216:219]
    v_cvt_pk_bf16_f32 v72, v208, v211
    v_cvt_pk_bf16_f32 v73, v209, v208
    v_cvt_pk_bf16_f32 v74, v210, v209
    v_cvt_pk_bf16_f32 v75, v211, v210
    ds_write_b16 v161, v72
    ds_write2_b32 v161, v73, v74 offset0:1 offset1:2
    ds_write_b32 v161, v75 offset:12
    ds_write_b16_d16_hi v161, v72 offset:18
    s_mov_b32 exec_lo, 0
    ds_write2_b32 v162, v76, v77 offset0:0 offset1:8
    s_mov_b32 exec_lo, -1
    v_cvt_pk_bf16_f32 v100, v216, v217
    v_cvt_pk_bf16_f32 v101, v218, v219
    v_cvt_pk_bf16_f32 v102, v216, v216
    s_mov_b32 exec_hi, 1
    ds_write_b16 v164, v100
    s_mov_b32 exec_hi, 0
    ds_write_b16_d16_hi v163, v100 offset:32
    ds_write_b16 v163, v101 offset:64
    ds_write_b16_d16_hi v163, v101 offset:96
    s_mov_b32 exec_hi, -1
    v_readlane_b32 s42, v102, 0
    s_nop 1
    v_and_b32 v124, s42, v124
    v_and_b32 v125, s42, v125
    v_and_b32 v126, s42, v126
    v_and_b32 v127, s42, v127
    v_lshlrev_b32 v6, 3, v0
    v_add_u32 v6, 92672, v6
    v_and_b32 v12, 1, v0
    v_lshlrev_b32 v12, 13, v12
    v_lshrrev_b32 v13, 1, v0
    v_lshl_add_u32 v12, v13, 4, v12
    v_add_u32 v9, 4096, v12
    v_bfe_u32 v13, v0, 2, 2
    v_lshlrev_b32 v13, 4, v13
    v_lshl_add_u32 v12, v0, 6, v13
    v_add_u32 v12, 129024, v12
    s_waitcnt vmcnt(0)
    buffer_load_dwordx4 v[144:147], v9, s[36:39], 0 offen sc1
    buffer_load_dwordx4 v[148:151], v9, s[36:39], s53 offen sc1
    ds_read_b128 v[224:227], v12
    v_xor_b32 v13, 16, v12
    ds_read_b128 v[228:231], v13
    v_xor_b32 v13, 32, v12
    ds_read_b128 v[232:235], v13
    v_xor_b32 v13, 48, v12
    ds_read_b128 v[236:239], v13
    v_bfe_u32 v10, v0, 2, 2
    v_mul_u32_u24 v10, 8512, v10
    v_lshrrev_b32 v11, 4, v0
    v_lshl_add_u32 v10, v11, 5, v10
    v_and_b32 v11, 3, v0
    v_lshl_add_u32 v4, v11, 3, v10
    v_lshlrev_b32 v11, 11, v0
    v_add_u32 v5, s49, v11
    s_mov_b32 s54, 0x100000
    s_mov_b32 s55, 0x200000
    v_and_b32 v10, 7, v1
    v_lshlrev_b32 v10, 4, v10
    s_lshl_b32 s43, s56, 7
    s_add_u32 s43, s43, 24576
    v_add_u32 v254, s43, v10
    v_xor_b32 v10, v0, v3
    v_lshlrev_b32 v10, 4, v10
    v_add_u32 v255, 129024, v10
    v_mov_b32 v12, v165
    v_mov_b32 v13, v166
    v_mov_b32 v14, v167
    v_mov_b32 v15, v168
    s_waitcnt lgkmcnt(0)
    v_lshlrev_b32 v176, 16, v224
    v_and_b32 v180, 0xffff0000, v224
    v_lshlrev_b32 v184, 16, v225
    v_and_b32 v188, 0xffff0000, v225
    ds_read2_b32 v[96:97], v15 offset0:67 offset1:66
    v_lshlrev_b32 v192, 16, v226
    v_and_b32 v196, 0xffff0000, v226
    v_lshlrev_b32 v200, 16, v227
    v_and_b32 v204, 0xffff0000, v227
    ds_read2_b32 v[98:99], v15 offset0:65 offset1:64
    v_lshlrev_b32 v177, 16, v228
    v_and_b32 v181, 0xffff0000, v228
    v_lshlrev_b32 v185, 16, v229
    v_and_b32 v189, 0xffff0000, v229
    ds_read2_b32 v[100:101], v15 offset0:83 offset1:82
    v_lshlrev_b32 v193, 16, v230
    v_and_b32 v197, 0xffff0000, v230
    v_lshlrev_b32 v201, 16, v231
    v_and_b32 v205, 0xffff0000, v231
    ds_read2_b32 v[102:103], v15 offset0:81 offset1:80
    v_lshlrev_b32 v178, 16, v232
    v_and_b32 v182, 0xffff0000, v232
    v_lshlrev_b32 v186, 16, v233
    v_and_b32 v190, 0xffff0000, v233
    ds_read2_b32 v[104:105], v15 offset0:99 offset1:98
    v_lshlrev_b32 v194, 16, v234
    v_and_b32 v198, 0xffff0000, v234
    v_lshlrev_b32 v202, 16, v235
    v_and_b32 v206, 0xffff0000, v235
    ds_read2_b32 v[106:107], v15 offset0:97 offset1:96
    v_lshlrev_b32 v179, 16, v236
    v_and_b32 v183, 0xffff0000, v236
    v_lshlrev_b32 v187, 16, v237
    v_and_b32 v191, 0xffff0000, v237
    ds_read2_b32 v[84:85], v15 offset0:3 offset1:2
    v_lshlrev_b32 v195, 16, v238
    v_and_b32 v199, 0xffff0000, v238
    v_lshlrev_b32 v203, 16, v239
    v_and_b32 v207, 0xffff0000, v239
    ds_read2_b32 v[86:87], v15 offset0:1 offset1:0
    s_mov_b32 s43, 0
L_poll_conv:
    s_waitcnt vmcnt(0)
    v_cmp_ne_u32 s[8:9], s52, v147
    v_cmp_ne_u32 s[10:11], s52, v151
    s_or_b64 vcc, s[8:9], s[10:11]
    s_cbranch_scc0 L_polled_conv
    s_add_u32 s43, s43, 1
    s_cmp_ge_u32 s43, 65536
    s_cbranch_scc1 L_polled_conv
    s_sleep 2
    s_mov_b64 exec, s[8:9]
    s_cbranch_execz L_ps_conv_0
    buffer_load_dwordx4 v[144:147], v9, s[36:39], 0 offen sc1
L_ps_conv_0:
    s_mov_b64 exec, s[10:11]
    s_cbranch_execz L_ps_conv_1
    buffer_load_dwordx4 v[148:151], v9, s[36:39], s53 offen sc1
L_ps_conv_1:
    s_mov_b64 exec, -1
    s_branch L_poll_conv
L_polled_conv:
    v_and_b32 v160, 0xffff0000, v144
    v_and_b32 v161, 0xffff0000, v145
    v_and_b32 v162, 0xffff0000, v148
    v_and_b32 v163, 0xffff0000, v149
    v_rcp_f32 v160, v160
    ds_read2_b32 v[88:89], v15 offset0:19 offset1:18
    v_rcp_f32 v161, v161
    ds_read2_b32 v[90:91], v15 offset0:17 offset1:16
    v_rcp_f32 v162, v162
    ds_read2_b32 v[92:93], v15 offset0:35 offset1:34
    v_rcp_f32 v163, v163
    ds_read2_b32 v[94:95], v15 offset0:33 offset1:32
    v_lshlrev_b32 v164, 16, v144
    v_lshlrev_b32 v165, 16, v145
    v_lshlrev_b32 v166, 16, v148
    v_lshlrev_b32 v167, 16, v149
    v_pk_mul_f32 v[164:165], v[164:165], v[160:161] neg_lo:[1,0] neg_hi:[1,0]
    v_pk_mul_f32 v[166:167], v[166:167], v[162:163] neg_lo:[1,0] neg_hi:[1,0]
    v_pk_fma_f32 v[176:177], v[176:177], v[160:161], v[164:165]
    v_pk_fma_f32 v[178:179], v[178:179], v[162:163], v[166:167]
    v_cvt_pk_bf16_f32 v208, v176, v177
    v_cvt_pk_bf16_f32 v209, v178, v179
    ds_write_b64 v6, v[208:209] offset:0
    v_pk_fma_f32 v[180:181], v[180:181], v[160:161], v[164:165]
    v_pk_fma_f32 v[182:183], v[182:183], v[162:163], v[166:167]
    v_cvt_pk_bf16_f32 v210, v180, v181
    v_cvt_pk_bf16_f32 v211, v182, v183
    ds_write_b64 v6, v[210:211] offset:4608
    v_pk_fma_f32 v[184:185], v[184:185], v[160:161], v[164:165]
    v_pk_fma_f32 v[186:187], v[186:187], v[162:163], v[166:167]
    v_cvt_pk_bf16_f32 v212, v184, v185
    v_cvt_pk_bf16_f32 v213, v186, v187
    ds_write_b64 v6, v[212:213] offset:9216
    v_pk_fma_f32 v[188:189], v[188:189], v[160:161], v[164:165]
    v_pk_fma_f32 v[190:191], v[190:191], v[162:163], v[166:167]
    v_cvt_pk_bf16_f32 v214, v188, v189
    v_cvt_pk_bf16_f32 v215, v190, v191
    ds_write_b64 v6, v[214:215] offset:13824
    v_pk_fma_f32 v[192:193], v[192:193], v[160:161], v[164:165]
    v_pk_fma_f32 v[194:195], v[194:195], v[162:163], v[166:167]
    v_cvt_pk_bf16_f32 v216, v192, v193
    v_cvt_pk_bf16_f32 v217, v194, v195
    ds_write_b64 v6, v[216:217] offset:18432
    v_pk_fma_f32 v[196:197], v[196:197], v[160:161], v[164:165]
    v_pk_fma_f32 v[198:199], v[198:199], v[162:163], v[166:167]
    v_cvt_pk_bf16_f32 v218, v196, v197
    v_cvt_pk_bf16_f32 v219, v198, v199
    ds_write_b64 v6, v[218:219] offset:23040
    v_pk_fma_f32 v[200:201], v[200:201], v[160:161], v[164:165]
    v_pk_fma_f32 v[202:203], v[202:203], v[162:163], v[166:167]
    v_cvt_pk_bf16_f32 v220, v200, v201
    v_cvt_pk_bf16_f32 v221, v202, v203
    ds_write_b64 v6, v[220:221] offset:27648
    v_pk_fma_f32 v[204:205], v[204:205], v[160:161], v[164:165]
    v_pk_fma_f32 v[206:207], v[206:207], v[162:163], v[166:167]
    v_cvt_pk_bf16_f32 v222, v204, v205
    v_cvt_pk_bf16_f32 v223, v206, v207
    ds_write_b64 v6, v[222:223] offset:32256
    s_waitcnt lgkmcnt(0)
    s_barrier
    ds_read_b128 v[176:179], v7 offset:448
    ds_read_b128 v[180:183], v7 offset:432
    s_waitcnt lgkmcnt(1)
    v_mfma_f32_16x16x32_bf16 v[212:215], v[176:179], v[128:131], 0
    ds_read_b128 v[184:187], v7 offset:960
    ds_read_b128 v[188:191], v7 offset:944
    v_mfma_f32_16x16x32_bf16 v[216:219], v[176:179], v[132:135], 0
    ds_read2_b32 v[108:109], v15 offset0:131 offset1:130
    s_waitcnt lgkmcnt(3)
    v_mfma_f32_16x16x32_bf16 v[204:207], v[180:183], v[128:131], 0
    ds_read2_b32 v[110:111], v15 offset0:129 offset1:128
    ds_read2_b32 v[112:113], v15 offset0:147 offset1:146
    v_mfma_f32_16x16x32_bf16 v[208:211], v[180:183], v[132:135], 0
    ds_read2_b32 v[114:115], v15 offset0:145 offset1:144
    ds_read2_b32 v[116:117], v15 offset0:163 offset1:162
    v_mfma_f32_16x16x32_bf16 v[160:163], v[124:127], v[176:179], 0
    ds_read2_b32 v[118:119], v15 offset0:161 offset1:160
    ds_read2_b32 v[120:121], v15 offset0:179 offset1:178
    v_mfma_f32_16x16x32_bf16 v[224:227], v[176:179], v[140:143], 0
    ds_read2_b32 v[122:123], v15 offset0:177 offset1:176
    ds_read2_b32 v[44:45], v12 offset0:230 offset1:228
    v_mfma_f32_16x16x32_bf16 v[220:223], v[180:183], v[136:139], 0
    v_cvt_pk_bf16_f32 v232, v212, v216
    v_cvt_pk_bf16_f32 v233, v213, v217
    v_cvt_pk_bf16_f32 v234, v214, v218
    v_cvt_pk_bf16_f32 v235, v215, v219
    s_waitcnt lgkmcnt(8)
    v_mfma_f32_16x16x32_bf16 v[212:215], v[184:187], v[128:131], 0
    ds_read_b128 v[176:179], v7 offset:1472
    ds_read_b128 v[180:183], v7 offset:1456
    v_mfma_f32_16x16x32_bf16 v[216:219], v[184:187], v[132:135], 0
    v_cvt_pk_bf16_f32 v228, v204, v208
    v_cvt_pk_bf16_f32 v229, v205, v209
    v_cvt_pk_bf16_f32 v230, v206, v210
    v_cvt_pk_bf16_f32 v231, v207, v211
    v_mfma_f32_16x16x32_bf16 v[204:207], v[188:191], v[128:131], 0
    ds_read2_b32 v[46:47], v12 offset0:226 offset1:224
    ds_read2_b32 v[76:77], v13 offset0:230 offset1:228
    v_mfma_f32_16x16x32_bf16 v[208:211], v[188:191], v[132:135], 0
    ds_read2_b32 v[78:79], v13 offset0:226 offset1:224
    ds_read2_b32 v[40:41], v12 offset0:198 offset1:196
    v_mfma_f32_16x16x32_bf16 v[164:167], v[124:127], v[184:187], 0
    v_cvt_pk_bf16_f32 v236, v220, v224
    v_cvt_pk_bf16_f32 v237, v221, v225
    v_cvt_pk_bf16_f32 v238, v222, v226
    v_cvt_pk_bf16_f32 v239, v223, v227
    v_mfma_f32_16x16x32_bf16 v[224:227], v[184:187], v[140:143], 0
    ds_read2_b32 v[42:43], v12 offset0:194 offset1:192
    ds_read2_b32 v[72:73], v13 offset0:198 offset1:196
    v_mfma_f32_16x16x32_bf16 v[220:223], v[188:191], v[136:139], 0
    ds_read_b128 v[184:187], v7 offset:1984
    ds_read_b128 v[188:191], v7 offset:1968
    v_mfma_f32_16x16x32_bf16 v[152:155], v[232:235], v[96:99], 0
    ds_read2_b32 v[74:75], v13 offset0:194 offset1:192
    ds_read2_b32 v[36:37], v12 offset0:166 offset1:164
    v_mfma_f32_16x16x32_bf16 v[156:159], v[232:235], v[100:103], 0
    ds_read2_b32 v[38:39], v12 offset0:162 offset1:160
    ds_read2_b32 v[68:69], v13 offset0:166 offset1:164
    v_mfma_f32_16x16x32_bf16 v[160:163], v[232:235], v[104:107], v[160:163]
    v_cvt_pk_bf16_f32 v232, v212, v216
    v_cvt_pk_bf16_f32 v233, v213, v217
    v_mfma_f32_16x16x32_bf16 v[152:155], v[228:231], v[84:87], v[152:155]
    v_cvt_pk_bf16_f32 v234, v214, v218
    v_cvt_pk_bf16_f32 v235, v215, v219
    v_mfma_f32_16x16x32_bf16 v[156:159], v[228:231], v[88:91], v[156:159]
    ds_read2_b32 v[70:71], v13 offset0:162 offset1:160
    ds_read2_b32 v[32:33], v12 offset0:134 offset1:132
    v_mfma_f32_16x16x32_bf16 v[160:163], v[228:231], v[92:95], v[160:163]
    v_cvt_pk_bf16_f32 v228, v204, v208
    s_waitcnt lgkmcnt(4)
    v_mfma_f32_16x16x32_bf16 v[160:163], v[236:239], v[108:111], v[160:163]
    v_cvt_pk_bf16_f32 v229, v205, v209
    v_cvt_pk_bf16_f32 v230, v206, v210
    v_mfma_f32_16x16x32_bf16 v[164:167], v[236:239], v[112:115], v[164:167]
    v_cvt_pk_bf16_f32 v231, v207, v211
    ds_read2_b32 v[34:35], v12 offset0:130 offset1:128
    v_mfma_f32_16x16x32_bf16 v[168:171], v[236:239], v[116:119], 0
    ds_read2_b32 v[64:65], v13 offset0:134 offset1:132
    ds_read2_b32 v[66:67], v13 offset0:130 offset1:128
    v_mfma_f32_16x16x32_bf16 v[172:175], v[236:239], v[120:123], 0
    v_cvt_pk_bf16_f32 v236, v220, v224
    v_cvt_pk_bf16_f32 v237, v221, v225
    v_mfma_f32_16x16x32_bf16 v[212:215], v[176:179], v[128:131], 0
    v_cvt_pk_bf16_f32 v238, v222, v226
    v_cvt_pk_bf16_f32 v239, v223, v227
    v_mfma_f32_16x16x32_bf16 v[216:219], v[176:179], v[132:135], 0
    ds_read2_b32 v[28:29], v12 offset0:102 offset1:100
    ds_read2_b32 v[30:31], v12 offset0:98 offset1:96
    v_mfma_f32_16x16x32_bf16 v[204:207], v[180:183], v[128:131], 0
    ds_read2_b32 v[60:61], v13 offset0:102 offset1:100
    ds_read2_b32 v[62:63], v13 offset0:98 offset1:96
    v_mfma_f32_16x16x32_bf16 v[208:211], v[180:183], v[132:135], 0
    ds_read2_b32 v[24:25], v12 offset0:70 offset1:68
    ds_read2_b32 v[26:27], v12 offset0:66 offset1:64
    v_mfma_f32_16x16x32_bf16 v[168:171], v[124:127], v[176:179], v[168:171]
    ds_read2_b32 v[56:57], v13 offset0:70 offset1:68
    ds_read2_b32 v[58:59], v13 offset0:66 offset1:64
    v_mfma_f32_16x16x32_bf16 v[224:227], v[176:179], v[140:143], 0
    ds_read2_b32 v[20:21], v12 offset0:38 offset1:36
    ds_read2_b32 v[22:23], v12 offset0:34 offset1:32
    v_mfma_f32_16x16x32_bf16 v[220:223], v[180:183], v[136:139], 0
    ds_read_b128 v[176:179], v7 offset:2496
    ds_read_b128 v[180:183], v7 offset:2480
    v_mfma_f32_16x16x32_bf16 v[156:159], v[232:235], v[96:99], v[156:159]
    ds_read2_b32 v[52:53], v13 offset0:38 offset1:36
    ds_read2_b32 v[54:55], v13 offset0:34 offset1:32
    v_mfma_f32_16x16x32_bf16 v[160:163], v[232:235], v[100:103], v[160:163]
    ds_read2_b32 v[16:17], v12 offset0:6 offset1:4
    ds_read2_b32 v[18:19], v12 offset0:2 offset1:0
    v_mfma_f32_16x16x32_bf16 v[164:167], v[232:235], v[104:107], v[164:167]
    v_cvt_pk_bf16_f32 v232, v212, v216
    v_cvt_pk_bf16_f32 v233, v213, v217
    v_mfma_f32_16x16x32_bf16 v[156:159], v[228:231], v[84:87], v[156:159]
    v_cvt_pk_bf16_f32 v234, v214, v218
    v_cvt_pk_bf16_f32 v235, v215, v219
    v_mfma_f32_16x16x32_bf16 v[160:163], v[228:231], v[88:91], v[160:163]
    ds_read2_b32 v[48:49], v13 offset0:6 offset1:4
    ds_read2_b32 v[50:51], v13 offset0:2 offset1:0
    v_mfma_f32_16x16x32_bf16 v[164:167], v[228:231], v[92:95], v[164:167]
    v_cvt_pk_bf16_f32 v228, v204, v208
    v_cvt_pk_bf16_f32 v229, v205, v209
    v_mfma_f32_16x16x32_bf16 v[164:167], v[236:239], v[108:111], v[164:167]
    v_cvt_pk_bf16_f32 v230, v206, v210
    v_cvt_pk_bf16_f32 v231, v207, v211
    v_mfma_f32_16x16x32_bf16 v[168:171], v[236:239], v[112:115], v[168:171]
    ds_read2_b32 v[80:81], v14 offset0:6 offset1:4
    ds_read2_b32 v[82:83], v14 offset0:2 offset1:0
    v_mfma_f32_16x16x32_bf16 v[172:175], v[236:239], v[116:119], v[172:175]
    v_cvt_pk_bf16_f32 v236, v220, v224
    v_cvt_pk_bf16_f32 v237, v221, v225
    v_mfma_f32_16x16x32_bf16 v[212:215], v[184:187], v[128:131], 0
    v_cvt_pk_bf16_f32 v238, v222, v226
    v_cvt_pk_bf16_f32 v239, v223, v227
    v_mfma_f32_16x16x32_bf16 v[216:219], v[184:187], v[132:135], 0
    v_mfma_f32_16x16x32_bf16 v[204:207], v[188:191], v[128:131], 0
    v_mfma_f32_16x16x32_bf16 v[208:211], v[188:191], v[132:135], 0
    v_mfma_f32_16x16x32_bf16 v[172:175], v[124:127], v[184:187], v[172:175]
    v_mfma_f32_16x16x32_bf16 v[224:227], v[184:187], v[140:143], 0
    v_mfma_f32_16x16x32_bf16 v[220:223], v[188:191], v[136:139], 0
    ds_read_b128 v[184:187], v7 offset:3008
    ds_read_b128 v[188:191], v7 offset:2992
    v_mfma_f32_16x16x32_bf16 v[160:163], v[232:235], v[96:99], v[160:163]
    v_mfma_f32_16x16x32_bf16 v[164:167], v[232:235], v[100:103], v[164:167]
    v_mfma_f32_16x16x32_bf16 v[168:171], v[232:235], v[104:107], v[168:171]
    v_cvt_pk_bf16_f32 v232, v212, v216
    v_cvt_pk_bf16_f32 v233, v213, v217
    v_mfma_f32_16x16x32_bf16 v[160:163], v[228:231], v[84:87], v[160:163]
    v_cvt_pk_bf16_f32 v234, v214, v218
    v_cvt_pk_bf16_f32 v235, v215, v219
    v_mfma_f32_16x16x32_bf16 v[164:167], v[228:231], v[88:91], v[164:167]
    v_mfma_f32_16x16x32_bf16 v[168:171], v[228:231], v[92:95], v[168:171]
    v_cvt_pk_bf16_f32 v228, v204, v208
    v_cvt_pk_bf16_f32 v229, v205, v209
    v_mfma_f32_16x16x32_bf16 v[168:171], v[236:239], v[108:111], v[168:171]
    v_cvt_pk_bf16_f32 v230, v206, v210
    v_cvt_pk_bf16_f32 v231, v207, v211
    v_mfma_f32_16x16x32_bf16 v[172:175], v[236:239], v[112:115], v[172:175]
    v_cvt_pk_bf16_f32 v236, v220, v224
    s_waitcnt lgkmcnt(0)
    v_mfma_f32_16x16x32_bf16 v[212:215], v[176:179], v[128:131], 0
    v_cvt_pk_bf16_f32 v237, v221, v225
    v_cvt_pk_bf16_f32 v238, v222, v226
    v_mfma_f32_16x16x32_bf16 v[216:219], v[176:179], v[132:135], 0
    v_cvt_pk_bf16_f32 v239, v223, v227
    v_mfma_f32_16x16x32_bf16 v[204:207], v[180:183], v[128:131], 0
    v_mfma_f32_16x16x32_bf16 v[208:211], v[180:183], v[132:135], 0
    ds_read_b128 v[176:179], v7 offset:0
    ds_read_b128 v[180:183], v7 offset:64
    v_mfma_f32_16x16x32_bf16 v[164:167], v[232:235], v[96:99], v[164:167]
    v_mfma_f32_16x16x32_bf16 v[168:171], v[232:235], v[100:103], v[168:171]
    v_mfma_f32_16x16x32_bf16 v[172:175], v[232:235], v[104:107], v[172:175]
    v_mfma_f32_16x16x32_bf16 v[164:167], v[228:231], v[84:87], v[164:167]
    v_mfma_f32_16x16x32_bf16 v[168:171], v[228:231], v[88:91], v[168:171]
    v_cvt_pk_bf16_f32 v232, v212, v216
    v_cvt_pk_bf16_f32 v233, v213, v217
    v_mfma_f32_16x16x32_bf16 v[172:175], v[228:231], v[92:95], v[172:175]
    v_cvt_pk_bf16_f32 v234, v214, v218
    v_cvt_pk_bf16_f32 v235, v215, v219
    v_mfma_f32_16x16x32_bf16 v[172:175], v[236:239], v[108:111], v[172:175]
    v_cvt_pk_bf16_f32 v228, v204, v208
    v_cvt_pk_bf16_f32 v229, v205, v209
    v_mfma_f32_16x16x32_bf16 v[212:215], v[184:187], v[128:131], 0
    v_cvt_pk_bf16_f32 v230, v206, v210
    v_cvt_pk_bf16_f32 v231, v207, v211
    v_mfma_f32_16x16x32_bf16 v[216:219], v[184:187], v[132:135], 0
    v_mfma_f32_16x16x32_bf16 v[204:207], v[188:191], v[128:131], 0
    ds_read_b128 v[240:243], v255 offset:0
    v_mfma_f32_16x16x32_bf16 v[208:211], v[188:191], v[132:135], 0
    ds_read_b128 v[184:187], v7 offset:128
    ds_read_b128 v[188:191], v7 offset:192
    v_mfma_f32_16x16x32_bf16 v[168:171], v[232:235], v[96:99], v[168:171]
    ds_read_b128 v[192:195], v7 offset:256
    ds_read_b128 v[196:199], v7 offset:320
    v_mfma_f32_16x16x32_bf16 v[172:175], v[232:235], v[100:103], v[172:175]
    v_mfma_f32_16x16x32_bf16 v[168:171], v[228:231], v[84:87], v[168:171]
    v_cvt_pk_bf16_f32 v232, v212, v216
    v_cvt_pk_bf16_f32 v233, v213, v217
    v_cvt_pk_bf16_f32 v234, v214, v218
    v_cvt_pk_bf16_f32 v235, v215, v219
    v_mfma_f32_16x16x32_bf16 v[172:175], v[228:231], v[88:91], v[172:175]
    v_cvt_pk_bf16_f32 v228, v204, v208
    v_cvt_pk_bf16_f32 v229, v205, v209
    v_cvt_pk_bf16_f32 v230, v206, v210
    v_cvt_pk_bf16_f32 v231, v207, v211
    v_mfma_f32_16x16x32_bf16 v[172:175], v[232:235], v[96:99], v[172:175]
    s_waitcnt lgkmcnt(4)
    v_lshlrev_b32 v244, 16, v240
    v_mfma_f32_16x16x32_bf16 v[172:175], v[228:231], v[84:87], v[172:175]
    v_and_b32 v245, 0xffff0000, v240
    v_lshlrev_b32 v246, 16, v241
    v_mfma_f32_16x16x32_bf16 v[144:147], v[44:47], v[176:179], 0
    v_and_b32 v247, 0xffff0000, v241
    v_lshlrev_b32 v248, 16, v242
    v_mfma_f32_16x16x32_bf16 v[148:151], v[76:79], v[176:179], 0
    ds_read_b128 v[176:179], v7 offset:384
    v_and_b32 v249, 0xffff0000, v242
    v_mfma_f32_16x16x32_bf16 v[144:147], v[40:43], v[180:183], v[144:147]
    v_lshlrev_b32 v250, 16, v243
    v_and_b32 v251, 0xffff0000, v243
    v_mfma_f32_16x16x32_bf16 v[148:151], v[72:75], v[180:183], v[148:151]
    ds_read_b128 v[180:183], v7 offset:448
    s_waitcnt lgkmcnt(2)
    v_mfma_f32_16x16x32_bf16 v[144:147], v[36:39], v[184:187], v[144:147]
    v_mfma_f32_16x16x32_bf16 v[148:151], v[68:71], v[184:187], v[148:151]
    ds_read_b128 v[184:187], v7 offset:512
    v_mfma_f32_16x16x32_bf16 v[144:147], v[32:35], v[188:191], v[144:147]
    v_mfma_f32_16x16x32_bf16 v[148:151], v[64:67], v[188:191], v[148:151]
    ds_read_b128 v[188:191], v7 offset:576
    v_mfma_f32_16x16x32_bf16 v[144:147], v[28:31], v[192:195], v[144:147]
    v_mfma_f32_16x16x32_bf16 v[148:151], v[60:63], v[192:195], v[148:151]
    ds_read_b128 v[192:195], v7 offset:640
    v_mfma_f32_16x16x32_bf16 v[144:147], v[24:27], v[196:199], v[144:147]
    v_mfma_f32_16x16x32_bf16 v[148:151], v[56:59], v[196:199], v[148:151]
    ds_read_b128 v[196:199], v7 offset:704
    s_waitcnt lgkmcnt(3)
    v_mfma_f32_16x16x32_bf16 v[144:147], v[20:23], v[176:179], v[144:147]
    v_mfma_f32_16x16x32_bf16 v[148:151], v[52:55], v[176:179], v[148:151]
    ds_read_b128 v[176:179], v7 offset:768
    v_mfma_f32_16x16x32_bf16 v[144:147], v[16:19], v[180:183], v[144:147]
    v_mfma_f32_16x16x32_bf16 v[148:151], v[48:51], v[180:183], v[148:151]
    v_mfma_f32_16x16x32_bf16 v[152:155], v[80:83], v[180:183], v[152:155]
    ds_read_b128 v[180:183], v7 offset:832
    v_mfma_f32_16x16x32_bf16 v[148:151], v[44:47], v[184:187], v[148:151]
    v_mfma_f32_16x16x32_bf16 v[152:155], v[76:79], v[184:187], v[152:155]
    ds_read_b128 v[184:187], v7 offset:896
    s_waitcnt lgkmcnt(2)
    v_mfma_f32_16x16x32_bf16 v[148:151], v[40:43], v[188:191], v[148:151]
    v_mfma_f32_16x16x32_bf16 v[152:155], v[72:75], v[188:191], v[152:155]
    ds_read_b128 v[188:191], v7 offset:960
    v_mfma_f32_16x16x32_bf16 v[148:151], v[36:39], v[192:195], v[148:151]
    v_cvt_pk_bf16_f32 v10, v144, v145
    v_cvt_pk_bf16_f32 v11, v146, v147
    v_mfma_f32_16x16x32_bf16 v[152:155], v[68:71], v[192:195], v[152:155]
    ds_read_b128 v[192:195], v7 offset:1024
    ds_write_b64 v8, v[10:11] offset:0
    v_mfma_f32_16x16x32_bf16 v[148:151], v[32:35], v[196:199], v[148:151]
    v_mfma_f32_16x16x32_bf16 v[152:155], v[64:67], v[196:199], v[152:155]
    ds_read_b128 v[196:199], v7 offset:1088
    v_mfma_f32_16x16x32_bf16 v[148:151], v[28:31], v[176:179], v[148:151]
    v_mfma_f32_16x16x32_bf16 v[152:155], v[60:63], v[176:179], v[152:155]
    ds_read_b128 v[176:179], v7 offset:1152
    s_waitcnt lgkmcnt(4)
    v_mfma_f32_16x16x32_bf16 v[148:151], v[24:27], v[180:183], v[148:151]
    v_mfma_f32_16x16x32_bf16 v[152:155], v[56:59], v[180:183], v[152:155]
    ds_read_b128 v[180:183], v7 offset:1216
    v_mfma_f32_16x16x32_bf16 v[148:151], v[20:23], v[184:187], v[148:151]
    v_mfma_f32_16x16x32_bf16 v[152:155], v[52:55], v[184:187], v[152:155]
    ds_read_b128 v[184:187], v7 offset:1280
    v_mfma_f32_16x16x32_bf16 v[148:151], v[16:19], v[188:191], v[148:151]
    v_mfma_f32_16x16x32_bf16 v[152:155], v[48:51], v[188:191], v[152:155]
    v_mfma_f32_16x16x32_bf16 v[156:159], v[80:83], v[188:191], v[156:159]
    ds_read_b128 v[188:191], v7 offset:1344
    s_waitcnt lgkmcnt(2)
    v_mfma_f32_16x16x32_bf16 v[152:155], v[44:47], v[192:195], v[152:155]
    v_mfma_f32_16x16x32_bf16 v[156:159], v[76:79], v[192:195], v[156:159]
    ds_read_b128 v[192:195], v7 offset:1408
    v_mfma_f32_16x16x32_bf16 v[152:155], v[40:43], v[196:199], v[152:155]
    v_mfma_f32_16x16x32_bf16 v[156:159], v[72:75], v[196:199], v[156:159]
    ds_read_b128 v[196:199], v7 offset:1472
    v_mfma_f32_16x16x32_bf16 v[152:155], v[36:39], v[176:179], v[152:155]
    v_cvt_pk_bf16_f32 v10, v148, v149
    v_cvt_pk_bf16_f32 v11, v150, v151
    v_mfma_f32_16x16x32_bf16 v[156:159], v[68:71], v[176:179], v[156:159]
    ds_read_b128 v[176:179], v7 offset:1536
    ds_write_b64 v8, v[10:11] offset:512
    v_mfma_f32_16x16x32_bf16 v[152:155], v[32:35], v[180:183], v[152:155]
    v_mfma_f32_16x16x32_bf16 v[156:159], v[64:67], v[180:183], v[156:159]
    ds_read_b128 v[180:183], v7 offset:1600
    s_waitcnt lgkmcnt(4)
    v_mfma_f32_16x16x32_bf16 v[152:155], v[28:31], v[184:187], v[152:155]
    v_mfma_f32_16x16x32_bf16 v[156:159], v[60:63], v[184:187], v[156:159]
    ds_read_b128 v[184:187], v7 offset:1664
    v_mfma_f32_16x16x32_bf16 v[152:155], v[24:27], v[188:191], v[152:155]
    v_mfma_f32_16x16x32_bf16 v[156:159], v[56:59], v[188:191], v[156:159]
    ds_read_b128 v[188:191], v7 offset:1728
    v_mfma_f32_16x16x32_bf16 v[152:155], v[20:23], v[192:195], v[152:155]
    v_mfma_f32_16x16x32_bf16 v[156:159], v[52:55], v[192:195], v[156:159]
    ds_read_b128 v[192:195], v7 offset:1792
    s_waitcnt lgkmcnt(3)
    v_mfma_f32_16x16x32_bf16 v[152:155], v[16:19], v[196:199], v[152:155]
    s_barrier
    ds_read_b64_tr_b16 v[12:13], v4 offset:0
    v_mfma_f32_16x16x32_bf16 v[156:159], v[48:51], v[196:199], v[156:159]
    ds_read_b64_tr_b16 v[14:15], v4 offset:34048
    v_mfma_f32_16x16x32_bf16 v[160:163], v[80:83], v[196:199], v[160:163]
    ds_read_b128 v[196:199], v7 offset:1856
    v_mfma_f32_16x16x32_bf16 v[156:159], v[44:47], v[176:179], v[156:159]
    v_mfma_f32_16x16x32_bf16 v[160:163], v[76:79], v[176:179], v[160:163]
    ds_read_b128 v[176:179], v7 offset:1920
    v_mfma_f32_16x16x32_bf16 v[156:159], v[40:43], v[180:183], v[156:159]
    v_mfma_f32_16x16x32_bf16 v[160:163], v[72:75], v[180:183], v[160:163]
    ds_read_b128 v[180:183], v7 offset:1984
    s_waitcnt lgkmcnt(3)
    v_mfma_f32_16x16x32_bf16 v[156:159], v[36:39], v[184:187], v[156:159]
    v_cvt_pk_bf16_f32 v10, v152, v153
    v_cvt_pk_bf16_f32 v11, v154, v155
    v_mfma_f32_16x16x32_bf16 v[160:163], v[68:71], v[184:187], v[160:163]
    ds_read_b128 v[184:187], v7 offset:2048
    ds_write_b64 v8, v[10:11] offset:1024
    v_mfma_f32_16x16x32_bf16 v[156:159], v[32:35], v[188:191], v[156:159]
    v_lshlrev_b32 v252, 16, v12
    v_and_b32 v253, 0xffff0000, v12
    v_mfma_f32_16x16x32_bf16 v[160:163], v[64:67], v[188:191], v[160:163]
    ds_read_b128 v[188:191], v7 offset:2112
    v_pk_add_f32 v[244:245], v[244:245], v[252:253]
    v_mfma_f32_16x16x32_bf16 v[156:159], v[28:31], v[192:195], v[156:159]
    v_cvt_pk_bf16_f32 v12, v244, v245
    v_lshlrev_b32 v252, 16, v13
    v_mfma_f32_16x16x32_bf16 v[160:163], v[60:63], v[192:195], v[160:163]
    ds_read_b128 v[192:195], v7 offset:2176
    s_waitcnt lgkmcnt(4)
    v_mfma_f32_16x16x32_bf16 v[156:159], v[24:27], v[196:199], v[156:159]
    v_and_b32 v253, 0xffff0000, v13
    v_pk_add_f32 v[246:247], v[246:247], v[252:253]
    v_mfma_f32_16x16x32_bf16 v[160:163], v[56:59], v[196:199], v[160:163]
    ds_read_b128 v[196:199], v7 offset:2240
    v_cvt_pk_bf16_f32 v13, v246, v247
    v_mfma_f32_16x16x32_bf16 v[156:159], v[20:23], v[176:179], v[156:159]
    v_lshlrev_b32 v252, 16, v14
    v_and_b32 v253, 0xffff0000, v14
    v_mfma_f32_16x16x32_bf16 v[160:163], v[52:55], v[176:179], v[160:163]
    ds_read_b128 v[176:179], v7 offset:2304
    v_pk_add_f32 v[248:249], v[248:249], v[252:253]
    v_mfma_f32_16x16x32_bf16 v[156:159], v[16:19], v[180:183], v[156:159]
    v_cvt_pk_bf16_f32 v14, v248, v249
    v_lshlrev_b32 v252, 16, v15
    v_mfma_f32_16x16x32_bf16 v[160:163], v[48:51], v[180:183], v[160:163]
    v_and_b32 v253, 0xffff0000, v15
    v_pk_add_f32 v[250:251], v[250:251], v[252:253]
    v_mfma_f32_16x16x32_bf16 v[164:167], v[80:83], v[180:183], v[164:167]
    ds_read_b128 v[180:183], v7 offset:2368
    s_waitcnt lgkmcnt(2)
    v_mfma_f32_16x16x32_bf16 v[160:163], v[44:47], v[184:187], v[160:163]
    v_cvt_pk_bf16_f32 v15, v250, v251
    buffer_store_dwordx4 v[12:15], v5, s[32:35], 0 offen
    ds_read_b128 v[240:243], v255 offset:8192
    v_mfma_f32_16x16x32_bf16 v[164:167], v[76:79], v[184:187], v[164:167]
    ds_read_b128 v[184:187], v7 offset:2432
    v_mfma_f32_16x16x32_bf16 v[160:163], v[40:43], v[188:191], v[160:163]
    v_mfma_f32_16x16x32_bf16 v[164:167], v[72:75], v[188:191], v[164:167]
    ds_read_b128 v[188:191], v7 offset:2496
    v_mfma_f32_16x16x32_bf16 v[160:163], v[36:39], v[192:195], v[160:163]
    v_cvt_pk_bf16_f32 v10, v156, v157
    v_cvt_pk_bf16_f32 v11, v158, v159
    v_mfma_f32_16x16x32_bf16 v[164:167], v[68:71], v[192:195], v[164:167]
    s_waitcnt lgkmcnt(2)
    v_lshlrev_b32 v244, 16, v240
    v_mfma_f32_16x16x32_bf16 v[160:163], v[32:35], v[196:199], v[160:163]
    v_and_b32 v245, 0xffff0000, v240
    v_lshlrev_b32 v246, 16, v241
    v_and_b32 v247, 0xffff0000, v241
    v_lshlrev_b32 v248, 16, v242
    v_and_b32 v249, 0xffff0000, v242
    v_lshlrev_b32 v250, 16, v243
    v_and_b32 v251, 0xffff0000, v243
    v_mfma_f32_16x16x32_bf16 v[164:167], v[64:67], v[196:199], v[164:167]
    ds_read_b128 v[192:195], v7 offset:2560
    ds_read_b128 v[196:199], v7 offset:2624
    v_mfma_f32_16x16x32_bf16 v[160:163], v[28:31], v[176:179], v[160:163]
    ds_write_b64 v8, v[10:11] offset:1536
    v_mfma_f32_16x16x32_bf16 v[164:167], v[60:63], v[176:179], v[164:167]
    ds_read_b128 v[176:179], v7 offset:2688
    v_mfma_f32_16x16x32_bf16 v[160:163], v[24:27], v[180:183], v[160:163]
    v_mfma_f32_16x16x32_bf16 v[164:167], v[56:59], v[180:183], v[164:167]
    ds_read_b128 v[180:183], v7 offset:2752
    s_waitcnt lgkmcnt(5)
    v_mfma_f32_16x16x32_bf16 v[160:163], v[20:23], v[184:187], v[160:163]
    v_mfma_f32_16x16x32_bf16 v[164:167], v[52:55], v[184:187], v[164:167]
    ds_read_b128 v[184:187], v7 offset:2816
    v_mfma_f32_16x16x32_bf16 v[160:163], v[16:19], v[188:191], v[160:163]
    s_waitcnt lgkmcnt(3)
    s_barrier
    v_mfma_f32_16x16x32_bf16 v[164:167], v[48:51], v[188:191], v[164:167]
    ds_read_b64_tr_b16 v[12:13], v4 offset:1024
    ds_read_b64_tr_b16 v[14:15], v4 offset:35072
    v_mfma_f32_16x16x32_bf16 v[168:171], v[80:83], v[188:191], v[168:171]
    ds_read_b128 v[188:191], v7 offset:2880
    v_mfma_f32_16x16x32_bf16 v[164:167], v[44:47], v[192:195], v[164:167]
    v_mfma_f32_16x16x32_bf16 v[168:171], v[76:79], v[192:195], v[168:171]
    ds_read_b128 v[192:195], v7 offset:2944
    v_mfma_f32_16x16x32_bf16 v[164:167], v[40:43], v[196:199], v[164:167]
    v_mfma_f32_16x16x32_bf16 v[168:171], v[72:75], v[196:199], v[168:171]
    ds_read_b128 v[196:199], v7 offset:3008
    s_waitcnt lgkmcnt(3)
    v_mfma_f32_16x16x32_bf16 v[164:167], v[36:39], v[176:179], v[164:167]
    v_cvt_pk_bf16_f32 v10, v160, v161
    v_cvt_pk_bf16_f32 v11, v162, v163
    v_mfma_f32_16x16x32_bf16 v[168:171], v[68:71], v[176:179], v[168:171]
    ds_read_b128 v[176:179], v7 offset:3072
    ds_write_b64 v8, v[10:11] offset:2048
    v_mfma_f32_16x16x32_bf16 v[164:167], v[32:35], v[180:183], v[164:167]
    buffer_load_dwordx4 v[108:111], v254, s[36:39], 0 offen sc1
    v_lshlrev_b32 v252, 16, v12
    v_mfma_f32_16x16x32_bf16 v[168:171], v[64:67], v[180:183], v[168:171]
    ds_read_b128 v[180:183], v7 offset:3136
    v_and_b32 v253, 0xffff0000, v12
    v_mfma_f32_16x16x32_bf16 v[164:167], v[28:31], v[184:187], v[164:167]
    v_pk_add_f32 v[244:245], v[244:245], v[252:253]
    v_cvt_pk_bf16_f32 v12, v244, v245
    v_mfma_f32_16x16x32_bf16 v[168:171], v[60:63], v[184:187], v[168:171]
    ds_read_b128 v[184:187], v7 offset:3200
    s_waitcnt lgkmcnt(4)
    v_mfma_f32_16x16x32_bf16 v[164:167], v[24:27], v[188:191], v[164:167]
    v_lshlrev_b32 v252, 16, v13
    v_and_b32 v253, 0xffff0000, v13
    v_mfma_f32_16x16x32_bf16 v[168:171], v[56:59], v[188:191], v[168:171]
    ds_read_b128 v[188:191], v7 offset:3264
    v_pk_add_f32 v[246:247], v[246:247], v[252:253]
    v_mfma_f32_16x16x32_bf16 v[164:167], v[20:23], v[192:195], v[164:167]
    v_cvt_pk_bf16_f32 v13, v246, v247
    v_lshlrev_b32 v252, 16, v14
    v_mfma_f32_16x16x32_bf16 v[168:171], v[52:55], v[192:195], v[168:171]
    ds_read_b128 v[192:195], v7 offset:3328
    v_and_b32 v253, 0xffff0000, v14
    v_mfma_f32_16x16x32_bf16 v[164:167], v[16:19], v[196:199], v[164:167]
    v_pk_add_f32 v[248:249], v[248:249], v[252:253]
    v_cvt_pk_bf16_f32 v14, v248, v249
    v_mfma_f32_16x16x32_bf16 v[168:171], v[48:51], v[196:199], v[168:171]
    v_lshlrev_b32 v252, 16, v15
    v_and_b32 v253, 0xffff0000, v15
    v_mfma_f32_16x16x32_bf16 v[172:175], v[80:83], v[196:199], v[172:175]
    ds_read_b128 v[196:199], v7 offset:3392
    s_waitcnt lgkmcnt(2)
    v_mfma_f32_16x16x32_bf16 v[168:171], v[44:47], v[176:179], v[168:171]
    v_pk_add_f32 v[250:251], v[250:251], v[252:253]
    v_cvt_pk_bf16_f32 v15, v250, v251
    v_mfma_f32_16x16x32_bf16 v[172:175], v[76:79], v[176:179], v[172:175]
    ds_read_b128 v[176:179], v7 offset:3456
    buffer_store_dwordx4 v[12:15], v5, s[32:35], s54 offen
    ds_read_b128 v[240:243], v255 offset:16384
    v_mfma_f32_16x16x32_bf16 v[168:171], v[40:43], v[180:183], v[168:171]
    v_mfma_f32_16x16x32_bf16 v[172:175], v[72:75], v[180:183], v[172:175]
    ds_read_b128 v[180:183], v7 offset:3520
    v_mfma_f32_16x16x32_bf16 v[168:171], v[36:39], v[184:187], v[168:171]
    v_cvt_pk_bf16_f32 v10, v164, v165
    v_cvt_pk_bf16_f32 v11, v166, v167
    v_mfma_f32_16x16x32_bf16 v[172:175], v[68:71], v[184:187], v[172:175]
    ds_read_b128 v[184:187], v7 offset:3584
    ds_write_b64 v8, v[10:11] offset:2560
    v_mfma_f32_16x16x32_bf16 v[168:171], v[32:35], v[188:191], v[168:171]
    s_waitcnt lgkmcnt(3)
    v_lshlrev_b32 v244, 16, v240
    v_and_b32 v245, 0xffff0000, v240
    v_lshlrev_b32 v246, 16, v241
    v_and_b32 v247, 0xffff0000, v241
    v_lshlrev_b32 v248, 16, v242
    v_and_b32 v249, 0xffff0000, v242
    v_lshlrev_b32 v250, 16, v243
    v_and_b32 v251, 0xffff0000, v243
    v_mfma_f32_16x16x32_bf16 v[172:175], v[64:67], v[188:191], v[172:175]
    ds_read_b128 v[188:191], v7 offset:3648
    v_mfma_f32_16x16x32_bf16 v[168:171], v[28:31], v[192:195], v[168:171]
    v_mfma_f32_16x16x32_bf16 v[172:175], v[60:63], v[192:195], v[172:175]
    ds_read_b128 v[192:195], v7 offset:3712
    v_mfma_f32_16x16x32_bf16 v[168:171], v[24:27], v[196:199], v[168:171]
    v_mfma_f32_16x16x32_bf16 v[172:175], v[56:59], v[196:199], v[172:175]
    ds_read_b128 v[196:199], v7 offset:3776
    v_mfma_f32_16x16x32_bf16 v[168:171], v[20:23], v[176:179], v[168:171]
    v_mfma_f32_16x16x32_bf16 v[172:175], v[52:55], v[176:179], v[172:175]
    ds_read_b128 v[176:179], v7 offset:3840
    s_waitcnt lgkmcnt(3)
    v_mfma_f32_16x16x32_bf16 v[168:171], v[16:19], v[180:183], v[168:171]
    s_barrier
    ds_read_b64_tr_b16 v[12:13], v4 offset:2048
    v_mfma_f32_16x16x32_bf16 v[172:175], v[48:51], v[180:183], v[172:175]
    ds_read_b128 v[180:183], v7 offset:3904
    ds_read_b64_tr_b16 v[14:15], v4 offset:36096
    s_waitcnt lgkmcnt(0)
    v_lshlrev_b32 v252, 16, v12
    v_and_b32 v253, 0xffff0000, v12
    v_pk_add_f32 v[244:245], v[244:245], v[252:253]
    v_cvt_pk_bf16_f32 v12, v244, v245
    v_lshlrev_b32 v252, 16, v13
    v_and_b32 v253, 0xffff0000, v13
    v_pk_add_f32 v[246:247], v[246:247], v[252:253]
    v_cvt_pk_bf16_f32 v13, v246, v247
    v_lshlrev_b32 v252, 16, v14
    v_and_b32 v253, 0xffff0000, v14
    v_pk_add_f32 v[248:249], v[248:249], v[252:253]
    v_cvt_pk_bf16_f32 v14, v248, v249
    v_lshlrev_b32 v252, 16, v15
    v_and_b32 v253, 0xffff0000, v15
    v_pk_add_f32 v[250:251], v[250:251], v[252:253]
    v_cvt_pk_bf16_f32 v15, v250, v251
    buffer_store_dwordx4 v[12:15], v5, s[32:35], s55 offen
    v_mfma_f32_16x16x32_bf16 v[172:175], v[44:47], v[184:187], v[172:175]
    ds_read_b128 v[184:187], v7 offset:3968
    ds_read_b128 v[240:243], v255 offset:24576
    v_mfma_f32_16x16x32_bf16 v[172:175], v[40:43], v[188:191], v[172:175]
    ds_read_b128 v[188:191], v7 offset:4032
    v_mfma_f32_16x16x32_bf16 v[172:175], v[36:39], v[192:195], v[172:175]
    v_mfma_f32_16x16x32_bf16 v[172:175], v[32:35], v[196:199], v[172:175]
    v_mfma_f32_16x16x32_bf16 v[172:175], v[28:31], v[176:179], v[172:175]
    v_mfma_f32_16x16x32_bf16 v[172:175], v[24:27], v[180:183], v[172:175]
    v_cvt_pk_bf16_f32 v10, v168, v169
    s_waitcnt lgkmcnt(1)
    v_mfma_f32_16x16x32_bf16 v[172:175], v[20:23], v[184:187], v[172:175]
    v_cvt_pk_bf16_f32 v11, v170, v171
    s_waitcnt lgkmcnt(0)
    v_mfma_f32_16x16x32_bf16 v[172:175], v[16:19], v[188:191], v[172:175]
    ds_write_b64 v8, v[10:11] offset:3072
    v_lshlrev_b32 v244, 16, v240
    v_and_b32 v245, 0xffff0000, v240
    v_lshlrev_b32 v246, 16, v241
    v_and_b32 v247, 0xffff0000, v241
    v_lshlrev_b32 v248, 16, v242
    v_and_b32 v249, 0xffff0000, v242
    v_lshlrev_b32 v250, 16, v243
    v_and_b32 v251, 0xffff0000, v243
    v_cvt_pk_bf16_f32 v10, v172, v173
    v_cvt_pk_bf16_f32 v11, v174, v175
    ds_write_b64 v8, v[10:11] offset:3584
    s_waitcnt lgkmcnt(0)
    s_waitcnt vmcnt(2)
    s_barrier
    ds_read_b64_tr_b16 v[12:13], v4 offset:3072
    ds_read_b64_tr_b16 v[14:15], v4 offset:37120
    s_lshl_b32 s43, s44, 11
    s_add_u32 s43, s43, 491520
    v_lshl_add_u32 v9, v1, 4, s43
    v_cmp_ne_u32 vcc, s52, v111
    s_cbranch_vccz L_conv_selok
    s_mov_b32 s43, 0
L_poll_sel:
    buffer_load_dwordx4 v[108:111], v254, s[36:39], 0 offen sc1
    s_waitcnt vmcnt(0)
    v_xor_b32 v11, s52, v111
    v_cmp_ne_u32 vcc, 0, v11
    s_cbranch_vccz L_polled_sel
    s_add_u32 s43, s43, 1
    s_cmp_ge_u32 s43, 65536
    s_cbranch_scc1 L_polled_sel
    s_sleep 2
    s_branch L_poll_sel
L_polled_sel:
L_conv_selok:
    s_cmp_lg_u32 s45, 0
    s_cbranch_scc1 L_conv_noy
    buffer_load_dwordx4 v[16:19], v9, s[36:39], 0 offen offset:0 sc1
    buffer_load_dwordx4 v[20:23], v9, s[36:39], 0 offen offset:1024 sc1
L_conv_noy:
    v_readlane_b32 s4, v108, 0
    v_readlane_b32 s5, v108, 1
    v_readlane_b32 s6, v108, 2
    v_readlane_b32 s7, v108, 3
    v_readlane_b32 s8, v108, 4
    v_readlane_b32 s9, v108, 5
    v_readlane_b32 s10, v108, 6
    v_readlane_b32 s11, v108, 7
    v_add_u32 v11, 1536, v0
    s_mov_b32 s43, 0x300000
    s_waitcnt lgkmcnt(0)
    v_lshlrev_b32 v252, 16, v12
    v_and_b32 v253, 0xffff0000, v12
    v_pk_add_f32 v[244:245], v[244:245], v[252:253]
    v_cvt_pk_bf16_f32 v12, v244, v245
    v_lshlrev_b32 v252, 16, v13
    v_and_b32 v253, 0xffff0000, v13
    v_pk_add_f32 v[246:247], v[246:247], v[252:253]
    v_cvt_pk_bf16_f32 v13, v246, v247
    v_lshlrev_b32 v252, 16, v14
    v_and_b32 v253, 0xffff0000, v14
    v_pk_add_f32 v[248:249], v[248:249], v[252:253]
    v_cvt_pk_bf16_f32 v14, v248, v249
    v_lshlrev_b32 v252, 16, v15
    v_and_b32 v253, 0xffff0000, v15
    v_pk_add_f32 v[250:251], v[250:251], v[252:253]
    v_cvt_pk_bf16_f32 v15, v250, v251
    v_cmpx_ne_u32 vcc, s4, v11
    s_nop 4
    v_cmpx_ne_u32 vcc, s5, v11
    s_nop 4
    v_cmpx_ne_u32 vcc, s6, v11
    s_nop 4
    v_cmpx_ne_u32 vcc, s7, v11
    s_nop 4
    v_cmpx_ne_u32 vcc, s8, v11
    s_nop 4
    v_cmpx_ne_u32 vcc, s9, v11
    s_nop 4
    v_cmpx_ne_u32 vcc, s10, v11
    s_nop 4
    v_cmpx_ne_u32 vcc, s11, v11
    s_nop 3
    buffer_store_dwordx4 v[12:15], v5, s[32:35], s43 offen
    s_mov_b64 exec, -1
    s_cmp_eq_u32 s45, 0
    s_cbranch_scc1 L_conv_fin
    s_waitcnt vmcnt(1)
    s_barrier
    s_branch L_conv_end
L_conv_fin:
    v_bfe_u32 v10, v1, 3, 1
    v_mul_u32_u24 v11, 34048, v10
    v_lshl_add_u32 v11, v108, 1, v11
    v_add_u32 v11, 0, v11
    ds_read_u16 v36, v11 offset:0
    ds_read_u16 v37, v11 offset:8512
    ds_read_u16 v38, v11 offset:17024
    ds_read_u16 v39, v11 offset:25536
    v_bfe_u32 v11, v108, 4, 2
    v_xor_b32 v11, v11, v108
    v_lshlrev_b32 v11, 4, v11
    v_lshl_add_u32 v11, v10, 3, v11
    v_add_u32 v11, 129024, v11
    ds_read_b64 v[44:45], v11
    v_lshlrev_b32 v12, 11, v108
    v_lshl_add_u32 v12, v10, 3, v12
    v_add_u32 v12, s49, v12
    s_mov_b32 s12, 0x0c0c0400
    s_mov_b32 s13, 0x05040100
    s_mov_b32 s43, 0
    s_waitcnt vmcnt(1)
L_conv_y:
    v_perm_b32 v13, v17, v16, s12
    v_perm_b32 v14, v19, v18, s12
    v_perm_b32 v32, v14, v13, s13
    v_perm_b32 v13, v21, v20, s12
    v_perm_b32 v14, v23, v22, s12
    v_perm_b32 v33, v14, v13, s13
    v_xor_b32 v32, s52, v32
    v_bitop3_b32 v32, v32, v33, s52 bitop3:0xf6
    v_cmp_ne_u32 vcc, 0, v32
    s_cbranch_vccz L_conv_yok
    s_add_u32 s43, s43, 1
    s_cmp_ge_u32 s43, 65536
    s_cbranch_scc1 L_conv_yok
    s_mov_b64 exec, vcc
    buffer_load_dwordx4 v[16:19], v9, s[36:39], 0 offen offset:0 sc1
    buffer_load_dwordx4 v[20:23], v9, s[36:39], 0 offen offset:1024 sc1
    s_mov_b64 exec, -1
    s_waitcnt vmcnt(0)
    s_branch L_conv_y
L_conv_yok:
    v_pk_add_f32 v[16:17], v[16:17], v[20:21]
    v_pk_add_f32 v[18:19], v[18:19], v[22:23]
    v_mov_b32 v20, v16
    v_mov_b32 v21, v17
    v_mov_b32 v22, v18
    v_mov_b32 v23, v19
    v_permlane16_swap_b32 v16, v20
    v_permlane16_swap_b32 v17, v21
    v_permlane16_swap_b32 v18, v22
    v_permlane16_swap_b32 v19, v23
    v_pk_add_f32 v[16:17], v[16:17], v[20:21]
    v_pk_add_f32 v[18:19], v[18:19], v[22:23]
    v_mov_b32 v20, v16
    v_mov_b32 v21, v17
    v_mov_b32 v22, v18
    v_mov_b32 v23, v19
    v_permlane32_swap_b32 v16, v20
    v_permlane32_swap_b32 v17, v21
    v_permlane32_swap_b32 v18, v22
    v_permlane32_swap_b32 v19, v23
    v_pk_add_f32 v[16:17], v[16:17], v[20:21]
    v_pk_add_f32 v[18:19], v[18:19], v[22:23]
    s_waitcnt lgkmcnt(0)
    v_lshlrev_b32 v36, 16, v36
    v_lshlrev_b32 v37, 16, v37
    v_lshlrev_b32 v38, 16, v38
    v_lshlrev_b32 v39, 16, v39
    v_lshlrev_b32 v48, 16, v44
    v_and_b32 v49, 0xffff0000, v44
    v_lshlrev_b32 v50, 16, v45
    v_and_b32 v51, 0xffff0000, v45
    v_pk_add_f32 v[36:37], v[36:37], v[48:49]
    v_pk_add_f32 v[38:39], v[38:39], v[50:51]
    v_fma_f32 v16, v16, v109, v36
    v_fma_f32 v17, v17, v109, v37
    v_fma_f32 v18, v18, v109, v38
    v_fma_f32 v19, v19, v109, v39
    v_cvt_pk_bf16_f32 v16, v16, v17
    v_cvt_pk_bf16_f32 v17, v18, v19
    s_barrier
    s_mov_b64 exec, 0xffff
    buffer_store_dwordx2 v[16:17], v12, s[32:35], 0 offen
L_conv_end:
    s_endpgm
L_code_end:
.section .rodata,"a"
.p2align 6
.amdhsa_kernel parallel_sum__ssm_conv_s4d__moe_arch_mod__prompt_kernel
  .amdhsa_next_free_vgpr 256
  .amdhsa_next_free_sgpr 96
  .amdhsa_accum_offset 256
  .amdhsa_group_segment_fixed_size 0
  .amdhsa_kernarg_size 120
  .amdhsa_user_sgpr_count 2
  .amdhsa_user_sgpr_kernarg_segment_ptr 1
  .amdhsa_system_sgpr_workgroup_id_x 1
.end_amdhsa_kernel
```

```asm
; @launch grid=(256,1,1) block=(512,1,1) lds=162368
.amdgcn_target "amdgcn-amd-amdhsa--gfx950"
.text
.globl parallel_sum__ssm_conv_s4d__moe_arch_mod__prompt_kernel
.p2align 8
.type parallel_sum__ssm_conv_s4d__moe_arch_mod__prompt_kernel,@function
parallel_sum__ssm_conv_s4d__moe_arch_mod__prompt_kernel:
    s_cmp_ge_u32 s2, 256
    s_cbranch_scc1 L_exit
    s_load_dwordx16 s[4:19], s[0:1], 0
    s_load_dwordx16 s[20:35], s[0:1], 56
    v_readfirstlane_b32 s56, v0
    s_bfe_u32 s3, s2, 0x40003
    v_and_b32 v1, 63, v0
    s_lshr_b32 s56, s56, 6
    s_cmp_ge_u32 s3, 2
    s_cbranch_scc1 L_nocp
    s_cmp_lg_u32 s56, 7
    s_cbranch_scc1 L_nocp
    s_getpc_b64 s[36:37]
L_pc_all:
    s_add_u32 s36, s36, L_auxk-L_pc_all
    s_addc_u32 s37, s37, 0
    s_mov_b32 s38, L_code_end-L_auxk
    s_mov_b32 s39, 0x00020000
    v_lshlrev_b32 v172, 7, v1
    buffer_load_dword v173, v172, s[36:39], 0 offen
    v_add_u32 v172, 8192, v172
    buffer_load_dword v173, v172, s[36:39], 0 offen
    v_add_u32 v172, 8192, v172
    buffer_load_dword v173, v172, s[36:39], 0 offen
L_nocp:
    s_bitcmp1_b32 s2, 7
    s_cbranch_scc0 L_auxk
    s_and_b32 s59, s2, 7
    s_lshl_b32 s57, s59, 4
    s_add_u32 s57, s57, s3
    s_lshl_b32 s36, s57, 3
    s_add_u32 s36, s36, s56
    s_lshl_b32 s37, s36, 8
    s_lshl_b32 s36, s36, 1
    v_lshl_add_u32 v4, v1, 2, s37
    v_mov_b32 v5, s36
    v_mov_b32 v6, 0
    s_waitcnt lgkmcnt(0)
    global_load_ushort v15, v5, s[14:15]
    global_load_dword v16, v4, s[6:7] nt
    global_load_dword v17, v4, s[8:9] nt
    global_load_dword v18, v4, s[10:11] nt
    global_load_dword v19, v4, s[12:13] nt
    global_load_ushort v14, v5, s[16:17]
    global_load_dword v175, v6, s[34:35]
    s_branch L_conv
L_auxk:
    s_and_b32 s57, s2, 7
    s_lshl_b32 s58, s57, 4
    s_add_u32 s58, s58, s3
    s_cmp_ge_u32 s56, 4
    s_cbranch_scc1 L_aux_sinit
    s_lshl_b32 s36, s58, 2
    s_add_u32 s36, s36, s56
    s_lshl_b32 s36, s36, 13
    s_add_u32 s36, s36, 4096
    v_lshlrev_b32 v28, 4, v1
    v_add_u32 v30, s36, v28
    s_waitcnt lgkmcnt(0)
    global_load_dwordx4 v[64:67], v28, s[22:23] offset:0
    global_load_dwordx4 v[68:71], v28, s[22:23] offset:1024
    global_load_dwordx4 v[32:35], v30, s[4:5] offset:-4096
    global_load_dwordx4 v[36:39], v30, s[4:5] offset:-3072
    global_load_dwordx4 v[40:43], v30, s[4:5] offset:-2048
    global_load_dwordx4 v[44:47], v30, s[4:5] offset:-1024
    global_load_dwordx4 v[48:51], v30, s[4:5] offset:0
    global_load_dwordx4 v[52:55], v30, s[4:5] offset:1024
    global_load_dwordx4 v[56:59], v30, s[4:5] offset:2048
    global_load_dwordx4 v[60:63], v30, s[4:5] offset:3072
    s_load_dword s59, s[34:35], 0
L_entry_end:
    s_setprio 2
    s_mov_b64 s[36:37], s[4:5]
    s_mov_b32 s38, 4194304
    s_mov_b32 s39, 0x00020000
    s_mov_b64 s[52:53], s[28:29]
    s_mov_b32 s54, 7340032
    s_mov_b32 s55, 0x00020000
    v_and_b32 v2, 15, v0
    v_bfe_u32 v3, v0, 4, 2
    v_mov_b32 v22, 148624
    v_mov_b32 v23, 1
    s_mov_b64 s[40:41], s[34:35]
    s_mov_b32 s42, 753664
    s_mov_b32 s43, 0x00020000
    s_and_b32 s61, s3, 1
    s_lshr_b32 s6, s3, 1
    s_add_u32 s7, s57, 3
    s_and_b32 s7, s7, 7
    s_cmp_eq_u32 s7, 7
    s_cselect_b32 s8, 7, 6
    s_add_u32 s9, s6, 1
    s_cmp_eq_u32 s9, s8
    s_cselect_b32 s9, 0, s9
    s_cmp_ge_u32 s9, s7
    s_addc_u32 s9, s9, 0
    s_cmp_ge_u32 s6, s7
    s_addc_u32 s10, s6, 0
    s_cmp_eq_u32 s7, 7
    s_cselect_b32 s62, 0, 1
    s_cmp_lt_u32 s6, s8
    s_cselect_b32 s62, 2, s62
    s_cselect_b32 s10, s10, s7
    s_cselect_b32 s11, 0, s6
    s_and_b32 s11, s11, 1
    s_cmp_ge_u32 s3, 3
    s_addc_u32 s63, s3, 0
    s_cmp_ge_u32 s3, 10
    s_addc_u32 s63, s63, 0
    s_sub_u32 s12, s6, s8
    s_cmp_eq_u32 s12, 1
    s_cselect_b32 s63, s3, s63
    s_lshl_b32 s13, s61, 3
    s_add_u32 s13, s13, 3
    s_cmp_eq_u32 s12, 0
    s_cselect_b32 s63, s13, s63
    s_mul_i32 s64, s57, 57344
    s_add_u32 s64, s64, 32768
    s_barrier
    s_lshl_b32 s6, s58, 5
    s_add_u32 s6, s6, 4096
    v_bfe_u32 v11, v1, 1, 2
    v_lshlrev_b32 v11, 12, v11
    v_and_b32 v10, 1, v1
    v_lshl_add_u32 v11, v10, 4, v11
    v_add_u32 v11, s6, v11
    s_and_b32 s6, s56, 1
    s_lshl_b32 s6, s6, 6
    s_lshr_b32 s7, s56, 1
    s_lshl_b32 s7, s7, 4
    s_add_u32 s6, s6, s7
    s_add_u32 s6, s6, 148944
    v_lshlrev_b32 v10, 5, v3
    v_add_u32 v10, s6, v10
    v_lshl_add_u32 v9, v1, 4, v22
    s_mov_b32 s8, 0x3f803f80
    s_waitcnt vmcnt(8)
    v_dot2_f32_bf16 v84, s8, v64, 0
    v_dot2_f32_bf16 v85, s8, v65, 0
    s_nop 1
    v_dot2c_f32_bf16 v84, s8, v66
    v_dot2c_f32_bf16 v85, s8, v67
    v_dot2c_f32_bf16 v84, s8, v68
    v_dot2c_f32_bf16 v85, s8, v69
    v_dot2c_f32_bf16 v84, s8, v70
    v_dot2c_f32_bf16 v85, s8, v71
    s_waitcnt vmcnt(6)
    v_dot2_f32_bf16 v72, s8, v32, 0
    v_dot2_f32_bf16 v76, v32, v32, 0
    v_dot2_f32_bf16 v80, v64, v32, 0
    s_nop 0
    v_dot2c_f32_bf16 v72, s8, v33
    v_dot2c_f32_bf16 v76, v33, v33
    v_dot2c_f32_bf16 v80, v65, v33
    v_dot2c_f32_bf16 v72, s8, v34
    v_dot2c_f32_bf16 v76, v34, v34
    v_dot2c_f32_bf16 v80, v66, v34
    v_dot2c_f32_bf16 v72, s8, v35
    v_dot2c_f32_bf16 v76, v35, v35
    v_dot2c_f32_bf16 v80, v67, v35
    v_dot2c_f32_bf16 v72, s8, v36
    v_dot2c_f32_bf16 v76, v36, v36
    v_dot2c_f32_bf16 v80, v68, v36
    v_dot2c_f32_bf16 v72, s8, v37
    v_dot2c_f32_bf16 v76, v37, v37
    v_dot2c_f32_bf16 v80, v69, v37
    v_dot2c_f32_bf16 v72, s8, v38
    v_dot2c_f32_bf16 v76, v38, v38
    v_dot2c_f32_bf16 v80, v70, v38
    v_dot2c_f32_bf16 v72, s8, v39
    v_dot2c_f32_bf16 v76, v39, v39
    v_dot2c_f32_bf16 v80, v71, v39
    v_add_f32 v84, v84, v85
    s_waitcnt vmcnt(4)
    v_dot2_f32_bf16 v73, s8, v40, 0
    v_dot2_f32_bf16 v77, v40, v40, 0
    v_dot2_f32_bf16 v81, v64, v40, 0
    s_nop 0
    v_dot2c_f32_bf16 v73, s8, v41
    v_dot2c_f32_bf16 v77, v41, v41
    v_dot2c_f32_bf16 v81, v65, v41
    v_dot2c_f32_bf16 v73, s8, v42
    v_dot2c_f32_bf16 v77, v42, v42
    v_dot2c_f32_bf16 v81, v66, v42
    v_dot2c_f32_bf16 v73, s8, v43
    v_dot2c_f32_bf16 v77, v43, v43
    v_dot2c_f32_bf16 v81, v67, v43
    v_dot2c_f32_bf16 v73, s8, v44
    v_dot2c_f32_bf16 v77, v44, v44
    v_dot2c_f32_bf16 v81, v68, v44
    v_dot2c_f32_bf16 v73, s8, v45
    v_dot2c_f32_bf16 v77, v45, v45
    v_dot2c_f32_bf16 v81, v69, v45
    v_dot2c_f32_bf16 v73, s8, v46
    v_dot2c_f32_bf16 v77, v46, v46
    v_dot2c_f32_bf16 v81, v70, v46
    v_dot2c_f32_bf16 v73, s8, v47
    v_dot2c_f32_bf16 v77, v47, v47
    v_dot2c_f32_bf16 v81, v71, v47
    v_mov_b32 v85, v84
    s_waitcnt vmcnt(2)
    v_dot2_f32_bf16 v74, s8, v48, 0
    v_dot2_f32_bf16 v78, v48, v48, 0
    v_dot2_f32_bf16 v82, v64, v48, 0
    s_nop 0
    v_dot2c_f32_bf16 v74, s8, v49
    v_dot2c_f32_bf16 v78, v49, v49
    v_dot2c_f32_bf16 v82, v65, v49
    v_dot2c_f32_bf16 v74, s8, v50
    v_dot2c_f32_bf16 v78, v50, v50
    v_dot2c_f32_bf16 v82, v66, v50
    v_dot2c_f32_bf16 v74, s8, v51
    v_dot2c_f32_bf16 v78, v51, v51
    v_dot2c_f32_bf16 v82, v67, v51
    v_dot2c_f32_bf16 v74, s8, v52
    v_dot2c_f32_bf16 v78, v52, v52
    v_dot2c_f32_bf16 v82, v68, v52
    v_dot2c_f32_bf16 v74, s8, v53
    v_dot2c_f32_bf16 v78, v53, v53
    v_dot2c_f32_bf16 v82, v69, v53
    v_dot2c_f32_bf16 v74, s8, v54
    v_dot2c_f32_bf16 v78, v54, v54
    v_dot2c_f32_bf16 v82, v70, v54
    v_dot2c_f32_bf16 v74, s8, v55
    v_dot2c_f32_bf16 v78, v55, v55
    v_dot2c_f32_bf16 v82, v71, v55
    s_waitcnt vmcnt(0)
    v_dot2_f32_bf16 v75, s8, v56, 0
    v_dot2_f32_bf16 v79, v56, v56, 0
    v_dot2_f32_bf16 v83, v64, v56, 0
    s_nop 0
    v_dot2c_f32_bf16 v75, s8, v57
    v_dot2c_f32_bf16 v79, v57, v57
    v_dot2c_f32_bf16 v83, v65, v57
    v_dot2c_f32_bf16 v75, s8, v58
    v_dot2c_f32_bf16 v79, v58, v58
    v_dot2c_f32_bf16 v83, v66, v58
    v_dot2c_f32_bf16 v75, s8, v59
    v_dot2c_f32_bf16 v79, v59, v59
    v_dot2c_f32_bf16 v83, v67, v59
    v_dot2c_f32_bf16 v75, s8, v60
    v_dot2c_f32_bf16 v79, v60, v60
    v_dot2c_f32_bf16 v83, v68, v60
    v_dot2c_f32_bf16 v75, s8, v61
    v_dot2c_f32_bf16 v79, v61, v61
    v_dot2c_f32_bf16 v83, v69, v61
    v_dot2c_f32_bf16 v75, s8, v62
    v_dot2c_f32_bf16 v79, v62, v62
    v_dot2c_f32_bf16 v83, v70, v62
    v_dot2c_f32_bf16 v75, s8, v63
    v_dot2c_f32_bf16 v79, v63, v63
    v_dot2c_f32_bf16 v83, v71, v63
    v_permlane32_swap_b32 v84, v85
    v_permlane32_swap_b32 v72, v73
    v_permlane32_swap_b32 v76, v77
    v_permlane32_swap_b32 v80, v81
    v_permlane32_swap_b32 v74, v75
    v_permlane32_swap_b32 v78, v79
    v_permlane32_swap_b32 v82, v83
    v_add_f32 v84, v84, v85
    v_add_f32 v72, v72, v73
    v_add_f32 v76, v76, v77
    v_add_f32 v80, v80, v81
    v_add_f32 v74, v74, v75
    v_add_f32 v78, v78, v79
    v_add_f32 v82, v82, v83
    v_mov_b32 v86, v84
    v_permlane16_swap_b32 v72, v74
    v_permlane16_swap_b32 v76, v78
    v_permlane16_swap_b32 v80, v82
    v_permlane16_swap_b32 v84, v86
    v_add_f32 v72, v72, v74
    v_add_f32 v76, v76, v78
    v_add_f32 v80, v80, v82
    v_add_f32 v84, v84, v86
    v_add_f32_dpp v72, v72, v72 row_ror:8 row_mask:0xf bank_mask:0xf
    v_add_f32_dpp v76, v76, v76 row_ror:8 row_mask:0xf bank_mask:0xf
    v_add_f32_dpp v80, v80, v80 row_ror:8 row_mask:0xf bank_mask:0xf
    v_add_f32_dpp v84, v84, v84 row_ror:8 row_mask:0xf bank_mask:0xf
    v_add_f32_dpp v72, v72, v72 row_ror:4 row_mask:0xf bank_mask:0xf
    v_add_f32_dpp v76, v76, v76 row_ror:4 row_mask:0xf bank_mask:0xf
    v_add_f32_dpp v80, v80, v80 row_ror:4 row_mask:0xf bank_mask:0xf
    v_add_f32_dpp v84, v84, v84 row_ror:4 row_mask:0xf bank_mask:0xf
    v_add_f32_dpp v72, v72, v72 row_ror:2 row_mask:0xf bank_mask:0xf
    v_add_f32_dpp v76, v76, v76 row_ror:2 row_mask:0xf bank_mask:0xf
    v_add_f32_dpp v80, v80, v80 row_ror:2 row_mask:0xf bank_mask:0xf
    v_add_f32_dpp v84, v84, v84 row_ror:2 row_mask:0xf bank_mask:0xf
    v_add_f32_dpp v72, v72, v72 row_ror:1 row_mask:0xf bank_mask:0xf
    v_add_f32_dpp v76, v76, v76 row_ror:1 row_mask:0xf bank_mask:0xf
    v_add_f32_dpp v80, v80, v80 row_ror:1 row_mask:0xf bank_mask:0xf
    v_add_f32_dpp v84, v84, v84 row_ror:1 row_mask:0xf bank_mask:0xf
    s_waitcnt lgkmcnt(0)
    s_mul_i32 s60, s59, 0x9e3779b1
    s_add_u32 s60, s60, 0x7f4a7c15
    v_mul_f32 v42, 0x3a800000, v72
    v_mul_f32 v43, 0x3a800000, v76
    v_fma_f32 v43, -v42, v42, v43
    v_max_f32 v43, 0, v43
    v_cvt_pk_bf16_f32 v42, v42, v43
    v_and_b32 v43, 0xffff0000, v42
    v_lshlrev_b32 v45, 16, v42
    v_add_f32 v43, 0x3727c5ac, v43
    v_cvt_pk_bf16_f32 v43, v43, v43
    v_and_b32 v43, 0xffff0000, v43
    v_sqrt_f32 v43, v43
    v_fma_f32 v44, -v45, v84, v80
    v_cvt_pk_bf16_f32 v60, v45, v43
    v_and_b32 v43, 0xffff0000, v60
    v_rcp_f32 v46, v43
    v_mov_b32 v61, v60
    v_mul_f32 v44, v44, v46
    v_cvt_pk_bf16_f32 v64, v44, v44
    v_ashrrev_i32 v65, 31, v64
    v_or_b32 v65, 0x80000000, v65
    v_xor_b32 v64, v64, v65
    v_permlane32_swap_b32 v60, v61
    v_lshrrev_b32 v64, 16, v64
    v_mov_b32 v63, s60
    v_mov_b32 v65, v64
    s_nop 1
    v_permlane32_swap_b32 v64, v65
    v_lshl_or_b32 v62, v65, 16, v64
    s_mov_b64 exec, 0x10001
    ds_write_b128 v10, v[60:63]
    s_mov_b64 exec, 1
    ds_add_rtn_u32 v13, v22, v23 offset:264
    s_mov_b64 exec, 0xff
    ds_read_b128 v[60:63], v9 offset:320
    s_waitcnt lgkmcnt(0)
    v_readfirstlane_b32 s6, v13
    s_cmp_lg_u32 s6, 3
    s_cbranch_scc1 L_aux_nopub
    buffer_store_dwordx4 v[60:63], v11, s[40:43], 0 offen sc1
    ds_write_b32 v22, v63 offset:284
    ds_write_b32 v22, v23 offset:260
L_aux_nopub:
    s_mov_b64 exec, -1
    s_bfe_u32 s65, s60, 0x80000
    s_bfe_u32 s66, s60, 0x80008
    s_bfe_u32 s67, s60, 0x80010
    s_bfe_u32 s68, s60, 0x80018
    s_cmp_lg_u32 s58, 78
    s_cbranch_scc1 L_aux_cons
    v_lshlrev_b32 v12, 4, v0
    v_add_u32 v12, 4096, v12
    v_lshlrev_b32 v13, 3, v0
    v_sub_u32 v13, 0x800, v13
    v_subrev_u32 v88, 0, v13
    v_subrev_u32 v89, 1, v13
    v_subrev_u32 v90, 2, v13
    v_subrev_u32 v91, 3, v13
    v_subrev_u32 v92, 4, v13
    v_subrev_u32 v93, 5, v13
    v_subrev_u32 v94, 6, v13
    v_subrev_u32 v95, 7, v13
    s_mov_b32 s6, 4096
    s_mov_b32 s7, 8192
    s_mov_b32 s8, 12288
    s_mov_b32 s9, 0xffff0000
    v_lshrrev_b32 v24, 4, v0
    v_lshl_add_u32 v24, v24, 2, v22
    v_lshl_add_u32 v25, v2, 2, v22
    v_and_b32 v26, 31, v1
    v_lshl_add_u32 v26, v26, 2, v22
    v_lshrrev_b32 v27, 5, v1
    v_lshl_add_u32 v27, v27, 6, v22
    s_lshl_b32 s10, s56, 5
    s_add_u32 s10, s10, 148688
    v_lshl_add_u32 v31, v1, 2, s10
    v_lshlrev_b32 v9, 5, v0
    s_sleep 28
    buffer_load_dwordx4 v[64:67], v12, s[40:43], 0 offen sc1
    buffer_load_dwordx4 v[68:71], v12, s[40:43], s6 offen sc1
    buffer_load_dwordx4 v[72:75], v12, s[40:43], s7 offen sc1
    buffer_load_dwordx4 v[76:79], v12, s[40:43], s8 offen sc1
    s_mov_b32 s11, 0
L_poll_aux:
    s_waitcnt vmcnt(0)
    v_cmp_ne_u32 s[12:13], s60, v67
    v_cmp_ne_u32 s[14:15], s60, v71
    v_cmp_ne_u32 s[16:17], s60, v75
    v_cmp_ne_u32 s[18:19], s60, v79
    s_or_b64 vcc, s[12:13], s[14:15]
    s_or_b64 vcc, vcc, s[16:17]
    s_or_b64 vcc, vcc, s[18:19]
    s_cbranch_scc0 L_polled_aux
    s_add_u32 s11, s11, 1
    s_cmp_ge_u32 s11, 65536
    s_cbranch_scc1 L_polled_aux
    s_sleep 2
    s_mov_b64 exec, s[12:13]
    s_cbranch_execz L_ps_aux_0
    buffer_load_dwordx4 v[64:67], v12, s[40:43], 0 offen sc1
L_ps_aux_0:
    s_mov_b64 exec, s[14:15]
    s_cbranch_execz L_ps_aux_1
    buffer_load_dwordx4 v[68:71], v12, s[40:43], s6 offen sc1
L_ps_aux_1:
    s_mov_b64 exec, s[16:17]
    s_cbranch_execz L_ps_aux_2
    buffer_load_dwordx4 v[72:75], v12, s[40:43], s7 offen sc1
L_ps_aux_2:
    s_mov_b64 exec, s[18:19]
    s_cbranch_execz L_ps_aux_3
    buffer_load_dwordx4 v[76:79], v12, s[40:43], s8 offen sc1
L_ps_aux_3:
    s_mov_b64 exec, -1
    s_branch L_poll_aux
L_polled_aux:
    v_lshl_or_b32 v80, v66, 16, v88
    v_and_or_b32 v81, v66, s9, v89
    v_lshl_or_b32 v82, v70, 16, v90
    v_and_or_b32 v83, v70, s9, v91
    v_lshl_or_b32 v84, v74, 16, v92
    v_and_or_b32 v85, v74, s9, v93
    v_lshl_or_b32 v86, v78, 16, v94
    v_and_or_b32 v87, v78, s9, v95
    v_max3_u32 v17, v80, v81, v82
    v_max3_u32 v18, v83, v84, v85
    v_max3_u32 v17, v17, v86, v87
    v_max_u32 v17, v17, v18
    v_max_u32 v14, v80, v81
    v_min_u32 v15, v80, v81
    v_max_u32_dpp v17, v17, v17 row_ror:8 row_mask:0xf bank_mask:0xf
    v_mov_b32 v16, 0
    v_med3_u32 v16, v15, v16, v82
    v_max_u32_dpp v17, v17, v17 row_ror:4 row_mask:0xf bank_mask:0xf
    v_med3_u32 v15, v14, v15, v82
    v_max_u32 v14, v14, v82
    v_max_u32_dpp v17, v17, v17 row_ror:2 row_mask:0xf bank_mask:0xf
    v_med3_u32 v16, v15, v16, v83
    v_med3_u32 v15, v14, v15, v83
    v_max_u32_dpp v17, v17, v17 row_ror:1 row_mask:0xf bank_mask:0xf
    ds_write_b32 v24, v17
    ds_read_b32 v17, v25
    ds_write_b64 v9, v[64:65] offset:0
    ds_write_b64 v9, v[68:69] offset:8
    ds_write_b64 v9, v[72:73] offset:16
    ds_write_b64 v9, v[76:77] offset:24
    v_max_u32 v14, v14, v83
    v_med3_u32 v16, v15, v16, v84
    v_med3_u32 v15, v14, v15, v84
    v_max_u32 v14, v14, v84
    v_med3_u32 v16, v15, v16, v85
    v_med3_u32 v15, v14, v15, v85
    v_max_u32 v14, v14, v85
    v_med3_u32 v16, v15, v16, v86
    v_med3_u32 v15, v14, v15, v86
    v_max_u32 v14, v14, v86
    v_med3_u32 v16, v15, v16, v87
    v_med3_u32 v15, v14, v15, v87
    v_max_u32 v14, v14, v87
    v_mov_b32 v19, 0
    s_mov_b32 s11, 0
    s_waitcnt lgkmcnt(4)
L_aux_gm:
    v_cmp_eq_u32 vcc, 0, v17
    s_cbranch_vccz L_aux_gmok
    ds_read_b32 v17, v25
    s_waitcnt lgkmcnt(0)
    s_add_u32 s11, s11, 1
    s_cmp_ge_u32 s11, 524288
    s_cbranch_scc1 L_aux_gmok
    s_branch L_aux_gm
L_aux_gmok:
    v_sub_co_u32_dpp v20, vcc, v17, v17 row_ror:1 row_mask:0xf bank_mask:0xf
    v_addc_co_u32 v19, vcc, 0, v19, vcc
    v_sub_co_u32_dpp v20, vcc, v17, v17 row_ror:2 row_mask:0xf bank_mask:0xf
    v_addc_co_u32 v19, vcc, 0, v19, vcc
    v_sub_co_u32_dpp v20, vcc, v17, v17 row_ror:3 row_mask:0xf bank_mask:0xf
    v_addc_co_u32 v19, vcc, 0, v19, vcc
    v_sub_co_u32_dpp v20, vcc, v17, v17 row_ror:4 row_mask:0xf bank_mask:0xf
    v_addc_co_u32 v19, vcc, 0, v19, vcc
    v_sub_co_u32_dpp v20, vcc, v17, v17 row_ror:5 row_mask:0xf bank_mask:0xf
    v_addc_co_u32 v19, vcc, 0, v19, vcc
    v_sub_co_u32_dpp v20, vcc, v17, v17 row_ror:6 row_mask:0xf bank_mask:0xf
    v_addc_co_u32 v19, vcc, 0, v19, vcc
    v_sub_co_u32_dpp v20, vcc, v17, v17 row_ror:7 row_mask:0xf bank_mask:0xf
    v_addc_co_u32 v19, vcc, 0, v19, vcc
    v_sub_co_u32_dpp v20, vcc, v17, v17 row_ror:8 row_mask:0xf bank_mask:0xf
    v_addc_co_u32 v19, vcc, 0, v19, vcc
    v_sub_co_u32_dpp v20, vcc, v17, v17 row_ror:9 row_mask:0xf bank_mask:0xf
    v_addc_co_u32 v19, vcc, 0, v19, vcc
    v_sub_co_u32_dpp v20, vcc, v17, v17 row_ror:10 row_mask:0xf bank_mask:0xf
    v_addc_co_u32 v19, vcc, 0, v19, vcc
    v_sub_co_u32_dpp v20, vcc, v17, v17 row_ror:11 row_mask:0xf bank_mask:0xf
    v_addc_co_u32 v19, vcc, 0, v19, vcc
    v_sub_co_u32_dpp v20, vcc, v17, v17 row_ror:12 row_mask:0xf bank_mask:0xf
    v_addc_co_u32 v19, vcc, 0, v19, vcc
    v_sub_co_u32_dpp v20, vcc, v17, v17 row_ror:13 row_mask:0xf bank_mask:0xf
    v_addc_co_u32 v19, vcc, 0, v19, vcc
    v_sub_co_u32_dpp v20, vcc, v17, v17 row_ror:14 row_mask:0xf bank_mask:0xf
    v_addc_co_u32 v19, vcc, 0, v19, vcc
    v_sub_co_u32_dpp v20, vcc, v17, v17 row_ror:15 row_mask:0xf bank_mask:0xf
    v_addc_co_u32 v19, vcc, 0, v19, vcc
    v_cmp_eq_u32 vcc, 8, v19
    s_ff1_i32_b64 s12, vcc
    v_readlane_b32 s12, v17, s12
    v_mov_b32 v18, 1
    s_nop 0
    v_cmp_le_u32 s[14:15], s12, v14
    v_cmp_le_u32 s[16:17], s12, v15
    v_cmp_le_u32 s[18:19], s12, v16
    s_bcnt1_i32_b64 s12, s[14:15]
    s_bcnt1_i32_b64 s20, s[16:17]
    v_mbcnt_lo_u32_b32 v20, s14, 0
    v_mbcnt_lo_u32_b32 v21, s16, 0
    v_mbcnt_hi_u32_b32 v20, s15, v20
    v_mbcnt_hi_u32_b32 v21, s17, v21
    s_add_u32 s20, s20, s12
    s_lshl_b32 s12, s12, 2
    s_add_u32 s12, s12, s10
    v_lshl_add_u32 v20, v20, 2, s10
    v_lshl_add_u32 v21, v21, 2, s12
    s_cmp_lg_u64 s[18:19], 0
    s_cselect_b32 s20, 9, s20
    s_cmp_gt_u32 s20, 8
    s_cbranch_scc0 L_aux_fit
    s_mov_b64 s[14:15], 0
    s_mov_b64 s[16:17], 0
    s_mov_b32 s20, 0
    v_mov_b32 v18, 2
L_aux_fit:
    s_lshl_b32 s20, 0xff, s20
    s_and_b32 s20, s20, 0xff
    s_mov_b32 s21, 0
    s_mov_b64 exec, s[14:15]
    ds_write_b32 v20, v14
    s_mov_b64 exec, s[16:17]
    ds_write_b32 v21, v15
    s_mov_b64 exec, s[20:21]
    ds_write_b32 v31, v18
    s_mov_b64 exec, -1
    s_mov_b32 s11, 0
    v_mov_b32 v20, 0
L_aux_ls:
    ds_read_b32 v17, v26 offset:64
    ds_read_b128 v[64:67], v27 offset:64
    ds_read_b128 v[68:71], v27 offset:80
    ds_read_b128 v[72:75], v27 offset:96
    ds_read_b128 v[76:79], v27 offset:112
    s_waitcnt lgkmcnt(4)
    v_cmp_eq_u32 vcc, 0, v17
    s_cbranch_vccz L_aux_lsok
    s_waitcnt lgkmcnt(0)
    s_add_u32 s11, s11, 1
    s_cmp_ge_u32 s11, 524288
    s_cbranch_scc1 L_aux_lsok
    s_branch L_aux_ls
L_aux_lsok:
    v_cmp_eq_u32 vcc, 2, v17
    s_cbranch_vccnz L_aux_slow
    s_cmp_ge_u32 s56, 2
    s_cbranch_scc1 L_aux_wd
    s_cmp_eq_u32 s56, 1
    s_cbranch_scc1 L_aux_nox
    v_and_b32 v60, 0xfff, v17
    v_sub_u32 v60, 0x800, v60
    v_lshlrev_b32 v15, 2, v60
    ds_read_b32 v62, v15
    s_waitcnt lgkmcnt(4)
    v_cmp_gt_u32 vcc, v64, v17
    v_addc_co_u32 v20, vcc, 0, v20, vcc
    v_cmp_gt_u32 vcc, v65, v17
    v_addc_co_u32 v20, vcc, 0, v20, vcc
    v_cmp_gt_u32 vcc, v66, v17
    v_addc_co_u32 v20, vcc, 0, v20, vcc
    v_cmp_gt_u32 vcc, v67, v17
    v_addc_co_u32 v20, vcc, 0, v20, vcc
    s_waitcnt lgkmcnt(3)
    v_cmp_gt_u32 vcc, v68, v17
    v_addc_co_u32 v20, vcc, 0, v20, vcc
    v_cmp_gt_u32 vcc, v69, v17
    v_addc_co_u32 v20, vcc, 0, v20, vcc
    v_cmp_gt_u32 vcc, v70, v17
    v_addc_co_u32 v20, vcc, 0, v20, vcc
    v_cmp_gt_u32 vcc, v71, v17
    v_addc_co_u32 v20, vcc, 0, v20, vcc
    s_waitcnt lgkmcnt(2)
    v_cmp_gt_u32 vcc, v72, v17
    v_addc_co_u32 v20, vcc, 0, v20, vcc
    v_cmp_gt_u32 vcc, v73, v17
    v_addc_co_u32 v20, vcc, 0, v20, vcc
    v_cmp_gt_u32 vcc, v74, v17
    v_addc_co_u32 v20, vcc, 0, v20, vcc
    v_cmp_gt_u32 vcc, v75, v17
    v_addc_co_u32 v20, vcc, 0, v20, vcc
    s_waitcnt lgkmcnt(1)
    v_cmp_gt_u32 vcc, v76, v17
    v_addc_co_u32 v20, vcc, 0, v20, vcc
    v_cmp_gt_u32 vcc, v77, v17
    v_addc_co_u32 v20, vcc, 0, v20, vcc
    v_cmp_gt_u32 vcc, v78, v17
    v_addc_co_u32 v20, vcc, 0, v20, vcc
    v_cmp_gt_u32 vcc, v79, v17
    v_addc_co_u32 v20, vcc, 0, v20, vcc
    v_mov_b32 v21, v20
    v_and_b32 v14, 0xffff0000, v17
    v_ashrrev_i32 v15, 31, v14
    v_permlane32_swap_b32 v20, v21
    v_not_b32 v15, v15
    v_add_u32 v20, v20, v21
    v_or_b32 v15, 0x80000000, v15
    v_xor_b32 v14, v14, v15
    v_and_b32 v14, 0xffff0000, v14
    v_mul_f32 v14, 0xbfb8aa3b, v14
    v_exp_f32 v14, v14
    v_mov_b32 v63, s60
    v_add_f32 v14, 1.0, v14
    v_rcp_f32 v14, v14
L_aux_sel:
    v_cmp_gt_u32 vcc, 8, v20
    v_lshlrev_b32 v21, 4, v20
    v_add_u32 v21, 24576, v21
    v_cvt_pk_bf16_f32 v14, v14, v14
    v_and_b32 v61, 0xffff0000, v14
    s_mov_b32 exec_lo, vcc_lo
    s_mov_b32 exec_hi, 0
    s_waitcnt lgkmcnt(0)
    buffer_store_dwordx4 v[60:63], v21, s[40:43], 0 offen sc1
    s_mov_b64 exec, -1
L_aux_nox:
    s_mov_b64 exec, 1
    ds_add_u32 v22, v23 offset:268
    s_mov_b64 exec, -1
    s_branch L_aux_b4
L_aux_cons:
    s_cmp_ge_u32 s56, 2
    s_cbranch_scc1 L_aux_wd
    s_cmp_eq_u32 s62, 0
    s_cbranch_scc1 L_aux_nox
    v_and_b32 v14, 7, v1
    v_lshlrev_b32 v21, 4, v14
    v_add_u32 v21, 24576, v21
    v_lshl_add_u32 v15, v14, 2, v22
    s_mul_i32 s6, s56, 4160
    s_add_u32 s6, s6, 131072
    s_lshl_b32 s7, s61, 10
    s_lshl_b32 s9, s56, 2
    s_sleep 80
    s_mov_b64 exec, 0xff
    s_mov_b32 s11, 0
L_aux_sp:
    buffer_load_dwordx4 v[60:63], v21, s[40:43], 0 offen sc1
    s_waitcnt vmcnt(0)
    v_cmp_ne_u32 vcc, s60, v63
    s_cbranch_vccz L_aux_spok
    s_add_u32 s11, s11, 1
    s_cmp_ge_u32 s11, 65536
    s_cbranch_scc1 L_aux_spok
    s_sleep 2
    s_branch L_aux_sp
L_aux_spok:
    v_lshl_add_u32 v60, v60, 11, s7
    ds_write_b32 v15, v62 offset:192
    s_mov_b64 exec, -1
    v_readlane_b32 s12, v60, s9
    s_add_u32 s9, s9, 1
    v_readlane_b32 s13, v60, s9
    s_add_u32 s9, s9, 1
    v_readlane_b32 s14, v60, s9
    s_add_u32 s9, s9, 1
    v_readlane_b32 s15, v60, s9
    s_add_u32 m0, s6, 0
    s_nop 0
    buffer_load_dwordx4 v28, s[36:39], s12 offen lds
    s_add_u32 m0, s6, 1040
    s_nop 0
    buffer_load_dwordx4 v28, s[36:39], s13 offen lds
    s_add_u32 m0, s6, 2080
    s_nop 0
    buffer_load_dwordx4 v28, s[36:39], s14 offen lds
    s_add_u32 m0, s6, 3120
    s_nop 0
    buffer_load_dwordx4 v28, s[36:39], s15 offen lds
    s_mov_b64 exec, 1
    ds_add_u32 v22, v23 offset:268
    s_waitcnt vmcnt(0)
    ds_add_u32 v22, v23 offset:272
    s_mov_b64 exec, -1
    s_branch L_aux_b4
L_aux_wd:
    s_mul_i32 s6, s57, 917504
    s_lshl_b32 s7, s63, 7
    s_add_u32 s6, s6, s7
    s_and_b32 s7, s56, 1
    s_lshl_b32 s8, s7, 14
    s_add_u32 s6, s6, s8
    v_lshrrev_b32 v14, 3, v1
    v_and_b32 v15, 7, v1
    v_xor_b32 v15, v15, v3
    s_lshl_b32 s8, s7, 2
    v_xor_b32 v15, s8, v15
    v_lshlrev_b32 v14, 11, v14
    v_lshl_add_u32 v14, v15, 4, v14
    v_add_u32 v14, s6, v14
    s_lshl_b32 s7, s7, 10
    s_setprio 0
    s_and_b32 s8, s63, 7
    s_cmp_eq_u32 s8, 3
    s_cselect_b32 s8, s62, 0
    s_cmp_lg_u32 s8, 1
    s_cbranch_scc1 L_aux_wdl
    s_mov_b32 s11, 0
L_lw_iss:
    ds_read_b32 v18, v22 offset:280
    s_add_u32 s11, s11, 1
    s_cmp_ge_u32 s11, 524288
    s_cbranch_scc1 L_lwx_iss
    s_waitcnt lgkmcnt(0)
    v_readfirstlane_b32 s8, v18
    s_cmp_ge_u32 s8, 4
    s_cbranch_scc1 L_lwx_iss
    s_sleep 1
    s_branch L_lw_iss
L_lwx_iss:
    s_waitcnt lgkmcnt(0)
    s_mov_b32 s6, 0
    s_add_u32 m0, s7, 0
    s_nop 0
    buffer_load_dwordx4 v14, s[52:55], s6 offen nt lds
    s_mov_b32 s6, 32768
    s_add_u32 m0, s7, 2048
    s_nop 0
    buffer_load_dwordx4 v14, s[52:55], s6 offen nt lds
    s_mov_b32 s6, 65536
    s_add_u32 m0, s7, 4096
    s_nop 0
    buffer_load_dwordx4 v14, s[52:55], s6 offen nt lds
    s_mov_b32 s6, 98304
    s_add_u32 m0, s7, 6144
    s_nop 0
    buffer_load_dwordx4 v14, s[52:55], s6 offen nt lds
    s_mov_b32 s6, 131072
    s_add_u32 m0, s7, 8192
    s_nop 0
    buffer_load_dwordx4 v14, s[52:55], s6 offen nt lds
    s_mov_b32 s6, 163840
    s_add_u32 m0, s7, 10240
    s_nop 0
    buffer_load_dwordx4 v14, s[52:55], s6 offen nt lds
    s_mov_b32 s6, 196608
    s_add_u32 m0, s7, 12288
    s_nop 0
    buffer_load_dwordx4 v14, s[52:55], s6 offen nt lds
    s_mov_b32 s6, 229376
    s_add_u32 m0, s7, 14336
    s_nop 0
    buffer_load_dwordx4 v14, s[52:55], s6 offen nt lds
    s_mov_b32 s6, 262144
    s_add_u32 m0, s7, 32768
    s_nop 0
    buffer_load_dwordx4 v14, s[52:55], s6 offen nt lds
    s_mov_b32 s6, 294912
    s_add_u32 m0, s7, 34816
    s_nop 0
    buffer_load_dwordx4 v14, s[52:55], s6 offen nt lds
    s_mov_b32 s6, 327680
    s_add_u32 m0, s7, 36864
    s_nop 0
    buffer_load_dwordx4 v14, s[52:55], s6 offen nt lds
    s_mov_b32 s6, 360448
    s_add_u32 m0, s7, 38912
    s_nop 0
    buffer_load_dwordx4 v14, s[52:55], s6 offen nt lds
    s_mov_b32 s11, 0
L_lw_wd2:
    ds_read_b32 v18, v22 offset:268
    s_add_u32 s11, s11, 1
    s_cmp_ge_u32 s11, 524288
    s_cbranch_scc1 L_lwx_wd2
    s_waitcnt lgkmcnt(0)
    v_readfirstlane_b32 s8, v18
    s_cmp_ge_u32 s8, 6
    s_cbranch_scc1 L_lwx_wd2
    s_branch L_lw_wd2
L_lwx_wd2:
    s_waitcnt lgkmcnt(0)
    s_branch L_aux_wdr
L_aux_wdl:
    s_mov_b32 s11, 0
L_lw_wd:
    ds_read_b32 v18, v22 offset:268
    s_add_u32 s11, s11, 1
    s_cmp_ge_u32 s11, 524288
    s_cbranch_scc1 L_lwx_wd
    s_waitcnt lgkmcnt(0)
    v_readfirstlane_b32 s8, v18
    s_cmp_ge_u32 s8, 6
    s_cbranch_scc1 L_lwx_wd
    s_branch L_lw_wd
L_lwx_wd:
    s_waitcnt lgkmcnt(0)
    s_mov_b32 s6, 0
    s_add_u32 m0, s7, 0
    s_nop 0
    buffer_load_dwordx4 v14, s[52:55], s6 offen nt lds
    s_mov_b32 s6, 32768
    s_add_u32 m0, s7, 2048
    s_nop 0
    buffer_load_dwordx4 v14, s[52:55], s6 offen nt lds
    s_mov_b32 s6, 65536
    s_add_u32 m0, s7, 4096
    s_nop 0
    buffer_load_dwordx4 v14, s[52:55], s6 offen nt lds
    s_mov_b32 s6, 98304
    s_add_u32 m0, s7, 6144
    s_nop 0
    buffer_load_dwordx4 v14, s[52:55], s6 offen nt lds
    s_mov_b32 s6, 131072
    s_add_u32 m0, s7, 8192
    s_nop 0
    buffer_load_dwordx4 v14, s[52:55], s6 offen nt lds
    s_mov_b32 s6, 163840
    s_add_u32 m0, s7, 10240
    s_nop 0
    buffer_load_dwordx4 v14, s[52:55], s6 offen nt lds
    s_mov_b32 s6, 196608
    s_add_u32 m0, s7, 12288
    s_nop 0
    buffer_load_dwordx4 v14, s[52:55], s6 offen nt lds
    s_mov_b32 s6, 229376
    s_add_u32 m0, s7, 14336
    s_nop 0
    buffer_load_dwordx4 v14, s[52:55], s6 offen nt lds
    s_mov_b32 s6, 262144
    s_add_u32 m0, s7, 32768
    s_nop 0
    buffer_load_dwordx4 v14, s[52:55], s6 offen nt lds
    s_mov_b32 s6, 294912
    s_add_u32 m0, s7, 34816
    s_nop 0
    buffer_load_dwordx4 v14, s[52:55], s6 offen nt lds
    s_mov_b32 s6, 327680
    s_add_u32 m0, s7, 36864
    s_nop 0
    buffer_load_dwordx4 v14, s[52:55], s6 offen nt lds
    s_mov_b32 s6, 360448
    s_add_u32 m0, s7, 38912
    s_nop 0
    buffer_load_dwordx4 v14, s[52:55], s6 offen nt lds
L_aux_wdr:
    s_mov_b32 s6, 393216
    s_add_u32 m0, s7, 40960
    s_nop 0
    buffer_load_dwordx4 v14, s[52:55], s6 offen nt lds
    s_mov_b32 s6, 425984
    s_add_u32 m0, s7, 43008
    s_nop 0
    buffer_load_dwordx4 v14, s[52:55], s6 offen nt lds
    s_mov_b32 s6, 458752
    s_add_u32 m0, s7, 45056
    s_nop 0
    buffer_load_dwordx4 v14, s[52:55], s6 offen nt lds
    s_mov_b32 s6, 491520
    s_add_u32 m0, s7, 47104
    s_nop 0
    buffer_load_dwordx4 v14, s[52:55], s6 offen nt lds
    s_mov_b32 s6, 524288
    s_add_u32 m0, s7, 65536
    s_nop 0
    buffer_load_dwordx4 v14, s[52:55], s6 offen nt lds
    s_mov_b32 s6, 557056
    s_add_u32 m0, s7, 67584
    s_nop 0
    buffer_load_dwordx4 v14, s[52:55], s6 offen nt lds
    s_mov_b32 s6, 589824
    s_add_u32 m0, s7, 69632
    s_nop 0
    buffer_load_dwordx4 v14, s[52:55], s6 offen nt lds
    s_mov_b32 s6, 622592
    s_add_u32 m0, s7, 71680
    s_nop 0
    buffer_load_dwordx4 v14, s[52:55], s6 offen nt lds
    s_mov_b32 s6, 655360
    s_add_u32 m0, s7, 73728
    s_nop 0
    buffer_load_dwordx4 v14, s[52:55], s6 offen nt lds
    s_mov_b32 s6, 688128
    s_add_u32 m0, s7, 75776
    s_nop 0
    buffer_load_dwordx4 v14, s[52:55], s6 offen nt lds
    s_mov_b32 s6, 720896
    s_add_u32 m0, s7, 77824
    s_nop 0
    buffer_load_dwordx4 v14, s[52:55], s6 offen nt lds
    s_mov_b32 s6, 753664
    s_add_u32 m0, s7, 79872
    s_nop 0
    buffer_load_dwordx4 v14, s[52:55], s6 offen nt lds
    s_mov_b32 s6, 786432
    s_add_u32 m0, s7, 98304
    s_nop 0
    buffer_load_dwordx4 v14, s[52:55], s6 offen nt lds
    s_mov_b32 s6, 819200
    s_add_u32 m0, s7, 100352
    s_nop 0
    buffer_load_dwordx4 v14, s[52:55], s6 offen nt lds
    s_mov_b32 s6, 851968
    s_add_u32 m0, s7, 102400
    s_nop 0
    buffer_load_dwordx4 v14, s[52:55], s6 offen nt lds
    s_mov_b32 s6, 884736
    s_add_u32 m0, s7, 104448
    s_nop 0
    buffer_load_dwordx4 v14, s[52:55], s6 offen nt lds
    s_waitcnt vmcnt(0)
    s_branch L_aux_b5
L_aux_sinit:
    v_mov_b32 v98, 148624
    v_mov_b32 v96, 0
    v_mov_b32 v97, 0
    v_lshl_add_u32 v98, v1, 3, v98
    ds_write_b64 v98, v[96:97]
    v_mov_b32 v96, 0x3f803f80
    v_and_b32 v98, 255, v0
    v_lshlrev_b32 v98, 2, v98
    v_add_u32 v98, 139392, v98
    ds_write_b32 v98, v96
    s_waitcnt lgkmcnt(0)
    v_and_b32 v2, 15, v0
    v_bfe_u32 v3, v0, 4, 2
    v_mov_b32 v22, 148624
    v_mov_b32 v23, 1
    s_mov_b64 s[40:41], s[34:35]
    s_mov_b32 s42, 753664
    s_mov_b32 s43, 0x00020000
    s_and_b32 s61, s3, 1
    s_lshr_b32 s6, s3, 1
    s_add_u32 s7, s57, 3
    s_and_b32 s7, s7, 7
    s_cmp_eq_u32 s7, 7
    s_cselect_b32 s8, 7, 6
    s_add_u32 s9, s6, 1
    s_cmp_eq_u32 s9, s8
    s_cselect_b32 s9, 0, s9
    s_cmp_ge_u32 s9, s7
    s_addc_u32 s9, s9, 0
    s_cmp_ge_u32 s6, s7
    s_addc_u32 s10, s6, 0
    s_cmp_eq_u32 s7, 7
    s_cselect_b32 s62, 0, 1
    s_cmp_lt_u32 s6, s8
    s_cselect_b32 s62, 2, s62
    s_cselect_b32 s10, s10, s7
    s_cselect_b32 s11, 0, s6
    s_and_b32 s11, s11, 1
    s_cmp_ge_u32 s3, 3
    s_addc_u32 s63, s3, 0
    s_cmp_ge_u32 s3, 10
    s_addc_u32 s63, s63, 0
    s_sub_u32 s12, s6, s8
    s_cmp_eq_u32 s12, 1
    s_cselect_b32 s63, s3, s63
    s_lshl_b32 s13, s61, 3
    s_add_u32 s13, s13, 3
    s_cmp_eq_u32 s12, 0
    s_cselect_b32 s63, s13, s63
    s_mul_i32 s64, s57, 57344
    s_add_u32 s64, s64, 32768
    s_cmp_eq_u32 s11, 1
    s_cselect_b64 s[44:45], s[26:27], s[24:25]
    s_mov_b32 s46, 7340032
    s_mov_b32 s47, 0x00020000
    s_mov_b64 s[48:49], s[26:27]
    s_mov_b32 s50, 7340032
    s_mov_b32 s51, 0x00020000
    s_lshl_b32 s12, s61, 1
    s_add_u32 s13, s12, s11
    s_mul_i32 s13, s13, 14336
    s_lshl_b32 s30, s10, 11
    s_add_u32 s30, s30, s13
    s_add_u32 s13, s12, 1
    s_mul_i32 s13, s13, 14336
    s_lshl_b32 s31, s9, 11
    s_add_u32 s31, s31, s13
    v_bfe_u32 v96, v1, 3, 2
    v_lshrrev_b32 v97, 5, v1
    v_lshl_add_u32 v96, v97, 3, v96
    v_mul_u32_u24 v96, 7168, v96
    v_lshlrev_b32 v98, 1, v3
    v_and_b32 v94, 7, v1
    v_xor_b32 v98, v98, v94
    s_mul_i32 s12, s57, 896
    s_lshl_b32 s10, s10, 7
    s_lshl_b32 s9, s9, 7
    s_add_u32 s10, s10, s12
    s_add_u32 s9, s9, s12
    v_lshl_add_u32 v96, v98, 4, v96
    v_add_u32 v97, s9, v96
    v_add_u32 v96, s10, v96
    s_sub_u32 s32, s56, 4
    s_lshl_b32 s33, s61, 2
    s_add_u32 s33, s33, s32
    s_mul_i32 s33, s33, 917504
    s_lshl_b32 s32, s32, 15
    s_barrier
    s_cmp_eq_u32 s62, 0
    s_cbranch_scc1 L_aux_idle
    s_add_u32 s6, s33, 0
    s_add_u32 m0, s32, 16384
    s_nop 0
    buffer_load_dwordx4 v96, s[44:47], s6 offen nt lds
    s_add_u32 s6, s33, 114688
    s_add_u32 m0, s32, 17408
    s_nop 0
    buffer_load_dwordx4 v96, s[44:47], s6 offen nt lds
    s_add_u32 s6, s33, 28672
    s_add_u32 m0, s32, 18432
    s_nop 0
    buffer_load_dwordx4 v96, s[44:47], s6 offen nt lds
    s_add_u32 s6, s33, 143360
    s_add_u32 m0, s32, 19456
    s_nop 0
    buffer_load_dwordx4 v96, s[44:47], s6 offen nt lds
    s_add_u32 s6, s33, 229376
    s_add_u32 m0, s32, 20480
    s_nop 0
    buffer_load_dwordx4 v96, s[44:47], s6 offen nt lds
    s_add_u32 s6, s33, 344064
    s_add_u32 m0, s32, 21504
    s_nop 0
    buffer_load_dwordx4 v96, s[44:47], s6 offen nt lds
    s_add_u32 s6, s33, 258048
    s_add_u32 m0, s32, 22528
    s_nop 0
    buffer_load_dwordx4 v96, s[44:47], s6 offen nt lds
    s_add_u32 s6, s33, 372736
    s_add_u32 m0, s32, 23552
    s_nop 0
    buffer_load_dwordx4 v96, s[44:47], s6 offen nt lds
    s_mov_b32 s11, 0
L_lw_st:
    ds_read_b32 v18, v22 offset:260
    s_add_u32 s11, s11, 1
    s_cmp_ge_u32 s11, 524288
    s_cbranch_scc1 L_lwx_st
    s_waitcnt lgkmcnt(0)
    v_readfirstlane_b32 s8, v18
    s_cmp_ge_u32 s8, 1
    s_cbranch_scc1 L_lwx_st
    s_sleep 1
    s_branch L_lw_st
L_lwx_st:
    s_waitcnt lgkmcnt(0)
    ds_read_b32 v18, v22 offset:284
    s_waitcnt lgkmcnt(0)
    v_readfirstlane_b32 s60, v18
    s_add_u32 s6, s33, 458752
    s_add_u32 m0, s32, 24576
    s_nop 0
    buffer_load_dwordx4 v96, s[44:47], s6 offen nt lds
    s_add_u32 s6, s33, 573440
    s_add_u32 m0, s32, 25600
    s_nop 0
    buffer_load_dwordx4 v96, s[44:47], s6 offen nt lds
    s_add_u32 s6, s33, 487424
    s_add_u32 m0, s32, 26624
    s_nop 0
    buffer_load_dwordx4 v96, s[44:47], s6 offen nt lds
    s_add_u32 s6, s33, 602112
    s_add_u32 m0, s32, 27648
    s_nop 0
    buffer_load_dwordx4 v96, s[44:47], s6 offen nt lds
    s_add_u32 s6, s33, 688128
    s_add_u32 m0, s32, 28672
    s_nop 0
    buffer_load_dwordx4 v96, s[44:47], s6 offen nt lds
    s_add_u32 s6, s33, 802816
    s_add_u32 m0, s32, 29696
    s_nop 0
    buffer_load_dwordx4 v96, s[44:47], s6 offen nt lds
    s_add_u32 s6, s33, 716800
    s_add_u32 m0, s32, 30720
    s_nop 0
    buffer_load_dwordx4 v96, s[44:47], s6 offen nt lds
    s_add_u32 s6, s33, 831488
    s_add_u32 m0, s32, 31744
    s_nop 0
    buffer_load_dwordx4 v96, s[44:47], s6 offen nt lds
    s_cmp_eq_u32 s62, 1
    s_cbranch_scc1 L_aux_one1
    s_add_u32 s6, s33, 0
    s_add_u32 m0, s32, 0
    s_nop 0
    buffer_load_dwordx4 v97, s[48:51], s6 offen nt lds
    s_add_u32 s6, s33, 114688
    s_add_u32 m0, s32, 1024
    s_nop 0
    buffer_load_dwordx4 v97, s[48:51], s6 offen nt lds
    s_add_u32 s6, s33, 28672
    s_add_u32 m0, s32, 2048
    s_nop 0
    buffer_load_dwordx4 v97, s[48:51], s6 offen nt lds
    s_add_u32 s6, s33, 143360
    s_add_u32 m0, s32, 3072
    s_nop 0
    buffer_load_dwordx4 v97, s[48:51], s6 offen nt lds
    s_add_u32 s6, s33, 229376
    s_add_u32 m0, s32, 4096
    s_nop 0
    buffer_load_dwordx4 v97, s[48:51], s6 offen nt lds
    s_add_u32 s6, s33, 344064
    s_add_u32 m0, s32, 5120
    s_nop 0
    buffer_load_dwordx4 v97, s[48:51], s6 offen nt lds
    s_add_u32 s6, s33, 258048
    s_add_u32 m0, s32, 6144
    s_nop 0
    buffer_load_dwordx4 v97, s[48:51], s6 offen nt lds
    s_add_u32 s6, s33, 372736
    s_add_u32 m0, s32, 7168
    s_nop 0
    buffer_load_dwordx4 v97, s[48:51], s6 offen nt lds
    s_add_u32 s6, s33, 458752
    s_add_u32 m0, s32, 8192
    s_nop 0
    buffer_load_dwordx4 v97, s[48:51], s6 offen nt lds
    s_add_u32 s6, s33, 573440
    s_add_u32 m0, s32, 9216
    s_nop 0
    buffer_load_dwordx4 v97, s[48:51], s6 offen nt lds
    s_add_u32 s6, s33, 487424
    s_add_u32 m0, s32, 10240
    s_nop 0
    buffer_load_dwordx4 v97, s[48:51], s6 offen nt lds
    s_add_u32 s6, s33, 602112
    s_add_u32 m0, s32, 11264
    s_nop 0
    buffer_load_dwordx4 v97, s[48:51], s6 offen nt lds
    s_add_u32 s6, s33, 688128
    s_add_u32 m0, s32, 12288
    s_nop 0
    buffer_load_dwordx4 v97, s[48:51], s6 offen nt lds
    s_add_u32 s6, s33, 802816
    s_add_u32 m0, s32, 13312
    s_nop 0
    buffer_load_dwordx4 v97, s[48:51], s6 offen nt lds
    s_add_u32 s6, s33, 716800
    s_add_u32 m0, s32, 14336
    s_nop 0
    buffer_load_dwordx4 v97, s[48:51], s6 offen nt lds
    s_add_u32 s6, s33, 831488
    s_add_u32 m0, s32, 15360
    s_nop 0
    buffer_load_dwordx4 v97, s[48:51], s6 offen nt lds
L_aux_one1:
    s_mov_b64 exec, 1
    ds_add_u32 v22, v23 offset:280
    s_mov_b64 exec, -1
    s_bfe_u32 s65, s60, 0x80000
    s_bfe_u32 s66, s60, 0x80008
    s_bfe_u32 s67, s60, 0x80010
    s_bfe_u32 s68, s60, 0x80018
    v_bfe_u32 v14, v1, 2, 3
    v_lshrrev_b32 v15, 1, v14
    v_lshlrev_b32 v14, 7, v14
    v_lshrrev_b32 v13, 5, v1
    v_lshl_add_u32 v14, v13, 10, v14
    v_and_b32 v13, 3, v1
    v_lshl_add_u32 v14, v13, 3, v14
    v_add_u32 v14, s32, v14
    v_xor_b32 v13, 0, v15
    v_lshl_add_u32 v24, v13, 5, v14
    v_xor_b32 v13, 1, v15
    v_lshl_add_u32 v25, v13, 5, v14
    v_xor_b32 v13, 2, v15
    v_lshl_add_u32 v26, v13, 5, v14
    v_xor_b32 v13, 3, v15
    v_lshl_add_u32 v27, v13, 5, v14
    v_min_u32 v20, 8, v2
    v_mul_u32_u24 v20, 1040, v20
    v_lshl_add_u32 v20, v3, 4, v20
    s_lshr_b32 s6, s32, 7
    s_add_u32 s6, s6, 131072
    v_add_u32 v20, s6, v20
    v_lshlrev_b32 v19, 6, v2
    v_lshl_add_u32 v19, v3, 4, v19
    s_lshr_b32 s6, s32, 11
    s_add_u32 s6, s6, s32
    s_add_u32 s6, s6, 24512
    v_add_u32 v19, s6, v19
    v_and_b32 v242, 7, v1
    v_lshl_add_u32 v243, v242, 2, v22
    v_bfe_u32 v241, v1, 3, 2
    v_mul_u32_u24 v241, 32784, v241
    v_lshrrev_b32 v240, 5, v1
    v_lshl_add_u32 v241, v240, 12, v241
    s_lshr_b32 s6, s32, 11
    s_add_u32 s6, s6, 24512
    v_add_u32 v241, s6, v241
    s_sub_u32 s6, s31, s30
    v_mul_i32_i24 v244, s6, v240
    v_lshl_add_u32 v244, v242, 4, v244
    v_bfe_u32 v240, v1, 4, 1
    v_lshl_add_u32 v244, v240, 9, v244
    v_bfe_u32 v240, v1, 3, 1
    v_lshl_add_u32 v244, v240, 10, v244
    s_lshr_b32 s6, s32, 8
    s_add_u32 s6, s6, s30
    s_add_u32 s6, s6, s64
    v_add_u32 v244, s6, v244
    v_lshl_add_u32 v242, v242, 6, v241
    v_mov_b32 v245, 0xffffff00
    v_cmp_eq_u32 s[70:71], 1, v240
    s_cmp_eq_u32 s62, 1
    s_cbranch_scc1 L_aux_one2
    s_waitcnt vmcnt(28)
    ds_read_b64_tr_b16 v[64:65], v24 offset:16384
    ds_read_b64_tr_b16 v[66:67], v24 offset:18432
    ds_read_b64_tr_b16 v[68:69], v25 offset:16384
    ds_read_b64_tr_b16 v[70:71], v25 offset:18432
    ds_read_b64_tr_b16 v[72:73], v26 offset:16384
    ds_read_b64_tr_b16 v[74:75], v26 offset:18432
    ds_read_b64_tr_b16 v[76:77], v27 offset:16384
    ds_read_b64_tr_b16 v[78:79], v27 offset:18432
    s_waitcnt vmcnt(24)
    ds_read_b64_tr_b16 v[96:97], v24 offset:20480
    ds_read_b64_tr_b16 v[98:99], v24 offset:22528
    ds_read_b64_tr_b16 v[100:101], v25 offset:20480
    ds_read_b64_tr_b16 v[102:103], v25 offset:22528
    ds_read_b64_tr_b16 v[104:105], v26 offset:20480
    ds_read_b64_tr_b16 v[106:107], v26 offset:22528
    ds_read_b64_tr_b16 v[108:109], v27 offset:20480
    ds_read_b64_tr_b16 v[110:111], v27 offset:22528
    s_waitcnt vmcnt(20)
    ds_read_b64_tr_b16 v[128:129], v24 offset:24576
    ds_read_b64_tr_b16 v[130:131], v24 offset:26624
    ds_read_b64_tr_b16 v[132:133], v25 offset:24576
    ds_read_b64_tr_b16 v[134:135], v25 offset:26624
    ds_read_b64_tr_b16 v[136:137], v26 offset:24576
    ds_read_b64_tr_b16 v[138:139], v26 offset:26624
    ds_read_b64_tr_b16 v[140:141], v27 offset:24576
    ds_read_b64_tr_b16 v[142:143], v27 offset:26624
    s_waitcnt vmcnt(16)
    ds_read_b64_tr_b16 v[160:161], v24 offset:28672
    ds_read_b64_tr_b16 v[162:163], v24 offset:30720
    ds_read_b64_tr_b16 v[164:165], v25 offset:28672
    ds_read_b64_tr_b16 v[166:167], v25 offset:30720
    ds_read_b64_tr_b16 v[168:169], v26 offset:28672
    ds_read_b64_tr_b16 v[170:171], v26 offset:30720
    ds_read_b64_tr_b16 v[172:173], v27 offset:28672
    ds_read_b64_tr_b16 v[174:175], v27 offset:30720
    s_waitcnt vmcnt(12)
    ds_read_b64_tr_b16 v[80:81], v24 offset:0
    ds_read_b64_tr_b16 v[82:83], v24 offset:2048
    ds_read_b64_tr_b16 v[84:85], v25 offset:0
    ds_read_b64_tr_b16 v[86:87], v25 offset:2048
    ds_read_b64_tr_b16 v[88:89], v26 offset:0
    ds_read_b64_tr_b16 v[90:91], v26 offset:2048
    ds_read_b64_tr_b16 v[92:93], v27 offset:0
    ds_read_b64_tr_b16 v[94:95], v27 offset:2048
    s_waitcnt vmcnt(8)
    ds_read_b64_tr_b16 v[112:113], v24 offset:4096
    ds_read_b64_tr_b16 v[114:115], v24 offset:6144
    ds_read_b64_tr_b16 v[116:117], v25 offset:4096
    ds_read_b64_tr_b16 v[118:119], v25 offset:6144
    ds_read_b64_tr_b16 v[120:121], v26 offset:4096
    ds_read_b64_tr_b16 v[122:123], v26 offset:6144
    ds_read_b64_tr_b16 v[124:125], v27 offset:4096
    ds_read_b64_tr_b16 v[126:127], v27 offset:6144
    s_waitcnt vmcnt(4)
    ds_read_b64_tr_b16 v[144:145], v24 offset:8192
    ds_read_b64_tr_b16 v[146:147], v24 offset:10240
    ds_read_b64_tr_b16 v[148:149], v25 offset:8192
    ds_read_b64_tr_b16 v[150:151], v25 offset:10240
    ds_read_b64_tr_b16 v[152:153], v26 offset:8192
    ds_read_b64_tr_b16 v[154:155], v26 offset:10240
    ds_read_b64_tr_b16 v[156:157], v27 offset:8192
    ds_read_b64_tr_b16 v[158:159], v27 offset:10240
    s_waitcnt vmcnt(0)
    ds_read_b64_tr_b16 v[176:177], v24 offset:12288
    ds_read_b64_tr_b16 v[178:179], v24 offset:14336
    ds_read_b64_tr_b16 v[180:181], v25 offset:12288
    ds_read_b64_tr_b16 v[182:183], v25 offset:14336
    ds_read_b64_tr_b16 v[184:185], v26 offset:12288
    ds_read_b64_tr_b16 v[186:187], v26 offset:14336
    ds_read_b64_tr_b16 v[188:189], v27 offset:12288
    ds_read_b64_tr_b16 v[190:191], v27 offset:14336
    s_branch L_aux_two2
L_aux_one2:
    s_waitcnt vmcnt(12)
    ds_read_b64_tr_b16 v[64:65], v24 offset:16384
    ds_read_b64_tr_b16 v[66:67], v24 offset:18432
    ds_read_b64_tr_b16 v[68:69], v25 offset:16384
    ds_read_b64_tr_b16 v[70:71], v25 offset:18432
    ds_read_b64_tr_b16 v[72:73], v26 offset:16384
    ds_read_b64_tr_b16 v[74:75], v26 offset:18432
    ds_read_b64_tr_b16 v[76:77], v27 offset:16384
    ds_read_b64_tr_b16 v[78:79], v27 offset:18432
    s_waitcnt vmcnt(8)
    ds_read_b64_tr_b16 v[96:97], v24 offset:20480
    ds_read_b64_tr_b16 v[98:99], v24 offset:22528
    ds_read_b64_tr_b16 v[100:101], v25 offset:20480
    ds_read_b64_tr_b16 v[102:103], v25 offset:22528
    ds_read_b64_tr_b16 v[104:105], v26 offset:20480
    ds_read_b64_tr_b16 v[106:107], v26 offset:22528
    ds_read_b64_tr_b16 v[108:109], v27 offset:20480
    ds_read_b64_tr_b16 v[110:111], v27 offset:22528
    s_waitcnt vmcnt(4)
    ds_read_b64_tr_b16 v[128:129], v24 offset:24576
    ds_read_b64_tr_b16 v[130:131], v24 offset:26624
    ds_read_b64_tr_b16 v[132:133], v25 offset:24576
    ds_read_b64_tr_b16 v[134:135], v25 offset:26624
    ds_read_b64_tr_b16 v[136:137], v26 offset:24576
    ds_read_b64_tr_b16 v[138:139], v26 offset:26624
    ds_read_b64_tr_b16 v[140:141], v27 offset:24576
    ds_read_b64_tr_b16 v[142:143], v27 offset:26624
    s_waitcnt vmcnt(0)
    ds_read_b64_tr_b16 v[160:161], v24 offset:28672
    ds_read_b64_tr_b16 v[162:163], v24 offset:30720
    ds_read_b64_tr_b16 v[164:165], v25 offset:28672
    ds_read_b64_tr_b16 v[166:167], v25 offset:30720
    ds_read_b64_tr_b16 v[168:169], v26 offset:28672
    ds_read_b64_tr_b16 v[170:171], v26 offset:30720
    ds_read_b64_tr_b16 v[172:173], v27 offset:28672
    ds_read_b64_tr_b16 v[174:175], v27 offset:30720
L_aux_two2:
    s_waitcnt lgkmcnt(0)
    s_mov_b64 exec, 1
    ds_add_u32 v22, v23 offset:268
    s_mov_b64 exec, -1
    s_mov_b32 s11, 0
L_lw_xs:
    ds_read_b32 v18, v22 offset:272
    s_add_u32 s11, s11, 1
    s_cmp_ge_u32 s11, 524288
    s_cbranch_scc1 L_lwx_xs
    s_waitcnt lgkmcnt(0)
    v_readfirstlane_b32 s8, v18
    s_cmp_ge_u32 s8, 2
    s_cbranch_scc1 L_lwx_xs
    s_branch L_lw_xs
L_lwx_xs:
    s_waitcnt lgkmcnt(0)
    ds_read_b32 v28, v243 offset:192
    ds_read_b128 v[32:35], v20 offset:0
    ds_read_b128 v[36:39], v20 offset:64
    ds_read_b128 v[40:43], v20 offset:128
    ds_read_b128 v[44:47], v20 offset:192
    s_waitcnt lgkmcnt(3)
    v_mfma_f32_16x16x32_bf16 v[192:195], v[64:67], v[32:35], 0
    s_waitcnt lgkmcnt(2)
    v_mfma_f32_16x16x32_bf16 v[192:195], v[96:99], v[36:39], v[192:195]
    s_waitcnt lgkmcnt(1)
    v_mfma_f32_16x16x32_bf16 v[192:195], v[128:131], v[40:43], v[192:195]
    s_waitcnt lgkmcnt(0)
    v_mfma_f32_16x16x32_bf16 v[192:195], v[160:163], v[44:47], v[192:195]
    v_mfma_f32_16x16x32_bf16 v[196:199], v[68:71], v[32:35], 0
    v_mfma_f32_16x16x32_bf16 v[196:199], v[100:103], v[36:39], v[196:199]
    v_mfma_f32_16x16x32_bf16 v[196:199], v[132:135], v[40:43], v[196:199]
    v_mfma_f32_16x16x32_bf16 v[196:199], v[164:167], v[44:47], v[196:199]
    v_mfma_f32_16x16x32_bf16 v[200:203], v[72:75], v[32:35], 0
    v_mfma_f32_16x16x32_bf16 v[200:203], v[104:107], v[36:39], v[200:203]
    v_mfma_f32_16x16x32_bf16 v[200:203], v[136:139], v[40:43], v[200:203]
    v_mfma_f32_16x16x32_bf16 v[200:203], v[168:171], v[44:47], v[200:203]
    ds_write_b128 v19, v[192:195] offset:0
    v_mfma_f32_16x16x32_bf16 v[204:207], v[76:79], v[32:35], 0
    v_mfma_f32_16x16x32_bf16 v[204:207], v[108:111], v[36:39], v[204:207]
    v_mfma_f32_16x16x32_bf16 v[204:207], v[140:143], v[40:43], v[204:207]
    v_mfma_f32_16x16x32_bf16 v[204:207], v[172:175], v[44:47], v[204:207]
    ds_write_b128 v19, v[196:199] offset:1024
    s_cmp_eq_u32 s62, 1
    s_cbranch_scc1 L_aux_one3
    v_mfma_f32_16x16x32_bf16 v[208:211], v[80:83], v[32:35], 0
    v_mfma_f32_16x16x32_bf16 v[208:211], v[112:115], v[36:39], v[208:211]
    v_mfma_f32_16x16x32_bf16 v[208:211], v[144:147], v[40:43], v[208:211]
    v_mfma_f32_16x16x32_bf16 v[208:211], v[176:179], v[44:47], v[208:211]
    ds_write_b128 v19, v[200:203] offset:2048
    v_mfma_f32_16x16x32_bf16 v[212:215], v[84:87], v[32:35], 0
    v_mfma_f32_16x16x32_bf16 v[212:215], v[116:119], v[36:39], v[212:215]
    v_mfma_f32_16x16x32_bf16 v[212:215], v[148:151], v[40:43], v[212:215]
    v_mfma_f32_16x16x32_bf16 v[212:215], v[180:183], v[44:47], v[212:215]
    ds_write_b128 v19, v[204:207] offset:3072
    v_mfma_f32_16x16x32_bf16 v[216:219], v[88:91], v[32:35], 0
    v_mfma_f32_16x16x32_bf16 v[216:219], v[120:123], v[36:39], v[216:219]
    v_mfma_f32_16x16x32_bf16 v[216:219], v[152:155], v[40:43], v[216:219]
    v_mfma_f32_16x16x32_bf16 v[216:219], v[184:187], v[44:47], v[216:219]
    ds_write_b128 v19, v[208:211] offset:4096
    v_mfma_f32_16x16x32_bf16 v[220:223], v[92:95], v[32:35], 0
    v_mfma_f32_16x16x32_bf16 v[220:223], v[124:127], v[36:39], v[220:223]
    v_mfma_f32_16x16x32_bf16 v[220:223], v[156:159], v[40:43], v[220:223]
    v_mfma_f32_16x16x32_bf16 v[220:223], v[188:191], v[44:47], v[220:223]
    ds_write_b128 v19, v[212:215] offset:5120
    s_nop 1
    ds_write_b128 v19, v[216:219] offset:6144
    s_nop 3
    ds_write_b128 v19, v[220:223] offset:7168
    s_branch L_aux_two3
L_aux_one3:
    s_nop 7
    ds_write_b128 v19, v[200:203] offset:2048
    ds_write_b128 v19, v[204:207] offset:3072
L_aux_two3:
    s_mov_b64 exec, 1
    ds_add_u32 v22, v23 offset:276
    s_mov_b64 exec, -1
    v_and_b32 v25, 0xffff0000, v28
    v_lshlrev_b32 v24, 16, v28
    v_rcp_f32 v25, v25
    s_mov_b32 s11, 0
L_lw_pp:
    ds_read_b32 v18, v22 offset:276
    s_add_u32 s11, s11, 1
    s_cmp_ge_u32 s11, 524288
    s_cbranch_scc1 L_lwx_pp
    s_waitcnt lgkmcnt(0)
    v_readfirstlane_b32 s8, v18
    s_cmp_ge_u32 s8, 4
    s_cbranch_scc1 L_lwx_pp
    s_branch L_lw_pp
L_lwx_pp:
    s_waitcnt lgkmcnt(0)
    ds_read_b128 v[64:67], v242 offset:0
    ds_read_b128 v[72:75], v241 offset:512
    ds_read_b128 v[68:71], v242 offset:2048
    ds_read_b128 v[76:79], v241 offset:2560
    ds_read_b128 v[80:83], v242 offset:1024
    ds_read_b128 v[88:91], v241 offset:1536
    ds_read_b128 v[84:87], v242 offset:3072
    ds_read_b128 v[92:95], v241 offset:3584
    s_cmp_eq_u32 s62, 1
    s_cselect_b32 s6, 0, -1
    s_waitcnt lgkmcnt(4)
    v_pk_fma_f32 v[64:65], v[72:73], v[24:25], v[64:65] op_sel:[0,0,0] op_sel_hi:[1,0,1] neg_lo:[1,0,0] neg_hi:[1,0,0]
    v_pk_fma_f32 v[66:67], v[74:75], v[24:25], v[66:67] op_sel:[0,0,0] op_sel_hi:[1,0,1] neg_lo:[1,0,0] neg_hi:[1,0,0]
    v_pk_fma_f32 v[68:69], v[76:77], v[24:25], v[68:69] op_sel:[0,0,0] op_sel_hi:[1,0,1] neg_lo:[1,0,0] neg_hi:[1,0,0]
    v_pk_fma_f32 v[70:71], v[78:79], v[24:25], v[70:71] op_sel:[0,0,0] op_sel_hi:[1,0,1] neg_lo:[1,0,0] neg_hi:[1,0,0]
    v_cndmask_b32 v72, v68, v64, s[70:71]
    v_cndmask_b32 v73, v69, v65, s[70:71]
    v_cndmask_b32 v74, v70, v66, s[70:71]
    v_cndmask_b32 v75, v71, v67, s[70:71]
    v_cndmask_b32 v64, v64, v68, s[70:71]
    v_cndmask_b32 v65, v65, v69, s[70:71]
    v_cndmask_b32 v66, v66, v70, s[70:71]
    v_cndmask_b32 v67, v67, v71, s[70:71]
    v_add_f32_dpp v64, v72, v64 row_ror:8 row_mask:0xf bank_mask:0xf
    v_add_f32_dpp v65, v73, v65 row_ror:8 row_mask:0xf bank_mask:0xf
    v_add_f32_dpp v66, v74, v66 row_ror:8 row_mask:0xf bank_mask:0xf
    v_add_f32_dpp v67, v75, v67 row_ror:8 row_mask:0xf bank_mask:0xf
    s_waitcnt lgkmcnt(0)
    v_pk_fma_f32 v[80:81], v[88:89], v[24:25], v[80:81] op_sel:[0,0,0] op_sel_hi:[1,0,1] neg_lo:[1,0,0] neg_hi:[1,0,0]
    v_pk_fma_f32 v[82:83], v[90:91], v[24:25], v[82:83] op_sel:[0,0,0] op_sel_hi:[1,0,1] neg_lo:[1,0,0] neg_hi:[1,0,0]
    v_pk_fma_f32 v[84:85], v[92:93], v[24:25], v[84:85] op_sel:[0,0,0] op_sel_hi:[1,0,1] neg_lo:[1,0,0] neg_hi:[1,0,0]
    v_pk_fma_f32 v[86:87], v[94:95], v[24:25], v[86:87] op_sel:[0,0,0] op_sel_hi:[1,0,1] neg_lo:[1,0,0] neg_hi:[1,0,0]
    v_cndmask_b32 v88, v84, v80, s[70:71]
    v_cndmask_b32 v89, v85, v81, s[70:71]
    v_cndmask_b32 v90, v86, v82, s[70:71]
    v_cndmask_b32 v91, v87, v83, s[70:71]
    v_cndmask_b32 v80, v80, v84, s[70:71]
    v_cndmask_b32 v81, v81, v85, s[70:71]
    v_cndmask_b32 v82, v82, v86, s[70:71]
    v_cndmask_b32 v83, v83, v87, s[70:71]
    v_add_f32_dpp v80, v88, v80 row_ror:8 row_mask:0xf bank_mask:0xf
    v_add_f32_dpp v81, v89, v81 row_ror:8 row_mask:0xf bank_mask:0xf
    v_add_f32_dpp v82, v90, v82 row_ror:8 row_mask:0xf bank_mask:0xf
    v_add_f32_dpp v83, v91, v83 row_ror:8 row_mask:0xf bank_mask:0xf
    v_permlane16_swap_b32 v64, v80
    v_permlane16_swap_b32 v65, v81
    v_permlane16_swap_b32 v66, v82
    v_permlane16_swap_b32 v67, v83
    v_pk_add_f32 v[64:65], v[64:65], v[80:81]
    v_pk_add_f32 v[66:67], v[66:67], v[82:83]
    v_pk_mul_f32 v[64:65], v[64:65], v[24:25] op_sel:[0,1] op_sel_hi:[1,1]
    v_pk_mul_f32 v[66:67], v[66:67], v[24:25] op_sel:[0,1] op_sel_hi:[1,1]
    v_and_or_b32 v64, v64, v245, s65
    v_and_or_b32 v65, v65, v245, s66
    v_and_or_b32 v66, v66, v245, s67
    v_and_or_b32 v67, v67, v245, s68
    s_mov_b32 exec_hi, s6
    buffer_store_dwordx4 v[64:67], v244, s[40:43], 0 offen sc1
    s_mov_b32 exec_hi, -1
    s_branch L_aux_b5
L_aux_idle:
    s_mov_b32 s11, 0
L_lw_id:
    ds_read_b32 v18, v22 offset:260
    s_add_u32 s11, s11, 1
    s_cmp_ge_u32 s11, 524288
    s_cbranch_scc1 L_lwx_id
    s_waitcnt lgkmcnt(0)
    v_readfirstlane_b32 s8, v18
    s_cmp_ge_u32 s8, 1
    s_cbranch_scc1 L_lwx_id
    s_sleep 1
    s_branch L_lw_id
L_lwx_id:
    s_waitcnt lgkmcnt(0)
    ds_read_b32 v18, v22 offset:284
    s_waitcnt lgkmcnt(0)
    v_readfirstlane_b32 s60, v18
    s_bfe_u32 s65, s60, 0x80000
    s_bfe_u32 s66, s60, 0x80008
    s_bfe_u32 s67, s60, 0x80010
    s_bfe_u32 s68, s60, 0x80018
    s_mov_b64 exec, 1
    ds_add_u32 v22, v23 offset:268
    s_mov_b64 exec, -1
    s_branch L_aux_b5
L_aux_b4:
L_aux_b5:
    v_bfe_u32 v11, v1, 1, 1
    v_bfe_u32 v10, v1, 2, 2
    v_lshl_add_u32 v10, v11, 2, v10
    v_lshl_add_u32 v10, v3, 3, v10
    v_bfe_u32 v11, v10, 1, 3
    v_xor_b32 v11, s56, v11
    v_lshlrev_b32 v10, 7, v10
    v_lshl_add_u32 v10, v11, 4, v10
    v_and_b32 v11, 1, v1
    v_lshl_add_u32 v10, v11, 3, v10
    v_add_u32 v11, 0x10000, v10
    v_lshl_add_u32 v14, v0, 4, s64
    v_lshlrev_b32 v15, 3, v1
    v_add_u32 v15, 131072, v15
    s_lshl_b32 s6, s56, 9
    v_add_u32 v16, s6, v15
    s_mov_b32 s21, 7168
    s_mov_b32 s22, 14336
    s_mov_b32 s23, 21504
    s_mov_b32 s24, 28672
    s_mov_b32 s25, 35840
    s_mov_b32 s26, 43008
    s_mov_b32 s27, 50176
    s_mov_b32 s18, 0xbfb8aa3b
    s_mov_b32 s16, 0
    v_mov_b32 v17, 0xff
    v_mov_b32 v245, 0xffffff00
    s_lshl_b32 s6, s63, 3
    s_add_u32 s6, s6, s56
    s_lshl_b32 s6, s6, 3
    s_add_u32 s6, s6, s57
    s_lshl_b32 s6, s6, 8
    s_add_u32 s6, s6, 491520
    v_lshlrev_b32 v12, 7, v3
    v_lshl_add_u32 v12, v2, 4, v12
    v_add_u32 v12, s6, v12
    s_barrier
    ds_read_b64_tr_b16 v[64:65], v10 offset:0
    ds_read_b64_tr_b16 v[66:67], v10 offset:4096
    ds_read_b64_tr_b16 v[68:69], v10 offset:8192
    ds_read_b64_tr_b16 v[70:71], v10 offset:12288
    ds_read_b64_tr_b16 v[72:73], v10 offset:32768
    ds_read_b64_tr_b16 v[74:75], v10 offset:36864
    ds_read_b64_tr_b16 v[76:77], v10 offset:40960
    ds_read_b64_tr_b16 v[78:79], v10 offset:45056
    ds_read_b64_tr_b16 v[80:81], v11 offset:0
    ds_read_b64_tr_b16 v[82:83], v11 offset:4096
    ds_read_b64_tr_b16 v[84:85], v11 offset:8192
    ds_read_b64_tr_b16 v[86:87], v11 offset:12288
    ds_read_b64_tr_b16 v[88:89], v11 offset:32768
    ds_read_b64_tr_b16 v[90:91], v11 offset:36864
    s_cmp_eq_u32 s56, 7
    s_cbranch_scc1 L_aux_nohp
    s_sleep 10
    buffer_load_dwordx4 v[128:131], v14, s[40:43], 0 offen sc1
    buffer_load_dwordx4 v[132:135], v14, s[40:43], s21 offen sc1
    buffer_load_dwordx4 v[136:139], v14, s[40:43], s22 offen sc1
    buffer_load_dwordx4 v[140:143], v14, s[40:43], s23 offen sc1
    buffer_load_dwordx4 v[144:147], v14, s[40:43], s24 offen sc1
    buffer_load_dwordx4 v[148:151], v14, s[40:43], s25 offen sc1
    buffer_load_dwordx4 v[152:155], v14, s[40:43], s26 offen sc1
    buffer_load_dwordx4 v[156:159], v14, s[40:43], s27 offen sc1
L_aux_gp:
    s_waitcnt vmcnt(0)
    v_bitop3_b32 v32, v128, v132, s65 bitop3:0x7e
    v_bitop3_b32 v36, v136, v140, s65 bitop3:0x7e
    v_bitop3_b32 v40, v144, v148, s65 bitop3:0x7e
    v_bitop3_b32 v44, v152, v156, s65 bitop3:0x7e
    v_bitop3_b32 v33, v129, v133, s66 bitop3:0x7e
    v_bitop3_b32 v37, v137, v141, s66 bitop3:0x7e
    v_bitop3_b32 v41, v145, v149, s66 bitop3:0x7e
    v_bitop3_b32 v45, v153, v157, s66 bitop3:0x7e
    v_bitop3_b32 v34, v130, v134, s67 bitop3:0x7e
    v_bitop3_b32 v38, v138, v142, s67 bitop3:0x7e
    v_bitop3_b32 v42, v146, v150, s67 bitop3:0x7e
    v_bitop3_b32 v46, v154, v158, s67 bitop3:0x7e
    v_bitop3_b32 v35, v131, v135, s68 bitop3:0x7e
    v_bitop3_b32 v39, v139, v143, s68 bitop3:0x7e
    v_bitop3_b32 v43, v147, v151, s68 bitop3:0x7e
    v_bitop3_b32 v47, v155, v159, s68 bitop3:0x7e
    v_or3_b32 v32, v32, v33, v34
    v_or3_b32 v36, v36, v37, v38
    v_or3_b32 v40, v40, v41, v42
    v_or3_b32 v44, v44, v45, v46
    v_bitop3_b32 v32, v32, v35, v17 bitop3:0xa8
    v_bitop3_b32 v36, v36, v39, v17 bitop3:0xa8
    v_bitop3_b32 v40, v40, v43, v17 bitop3:0xa8
    v_bitop3_b32 v44, v44, v47, v17 bitop3:0xa8
    v_cmp_ne_u32 s[6:7], 0, v32
    v_cmp_ne_u32 s[8:9], 0, v36
    v_cmp_ne_u32 s[10:11], 0, v40
    v_cmp_ne_u32 s[12:13], 0, v44
    s_or_b64 vcc, s[6:7], s[8:9]
    s_or_b64 s[14:15], s[10:11], s[12:13]
    s_or_b64 vcc, vcc, s[14:15]
    s_cbranch_scc0 L_aux_gok
    s_add_u32 s16, s16, 1
    s_cmp_ge_u32 s16, 65536
    s_cbranch_scc1 L_aux_gok
    s_sleep 2
    s_mov_b64 exec, s[6:7]
    s_cbranch_execz L_aux_gs0
    buffer_load_dwordx4 v[128:131], v14, s[40:43], 0 offen sc1
    buffer_load_dwordx4 v[132:135], v14, s[40:43], s21 offen sc1
L_aux_gs0:
    s_mov_b64 exec, s[8:9]
    s_cbranch_execz L_aux_gs1
    buffer_load_dwordx4 v[136:139], v14, s[40:43], s22 offen sc1
    buffer_load_dwordx4 v[140:143], v14, s[40:43], s23 offen sc1
L_aux_gs1:
    s_mov_b64 exec, s[10:11]
    s_cbranch_execz L_aux_gs2
    buffer_load_dwordx4 v[144:147], v14, s[40:43], s24 offen sc1
    buffer_load_dwordx4 v[148:151], v14, s[40:43], s25 offen sc1
L_aux_gs2:
    s_mov_b64 exec, s[12:13]
    s_cbranch_execz L_aux_gs3
    buffer_load_dwordx4 v[152:155], v14, s[40:43], s26 offen sc1
    buffer_load_dwordx4 v[156:159], v14, s[40:43], s27 offen sc1
L_aux_gs3:
    s_mov_b64 exec, -1
    s_branch L_aux_gp
L_aux_gok:
    v_pk_add_f32 v[128:129], v[128:129], v[144:145]
    v_pk_add_f32 v[130:131], v[130:131], v[146:147]
    v_pk_add_f32 v[132:133], v[132:133], v[148:149]
    v_pk_add_f32 v[134:135], v[134:135], v[150:151]
    v_pk_mul_f32 v[144:145], v[128:129], s[18:19] op_sel_hi:[1,0]
    v_pk_mul_f32 v[146:147], v[130:131], s[18:19] op_sel_hi:[1,0]
    v_pk_mul_f32 v[148:149], v[132:133], s[18:19] op_sel_hi:[1,0]
    v_pk_mul_f32 v[150:151], v[134:135], s[18:19] op_sel_hi:[1,0]
    v_exp_f32 v144, v144
    v_exp_f32 v145, v145
    v_exp_f32 v146, v146
    v_exp_f32 v147, v147
    v_pk_add_f32 v[136:137], v[136:137], v[152:153]
    v_pk_add_f32 v[138:139], v[138:139], v[154:155]
    v_exp_f32 v148, v148
    v_exp_f32 v149, v149
    v_exp_f32 v150, v150
    v_exp_f32 v151, v151
    v_pk_add_f32 v[140:141], v[140:141], v[156:157]
    v_pk_add_f32 v[142:143], v[142:143], v[158:159]
    v_pk_add_f32 v[144:145], v[144:145], 1.0 op_sel_hi:[1,0]
    v_pk_add_f32 v[146:147], v[146:147], 1.0 op_sel_hi:[1,0]
    v_pk_add_f32 v[148:149], v[148:149], 1.0 op_sel_hi:[1,0]
    v_pk_add_f32 v[150:151], v[150:151], 1.0 op_sel_hi:[1,0]
    v_rcp_f32 v144, v144
    v_rcp_f32 v145, v145
    v_rcp_f32 v146, v146
    v_rcp_f32 v147, v147
    v_pk_mul_f32 v[128:129], v[128:129], v[136:137]
    v_pk_mul_f32 v[130:131], v[130:131], v[138:139]
    v_rcp_f32 v148, v148
    v_rcp_f32 v149, v149
    v_rcp_f32 v150, v150
    v_rcp_f32 v151, v151
    v_pk_mul_f32 v[132:133], v[132:133], v[140:141]
    v_pk_mul_f32 v[134:135], v[134:135], v[142:143]
    v_pk_mul_f32 v[128:129], v[128:129], v[144:145]
    v_pk_mul_f32 v[130:131], v[130:131], v[146:147]
    v_cvt_pk_bf16_f32 v136, v128, v129
    v_cvt_pk_bf16_f32 v137, v130, v131
    ds_write_b64 v16, v[136:137] offset:0
    v_pk_mul_f32 v[132:133], v[132:133], v[148:149]
    v_pk_mul_f32 v[134:135], v[134:135], v[150:151]
    v_cvt_pk_bf16_f32 v140, v132, v133
    v_cvt_pk_bf16_f32 v141, v134, v135
    ds_write_b64 v16, v[140:141] offset:3584
L_aux_nohp:
    s_waitcnt lgkmcnt(0)
    s_barrier
    ds_read2st64_b64 v[96:99], v15 offset0:0 offset1:1
    ds_read2st64_b64 v[100:103], v15 offset0:2 offset1:3
    ds_read2st64_b64 v[104:107], v15 offset0:4 offset1:5
    ds_read2st64_b64 v[108:111], v15 offset0:6 offset1:7
    ds_read2st64_b64 v[112:115], v15 offset0:8 offset1:9
    ds_read2st64_b64 v[116:119], v15 offset0:10 offset1:11
    ds_read2st64_b64 v[120:123], v15 offset0:12 offset1:13
    s_waitcnt lgkmcnt(6)
    v_mfma_f32_16x16x32_bf16 v[32:35], v[64:67], v[96:99], 0
    s_waitcnt lgkmcnt(5)
    v_mfma_f32_16x16x32_bf16 v[32:35], v[68:71], v[100:103], v[32:35]
    s_waitcnt lgkmcnt(4)
    v_mfma_f32_16x16x32_bf16 v[32:35], v[72:75], v[104:107], v[32:35]
    s_waitcnt lgkmcnt(3)
    v_mfma_f32_16x16x32_bf16 v[32:35], v[76:79], v[108:111], v[32:35]
    s_waitcnt lgkmcnt(2)
    v_mfma_f32_16x16x32_bf16 v[32:35], v[80:83], v[112:115], v[32:35]
    s_waitcnt lgkmcnt(1)
    v_mfma_f32_16x16x32_bf16 v[32:35], v[84:87], v[116:119], v[32:35]
    s_waitcnt lgkmcnt(0)
    v_mfma_f32_16x16x32_bf16 v[32:35], v[88:91], v[120:123], v[32:35]
    s_nop 7
    v_mov_b32_dpp v36, v32 row_ror:8 row_mask:0xf bank_mask:0xf
    v_mov_b32_dpp v37, v33 row_ror:8 row_mask:0xf bank_mask:0xf
    v_mov_b32_dpp v38, v34 row_ror:8 row_mask:0xf bank_mask:0xf
    v_mov_b32_dpp v39, v35 row_ror:8 row_mask:0xf bank_mask:0xf
    v_permlane32_swap_b32 v36, v40
    v_permlane32_swap_b32 v37, v41
    v_permlane32_swap_b32 v38, v42
    v_permlane32_swap_b32 v39, v43
    v_pk_add_f32 v[32:33], v[32:33], v[40:41]
    v_pk_add_f32 v[34:35], v[34:35], v[42:43]
    v_and_or_b32 v32, v32, v245, s65
    v_and_or_b32 v33, v33, v245, s66
    v_and_or_b32 v34, v34, v245, s67
    v_and_or_b32 v35, v35, v245, s68
    s_mov_b64 exec, 0x00ff00ff
    buffer_store_dwordx4 v[32:35], v12, s[40:43], 0 offen sc1
    s_mov_b64 exec, -1
    s_lshl_b32 s6, s58, 3
    s_add_u32 s6, s6, s56
    s_cmp_lg_u32 s6, 632
    s_cbranch_scc1 L_aux_done
    v_lshlrev_b32 v21, 3, v1
    v_add_u32 v21, 2048, v21
    s_mov_b32 s11, 0
L_poll_ack:
    buffer_load_dwordx2 v[60:61], v21, s[40:43], 0 offen sc1
    s_waitcnt vmcnt(0)
    v_xor_b32 v14, s60, v60
    v_bitop3_b32 v14, v14, v61, s60 bitop3:0xf6
    v_cmp_ne_u32 vcc, 0, v14
    s_cbranch_vccz L_polled_ack
    s_add_u32 s11, s11, 1
    s_cmp_ge_u32 s11, 65536
    s_cbranch_scc1 L_polled_ack
    s_sleep 4
    s_branch L_poll_ack
L_polled_ack:
    v_mov_b32 v5, s60
    v_mov_b32 v4, 0
    s_mov_b64 exec, 1
    buffer_store_dword v5, v4, s[40:43], 0 offen sc1
L_aux_done:
    s_endpgm
L_aux_slow:
    s_waitcnt lgkmcnt(0)
    v_lshlrev_b32 v14, 5, v0
    v_add_u32 v14, 140432, v14
    ds_write_b128 v14, v[80:83]
    ds_write_b128 v14, v[84:87] offset:16
    s_mov_b64 exec, 1
    ds_add_u32 v22, v23 offset:256
    s_mov_b64 exec, -1
    s_cmp_ge_u32 s56, 2
    s_cbranch_scc1 L_aux_wd
    s_cmp_eq_u32 s56, 1
    s_cbranch_scc1 L_aux_nox
    s_mov_b32 s11, 0
L_lw_slow:
    ds_read_b32 v18, v22 offset:256
    s_add_u32 s11, s11, 1
    s_cmp_ge_u32 s11, 524288
    s_cbranch_scc1 L_lwx_slow
    s_waitcnt lgkmcnt(0)
    v_readfirstlane_b32 s8, v18
    s_cmp_ge_u32 s8, 4
    s_cbranch_scc1 L_lwx_slow
    s_branch L_lw_slow
L_lwx_slow:
    s_waitcnt lgkmcnt(0)
    v_lshlrev_b32 v14, 4, v1
    v_add_u32 v14, 140432, v14
    ds_read_b128 v[128:131], v14 offset:0
    ds_read_b128 v[132:135], v14 offset:1024
    ds_read_b128 v[136:139], v14 offset:2048
    ds_read_b128 v[140:143], v14 offset:3072
    ds_read_b128 v[144:147], v14 offset:4096
    ds_read_b128 v[148:151], v14 offset:5120
    ds_read_b128 v[152:155], v14 offset:6144
    ds_read_b128 v[156:159], v14 offset:7168
    s_waitcnt lgkmcnt(0)
    s_mov_b32 s8, 0
    v_mov_b32 v20, v1
    v_mov_b32 v17, 1
L_aux_slow2:
    v_max3_u32 v14, v128, v129, v130
    v_max3_u32 v14, v14, v131, v132
    v_max3_u32 v14, v14, v133, v134
    v_max3_u32 v14, v14, v135, v136
    v_max3_u32 v14, v14, v137, v138
    v_max3_u32 v14, v14, v139, v140
    v_max3_u32 v14, v14, v141, v142
    v_max3_u32 v14, v14, v143, v144
    v_max3_u32 v14, v14, v145, v146
    v_max3_u32 v14, v14, v147, v148
    v_max3_u32 v14, v14, v149, v150
    v_max3_u32 v14, v14, v151, v152
    v_max3_u32 v14, v14, v153, v154
    v_max3_u32 v14, v14, v155, v156
    v_max3_u32 v14, v14, v157, v158
    v_max_u32 v14, v14, v159
    s_nop 1
    v_max_u32_dpp v14, v14, v14 row_ror:8 row_mask:0xf bank_mask:0xf
    s_nop 1
    v_max_u32_dpp v14, v14, v14 row_ror:4 row_mask:0xf bank_mask:0xf
    s_nop 1
    v_max_u32_dpp v14, v14, v14 row_ror:2 row_mask:0xf bank_mask:0xf
    s_nop 1
    v_max_u32_dpp v14, v14, v14 row_ror:1 row_mask:0xf bank_mask:0xf
    v_mov_b32 v15, v14
    s_nop 1
    v_permlane16_swap_b32 v14, v15
    v_max_u32 v14, v14, v15
    v_mov_b32 v15, v14
    s_nop 1
    v_permlane32_swap_b32 v14, v15
    v_max_u32 v14, v14, v15
    v_cmp_eq_u32 vcc, s8, v20
    s_nop 1
    v_cndmask_b32 v17, v17, v14, vcc
    v_cmp_ne_u32 vcc, v14, v128
    s_nop 1
    v_cndmask_b32 v128, 0, v128, vcc
    v_cmp_ne_u32 vcc, v14, v129
    s_nop 1
    v_cndmask_b32 v129, 0, v129, vcc
    v_cmp_ne_u32 vcc, v14, v130
    s_nop 1
    v_cndmask_b32 v130, 0, v130, vcc
    v_cmp_ne_u32 vcc, v14, v131
    s_nop 1
    v_cndmask_b32 v131, 0, v131, vcc
    v_cmp_ne_u32 vcc, v14, v132
    s_nop 1
    v_cndmask_b32 v132, 0, v132, vcc
    v_cmp_ne_u32 vcc, v14, v133
    s_nop 1
    v_cndmask_b32 v133, 0, v133, vcc
    v_cmp_ne_u32 vcc, v14, v134
    s_nop 1
    v_cndmask_b32 v134, 0, v134, vcc
    v_cmp_ne_u32 vcc, v14, v135
    s_nop 1
    v_cndmask_b32 v135, 0, v135, vcc
    v_cmp_ne_u32 vcc, v14, v136
    s_nop 1
    v_cndmask_b32 v136, 0, v136, vcc
    v_cmp_ne_u32 vcc, v14, v137
    s_nop 1
    v_cndmask_b32 v137, 0, v137, vcc
    v_cmp_ne_u32 vcc, v14, v138
    s_nop 1
    v_cndmask_b32 v138, 0, v138, vcc
    v_cmp_ne_u32 vcc, v14, v139
    s_nop 1
    v_cndmask_b32 v139, 0, v139, vcc
    v_cmp_ne_u32 vcc, v14, v140
    s_nop 1
    v_cndmask_b32 v140, 0, v140, vcc
    v_cmp_ne_u32 vcc, v14, v141
    s_nop 1
    v_cndmask_b32 v141, 0, v141, vcc
    v_cmp_ne_u32 vcc, v14, v142
    s_nop 1
    v_cndmask_b32 v142, 0, v142, vcc
    v_cmp_ne_u32 vcc, v14, v143
    s_nop 1
    v_cndmask_b32 v143, 0, v143, vcc
    v_cmp_ne_u32 vcc, v14, v144
    s_nop 1
    v_cndmask_b32 v144, 0, v144, vcc
    v_cmp_ne_u32 vcc, v14, v145
    s_nop 1
    v_cndmask_b32 v145, 0, v145, vcc
    v_cmp_ne_u32 vcc, v14, v146
    s_nop 1
    v_cndmask_b32 v146, 0, v146, vcc
    v_cmp_ne_u32 vcc, v14, v147
    s_nop 1
    v_cndmask_b32 v147, 0, v147, vcc
    v_cmp_ne_u32 vcc, v14, v148
    s_nop 1
    v_cndmask_b32 v148, 0, v148, vcc
    v_cmp_ne_u32 vcc, v14, v149
    s_nop 1
    v_cndmask_b32 v149, 0, v149, vcc
    v_cmp_ne_u32 vcc, v14, v150
    s_nop 1
    v_cndmask_b32 v150, 0, v150, vcc
    v_cmp_ne_u32 vcc, v14, v151
    s_nop 1
    v_cndmask_b32 v151, 0, v151, vcc
    v_cmp_ne_u32 vcc, v14, v152
    s_nop 1
    v_cndmask_b32 v152, 0, v152, vcc
    v_cmp_ne_u32 vcc, v14, v153
    s_nop 1
    v_cndmask_b32 v153, 0, v153, vcc
    v_cmp_ne_u32 vcc, v14, v154
    s_nop 1
    v_cndmask_b32 v154, 0, v154, vcc
    v_cmp_ne_u32 vcc, v14, v155
    s_nop 1
    v_cndmask_b32 v155, 0, v155, vcc
    v_cmp_ne_u32 vcc, v14, v156
    s_nop 1
    v_cndmask_b32 v156, 0, v156, vcc
    v_cmp_ne_u32 vcc, v14, v157
    s_nop 1
    v_cndmask_b32 v157, 0, v157, vcc
    v_cmp_ne_u32 vcc, v14, v158
    s_nop 1
    v_cndmask_b32 v158, 0, v158, vcc
    v_cmp_ne_u32 vcc, v14, v159
    s_nop 1
    v_cndmask_b32 v159, 0, v159, vcc
    s_add_u32 s8, s8, 1
    s_cmp_lt_u32 s8, 8
    s_cbranch_scc1 L_aux_slow2
    v_and_b32 v60, 0xfff, v17
    v_sub_u32 v60, 0x800, v60
    v_lshlrev_b32 v15, 2, v60
    ds_read_b32 v62, v15
    v_and_b32 v14, 0xffff0000, v17
    v_ashrrev_i32 v15, 31, v14
    v_not_b32 v15, v15
    v_or_b32 v15, 0x80000000, v15
    v_xor_b32 v14, v14, v15
    v_and_b32 v14, 0xffff0000, v14
    v_mul_f32 v14, 0xbfb8aa3b, v14
    v_exp_f32 v14, v14
    v_mov_b32 v63, s60
    v_add_f32 v14, 1.0, v14
    v_rcp_f32 v14, v14
    s_branch L_aux_sel
L_exit:
    s_endpgm
.p2align 6
L_conv:
    v_and_b32 v2, 15, v0
    v_bfe_u32 v3, v0, 4, 2
    s_getpc_b64 s[36:37]
L_pc_band:
    s_add_u32 s36, s36, L_bands-L_pc_band
    s_addc_u32 s37, s37, 0
    s_mov_b32 s38, 5120
    s_mov_b32 s39, 0x00020000
    v_lshlrev_b32 v10, 4, v1
    s_mov_b32 s53, 4096
    buffer_load_dwordx4 v[128:131], v10, s[36:39], 0 offen offset:0
    buffer_load_dwordx4 v[132:135], v10, s[36:39], 0 offen offset:1024
    buffer_load_dwordx4 v[136:139], v10, s[36:39], 0 offen offset:2048
    buffer_load_dwordx4 v[140:143], v10, s[36:39], 0 offen offset:3072
    buffer_load_dwordx4 v[124:127], v10, s[36:39], s53 offen
    s_mov_b64 s[36:37], s[4:5]
    s_mov_b32 s38, 4194304
    s_mov_b32 s39, 0x00020000
    s_mov_b64 s[40:41], s[34:35]
    s_mov_b32 s42, 753664
    s_mov_b32 s43, 0x00020000
    s_mov_b64 s[44:45], s[30:31]
    s_mov_b32 s46, 4194304
    s_mov_b32 s47, 0x00020000
    s_mov_b32 s48, 0x3fb8aa3b
    s_mov_b32 s49, 0x32a57060
    s_lshl_b32 s58, s57, 4
    s_cmp_lt_u32 s56, 4
    s_cbranch_scc1 L_conv_p
    s_setprio 1
L_conv_p:
    v_lshlrev_b32 v9, 13, v0
    v_add_u32 v9, s58, v9
    s_lshl_b32 s6, s3, 7
    s_lshl_b32 s7, s56, 4
    s_add_u32 s6, s6, s7
    s_lshl_b32 s6, s6, 11
    s_lshl_b32 s7, s59, 8
    s_add_u32 s6, s6, s7
    v_lshrrev_b32 v11, 1, v1
    v_lshlrev_b32 v11, 11, v11
    v_and_b32 v10, 1, v1
    v_lshl_add_u32 v11, v10, 7, v11
    v_add_u32 v11, s6, v11
    s_mul_i32 s6, s56, 3072
    s_add_u32 s6, s6, 67584
    s_mul_i32 s7, s56, 4608
    s_add_u32 s7, s7, 92160
    v_mov_b32 v64, 0
    v_mov_b32 v65, 0
    v_mov_b32 v66, 0
    v_mov_b32 v67, 0
    v_lshl_add_u32 v10, v1, 4, s6
    ds_write_b128 v10, v[64:67] offset:0
    ds_write_b128 v10, v[64:67] offset:1024
    ds_write_b128 v10, v[64:67] offset:2048
    v_lshl_add_u32 v10, v1, 3, s7
    ds_write_b64 v10, v[64:65]
    v_lshlrev_b32 v10, 5, v2
    v_lshl_add_u32 v160, v3, 9, v10
    v_add_u32 v160, s6, v160
    v_add_u32 v160, 1084, v160
    v_and_b32 v12, 1, v3
    v_lshl_add_u32 v161, v12, 4, v10
    v_lshrrev_b32 v12, 1, v3
    v_lshl_add_u32 v161, v12, 9, v161
    v_add3_u32 v161, v161, s6, 64
    v_and_b32 v12, 1, v2
    v_lshrrev_b32 v13, 1, v2
    v_lshlrev_b32 v162, 2, v13
    v_lshl_add_u32 v162, v3, 6, v162
    v_mul_u32_u24 v13, 260, v12
    v_add3_u32 v162, v162, v13, s6
    v_add_u32 v162, 2172, v162
    v_lshlrev_b32 v163, 1, v2
    v_lshl_add_u32 v163, v3, 7, v163
    v_lshl_add_u32 v163, v12, 2, v163
    v_add_u32 v163, s6, v163
    v_add_u32 v163, 2812, v163
    v_mov_b32 v164, v163
    s_add_u32 s54, s6, 2428
    v_writelane_b32 v164, s54, 0
    v_lshl_add_u32 v10, v2, 2, s6
    v_lshlrev_b32 v12, 5, v3
    v_sub_u32 v165, v10, v12
    v_add_u32 v165, 104, v165
    v_add_u32 v166, 1024, v165
    v_add_u32 v167, 2048, v165
    v_lshlrev_b32 v12, 4, v3
    v_sub_u32 v168, v10, v12
    v_add_u32 v168, 2292, v168
    v_mov_b32 v169, 0
    v_writelane_b32 v169, -1, 0
    s_mov_b32 s62, 0
    s_mov_b32 s63, 1
    s_mul_i32 s8, s56, 8448
    s_mov_b32 m0, s8
    v_bfe_u32 v10, v0, 2, 2
    v_mul_u32_u24 v10, 4160, v10
    v_lshrrev_b32 v12, 4, v0
    v_lshl_add_u32 v10, v12, 5, v10
    v_and_b32 v12, 3, v0
    v_lshl_add_u32 v10, v12, 3, v10
    v_add_u32 v4, 129024, v10
    v_lshlrev_b32 v10, 11, v0
    v_add_u32 v174, s58, v10
    v_lshlrev_b32 v10, 3, v0
    v_add_u32 v220, 92672, v10
    v_add_u32 v222, 129024, v10
    v_and_b32 v12, 1, v0
    v_lshlrev_b32 v12, 13, v12
    v_lshrrev_b32 v13, 1, v0
    v_lshl_add_u32 v12, v13, 4, v12
    v_add_u32 v221, 4096, v12
    v_lshrrev_b32 v10, 3, v1
    v_lshlrev_b32 v10, 4, v10
    v_add_u32 v223, 24576, v10
    s_mov_b32 s53, 4096
    s_mov_b32 s50, 0x100000
    s_mov_b32 s51, 0x200000
    s_mov_b32 s64, 0x05040100
    s_mov_b32 s65, 0x07060302
    v_lshl_add_u32 v5, v1, 3, s8
    v_mul_u32_u24 v6, 528, v2
    v_and_b32 v10, 1, v3
    v_lshl_add_u32 v6, v10, 8, v6
    v_lshrrev_b32 v10, 1, v3
    v_lshl_add_u32 v6, v10, 4, v6
    v_add_u32 v6, s8, v6
    v_lshlrev_b32 v10, 5, v2
    v_lshl_add_u32 v7, v3, 4, v10
    v_add3_u32 v7, v7, s7, 32
    s_mul_i32 s8, s56, 4160
    s_add_u32 s8, s8, 129024
    v_lshl_add_u32 v8, v3, 3, v10
    v_add_u32 v8, s8, v8
    s_waitcnt vmcnt(6)
L_conv_kg:
    s_mov_b32 exec_hi, 0
    buffer_load_dword v170, v11, s[36:39], 0 offen
    s_mov_b32 exec_hi, -1
    v_lshlrev_b32 v15, 16, v15
    v_lshlrev_b32 v116, 16, v16
    v_and_b32 v117, 0xffff0000, v16
    v_mul_f32 v112, s48, v15
    v_mul_f32 v114, s48, v116
    v_mul_f32 v118, s48, v117
    v_fma_f32 v113, v15, s48, -v112
    v_fma_f32 v115, v116, s48, -v114
    v_fma_f32 v119, v117, s48, -v118
    v_fma_f32 v113, v15, s49, v113
    v_fma_f32 v115, v116, s49, v115
    v_fma_f32 v119, v117, s49, v119
    v_exp_f32 v76, v112
    v_exp_f32 v72, v114
    v_exp_f32 v73, v118
    v_mul_f32 v113, 0x3f317218, v113
    v_mul_f32 v115, 0x3f317218, v115
    v_mul_f32 v119, 0x3f317218, v119
    v_fma_f32 v76, v76, v113, v76
    v_fma_f32 v72, v72, v115, v72
    v_fma_f32 v73, v73, v119, v73
    v_lshlrev_b32 v74, 16, v17
    v_and_b32 v75, 0xffff0000, v17
    v_cvt_pk_bf16_f32 v76, v76, v76
    v_cvt_pk_bf16_f32 v64, v72, v73
    v_and_b32 v76, 0xffff0000, v76
    v_lshlrev_b32 v72, 16, v64
    v_and_b32 v73, 0xffff0000, v64
    v_pk_mul_f32 v[74:75], v[74:75], v[76:77] op_sel_hi:[1,0]
    v_pk_mul_f32 v[72:73], v[72:73], v[76:77] op_sel_hi:[1,0]
    v_mul_f32 v74, 0.15915494, v74
    v_mul_f32 v72, 0xbfb8aa3b, v72
    v_mul_f32 v75, 0.15915494, v75
    v_mul_f32 v73, 0xbfb8aa3b, v73
    v_mul_f32 v112, 0x41000000, v72
    v_mul_f32 v113, 0x41000000, v74
    v_mul_f32 v114, 0x41000000, v73
    v_mul_f32 v115, 0x41000000, v75
    v_exp_f32 v112, v112
    v_fract_f32 v113, v113
    v_exp_f32 v114, v114
    v_fract_f32 v115, v115
    v_cos_f32 v24, v113
    v_sin_f32 v25, v113
    v_cos_f32 v26, v115
    v_sin_f32 v27, v115
    v_pk_mul_f32 v[24:25], v[24:25], v[112:113] op_sel:[0,0] op_sel_hi:[1,0] neg_hi:[1,0]
    v_pk_mul_f32 v[26:27], v[26:27], v[114:115] op_sel:[0,0] op_sel_hi:[1,0] neg_hi:[1,0]
    v_lshlrev_b32 v120, 16, v14
    v_mov_b32 v68, 0x3f80
    v_mov_b32 v69, 0x3f80
    ds_write_addtid_b32 v68 offset:0
    ds_write_addtid_b32 v69 offset:256
    v_cvt_pk_bf16_f32 v70, v24, v25
    v_cvt_pk_bf16_f32 v71, v26, v27
    ds_write_addtid_b32 v70 offset:528
    ds_write_addtid_b32 v71 offset:784
    v_pk_mul_f32 v[64:65], v[24:25], v[24:25] op_sel:[1,1] op_sel_hi:[1,0] neg_lo:[1,0]
    v_pk_mul_f32 v[66:67], v[26:27], v[26:27] op_sel:[1,1] op_sel_hi:[1,0] neg_lo:[1,0]
    v_pk_fma_f32 v[12:13], v[24:25], v[24:25], v[64:65] op_sel:[0,0,0] op_sel_hi:[0,1,1]
    v_pk_fma_f32 v[14:15], v[26:27], v[26:27], v[66:67] op_sel:[0,0,0] op_sel_hi:[0,1,1]
    v_cvt_pk_bf16_f32 v68, v12, v13
    v_cvt_pk_bf16_f32 v69, v14, v15
    ds_write_addtid_b32 v68 offset:1056
    ds_write_addtid_b32 v69 offset:1312
    v_pk_mul_f32 v[64:65], v[12:13], v[24:25] op_sel:[1,1] op_sel_hi:[1,0] neg_lo:[1,0]
    v_pk_mul_f32 v[66:67], v[14:15], v[26:27] op_sel:[1,1] op_sel_hi:[1,0] neg_lo:[1,0]
    v_pk_fma_f32 v[12:13], v[12:13], v[24:25], v[64:65] op_sel:[0,0,0] op_sel_hi:[0,1,1]
    v_pk_fma_f32 v[14:15], v[14:15], v[26:27], v[66:67] op_sel:[0,0,0] op_sel_hi:[0,1,1]
    v_cvt_pk_bf16_f32 v70, v12, v13
    v_cvt_pk_bf16_f32 v71, v14, v15
    ds_write_addtid_b32 v70 offset:1584
    ds_write_addtid_b32 v71 offset:1840
    v_add_f32 v77, v76, v76
    v_add_f32 v120, 1.0, v120
    v_lshlrev_b32 v32, 16, v18
    v_pk_mul_f32 v[64:65], v[12:13], v[24:25] op_sel:[1,1] op_sel_hi:[1,0] neg_lo:[1,0]
    v_pk_mul_f32 v[66:67], v[14:15], v[26:27] op_sel:[1,1] op_sel_hi:[1,0] neg_lo:[1,0]
    v_pk_fma_f32 v[12:13], v[12:13], v[24:25], v[64:65] op_sel:[0,0,0] op_sel_hi:[0,1,1]
    v_pk_fma_f32 v[14:15], v[14:15], v[26:27], v[66:67] op_sel:[0,0,0] op_sel_hi:[0,1,1]
    v_cvt_pk_bf16_f32 v68, v12, v13
    v_cvt_pk_bf16_f32 v69, v14, v15
    ds_write_addtid_b32 v68 offset:2112
    ds_write_addtid_b32 v69 offset:2368
    v_lshlrev_b32 v33, 16, v19
    v_and_b32 v34, 0xffff0000, v18
    v_and_b32 v35, 0xffff0000, v19
    v_pk_mul_f32 v[64:65], v[12:13], v[24:25] op_sel:[1,1] op_sel_hi:[1,0] neg_lo:[1,0]
    v_pk_mul_f32 v[66:67], v[14:15], v[26:27] op_sel:[1,1] op_sel_hi:[1,0] neg_lo:[1,0]
    v_pk_fma_f32 v[12:13], v[12:13], v[24:25], v[64:65] op_sel:[0,0,0] op_sel_hi:[0,1,1]
    v_pk_fma_f32 v[14:15], v[14:15], v[26:27], v[66:67] op_sel:[0,0,0] op_sel_hi:[0,1,1]
    v_cvt_pk_bf16_f32 v70, v12, v13
    v_cvt_pk_bf16_f32 v71, v14, v15
    ds_write_addtid_b32 v70 offset:2640
    ds_write_addtid_b32 v71 offset:2896
    v_and_b32 v169, v169, v120
    v_pk_mul_f32 v[32:33], v[32:33], v[76:77] op_sel:[0,1] op_sel_hi:[1,1]
    v_pk_mul_f32 v[34:35], v[34:35], v[76:77] op_sel:[0,1] op_sel_hi:[1,1]
    v_pk_mul_f32 v[64:65], v[12:13], v[24:25] op_sel:[1,1] op_sel_hi:[1,0] neg_lo:[1,0]
    v_pk_mul_f32 v[66:67], v[14:15], v[26:27] op_sel:[1,1] op_sel_hi:[1,0] neg_lo:[1,0]
    v_pk_fma_f32 v[12:13], v[12:13], v[24:25], v[64:65] op_sel:[0,0,0] op_sel_hi:[0,1,1]
    v_pk_fma_f32 v[14:15], v[14:15], v[26:27], v[66:67] op_sel:[0,0,0] op_sel_hi:[0,1,1]
    v_cvt_pk_bf16_f32 v68, v12, v13
    v_cvt_pk_bf16_f32 v69, v14, v15
    ds_write_addtid_b32 v68 offset:3168
    ds_write_addtid_b32 v69 offset:3424
    v_exp_f32 v112, v72
    v_fract_f32 v113, v74
    v_exp_f32 v114, v73
    v_pk_mul_f32 v[64:65], v[12:13], v[24:25] op_sel:[1,1] op_sel_hi:[1,0] neg_lo:[1,0]
    v_pk_mul_f32 v[66:67], v[14:15], v[26:27] op_sel:[1,1] op_sel_hi:[1,0] neg_lo:[1,0]
    v_pk_fma_f32 v[12:13], v[12:13], v[24:25], v[64:65] op_sel:[0,0,0] op_sel_hi:[0,1,1]
    v_pk_fma_f32 v[14:15], v[14:15], v[26:27], v[66:67] op_sel:[0,0,0] op_sel_hi:[0,1,1]
    v_cvt_pk_bf16_f32 v70, v12, v13
    v_cvt_pk_bf16_f32 v71, v14, v15
    ds_write_addtid_b32 v70 offset:3696
    ds_write_addtid_b32 v71 offset:3952
    v_fract_f32 v115, v75
    v_cos_f32 v20, v113
    v_sin_f32 v21, v113
    v_pk_mul_f32 v[64:65], v[12:13], v[24:25] op_sel:[1,1] op_sel_hi:[1,0] neg_lo:[1,0]
    v_pk_mul_f32 v[66:67], v[14:15], v[26:27] op_sel:[1,1] op_sel_hi:[1,0] neg_lo:[1,0]
    v_pk_fma_f32 v[12:13], v[12:13], v[24:25], v[64:65] op_sel:[0,0,0] op_sel_hi:[0,1,1]
    v_pk_fma_f32 v[14:15], v[14:15], v[26:27], v[66:67] op_sel:[0,0,0] op_sel_hi:[0,1,1]
    v_cvt_pk_bf16_f32 v68, v12, v13
    v_cvt_pk_bf16_f32 v69, v14, v15
    ds_write_addtid_b32 v68 offset:4224
    ds_write_addtid_b32 v69 offset:4480
    v_cos_f32 v22, v115
    v_sin_f32 v23, v115
    v_pk_mul_f32 v[20:21], v[20:21], v[112:113] op_sel:[0,0] op_sel_hi:[1,0]
    v_pk_mul_f32 v[64:65], v[12:13], v[24:25] op_sel:[1,1] op_sel_hi:[1,0] neg_lo:[1,0]
    v_pk_mul_f32 v[66:67], v[14:15], v[26:27] op_sel:[1,1] op_sel_hi:[1,0] neg_lo:[1,0]
    v_pk_fma_f32 v[12:13], v[12:13], v[24:25], v[64:65] op_sel:[0,0,0] op_sel_hi:[0,1,1]
    v_pk_fma_f32 v[14:15], v[14:15], v[26:27], v[66:67] op_sel:[0,0,0] op_sel_hi:[0,1,1]
    v_cvt_pk_bf16_f32 v70, v12, v13
    v_cvt_pk_bf16_f32 v71, v14, v15
    ds_write_addtid_b32 v70 offset:4752
    ds_write_addtid_b32 v71 offset:5008
    v_pk_mul_f32 v[22:23], v[22:23], v[114:115] op_sel:[0,0] op_sel_hi:[1,0]
    v_mul_f32 v112, 0x43000000, v72
    v_mul_f32 v113, 0x43000000, v74
    v_pk_mul_f32 v[64:65], v[12:13], v[24:25] op_sel:[1,1] op_sel_hi:[1,0] neg_lo:[1,0]
    v_pk_mul_f32 v[66:67], v[14:15], v[26:27] op_sel:[1,1] op_sel_hi:[1,0] neg_lo:[1,0]
    v_pk_fma_f32 v[12:13], v[12:13], v[24:25], v[64:65] op_sel:[0,0,0] op_sel_hi:[0,1,1]
    v_pk_fma_f32 v[14:15], v[14:15], v[26:27], v[66:67] op_sel:[0,0,0] op_sel_hi:[0,1,1]
    v_cvt_pk_bf16_f32 v68, v12, v13
    v_cvt_pk_bf16_f32 v69, v14, v15
    ds_write_addtid_b32 v68 offset:5280
    ds_write_addtid_b32 v69 offset:5536
    v_mul_f32 v114, 0x43000000, v73
    v_mul_f32 v115, 0x43000000, v75
    v_exp_f32 v112, v112
    v_pk_mul_f32 v[64:65], v[12:13], v[24:25] op_sel:[1,1] op_sel_hi:[1,0] neg_lo:[1,0]
    v_pk_mul_f32 v[66:67], v[14:15], v[26:27] op_sel:[1,1] op_sel_hi:[1,0] neg_lo:[1,0]
    v_pk_fma_f32 v[12:13], v[12:13], v[24:25], v[64:65] op_sel:[0,0,0] op_sel_hi:[0,1,1]
    v_pk_fma_f32 v[14:15], v[14:15], v[26:27], v[66:67] op_sel:[0,0,0] op_sel_hi:[0,1,1]
    v_cvt_pk_bf16_f32 v70, v12, v13
    v_cvt_pk_bf16_f32 v71, v14, v15
    ds_write_addtid_b32 v70 offset:5808
    ds_write_addtid_b32 v71 offset:6064
    v_fract_f32 v113, v113
    v_exp_f32 v114, v114
    v_fract_f32 v115, v115
    v_pk_mul_f32 v[64:65], v[12:13], v[24:25] op_sel:[1,1] op_sel_hi:[1,0] neg_lo:[1,0]
    v_pk_mul_f32 v[66:67], v[14:15], v[26:27] op_sel:[1,1] op_sel_hi:[1,0] neg_lo:[1,0]
    v_pk_fma_f32 v[12:13], v[12:13], v[24:25], v[64:65] op_sel:[0,0,0] op_sel_hi:[0,1,1]
    v_pk_fma_f32 v[14:15], v[14:15], v[26:27], v[66:67] op_sel:[0,0,0] op_sel_hi:[0,1,1]
    v_cvt_pk_bf16_f32 v68, v12, v13
    v_cvt_pk_bf16_f32 v69, v14, v15
    ds_write_addtid_b32 v68 offset:6336
    ds_write_addtid_b32 v69 offset:6592
    v_cos_f32 v28, v113
    v_sin_f32 v29, v113
    v_cos_f32 v30, v115
    v_pk_mul_f32 v[64:65], v[12:13], v[24:25] op_sel:[1,1] op_sel_hi:[1,0] neg_lo:[1,0]
    v_pk_mul_f32 v[66:67], v[14:15], v[26:27] op_sel:[1,1] op_sel_hi:[1,0] neg_lo:[1,0]
    v_pk_fma_f32 v[12:13], v[12:13], v[24:25], v[64:65] op_sel:[0,0,0] op_sel_hi:[0,1,1]
    v_pk_fma_f32 v[14:15], v[14:15], v[26:27], v[66:67] op_sel:[0,0,0] op_sel_hi:[0,1,1]
    v_cvt_pk_bf16_f32 v70, v12, v13
    v_cvt_pk_bf16_f32 v71, v14, v15
    ds_write_addtid_b32 v70 offset:6864
    ds_write_addtid_b32 v71 offset:7120
    v_sin_f32 v31, v115
    v_pk_mul_f32 v[28:29], v[28:29], v[112:113] op_sel:[0,0] op_sel_hi:[1,0]
    v_pk_mul_f32 v[30:31], v[30:31], v[114:115] op_sel:[0,0] op_sel_hi:[1,0]
    v_pk_mul_f32 v[64:65], v[12:13], v[24:25] op_sel:[1,1] op_sel_hi:[1,0] neg_lo:[1,0]
    v_pk_mul_f32 v[66:67], v[14:15], v[26:27] op_sel:[1,1] op_sel_hi:[1,0] neg_lo:[1,0]
    v_pk_fma_f32 v[12:13], v[12:13], v[24:25], v[64:65] op_sel:[0,0,0] op_sel_hi:[0,1,1]
    v_pk_fma_f32 v[14:15], v[14:15], v[26:27], v[66:67] op_sel:[0,0,0] op_sel_hi:[0,1,1]
    v_cvt_pk_bf16_f32 v68, v12, v13
    v_cvt_pk_bf16_f32 v69, v14, v15
    ds_write_addtid_b32 v68 offset:7392
    ds_write_addtid_b32 v69 offset:7648
    v_pk_mul_f32 v[64:65], v[12:13], v[24:25] op_sel:[1,1] op_sel_hi:[1,0] neg_lo:[1,0]
    v_pk_mul_f32 v[66:67], v[14:15], v[26:27] op_sel:[1,1] op_sel_hi:[1,0] neg_lo:[1,0]
    v_pk_fma_f32 v[12:13], v[12:13], v[24:25], v[64:65] op_sel:[0,0,0] op_sel_hi:[0,1,1]
    v_pk_fma_f32 v[14:15], v[14:15], v[26:27], v[66:67] op_sel:[0,0,0] op_sel_hi:[0,1,1]
    v_cvt_pk_bf16_f32 v70, v12, v13
    v_cvt_pk_bf16_f32 v71, v14, v15
    ds_write_addtid_b32 v70 offset:7920
    ds_write_addtid_b32 v71 offset:8176
    ds_read_b128 v[80:83], v6 offset:0
    ds_read_b128 v[84:87], v6 offset:32
    ds_read_b128 v[88:91], v6 offset:64
    ds_read_b128 v[92:95], v6 offset:96
    ds_read_b128 v[96:99], v6 offset:128
    ds_read_b128 v[100:103], v6 offset:160
    ds_read_b128 v[104:107], v6 offset:192
    ds_read_b128 v[108:111], v6 offset:224
    v_cvt_pk_bf16_f32 v68, v32, v33
    v_cvt_pk_bf16_f32 v69, v34, v35
    ds_write_addtid_b32 v68 offset:0
    ds_write_addtid_b32 v69 offset:256
    v_pk_mul_f32 v[64:65], v[32:33], v[20:21] op_sel:[1,1] op_sel_hi:[1,0] neg_lo:[1,0]
    v_pk_mul_f32 v[66:67], v[34:35], v[22:23] op_sel:[1,1] op_sel_hi:[1,0] neg_lo:[1,0]
    v_pk_fma_f32 v[36:37], v[32:33], v[20:21], v[64:65] op_sel:[0,0,0] op_sel_hi:[0,1,1]
    v_pk_fma_f32 v[38:39], v[34:35], v[22:23], v[66:67] op_sel:[0,0,0] op_sel_hi:[0,1,1]
    v_cvt_pk_bf16_f32 v70, v36, v37
    v_cvt_pk_bf16_f32 v71, v38, v39
    ds_write_addtid_b32 v70 offset:528
    ds_write_addtid_b32 v71 offset:784
    v_pk_mul_f32 v[64:65], v[36:37], v[20:21] op_sel:[1,1] op_sel_hi:[1,0] neg_lo:[1,0]
    v_pk_mul_f32 v[66:67], v[38:39], v[22:23] op_sel:[1,1] op_sel_hi:[1,0] neg_lo:[1,0]
    v_pk_fma_f32 v[40:41], v[36:37], v[20:21], v[64:65] op_sel:[0,0,0] op_sel_hi:[0,1,1]
    v_pk_fma_f32 v[42:43], v[38:39], v[22:23], v[66:67] op_sel:[0,0,0] op_sel_hi:[0,1,1]
    v_cvt_pk_bf16_f32 v68, v40, v41
    v_cvt_pk_bf16_f32 v69, v42, v43
    ds_write_addtid_b32 v68 offset:1056
    ds_write_addtid_b32 v69 offset:1312
    v_pk_mul_f32 v[64:65], v[40:41], v[20:21] op_sel:[1,1] op_sel_hi:[1,0] neg_lo:[1,0]
    v_pk_mul_f32 v[66:67], v[42:43], v[22:23] op_sel:[1,1] op_sel_hi:[1,0] neg_lo:[1,0]
    v_pk_fma_f32 v[44:45], v[40:41], v[20:21], v[64:65] op_sel:[0,0,0] op_sel_hi:[0,1,1]
    v_pk_fma_f32 v[46:47], v[42:43], v[22:23], v[66:67] op_sel:[0,0,0] op_sel_hi:[0,1,1]
    v_cvt_pk_bf16_f32 v70, v44, v45
    v_cvt_pk_bf16_f32 v71, v46, v47
    ds_write_addtid_b32 v70 offset:1584
    ds_write_addtid_b32 v71 offset:1840
    v_pk_mul_f32 v[64:65], v[44:45], v[20:21] op_sel:[1,1] op_sel_hi:[1,0] neg_lo:[1,0]
    v_pk_mul_f32 v[66:67], v[46:47], v[22:23] op_sel:[1,1] op_sel_hi:[1,0] neg_lo:[1,0]
    s_waitcnt vmcnt(0)
    buffer_load_dwordx4 v[240:243], v9, s[36:39], 0 offen offset:0
    v_pk_fma_f32 v[48:49], v[44:45], v[20:21], v[64:65] op_sel:[0,0,0] op_sel_hi:[0,1,1]
    v_pk_fma_f32 v[50:51], v[46:47], v[22:23], v[66:67] op_sel:[0,0,0] op_sel_hi:[0,1,1]
    v_cvt_pk_bf16_f32 v68, v48, v49
    v_cvt_pk_bf16_f32 v69, v50, v51
    ds_write_addtid_b32 v68 offset:2112
    ds_write_addtid_b32 v69 offset:2368
    v_pk_mul_f32 v[64:65], v[48:49], v[20:21] op_sel:[1,1] op_sel_hi:[1,0] neg_lo:[1,0]
    v_pk_mul_f32 v[66:67], v[50:51], v[22:23] op_sel:[1,1] op_sel_hi:[1,0] neg_lo:[1,0]
    v_pk_fma_f32 v[52:53], v[48:49], v[20:21], v[64:65] op_sel:[0,0,0] op_sel_hi:[0,1,1]
    v_pk_fma_f32 v[54:55], v[50:51], v[22:23], v[66:67] op_sel:[0,0,0] op_sel_hi:[0,1,1]
    v_cvt_pk_bf16_f32 v70, v52, v53
    v_cvt_pk_bf16_f32 v71, v54, v55
    ds_write_addtid_b32 v70 offset:2640
    ds_write_addtid_b32 v71 offset:2896
    v_pk_mul_f32 v[64:65], v[52:53], v[20:21] op_sel:[1,1] op_sel_hi:[1,0] neg_lo:[1,0]
    v_pk_mul_f32 v[66:67], v[54:55], v[22:23] op_sel:[1,1] op_sel_hi:[1,0] neg_lo:[1,0]
    v_pk_fma_f32 v[56:57], v[52:53], v[20:21], v[64:65] op_sel:[0,0,0] op_sel_hi:[0,1,1]
    v_pk_fma_f32 v[58:59], v[54:55], v[22:23], v[66:67] op_sel:[0,0,0] op_sel_hi:[0,1,1]
    v_cvt_pk_bf16_f32 v68, v56, v57
    v_cvt_pk_bf16_f32 v69, v58, v59
    ds_write_addtid_b32 v68 offset:3168
    ds_write_addtid_b32 v69 offset:3424
    v_pk_mul_f32 v[64:65], v[56:57], v[20:21] op_sel:[1,1] op_sel_hi:[1,0] neg_lo:[1,0]
    v_pk_mul_f32 v[66:67], v[58:59], v[22:23] op_sel:[1,1] op_sel_hi:[1,0] neg_lo:[1,0]
    v_pk_fma_f32 v[60:61], v[56:57], v[20:21], v[64:65] op_sel:[0,0,0] op_sel_hi:[0,1,1]
    v_pk_fma_f32 v[62:63], v[58:59], v[22:23], v[66:67] op_sel:[0,0,0] op_sel_hi:[0,1,1]
    v_cvt_pk_bf16_f32 v70, v60, v61
    v_cvt_pk_bf16_f32 v71, v62, v63
    ds_write_addtid_b32 v70 offset:3696
    ds_write_addtid_b32 v71 offset:3952
    v_pk_mul_f32 v[64:65], v[32:33], v[28:29] op_sel:[1,1] op_sel_hi:[1,0] neg_lo:[1,0]
    v_pk_mul_f32 v[66:67], v[34:35], v[30:31] op_sel:[1,1] op_sel_hi:[1,0] neg_lo:[1,0]
    v_pk_fma_f32 v[32:33], v[32:33], v[28:29], v[64:65] op_sel:[0,0,0] op_sel_hi:[0,1,1]
    v_pk_fma_f32 v[34:35], v[34:35], v[30:31], v[66:67] op_sel:[0,0,0] op_sel_hi:[0,1,1]
    v_cvt_pk_bf16_f32 v68, v32, v33
    v_cvt_pk_bf16_f32 v69, v34, v35
    ds_write_addtid_b32 v68 offset:4224
    ds_write_addtid_b32 v69 offset:4480
    v_pk_mul_f32 v[64:65], v[36:37], v[28:29] op_sel:[1,1] op_sel_hi:[1,0] neg_lo:[1,0]
    v_pk_mul_f32 v[66:67], v[38:39], v[30:31] op_sel:[1,1] op_sel_hi:[1,0] neg_lo:[1,0]
    v_pk_fma_f32 v[36:37], v[36:37], v[28:29], v[64:65] op_sel:[0,0,0] op_sel_hi:[0,1,1]
    v_pk_fma_f32 v[38:39], v[38:39], v[30:31], v[66:67] op_sel:[0,0,0] op_sel_hi:[0,1,1]
    v_cvt_pk_bf16_f32 v70, v36, v37
    v_cvt_pk_bf16_f32 v71, v38, v39
    ds_write_addtid_b32 v70 offset:4752
    ds_write_addtid_b32 v71 offset:5008
    v_pk_mul_f32 v[64:65], v[40:41], v[28:29] op_sel:[1,1] op_sel_hi:[1,0] neg_lo:[1,0]
    v_pk_mul_f32 v[66:67], v[42:43], v[30:31] op_sel:[1,1] op_sel_hi:[1,0] neg_lo:[1,0]
    v_pk_fma_f32 v[40:41], v[40:41], v[28:29], v[64:65] op_sel:[0,0,0] op_sel_hi:[0,1,1]
    v_pk_fma_f32 v[42:43], v[42:43], v[30:31], v[66:67] op_sel:[0,0,0] op_sel_hi:[0,1,1]
    v_cvt_pk_bf16_f32 v68, v40, v41
    v_cvt_pk_bf16_f32 v69, v42, v43
    ds_write_addtid_b32 v68 offset:5280
    ds_write_addtid_b32 v69 offset:5536
    v_pk_mul_f32 v[64:65], v[44:45], v[28:29] op_sel:[1,1] op_sel_hi:[1,0] neg_lo:[1,0]
    v_pk_mul_f32 v[66:67], v[46:47], v[30:31] op_sel:[1,1] op_sel_hi:[1,0] neg_lo:[1,0]
    v_pk_fma_f32 v[44:45], v[44:45], v[28:29], v[64:65] op_sel:[0,0,0] op_sel_hi:[0,1,1]
    v_pk_fma_f32 v[46:47], v[46:47], v[30:31], v[66:67] op_sel:[0,0,0] op_sel_hi:[0,1,1]
    v_cvt_pk_bf16_f32 v70, v44, v45
    v_cvt_pk_bf16_f32 v71, v46, v47
    buffer_load_dwordx4 v[244:247], v9, s[36:39], 0 offen offset:2048
    ds_write_addtid_b32 v70 offset:5808
    ds_write_addtid_b32 v71 offset:6064
    v_pk_mul_f32 v[64:65], v[48:49], v[28:29] op_sel:[1,1] op_sel_hi:[1,0] neg_lo:[1,0]
    v_pk_mul_f32 v[66:67], v[50:51], v[30:31] op_sel:[1,1] op_sel_hi:[1,0] neg_lo:[1,0]
    v_pk_fma_f32 v[48:49], v[48:49], v[28:29], v[64:65] op_sel:[0,0,0] op_sel_hi:[0,1,1]
    v_pk_fma_f32 v[50:51], v[50:51], v[30:31], v[66:67] op_sel:[0,0,0] op_sel_hi:[0,1,1]
    v_cvt_pk_bf16_f32 v68, v48, v49
    v_cvt_pk_bf16_f32 v69, v50, v51
    ds_write_addtid_b32 v68 offset:6336
    ds_write_addtid_b32 v69 offset:6592
    v_pk_mul_f32 v[64:65], v[52:53], v[28:29] op_sel:[1,1] op_sel_hi:[1,0] neg_lo:[1,0]
    v_pk_mul_f32 v[66:67], v[54:55], v[30:31] op_sel:[1,1] op_sel_hi:[1,0] neg_lo:[1,0]
    v_pk_fma_f32 v[52:53], v[52:53], v[28:29], v[64:65] op_sel:[0,0,0] op_sel_hi:[0,1,1]
    v_pk_fma_f32 v[54:55], v[54:55], v[30:31], v[66:67] op_sel:[0,0,0] op_sel_hi:[0,1,1]
    v_cvt_pk_bf16_f32 v70, v52, v53
    v_cvt_pk_bf16_f32 v71, v54, v55
    ds_write_addtid_b32 v70 offset:6864
    ds_write_addtid_b32 v71 offset:7120
    v_pk_mul_f32 v[64:65], v[56:57], v[28:29] op_sel:[1,1] op_sel_hi:[1,0] neg_lo:[1,0]
    v_pk_mul_f32 v[66:67], v[58:59], v[30:31] op_sel:[1,1] op_sel_hi:[1,0] neg_lo:[1,0]
    v_pk_fma_f32 v[56:57], v[56:57], v[28:29], v[64:65] op_sel:[0,0,0] op_sel_hi:[0,1,1]
    v_pk_fma_f32 v[58:59], v[58:59], v[30:31], v[66:67] op_sel:[0,0,0] op_sel_hi:[0,1,1]
    v_cvt_pk_bf16_f32 v68, v56, v57
    v_cvt_pk_bf16_f32 v69, v58, v59
    ds_write_addtid_b32 v68 offset:7392
    ds_write_addtid_b32 v69 offset:7648
    v_pk_mul_f32 v[64:65], v[60:61], v[28:29] op_sel:[1,1] op_sel_hi:[1,0] neg_lo:[1,0]
    v_pk_mul_f32 v[66:67], v[62:63], v[30:31] op_sel:[1,1] op_sel_hi:[1,0] neg_lo:[1,0]
    v_pk_fma_f32 v[60:61], v[60:61], v[28:29], v[64:65] op_sel:[0,0,0] op_sel_hi:[0,1,1]
    v_pk_fma_f32 v[62:63], v[62:63], v[30:31], v[66:67] op_sel:[0,0,0] op_sel_hi:[0,1,1]
    v_cvt_pk_bf16_f32 v70, v60, v61
    v_cvt_pk_bf16_f32 v71, v62, v63
    ds_write_addtid_b32 v70 offset:7920
    ds_write_addtid_b32 v71 offset:8176
    ds_read_b128 v[176:179], v6 offset:0
    ds_read_b128 v[180:183], v6 offset:32
    ds_read_b128 v[184:187], v6 offset:64
    ds_read_b128 v[188:191], v6 offset:96
    ds_read_b128 v[192:195], v6 offset:128
    ds_read_b128 v[196:199], v6 offset:160
    ds_read_b128 v[200:203], v6 offset:192
    ds_read_b128 v[204:207], v6 offset:224
    v_pk_mul_f32 v[64:65], v[32:33], v[28:29] op_sel:[1,1] op_sel_hi:[1,0] neg_lo:[1,0]
    v_pk_mul_f32 v[66:67], v[34:35], v[30:31] op_sel:[1,1] op_sel_hi:[1,0] neg_lo:[1,0]
    v_pk_fma_f32 v[32:33], v[32:33], v[28:29], v[64:65] op_sel:[0,0,0] op_sel_hi:[0,1,1]
    v_pk_fma_f32 v[34:35], v[34:35], v[30:31], v[66:67] op_sel:[0,0,0] op_sel_hi:[0,1,1]
    v_cvt_pk_bf16_f32 v68, v32, v33
    v_cvt_pk_bf16_f32 v69, v34, v35
    ds_write_addtid_b32 v68 offset:0
    ds_write_addtid_b32 v69 offset:256
    v_pk_mul_f32 v[64:65], v[40:41], v[28:29] op_sel:[1,1] op_sel_hi:[1,0] neg_lo:[1,0]
    v_pk_mul_f32 v[66:67], v[42:43], v[30:31] op_sel:[1,1] op_sel_hi:[1,0] neg_lo:[1,0]
    v_pk_fma_f32 v[40:41], v[40:41], v[28:29], v[64:65] op_sel:[0,0,0] op_sel_hi:[0,1,1]
    v_pk_fma_f32 v[42:43], v[42:43], v[30:31], v[66:67] op_sel:[0,0,0] op_sel_hi:[0,1,1]
    v_cvt_pk_bf16_f32 v70, v40, v41
    v_cvt_pk_bf16_f32 v71, v42, v43
    ds_write_addtid_b32 v70 offset:528
    ds_write_addtid_b32 v71 offset:784
    v_pk_mul_f32 v[64:65], v[48:49], v[28:29] op_sel:[1,1] op_sel_hi:[1,0] neg_lo:[1,0]
    v_pk_mul_f32 v[66:67], v[50:51], v[30:31] op_sel:[1,1] op_sel_hi:[1,0] neg_lo:[1,0]
    buffer_load_dwordx4 v[248:251], v9, s[36:39], s53 offen offset:0
    v_pk_fma_f32 v[48:49], v[48:49], v[28:29], v[64:65] op_sel:[0,0,0] op_sel_hi:[0,1,1]
    v_pk_fma_f32 v[50:51], v[50:51], v[30:31], v[66:67] op_sel:[0,0,0] op_sel_hi:[0,1,1]
    v_cvt_pk_bf16_f32 v68, v48, v49
    v_cvt_pk_bf16_f32 v69, v50, v51
    ds_write_addtid_b32 v68 offset:1056
    ds_write_addtid_b32 v69 offset:1312
    v_pk_mul_f32 v[64:65], v[56:57], v[28:29] op_sel:[1,1] op_sel_hi:[1,0] neg_lo:[1,0]
    v_pk_mul_f32 v[66:67], v[58:59], v[30:31] op_sel:[1,1] op_sel_hi:[1,0] neg_lo:[1,0]
    v_pk_fma_f32 v[56:57], v[56:57], v[28:29], v[64:65] op_sel:[0,0,0] op_sel_hi:[0,1,1]
    v_pk_fma_f32 v[58:59], v[58:59], v[30:31], v[66:67] op_sel:[0,0,0] op_sel_hi:[0,1,1]
    v_cvt_pk_bf16_f32 v70, v56, v57
    v_cvt_pk_bf16_f32 v71, v58, v59
    ds_write_addtid_b32 v70 offset:1584
    ds_write_addtid_b32 v71 offset:1840
    s_waitcnt lgkmcnt(15)
    v_mfma_f32_16x16x32_bf16 v[208:211], v[176:179], v[80:83], 0
    v_pk_mul_f32 v[64:65], v[32:33], v[28:29] op_sel:[1,1] op_sel_hi:[1,0] neg_lo:[1,0]
    v_pk_mul_f32 v[66:67], v[34:35], v[30:31] op_sel:[1,1] op_sel_hi:[1,0] neg_lo:[1,0]
    v_pk_fma_f32 v[32:33], v[32:33], v[28:29], v[64:65] op_sel:[0,0,0] op_sel_hi:[0,1,1]
    v_pk_fma_f32 v[34:35], v[34:35], v[30:31], v[66:67] op_sel:[0,0,0] op_sel_hi:[0,1,1]
    v_cvt_pk_bf16_f32 v68, v32, v33
    v_cvt_pk_bf16_f32 v69, v34, v35
    ds_write_addtid_b32 v68 offset:2112
    ds_write_addtid_b32 v69 offset:2368
    s_waitcnt lgkmcnt(15)
    v_mfma_f32_16x16x32_bf16 v[208:211], v[180:183], v[84:87], v[208:211]
    v_pk_mul_f32 v[64:65], v[40:41], v[28:29] op_sel:[1,1] op_sel_hi:[1,0] neg_lo:[1,0]
    v_pk_mul_f32 v[66:67], v[42:43], v[30:31] op_sel:[1,1] op_sel_hi:[1,0] neg_lo:[1,0]
    v_pk_fma_f32 v[40:41], v[40:41], v[28:29], v[64:65] op_sel:[0,0,0] op_sel_hi:[0,1,1]
    v_pk_fma_f32 v[42:43], v[42:43], v[30:31], v[66:67] op_sel:[0,0,0] op_sel_hi:[0,1,1]
    v_cvt_pk_bf16_f32 v70, v40, v41
    v_cvt_pk_bf16_f32 v71, v42, v43
    ds_write_addtid_b32 v70 offset:2640
    ds_write_addtid_b32 v71 offset:2896
    v_mfma_f32_16x16x32_bf16 v[208:211], v[184:187], v[88:91], v[208:211]
    v_pk_mul_f32 v[64:65], v[48:49], v[28:29] op_sel:[1,1] op_sel_hi:[1,0] neg_lo:[1,0]
    v_pk_mul_f32 v[66:67], v[50:51], v[30:31] op_sel:[1,1] op_sel_hi:[1,0] neg_lo:[1,0]
    v_pk_fma_f32 v[48:49], v[48:49], v[28:29], v[64:65] op_sel:[0,0,0] op_sel_hi:[0,1,1]
    v_pk_fma_f32 v[50:51], v[50:51], v[30:31], v[66:67] op_sel:[0,0,0] op_sel_hi:[0,1,1]
    v_cvt_pk_bf16_f32 v68, v48, v49
    v_cvt_pk_bf16_f32 v69, v50, v51
    ds_write_addtid_b32 v68 offset:3168
    ds_write_addtid_b32 v69 offset:3424
    s_waitcnt lgkmcnt(15)
    v_mfma_f32_16x16x32_bf16 v[208:211], v[188:191], v[92:95], v[208:211]
    v_pk_mul_f32 v[64:65], v[56:57], v[28:29] op_sel:[1,1] op_sel_hi:[1,0] neg_lo:[1,0]
    v_pk_mul_f32 v[66:67], v[58:59], v[30:31] op_sel:[1,1] op_sel_hi:[1,0] neg_lo:[1,0]
    v_pk_fma_f32 v[56:57], v[56:57], v[28:29], v[64:65] op_sel:[0,0,0] op_sel_hi:[0,1,1]
    v_pk_fma_f32 v[58:59], v[58:59], v[30:31], v[66:67] op_sel:[0,0,0] op_sel_hi:[0,1,1]
    v_cvt_pk_bf16_f32 v70, v56, v57
    v_cvt_pk_bf16_f32 v71, v58, v59
    ds_write_addtid_b32 v70 offset:3696
    ds_write_addtid_b32 v71 offset:3952
    v_mfma_f32_16x16x32_bf16 v[208:211], v[192:195], v[96:99], v[208:211]
    v_pk_mul_f32 v[64:65], v[32:33], v[28:29] op_sel:[1,1] op_sel_hi:[1,0] neg_lo:[1,0]
    v_pk_mul_f32 v[66:67], v[34:35], v[30:31] op_sel:[1,1] op_sel_hi:[1,0] neg_lo:[1,0]
    v_pk_fma_f32 v[32:33], v[32:33], v[28:29], v[64:65] op_sel:[0,0,0] op_sel_hi:[0,1,1]
    v_pk_fma_f32 v[34:35], v[34:35], v[30:31], v[66:67] op_sel:[0,0,0] op_sel_hi:[0,1,1]
    v_cvt_pk_bf16_f32 v68, v32, v33
    v_cvt_pk_bf16_f32 v69, v34, v35
    buffer_load_dwordx4 v[252:255], v9, s[36:39], s53 offen offset:2048
    ds_write_addtid_b32 v68 offset:4224
    ds_write_addtid_b32 v69 offset:4480
    v_mfma_f32_16x16x32_bf16 v[208:211], v[196:199], v[100:103], v[208:211]
    v_pk_mul_f32 v[64:65], v[48:49], v[28:29] op_sel:[1,1] op_sel_hi:[1,0] neg_lo:[1,0]
    v_pk_mul_f32 v[66:67], v[50:51], v[30:31] op_sel:[1,1] op_sel_hi:[1,0] neg_lo:[1,0]
    v_pk_fma_f32 v[48:49], v[48:49], v[28:29], v[64:65] op_sel:[0,0,0] op_sel_hi:[0,1,1]
    v_pk_fma_f32 v[50:51], v[50:51], v[30:31], v[66:67] op_sel:[0,0,0] op_sel_hi:[0,1,1]
    v_cvt_pk_bf16_f32 v70, v48, v49
    v_cvt_pk_bf16_f32 v71, v50, v51
    ds_write_addtid_b32 v70 offset:4752
    ds_write_addtid_b32 v71 offset:5008
    v_mfma_f32_16x16x32_bf16 v[208:211], v[200:203], v[104:107], v[208:211]
    v_pk_mul_f32 v[64:65], v[32:33], v[28:29] op_sel:[1,1] op_sel_hi:[1,0] neg_lo:[1,0]
    v_pk_mul_f32 v[66:67], v[34:35], v[30:31] op_sel:[1,1] op_sel_hi:[1,0] neg_lo:[1,0]
    v_pk_fma_f32 v[32:33], v[32:33], v[28:29], v[64:65] op_sel:[0,0,0] op_sel_hi:[0,1,1]
    v_pk_fma_f32 v[34:35], v[34:35], v[30:31], v[66:67] op_sel:[0,0,0] op_sel_hi:[0,1,1]
    v_cvt_pk_bf16_f32 v68, v32, v33
    v_cvt_pk_bf16_f32 v69, v34, v35
    ds_write_addtid_b32 v68 offset:5280
    ds_write_addtid_b32 v69 offset:5536
    s_waitcnt lgkmcnt(15)
    v_mfma_f32_16x16x32_bf16 v[208:211], v[204:207], v[108:111], v[208:211]
    v_pk_mul_f32 v[64:65], v[48:49], v[28:29] op_sel:[1,1] op_sel_hi:[1,0] neg_lo:[1,0]
    v_pk_mul_f32 v[66:67], v[50:51], v[30:31] op_sel:[1,1] op_sel_hi:[1,0] neg_lo:[1,0]
    v_pk_fma_f32 v[48:49], v[48:49], v[28:29], v[64:65] op_sel:[0,0,0] op_sel_hi:[0,1,1]
    v_pk_fma_f32 v[50:51], v[50:51], v[30:31], v[66:67] op_sel:[0,0,0] op_sel_hi:[0,1,1]
    v_cvt_pk_bf16_f32 v70, v48, v49
    v_cvt_pk_bf16_f32 v71, v50, v51
    ds_write_addtid_b32 v70 offset:5808
    ds_write_addtid_b32 v71 offset:6064
    v_pk_mul_f32 v[64:65], v[32:33], v[28:29] op_sel:[1,1] op_sel_hi:[1,0] neg_lo:[1,0]
    v_pk_mul_f32 v[66:67], v[34:35], v[30:31] op_sel:[1,1] op_sel_hi:[1,0] neg_lo:[1,0]
    v_pk_fma_f32 v[32:33], v[32:33], v[28:29], v[64:65] op_sel:[0,0,0] op_sel_hi:[0,1,1]
    v_pk_fma_f32 v[34:35], v[34:35], v[30:31], v[66:67] op_sel:[0,0,0] op_sel_hi:[0,1,1]
    v_cvt_pk_bf16_f32 v68, v32, v33
    v_cvt_pk_bf16_f32 v69, v34, v35
    ds_write_addtid_b32 v68 offset:6336
    ds_write_addtid_b32 v69 offset:6592
    v_pk_mul_f32 v[64:65], v[48:49], v[28:29] op_sel:[1,1] op_sel_hi:[1,0] neg_lo:[1,0]
    v_pk_mul_f32 v[66:67], v[50:51], v[30:31] op_sel:[1,1] op_sel_hi:[1,0] neg_lo:[1,0]
    v_pk_fma_f32 v[48:49], v[48:49], v[28:29], v[64:65] op_sel:[0,0,0] op_sel_hi:[0,1,1]
    v_pk_fma_f32 v[50:51], v[50:51], v[30:31], v[66:67] op_sel:[0,0,0] op_sel_hi:[0,1,1]
    v_cvt_pk_bf16_f32 v70, v48, v49
    v_cvt_pk_bf16_f32 v71, v50, v51
    ds_write_addtid_b32 v70 offset:6864
    ds_write_addtid_b32 v71 offset:7120
    v_pk_mul_f32 v[64:65], v[32:33], v[28:29] op_sel:[1,1] op_sel_hi:[1,0] neg_lo:[1,0]
    v_pk_mul_f32 v[66:67], v[34:35], v[30:31] op_sel:[1,1] op_sel_hi:[1,0] neg_lo:[1,0]
    v_pk_fma_f32 v[32:33], v[32:33], v[28:29], v[64:65] op_sel:[0,0,0] op_sel_hi:[0,1,1]
    v_pk_fma_f32 v[34:35], v[34:35], v[30:31], v[66:67] op_sel:[0,0,0] op_sel_hi:[0,1,1]
    v_cvt_pk_bf16_f32 v68, v32, v33
    v_cvt_pk_bf16_f32 v69, v34, v35
    ds_write_addtid_b32 v68 offset:7392
    ds_write_addtid_b32 v69 offset:7648
    v_pk_mul_f32 v[64:65], v[48:49], v[28:29] op_sel:[1,1] op_sel_hi:[1,0] neg_lo:[1,0]
    v_pk_mul_f32 v[66:67], v[50:51], v[30:31] op_sel:[1,1] op_sel_hi:[1,0] neg_lo:[1,0]
    v_pk_fma_f32 v[48:49], v[48:49], v[28:29], v[64:65] op_sel:[0,0,0] op_sel_hi:[0,1,1]
    v_pk_fma_f32 v[50:51], v[50:51], v[30:31], v[66:67] op_sel:[0,0,0] op_sel_hi:[0,1,1]
    v_cvt_pk_bf16_f32 v70, v48, v49
    v_cvt_pk_bf16_f32 v71, v50, v51
    ds_write_addtid_b32 v70 offset:7920
    ds_write_addtid_b32 v71 offset:8176
    ds_read_b128 v[176:179], v6 offset:0
    ds_read_b128 v[180:183], v6 offset:32
    ds_read_b128 v[184:187], v6 offset:64
    ds_read_b128 v[188:191], v6 offset:96
    ds_read_b128 v[192:195], v6 offset:128
    ds_read_b128 v[196:199], v6 offset:160
    ds_read_b128 v[200:203], v6 offset:192
    ds_read_b128 v[204:207], v6 offset:224
    v_pk_mul_f32 v[64:65], v[32:33], v[28:29] op_sel:[1,1] op_sel_hi:[1,0] neg_lo:[1,0]
    v_pk_mul_f32 v[66:67], v[34:35], v[30:31] op_sel:[1,1] op_sel_hi:[1,0] neg_lo:[1,0]
    v_pk_fma_f32 v[32:33], v[32:33], v[28:29], v[64:65] op_sel:[0,0,0] op_sel_hi:[0,1,1]
    v_pk_fma_f32 v[34:35], v[34:35], v[30:31], v[66:67] op_sel:[0,0,0] op_sel_hi:[0,1,1]
    v_cvt_pk_bf16_f32 v68, v32, v33
    v_cvt_pk_bf16_f32 v69, v34, v35
    ds_write_addtid_b32 v68 offset:0
    ds_write_addtid_b32 v69 offset:256
    v_pk_mul_f32 v[64:65], v[32:33], v[28:29] op_sel:[1,1] op_sel_hi:[1,0] neg_lo:[1,0]
    v_pk_mul_f32 v[66:67], v[34:35], v[30:31] op_sel:[1,1] op_sel_hi:[1,0] neg_lo:[1,0]
    v_pk_fma_f32 v[32:33], v[32:33], v[28:29], v[64:65] op_sel:[0,0,0] op_sel_hi:[0,1,1]
    v_pk_fma_f32 v[34:35], v[34:35], v[30:31], v[66:67] op_sel:[0,0,0] op_sel_hi:[0,1,1]
    v_cvt_pk_bf16_f32 v70, v32, v33
    v_cvt_pk_bf16_f32 v71, v34, v35
    ds_write_addtid_b32 v70 offset:528
    ds_write_addtid_b32 v71 offset:784
    v_pk_mul_f32 v[64:65], v[32:33], v[28:29] op_sel:[1,1] op_sel_hi:[1,0] neg_lo:[1,0]
    v_pk_mul_f32 v[66:67], v[34:35], v[30:31] op_sel:[1,1] op_sel_hi:[1,0] neg_lo:[1,0]
    v_pk_fma_f32 v[32:33], v[32:33], v[28:29], v[64:65] op_sel:[0,0,0] op_sel_hi:[0,1,1]
    v_pk_fma_f32 v[34:35], v[34:35], v[30:31], v[66:67] op_sel:[0,0,0] op_sel_hi:[0,1,1]
    v_cvt_pk_bf16_f32 v68, v32, v33
    v_cvt_pk_bf16_f32 v69, v34, v35
    ds_write_addtid_b32 v68 offset:1056
    ds_write_addtid_b32 v69 offset:1312
    s_waitcnt lgkmcnt(13)
    v_mfma_f32_16x16x32_bf16 v[212:215], v[176:179], v[80:83], 0
    v_pk_mul_f32 v[64:65], v[32:33], v[28:29] op_sel:[1,1] op_sel_hi:[1,0] neg_lo:[1,0]
    v_pk_mul_f32 v[66:67], v[34:35], v[30:31] op_sel:[1,1] op_sel_hi:[1,0] neg_lo:[1,0]
    v_pk_fma_f32 v[32:33], v[32:33], v[28:29], v[64:65] op_sel:[0,0,0] op_sel_hi:[0,1,1]
    v_pk_fma_f32 v[34:35], v[34:35], v[30:31], v[66:67] op_sel:[0,0,0] op_sel_hi:[0,1,1]
    v_cvt_pk_bf16_f32 v70, v32, v33
    v_cvt_pk_bf16_f32 v71, v34, v35
    ds_write_addtid_b32 v70 offset:1584
    ds_write_addtid_b32 v71 offset:1840
    s_waitcnt lgkmcnt(14)
    v_mfma_f32_16x16x32_bf16 v[212:215], v[180:183], v[84:87], v[212:215]
    v_pk_mul_f32 v[64:65], v[32:33], v[28:29] op_sel:[1,1] op_sel_hi:[1,0] neg_lo:[1,0]
    v_pk_mul_f32 v[66:67], v[34:35], v[30:31] op_sel:[1,1] op_sel_hi:[1,0] neg_lo:[1,0]
    v_pk_fma_f32 v[32:33], v[32:33], v[28:29], v[64:65] op_sel:[0,0,0] op_sel_hi:[0,1,1]
    v_pk_fma_f32 v[34:35], v[34:35], v[30:31], v[66:67] op_sel:[0,0,0] op_sel_hi:[0,1,1]
    v_cvt_pk_bf16_f32 v68, v32, v33
    v_cvt_pk_bf16_f32 v69, v34, v35
    ds_write_addtid_b32 v68 offset:2112
    ds_write_addtid_b32 v69 offset:2368
    s_waitcnt lgkmcnt(15)
    v_mfma_f32_16x16x32_bf16 v[212:215], v[184:187], v[88:91], v[212:215]
    v_pk_mul_f32 v[64:65], v[32:33], v[28:29] op_sel:[1,1] op_sel_hi:[1,0] neg_lo:[1,0]
    v_pk_mul_f32 v[66:67], v[34:35], v[30:31] op_sel:[1,1] op_sel_hi:[1,0] neg_lo:[1,0]
    v_pk_fma_f32 v[32:33], v[32:33], v[28:29], v[64:65] op_sel:[0,0,0] op_sel_hi:[0,1,1]
    v_pk_fma_f32 v[34:35], v[34:35], v[30:31], v[66:67] op_sel:[0,0,0] op_sel_hi:[0,1,1]
    v_cvt_pk_bf16_f32 v70, v32, v33
    v_cvt_pk_bf16_f32 v71, v34, v35
    ds_write_addtid_b32 v70 offset:2640
    ds_write_addtid_b32 v71 offset:2896
    s_waitcnt lgkmcnt(15)
    v_mfma_f32_16x16x32_bf16 v[212:215], v[188:191], v[92:95], v[212:215]
    v_pk_mul_f32 v[64:65], v[32:33], v[28:29] op_sel:[1,1] op_sel_hi:[1,0] neg_lo:[1,0]
    v_pk_mul_f32 v[66:67], v[34:35], v[30:31] op_sel:[1,1] op_sel_hi:[1,0] neg_lo:[1,0]
    v_pk_fma_f32 v[32:33], v[32:33], v[28:29], v[64:65] op_sel:[0,0,0] op_sel_hi:[0,1,1]
    v_pk_fma_f32 v[34:35], v[34:35], v[30:31], v[66:67] op_sel:[0,0,0] op_sel_hi:[0,1,1]
    v_cvt_pk_bf16_f32 v68, v32, v33
    v_cvt_pk_bf16_f32 v69, v34, v35
    ds_write_addtid_b32 v68 offset:3168
    ds_write_addtid_b32 v69 offset:3424
    v_mfma_f32_16x16x32_bf16 v[212:215], v[192:195], v[96:99], v[212:215]
    v_pk_mul_f32 v[64:65], v[32:33], v[28:29] op_sel:[1,1] op_sel_hi:[1,0] neg_lo:[1,0]
    v_pk_mul_f32 v[66:67], v[34:35], v[30:31] op_sel:[1,1] op_sel_hi:[1,0] neg_lo:[1,0]
    v_pk_fma_f32 v[32:33], v[32:33], v[28:29], v[64:65] op_sel:[0,0,0] op_sel_hi:[0,1,1]
    v_pk_fma_f32 v[34:35], v[34:35], v[30:31], v[66:67] op_sel:[0,0,0] op_sel_hi:[0,1,1]
    v_cvt_pk_bf16_f32 v70, v32, v33
    v_cvt_pk_bf16_f32 v71, v34, v35
    ds_write_addtid_b32 v70 offset:3696
    ds_write_addtid_b32 v71 offset:3952
    s_waitcnt lgkmcnt(15)
    v_mfma_f32_16x16x32_bf16 v[212:215], v[196:199], v[100:103], v[212:215]
    v_pk_mul_f32 v[64:65], v[32:33], v[28:29] op_sel:[1,1] op_sel_hi:[1,0] neg_lo:[1,0]
    v_pk_mul_f32 v[66:67], v[34:35], v[30:31] op_sel:[1,1] op_sel_hi:[1,0] neg_lo:[1,0]
    v_pk_fma_f32 v[32:33], v[32:33], v[28:29], v[64:65] op_sel:[0,0,0] op_sel_hi:[0,1,1]
    v_pk_fma_f32 v[34:35], v[34:35], v[30:31], v[66:67] op_sel:[0,0,0] op_sel_hi:[0,1,1]
    v_cvt_pk_bf16_f32 v68, v32, v33
    v_cvt_pk_bf16_f32 v69, v34, v35
    ds_write_addtid_b32 v68 offset:4224
    ds_write_addtid_b32 v69 offset:4480
    v_mfma_f32_16x16x32_bf16 v[212:215], v[200:203], v[104:107], v[212:215]
    v_mfma_f32_16x16x32_bf16 v[212:215], v[204:207], v[108:111], v[212:215]
    ds_read_b128 v[176:179], v6 offset:0
    ds_read_b128 v[180:183], v6 offset:32
    ds_read_b128 v[184:187], v6 offset:64
    ds_read_b128 v[188:191], v6 offset:96
    ds_read_b128 v[192:195], v6 offset:128
    ds_read_b128 v[196:199], v6 offset:160
    ds_read_b128 v[200:203], v6 offset:192
    ds_read_b128 v[204:207], v6 offset:224
    v_add_f32 v208, v208, v169
    v_cndmask_b32 v72, v213, v212, s[62:63]
    v_cndmask_b32 v73, v214, v213, s[62:63]
    v_cndmask_b32 v74, v215, 0, s[62:63]
    v_cvt_pk_bf16_f32 v76, v212, v213
    v_cvt_pk_bf16_f32 v77, v214, v215
    s_waitcnt lgkmcnt(7)
    v_mfma_f32_16x16x32_bf16 v[216:219], v[176:179], v[80:83], 0
    s_waitcnt lgkmcnt(6)
    v_mfma_f32_16x16x32_bf16 v[216:219], v[180:183], v[84:87], v[216:219]
    v_cvt_pk_bf16_f32 v64, v212, v212
    v_cvt_pk_bf16_f32 v65, v212, v212
    v_cvt_pk_bf16_f32 v66, v72, v212
    v_cvt_pk_bf16_f32 v67, v73, v72
    s_waitcnt lgkmcnt(5)
    v_mfma_f32_16x16x32_bf16 v[216:219], v[184:187], v[88:91], v[216:219]
    s_waitcnt lgkmcnt(4)
    v_mfma_f32_16x16x32_bf16 v[216:219], v[188:191], v[92:95], v[216:219]
    v_cvt_pk_bf16_f32 v68, v73, v73
    v_cvt_pk_bf16_f32 v69, v73, v73
    v_cvt_pk_bf16_f32 v70, v74, v73
    v_cvt_pk_bf16_f32 v71, v74, v74
    s_waitcnt lgkmcnt(3)
    v_mfma_f32_16x16x32_bf16 v[216:219], v[192:195], v[96:99], v[216:219]
    s_waitcnt lgkmcnt(2)
    v_mfma_f32_16x16x32_bf16 v[216:219], v[196:199], v[100:103], v[216:219]
    v_cndmask_b32 v76, v76, 0, s[62:63]
    s_mov_b32 exec_hi, 1
    ds_write_b128 v160, v[64:67] offset:4
    ds_write_b128 v160, v[68:71] offset:20
    ds_write_b16 v160, v64
    s_mov_b32 exec_hi, -1
    s_waitcnt lgkmcnt(4)
    v_mfma_f32_16x16x32_bf16 v[216:219], v[200:203], v[104:107], v[216:219]
    s_waitcnt lgkmcnt(3)
    v_mfma_f32_16x16x32_bf16 v[216:219], v[204:207], v[108:111], v[216:219]
    v_cvt_pk_bf16_f32 v72, v208, v211
    v_cvt_pk_bf16_f32 v73, v209, v208
    v_cvt_pk_bf16_f32 v74, v210, v209
    v_cvt_pk_bf16_f32 v75, v211, v210
    ds_write_b16 v161, v72
    ds_write2_b32 v161, v73, v74 offset0:1 offset1:2
    ds_write_b32 v161, v75 offset:12
    ds_write_b16_d16_hi v161, v72 offset:18
    s_mov_b32 exec_lo, 0
    ds_write2_b32 v162, v76, v77 offset0:0 offset1:8
    s_mov_b32 exec_lo, -1
    v_cvt_pk_bf16_f32 v100, v216, v217
    v_cvt_pk_bf16_f32 v101, v218, v219
    v_cvt_pk_bf16_f32 v102, v216, v216
    s_mov_b32 exec_hi, 1
    ds_write_b16 v164, v100
    s_mov_b32 exec_hi, 0
    ds_write_b16_d16_hi v163, v100 offset:32
    ds_write_b16 v163, v101 offset:64
    ds_write_b16_d16_hi v163, v101 offset:96
    s_mov_b32 exec_hi, -1
    v_readlane_b32 s52, v102, 0
    s_nop 1
    v_and_b32 v124, s52, v124
    v_and_b32 v125, s52, v125
    v_and_b32 v126, s52, v126
    v_and_b32 v127, s52, v127
    v_mov_b32 v12, v165
    v_mov_b32 v13, v166
    v_mov_b32 v14, v167
    v_mov_b32 v15, v168
    v_mov_b32 v5, v174
    v_mov_b32 v6, v223
    v_readfirstlane_b32 s61, v175
    s_waitcnt vmcnt(0)
    buffer_load_dwordx4 v[144:147], v221, s[40:43], 0 offen sc1
    buffer_load_dwordx4 v[148:151], v221, s[40:43], s53 offen sc1
    s_mul_i32 s60, s61, 0x9e3779b1
    s_add_u32 s60, s60, 0x7f4a7c15
    v_perm_b32 v224, v244, v240, s64
    v_perm_b32 v225, v252, v248, s64
    ds_write_b64 v222, v[224:225] offset:0
    v_perm_b32 v226, v244, v240, s65
    v_perm_b32 v227, v252, v248, s65
    ds_write_b64 v222, v[226:227] offset:4160
    v_perm_b32 v228, v245, v241, s64
    v_perm_b32 v229, v253, v249, s64
    ds_write_b64 v222, v[228:229] offset:8320
    v_perm_b32 v230, v245, v241, s65
    v_perm_b32 v231, v253, v249, s65
    ds_write_b64 v222, v[230:231] offset:12480
    v_perm_b32 v232, v246, v242, s64
    v_perm_b32 v233, v254, v250, s64
    ds_write_b64 v222, v[232:233] offset:16640
    v_perm_b32 v234, v246, v242, s65
    v_perm_b32 v235, v254, v250, s65
    ds_write_b64 v222, v[234:235] offset:20800
    v_perm_b32 v236, v247, v243, s64
    v_perm_b32 v237, v255, v251, s64
    ds_write_b64 v222, v[236:237] offset:24960
    v_perm_b32 v238, v247, v243, s65
    v_perm_b32 v239, v255, v251, s65
    ds_write_b64 v222, v[238:239] offset:29120
    v_lshlrev_b32 v176, 16, v240
    v_and_b32 v180, 0xffff0000, v240
    v_lshlrev_b32 v184, 16, v241
    v_and_b32 v188, 0xffff0000, v241
    ds_read2_b32 v[96:97], v15 offset0:67 offset1:66
    v_lshlrev_b32 v192, 16, v242
    v_and_b32 v196, 0xffff0000, v242
    v_lshlrev_b32 v200, 16, v243
    v_and_b32 v204, 0xffff0000, v243
    ds_read2_b32 v[98:99], v15 offset0:65 offset1:64
    v_lshlrev_b32 v177, 16, v244
    v_and_b32 v181, 0xffff0000, v244
    v_lshlrev_b32 v185, 16, v245
    v_and_b32 v189, 0xffff0000, v245
    ds_read2_b32 v[100:101], v15 offset0:83 offset1:82
    v_lshlrev_b32 v193, 16, v246
    v_and_b32 v197, 0xffff0000, v246
    v_lshlrev_b32 v201, 16, v247
    v_and_b32 v205, 0xffff0000, v247
    ds_read2_b32 v[102:103], v15 offset0:81 offset1:80
    v_lshlrev_b32 v178, 16, v248
    v_and_b32 v182, 0xffff0000, v248
    v_lshlrev_b32 v186, 16, v249
    v_and_b32 v190, 0xffff0000, v249
    ds_read2_b32 v[104:105], v15 offset0:99 offset1:98
    v_lshlrev_b32 v194, 16, v250
    v_and_b32 v198, 0xffff0000, v250
    v_lshlrev_b32 v202, 16, v251
    v_and_b32 v206, 0xffff0000, v251
    ds_read2_b32 v[106:107], v15 offset0:97 offset1:96
    v_lshlrev_b32 v179, 16, v252
    v_and_b32 v183, 0xffff0000, v252
    v_lshlrev_b32 v187, 16, v253
    v_and_b32 v191, 0xffff0000, v253
    ds_read2_b32 v[84:85], v15 offset0:3 offset1:2
    v_lshlrev_b32 v195, 16, v254
    v_and_b32 v199, 0xffff0000, v254
    v_lshlrev_b32 v203, 16, v255
    v_and_b32 v207, 0xffff0000, v255
    ds_read2_b32 v[86:87], v15 offset0:1 offset1:0
    s_mov_b32 s54, 0
L_poll_conv:
    s_waitcnt vmcnt(0)
    v_cmp_ne_u32 s[8:9], s60, v147
    v_cmp_ne_u32 s[10:11], s60, v151
    s_or_b64 vcc, s[8:9], s[10:11]
    s_cbranch_scc0 L_polled_conv
    s_add_u32 s54, s54, 1
    s_cmp_ge_u32 s54, 65536
    s_cbranch_scc1 L_polled_conv
    s_sleep 2
    s_mov_b64 exec, s[8:9]
    s_cbranch_execz L_ps_conv_0
    buffer_load_dwordx4 v[144:147], v221, s[40:43], 0 offen sc1
L_ps_conv_0:
    s_mov_b64 exec, s[10:11]
    s_cbranch_execz L_ps_conv_1
    buffer_load_dwordx4 v[148:151], v221, s[40:43], s53 offen sc1
L_ps_conv_1:
    s_mov_b64 exec, -1
    s_branch L_poll_conv
L_polled_conv:
    v_and_b32 v160, 0xffff0000, v144
    v_and_b32 v161, 0xffff0000, v145
    v_and_b32 v162, 0xffff0000, v148
    v_and_b32 v163, 0xffff0000, v149
    v_rcp_f32 v160, v160
    ds_read2_b32 v[88:89], v15 offset0:19 offset1:18
    v_rcp_f32 v161, v161
    ds_read2_b32 v[90:91], v15 offset0:17 offset1:16
    v_rcp_f32 v162, v162
    ds_read2_b32 v[92:93], v15 offset0:35 offset1:34
    v_rcp_f32 v163, v163
    ds_read2_b32 v[94:95], v15 offset0:33 offset1:32
    v_lshlrev_b32 v164, 16, v144
    v_lshlrev_b32 v165, 16, v145
    v_lshlrev_b32 v166, 16, v148
    v_lshlrev_b32 v167, 16, v149
    v_pk_mul_f32 v[164:165], v[164:165], v[160:161] neg_lo:[1,0] neg_hi:[1,0]
    v_pk_mul_f32 v[166:167], v[166:167], v[162:163] neg_lo:[1,0] neg_hi:[1,0]
    v_pk_fma_f32 v[176:177], v[176:177], v[160:161], v[164:165]
    v_pk_fma_f32 v[178:179], v[178:179], v[162:163], v[166:167]
    v_cvt_pk_bf16_f32 v224, v176, v177
    v_cvt_pk_bf16_f32 v225, v178, v179
    ds_write_b64 v220, v[224:225] offset:0
    v_pk_fma_f32 v[180:181], v[180:181], v[160:161], v[164:165]
    v_pk_fma_f32 v[182:183], v[182:183], v[162:163], v[166:167]
    v_cvt_pk_bf16_f32 v226, v180, v181
    v_cvt_pk_bf16_f32 v227, v182, v183
    ds_write_b64 v220, v[226:227] offset:4608
    v_pk_fma_f32 v[184:185], v[184:185], v[160:161], v[164:165]
    v_pk_fma_f32 v[186:187], v[186:187], v[162:163], v[166:167]
    v_cvt_pk_bf16_f32 v228, v184, v185
    v_cvt_pk_bf16_f32 v229, v186, v187
    ds_write_b64 v220, v[228:229] offset:9216
    v_pk_fma_f32 v[188:189], v[188:189], v[160:161], v[164:165]
    v_pk_fma_f32 v[190:191], v[190:191], v[162:163], v[166:167]
    v_cvt_pk_bf16_f32 v230, v188, v189
    v_cvt_pk_bf16_f32 v231, v190, v191
    ds_write_b64 v220, v[230:231] offset:13824
    v_pk_fma_f32 v[192:193], v[192:193], v[160:161], v[164:165]
    v_pk_fma_f32 v[194:195], v[194:195], v[162:163], v[166:167]
    v_cvt_pk_bf16_f32 v232, v192, v193
    v_cvt_pk_bf16_f32 v233, v194, v195
    ds_write_b64 v220, v[232:233] offset:18432
    v_pk_fma_f32 v[196:197], v[196:197], v[160:161], v[164:165]
    v_pk_fma_f32 v[198:199], v[198:199], v[162:163], v[166:167]
    v_cvt_pk_bf16_f32 v234, v196, v197
    v_cvt_pk_bf16_f32 v235, v198, v199
    ds_write_b64 v220, v[234:235] offset:23040
    v_pk_fma_f32 v[200:201], v[200:201], v[160:161], v[164:165]
    v_pk_fma_f32 v[202:203], v[202:203], v[162:163], v[166:167]
    v_cvt_pk_bf16_f32 v236, v200, v201
    v_cvt_pk_bf16_f32 v237, v202, v203
    ds_write_b64 v220, v[236:237] offset:27648
    v_pk_fma_f32 v[204:205], v[204:205], v[160:161], v[164:165]
    v_pk_fma_f32 v[206:207], v[206:207], v[162:163], v[166:167]
    v_cvt_pk_bf16_f32 v238, v204, v205
    v_cvt_pk_bf16_f32 v239, v206, v207
    ds_write_b64 v220, v[238:239] offset:32256
    s_waitcnt lgkmcnt(0)
    s_barrier
    s_cmp_lg_u32 s56, 0
    s_cbranch_scc1 L_conv_noack
    s_lshl_b32 s6, s57, 2
    s_add_u32 s6, s6, 2048
    v_mov_b32 v10, s6
    v_mov_b32 v11, s60
    s_mov_b64 exec, 1
    buffer_store_dword v11, v10, s[40:43], 0 offen sc1
    s_mov_b64 exec, -1
L_conv_noack:
    ds_read_b128 v[176:179], v7 offset:448
    ds_read_b128 v[180:183], v7 offset:432
    ds_read_b64 v[248:249], v8 offset:2048
    s_waitcnt lgkmcnt(2)
    v_mfma_f32_16x16x32_bf16 v[212:215], v[176:179], v[128:131], 0
    ds_read_b128 v[184:187], v7 offset:960
    ds_read_b128 v[188:191], v7 offset:944
    v_mfma_f32_16x16x32_bf16 v[216:219], v[176:179], v[132:135], 0
    ds_read_b64 v[250:251], v8 offset:2560
    s_waitcnt lgkmcnt(4)
    v_mfma_f32_16x16x32_bf16 v[204:207], v[180:183], v[128:131], 0
    s_waitcnt lgkmcnt(3)
    v_lshlrev_b32 v160, 16, v248
    v_and_b32 v161, 0xffff0000, v248
    v_lshlrev_b32 v162, 16, v249
    v_and_b32 v163, 0xffff0000, v249
    v_mfma_f32_16x16x32_bf16 v[208:211], v[180:183], v[132:135], 0
    ds_read_b64 v[244:245], v8 offset:1024
    ds_read_b64 v[246:247], v8 offset:1536
    v_mfma_f32_16x16x32_bf16 v[160:163], v[124:127], v[176:179], v[160:163]
    ds_read_b64 v[252:253], v8 offset:3072
    ds_read2_b32 v[108:109], v15 offset0:131 offset1:130
    v_mfma_f32_16x16x32_bf16 v[224:227], v[176:179], v[140:143], 0
    s_waitcnt lgkmcnt(4)
    v_lshlrev_b32 v164, 16, v250
    v_mfma_f32_16x16x32_bf16 v[220:223], v[180:183], v[136:139], 0
    v_cvt_pk_bf16_f32 v232, v212, v216
    v_cvt_pk_bf16_f32 v233, v213, v217
    v_cvt_pk_bf16_f32 v234, v214, v218
    v_cvt_pk_bf16_f32 v235, v215, v219
    v_mfma_f32_16x16x32_bf16 v[212:215], v[184:187], v[128:131], 0
    v_and_b32 v165, 0xffff0000, v250
    v_lshlrev_b32 v166, 16, v251
    v_mfma_f32_16x16x32_bf16 v[216:219], v[184:187], v[132:135], 0
    v_cvt_pk_bf16_f32 v228, v204, v208
    v_cvt_pk_bf16_f32 v229, v205, v209
    v_cvt_pk_bf16_f32 v230, v206, v210
    v_cvt_pk_bf16_f32 v231, v207, v211
    v_mfma_f32_16x16x32_bf16 v[204:207], v[188:191], v[128:131], 0
    v_and_b32 v167, 0xffff0000, v251
    ds_read2_b32 v[110:111], v15 offset0:129 offset1:128
    v_mfma_f32_16x16x32_bf16 v[208:211], v[188:191], v[132:135], 0
    s_waitcnt lgkmcnt(1)
    v_lshlrev_b32 v152, 16, v244
    v_mfma_f32_16x16x32_bf16 v[164:167], v[124:127], v[184:187], v[164:167]
    v_cvt_pk_bf16_f32 v236, v220, v224
    v_cvt_pk_bf16_f32 v237, v221, v225
    v_cvt_pk_bf16_f32 v238, v222, v226
    v_cvt_pk_bf16_f32 v239, v223, v227
    v_mfma_f32_16x16x32_bf16 v[224:227], v[184:187], v[140:143], 0
    v_and_b32 v153, 0xffff0000, v244
    v_lshlrev_b32 v154, 16, v245
    v_and_b32 v155, 0xffff0000, v245
    v_mfma_f32_16x16x32_bf16 v[220:223], v[188:191], v[136:139], 0
    v_lshlrev_b32 v156, 16, v246
    v_and_b32 v157, 0xffff0000, v246
    v_lshlrev_b32 v158, 16, v247
    v_and_b32 v159, 0xffff0000, v247
    ds_read_b64 v[254:255], v8 offset:3584
    v_mfma_f32_16x16x32_bf16 v[152:155], v[232:235], v[96:99], v[152:155]
    ds_read2_b32 v[112:113], v15 offset0:147 offset1:146
    ds_read2_b32 v[114:115], v15 offset0:145 offset1:144
    v_mfma_f32_16x16x32_bf16 v[156:159], v[232:235], v[100:103], v[156:159]
    ds_read2_b32 v[116:117], v15 offset0:163 offset1:162
    ds_read2_b32 v[118:119], v15 offset0:161 offset1:160
    v_mfma_f32_16x16x32_bf16 v[160:163], v[232:235], v[104:107], v[160:163]
    ds_read2_b32 v[120:121], v15 offset0:179 offset1:178
    ds_read2_b32 v[122:123], v15 offset0:177 offset1:176
    v_mfma_f32_16x16x32_bf16 v[152:155], v[228:231], v[84:87], v[152:155]
    ds_read_b128 v[176:179], v7 offset:1472
    ds_read_b128 v[180:183], v7 offset:1456
    v_mfma_f32_16x16x32_bf16 v[156:159], v[228:231], v[88:91], v[156:159]
    v_lshlrev_b32 v168, 16, v252
    v_and_b32 v169, 0xffff0000, v252
    v_mfma_f32_16x16x32_bf16 v[160:163], v[228:231], v[92:95], v[160:163]
    v_lshlrev_b32 v170, 16, v253
    s_waitcnt lgkmcnt(6)
    v_mfma_f32_16x16x32_bf16 v[160:163], v[236:239], v[108:111], v[160:163]
    v_and_b32 v171, 0xffff0000, v253
    v_lshlrev_b32 v172, 16, v254
    v_mfma_f32_16x16x32_bf16 v[164:167], v[236:239], v[112:115], v[164:167]
    v_and_b32 v173, 0xffff0000, v254
    v_lshlrev_b32 v174, 16, v255
    v_and_b32 v175, 0xffff0000, v255
    s_waitcnt lgkmcnt(2)
    v_mfma_f32_16x16x32_bf16 v[168:171], v[236:239], v[116:119], v[168:171]
    v_cvt_pk_bf16_f32 v232, v212, v216
    v_cvt_pk_bf16_f32 v233, v213, v217
    v_mfma_f32_16x16x32_bf16 v[172:175], v[236:239], v[120:123], v[172:175]
    v_cvt_pk_bf16_f32 v234, v214, v218
    v_cvt_pk_bf16_f32 v235, v215, v219
    s_waitcnt lgkmcnt(0)
    v_mfma_f32_16x16x32_bf16 v[212:215], v[176:179], v[128:131], 0
    v_cvt_pk_bf16_f32 v228, v204, v208
    v_cvt_pk_bf16_f32 v229, v205, v209
    v_mfma_f32_16x16x32_bf16 v[216:219], v[176:179], v[132:135], 0
    v_cvt_pk_bf16_f32 v230, v206, v210
    v_cvt_pk_bf16_f32 v231, v207, v211
    v_mfma_f32_16x16x32_bf16 v[204:207], v[180:183], v[128:131], 0
    v_cvt_pk_bf16_f32 v236, v220, v224
    v_cvt_pk_bf16_f32 v237, v221, v225
    v_mfma_f32_16x16x32_bf16 v[208:211], v[180:183], v[132:135], 0
    v_cvt_pk_bf16_f32 v238, v222, v226
    v_cvt_pk_bf16_f32 v239, v223, v227
    v_mfma_f32_16x16x32_bf16 v[168:171], v[124:127], v[176:179], v[168:171]
    ds_read_b128 v[184:187], v7 offset:1984
    ds_read_b128 v[188:191], v7 offset:1968
    v_mfma_f32_16x16x32_bf16 v[224:227], v[176:179], v[140:143], 0
    ds_read_b64 v[240:241], v8 offset:0
    ds_read_b64 v[242:243], v8 offset:512
    v_mfma_f32_16x16x32_bf16 v[220:223], v[180:183], v[136:139], 0
    ds_read_b128 v[176:179], v7 offset:2496
    ds_read_b128 v[180:183], v7 offset:2480
    v_mfma_f32_16x16x32_bf16 v[156:159], v[232:235], v[96:99], v[156:159]
    ds_read2_b32 v[44:45], v12 offset0:230 offset1:228
    ds_read2_b32 v[46:47], v12 offset0:226 offset1:224
    v_mfma_f32_16x16x32_bf16 v[160:163], v[232:235], v[100:103], v[160:163]
    ds_read2_b32 v[76:77], v13 offset0:230 offset1:228
    ds_read2_b32 v[78:79], v13 offset0:226 offset1:224
    v_mfma_f32_16x16x32_bf16 v[164:167], v[232:235], v[104:107], v[164:167]
    v_cvt_pk_bf16_f32 v232, v212, v216
    v_cvt_pk_bf16_f32 v233, v213, v217
    v_mfma_f32_16x16x32_bf16 v[156:159], v[228:231], v[84:87], v[156:159]
    v_cvt_pk_bf16_f32 v234, v214, v218
    v_cvt_pk_bf16_f32 v235, v215, v219
    v_mfma_f32_16x16x32_bf16 v[160:163], v[228:231], v[88:91], v[160:163]
    ds_read2_b32 v[40:41], v12 offset0:198 offset1:196
    ds_read2_b32 v[42:43], v12 offset0:194 offset1:192
    v_mfma_f32_16x16x32_bf16 v[164:167], v[228:231], v[92:95], v[164:167]
    v_cvt_pk_bf16_f32 v228, v204, v208
    v_cvt_pk_bf16_f32 v229, v205, v209
    v_mfma_f32_16x16x32_bf16 v[164:167], v[236:239], v[108:111], v[164:167]
    v_cvt_pk_bf16_f32 v230, v206, v210
    v_cvt_pk_bf16_f32 v231, v207, v211
    v_mfma_f32_16x16x32_bf16 v[168:171], v[236:239], v[112:115], v[168:171]
    ds_read2_b32 v[72:73], v13 offset0:198 offset1:196
    ds_read2_b32 v[74:75], v13 offset0:194 offset1:192
    v_mfma_f32_16x16x32_bf16 v[172:175], v[236:239], v[116:119], v[172:175]
    v_cvt_pk_bf16_f32 v236, v220, v224
    s_waitcnt lgkmcnt(4)
    v_mfma_f32_16x16x32_bf16 v[212:215], v[184:187], v[128:131], 0
    v_cvt_pk_bf16_f32 v237, v221, v225
    v_cvt_pk_bf16_f32 v238, v222, v226
    v_mfma_f32_16x16x32_bf16 v[216:219], v[184:187], v[132:135], 0
    v_cvt_pk_bf16_f32 v239, v223, v227
    ds_read2_b32 v[36:37], v12 offset0:166 offset1:164
    v_mfma_f32_16x16x32_bf16 v[204:207], v[188:191], v[128:131], 0
    ds_read2_b32 v[38:39], v12 offset0:162 offset1:160
    ds_read2_b32 v[68:69], v13 offset0:166 offset1:164
    v_mfma_f32_16x16x32_bf16 v[208:211], v[188:191], v[132:135], 0
    ds_read2_b32 v[70:71], v13 offset0:162 offset1:160
    v_lshlrev_b32 v144, 16, v240
    v_mfma_f32_16x16x32_bf16 v[172:175], v[124:127], v[184:187], v[172:175]
    v_and_b32 v145, 0xffff0000, v240
    v_lshlrev_b32 v146, 16, v241
    v_mfma_f32_16x16x32_bf16 v[224:227], v[184:187], v[140:143], 0
    v_and_b32 v147, 0xffff0000, v241
    ds_read2_b32 v[32:33], v12 offset0:134 offset1:132
    v_mfma_f32_16x16x32_bf16 v[220:223], v[188:191], v[136:139], 0
    ds_read_b128 v[184:187], v7 offset:3008
    ds_read_b128 v[188:191], v7 offset:2992
    v_mfma_f32_16x16x32_bf16 v[160:163], v[232:235], v[96:99], v[160:163]
    ds_read2_b32 v[34:35], v12 offset0:130 offset1:128
    v_lshlrev_b32 v148, 16, v242
    v_mfma_f32_16x16x32_bf16 v[164:167], v[232:235], v[100:103], v[164:167]
    v_and_b32 v149, 0xffff0000, v242
    v_lshlrev_b32 v150, 16, v243
    v_mfma_f32_16x16x32_bf16 v[168:171], v[232:235], v[104:107], v[168:171]
    v_cvt_pk_bf16_f32 v232, v212, v216
    v_cvt_pk_bf16_f32 v233, v213, v217
    v_mfma_f32_16x16x32_bf16 v[160:163], v[228:231], v[84:87], v[160:163]
    v_cvt_pk_bf16_f32 v234, v214, v218
    v_cvt_pk_bf16_f32 v235, v215, v219
    v_mfma_f32_16x16x32_bf16 v[164:167], v[228:231], v[88:91], v[164:167]
    v_and_b32 v151, 0xffff0000, v243
    ds_read2_b32 v[64:65], v13 offset0:134 offset1:132
    v_mfma_f32_16x16x32_bf16 v[168:171], v[228:231], v[92:95], v[168:171]
    v_cvt_pk_bf16_f32 v228, v204, v208
    v_cvt_pk_bf16_f32 v229, v205, v209
    v_mfma_f32_16x16x32_bf16 v[168:171], v[236:239], v[108:111], v[168:171]
    v_cvt_pk_bf16_f32 v230, v206, v210
    v_cvt_pk_bf16_f32 v231, v207, v211
    v_mfma_f32_16x16x32_bf16 v[172:175], v[236:239], v[112:115], v[172:175]
    v_cvt_pk_bf16_f32 v236, v220, v224
    v_cvt_pk_bf16_f32 v237, v221, v225
    v_mfma_f32_16x16x32_bf16 v[212:215], v[176:179], v[128:131], 0
    v_cvt_pk_bf16_f32 v238, v222, v226
    v_cvt_pk_bf16_f32 v239, v223, v227
    v_mfma_f32_16x16x32_bf16 v[216:219], v[176:179], v[132:135], 0
    ds_read2_b32 v[66:67], v13 offset0:130 offset1:128
    ds_read2_b32 v[28:29], v12 offset0:102 offset1:100
    v_mfma_f32_16x16x32_bf16 v[204:207], v[180:183], v[128:131], 0
    ds_read2_b32 v[30:31], v12 offset0:98 offset1:96
    ds_read2_b32 v[60:61], v13 offset0:102 offset1:100
    v_mfma_f32_16x16x32_bf16 v[208:211], v[180:183], v[132:135], 0
    ds_read_b128 v[176:179], v7 offset:0
    ds_read_b128 v[180:183], v7 offset:64
    v_mfma_f32_16x16x32_bf16 v[164:167], v[232:235], v[96:99], v[164:167]
    ds_read2_b32 v[62:63], v13 offset0:98 offset1:96
    ds_read2_b32 v[24:25], v12 offset0:70 offset1:68
    v_mfma_f32_16x16x32_bf16 v[168:171], v[232:235], v[100:103], v[168:171]
    ds_read2_b32 v[26:27], v12 offset0:66 offset1:64
    ds_read2_b32 v[56:57], v13 offset0:70 offset1:68
    v_mfma_f32_16x16x32_bf16 v[172:175], v[232:235], v[104:107], v[172:175]
    ds_read2_b32 v[58:59], v13 offset0:66 offset1:64
    ds_read2_b32 v[20:21], v12 offset0:38 offset1:36
    v_mfma_f32_16x16x32_bf16 v[164:167], v[228:231], v[84:87], v[164:167]
    ds_read2_b32 v[22:23], v12 offset0:34 offset1:32
    ds_read2_b32 v[52:53], v13 offset0:38 offset1:36
    v_mfma_f32_16x16x32_bf16 v[168:171], v[228:231], v[88:91], v[168:171]
    v_cvt_pk_bf16_f32 v232, v212, v216
    v_cvt_pk_bf16_f32 v233, v213, v217
    v_mfma_f32_16x16x32_bf16 v[172:175], v[228:231], v[92:95], v[172:175]
    v_cvt_pk_bf16_f32 v234, v214, v218
    v_cvt_pk_bf16_f32 v235, v215, v219
    v_mfma_f32_16x16x32_bf16 v[172:175], v[236:239], v[108:111], v[172:175]
    v_cvt_pk_bf16_f32 v228, v204, v208
    s_waitcnt lgkmcnt(4)
    v_mfma_f32_16x16x32_bf16 v[212:215], v[184:187], v[128:131], 0
    v_cvt_pk_bf16_f32 v229, v205, v209
    v_cvt_pk_bf16_f32 v230, v206, v210
    v_mfma_f32_16x16x32_bf16 v[216:219], v[184:187], v[132:135], 0
    v_cvt_pk_bf16_f32 v231, v207, v211
    ds_read2_b32 v[54:55], v13 offset0:34 offset1:32
    v_mfma_f32_16x16x32_bf16 v[204:207], v[188:191], v[128:131], 0
    ds_read2_b32 v[16:17], v12 offset0:6 offset1:4
    ds_read2_b32 v[18:19], v12 offset0:2 offset1:0
    v_mfma_f32_16x16x32_bf16 v[208:211], v[188:191], v[132:135], 0
    ds_read_b128 v[184:187], v7 offset:128
    ds_read_b128 v[188:191], v7 offset:192
    v_mfma_f32_16x16x32_bf16 v[168:171], v[232:235], v[96:99], v[168:171]
    ds_read_b128 v[192:195], v7 offset:256
    ds_read_b128 v[196:199], v7 offset:320
    v_mfma_f32_16x16x32_bf16 v[172:175], v[232:235], v[100:103], v[172:175]
    ds_read2_b32 v[48:49], v13 offset0:6 offset1:4
    ds_read2_b32 v[50:51], v13 offset0:2 offset1:0
    v_mfma_f32_16x16x32_bf16 v[168:171], v[228:231], v[84:87], v[168:171]
    v_cvt_pk_bf16_f32 v232, v212, v216
    v_cvt_pk_bf16_f32 v233, v213, v217
    v_cvt_pk_bf16_f32 v234, v214, v218
    v_cvt_pk_bf16_f32 v235, v215, v219
    v_mfma_f32_16x16x32_bf16 v[172:175], v[228:231], v[88:91], v[172:175]
    v_cvt_pk_bf16_f32 v228, v204, v208
    v_cvt_pk_bf16_f32 v229, v205, v209
    v_cvt_pk_bf16_f32 v230, v206, v210
    v_cvt_pk_bf16_f32 v231, v207, v211
    v_mfma_f32_16x16x32_bf16 v[172:175], v[232:235], v[96:99], v[172:175]
    ds_read2_b32 v[80:81], v14 offset0:6 offset1:4
    ds_read2_b32 v[82:83], v14 offset0:2 offset1:0
    v_mfma_f32_16x16x32_bf16 v[172:175], v[228:231], v[84:87], v[172:175]
    v_mfma_f32_16x16x32_bf16 v[144:147], v[44:47], v[176:179], v[144:147]
    v_mfma_f32_16x16x32_bf16 v[148:151], v[76:79], v[176:179], v[148:151]
    ds_read_b128 v[176:179], v7 offset:384
    v_mfma_f32_16x16x32_bf16 v[144:147], v[40:43], v[180:183], v[144:147]
    v_mfma_f32_16x16x32_bf16 v[148:151], v[72:75], v[180:183], v[148:151]
    ds_read_b128 v[180:183], v7 offset:448
    s_waitcnt lgkmcnt(2)
    v_mfma_f32_16x16x32_bf16 v[144:147], v[36:39], v[184:187], v[144:147]
    v_mfma_f32_16x16x32_bf16 v[148:151], v[68:71], v[184:187], v[148:151]
    ds_read_b128 v[184:187], v7 offset:512
    v_mfma_f32_16x16x32_bf16 v[144:147], v[32:35], v[188:191], v[144:147]
    v_mfma_f32_16x16x32_bf16 v[148:151], v[64:67], v[188:191], v[148:151]
    ds_read_b128 v[188:191], v7 offset:576
    v_mfma_f32_16x16x32_bf16 v[144:147], v[28:31], v[192:195], v[144:147]
    v_mfma_f32_16x16x32_bf16 v[148:151], v[60:63], v[192:195], v[148:151]
    ds_read_b128 v[192:195], v7 offset:640
    v_mfma_f32_16x16x32_bf16 v[144:147], v[24:27], v[196:199], v[144:147]
    v_mfma_f32_16x16x32_bf16 v[148:151], v[56:59], v[196:199], v[148:151]
    ds_read_b128 v[196:199], v7 offset:704
    s_waitcnt lgkmcnt(3)
    v_mfma_f32_16x16x32_bf16 v[144:147], v[20:23], v[176:179], v[144:147]
    v_mfma_f32_16x16x32_bf16 v[148:151], v[52:55], v[176:179], v[148:151]
    ds_read_b128 v[176:179], v7 offset:768
    v_mfma_f32_16x16x32_bf16 v[144:147], v[16:19], v[180:183], v[144:147]
    v_mfma_f32_16x16x32_bf16 v[148:151], v[48:51], v[180:183], v[148:151]
    v_mfma_f32_16x16x32_bf16 v[152:155], v[80:83], v[180:183], v[152:155]
    ds_read_b128 v[180:183], v7 offset:832
    v_mfma_f32_16x16x32_bf16 v[148:151], v[44:47], v[184:187], v[148:151]
    v_mfma_f32_16x16x32_bf16 v[152:155], v[76:79], v[184:187], v[152:155]
    ds_read_b128 v[184:187], v7 offset:896
    s_waitcnt lgkmcnt(2)
    v_mfma_f32_16x16x32_bf16 v[148:151], v[40:43], v[188:191], v[148:151]
    v_mfma_f32_16x16x32_bf16 v[152:155], v[72:75], v[188:191], v[152:155]
    ds_read_b128 v[188:191], v7 offset:960
    v_mfma_f32_16x16x32_bf16 v[148:151], v[36:39], v[192:195], v[148:151]
    v_cvt_pk_bf16_f32 v10, v144, v145
    v_cvt_pk_bf16_f32 v11, v146, v147
    v_mfma_f32_16x16x32_bf16 v[152:155], v[68:71], v[192:195], v[152:155]
    ds_write_b64 v8, v[10:11] offset:0
    ds_read_b128 v[192:195], v7 offset:1024
    v_mfma_f32_16x16x32_bf16 v[148:151], v[32:35], v[196:199], v[148:151]
    v_mfma_f32_16x16x32_bf16 v[152:155], v[64:67], v[196:199], v[152:155]
    ds_read_b128 v[196:199], v7 offset:1088
    v_mfma_f32_16x16x32_bf16 v[148:151], v[28:31], v[176:179], v[148:151]
    v_mfma_f32_16x16x32_bf16 v[152:155], v[60:63], v[176:179], v[152:155]
    ds_read_b128 v[176:179], v7 offset:1152
    s_waitcnt lgkmcnt(4)
    v_mfma_f32_16x16x32_bf16 v[148:151], v[24:27], v[180:183], v[148:151]
    v_mfma_f32_16x16x32_bf16 v[152:155], v[56:59], v[180:183], v[152:155]
    ds_read_b128 v[180:183], v7 offset:1216
    v_mfma_f32_16x16x32_bf16 v[148:151], v[20:23], v[184:187], v[148:151]
    v_mfma_f32_16x16x32_bf16 v[152:155], v[52:55], v[184:187], v[152:155]
    ds_read_b128 v[184:187], v7 offset:1280
    v_mfma_f32_16x16x32_bf16 v[148:151], v[16:19], v[188:191], v[148:151]
    v_mfma_f32_16x16x32_bf16 v[152:155], v[48:51], v[188:191], v[152:155]
    v_mfma_f32_16x16x32_bf16 v[156:159], v[80:83], v[188:191], v[156:159]
    ds_read_b128 v[188:191], v7 offset:1344
    s_waitcnt lgkmcnt(2)
    v_mfma_f32_16x16x32_bf16 v[152:155], v[44:47], v[192:195], v[152:155]
    v_mfma_f32_16x16x32_bf16 v[156:159], v[76:79], v[192:195], v[156:159]
    ds_read_b128 v[192:195], v7 offset:1408
    v_mfma_f32_16x16x32_bf16 v[152:155], v[40:43], v[196:199], v[152:155]
    v_mfma_f32_16x16x32_bf16 v[156:159], v[72:75], v[196:199], v[156:159]
    ds_read_b128 v[196:199], v7 offset:1472
    v_mfma_f32_16x16x32_bf16 v[152:155], v[36:39], v[176:179], v[152:155]
    v_cvt_pk_bf16_f32 v10, v148, v149
    v_cvt_pk_bf16_f32 v11, v150, v151
    v_mfma_f32_16x16x32_bf16 v[156:159], v[68:71], v[176:179], v[156:159]
    ds_write_b64 v8, v[10:11] offset:512
    ds_read_b128 v[176:179], v7 offset:1536
    v_mfma_f32_16x16x32_bf16 v[152:155], v[32:35], v[180:183], v[152:155]
    v_mfma_f32_16x16x32_bf16 v[156:159], v[64:67], v[180:183], v[156:159]
    ds_read_b128 v[180:183], v7 offset:1600
    s_waitcnt lgkmcnt(4)
    v_mfma_f32_16x16x32_bf16 v[152:155], v[28:31], v[184:187], v[152:155]
    v_mfma_f32_16x16x32_bf16 v[156:159], v[60:63], v[184:187], v[156:159]
    ds_read_b128 v[184:187], v7 offset:1664
    v_mfma_f32_16x16x32_bf16 v[152:155], v[24:27], v[188:191], v[152:155]
    s_waitcnt lgkmcnt(3)
    s_barrier
    v_mfma_f32_16x16x32_bf16 v[156:159], v[56:59], v[188:191], v[156:159]
    ds_read_b64_tr_b16 v[12:13], v4 offset:0
    ds_read_b64_tr_b16 v[14:15], v4 offset:16640
    v_mfma_f32_16x16x32_bf16 v[152:155], v[20:23], v[192:195], v[152:155]
    ds_read_b128 v[188:191], v7 offset:1728
    v_mfma_f32_16x16x32_bf16 v[156:159], v[52:55], v[192:195], v[156:159]
    ds_read_b128 v[192:195], v7 offset:1792
    v_mfma_f32_16x16x32_bf16 v[152:155], v[16:19], v[196:199], v[152:155]
    v_mfma_f32_16x16x32_bf16 v[156:159], v[48:51], v[196:199], v[156:159]
    v_mfma_f32_16x16x32_bf16 v[160:163], v[80:83], v[196:199], v[160:163]
    ds_read_b128 v[196:199], v7 offset:1856
    s_waitcnt lgkmcnt(3)
    v_mfma_f32_16x16x32_bf16 v[156:159], v[44:47], v[176:179], v[156:159]
    buffer_store_dwordx4 v[12:15], v5, s[44:47], 0 offen
    v_mfma_f32_16x16x32_bf16 v[160:163], v[76:79], v[176:179], v[160:163]
    ds_read_b128 v[176:179], v7 offset:1920
    v_mfma_f32_16x16x32_bf16 v[156:159], v[40:43], v[180:183], v[156:159]
    v_mfma_f32_16x16x32_bf16 v[160:163], v[72:75], v[180:183], v[160:163]
    ds_read_b128 v[180:183], v7 offset:1984
    v_mfma_f32_16x16x32_bf16 v[156:159], v[36:39], v[184:187], v[156:159]
    v_cvt_pk_bf16_f32 v10, v152, v153
    v_cvt_pk_bf16_f32 v11, v154, v155
    v_mfma_f32_16x16x32_bf16 v[160:163], v[68:71], v[184:187], v[160:163]
    ds_write_b64 v8, v[10:11] offset:1024
    s_waitcnt lgkmcnt(3)
    v_mfma_f32_16x16x32_bf16 v[156:159], v[32:35], v[188:191], v[156:159]
    ds_read_b128 v[184:187], v7 offset:2048
    v_mfma_f32_16x16x32_bf16 v[160:163], v[64:67], v[188:191], v[160:163]
    ds_read_b128 v[188:191], v7 offset:2112
    v_mfma_f32_16x16x32_bf16 v[156:159], v[28:31], v[192:195], v[156:159]
    v_mfma_f32_16x16x32_bf16 v[160:163], v[60:63], v[192:195], v[160:163]
    ds_read_b128 v[192:195], v7 offset:2176
    v_mfma_f32_16x16x32_bf16 v[156:159], v[24:27], v[196:199], v[156:159]
    v_mfma_f32_16x16x32_bf16 v[160:163], v[56:59], v[196:199], v[160:163]
    ds_read_b128 v[196:199], v7 offset:2240
    s_waitcnt lgkmcnt(3)
    v_mfma_f32_16x16x32_bf16 v[156:159], v[20:23], v[176:179], v[156:159]
    v_mfma_f32_16x16x32_bf16 v[160:163], v[52:55], v[176:179], v[160:163]
    ds_read_b128 v[176:179], v7 offset:2304
    v_mfma_f32_16x16x32_bf16 v[156:159], v[16:19], v[180:183], v[156:159]
    v_mfma_f32_16x16x32_bf16 v[160:163], v[48:51], v[180:183], v[160:163]
    v_mfma_f32_16x16x32_bf16 v[164:167], v[80:83], v[180:183], v[164:167]
    ds_read_b128 v[180:183], v7 offset:2368
    v_mfma_f32_16x16x32_bf16 v[160:163], v[44:47], v[184:187], v[160:163]
    v_mfma_f32_16x16x32_bf16 v[164:167], v[76:79], v[184:187], v[164:167]
    ds_read_b128 v[184:187], v7 offset:2432
    s_waitcnt lgkmcnt(2)
    v_mfma_f32_16x16x32_bf16 v[160:163], v[40:43], v[188:191], v[160:163]
    v_mfma_f32_16x16x32_bf16 v[164:167], v[72:75], v[188:191], v[164:167]
    ds_read_b128 v[188:191], v7 offset:2496
    v_mfma_f32_16x16x32_bf16 v[160:163], v[36:39], v[192:195], v[160:163]
    v_cvt_pk_bf16_f32 v10, v156, v157
    v_cvt_pk_bf16_f32 v11, v158, v159
    v_mfma_f32_16x16x32_bf16 v[164:167], v[68:71], v[192:195], v[164:167]
    ds_write_b64 v8, v[10:11] offset:1536
    ds_read_b128 v[192:195], v7 offset:2560
    v_mfma_f32_16x16x32_bf16 v[160:163], v[32:35], v[196:199], v[160:163]
    v_mfma_f32_16x16x32_bf16 v[164:167], v[64:67], v[196:199], v[164:167]
    ds_read_b128 v[196:199], v7 offset:2624
    v_mfma_f32_16x16x32_bf16 v[160:163], v[28:31], v[176:179], v[160:163]
    v_mfma_f32_16x16x32_bf16 v[164:167], v[60:63], v[176:179], v[164:167]
    ds_read_b128 v[176:179], v7 offset:2688
    s_waitcnt lgkmcnt(4)
    v_mfma_f32_16x16x32_bf16 v[160:163], v[24:27], v[180:183], v[160:163]
    buffer_load_dwordx4 v[108:111], v6, s[40:43], 0 offen sc1
    v_mfma_f32_16x16x32_bf16 v[164:167], v[56:59], v[180:183], v[164:167]
    s_waitcnt lgkmcnt(2)
    s_barrier
    v_mfma_f32_16x16x32_bf16 v[160:163], v[20:23], v[184:187], v[160:163]
    ds_read_b64_tr_b16 v[12:13], v4 offset:1024
    ds_read_b64_tr_b16 v[14:15], v4 offset:17664
    v_mfma_f32_16x16x32_bf16 v[164:167], v[52:55], v[184:187], v[164:167]
    ds_read_b128 v[180:183], v7 offset:2752
    ds_read_b128 v[184:187], v7 offset:2816
    v_mfma_f32_16x16x32_bf16 v[160:163], v[16:19], v[188:191], v[160:163]
    v_mfma_f32_16x16x32_bf16 v[164:167], v[48:51], v[188:191], v[164:167]
    v_mfma_f32_16x16x32_bf16 v[168:171], v[80:83], v[188:191], v[168:171]
    ds_read_b128 v[188:191], v7 offset:2880
    v_mfma_f32_16x16x32_bf16 v[164:167], v[44:47], v[192:195], v[164:167]
    s_waitcnt lgkmcnt(3)
    buffer_store_dwordx4 v[12:15], v5, s[44:47], s50 offen
    v_mfma_f32_16x16x32_bf16 v[168:171], v[76:79], v[192:195], v[168:171]
    ds_read_b128 v[192:195], v7 offset:2944
    v_mfma_f32_16x16x32_bf16 v[164:167], v[40:43], v[196:199], v[164:167]
    v_mfma_f32_16x16x32_bf16 v[168:171], v[72:75], v[196:199], v[168:171]
    ds_read_b128 v[196:199], v7 offset:3008
    v_mfma_f32_16x16x32_bf16 v[164:167], v[36:39], v[176:179], v[164:167]
    v_cvt_pk_bf16_f32 v10, v160, v161
    v_cvt_pk_bf16_f32 v11, v162, v163
    v_mfma_f32_16x16x32_bf16 v[168:171], v[68:71], v[176:179], v[168:171]
    ds_write_b64 v8, v[10:11] offset:2048
    s_waitcnt lgkmcnt(3)
    v_mfma_f32_16x16x32_bf16 v[164:167], v[32:35], v[180:183], v[164:167]
    ds_read_b128 v[176:179], v7 offset:3072
    v_mfma_f32_16x16x32_bf16 v[168:171], v[64:67], v[180:183], v[168:171]
    ds_read_b128 v[180:183], v7 offset:3136
    v_mfma_f32_16x16x32_bf16 v[164:167], v[28:31], v[184:187], v[164:167]
    v_mfma_f32_16x16x32_bf16 v[168:171], v[60:63], v[184:187], v[168:171]
    ds_read_b128 v[184:187], v7 offset:3200
    v_mfma_f32_16x16x32_bf16 v[164:167], v[24:27], v[188:191], v[164:167]
    v_mfma_f32_16x16x32_bf16 v[168:171], v[56:59], v[188:191], v[168:171]
    ds_read_b128 v[188:191], v7 offset:3264
    s_waitcnt lgkmcnt(3)
    v_mfma_f32_16x16x32_bf16 v[164:167], v[20:23], v[192:195], v[164:167]
    v_mfma_f32_16x16x32_bf16 v[168:171], v[52:55], v[192:195], v[168:171]
    ds_read_b128 v[192:195], v7 offset:3328
    v_mfma_f32_16x16x32_bf16 v[164:167], v[16:19], v[196:199], v[164:167]
    v_mfma_f32_16x16x32_bf16 v[168:171], v[48:51], v[196:199], v[168:171]
    v_mfma_f32_16x16x32_bf16 v[172:175], v[80:83], v[196:199], v[172:175]
    ds_read_b128 v[196:199], v7 offset:3392
    v_mfma_f32_16x16x32_bf16 v[168:171], v[44:47], v[176:179], v[168:171]
    v_mfma_f32_16x16x32_bf16 v[172:175], v[76:79], v[176:179], v[172:175]
    ds_read_b128 v[176:179], v7 offset:3456
    s_waitcnt lgkmcnt(2)
    v_mfma_f32_16x16x32_bf16 v[168:171], v[40:43], v[180:183], v[168:171]
    v_mfma_f32_16x16x32_bf16 v[172:175], v[72:75], v[180:183], v[172:175]
    ds_read_b128 v[180:183], v7 offset:3520
    v_mfma_f32_16x16x32_bf16 v[168:171], v[36:39], v[184:187], v[168:171]
    v_cvt_pk_bf16_f32 v10, v164, v165
    v_cvt_pk_bf16_f32 v11, v166, v167
    v_mfma_f32_16x16x32_bf16 v[172:175], v[68:71], v[184:187], v[172:175]
    ds_read_b128 v[184:187], v7 offset:3584
    ds_write_b64 v8, v[10:11] offset:2560
    v_mfma_f32_16x16x32_bf16 v[168:171], v[32:35], v[188:191], v[168:171]
    v_mfma_f32_16x16x32_bf16 v[172:175], v[64:67], v[188:191], v[172:175]
    ds_read_b128 v[188:191], v7 offset:3648
    v_mfma_f32_16x16x32_bf16 v[168:171], v[28:31], v[192:195], v[168:171]
    v_mfma_f32_16x16x32_bf16 v[172:175], v[60:63], v[192:195], v[172:175]
    ds_read_b128 v[192:195], v7 offset:3712
    s_waitcnt lgkmcnt(4)
    v_mfma_f32_16x16x32_bf16 v[168:171], v[24:27], v[196:199], v[168:171]
    s_waitcnt lgkmcnt(2)
    s_barrier
    v_mfma_f32_16x16x32_bf16 v[172:175], v[56:59], v[196:199], v[172:175]
    ds_read_b128 v[196:199], v7 offset:3776
    ds_read_b64_tr_b16 v[12:13], v4 offset:2048
    v_mfma_f32_16x16x32_bf16 v[168:171], v[20:23], v[176:179], v[168:171]
    ds_read_b64_tr_b16 v[14:15], v4 offset:18688
    v_mfma_f32_16x16x32_bf16 v[172:175], v[52:55], v[176:179], v[172:175]
    ds_read_b128 v[176:179], v7 offset:3840
    v_mfma_f32_16x16x32_bf16 v[168:171], v[16:19], v[180:183], v[168:171]
    v_mfma_f32_16x16x32_bf16 v[172:175], v[48:51], v[180:183], v[172:175]
    ds_read_b128 v[180:183], v7 offset:3904
    v_mfma_f32_16x16x32_bf16 v[172:175], v[44:47], v[184:187], v[172:175]
    ds_read_b128 v[184:187], v7 offset:3968
    s_waitcnt lgkmcnt(4)
    v_mfma_f32_16x16x32_bf16 v[172:175], v[40:43], v[188:191], v[172:175]
    ds_read_b128 v[188:191], v7 offset:4032
    v_mfma_f32_16x16x32_bf16 v[172:175], v[36:39], v[192:195], v[172:175]
    s_waitcnt lgkmcnt(4)
    buffer_store_dwordx4 v[12:15], v5, s[44:47], s51 offen
    v_mfma_f32_16x16x32_bf16 v[172:175], v[32:35], v[196:199], v[172:175]
    s_waitcnt lgkmcnt(3)
    v_mfma_f32_16x16x32_bf16 v[172:175], v[28:31], v[176:179], v[172:175]
    s_waitcnt lgkmcnt(2)
    v_mfma_f32_16x16x32_bf16 v[172:175], v[24:27], v[180:183], v[172:175]
    v_cvt_pk_bf16_f32 v10, v168, v169
    s_waitcnt lgkmcnt(1)
    v_mfma_f32_16x16x32_bf16 v[172:175], v[20:23], v[184:187], v[172:175]
    v_cvt_pk_bf16_f32 v11, v170, v171
    s_waitcnt lgkmcnt(0)
    v_mfma_f32_16x16x32_bf16 v[172:175], v[16:19], v[188:191], v[172:175]
    ds_write_b64 v8, v[10:11] offset:3072
    s_waitcnt vmcnt(2)
    v_cmp_ne_u32 vcc, s60, v111
    s_cbranch_vccz L_conv_selok
    s_mov_b32 s54, 0
L_poll_sel:
    buffer_load_dwordx4 v[108:111], v6, s[40:43], 0 offen sc1
    s_waitcnt vmcnt(0)
    v_xor_b32 v16, s60, v111
    v_cmp_ne_u32 vcc, 0, v16
    s_cbranch_vccz L_polled_sel
    s_add_u32 s54, s54, 1
    s_cmp_ge_u32 s54, 65536
    s_cbranch_scc1 L_polled_sel
    s_sleep 2
    s_branch L_poll_sel
L_polled_sel:
L_conv_selok:
    s_lshl_b32 s6, s57, 11
    s_add_u32 s6, s6, 491520
    v_bfe_u32 v16, v1, 2, 1
    v_lshlrev_b32 v16, 7, v16
    v_and_b32 v17, 3, v1
    v_lshl_add_u32 v16, v17, 2, v16
    v_subrev_u32 v18, 24576, v6
    v_add3_u32 v9, v16, v18, s6
    s_cmp_lg_u32 s56, 0
    s_cbranch_scc1 L_conv_noy
    buffer_load_dword v112, v9, s[40:43], 0 offen offset:0 sc1
    buffer_load_dword v113, v9, s[40:43], 0 offen offset:256 sc1
    buffer_load_dword v114, v9, s[40:43], 0 offen offset:512 sc1
    buffer_load_dword v115, v9, s[40:43], 0 offen offset:768 sc1
    buffer_load_dword v116, v9, s[40:43], 0 offen offset:1024 sc1
    buffer_load_dword v117, v9, s[40:43], 0 offen offset:1280 sc1
    buffer_load_dword v118, v9, s[40:43], 0 offen offset:1536 sc1
    buffer_load_dword v119, v9, s[40:43], 0 offen offset:1792 sc1
L_conv_noy:
    v_cvt_pk_bf16_f32 v10, v172, v173
    v_cvt_pk_bf16_f32 v11, v174, v175
    ds_write_b64 v8, v[10:11] offset:3584
    v_readlane_b32 s8, v108, 0
    v_readlane_b32 s9, v108, 8
    v_readlane_b32 s10, v108, 16
    v_readlane_b32 s11, v108, 24
    v_readlane_b32 s12, v108, 32
    v_readlane_b32 s13, v108, 40
    v_readlane_b32 s14, v108, 48
    v_readlane_b32 s15, v108, 56
    v_add_u32 v16, 1536, v0
    s_mov_b32 s54, 0x300000
    v_cmp_ne_u32 s[16:17], s8, v16
    v_cmp_ne_u32 s[18:19], s9, v16
    v_cmp_ne_u32 s[20:21], s10, v16
    v_cmp_ne_u32 s[22:23], s11, v16
    v_cmp_ne_u32 s[24:25], s12, v16
    v_cmp_ne_u32 s[26:27], s13, v16
    v_cmp_ne_u32 s[28:29], s14, v16
    v_cmp_ne_u32 s[30:31], s15, v16
    s_and_b64 s[16:17], s[16:17], s[18:19]
    s_and_b64 s[20:21], s[20:21], s[22:23]
    s_and_b64 s[24:25], s[24:25], s[26:27]
    s_and_b64 s[28:29], s[28:29], s[30:31]
    s_and_b64 s[16:17], s[16:17], s[20:21]
    s_and_b64 s[24:25], s[24:25], s[28:29]
    s_and_b64 s[16:17], s[16:17], s[24:25]
    s_waitcnt lgkmcnt(0)
    s_barrier
    ds_read_b64_tr_b16 v[12:13], v4 offset:3072
    ds_read_b64_tr_b16 v[14:15], v4 offset:19712
    s_cmp_eq_u32 s56, 0
    s_cbranch_scc1 L_conv_fin
    s_waitcnt lgkmcnt(0)
    s_mov_b64 exec, s[16:17]
    buffer_store_dwordx4 v[12:15], v5, s[44:47], s54 offen
    s_waitcnt vmcnt(1)
    s_barrier
    s_branch L_conv_end
L_conv_fin:
    v_and_b32 v16, 7, v1
    v_mul_u32_u24 v18, 4160, v16
    v_lshl_add_u32 v18, v108, 1, v18
    v_add_u32 v18, 129024, v18
    ds_read_u16 v20, v18
    v_lshlrev_b32 v18, 11, v108
    v_lshl_add_u32 v18, v16, 1, v18
    v_add_u32 v18, s58, v18
    v_lshlrev_b32 v17, 3, v17
    v_lshrrev_b32 v17, v17, s60
    v_mov_b32 v19, 0xff
    s_waitcnt lgkmcnt(1)
    s_mov_b64 exec, s[16:17]
    buffer_store_dwordx4 v[12:15], v5, s[44:47], s54 offen
    s_mov_b64 exec, -1
    s_mov_b32 s54, 0
    s_waitcnt vmcnt(1)
L_conv_y:
    v_bitop3_b32 v24, v112, v113, v17 bitop3:0x7e
    v_bitop3_b32 v25, v114, v115, v17 bitop3:0x7e
    v_bitop3_b32 v26, v116, v117, v17 bitop3:0x7e
    v_bitop3_b32 v27, v118, v119, v17 bitop3:0x7e
    v_or3_b32 v24, v24, v25, v26
    v_bitop3_b32 v24, v24, v27, v19 bitop3:0xa8
    v_cmp_ne_u32 vcc, 0, v24
    s_cbranch_vccz L_conv_yok
    s_add_u32 s54, s54, 1
    s_cmp_ge_u32 s54, 65536
    s_cbranch_scc1 L_conv_yok
    buffer_load_dword v112, v9, s[40:43], 0 offen offset:0 sc1
    buffer_load_dword v113, v9, s[40:43], 0 offen offset:256 sc1
    buffer_load_dword v114, v9, s[40:43], 0 offen offset:512 sc1
    buffer_load_dword v115, v9, s[40:43], 0 offen offset:768 sc1
    buffer_load_dword v116, v9, s[40:43], 0 offen offset:1024 sc1
    buffer_load_dword v117, v9, s[40:43], 0 offen offset:1280 sc1
    buffer_load_dword v118, v9, s[40:43], 0 offen offset:1536 sc1
    buffer_load_dword v119, v9, s[40:43], 0 offen offset:1792 sc1
    s_waitcnt vmcnt(0)
    s_branch L_conv_y
L_conv_yok:
    v_pk_add_f32 v[112:113], v[112:113], v[116:117]
    v_pk_add_f32 v[114:115], v[114:115], v[118:119]
    s_waitcnt lgkmcnt(0)
    v_lshlrev_b32 v20, 16, v20
    v_pk_add_f32 v[112:113], v[112:113], v[114:115]
    v_add_f32 v112, v112, v113
    v_fma_f32 v20, v112, v109, v20
    v_cvt_pk_bf16_f32 v20, v20, v20
    s_barrier
    buffer_store_short v20, v18, s[44:47], 0 offen
L_conv_end:
    s_endpgm
L_code_end:
.p2align 7
L_bands:
.long 0x0, 0x0, 0x0, 0x3f803f80
.long 0x0, 0x0, 0x0, 0x3f800000
.long 0x0, 0x0, 0x0, 0x0
.long 0x0, 0x0, 0x0, 0x0
.long 0x0, 0x0, 0x0, 0x0
.long 0x0, 0x0, 0x0, 0x0
.long 0x0, 0x0, 0x0, 0x0
.long 0x0, 0x0, 0x0, 0x0
.long 0x0, 0x0, 0x0, 0x0
.long 0x0, 0x0, 0x0, 0x0
.long 0x0, 0x0, 0x0, 0x0
.long 0x0, 0x0, 0x0, 0x0
.long 0x0, 0x0, 0x0, 0x0
.long 0x0, 0x0, 0x0, 0x0
.long 0x0, 0x0, 0x0, 0x0
.long 0x0, 0x0, 0x0, 0x0
.long 0x3f803f80, 0x3f80, 0x0, 0x0
.long 0x3f803f80, 0x3f803f80, 0x0, 0x0
.long 0x3f803f80, 0x3f803f80, 0x3f80, 0x0
.long 0x3f800000, 0x3f803f80, 0x3f803f80, 0x0
.long 0x0, 0x3f803f80, 0x3f803f80, 0x3f80
.long 0x0, 0x3f800000, 0x3f803f80, 0x3f803f80
.long 0x0, 0x0, 0x3f803f80, 0x3f803f80
.long 0x0, 0x0, 0x3f800000, 0x3f803f80
.long 0x0, 0x0, 0x0, 0x3f803f80
.long 0x0, 0x0, 0x0, 0x3f800000
.long 0x0, 0x0, 0x0, 0x0
.long 0x0, 0x0, 0x0, 0x0
.long 0x0, 0x0, 0x0, 0x0
.long 0x0, 0x0, 0x0, 0x0
.long 0x0, 0x0, 0x0, 0x0
.long 0x0, 0x0, 0x0, 0x0
.long 0x0, 0x0, 0x0, 0x0
.long 0x0, 0x0, 0x0, 0x0
.long 0x0, 0x0, 0x0, 0x0
.long 0x0, 0x0, 0x0, 0x0
.long 0x0, 0x0, 0x0, 0x0
.long 0x0, 0x0, 0x0, 0x0
.long 0x3f80, 0x0, 0x0, 0x0
.long 0x3f803f80, 0x0, 0x0, 0x0
.long 0x3f803f80, 0x3f80, 0x0, 0x0
.long 0x3f803f80, 0x3f803f80, 0x0, 0x0
.long 0x3f803f80, 0x3f803f80, 0x3f80, 0x0
.long 0x3f800000, 0x3f803f80, 0x3f803f80, 0x0
.long 0x0, 0x3f803f80, 0x3f803f80, 0x3f80
.long 0x0, 0x3f800000, 0x3f803f80, 0x3f803f80
.long 0x0, 0x0, 0x3f803f80, 0x3f803f80
.long 0x0, 0x0, 0x3f800000, 0x3f803f80
.long 0x0, 0x0, 0x0, 0x0
.long 0x0, 0x0, 0x0, 0x0
.long 0x0, 0x0, 0x0, 0x0
.long 0x0, 0x0, 0x0, 0x0
.long 0x0, 0x0, 0x0, 0x0
.long 0x0, 0x0, 0x0, 0x0
.long 0x0, 0x0, 0x0, 0x0
.long 0x0, 0x0, 0x0, 0x0
.long 0x0, 0x0, 0x0, 0x0
.long 0x0, 0x0, 0x0, 0x0
.long 0x0, 0x0, 0x0, 0x0
.long 0x0, 0x0, 0x0, 0x0
.long 0x0, 0x0, 0x0, 0x0
.long 0x0, 0x0, 0x0, 0x0
.long 0x3f80, 0x0, 0x0, 0x0
.long 0x3f803f80, 0x0, 0x0, 0x0
.long 0x0, 0x3f800000, 0x3f803f80, 0x0
.long 0x0, 0x0, 0x3f803f80, 0x3f80
.long 0x0, 0x0, 0x3f800000, 0x3f803f80
.long 0x0, 0x0, 0x0, 0x3f803f80
.long 0x0, 0x0, 0x0, 0x3f800000
.long 0x0, 0x0, 0x0, 0x0
.long 0x0, 0x0, 0x0, 0x0
.long 0x0, 0x0, 0x0, 0x0
.long 0x0, 0x0, 0x0, 0x0
.long 0x0, 0x0, 0x0, 0x0
.long 0x0, 0x0, 0x0, 0x0
.long 0x0, 0x0, 0x0, 0x0
.long 0x0, 0x0, 0x0, 0x0
.long 0x0, 0x0, 0x0, 0x0
.long 0x0, 0x0, 0x0, 0x0
.long 0x0, 0x0, 0x0, 0x0
.long 0x0, 0x0, 0x0, 0x0
.long 0x0, 0x0, 0x0, 0x0
.long 0x0, 0x0, 0x0, 0x0
.long 0x3f80, 0x0, 0x0, 0x0
.long 0x3f803f80, 0x0, 0x0, 0x0
.long 0x3f803f80, 0x3f80, 0x0, 0x0
.long 0x3f800000, 0x3f803f80, 0x0, 0x0
.long 0x0, 0x3f803f80, 0x3f80, 0x0
.long 0x0, 0x3f800000, 0x3f803f80, 0x0
.long 0x0, 0x0, 0x3f803f80, 0x3f80
.long 0x0, 0x0, 0x3f800000, 0x3f803f80
.long 0x0, 0x0, 0x0, 0x3f803f80
.long 0x0, 0x0, 0x0, 0x3f800000
.long 0x0, 0x0, 0x0, 0x0
.long 0x0, 0x0, 0x0, 0x0
.long 0x0, 0x0, 0x0, 0x0
.long 0x0, 0x0, 0x0, 0x0
.long 0x0, 0x0, 0x0, 0x0
.long 0x0, 0x0, 0x0, 0x0
.long 0x0, 0x0, 0x0, 0x0
.long 0x0, 0x0, 0x0, 0x0
.long 0x0, 0x0, 0x0, 0x0
.long 0x0, 0x0, 0x0, 0x0
.long 0x0, 0x0, 0x0, 0x0
.long 0x0, 0x0, 0x0, 0x0
.long 0x0, 0x0, 0x0, 0x0
.long 0x0, 0x0, 0x0, 0x0
.long 0x3f80, 0x0, 0x0, 0x0
.long 0x3f803f80, 0x0, 0x0, 0x0
.long 0x3f803f80, 0x3f80, 0x0, 0x0
.long 0x3f800000, 0x3f803f80, 0x0, 0x0
.long 0x0, 0x3f803f80, 0x3f80, 0x0
.long 0x0, 0x0, 0x0, 0x0
.long 0x0, 0x0, 0x0, 0x0
.long 0x0, 0x0, 0x0, 0x0
.long 0x0, 0x0, 0x0, 0x0
.long 0x0, 0x0, 0x0, 0x0
.long 0x0, 0x0, 0x0, 0x0
.long 0x0, 0x0, 0x0, 0x0
.long 0x0, 0x0, 0x0, 0x0
.long 0x0, 0x0, 0x0, 0x0
.long 0x0, 0x0, 0x0, 0x0
.long 0x0, 0x0, 0x0, 0x0
.long 0x0, 0x0, 0x0, 0x0
.long 0x0, 0x0, 0x0, 0x0
.long 0x0, 0x0, 0x0, 0x0
.long 0x0, 0x0, 0x0, 0x0
.long 0x0, 0x0, 0x0, 0x0
.long 0x0, 0x0, 0x3f803f80, 0x3f803f80
.long 0x0, 0x0, 0x3f800000, 0x3f803f80
.long 0x0, 0x0, 0x0, 0x3f803f80
.long 0x0, 0x0, 0x0, 0x3f800000
.long 0x0, 0x0, 0x0, 0x0
.long 0x0, 0x0, 0x0, 0x0
.long 0x0, 0x0, 0x0, 0x0
.long 0x0, 0x0, 0x0, 0x0
.long 0x0, 0x0, 0x0, 0x0
.long 0x0, 0x0, 0x0, 0x0
.long 0x0, 0x0, 0x0, 0x0
.long 0x0, 0x0, 0x0, 0x0
.long 0x0, 0x0, 0x0, 0x0
.long 0x0, 0x0, 0x0, 0x0
.long 0x0, 0x0, 0x0, 0x0
.long 0x0, 0x0, 0x0, 0x0
.long 0x3f803f80, 0x3f803f80, 0x3f80, 0x0
.long 0x3f803f80, 0x3f803f80, 0x3f803f80, 0x0
.long 0x3f803f80, 0x3f803f80, 0x3f803f80, 0x3f80
.long 0x3f803f80, 0x3f803f80, 0x3f803f80, 0x3f803f80
.long 0x3f803f80, 0x3f803f80, 0x3f803f80, 0x3f803f80
.long 0x3f800000, 0x3f803f80, 0x3f803f80, 0x3f803f80
.long 0x0, 0x3f803f80, 0x3f803f80, 0x3f803f80
.long 0x0, 0x3f800000, 0x3f803f80, 0x3f803f80
.long 0x0, 0x0, 0x3f803f80, 0x3f803f80
.long 0x0, 0x0, 0x3f800000, 0x3f803f80
.long 0x0, 0x0, 0x0, 0x3f803f80
.long 0x0, 0x0, 0x0, 0x3f800000
.long 0x0, 0x0, 0x0, 0x0
.long 0x0, 0x0, 0x0, 0x0
.long 0x0, 0x0, 0x0, 0x0
.long 0x0, 0x0, 0x0, 0x0
.long 0x0, 0x0, 0x0, 0x0
.long 0x0, 0x0, 0x0, 0x0
.long 0x0, 0x0, 0x0, 0x0
.long 0x0, 0x0, 0x0, 0x0
.long 0x3f80, 0x0, 0x0, 0x0
.long 0x3f803f80, 0x0, 0x0, 0x0
.long 0x3f803f80, 0x3f80, 0x0, 0x0
.long 0x3f803f80, 0x3f803f80, 0x0, 0x0
.long 0x3f803f80, 0x3f803f80, 0x3f80, 0x0
.long 0x3f803f80, 0x3f803f80, 0x3f803f80, 0x0
.long 0x3f803f80, 0x3f803f80, 0x3f803f80, 0x3f80
.long 0x3f803f80, 0x3f803f80, 0x3f803f80, 0x3f803f80
.long 0x3f803f80, 0x3f803f80, 0x3f803f80, 0x3f803f80
.long 0x3f800000, 0x3f803f80, 0x3f803f80, 0x3f803f80
.long 0x0, 0x3f803f80, 0x3f803f80, 0x3f803f80
.long 0x0, 0x3f800000, 0x3f803f80, 0x3f803f80
.long 0x0, 0x0, 0x0, 0x0
.long 0x0, 0x0, 0x0, 0x0
.long 0x0, 0x0, 0x0, 0x0
.long 0x0, 0x0, 0x0, 0x0
.long 0x0, 0x0, 0x0, 0x0
.long 0x0, 0x0, 0x0, 0x0
.long 0x0, 0x0, 0x0, 0x0
.long 0x0, 0x0, 0x0, 0x0
.long 0x0, 0x0, 0x0, 0x0
.long 0x0, 0x0, 0x0, 0x0
.long 0x0, 0x0, 0x0, 0x0
.long 0x0, 0x0, 0x0, 0x0
.long 0x3f80, 0x0, 0x0, 0x0
.long 0x3f803f80, 0x0, 0x0, 0x0
.long 0x3f803f80, 0x3f80, 0x0, 0x0
.long 0x3f803f80, 0x3f803f80, 0x0, 0x0
.long 0x0, 0x0, 0x3f800000, 0x3f803f80
.long 0x0, 0x0, 0x0, 0x3f803f80
.long 0x0, 0x0, 0x0, 0x3f800000
.long 0x0, 0x0, 0x0, 0x0
.long 0x0, 0x0, 0x0, 0x0
.long 0x0, 0x0, 0x0, 0x0
.long 0x0, 0x0, 0x0, 0x0
.long 0x0, 0x0, 0x0, 0x0
.long 0x0, 0x0, 0x0, 0x0
.long 0x0, 0x0, 0x0, 0x0
.long 0x0, 0x0, 0x0, 0x0
.long 0x0, 0x0, 0x0, 0x0
.long 0x0, 0x0, 0x0, 0x0
.long 0x0, 0x0, 0x0, 0x0
.long 0x0, 0x0, 0x0, 0x0
.long 0x0, 0x0, 0x0, 0x0
.long 0x3f803f80, 0x3f803f80, 0x0, 0x0
.long 0x3f803f80, 0x3f803f80, 0x3f80, 0x0
.long 0x3f803f80, 0x3f803f80, 0x3f803f80, 0x0
.long 0x3f803f80, 0x3f803f80, 0x3f803f80, 0x3f80
.long 0x3f800000, 0x3f803f80, 0x3f803f80, 0x3f803f80
.long 0x0, 0x3f803f80, 0x3f803f80, 0x3f803f80
.long 0x0, 0x3f800000, 0x3f803f80, 0x3f803f80
.long 0x0, 0x0, 0x3f803f80, 0x3f803f80
.long 0x0, 0x0, 0x3f800000, 0x3f803f80
.long 0x0, 0x0, 0x0, 0x3f803f80
.long 0x0, 0x0, 0x0, 0x3f800000
.long 0x0, 0x0, 0x0, 0x0
.long 0x0, 0x0, 0x0, 0x0
.long 0x0, 0x0, 0x0, 0x0
.long 0x0, 0x0, 0x0, 0x0
.long 0x0, 0x0, 0x0, 0x0
.long 0x0, 0x0, 0x0, 0x0
.long 0x0, 0x0, 0x0, 0x0
.long 0x0, 0x0, 0x0, 0x0
.long 0x0, 0x0, 0x0, 0x0
.long 0x0, 0x0, 0x0, 0x0
.long 0x3f80, 0x0, 0x0, 0x0
.long 0x3f803f80, 0x0, 0x0, 0x0
.long 0x3f803f80, 0x3f80, 0x0, 0x0
.long 0x3f803f80, 0x3f803f80, 0x0, 0x0
.long 0x3f803f80, 0x3f803f80, 0x3f80, 0x0
.long 0x3f803f80, 0x3f803f80, 0x3f803f80, 0x0
.long 0x3f803f80, 0x3f803f80, 0x3f803f80, 0x3f80
.long 0x3f800000, 0x3f803f80, 0x3f803f80, 0x3f803f80
.long 0x0, 0x3f803f80, 0x3f803f80, 0x3f803f80
.long 0x0, 0x3f800000, 0x3f803f80, 0x3f803f80
.long 0x0, 0x0, 0x3f803f80, 0x3f803f80
.long 0x0, 0x0, 0x0, 0x0
.long 0x0, 0x0, 0x0, 0x0
.long 0x0, 0x0, 0x0, 0x0
.long 0x0, 0x0, 0x0, 0x0
.long 0x0, 0x0, 0x0, 0x0
.long 0x0, 0x0, 0x0, 0x0
.long 0x0, 0x0, 0x0, 0x0
.long 0x0, 0x0, 0x0, 0x0
.long 0x0, 0x0, 0x0, 0x0
.long 0x0, 0x0, 0x0, 0x0
.long 0x0, 0x0, 0x0, 0x0
.long 0x0, 0x0, 0x0, 0x0
.long 0x0, 0x0, 0x0, 0x0
.long 0x3f80, 0x0, 0x0, 0x0
.long 0x3f803f80, 0x0, 0x0, 0x0
.long 0x3f803f80, 0x3f80, 0x0, 0x0
.long 0x0, 0x0, 0x0, 0x0
.long 0x0, 0x0, 0x0, 0x0
.long 0x0, 0x0, 0x0, 0x0
.long 0x0, 0x0, 0x0, 0x0
.long 0x0, 0x0, 0x0, 0x0
.long 0x0, 0x0, 0x0, 0x0
.long 0x0, 0x0, 0x0, 0x0
.long 0x0, 0x0, 0x0, 0x0
.long 0x0, 0x0, 0x0, 0x0
.long 0x0, 0x0, 0x0, 0x0
.long 0x0, 0x0, 0x0, 0x0
.long 0x0, 0x0, 0x0, 0x0
.long 0x0, 0x0, 0x0, 0x0
.long 0x0, 0x0, 0x0, 0x0
.long 0x0, 0x0, 0x0, 0x0
.long 0x0, 0x0, 0x0, 0x0
.long 0x0, 0x0, 0xffffffff, 0x0
.long 0x0, 0x0, 0xffff0000, 0xffff
.long 0x0, 0x0, 0x0, 0xffffffff
.long 0x0, 0x0, 0x0, 0xffff0000
.long 0x0, 0x0, 0x0, 0x0
.long 0x0, 0x0, 0x0, 0x0
.long 0x0, 0x0, 0x0, 0x0
.long 0x0, 0x0, 0x0, 0x0
.long 0x0, 0x0, 0x0, 0x0
.long 0x0, 0x0, 0x0, 0x0
.long 0x0, 0x0, 0x0, 0x0
.long 0x0, 0x0, 0x0, 0x0
.long 0x0, 0x0, 0x0, 0x0
.long 0x0, 0x0, 0x0, 0x0
.long 0x0, 0x0, 0x0, 0x0
.long 0x0, 0x0, 0x0, 0x0
.long 0x0, 0x0, 0x0, 0x0
.long 0x0, 0x0, 0x0, 0x0
.long 0x0, 0x0, 0x0, 0x0
.long 0xffff, 0x0, 0x0, 0x0
.long 0xffffffff, 0x0, 0x0, 0x0
.long 0xffff0000, 0xffff, 0x0, 0x0
.long 0x0, 0xffffffff, 0x0, 0x0
.long 0x0, 0xffff0000, 0xffff, 0x0
.long 0x0, 0x0, 0xffffffff, 0x0
.long 0x0, 0x0, 0xffff0000, 0xffff
.long 0x0, 0x0, 0x0, 0xffffffff
.long 0x0, 0x0, 0x0, 0xffff0000
.long 0x0, 0x0, 0x0, 0x0
.long 0x0, 0x0, 0x0, 0x0
.long 0x0, 0x0, 0x0, 0x0
.long 0x0, 0x0, 0x0, 0x0
.long 0x0, 0x0, 0x0, 0x0
.long 0x0, 0x0, 0x0, 0x0
.long 0x0, 0x0, 0x0, 0x0
.long 0x0, 0x0, 0x0, 0x0
.long 0x0, 0x0, 0x0, 0x0
.long 0x0, 0x0, 0x0, 0x0
.long 0x0, 0x0, 0x0, 0x0
.long 0x0, 0x0, 0x0, 0x0
.long 0x0, 0x0, 0x0, 0x0
.long 0x0, 0x0, 0x0, 0x0
.long 0x0, 0x0, 0x0, 0x0
.long 0xffff, 0x0, 0x0, 0x0
.long 0xffffffff, 0x0, 0x0, 0x0
.long 0xffff0000, 0xffff, 0x0, 0x0
.long 0x0, 0xffffffff, 0x0, 0x0
.long 0x0, 0xffff0000, 0xffff, 0x0
.section .rodata,"a"
.p2align 6
.amdhsa_kernel parallel_sum__ssm_conv_s4d__moe_arch_mod__prompt_kernel
  .amdhsa_next_free_vgpr 256
  .amdhsa_next_free_sgpr 96
  .amdhsa_accum_offset 256
  .amdhsa_group_segment_fixed_size 0
  .amdhsa_kernarg_size 120
  .amdhsa_user_sgpr_count 2
  .amdhsa_user_sgpr_kernarg_segment_ptr 1
  .amdhsa_system_sgpr_workgroup_id_x 1
.end_amdhsa_kernel
```

```asm
; @launch grid=(256,1,1) block=(512,1,1) lds=162368
.amdgcn_target "amdgcn-amd-amdhsa--gfx950"
.text
.globl parallel_sum__ssm_conv_s4d__moe_arch_mod__prompt_kernel
.p2align 8
.type parallel_sum__ssm_conv_s4d__moe_arch_mod__prompt_kernel,@function
parallel_sum__ssm_conv_s4d__moe_arch_mod__prompt_kernel:
    s_cmp_ge_u32 s2, 256
    s_cbranch_scc1 L_exit
    s_load_dwordx16 s[4:19], s[0:1], 0
    s_load_dwordx16 s[20:35], s[0:1], 56
    v_readfirstlane_b32 s56, v0
    s_bfe_u32 s3, s2, 0x40003
    v_and_b32 v1, 63, v0
    s_lshr_b32 s56, s56, 6
    s_cmp_ge_u32 s3, 2
    s_cbranch_scc1 L_nocp
    s_cmp_lg_u32 s56, 7
    s_cbranch_scc1 L_nocp
    s_getpc_b64 s[36:37]
L_pc_all:
    s_add_u32 s36, s36, L_auxk-L_pc_all
    s_addc_u32 s37, s37, 0
    s_mov_b32 s38, L_code_end-L_auxk
    s_mov_b32 s39, 0x00020000
    v_lshlrev_b32 v172, 7, v1
    buffer_load_dword v173, v172, s[36:39], 0 offen
    v_add_u32 v172, 8192, v172
    buffer_load_dword v173, v172, s[36:39], 0 offen
    v_add_u32 v172, 8192, v172
    buffer_load_dword v173, v172, s[36:39], 0 offen
L_nocp:
    s_bitcmp1_b32 s2, 7
    s_cbranch_scc0 L_auxk
    s_and_b32 s59, s2, 7
    s_lshl_b32 s57, s59, 4
    s_add_u32 s57, s57, s3
    s_lshl_b32 s36, s57, 3
    s_add_u32 s36, s36, s56
    s_lshl_b32 s37, s36, 8
    s_lshl_b32 s36, s36, 1
    v_lshl_add_u32 v4, v1, 2, s37
    v_mov_b32 v5, s36
    v_mov_b32 v6, 0
    s_waitcnt lgkmcnt(0)
    global_load_ushort v15, v5, s[14:15]
    global_load_dword v16, v4, s[6:7] nt
    global_load_dword v17, v4, s[8:9] nt
    global_load_dword v18, v4, s[10:11] nt
    global_load_dword v19, v4, s[12:13] nt
    global_load_ushort v14, v5, s[16:17]
    global_load_dword v175, v6, s[34:35]
    s_branch L_conv
L_auxk:
    s_and_b32 s57, s2, 7
    s_lshl_b32 s58, s57, 4
    s_add_u32 s58, s58, s3
    s_cmp_ge_u32 s56, 4
    s_cbranch_scc1 L_aux_sinit
    s_lshl_b32 s36, s58, 2
    s_add_u32 s36, s36, s56
    s_lshl_b32 s36, s36, 13
    s_add_u32 s36, s36, 4096
    v_lshlrev_b32 v28, 4, v1
    v_add_u32 v30, s36, v28
    s_waitcnt lgkmcnt(0)
    global_load_dwordx4 v[64:67], v28, s[22:23] offset:0
    global_load_dwordx4 v[68:71], v28, s[22:23] offset:1024
    global_load_dwordx4 v[32:35], v30, s[4:5] offset:-4096
    global_load_dwordx4 v[36:39], v30, s[4:5] offset:-3072
    global_load_dwordx4 v[40:43], v30, s[4:5] offset:-2048
    global_load_dwordx4 v[44:47], v30, s[4:5] offset:-1024
    global_load_dwordx4 v[48:51], v30, s[4:5] offset:0
    global_load_dwordx4 v[52:55], v30, s[4:5] offset:1024
    global_load_dwordx4 v[56:59], v30, s[4:5] offset:2048
    global_load_dwordx4 v[60:63], v30, s[4:5] offset:3072
    s_load_dword s59, s[34:35], 0
L_entry_end:
    s_setprio 2
    s_mov_b64 s[36:37], s[4:5]
    s_mov_b32 s38, 4194304
    s_mov_b32 s39, 0x00020000
    s_mov_b64 s[52:53], s[28:29]
    s_mov_b32 s54, 7340032
    s_mov_b32 s55, 0x00020000
    v_and_b32 v2, 15, v0
    v_bfe_u32 v3, v0, 4, 2
    v_mov_b32 v22, 148624
    v_mov_b32 v23, 1
    s_mov_b64 s[40:41], s[34:35]
    s_mov_b32 s42, 753664
    s_mov_b32 s43, 0x00020000
    s_and_b32 s61, s3, 1
    s_lshr_b32 s6, s3, 1
    s_add_u32 s7, s57, 3
    s_and_b32 s7, s7, 7
    s_cmp_eq_u32 s7, 7
    s_cselect_b32 s8, 7, 6
    s_add_u32 s9, s6, 1
    s_cmp_eq_u32 s9, s8
    s_cselect_b32 s9, 0, s9
    s_cmp_ge_u32 s9, s7
    s_addc_u32 s9, s9, 0
    s_cmp_ge_u32 s6, s7
    s_addc_u32 s10, s6, 0
    s_cmp_eq_u32 s7, 7
    s_cselect_b32 s62, 0, 1
    s_cmp_lt_u32 s6, s8
    s_cselect_b32 s62, 2, s62
    s_cselect_b32 s10, s10, s7
    s_cselect_b32 s11, 0, s6
    s_and_b32 s11, s11, 1
    s_cmp_ge_u32 s3, 3
    s_addc_u32 s63, s3, 0
    s_cmp_ge_u32 s3, 10
    s_addc_u32 s63, s63, 0
    s_sub_u32 s12, s6, s8
    s_cmp_eq_u32 s12, 1
    s_cselect_b32 s63, s3, s63
    s_lshl_b32 s13, s61, 3
    s_add_u32 s13, s13, 3
    s_cmp_eq_u32 s12, 0
    s_cselect_b32 s63, s13, s63
    s_mul_i32 s64, s57, 57344
    s_add_u32 s64, s64, 32768
    s_barrier
    s_lshl_b32 s6, s58, 5
    s_add_u32 s6, s6, 4096
    v_bfe_u32 v11, v1, 1, 2
    v_lshlrev_b32 v11, 12, v11
    v_and_b32 v10, 1, v1
    v_lshl_add_u32 v11, v10, 4, v11
    v_add_u32 v11, s6, v11
    s_and_b32 s6, s56, 1
    s_lshl_b32 s6, s6, 6
    s_lshr_b32 s7, s56, 1
    s_lshl_b32 s7, s7, 4
    s_add_u32 s6, s6, s7
    s_add_u32 s6, s6, 148944
    v_lshlrev_b32 v10, 5, v3
    v_add_u32 v10, s6, v10
    v_lshl_add_u32 v9, v1, 4, v22
    s_mov_b32 s8, 0x3f803f80
    s_waitcnt vmcnt(8)
    v_dot2_f32_bf16 v84, s8, v64, 0
    v_dot2_f32_bf16 v85, s8, v65, 0
    s_nop 1
    v_dot2c_f32_bf16 v84, s8, v66
    v_dot2c_f32_bf16 v85, s8, v67
    v_dot2c_f32_bf16 v84, s8, v68
    v_dot2c_f32_bf16 v85, s8, v69
    v_dot2c_f32_bf16 v84, s8, v70
    v_dot2c_f32_bf16 v85, s8, v71
    s_waitcnt vmcnt(6)
    v_dot2_f32_bf16 v72, s8, v32, 0
    v_dot2_f32_bf16 v76, v32, v32, 0
    v_dot2_f32_bf16 v80, v64, v32, 0
    s_nop 0
    v_dot2c_f32_bf16 v72, s8, v33
    v_dot2c_f32_bf16 v76, v33, v33
    v_dot2c_f32_bf16 v80, v65, v33
    v_dot2c_f32_bf16 v72, s8, v34
    v_dot2c_f32_bf16 v76, v34, v34
    v_dot2c_f32_bf16 v80, v66, v34
    v_dot2c_f32_bf16 v72, s8, v35
    v_dot2c_f32_bf16 v76, v35, v35
    v_dot2c_f32_bf16 v80, v67, v35
    v_dot2c_f32_bf16 v72, s8, v36
    v_dot2c_f32_bf16 v76, v36, v36
    v_dot2c_f32_bf16 v80, v68, v36
    v_dot2c_f32_bf16 v72, s8, v37
    v_dot2c_f32_bf16 v76, v37, v37
    v_dot2c_f32_bf16 v80, v69, v37
    v_dot2c_f32_bf16 v72, s8, v38
    v_dot2c_f32_bf16 v76, v38, v38
    v_dot2c_f32_bf16 v80, v70, v38
    v_dot2c_f32_bf16 v72, s8, v39
    v_dot2c_f32_bf16 v76, v39, v39
    v_dot2c_f32_bf16 v80, v71, v39
    v_add_f32 v84, v84, v85
    s_waitcnt vmcnt(4)
    v_dot2_f32_bf16 v73, s8, v40, 0
    v_dot2_f32_bf16 v77, v40, v40, 0
    v_dot2_f32_bf16 v81, v64, v40, 0
    s_nop 0
    v_dot2c_f32_bf16 v73, s8, v41
    v_dot2c_f32_bf16 v77, v41, v41
    v_dot2c_f32_bf16 v81, v65, v41
    v_dot2c_f32_bf16 v73, s8, v42
    v_dot2c_f32_bf16 v77, v42, v42
    v_dot2c_f32_bf16 v81, v66, v42
    v_dot2c_f32_bf16 v73, s8, v43
    v_dot2c_f32_bf16 v77, v43, v43
    v_dot2c_f32_bf16 v81, v67, v43
    v_dot2c_f32_bf16 v73, s8, v44
    v_dot2c_f32_bf16 v77, v44, v44
    v_dot2c_f32_bf16 v81, v68, v44
    v_dot2c_f32_bf16 v73, s8, v45
    v_dot2c_f32_bf16 v77, v45, v45
    v_dot2c_f32_bf16 v81, v69, v45
    v_dot2c_f32_bf16 v73, s8, v46
    v_dot2c_f32_bf16 v77, v46, v46
    v_dot2c_f32_bf16 v81, v70, v46
    v_dot2c_f32_bf16 v73, s8, v47
    v_dot2c_f32_bf16 v77, v47, v47
    v_dot2c_f32_bf16 v81, v71, v47
    v_mov_b32 v85, v84
    s_waitcnt vmcnt(2)
    v_dot2_f32_bf16 v74, s8, v48, 0
    v_dot2_f32_bf16 v78, v48, v48, 0
    v_dot2_f32_bf16 v82, v64, v48, 0
    s_nop 0
    v_dot2c_f32_bf16 v74, s8, v49
    v_dot2c_f32_bf16 v78, v49, v49
    v_dot2c_f32_bf16 v82, v65, v49
    v_dot2c_f32_bf16 v74, s8, v50
    v_dot2c_f32_bf16 v78, v50, v50
    v_dot2c_f32_bf16 v82, v66, v50
    v_dot2c_f32_bf16 v74, s8, v51
    v_dot2c_f32_bf16 v78, v51, v51
    v_dot2c_f32_bf16 v82, v67, v51
    v_dot2c_f32_bf16 v74, s8, v52
    v_dot2c_f32_bf16 v78, v52, v52
    v_dot2c_f32_bf16 v82, v68, v52
    v_dot2c_f32_bf16 v74, s8, v53
    v_dot2c_f32_bf16 v78, v53, v53
    v_dot2c_f32_bf16 v82, v69, v53
    v_dot2c_f32_bf16 v74, s8, v54
    v_dot2c_f32_bf16 v78, v54, v54
    v_dot2c_f32_bf16 v82, v70, v54
    v_dot2c_f32_bf16 v74, s8, v55
    v_dot2c_f32_bf16 v78, v55, v55
    v_dot2c_f32_bf16 v82, v71, v55
    s_waitcnt vmcnt(0)
    v_dot2_f32_bf16 v75, s8, v56, 0
    v_dot2_f32_bf16 v79, v56, v56, 0
    v_dot2_f32_bf16 v83, v64, v56, 0
    s_nop 0
    v_dot2c_f32_bf16 v75, s8, v57
    v_dot2c_f32_bf16 v79, v57, v57
    v_dot2c_f32_bf16 v83, v65, v57
    v_dot2c_f32_bf16 v75, s8, v58
    v_dot2c_f32_bf16 v79, v58, v58
    v_dot2c_f32_bf16 v83, v66, v58
    v_dot2c_f32_bf16 v75, s8, v59
    v_dot2c_f32_bf16 v79, v59, v59
    v_dot2c_f32_bf16 v83, v67, v59
    v_dot2c_f32_bf16 v75, s8, v60
    v_dot2c_f32_bf16 v79, v60, v60
    v_dot2c_f32_bf16 v83, v68, v60
    v_dot2c_f32_bf16 v75, s8, v61
    v_dot2c_f32_bf16 v79, v61, v61
    v_dot2c_f32_bf16 v83, v69, v61
    v_dot2c_f32_bf16 v75, s8, v62
    v_dot2c_f32_bf16 v79, v62, v62
    v_dot2c_f32_bf16 v83, v70, v62
    v_dot2c_f32_bf16 v75, s8, v63
    v_dot2c_f32_bf16 v79, v63, v63
    v_dot2c_f32_bf16 v83, v71, v63
    v_permlane32_swap_b32 v84, v85
    v_permlane32_swap_b32 v72, v73
    v_permlane32_swap_b32 v76, v77
    v_permlane32_swap_b32 v80, v81
    v_permlane32_swap_b32 v74, v75
    v_permlane32_swap_b32 v78, v79
    v_permlane32_swap_b32 v82, v83
    v_add_f32 v84, v84, v85
    v_add_f32 v72, v72, v73
    v_add_f32 v76, v76, v77
    v_add_f32 v80, v80, v81
    v_add_f32 v74, v74, v75
    v_add_f32 v78, v78, v79
    v_add_f32 v82, v82, v83
    v_mov_b32 v86, v84
    v_permlane16_swap_b32 v72, v74
    v_permlane16_swap_b32 v76, v78
    v_permlane16_swap_b32 v80, v82
    v_permlane16_swap_b32 v84, v86
    v_add_f32 v72, v72, v74
    v_add_f32 v76, v76, v78
    v_add_f32 v80, v80, v82
    v_add_f32 v84, v84, v86
    v_add_f32_dpp v72, v72, v72 row_ror:8 row_mask:0xf bank_mask:0xf
    v_add_f32_dpp v76, v76, v76 row_ror:8 row_mask:0xf bank_mask:0xf
    v_add_f32_dpp v80, v80, v80 row_ror:8 row_mask:0xf bank_mask:0xf
    v_add_f32_dpp v84, v84, v84 row_ror:8 row_mask:0xf bank_mask:0xf
    v_add_f32_dpp v72, v72, v72 row_ror:4 row_mask:0xf bank_mask:0xf
    v_add_f32_dpp v76, v76, v76 row_ror:4 row_mask:0xf bank_mask:0xf
    v_add_f32_dpp v80, v80, v80 row_ror:4 row_mask:0xf bank_mask:0xf
    v_add_f32_dpp v84, v84, v84 row_ror:4 row_mask:0xf bank_mask:0xf
    v_add_f32_dpp v72, v72, v72 row_ror:2 row_mask:0xf bank_mask:0xf
    v_add_f32_dpp v76, v76, v76 row_ror:2 row_mask:0xf bank_mask:0xf
    v_add_f32_dpp v80, v80, v80 row_ror:2 row_mask:0xf bank_mask:0xf
    v_add_f32_dpp v84, v84, v84 row_ror:2 row_mask:0xf bank_mask:0xf
    v_add_f32_dpp v72, v72, v72 row_ror:1 row_mask:0xf bank_mask:0xf
    v_add_f32_dpp v76, v76, v76 row_ror:1 row_mask:0xf bank_mask:0xf
    v_add_f32_dpp v80, v80, v80 row_ror:1 row_mask:0xf bank_mask:0xf
    v_add_f32_dpp v84, v84, v84 row_ror:1 row_mask:0xf bank_mask:0xf
    s_waitcnt lgkmcnt(0)
    s_mul_i32 s60, s59, 0x9e3779b1
    s_add_u32 s60, s60, 0x7f4a7c15
    v_mul_f32 v42, 0x3a800000, v72
    v_mul_f32 v43, 0x3a800000, v76
    v_fma_f32 v43, -v42, v42, v43
    v_max_f32 v43, 0, v43
    v_cvt_pk_bf16_f32 v42, v42, v43
    v_and_b32 v43, 0xffff0000, v42
    v_lshlrev_b32 v45, 16, v42
    v_add_f32 v43, 0x3727c5ac, v43
    v_cvt_pk_bf16_f32 v43, v43, v43
    v_and_b32 v43, 0xffff0000, v43
    v_sqrt_f32 v43, v43
    v_fma_f32 v44, -v45, v84, v80
    v_cvt_pk_bf16_f32 v60, v45, v43
    v_and_b32 v43, 0xffff0000, v60
    v_rcp_f32 v46, v43
    v_mov_b32 v61, v60
    v_mul_f32 v44, v44, v46
    v_cvt_pk_bf16_f32 v64, v44, v44
    v_ashrrev_i32 v65, 31, v64
    v_or_b32 v65, 0x80000000, v65
    v_xor_b32 v64, v64, v65
    v_permlane32_swap_b32 v60, v61
    v_lshrrev_b32 v64, 16, v64
    v_mov_b32 v63, s60
    v_mov_b32 v65, v64
    s_nop 1
    v_permlane32_swap_b32 v64, v65
    v_lshl_or_b32 v62, v65, 16, v64
    s_mov_b64 exec, 0x10001
    ds_write_b128 v10, v[60:63]
    s_mov_b64 exec, 1
    ds_add_rtn_u32 v13, v22, v23 offset:264
    s_mov_b64 exec, 0xff
    ds_read_b128 v[60:63], v9 offset:320
    s_waitcnt lgkmcnt(0)
    v_readfirstlane_b32 s6, v13
    s_cmp_lg_u32 s6, 3
    s_cbranch_scc1 L_aux_nopub
    buffer_store_dwordx4 v[60:63], v11, s[40:43], 0 offen sc1
    ds_write_b32 v22, v63 offset:284
    ds_write_b32 v22, v23 offset:260
L_aux_nopub:
    s_mov_b64 exec, -1
    s_bfe_u32 s65, s60, 0x80000
    s_bfe_u32 s66, s60, 0x80008
    s_bfe_u32 s67, s60, 0x80010
    s_bfe_u32 s68, s60, 0x80018
    s_cmp_lg_u32 s58, 78
    s_cbranch_scc1 L_aux_cons
    v_lshlrev_b32 v12, 4, v0
    v_add_u32 v12, 4096, v12
    v_lshlrev_b32 v13, 3, v0
    v_sub_u32 v13, 0x800, v13
    v_subrev_u32 v88, 0, v13
    v_subrev_u32 v89, 1, v13
    v_subrev_u32 v90, 2, v13
    v_subrev_u32 v91, 3, v13
    v_subrev_u32 v92, 4, v13
    v_subrev_u32 v93, 5, v13
    v_subrev_u32 v94, 6, v13
    v_subrev_u32 v95, 7, v13
    s_mov_b32 s6, 4096
    s_mov_b32 s7, 8192
    s_mov_b32 s8, 12288
    s_mov_b32 s9, 0xffff0000
    v_lshrrev_b32 v24, 4, v0
    v_lshl_add_u32 v24, v24, 2, v22
    v_lshl_add_u32 v25, v2, 2, v22
    v_and_b32 v26, 31, v1
    v_lshl_add_u32 v26, v26, 2, v22
    v_lshrrev_b32 v27, 5, v1
    v_lshl_add_u32 v27, v27, 6, v22
    s_lshl_b32 s10, s56, 5
    s_add_u32 s10, s10, 148688
    v_lshl_add_u32 v31, v1, 2, s10
    v_lshlrev_b32 v9, 5, v0
    s_sleep 28
    buffer_load_dwordx4 v[64:67], v12, s[40:43], 0 offen sc1
    buffer_load_dwordx4 v[68:71], v12, s[40:43], s6 offen sc1
    buffer_load_dwordx4 v[72:75], v12, s[40:43], s7 offen sc1
    buffer_load_dwordx4 v[76:79], v12, s[40:43], s8 offen sc1
    s_mov_b32 s11, 0
L_poll_aux:
    s_waitcnt vmcnt(0)
    v_cmp_ne_u32 s[12:13], s60, v67
    v_cmp_ne_u32 s[14:15], s60, v71
    v_cmp_ne_u32 s[16:17], s60, v75
    v_cmp_ne_u32 s[18:19], s60, v79
    s_or_b64 vcc, s[12:13], s[14:15]
    s_or_b64 vcc, vcc, s[16:17]
    s_or_b64 vcc, vcc, s[18:19]
    s_cbranch_scc0 L_polled_aux
    s_add_u32 s11, s11, 1
    s_cmp_ge_u32 s11, 65536
    s_cbranch_scc1 L_polled_aux
    s_sleep 2
    s_mov_b64 exec, s[12:13]
    s_cbranch_execz L_ps_aux_0
    buffer_load_dwordx4 v[64:67], v12, s[40:43], 0 offen sc1
L_ps_aux_0:
    s_mov_b64 exec, s[14:15]
    s_cbranch_execz L_ps_aux_1
    buffer_load_dwordx4 v[68:71], v12, s[40:43], s6 offen sc1
L_ps_aux_1:
    s_mov_b64 exec, s[16:17]
    s_cbranch_execz L_ps_aux_2
    buffer_load_dwordx4 v[72:75], v12, s[40:43], s7 offen sc1
L_ps_aux_2:
    s_mov_b64 exec, s[18:19]
    s_cbranch_execz L_ps_aux_3
    buffer_load_dwordx4 v[76:79], v12, s[40:43], s8 offen sc1
L_ps_aux_3:
    s_mov_b64 exec, -1
    s_branch L_poll_aux
L_polled_aux:
    v_lshl_or_b32 v80, v66, 16, v88
    v_and_or_b32 v81, v66, s9, v89
    v_lshl_or_b32 v82, v70, 16, v90
    v_and_or_b32 v83, v70, s9, v91
    v_lshl_or_b32 v84, v74, 16, v92
    v_and_or_b32 v85, v74, s9, v93
    v_lshl_or_b32 v86, v78, 16, v94
    v_and_or_b32 v87, v78, s9, v95
    v_max3_u32 v17, v80, v81, v82
    v_max3_u32 v18, v83, v84, v85
    v_max3_u32 v17, v17, v86, v87
    v_max_u32 v17, v17, v18
    v_max_u32 v14, v80, v81
    v_min_u32 v15, v80, v81
    v_max_u32_dpp v17, v17, v17 row_ror:8 row_mask:0xf bank_mask:0xf
    v_mov_b32 v16, 0
    v_med3_u32 v16, v15, v16, v82
    v_max_u32_dpp v17, v17, v17 row_ror:4 row_mask:0xf bank_mask:0xf
    v_med3_u32 v15, v14, v15, v82
    v_max_u32 v14, v14, v82
    v_max_u32_dpp v17, v17, v17 row_ror:2 row_mask:0xf bank_mask:0xf
    v_med3_u32 v16, v15, v16, v83
    v_med3_u32 v15, v14, v15, v83
    v_max_u32_dpp v17, v17, v17 row_ror:1 row_mask:0xf bank_mask:0xf
    ds_write_b32 v24, v17
    ds_read_b32 v17, v25
    ds_write_b64 v9, v[64:65] offset:0
    ds_write_b64 v9, v[68:69] offset:8
    ds_write_b64 v9, v[72:73] offset:16
    ds_write_b64 v9, v[76:77] offset:24
    v_max_u32 v14, v14, v83
    v_med3_u32 v16, v15, v16, v84
    v_med3_u32 v15, v14, v15, v84
    v_max_u32 v14, v14, v84
    v_med3_u32 v16, v15, v16, v85
    v_med3_u32 v15, v14, v15, v85
    v_max_u32 v14, v14, v85
    v_med3_u32 v16, v15, v16, v86
    v_med3_u32 v15, v14, v15, v86
    v_max_u32 v14, v14, v86
    v_med3_u32 v16, v15, v16, v87
    v_med3_u32 v15, v14, v15, v87
    v_max_u32 v14, v14, v87
    v_mov_b32 v19, 0
    s_mov_b32 s11, 0
    s_waitcnt lgkmcnt(4)
L_aux_gm:
    v_cmp_eq_u32 vcc, 0, v17
    s_cbranch_vccz L_aux_gmok
    ds_read_b32 v17, v25
    s_waitcnt lgkmcnt(0)
    s_add_u32 s11, s11, 1
    s_cmp_ge_u32 s11, 524288
    s_cbranch_scc1 L_aux_gmok
    s_branch L_aux_gm
L_aux_gmok:
    v_sub_co_u32_dpp v20, vcc, v17, v17 row_ror:1 row_mask:0xf bank_mask:0xf
    v_addc_co_u32 v19, vcc, 0, v19, vcc
    v_sub_co_u32_dpp v20, vcc, v17, v17 row_ror:2 row_mask:0xf bank_mask:0xf
    v_addc_co_u32 v19, vcc, 0, v19, vcc
    v_sub_co_u32_dpp v20, vcc, v17, v17 row_ror:3 row_mask:0xf bank_mask:0xf
    v_addc_co_u32 v19, vcc, 0, v19, vcc
    v_sub_co_u32_dpp v20, vcc, v17, v17 row_ror:4 row_mask:0xf bank_mask:0xf
    v_addc_co_u32 v19, vcc, 0, v19, vcc
    v_sub_co_u32_dpp v20, vcc, v17, v17 row_ror:5 row_mask:0xf bank_mask:0xf
    v_addc_co_u32 v19, vcc, 0, v19, vcc
    v_sub_co_u32_dpp v20, vcc, v17, v17 row_ror:6 row_mask:0xf bank_mask:0xf
    v_addc_co_u32 v19, vcc, 0, v19, vcc
    v_sub_co_u32_dpp v20, vcc, v17, v17 row_ror:7 row_mask:0xf bank_mask:0xf
    v_addc_co_u32 v19, vcc, 0, v19, vcc
    v_sub_co_u32_dpp v20, vcc, v17, v17 row_ror:8 row_mask:0xf bank_mask:0xf
    v_addc_co_u32 v19, vcc, 0, v19, vcc
    v_sub_co_u32_dpp v20, vcc, v17, v17 row_ror:9 row_mask:0xf bank_mask:0xf
    v_addc_co_u32 v19, vcc, 0, v19, vcc
    v_sub_co_u32_dpp v20, vcc, v17, v17 row_ror:10 row_mask:0xf bank_mask:0xf
    v_addc_co_u32 v19, vcc, 0, v19, vcc
    v_sub_co_u32_dpp v20, vcc, v17, v17 row_ror:11 row_mask:0xf bank_mask:0xf
    v_addc_co_u32 v19, vcc, 0, v19, vcc
    v_sub_co_u32_dpp v20, vcc, v17, v17 row_ror:12 row_mask:0xf bank_mask:0xf
    v_addc_co_u32 v19, vcc, 0, v19, vcc
    v_sub_co_u32_dpp v20, vcc, v17, v17 row_ror:13 row_mask:0xf bank_mask:0xf
    v_addc_co_u32 v19, vcc, 0, v19, vcc
    v_sub_co_u32_dpp v20, vcc, v17, v17 row_ror:14 row_mask:0xf bank_mask:0xf
    v_addc_co_u32 v19, vcc, 0, v19, vcc
    v_sub_co_u32_dpp v20, vcc, v17, v17 row_ror:15 row_mask:0xf bank_mask:0xf
    v_addc_co_u32 v19, vcc, 0, v19, vcc
    v_cmp_eq_u32 vcc, 8, v19
    s_ff1_i32_b64 s12, vcc
    v_readlane_b32 s12, v17, s12
    v_mov_b32 v18, 1
    s_nop 0
    v_cmp_le_u32 s[14:15], s12, v14
    v_cmp_le_u32 s[16:17], s12, v15
    v_cmp_le_u32 s[18:19], s12, v16
    s_bcnt1_i32_b64 s12, s[14:15]
    s_bcnt1_i32_b64 s20, s[16:17]
    v_mbcnt_lo_u32_b32 v20, s14, 0
    v_mbcnt_lo_u32_b32 v21, s16, 0
    v_mbcnt_hi_u32_b32 v20, s15, v20
    v_mbcnt_hi_u32_b32 v21, s17, v21
    s_add_u32 s20, s20, s12
    s_lshl_b32 s12, s12, 2
    s_add_u32 s12, s12, s10
    v_lshl_add_u32 v20, v20, 2, s10
    v_lshl_add_u32 v21, v21, 2, s12
    s_cmp_lg_u64 s[18:19], 0
    s_cselect_b32 s20, 9, s20
    s_cmp_gt_u32 s20, 8
    s_cbranch_scc0 L_aux_fit
    s_mov_b64 s[14:15], 0
    s_mov_b64 s[16:17], 0
    s_mov_b32 s20, 0
    v_mov_b32 v18, 2
L_aux_fit:
    s_lshl_b32 s20, 0xff, s20
    s_and_b32 s20, s20, 0xff
    s_mov_b32 s21, 0
    s_mov_b64 exec, s[14:15]
    ds_write_b32 v20, v14
    s_mov_b64 exec, s[16:17]
    ds_write_b32 v21, v15
    s_mov_b64 exec, s[20:21]
    ds_write_b32 v31, v18
    s_mov_b64 exec, -1
    s_mov_b32 s11, 0
    v_mov_b32 v20, 0
L_aux_ls:
    ds_read_b32 v17, v26 offset:64
    ds_read_b128 v[64:67], v27 offset:64
    ds_read_b128 v[68:71], v27 offset:80
    ds_read_b128 v[72:75], v27 offset:96
    ds_read_b128 v[76:79], v27 offset:112
    s_waitcnt lgkmcnt(4)
    v_cmp_eq_u32 vcc, 0, v17
    s_cbranch_vccz L_aux_lsok
    s_waitcnt lgkmcnt(0)
    s_add_u32 s11, s11, 1
    s_cmp_ge_u32 s11, 524288
    s_cbranch_scc1 L_aux_lsok
    s_branch L_aux_ls
L_aux_lsok:
    v_cmp_eq_u32 vcc, 2, v17
    s_cbranch_vccnz L_aux_slow
    s_cmp_ge_u32 s56, 2
    s_cbranch_scc1 L_aux_wd
    s_cmp_eq_u32 s56, 1
    s_cbranch_scc1 L_aux_nox
    v_and_b32 v60, 0xfff, v17
    v_sub_u32 v60, 0x800, v60
    v_lshlrev_b32 v15, 2, v60
    ds_read_b32 v62, v15
    s_waitcnt lgkmcnt(4)
    v_cmp_gt_u32 vcc, v64, v17
    v_addc_co_u32 v20, vcc, 0, v20, vcc
    v_cmp_gt_u32 vcc, v65, v17
    v_addc_co_u32 v20, vcc, 0, v20, vcc
    v_cmp_gt_u32 vcc, v66, v17
    v_addc_co_u32 v20, vcc, 0, v20, vcc
    v_cmp_gt_u32 vcc, v67, v17
    v_addc_co_u32 v20, vcc, 0, v20, vcc
    s_waitcnt lgkmcnt(3)
    v_cmp_gt_u32 vcc, v68, v17
    v_addc_co_u32 v20, vcc, 0, v20, vcc
    v_cmp_gt_u32 vcc, v69, v17
    v_addc_co_u32 v20, vcc, 0, v20, vcc
    v_cmp_gt_u32 vcc, v70, v17
    v_addc_co_u32 v20, vcc, 0, v20, vcc
    v_cmp_gt_u32 vcc, v71, v17
    v_addc_co_u32 v20, vcc, 0, v20, vcc
    s_waitcnt lgkmcnt(2)
    v_cmp_gt_u32 vcc, v72, v17
    v_addc_co_u32 v20, vcc, 0, v20, vcc
    v_cmp_gt_u32 vcc, v73, v17
    v_addc_co_u32 v20, vcc, 0, v20, vcc
    v_cmp_gt_u32 vcc, v74, v17
    v_addc_co_u32 v20, vcc, 0, v20, vcc
    v_cmp_gt_u32 vcc, v75, v17
    v_addc_co_u32 v20, vcc, 0, v20, vcc
    s_waitcnt lgkmcnt(1)
    v_cmp_gt_u32 vcc, v76, v17
    v_addc_co_u32 v20, vcc, 0, v20, vcc
    v_cmp_gt_u32 vcc, v77, v17
    v_addc_co_u32 v20, vcc, 0, v20, vcc
    v_cmp_gt_u32 vcc, v78, v17
    v_addc_co_u32 v20, vcc, 0, v20, vcc
    v_cmp_gt_u32 vcc, v79, v17
    v_addc_co_u32 v20, vcc, 0, v20, vcc
    v_mov_b32 v21, v20
    v_and_b32 v14, 0xffff0000, v17
    v_ashrrev_i32 v15, 31, v14
    v_permlane32_swap_b32 v20, v21
    v_not_b32 v15, v15
    v_add_u32 v20, v20, v21
    v_or_b32 v15, 0x80000000, v15
    v_xor_b32 v14, v14, v15
    v_and_b32 v14, 0xffff0000, v14
    v_mul_f32 v14, 0xbfb8aa3b, v14
    v_exp_f32 v14, v14
    v_mov_b32 v63, s60
    v_add_f32 v14, 1.0, v14
    v_rcp_f32 v14, v14
L_aux_sel:
    v_cmp_gt_u32 vcc, 8, v20
    v_lshlrev_b32 v21, 4, v20
    v_add_u32 v21, 24576, v21
    v_cvt_pk_bf16_f32 v14, v14, v14
    v_and_b32 v61, 0xffff0000, v14
    s_mov_b32 exec_lo, vcc_lo
    s_mov_b32 exec_hi, 0
    s_waitcnt lgkmcnt(0)
    buffer_store_dwordx4 v[60:63], v21, s[40:43], 0 offen sc1
    s_mov_b64 exec, -1
L_aux_nox:
    s_mov_b64 exec, 1
    ds_add_u32 v22, v23 offset:268
    s_mov_b64 exec, -1
    s_branch L_aux_b4
L_aux_cons:
    s_cmp_ge_u32 s56, 2
    s_cbranch_scc1 L_aux_wd
    s_cmp_eq_u32 s62, 0
    s_cbranch_scc1 L_aux_nox
    v_and_b32 v14, 7, v1
    v_lshlrev_b32 v21, 4, v14
    v_add_u32 v21, 24576, v21
    v_lshl_add_u32 v15, v14, 2, v22
    s_mul_i32 s6, s56, 4160
    s_add_u32 s6, s6, 131072
    s_lshl_b32 s7, s61, 10
    s_lshl_b32 s9, s56, 2
    s_sleep 86
    s_mov_b64 exec, 0xff
    s_mov_b32 s11, 0
L_aux_sp:
    buffer_load_dwordx4 v[60:63], v21, s[40:43], 0 offen sc1
    s_waitcnt vmcnt(0)
    v_cmp_ne_u32 vcc, s60, v63
    s_cbranch_vccz L_aux_spok
    s_add_u32 s11, s11, 1
    s_cmp_ge_u32 s11, 65536
    s_cbranch_scc1 L_aux_spok
    s_sleep 2
    s_branch L_aux_sp
L_aux_spok:
    v_lshl_add_u32 v60, v60, 11, s7
    ds_write_b32 v15, v62 offset:192
    s_mov_b64 exec, -1
    v_readlane_b32 s12, v60, s9
    s_add_u32 s9, s9, 1
    v_readlane_b32 s13, v60, s9
    s_add_u32 s9, s9, 1
    v_readlane_b32 s14, v60, s9
    s_add_u32 s9, s9, 1
    v_readlane_b32 s15, v60, s9
    s_add_u32 m0, s6, 0
    s_nop 0
    buffer_load_dwordx4 v28, s[36:39], s12 offen lds
    s_add_u32 m0, s6, 1040
    s_nop 0
    buffer_load_dwordx4 v28, s[36:39], s13 offen lds
    s_add_u32 m0, s6, 2080
    s_nop 0
    buffer_load_dwordx4 v28, s[36:39], s14 offen lds
    s_add_u32 m0, s6, 3120
    s_nop 0
    buffer_load_dwordx4 v28, s[36:39], s15 offen lds
    s_mov_b64 exec, 1
    ds_add_u32 v22, v23 offset:268
    s_waitcnt vmcnt(0)
    ds_add_u32 v22, v23 offset:272
    s_mov_b64 exec, -1
    s_branch L_aux_b4
L_aux_wd:
    s_mul_i32 s6, s57, 917504
    s_lshl_b32 s7, s63, 7
    s_add_u32 s6, s6, s7
    s_and_b32 s7, s56, 1
    s_lshl_b32 s8, s7, 14
    s_add_u32 s6, s6, s8
    v_lshrrev_b32 v14, 3, v1
    v_and_b32 v15, 7, v1
    v_xor_b32 v15, v15, v3
    s_lshl_b32 s8, s7, 2
    v_xor_b32 v15, s8, v15
    v_lshlrev_b32 v14, 11, v14
    v_lshl_add_u32 v14, v15, 4, v14
    v_add_u32 v14, s6, v14
    s_lshl_b32 s7, s7, 10
    s_setprio 0
    v_lshl_add_u32 v20, v1, 4, s7
    v_add_u32 v21, 0x10000, v20
    s_and_b32 s8, s63, 7
    s_cmp_eq_u32 s8, 3
    s_cselect_b32 s8, s62, 0
    s_cmp_lg_u32 s8, 1
    s_cbranch_scc1 L_aux_wdl
    s_mov_b32 s11, 0
L_lw_iss:
    ds_read_b32 v18, v22 offset:280
    s_add_u32 s11, s11, 1
    s_cmp_ge_u32 s11, 524288
    s_cbranch_scc1 L_lwx_iss
    s_waitcnt lgkmcnt(0)
    v_readfirstlane_b32 s8, v18
    s_cmp_ge_u32 s8, 4
    s_cbranch_scc1 L_lwx_iss
    s_sleep 1
    s_branch L_lw_iss
L_lwx_iss:
    s_waitcnt lgkmcnt(0)
    s_mov_b32 s6, 0
    buffer_load_dwordx4 v[128:131], v14, s[52:55], s6 offen nt
    s_mov_b32 s6, 32768
    buffer_load_dwordx4 v[132:135], v14, s[52:55], s6 offen nt
    s_mov_b32 s6, 65536
    buffer_load_dwordx4 v[136:139], v14, s[52:55], s6 offen nt
    s_mov_b32 s6, 98304
    buffer_load_dwordx4 v[140:143], v14, s[52:55], s6 offen nt
    s_mov_b32 s6, 131072
    buffer_load_dwordx4 v[144:147], v14, s[52:55], s6 offen nt
    s_mov_b32 s6, 163840
    buffer_load_dwordx4 v[148:151], v14, s[52:55], s6 offen nt
    s_mov_b32 s6, 196608
    buffer_load_dwordx4 v[152:155], v14, s[52:55], s6 offen nt
    s_mov_b32 s6, 229376
    buffer_load_dwordx4 v[156:159], v14, s[52:55], s6 offen nt
    s_mov_b32 s6, 262144
    buffer_load_dwordx4 v[160:163], v14, s[52:55], s6 offen nt
    s_mov_b32 s6, 294912
    buffer_load_dwordx4 v[164:167], v14, s[52:55], s6 offen nt
    s_mov_b32 s6, 327680
    buffer_load_dwordx4 v[168:171], v14, s[52:55], s6 offen nt
    s_mov_b32 s6, 360448
    buffer_load_dwordx4 v[172:175], v14, s[52:55], s6 offen nt
    s_mov_b32 s11, 0
L_lw_wd2:
    ds_read_b32 v18, v22 offset:268
    s_add_u32 s11, s11, 1
    s_cmp_ge_u32 s11, 524288
    s_cbranch_scc1 L_lwx_wd2
    s_waitcnt lgkmcnt(0)
    v_readfirstlane_b32 s8, v18
    s_cmp_ge_u32 s8, 2
    s_cbranch_scc1 L_lwx_wd2
    s_branch L_lw_wd2
L_lwx_wd2:
    s_waitcnt lgkmcnt(0)
    s_branch L_aux_wdr
L_aux_wdl:
    s_mov_b32 s11, 0
L_lw_wd:
    ds_read_b32 v18, v22 offset:268
    s_add_u32 s11, s11, 1
    s_cmp_ge_u32 s11, 524288
    s_cbranch_scc1 L_lwx_wd
    s_waitcnt lgkmcnt(0)
    v_readfirstlane_b32 s8, v18
    s_cmp_ge_u32 s8, 2
    s_cbranch_scc1 L_lwx_wd
    s_branch L_lw_wd
L_lwx_wd:
    s_waitcnt lgkmcnt(0)
    s_mov_b32 s6, 0
    buffer_load_dwordx4 v[128:131], v14, s[52:55], s6 offen nt
    s_mov_b32 s6, 32768
    buffer_load_dwordx4 v[132:135], v14, s[52:55], s6 offen nt
    s_mov_b32 s6, 65536
    buffer_load_dwordx4 v[136:139], v14, s[52:55], s6 offen nt
    s_mov_b32 s6, 98304
    buffer_load_dwordx4 v[140:143], v14, s[52:55], s6 offen nt
    s_mov_b32 s6, 131072
    buffer_load_dwordx4 v[144:147], v14, s[52:55], s6 offen nt
    s_mov_b32 s6, 163840
    buffer_load_dwordx4 v[148:151], v14, s[52:55], s6 offen nt
    s_mov_b32 s6, 196608
    buffer_load_dwordx4 v[152:155], v14, s[52:55], s6 offen nt
    s_mov_b32 s6, 229376
    buffer_load_dwordx4 v[156:159], v14, s[52:55], s6 offen nt
    s_mov_b32 s6, 262144
    buffer_load_dwordx4 v[160:163], v14, s[52:55], s6 offen nt
    s_mov_b32 s6, 294912
    buffer_load_dwordx4 v[164:167], v14, s[52:55], s6 offen nt
    s_mov_b32 s6, 327680
    buffer_load_dwordx4 v[168:171], v14, s[52:55], s6 offen nt
    s_mov_b32 s6, 360448
    buffer_load_dwordx4 v[172:175], v14, s[52:55], s6 offen nt
L_aux_wdr:
    s_mov_b32 s6, 393216
    buffer_load_dwordx4 v[176:179], v14, s[52:55], s6 offen nt
    s_mov_b32 s6, 425984
    buffer_load_dwordx4 v[180:183], v14, s[52:55], s6 offen nt
    s_mov_b32 s6, 458752
    buffer_load_dwordx4 v[184:187], v14, s[52:55], s6 offen nt
    s_mov_b32 s6, 491520
    buffer_load_dwordx4 v[188:191], v14, s[52:55], s6 offen nt
    s_mov_b32 s6, 524288
    buffer_load_dwordx4 v[192:195], v14, s[52:55], s6 offen nt
    s_mov_b32 s6, 557056
    buffer_load_dwordx4 v[196:199], v14, s[52:55], s6 offen nt
    s_mov_b32 s6, 589824
    buffer_load_dwordx4 v[200:203], v14, s[52:55], s6 offen nt
    s_mov_b32 s6, 622592
    buffer_load_dwordx4 v[204:207], v14, s[52:55], s6 offen nt
    s_mov_b32 s6, 655360
    buffer_load_dwordx4 v[208:211], v14, s[52:55], s6 offen nt
    s_mov_b32 s6, 688128
    buffer_load_dwordx4 v[212:215], v14, s[52:55], s6 offen nt
    s_mov_b32 s6, 720896
    buffer_load_dwordx4 v[216:219], v14, s[52:55], s6 offen nt
    s_mov_b32 s6, 753664
    buffer_load_dwordx4 v[220:223], v14, s[52:55], s6 offen nt
    s_mov_b32 s6, 786432
    buffer_load_dwordx4 v[224:227], v14, s[52:55], s6 offen nt
    s_mov_b32 s6, 819200
    buffer_load_dwordx4 v[228:231], v14, s[52:55], s6 offen nt
    s_mov_b32 s6, 851968
    buffer_load_dwordx4 v[232:235], v14, s[52:55], s6 offen nt
    s_mov_b32 s6, 884736
    buffer_load_dwordx4 v[236:239], v14, s[52:55], s6 offen nt
    s_mov_b32 s11, 0
L_lw_gp:
    ds_read_b32 v18, v22 offset:292
    s_add_u32 s11, s11, 1
    s_cmp_ge_u32 s11, 524288
    s_cbranch_scc1 L_lwx_gp
    s_waitcnt lgkmcnt(0)
    v_readfirstlane_b32 s8, v18
    s_cmp_ge_u32 s8, 4
    s_cbranch_scc1 L_lwx_gp
    s_sleep 1
    s_branch L_lw_gp
L_lwx_gp:
    s_waitcnt lgkmcnt(0)
    s_waitcnt vmcnt(24)
    ds_write_b128 v20, v[128:131] offset:0
    ds_write_b128 v20, v[132:135] offset:2048
    ds_write_b128 v20, v[136:139] offset:4096
    ds_write_b128 v20, v[140:143] offset:6144
    s_waitcnt vmcnt(20)
    ds_write_b128 v20, v[144:147] offset:8192
    ds_write_b128 v20, v[148:151] offset:10240
    ds_write_b128 v20, v[152:155] offset:12288
    ds_write_b128 v20, v[156:159] offset:14336
    s_waitcnt vmcnt(16)
    ds_write_b128 v20, v[160:163] offset:32768
    ds_write_b128 v20, v[164:167] offset:34816
    ds_write_b128 v20, v[168:171] offset:36864
    ds_write_b128 v20, v[172:175] offset:38912
    s_waitcnt vmcnt(12)
    ds_write_b128 v20, v[176:179] offset:40960
    ds_write_b128 v20, v[180:183] offset:43008
    ds_write_b128 v20, v[184:187] offset:45056
    ds_write_b128 v20, v[188:191] offset:47104
    s_waitcnt vmcnt(8)
    ds_write_b128 v21, v[192:195] offset:0
    ds_write_b128 v21, v[196:199] offset:2048
    ds_write_b128 v21, v[200:203] offset:4096
    ds_write_b128 v21, v[204:207] offset:6144
    s_waitcnt vmcnt(4)
    ds_write_b128 v21, v[208:211] offset:8192
    ds_write_b128 v21, v[212:215] offset:10240
    ds_write_b128 v21, v[216:219] offset:12288
    ds_write_b128 v21, v[220:223] offset:14336
    s_waitcnt vmcnt(0)
    ds_write_b128 v21, v[224:227] offset:32768
    ds_write_b128 v21, v[228:231] offset:34816
    ds_write_b128 v21, v[232:235] offset:36864
    ds_write_b128 v21, v[236:239] offset:38912
    s_waitcnt lgkmcnt(0)
    s_branch L_aux_b5
L_aux_sinit:
    v_mov_b32 v98, 148624
    v_mov_b32 v96, 0
    v_mov_b32 v97, 0
    v_lshl_add_u32 v98, v1, 3, v98
    ds_write_b64 v98, v[96:97]
    v_mov_b32 v96, 0x3f803f80
    v_and_b32 v98, 255, v0
    v_lshlrev_b32 v98, 2, v98
    v_add_u32 v98, 139392, v98
    ds_write_b32 v98, v96
    s_waitcnt lgkmcnt(0)
    v_and_b32 v2, 15, v0
    v_bfe_u32 v3, v0, 4, 2
    v_mov_b32 v22, 148624
    v_mov_b32 v23, 1
    s_mov_b64 s[40:41], s[34:35]
    s_mov_b32 s42, 753664
    s_mov_b32 s43, 0x00020000
    s_and_b32 s61, s3, 1
    s_lshr_b32 s6, s3, 1
    s_add_u32 s7, s57, 3
    s_and_b32 s7, s7, 7
    s_cmp_eq_u32 s7, 7
    s_cselect_b32 s8, 7, 6
    s_add_u32 s9, s6, 1
    s_cmp_eq_u32 s9, s8
    s_cselect_b32 s9, 0, s9
    s_cmp_ge_u32 s9, s7
    s_addc_u32 s9, s9, 0
    s_cmp_ge_u32 s6, s7
    s_addc_u32 s10, s6, 0
    s_cmp_eq_u32 s7, 7
    s_cselect_b32 s62, 0, 1
    s_cmp_lt_u32 s6, s8
    s_cselect_b32 s62, 2, s62
    s_cselect_b32 s10, s10, s7
    s_cselect_b32 s11, 0, s6
    s_and_b32 s11, s11, 1
    s_cmp_ge_u32 s3, 3
    s_addc_u32 s63, s3, 0
    s_cmp_ge_u32 s3, 10
    s_addc_u32 s63, s63, 0
    s_sub_u32 s12, s6, s8
    s_cmp_eq_u32 s12, 1
    s_cselect_b32 s63, s3, s63
    s_lshl_b32 s13, s61, 3
    s_add_u32 s13, s13, 3
    s_cmp_eq_u32 s12, 0
    s_cselect_b32 s63, s13, s63
    s_mul_i32 s64, s57, 57344
    s_add_u32 s64, s64, 32768
    s_cmp_eq_u32 s11, 1
    s_cselect_b64 s[44:45], s[26:27], s[24:25]
    s_mov_b32 s46, 7340032
    s_mov_b32 s47, 0x00020000
    s_mov_b64 s[48:49], s[26:27]
    s_mov_b32 s50, 7340032
    s_mov_b32 s51, 0x00020000
    s_lshl_b32 s12, s61, 1
    s_add_u32 s13, s12, s11
    s_mul_i32 s13, s13, 14336
    s_lshl_b32 s30, s10, 11
    s_add_u32 s30, s30, s13
    s_add_u32 s13, s12, 1
    s_mul_i32 s13, s13, 14336
    s_lshl_b32 s31, s9, 11
    s_add_u32 s31, s31, s13
    v_bfe_u32 v96, v1, 3, 2
    v_lshrrev_b32 v97, 5, v1
    v_lshl_add_u32 v96, v97, 3, v96
    v_mul_u32_u24 v96, 7168, v96
    v_lshlrev_b32 v98, 1, v3
    v_and_b32 v94, 7, v1
    v_xor_b32 v98, v98, v94
    s_mul_i32 s12, s57, 896
    s_lshl_b32 s10, s10, 7
    s_lshl_b32 s9, s9, 7
    s_add_u32 s10, s10, s12
    s_add_u32 s9, s9, s12
    v_lshl_add_u32 v96, v98, 4, v96
    v_add_u32 v97, s9, v96
    v_add_u32 v96, s10, v96
    s_sub_u32 s32, s56, 4
    s_lshl_b32 s33, s61, 2
    s_add_u32 s33, s33, s32
    s_mul_i32 s33, s33, 917504
    s_lshl_b32 s32, s32, 15
    s_barrier
    s_cmp_eq_u32 s62, 0
    s_cbranch_scc1 L_aux_idle
    s_add_u32 s6, s33, 0
    s_add_u32 m0, s32, 16384
    s_nop 0
    buffer_load_dwordx4 v96, s[44:47], s6 offen nt lds
    s_add_u32 s6, s33, 114688
    s_add_u32 m0, s32, 17408
    s_nop 0
    buffer_load_dwordx4 v96, s[44:47], s6 offen nt lds
    s_add_u32 s6, s33, 28672
    s_add_u32 m0, s32, 18432
    s_nop 0
    buffer_load_dwordx4 v96, s[44:47], s6 offen nt lds
    s_add_u32 s6, s33, 143360
    s_add_u32 m0, s32, 19456
    s_nop 0
    buffer_load_dwordx4 v96, s[44:47], s6 offen nt lds
    s_add_u32 s6, s33, 229376
    s_add_u32 m0, s32, 20480
    s_nop 0
    buffer_load_dwordx4 v96, s[44:47], s6 offen nt lds
    s_add_u32 s6, s33, 344064
    s_add_u32 m0, s32, 21504
    s_nop 0
    buffer_load_dwordx4 v96, s[44:47], s6 offen nt lds
    s_add_u32 s6, s33, 258048
    s_add_u32 m0, s32, 22528
    s_nop 0
    buffer_load_dwordx4 v96, s[44:47], s6 offen nt lds
    s_add_u32 s6, s33, 372736
    s_add_u32 m0, s32, 23552
    s_nop 0
    buffer_load_dwordx4 v96, s[44:47], s6 offen nt lds
    s_mov_b32 s11, 0
L_lw_st:
    ds_read_b32 v18, v22 offset:260
    s_add_u32 s11, s11, 1
    s_cmp_ge_u32 s11, 524288
    s_cbranch_scc1 L_lwx_st
    s_waitcnt lgkmcnt(0)
    v_readfirstlane_b32 s8, v18
    s_cmp_ge_u32 s8, 1
    s_cbranch_scc1 L_lwx_st
    s_sleep 1
    s_branch L_lw_st
L_lwx_st:
    s_waitcnt lgkmcnt(0)
    ds_read_b32 v18, v22 offset:284
    s_waitcnt lgkmcnt(0)
    v_readfirstlane_b32 s60, v18
    s_add_u32 s6, s33, 458752
    s_add_u32 m0, s32, 24576
    s_nop 0
    buffer_load_dwordx4 v96, s[44:47], s6 offen nt lds
    s_add_u32 s6, s33, 573440
    s_add_u32 m0, s32, 25600
    s_nop 0
    buffer_load_dwordx4 v96, s[44:47], s6 offen nt lds
    s_add_u32 s6, s33, 487424
    s_add_u32 m0, s32, 26624
    s_nop 0
    buffer_load_dwordx4 v96, s[44:47], s6 offen nt lds
    s_add_u32 s6, s33, 602112
    s_add_u32 m0, s32, 27648
    s_nop 0
    buffer_load_dwordx4 v96, s[44:47], s6 offen nt lds
    s_add_u32 s6, s33, 688128
    s_add_u32 m0, s32, 28672
    s_nop 0
    buffer_load_dwordx4 v96, s[44:47], s6 offen nt lds
    s_add_u32 s6, s33, 802816
    s_add_u32 m0, s32, 29696
    s_nop 0
    buffer_load_dwordx4 v96, s[44:47], s6 offen nt lds
    s_add_u32 s6, s33, 716800
    s_add_u32 m0, s32, 30720
    s_nop 0
    buffer_load_dwordx4 v96, s[44:47], s6 offen nt lds
    s_add_u32 s6, s33, 831488
    s_add_u32 m0, s32, 31744
    s_nop 0
    buffer_load_dwordx4 v96, s[44:47], s6 offen nt lds
    s_cmp_eq_u32 s62, 1
    s_cbranch_scc1 L_aux_one1
    s_add_u32 s6, s33, 0
    s_add_u32 m0, s32, 0
    s_nop 0
    buffer_load_dwordx4 v97, s[48:51], s6 offen nt lds
    s_add_u32 s6, s33, 114688
    s_add_u32 m0, s32, 1024
    s_nop 0
    buffer_load_dwordx4 v97, s[48:51], s6 offen nt lds
    s_add_u32 s6, s33, 28672
    s_add_u32 m0, s32, 2048
    s_nop 0
    buffer_load_dwordx4 v97, s[48:51], s6 offen nt lds
    s_add_u32 s6, s33, 143360
    s_add_u32 m0, s32, 3072
    s_nop 0
    buffer_load_dwordx4 v97, s[48:51], s6 offen nt lds
    s_add_u32 s6, s33, 229376
    s_add_u32 m0, s32, 4096
    s_nop 0
    buffer_load_dwordx4 v97, s[48:51], s6 offen nt lds
    s_add_u32 s6, s33, 344064
    s_add_u32 m0, s32, 5120
    s_nop 0
    buffer_load_dwordx4 v97, s[48:51], s6 offen nt lds
    s_add_u32 s6, s33, 258048
    s_add_u32 m0, s32, 6144
    s_nop 0
    buffer_load_dwordx4 v97, s[48:51], s6 offen nt lds
    s_add_u32 s6, s33, 372736
    s_add_u32 m0, s32, 7168
    s_nop 0
    buffer_load_dwordx4 v97, s[48:51], s6 offen nt lds
    s_add_u32 s6, s33, 458752
    s_add_u32 m0, s32, 8192
    s_nop 0
    buffer_load_dwordx4 v97, s[48:51], s6 offen nt lds
    s_add_u32 s6, s33, 573440
    s_add_u32 m0, s32, 9216
    s_nop 0
    buffer_load_dwordx4 v97, s[48:51], s6 offen nt lds
    s_add_u32 s6, s33, 487424
    s_add_u32 m0, s32, 10240
    s_nop 0
    buffer_load_dwordx4 v97, s[48:51], s6 offen nt lds
    s_add_u32 s6, s33, 602112
    s_add_u32 m0, s32, 11264
    s_nop 0
    buffer_load_dwordx4 v97, s[48:51], s6 offen nt lds
    s_add_u32 s6, s33, 688128
    s_add_u32 m0, s32, 12288
    s_nop 0
    buffer_load_dwordx4 v97, s[48:51], s6 offen nt lds
    s_add_u32 s6, s33, 802816
    s_add_u32 m0, s32, 13312
    s_nop 0
    buffer_load_dwordx4 v97, s[48:51], s6 offen nt lds
    s_add_u32 s6, s33, 716800
    s_add_u32 m0, s32, 14336
    s_nop 0
    buffer_load_dwordx4 v97, s[48:51], s6 offen nt lds
    s_add_u32 s6, s33, 831488
    s_add_u32 m0, s32, 15360
    s_nop 0
    buffer_load_dwordx4 v97, s[48:51], s6 offen nt lds
L_aux_one1:
    s_mov_b64 exec, 1
    ds_add_u32 v22, v23 offset:280
    s_mov_b64 exec, -1
    s_bfe_u32 s65, s60, 0x80000
    s_bfe_u32 s66, s60, 0x80008
    s_bfe_u32 s67, s60, 0x80010
    s_bfe_u32 s68, s60, 0x80018
    v_bfe_u32 v14, v1, 2, 3
    v_lshrrev_b32 v15, 1, v14
    v_lshlrev_b32 v14, 7, v14
    v_lshrrev_b32 v13, 5, v1
    v_lshl_add_u32 v14, v13, 10, v14
    v_and_b32 v13, 3, v1
    v_lshl_add_u32 v14, v13, 3, v14
    v_add_u32 v14, s32, v14
    v_xor_b32 v13, 0, v15
    v_lshl_add_u32 v24, v13, 5, v14
    v_xor_b32 v13, 1, v15
    v_lshl_add_u32 v25, v13, 5, v14
    v_xor_b32 v13, 2, v15
    v_lshl_add_u32 v26, v13, 5, v14
    v_xor_b32 v13, 3, v15
    v_lshl_add_u32 v27, v13, 5, v14
    v_min_u32 v20, 8, v2
    v_mul_u32_u24 v20, 1040, v20
    v_lshl_add_u32 v20, v3, 4, v20
    s_lshr_b32 s6, s32, 7
    s_add_u32 s6, s6, 131072
    v_add_u32 v20, s6, v20
    v_lshlrev_b32 v19, 6, v2
    v_lshl_add_u32 v19, v3, 4, v19
    s_lshr_b32 s6, s32, 11
    s_add_u32 s6, s6, s32
    s_add_u32 s6, s6, 24512
    v_add_u32 v19, s6, v19
    v_and_b32 v242, 7, v1
    v_lshl_add_u32 v243, v242, 2, v22
    v_bfe_u32 v241, v1, 3, 2
    v_mul_u32_u24 v241, 32784, v241
    v_lshrrev_b32 v240, 5, v1
    v_lshl_add_u32 v241, v240, 12, v241
    s_lshr_b32 s6, s32, 11
    s_add_u32 s6, s6, 24512
    v_add_u32 v241, s6, v241
    s_sub_u32 s6, s31, s30
    v_mul_i32_i24 v244, s6, v240
    v_lshl_add_u32 v244, v242, 4, v244
    v_bfe_u32 v240, v1, 4, 1
    v_lshl_add_u32 v244, v240, 9, v244
    v_bfe_u32 v240, v1, 3, 1
    v_lshl_add_u32 v244, v240, 10, v244
    s_lshr_b32 s6, s32, 8
    s_add_u32 s6, s6, s30
    s_add_u32 s6, s6, s64
    v_add_u32 v244, s6, v244
    v_lshl_add_u32 v242, v242, 6, v241
    v_mov_b32 v245, 0xffffff00
    v_cmp_eq_u32 s[70:71], 1, v240
    s_cmp_eq_u32 s62, 1
    s_cbranch_scc1 L_aux_one2
    s_waitcnt vmcnt(28)
    ds_read_b64_tr_b16 v[64:65], v24 offset:16384
    ds_read_b64_tr_b16 v[66:67], v24 offset:18432
    ds_read_b64_tr_b16 v[68:69], v25 offset:16384
    ds_read_b64_tr_b16 v[70:71], v25 offset:18432
    ds_read_b64_tr_b16 v[72:73], v26 offset:16384
    ds_read_b64_tr_b16 v[74:75], v26 offset:18432
    ds_read_b64_tr_b16 v[76:77], v27 offset:16384
    ds_read_b64_tr_b16 v[78:79], v27 offset:18432
    s_waitcnt vmcnt(24)
    ds_read_b64_tr_b16 v[96:97], v24 offset:20480
    ds_read_b64_tr_b16 v[98:99], v24 offset:22528
    ds_read_b64_tr_b16 v[100:101], v25 offset:20480
    ds_read_b64_tr_b16 v[102:103], v25 offset:22528
    ds_read_b64_tr_b16 v[104:105], v26 offset:20480
    ds_read_b64_tr_b16 v[106:107], v26 offset:22528
    ds_read_b64_tr_b16 v[108:109], v27 offset:20480
    ds_read_b64_tr_b16 v[110:111], v27 offset:22528
    s_waitcnt vmcnt(20)
    ds_read_b64_tr_b16 v[128:129], v24 offset:24576
    ds_read_b64_tr_b16 v[130:131], v24 offset:26624
    ds_read_b64_tr_b16 v[132:133], v25 offset:24576
    ds_read_b64_tr_b16 v[134:135], v25 offset:26624
    ds_read_b64_tr_b16 v[136:137], v26 offset:24576
    ds_read_b64_tr_b16 v[138:139], v26 offset:26624
    ds_read_b64_tr_b16 v[140:141], v27 offset:24576
    ds_read_b64_tr_b16 v[142:143], v27 offset:26624
    s_waitcnt vmcnt(16)
    ds_read_b64_tr_b16 v[160:161], v24 offset:28672
    ds_read_b64_tr_b16 v[162:163], v24 offset:30720
    ds_read_b64_tr_b16 v[164:165], v25 offset:28672
    ds_read_b64_tr_b16 v[166:167], v25 offset:30720
    ds_read_b64_tr_b16 v[168:169], v26 offset:28672
    ds_read_b64_tr_b16 v[170:171], v26 offset:30720
    ds_read_b64_tr_b16 v[172:173], v27 offset:28672
    ds_read_b64_tr_b16 v[174:175], v27 offset:30720
    s_waitcnt vmcnt(12)
    ds_read_b64_tr_b16 v[80:81], v24 offset:0
    ds_read_b64_tr_b16 v[82:83], v24 offset:2048
    ds_read_b64_tr_b16 v[84:85], v25 offset:0
    ds_read_b64_tr_b16 v[86:87], v25 offset:2048
    ds_read_b64_tr_b16 v[88:89], v26 offset:0
    ds_read_b64_tr_b16 v[90:91], v26 offset:2048
    ds_read_b64_tr_b16 v[92:93], v27 offset:0
    ds_read_b64_tr_b16 v[94:95], v27 offset:2048
    s_waitcnt vmcnt(8)
    ds_read_b64_tr_b16 v[112:113], v24 offset:4096
    ds_read_b64_tr_b16 v[114:115], v24 offset:6144
    ds_read_b64_tr_b16 v[116:117], v25 offset:4096
    ds_read_b64_tr_b16 v[118:119], v25 offset:6144
    ds_read_b64_tr_b16 v[120:121], v26 offset:4096
    ds_read_b64_tr_b16 v[122:123], v26 offset:6144
    ds_read_b64_tr_b16 v[124:125], v27 offset:4096
    ds_read_b64_tr_b16 v[126:127], v27 offset:6144
    s_waitcnt vmcnt(4)
    ds_read_b64_tr_b16 v[144:145], v24 offset:8192
    ds_read_b64_tr_b16 v[146:147], v24 offset:10240
    ds_read_b64_tr_b16 v[148:149], v25 offset:8192
    ds_read_b64_tr_b16 v[150:151], v25 offset:10240
    ds_read_b64_tr_b16 v[152:153], v26 offset:8192
    ds_read_b64_tr_b16 v[154:155], v26 offset:10240
    ds_read_b64_tr_b16 v[156:157], v27 offset:8192
    ds_read_b64_tr_b16 v[158:159], v27 offset:10240
    s_waitcnt vmcnt(0)
    ds_read_b64_tr_b16 v[176:177], v24 offset:12288
    ds_read_b64_tr_b16 v[178:179], v24 offset:14336
    ds_read_b64_tr_b16 v[180:181], v25 offset:12288
    ds_read_b64_tr_b16 v[182:183], v25 offset:14336
    ds_read_b64_tr_b16 v[184:185], v26 offset:12288
    ds_read_b64_tr_b16 v[186:187], v26 offset:14336
    ds_read_b64_tr_b16 v[188:189], v27 offset:12288
    ds_read_b64_tr_b16 v[190:191], v27 offset:14336
    s_branch L_aux_two2
L_aux_one2:
    s_waitcnt vmcnt(12)
    ds_read_b64_tr_b16 v[64:65], v24 offset:16384
    ds_read_b64_tr_b16 v[66:67], v24 offset:18432
    ds_read_b64_tr_b16 v[68:69], v25 offset:16384
    ds_read_b64_tr_b16 v[70:71], v25 offset:18432
    ds_read_b64_tr_b16 v[72:73], v26 offset:16384
    ds_read_b64_tr_b16 v[74:75], v26 offset:18432
    ds_read_b64_tr_b16 v[76:77], v27 offset:16384
    ds_read_b64_tr_b16 v[78:79], v27 offset:18432
    s_waitcnt vmcnt(8)
    ds_read_b64_tr_b16 v[96:97], v24 offset:20480
    ds_read_b64_tr_b16 v[98:99], v24 offset:22528
    ds_read_b64_tr_b16 v[100:101], v25 offset:20480
    ds_read_b64_tr_b16 v[102:103], v25 offset:22528
    ds_read_b64_tr_b16 v[104:105], v26 offset:20480
    ds_read_b64_tr_b16 v[106:107], v26 offset:22528
    ds_read_b64_tr_b16 v[108:109], v27 offset:20480
    ds_read_b64_tr_b16 v[110:111], v27 offset:22528
    s_waitcnt vmcnt(4)
    ds_read_b64_tr_b16 v[128:129], v24 offset:24576
    ds_read_b64_tr_b16 v[130:131], v24 offset:26624
    ds_read_b64_tr_b16 v[132:133], v25 offset:24576
    ds_read_b64_tr_b16 v[134:135], v25 offset:26624
    ds_read_b64_tr_b16 v[136:137], v26 offset:24576
    ds_read_b64_tr_b16 v[138:139], v26 offset:26624
    ds_read_b64_tr_b16 v[140:141], v27 offset:24576
    ds_read_b64_tr_b16 v[142:143], v27 offset:26624
    s_waitcnt vmcnt(0)
    ds_read_b64_tr_b16 v[160:161], v24 offset:28672
    ds_read_b64_tr_b16 v[162:163], v24 offset:30720
    ds_read_b64_tr_b16 v[164:165], v25 offset:28672
    ds_read_b64_tr_b16 v[166:167], v25 offset:30720
    ds_read_b64_tr_b16 v[168:169], v26 offset:28672
    ds_read_b64_tr_b16 v[170:171], v26 offset:30720
    ds_read_b64_tr_b16 v[172:173], v27 offset:28672
    ds_read_b64_tr_b16 v[174:175], v27 offset:30720
L_aux_two2:
    s_waitcnt lgkmcnt(0)
    s_mov_b32 s11, 0
L_lw_xs:
    ds_read_b32 v18, v22 offset:272
    s_add_u32 s11, s11, 1
    s_cmp_ge_u32 s11, 524288
    s_cbranch_scc1 L_lwx_xs
    s_waitcnt lgkmcnt(0)
    v_readfirstlane_b32 s8, v18
    s_cmp_ge_u32 s8, 2
    s_cbranch_scc1 L_lwx_xs
    s_branch L_lw_xs
L_lwx_xs:
    s_waitcnt lgkmcnt(0)
    ds_read_b32 v28, v243 offset:192
    ds_read_b128 v[32:35], v20 offset:0
    ds_read_b128 v[36:39], v20 offset:64
    ds_read_b128 v[40:43], v20 offset:128
    ds_read_b128 v[44:47], v20 offset:192
    s_waitcnt lgkmcnt(3)
    v_mfma_f32_16x16x32_bf16 v[192:195], v[64:67], v[32:35], 0
    s_waitcnt lgkmcnt(2)
    v_mfma_f32_16x16x32_bf16 v[192:195], v[96:99], v[36:39], v[192:195]
    s_waitcnt lgkmcnt(1)
    v_mfma_f32_16x16x32_bf16 v[192:195], v[128:131], v[40:43], v[192:195]
    s_waitcnt lgkmcnt(0)
    v_mfma_f32_16x16x32_bf16 v[192:195], v[160:163], v[44:47], v[192:195]
    v_mfma_f32_16x16x32_bf16 v[196:199], v[68:71], v[32:35], 0
    v_mfma_f32_16x16x32_bf16 v[196:199], v[100:103], v[36:39], v[196:199]
    v_mfma_f32_16x16x32_bf16 v[196:199], v[132:135], v[40:43], v[196:199]
    v_mfma_f32_16x16x32_bf16 v[196:199], v[164:167], v[44:47], v[196:199]
    v_mfma_f32_16x16x32_bf16 v[200:203], v[72:75], v[32:35], 0
    v_mfma_f32_16x16x32_bf16 v[200:203], v[104:107], v[36:39], v[200:203]
    v_mfma_f32_16x16x32_bf16 v[200:203], v[136:139], v[40:43], v[200:203]
    v_mfma_f32_16x16x32_bf16 v[200:203], v[168:171], v[44:47], v[200:203]
    ds_write_b128 v19, v[192:195] offset:0
    v_mfma_f32_16x16x32_bf16 v[204:207], v[76:79], v[32:35], 0
    v_mfma_f32_16x16x32_bf16 v[204:207], v[108:111], v[36:39], v[204:207]
    v_mfma_f32_16x16x32_bf16 v[204:207], v[140:143], v[40:43], v[204:207]
    v_mfma_f32_16x16x32_bf16 v[204:207], v[172:175], v[44:47], v[204:207]
    ds_write_b128 v19, v[196:199] offset:1024
    s_cmp_eq_u32 s62, 1
    s_cbranch_scc1 L_aux_one3
    v_mfma_f32_16x16x32_bf16 v[208:211], v[80:83], v[32:35], 0
    v_mfma_f32_16x16x32_bf16 v[208:211], v[112:115], v[36:39], v[208:211]
    v_mfma_f32_16x16x32_bf16 v[208:211], v[144:147], v[40:43], v[208:211]
    v_mfma_f32_16x16x32_bf16 v[208:211], v[176:179], v[44:47], v[208:211]
    ds_write_b128 v19, v[200:203] offset:2048
    v_mfma_f32_16x16x32_bf16 v[212:215], v[84:87], v[32:35], 0
    v_mfma_f32_16x16x32_bf16 v[212:215], v[116:119], v[36:39], v[212:215]
    v_mfma_f32_16x16x32_bf16 v[212:215], v[148:151], v[40:43], v[212:215]
    v_mfma_f32_16x16x32_bf16 v[212:215], v[180:183], v[44:47], v[212:215]
    ds_write_b128 v19, v[204:207] offset:3072
    v_mfma_f32_16x16x32_bf16 v[216:219], v[88:91], v[32:35], 0
    v_mfma_f32_16x16x32_bf16 v[216:219], v[120:123], v[36:39], v[216:219]
    v_mfma_f32_16x16x32_bf16 v[216:219], v[152:155], v[40:43], v[216:219]
    v_mfma_f32_16x16x32_bf16 v[216:219], v[184:187], v[44:47], v[216:219]
    ds_write_b128 v19, v[208:211] offset:4096
    v_mfma_f32_16x16x32_bf16 v[220:223], v[92:95], v[32:35], 0
    v_mfma_f32_16x16x32_bf16 v[220:223], v[124:127], v[36:39], v[220:223]
    v_mfma_f32_16x16x32_bf16 v[220:223], v[156:159], v[40:43], v[220:223]
    v_mfma_f32_16x16x32_bf16 v[220:223], v[188:191], v[44:47], v[220:223]
    ds_write_b128 v19, v[212:215] offset:5120
    s_nop 1
    ds_write_b128 v19, v[216:219] offset:6144
    s_nop 3
    ds_write_b128 v19, v[220:223] offset:7168
    s_branch L_aux_two3
L_aux_one3:
    s_nop 7
    ds_write_b128 v19, v[200:203] offset:2048
    ds_write_b128 v19, v[204:207] offset:3072
L_aux_two3:
    s_mov_b64 exec, 1
    ds_add_u32 v22, v23 offset:276
    s_mov_b64 exec, -1
    v_and_b32 v25, 0xffff0000, v28
    v_lshlrev_b32 v24, 16, v28
    v_rcp_f32 v25, v25
    s_mov_b32 s11, 0
L_lw_pp:
    ds_read_b32 v18, v22 offset:276
    s_add_u32 s11, s11, 1
    s_cmp_ge_u32 s11, 524288
    s_cbranch_scc1 L_lwx_pp
    s_waitcnt lgkmcnt(0)
    v_readfirstlane_b32 s8, v18
    s_cmp_ge_u32 s8, 4
    s_cbranch_scc1 L_lwx_pp
    s_branch L_lw_pp
L_lwx_pp:
    s_waitcnt lgkmcnt(0)
    ds_read_b128 v[64:67], v242 offset:0
    ds_read_b128 v[72:75], v241 offset:512
    ds_read_b128 v[68:71], v242 offset:2048
    ds_read_b128 v[76:79], v241 offset:2560
    ds_read_b128 v[80:83], v242 offset:1024
    ds_read_b128 v[88:91], v241 offset:1536
    ds_read_b128 v[84:87], v242 offset:3072
    ds_read_b128 v[92:95], v241 offset:3584
    s_cmp_eq_u32 s62, 1
    s_cselect_b32 s6, 0, -1
    s_waitcnt lgkmcnt(4)
    v_pk_fma_f32 v[64:65], v[72:73], v[24:25], v[64:65] op_sel:[0,0,0] op_sel_hi:[1,0,1] neg_lo:[1,0,0] neg_hi:[1,0,0]
    v_pk_fma_f32 v[66:67], v[74:75], v[24:25], v[66:67] op_sel:[0,0,0] op_sel_hi:[1,0,1] neg_lo:[1,0,0] neg_hi:[1,0,0]
    v_pk_fma_f32 v[68:69], v[76:77], v[24:25], v[68:69] op_sel:[0,0,0] op_sel_hi:[1,0,1] neg_lo:[1,0,0] neg_hi:[1,0,0]
    v_pk_fma_f32 v[70:71], v[78:79], v[24:25], v[70:71] op_sel:[0,0,0] op_sel_hi:[1,0,1] neg_lo:[1,0,0] neg_hi:[1,0,0]
    v_cndmask_b32 v72, v68, v64, s[70:71]
    v_cndmask_b32 v73, v69, v65, s[70:71]
    v_cndmask_b32 v74, v70, v66, s[70:71]
    v_cndmask_b32 v75, v71, v67, s[70:71]
    v_cndmask_b32 v64, v64, v68, s[70:71]
    v_cndmask_b32 v65, v65, v69, s[70:71]
    v_cndmask_b32 v66, v66, v70, s[70:71]
    v_cndmask_b32 v67, v67, v71, s[70:71]
    v_add_f32_dpp v64, v72, v64 row_ror:8 row_mask:0xf bank_mask:0xf
    v_add_f32_dpp v65, v73, v65 row_ror:8 row_mask:0xf bank_mask:0xf
    v_add_f32_dpp v66, v74, v66 row_ror:8 row_mask:0xf bank_mask:0xf
    v_add_f32_dpp v67, v75, v67 row_ror:8 row_mask:0xf bank_mask:0xf
    s_waitcnt lgkmcnt(0)
    v_pk_fma_f32 v[80:81], v[88:89], v[24:25], v[80:81] op_sel:[0,0,0] op_sel_hi:[1,0,1] neg_lo:[1,0,0] neg_hi:[1,0,0]
    v_pk_fma_f32 v[82:83], v[90:91], v[24:25], v[82:83] op_sel:[0,0,0] op_sel_hi:[1,0,1] neg_lo:[1,0,0] neg_hi:[1,0,0]
    v_pk_fma_f32 v[84:85], v[92:93], v[24:25], v[84:85] op_sel:[0,0,0] op_sel_hi:[1,0,1] neg_lo:[1,0,0] neg_hi:[1,0,0]
    v_pk_fma_f32 v[86:87], v[94:95], v[24:25], v[86:87] op_sel:[0,0,0] op_sel_hi:[1,0,1] neg_lo:[1,0,0] neg_hi:[1,0,0]
    v_cndmask_b32 v88, v84, v80, s[70:71]
    v_cndmask_b32 v89, v85, v81, s[70:71]
    v_cndmask_b32 v90, v86, v82, s[70:71]
    v_cndmask_b32 v91, v87, v83, s[70:71]
    v_cndmask_b32 v80, v80, v84, s[70:71]
    v_cndmask_b32 v81, v81, v85, s[70:71]
    v_cndmask_b32 v82, v82, v86, s[70:71]
    v_cndmask_b32 v83, v83, v87, s[70:71]
    v_add_f32_dpp v80, v88, v80 row_ror:8 row_mask:0xf bank_mask:0xf
    v_add_f32_dpp v81, v89, v81 row_ror:8 row_mask:0xf bank_mask:0xf
    v_add_f32_dpp v82, v90, v82 row_ror:8 row_mask:0xf bank_mask:0xf
    v_add_f32_dpp v83, v91, v83 row_ror:8 row_mask:0xf bank_mask:0xf
    v_permlane16_swap_b32 v64, v80
    v_permlane16_swap_b32 v65, v81
    v_permlane16_swap_b32 v66, v82
    v_permlane16_swap_b32 v67, v83
    v_pk_add_f32 v[64:65], v[64:65], v[80:81]
    v_pk_add_f32 v[66:67], v[66:67], v[82:83]
    v_pk_mul_f32 v[64:65], v[64:65], v[24:25] op_sel:[0,1] op_sel_hi:[1,1]
    v_pk_mul_f32 v[66:67], v[66:67], v[24:25] op_sel:[0,1] op_sel_hi:[1,1]
    v_and_or_b32 v64, v64, v245, s65
    v_and_or_b32 v65, v65, v245, s66
    v_and_or_b32 v66, v66, v245, s67
    v_and_or_b32 v67, v67, v245, s68
    s_mov_b32 exec_hi, s6
    buffer_store_dwordx4 v[64:67], v244, s[40:43], 0 offen sc1
    s_mov_b64 exec, 1
    ds_add_u32 v22, v23 offset:292
    s_mov_b64 exec, -1
    s_branch L_aux_b5
L_aux_idle:
    s_mov_b32 s11, 0
L_lw_id:
    ds_read_b32 v18, v22 offset:260
    s_add_u32 s11, s11, 1
    s_cmp_ge_u32 s11, 524288
    s_cbranch_scc1 L_lwx_id
    s_waitcnt lgkmcnt(0)
    v_readfirstlane_b32 s8, v18
    s_cmp_ge_u32 s8, 1
    s_cbranch_scc1 L_lwx_id
    s_sleep 1
    s_branch L_lw_id
L_lwx_id:
    s_waitcnt lgkmcnt(0)
    ds_read_b32 v18, v22 offset:284
    s_waitcnt lgkmcnt(0)
    v_readfirstlane_b32 s60, v18
    s_bfe_u32 s65, s60, 0x80000
    s_bfe_u32 s66, s60, 0x80008
    s_bfe_u32 s67, s60, 0x80010
    s_bfe_u32 s68, s60, 0x80018
    s_mov_b64 exec, 1
    ds_add_u32 v22, v23 offset:292
    s_mov_b64 exec, -1
    s_branch L_aux_b5
L_aux_b4:
L_aux_b5:
    v_bfe_u32 v11, v1, 1, 1
    v_bfe_u32 v10, v1, 2, 2
    v_lshl_add_u32 v10, v11, 2, v10
    v_lshl_add_u32 v10, v3, 3, v10
    v_bfe_u32 v11, v10, 1, 3
    v_xor_b32 v11, s56, v11
    v_lshlrev_b32 v10, 7, v10
    v_lshl_add_u32 v10, v11, 4, v10
    v_and_b32 v11, 1, v1
    v_lshl_add_u32 v10, v11, 3, v10
    v_add_u32 v11, 0x10000, v10
    v_lshl_add_u32 v14, v0, 4, s64
    v_lshlrev_b32 v15, 3, v1
    v_add_u32 v15, 131072, v15
    s_lshl_b32 s6, s56, 9
    v_add_u32 v16, s6, v15
    s_mov_b32 s21, 7168
    s_mov_b32 s22, 14336
    s_mov_b32 s23, 21504
    s_mov_b32 s24, 28672
    s_mov_b32 s25, 35840
    s_mov_b32 s26, 43008
    s_mov_b32 s27, 50176
    s_mov_b32 s18, 0xbfb8aa3b
    s_mov_b32 s16, 0
    v_mov_b32 v17, 0xff
    v_mov_b32 v245, 0xffffff00
    s_lshl_b32 s6, s63, 3
    s_add_u32 s6, s6, s56
    s_lshl_b32 s6, s6, 3
    s_add_u32 s6, s6, s57
    s_lshl_b32 s6, s6, 8
    s_add_u32 s6, s6, 491520
    v_lshlrev_b32 v12, 7, v3
    v_lshl_add_u32 v12, v2, 4, v12
    v_add_u32 v12, s6, v12
    s_barrier
    ds_read_b64_tr_b16 v[64:65], v10 offset:0
    ds_read_b64_tr_b16 v[66:67], v10 offset:4096
    ds_read_b64_tr_b16 v[68:69], v10 offset:8192
    ds_read_b64_tr_b16 v[70:71], v10 offset:12288
    ds_read_b64_tr_b16 v[72:73], v10 offset:32768
    ds_read_b64_tr_b16 v[74:75], v10 offset:36864
    ds_read_b64_tr_b16 v[76:77], v10 offset:40960
    ds_read_b64_tr_b16 v[78:79], v10 offset:45056
    ds_read_b64_tr_b16 v[80:81], v11 offset:0
    ds_read_b64_tr_b16 v[82:83], v11 offset:4096
    ds_read_b64_tr_b16 v[84:85], v11 offset:8192
    ds_read_b64_tr_b16 v[86:87], v11 offset:12288
    ds_read_b64_tr_b16 v[88:89], v11 offset:32768
    ds_read_b64_tr_b16 v[90:91], v11 offset:36864
    s_cmp_eq_u32 s56, 7
    s_cbranch_scc1 L_aux_nohp
    s_sleep 3
    buffer_load_dwordx4 v[128:131], v14, s[40:43], 0 offen sc1
    buffer_load_dwordx4 v[132:135], v14, s[40:43], s21 offen sc1
    buffer_load_dwordx4 v[136:139], v14, s[40:43], s22 offen sc1
    buffer_load_dwordx4 v[140:143], v14, s[40:43], s23 offen sc1
    buffer_load_dwordx4 v[144:147], v14, s[40:43], s24 offen sc1
    buffer_load_dwordx4 v[148:151], v14, s[40:43], s25 offen sc1
    buffer_load_dwordx4 v[152:155], v14, s[40:43], s26 offen sc1
    buffer_load_dwordx4 v[156:159], v14, s[40:43], s27 offen sc1
L_aux_gp:
    s_waitcnt vmcnt(0)
    v_bitop3_b32 v32, v128, v132, s65 bitop3:0x7e
    v_bitop3_b32 v36, v136, v140, s65 bitop3:0x7e
    v_bitop3_b32 v40, v144, v148, s65 bitop3:0x7e
    v_bitop3_b32 v44, v152, v156, s65 bitop3:0x7e
    v_bitop3_b32 v33, v129, v133, s66 bitop3:0x7e
    v_bitop3_b32 v37, v137, v141, s66 bitop3:0x7e
    v_bitop3_b32 v41, v145, v149, s66 bitop3:0x7e
    v_bitop3_b32 v45, v153, v157, s66 bitop3:0x7e
    v_bitop3_b32 v34, v130, v134, s67 bitop3:0x7e
    v_bitop3_b32 v38, v138, v142, s67 bitop3:0x7e
    v_bitop3_b32 v42, v146, v150, s67 bitop3:0x7e
    v_bitop3_b32 v46, v154, v158, s67 bitop3:0x7e
    v_bitop3_b32 v35, v131, v135, s68 bitop3:0x7e
    v_bitop3_b32 v39, v139, v143, s68 bitop3:0x7e
    v_bitop3_b32 v43, v147, v151, s68 bitop3:0x7e
    v_bitop3_b32 v47, v155, v159, s68 bitop3:0x7e
    v_or3_b32 v32, v32, v33, v34
    v_or3_b32 v36, v36, v37, v38
    v_or3_b32 v40, v40, v41, v42
    v_or3_b32 v44, v44, v45, v46
    v_bitop3_b32 v32, v32, v35, v17 bitop3:0xa8
    v_bitop3_b32 v36, v36, v39, v17 bitop3:0xa8
    v_bitop3_b32 v40, v40, v43, v17 bitop3:0xa8
    v_bitop3_b32 v44, v44, v47, v17 bitop3:0xa8
    v_cmp_ne_u32 s[6:7], 0, v32
    v_cmp_ne_u32 s[8:9], 0, v36
    v_cmp_ne_u32 s[10:11], 0, v40
    v_cmp_ne_u32 s[12:13], 0, v44
    s_or_b64 vcc, s[6:7], s[8:9]
    s_or_b64 s[14:15], s[10:11], s[12:13]
    s_or_b64 vcc, vcc, s[14:15]
    s_cbranch_scc0 L_aux_gok
    s_add_u32 s16, s16, 1
    s_cmp_ge_u32 s16, 65536
    s_cbranch_scc1 L_aux_gok
    s_sleep 2
    s_mov_b64 exec, s[6:7]
    s_cbranch_execz L_aux_gs0
    buffer_load_dwordx4 v[128:131], v14, s[40:43], 0 offen sc1
    buffer_load_dwordx4 v[132:135], v14, s[40:43], s21 offen sc1
L_aux_gs0:
    s_mov_b64 exec, s[8:9]
    s_cbranch_execz L_aux_gs1
    buffer_load_dwordx4 v[136:139], v14, s[40:43], s22 offen sc1
    buffer_load_dwordx4 v[140:143], v14, s[40:43], s23 offen sc1
L_aux_gs1:
    s_mov_b64 exec, s[10:11]
    s_cbranch_execz L_aux_gs2
    buffer_load_dwordx4 v[144:147], v14, s[40:43], s24 offen sc1
    buffer_load_dwordx4 v[148:151], v14, s[40:43], s25 offen sc1
L_aux_gs2:
    s_mov_b64 exec, s[12:13]
    s_cbranch_execz L_aux_gs3
    buffer_load_dwordx4 v[152:155], v14, s[40:43], s26 offen sc1
    buffer_load_dwordx4 v[156:159], v14, s[40:43], s27 offen sc1
L_aux_gs3:
    s_mov_b64 exec, -1
    s_branch L_aux_gp
L_aux_gok:
    v_pk_add_f32 v[128:129], v[128:129], v[144:145]
    v_pk_add_f32 v[130:131], v[130:131], v[146:147]
    v_pk_add_f32 v[132:133], v[132:133], v[148:149]
    v_pk_add_f32 v[134:135], v[134:135], v[150:151]
    v_pk_mul_f32 v[144:145], v[128:129], s[18:19] op_sel_hi:[1,0]
    v_pk_mul_f32 v[146:147], v[130:131], s[18:19] op_sel_hi:[1,0]
    v_pk_mul_f32 v[148:149], v[132:133], s[18:19] op_sel_hi:[1,0]
    v_pk_mul_f32 v[150:151], v[134:135], s[18:19] op_sel_hi:[1,0]
    v_exp_f32 v144, v144
    v_exp_f32 v145, v145
    v_exp_f32 v146, v146
    v_exp_f32 v147, v147
    v_pk_add_f32 v[136:137], v[136:137], v[152:153]
    v_pk_add_f32 v[138:139], v[138:139], v[154:155]
    v_exp_f32 v148, v148
    v_exp_f32 v149, v149
    v_exp_f32 v150, v150
    v_exp_f32 v151, v151
    v_pk_add_f32 v[140:141], v[140:141], v[156:157]
    v_pk_add_f32 v[142:143], v[142:143], v[158:159]
    v_pk_add_f32 v[144:145], v[144:145], 1.0 op_sel_hi:[1,0]
    v_pk_add_f32 v[146:147], v[146:147], 1.0 op_sel_hi:[1,0]
    v_pk_add_f32 v[148:149], v[148:149], 1.0 op_sel_hi:[1,0]
    v_pk_add_f32 v[150:151], v[150:151], 1.0 op_sel_hi:[1,0]
    v_rcp_f32 v144, v144
    v_rcp_f32 v145, v145
    v_rcp_f32 v146, v146
    v_rcp_f32 v147, v147
    v_pk_mul_f32 v[128:129], v[128:129], v[136:137]
    v_pk_mul_f32 v[130:131], v[130:131], v[138:139]
    v_rcp_f32 v148, v148
    v_rcp_f32 v149, v149
    v_rcp_f32 v150, v150
    v_rcp_f32 v151, v151
    v_pk_mul_f32 v[132:133], v[132:133], v[140:141]
    v_pk_mul_f32 v[134:135], v[134:135], v[142:143]
    v_pk_mul_f32 v[128:129], v[128:129], v[144:145]
    v_pk_mul_f32 v[130:131], v[130:131], v[146:147]
    v_cvt_pk_bf16_f32 v136, v128, v129
    v_cvt_pk_bf16_f32 v137, v130, v131
    ds_write_b64 v16, v[136:137] offset:0
    v_pk_mul_f32 v[132:133], v[132:133], v[148:149]
    v_pk_mul_f32 v[134:135], v[134:135], v[150:151]
    v_cvt_pk_bf16_f32 v140, v132, v133
    v_cvt_pk_bf16_f32 v141, v134, v135
    ds_write_b64 v16, v[140:141] offset:3584
L_aux_nohp:
    s_waitcnt lgkmcnt(0)
    s_barrier
    ds_read2st64_b64 v[96:99], v15 offset0:0 offset1:1
    ds_read2st64_b64 v[100:103], v15 offset0:2 offset1:3
    ds_read2st64_b64 v[104:107], v15 offset0:4 offset1:5
    ds_read2st64_b64 v[108:111], v15 offset0:6 offset1:7
    ds_read2st64_b64 v[112:115], v15 offset0:8 offset1:9
    ds_read2st64_b64 v[116:119], v15 offset0:10 offset1:11
    ds_read2st64_b64 v[120:123], v15 offset0:12 offset1:13
    s_waitcnt lgkmcnt(6)
    v_mfma_f32_16x16x32_bf16 v[32:35], v[64:67], v[96:99], 0
    s_waitcnt lgkmcnt(5)
    v_mfma_f32_16x16x32_bf16 v[32:35], v[68:71], v[100:103], v[32:35]
    s_waitcnt lgkmcnt(4)
    v_mfma_f32_16x16x32_bf16 v[32:35], v[72:75], v[104:107], v[32:35]
    s_waitcnt lgkmcnt(3)
    v_mfma_f32_16x16x32_bf16 v[32:35], v[76:79], v[108:111], v[32:35]
    s_waitcnt lgkmcnt(2)
    v_mfma_f32_16x16x32_bf16 v[32:35], v[80:83], v[112:115], v[32:35]
    s_waitcnt lgkmcnt(1)
    v_mfma_f32_16x16x32_bf16 v[32:35], v[84:87], v[116:119], v[32:35]
    s_waitcnt lgkmcnt(0)
    v_mfma_f32_16x16x32_bf16 v[32:35], v[88:91], v[120:123], v[32:35]
    s_nop 7
    v_mov_b32_dpp v36, v32 row_ror:8 row_mask:0xf bank_mask:0xf
    v_mov_b32_dpp v37, v33 row_ror:8 row_mask:0xf bank_mask:0xf
    v_mov_b32_dpp v38, v34 row_ror:8 row_mask:0xf bank_mask:0xf
    v_mov_b32_dpp v39, v35 row_ror:8 row_mask:0xf bank_mask:0xf
    v_permlane32_swap_b32 v36, v40
    v_permlane32_swap_b32 v37, v41
    v_permlane32_swap_b32 v38, v42
    v_permlane32_swap_b32 v39, v43
    v_pk_add_f32 v[32:33], v[32:33], v[40:41]
    v_pk_add_f32 v[34:35], v[34:35], v[42:43]
    v_and_or_b32 v32, v32, v245, s65
    v_and_or_b32 v33, v33, v245, s66
    v_and_or_b32 v34, v34, v245, s67
    v_and_or_b32 v35, v35, v245, s68
    s_mov_b64 exec, 0x00ff00ff
    buffer_store_dwordx4 v[32:35], v12, s[40:43], 0 offen sc1
    s_mov_b64 exec, -1
    s_lshl_b32 s6, s58, 3
    s_add_u32 s6, s6, s56
    s_cmp_lg_u32 s6, 632
    s_cbranch_scc1 L_aux_done
    v_lshlrev_b32 v21, 3, v1
    v_add_u32 v21, 2048, v21
    s_mov_b32 s11, 0
L_poll_ack:
    buffer_load_dwordx2 v[60:61], v21, s[40:43], 0 offen sc1
    s_waitcnt vmcnt(0)
    v_xor_b32 v14, s60, v60
    v_bitop3_b32 v14, v14, v61, s60 bitop3:0xf6
    v_cmp_ne_u32 vcc, 0, v14
    s_cbranch_vccz L_polled_ack
    s_add_u32 s11, s11, 1
    s_cmp_ge_u32 s11, 65536
    s_cbranch_scc1 L_polled_ack
    s_sleep 4
    s_branch L_poll_ack
L_polled_ack:
    v_mov_b32 v5, s60
    v_mov_b32 v4, 0
    s_mov_b64 exec, 1
    buffer_store_dword v5, v4, s[40:43], 0 offen sc1
L_aux_done:
    s_endpgm
L_aux_slow:
    s_waitcnt lgkmcnt(0)
    v_lshlrev_b32 v14, 5, v0
    v_add_u32 v14, 140432, v14
    ds_write_b128 v14, v[80:83]
    ds_write_b128 v14, v[84:87] offset:16
    s_mov_b64 exec, 1
    ds_add_u32 v22, v23 offset:256
    s_mov_b64 exec, -1
    s_cmp_ge_u32 s56, 2
    s_cbranch_scc1 L_aux_wd
    s_cmp_eq_u32 s56, 1
    s_cbranch_scc1 L_aux_nox
    s_mov_b32 s11, 0
L_lw_slow:
    ds_read_b32 v18, v22 offset:256
    s_add_u32 s11, s11, 1
    s_cmp_ge_u32 s11, 524288
    s_cbranch_scc1 L_lwx_slow
    s_waitcnt lgkmcnt(0)
    v_readfirstlane_b32 s8, v18
    s_cmp_ge_u32 s8, 4
    s_cbranch_scc1 L_lwx_slow
    s_branch L_lw_slow
L_lwx_slow:
    s_waitcnt lgkmcnt(0)
    v_lshlrev_b32 v14, 4, v1
    v_add_u32 v14, 140432, v14
    ds_read_b128 v[128:131], v14 offset:0
    ds_read_b128 v[132:135], v14 offset:1024
    ds_read_b128 v[136:139], v14 offset:2048
    ds_read_b128 v[140:143], v14 offset:3072
    ds_read_b128 v[144:147], v14 offset:4096
    ds_read_b128 v[148:151], v14 offset:5120
    ds_read_b128 v[152:155], v14 offset:6144
    ds_read_b128 v[156:159], v14 offset:7168
    s_waitcnt lgkmcnt(0)
    s_mov_b32 s8, 0
    v_mov_b32 v20, v1
    v_mov_b32 v17, 1
L_aux_slow2:
    v_max3_u32 v14, v128, v129, v130
    v_max3_u32 v14, v14, v131, v132
    v_max3_u32 v14, v14, v133, v134
    v_max3_u32 v14, v14, v135, v136
    v_max3_u32 v14, v14, v137, v138
    v_max3_u32 v14, v14, v139, v140
    v_max3_u32 v14, v14, v141, v142
    v_max3_u32 v14, v14, v143, v144
    v_max3_u32 v14, v14, v145, v146
    v_max3_u32 v14, v14, v147, v148
    v_max3_u32 v14, v14, v149, v150
    v_max3_u32 v14, v14, v151, v152
    v_max3_u32 v14, v14, v153, v154
    v_max3_u32 v14, v14, v155, v156
    v_max3_u32 v14, v14, v157, v158
    v_max_u32 v14, v14, v159
    s_nop 1
    v_max_u32_dpp v14, v14, v14 row_ror:8 row_mask:0xf bank_mask:0xf
    s_nop 1
    v_max_u32_dpp v14, v14, v14 row_ror:4 row_mask:0xf bank_mask:0xf
    s_nop 1
    v_max_u32_dpp v14, v14, v14 row_ror:2 row_mask:0xf bank_mask:0xf
    s_nop 1
    v_max_u32_dpp v14, v14, v14 row_ror:1 row_mask:0xf bank_mask:0xf
    v_mov_b32 v15, v14
    s_nop 1
    v_permlane16_swap_b32 v14, v15
    v_max_u32 v14, v14, v15
    v_mov_b32 v15, v14
    s_nop 1
    v_permlane32_swap_b32 v14, v15
    v_max_u32 v14, v14, v15
    v_cmp_eq_u32 vcc, s8, v20
    s_nop 1
    v_cndmask_b32 v17, v17, v14, vcc
    v_cmp_ne_u32 vcc, v14, v128
    s_nop 1
    v_cndmask_b32 v128, 0, v128, vcc
    v_cmp_ne_u32 vcc, v14, v129
    s_nop 1
    v_cndmask_b32 v129, 0, v129, vcc
    v_cmp_ne_u32 vcc, v14, v130
    s_nop 1
    v_cndmask_b32 v130, 0, v130, vcc
    v_cmp_ne_u32 vcc, v14, v131
    s_nop 1
    v_cndmask_b32 v131, 0, v131, vcc
    v_cmp_ne_u32 vcc, v14, v132
    s_nop 1
    v_cndmask_b32 v132, 0, v132, vcc
    v_cmp_ne_u32 vcc, v14, v133
    s_nop 1
    v_cndmask_b32 v133, 0, v133, vcc
    v_cmp_ne_u32 vcc, v14, v134
    s_nop 1
    v_cndmask_b32 v134, 0, v134, vcc
    v_cmp_ne_u32 vcc, v14, v135
    s_nop 1
    v_cndmask_b32 v135, 0, v135, vcc
    v_cmp_ne_u32 vcc, v14, v136
    s_nop 1
    v_cndmask_b32 v136, 0, v136, vcc
    v_cmp_ne_u32 vcc, v14, v137
    s_nop 1
    v_cndmask_b32 v137, 0, v137, vcc
    v_cmp_ne_u32 vcc, v14, v138
    s_nop 1
    v_cndmask_b32 v138, 0, v138, vcc
    v_cmp_ne_u32 vcc, v14, v139
    s_nop 1
    v_cndmask_b32 v139, 0, v139, vcc
    v_cmp_ne_u32 vcc, v14, v140
    s_nop 1
    v_cndmask_b32 v140, 0, v140, vcc
    v_cmp_ne_u32 vcc, v14, v141
    s_nop 1
    v_cndmask_b32 v141, 0, v141, vcc
    v_cmp_ne_u32 vcc, v14, v142
    s_nop 1
    v_cndmask_b32 v142, 0, v142, vcc
    v_cmp_ne_u32 vcc, v14, v143
    s_nop 1
    v_cndmask_b32 v143, 0, v143, vcc
    v_cmp_ne_u32 vcc, v14, v144
    s_nop 1
    v_cndmask_b32 v144, 0, v144, vcc
    v_cmp_ne_u32 vcc, v14, v145
    s_nop 1
    v_cndmask_b32 v145, 0, v145, vcc
    v_cmp_ne_u32 vcc, v14, v146
    s_nop 1
    v_cndmask_b32 v146, 0, v146, vcc
    v_cmp_ne_u32 vcc, v14, v147
    s_nop 1
    v_cndmask_b32 v147, 0, v147, vcc
    v_cmp_ne_u32 vcc, v14, v148
    s_nop 1
    v_cndmask_b32 v148, 0, v148, vcc
    v_cmp_ne_u32 vcc, v14, v149
    s_nop 1
    v_cndmask_b32 v149, 0, v149, vcc
    v_cmp_ne_u32 vcc, v14, v150
    s_nop 1
    v_cndmask_b32 v150, 0, v150, vcc
    v_cmp_ne_u32 vcc, v14, v151
    s_nop 1
    v_cndmask_b32 v151, 0, v151, vcc
    v_cmp_ne_u32 vcc, v14, v152
    s_nop 1
    v_cndmask_b32 v152, 0, v152, vcc
    v_cmp_ne_u32 vcc, v14, v153
    s_nop 1
    v_cndmask_b32 v153, 0, v153, vcc
    v_cmp_ne_u32 vcc, v14, v154
    s_nop 1
    v_cndmask_b32 v154, 0, v154, vcc
    v_cmp_ne_u32 vcc, v14, v155
    s_nop 1
    v_cndmask_b32 v155, 0, v155, vcc
    v_cmp_ne_u32 vcc, v14, v156
    s_nop 1
    v_cndmask_b32 v156, 0, v156, vcc
    v_cmp_ne_u32 vcc, v14, v157
    s_nop 1
    v_cndmask_b32 v157, 0, v157, vcc
    v_cmp_ne_u32 vcc, v14, v158
    s_nop 1
    v_cndmask_b32 v158, 0, v158, vcc
    v_cmp_ne_u32 vcc, v14, v159
    s_nop 1
    v_cndmask_b32 v159, 0, v159, vcc
    s_add_u32 s8, s8, 1
    s_cmp_lt_u32 s8, 8
    s_cbranch_scc1 L_aux_slow2
    v_and_b32 v60, 0xfff, v17
    v_sub_u32 v60, 0x800, v60
    v_lshlrev_b32 v15, 2, v60
    ds_read_b32 v62, v15
    v_and_b32 v14, 0xffff0000, v17
    v_ashrrev_i32 v15, 31, v14
    v_not_b32 v15, v15
    v_or_b32 v15, 0x80000000, v15
    v_xor_b32 v14, v14, v15
    v_and_b32 v14, 0xffff0000, v14
    v_mul_f32 v14, 0xbfb8aa3b, v14
    v_exp_f32 v14, v14
    v_mov_b32 v63, s60
    v_add_f32 v14, 1.0, v14
    v_rcp_f32 v14, v14
    s_branch L_aux_sel
L_exit:
    s_endpgm
.p2align 6
L_conv:
    v_and_b32 v2, 15, v0
    v_bfe_u32 v3, v0, 4, 2
    s_getpc_b64 s[36:37]
L_pc_band:
    s_add_u32 s36, s36, L_bands-L_pc_band
    s_addc_u32 s37, s37, 0
    s_mov_b32 s38, 5120
    s_mov_b32 s39, 0x00020000
    v_lshlrev_b32 v10, 4, v1
    s_mov_b32 s53, 4096
    buffer_load_dwordx4 v[128:131], v10, s[36:39], 0 offen offset:0
    buffer_load_dwordx4 v[132:135], v10, s[36:39], 0 offen offset:1024
    buffer_load_dwordx4 v[136:139], v10, s[36:39], 0 offen offset:2048
    buffer_load_dwordx4 v[140:143], v10, s[36:39], 0 offen offset:3072
    buffer_load_dwordx4 v[124:127], v10, s[36:39], s53 offen
    s_mov_b64 s[36:37], s[4:5]
    s_mov_b32 s38, 4194304
    s_mov_b32 s39, 0x00020000
    s_mov_b64 s[40:41], s[34:35]
    s_mov_b32 s42, 753664
    s_mov_b32 s43, 0x00020000
    s_mov_b64 s[44:45], s[30:31]
    s_mov_b32 s46, 4194304
    s_mov_b32 s47, 0x00020000
    s_mov_b32 s48, 0x3fb8aa3b
    s_mov_b32 s49, 0x32a57060
    s_lshl_b32 s58, s57, 4
    s_cmp_lt_u32 s56, 4
    s_cbranch_scc1 L_conv_p
    s_setprio 1
L_conv_p:
    v_lshlrev_b32 v9, 13, v0
    v_add_u32 v9, s58, v9
    s_lshl_b32 s6, s3, 7
    s_lshl_b32 s7, s56, 4
    s_add_u32 s6, s6, s7
    s_lshl_b32 s6, s6, 11
    s_lshl_b32 s7, s59, 8
    s_add_u32 s6, s6, s7
    v_lshrrev_b32 v11, 1, v1
    v_lshlrev_b32 v11, 11, v11
    v_and_b32 v10, 1, v1
    v_lshl_add_u32 v11, v10, 7, v11
    v_add_u32 v11, s6, v11
    s_mul_i32 s6, s56, 3072
    s_add_u32 s6, s6, 67584
    s_mul_i32 s7, s56, 4608
    s_add_u32 s7, s7, 92160
    v_mov_b32 v64, 0
    v_mov_b32 v65, 0
    v_mov_b32 v66, 0
    v_mov_b32 v67, 0
    v_lshl_add_u32 v10, v1, 4, s6
    ds_write_b128 v10, v[64:67] offset:0
    ds_write_b128 v10, v[64:67] offset:1024
    ds_write_b128 v10, v[64:67] offset:2048
    v_lshl_add_u32 v10, v1, 3, s7
    ds_write_b64 v10, v[64:65]
    v_lshlrev_b32 v10, 5, v2
    v_lshl_add_u32 v160, v3, 9, v10
    v_add_u32 v160, s6, v160
    v_add_u32 v160, 1084, v160
    v_and_b32 v12, 1, v3
    v_lshl_add_u32 v161, v12, 4, v10
    v_lshrrev_b32 v12, 1, v3
    v_lshl_add_u32 v161, v12, 9, v161
    v_add3_u32 v161, v161, s6, 64
    v_and_b32 v12, 1, v2
    v_lshrrev_b32 v13, 1, v2
    v_lshlrev_b32 v162, 2, v13
    v_lshl_add_u32 v162, v3, 6, v162
    v_mul_u32_u24 v13, 260, v12
    v_add3_u32 v162, v162, v13, s6
    v_add_u32 v162, 2172, v162
    v_lshlrev_b32 v163, 1, v2
    v_lshl_add_u32 v163, v3, 7, v163
    v_lshl_add_u32 v163, v12, 2, v163
    v_add_u32 v163, s6, v163
    v_add_u32 v163, 2812, v163
    v_mov_b32 v164, v163
    s_add_u32 s54, s6, 2428
    v_writelane_b32 v164, s54, 0
    v_lshl_add_u32 v10, v2, 2, s6
    v_lshlrev_b32 v12, 5, v3
    v_sub_u32 v165, v10, v12
    v_add_u32 v165, 104, v165
    v_add_u32 v166, 1024, v165
    v_add_u32 v167, 2048, v165
    v_lshlrev_b32 v12, 4, v3
    v_sub_u32 v168, v10, v12
    v_add_u32 v168, 2292, v168
    v_mov_b32 v169, 0
    v_writelane_b32 v169, -1, 0
    s_mov_b32 s62, 0
    s_mov_b32 s63, 1
    s_mul_i32 s8, s56, 8448
    s_mov_b32 m0, s8
    v_bfe_u32 v10, v0, 2, 2
    v_mul_u32_u24 v10, 4160, v10
    v_lshrrev_b32 v12, 4, v0
    v_lshl_add_u32 v10, v12, 5, v10
    v_and_b32 v12, 3, v0
    v_lshl_add_u32 v10, v12, 3, v10
    v_add_u32 v4, 129024, v10
    v_lshlrev_b32 v10, 11, v0
    v_add_u32 v174, s58, v10
    v_lshlrev_b32 v10, 3, v0
    v_add_u32 v220, 92672, v10
    v_add_u32 v222, 129024, v10
    v_and_b32 v12, 1, v0
    v_lshlrev_b32 v12, 13, v12
    v_lshrrev_b32 v13, 1, v0
    v_lshl_add_u32 v12, v13, 4, v12
    v_add_u32 v221, 4096, v12
    v_lshrrev_b32 v10, 3, v1
    v_lshlrev_b32 v10, 4, v10
    v_add_u32 v223, 24576, v10
    s_mov_b32 s53, 4096
    s_mov_b32 s50, 0x100000
    s_mov_b32 s51, 0x200000
    s_mov_b32 s64, 0x05040100
    s_mov_b32 s65, 0x07060302
    v_lshl_add_u32 v5, v1, 3, s8
    v_mul_u32_u24 v6, 528, v2
    v_and_b32 v10, 1, v3
    v_lshl_add_u32 v6, v10, 8, v6
    v_lshrrev_b32 v10, 1, v3
    v_lshl_add_u32 v6, v10, 4, v6
    v_add_u32 v6, s8, v6
    v_lshlrev_b32 v10, 5, v2
    v_lshl_add_u32 v7, v3, 4, v10
    v_add3_u32 v7, v7, s7, 32
    s_mul_i32 s8, s56, 4160
    s_add_u32 s8, s8, 129024
    v_lshl_add_u32 v8, v3, 3, v10
    v_add_u32 v8, s8, v8
    s_waitcnt vmcnt(6)
L_conv_kg:
    s_mov_b32 exec_hi, 0
    buffer_load_dword v170, v11, s[36:39], 0 offen
    s_mov_b32 exec_hi, -1
    v_lshlrev_b32 v15, 16, v15
    v_lshlrev_b32 v116, 16, v16
    v_and_b32 v117, 0xffff0000, v16
    v_mul_f32 v112, s48, v15
    v_mul_f32 v114, s48, v116
    v_mul_f32 v118, s48, v117
    v_fma_f32 v113, v15, s48, -v112
    v_fma_f32 v115, v116, s48, -v114
    v_fma_f32 v119, v117, s48, -v118
    v_fma_f32 v113, v15, s49, v113
    v_fma_f32 v115, v116, s49, v115
    v_fma_f32 v119, v117, s49, v119
    v_exp_f32 v76, v112
    v_exp_f32 v72, v114
    v_exp_f32 v73, v118
    v_mul_f32 v113, 0x3f317218, v113
    v_mul_f32 v115, 0x3f317218, v115
    v_mul_f32 v119, 0x3f317218, v119
    v_fma_f32 v76, v76, v113, v76
    v_fma_f32 v72, v72, v115, v72
    v_fma_f32 v73, v73, v119, v73
    v_lshlrev_b32 v74, 16, v17
    v_and_b32 v75, 0xffff0000, v17
    v_cvt_pk_bf16_f32 v76, v76, v76
    v_cvt_pk_bf16_f32 v64, v72, v73
    v_and_b32 v76, 0xffff0000, v76
    v_lshlrev_b32 v72, 16, v64
    v_and_b32 v73, 0xffff0000, v64
    v_pk_mul_f32 v[74:75], v[74:75], v[76:77] op_sel_hi:[1,0]
    v_pk_mul_f32 v[72:73], v[72:73], v[76:77] op_sel_hi:[1,0]
    v_mul_f32 v74, 0.15915494, v74
    v_mul_f32 v72, 0xbfb8aa3b, v72
    v_mul_f32 v75, 0.15915494, v75
    v_mul_f32 v73, 0xbfb8aa3b, v73
    v_mul_f32 v112, 0x41000000, v72
    v_mul_f32 v113, 0x41000000, v74
    v_mul_f32 v114, 0x41000000, v73
    v_mul_f32 v115, 0x41000000, v75
    v_exp_f32 v112, v112
    v_fract_f32 v113, v113
    v_exp_f32 v114, v114
    v_fract_f32 v115, v115
    v_cos_f32 v24, v113
    v_sin_f32 v25, v113
    v_cos_f32 v26, v115
    v_sin_f32 v27, v115
    v_pk_mul_f32 v[24:25], v[24:25], v[112:113] op_sel:[0,0] op_sel_hi:[1,0] neg_hi:[1,0]
    v_pk_mul_f32 v[26:27], v[26:27], v[114:115] op_sel:[0,0] op_sel_hi:[1,0] neg_hi:[1,0]
    v_lshlrev_b32 v120, 16, v14
    v_mov_b32 v68, 0x3f80
    v_mov_b32 v69, 0x3f80
    ds_write_addtid_b32 v68 offset:0
    ds_write_addtid_b32 v69 offset:256
    v_cvt_pk_bf16_f32 v70, v24, v25
    v_cvt_pk_bf16_f32 v71, v26, v27
    ds_write_addtid_b32 v70 offset:528
    ds_write_addtid_b32 v71 offset:784
    v_pk_mul_f32 v[64:65], v[24:25], v[24:25] op_sel:[1,1] op_sel_hi:[1,0] neg_lo:[1,0]
    v_pk_mul_f32 v[66:67], v[26:27], v[26:27] op_sel:[1,1] op_sel_hi:[1,0] neg_lo:[1,0]
    v_pk_fma_f32 v[12:13], v[24:25], v[24:25], v[64:65] op_sel:[0,0,0] op_sel_hi:[0,1,1]
    v_pk_fma_f32 v[14:15], v[26:27], v[26:27], v[66:67] op_sel:[0,0,0] op_sel_hi:[0,1,1]
    v_cvt_pk_bf16_f32 v68, v12, v13
    v_cvt_pk_bf16_f32 v69, v14, v15
    ds_write_addtid_b32 v68 offset:1056
    ds_write_addtid_b32 v69 offset:1312
    v_pk_mul_f32 v[64:65], v[12:13], v[24:25] op_sel:[1,1] op_sel_hi:[1,0] neg_lo:[1,0]
    v_pk_mul_f32 v[66:67], v[14:15], v[26:27] op_sel:[1,1] op_sel_hi:[1,0] neg_lo:[1,0]
    v_pk_fma_f32 v[12:13], v[12:13], v[24:25], v[64:65] op_sel:[0,0,0] op_sel_hi:[0,1,1]
    v_pk_fma_f32 v[14:15], v[14:15], v[26:27], v[66:67] op_sel:[0,0,0] op_sel_hi:[0,1,1]
    v_cvt_pk_bf16_f32 v70, v12, v13
    v_cvt_pk_bf16_f32 v71, v14, v15
    ds_write_addtid_b32 v70 offset:1584
    ds_write_addtid_b32 v71 offset:1840
    v_add_f32 v77, v76, v76
    v_add_f32 v120, 1.0, v120
    v_lshlrev_b32 v32, 16, v18
    v_pk_mul_f32 v[64:65], v[12:13], v[24:25] op_sel:[1,1] op_sel_hi:[1,0] neg_lo:[1,0]
    v_pk_mul_f32 v[66:67], v[14:15], v[26:27] op_sel:[1,1] op_sel_hi:[1,0] neg_lo:[1,0]
    v_pk_fma_f32 v[12:13], v[12:13], v[24:25], v[64:65] op_sel:[0,0,0] op_sel_hi:[0,1,1]
    v_pk_fma_f32 v[14:15], v[14:15], v[26:27], v[66:67] op_sel:[0,0,0] op_sel_hi:[0,1,1]
    v_cvt_pk_bf16_f32 v68, v12, v13
    v_cvt_pk_bf16_f32 v69, v14, v15
    ds_write_addtid_b32 v68 offset:2112
    ds_write_addtid_b32 v69 offset:2368
    v_lshlrev_b32 v33, 16, v19
    v_and_b32 v34, 0xffff0000, v18
    v_and_b32 v35, 0xffff0000, v19
    v_pk_mul_f32 v[64:65], v[12:13], v[24:25] op_sel:[1,1] op_sel_hi:[1,0] neg_lo:[1,0]
    v_pk_mul_f32 v[66:67], v[14:15], v[26:27] op_sel:[1,1] op_sel_hi:[1,0] neg_lo:[1,0]
    v_pk_fma_f32 v[12:13], v[12:13], v[24:25], v[64:65] op_sel:[0,0,0] op_sel_hi:[0,1,1]
    v_pk_fma_f32 v[14:15], v[14:15], v[26:27], v[66:67] op_sel:[0,0,0] op_sel_hi:[0,1,1]
    v_cvt_pk_bf16_f32 v70, v12, v13
    v_cvt_pk_bf16_f32 v71, v14, v15
    ds_write_addtid_b32 v70 offset:2640
    ds_write_addtid_b32 v71 offset:2896
    v_and_b32 v169, v169, v120
    v_pk_mul_f32 v[32:33], v[32:33], v[76:77] op_sel:[0,1] op_sel_hi:[1,1]
    v_pk_mul_f32 v[34:35], v[34:35], v[76:77] op_sel:[0,1] op_sel_hi:[1,1]
    v_pk_mul_f32 v[64:65], v[12:13], v[24:25] op_sel:[1,1] op_sel_hi:[1,0] neg_lo:[1,0]
    v_pk_mul_f32 v[66:67], v[14:15], v[26:27] op_sel:[1,1] op_sel_hi:[1,0] neg_lo:[1,0]
    v_pk_fma_f32 v[12:13], v[12:13], v[24:25], v[64:65] op_sel:[0,0,0] op_sel_hi:[0,1,1]
    v_pk_fma_f32 v[14:15], v[14:15], v[26:27], v[66:67] op_sel:[0,0,0] op_sel_hi:[0,1,1]
    v_cvt_pk_bf16_f32 v68, v12, v13
    v_cvt_pk_bf16_f32 v69, v14, v15
    ds_write_addtid_b32 v68 offset:3168
    ds_write_addtid_b32 v69 offset:3424
    v_exp_f32 v112, v72
    v_fract_f32 v113, v74
    v_exp_f32 v114, v73
    v_pk_mul_f32 v[64:65], v[12:13], v[24:25] op_sel:[1,1] op_sel_hi:[1,0] neg_lo:[1,0]
    v_pk_mul_f32 v[66:67], v[14:15], v[26:27] op_sel:[1,1] op_sel_hi:[1,0] neg_lo:[1,0]
    v_pk_fma_f32 v[12:13], v[12:13], v[24:25], v[64:65] op_sel:[0,0,0] op_sel_hi:[0,1,1]
    v_pk_fma_f32 v[14:15], v[14:15], v[26:27], v[66:67] op_sel:[0,0,0] op_sel_hi:[0,1,1]
    v_cvt_pk_bf16_f32 v70, v12, v13
    v_cvt_pk_bf16_f32 v71, v14, v15
    ds_write_addtid_b32 v70 offset:3696
    ds_write_addtid_b32 v71 offset:3952
    v_fract_f32 v115, v75
    v_cos_f32 v20, v113
    v_sin_f32 v21, v113
    v_pk_mul_f32 v[64:65], v[12:13], v[24:25] op_sel:[1,1] op_sel_hi:[1,0] neg_lo:[1,0]
    v_pk_mul_f32 v[66:67], v[14:15], v[26:27] op_sel:[1,1] op_sel_hi:[1,0] neg_lo:[1,0]
    v_pk_fma_f32 v[12:13], v[12:13], v[24:25], v[64:65] op_sel:[0,0,0] op_sel_hi:[0,1,1]
    v_pk_fma_f32 v[14:15], v[14:15], v[26:27], v[66:67] op_sel:[0,0,0] op_sel_hi:[0,1,1]
    v_cvt_pk_bf16_f32 v68, v12, v13
    v_cvt_pk_bf16_f32 v69, v14, v15
    ds_write_addtid_b32 v68 offset:4224
    ds_write_addtid_b32 v69 offset:4480
    v_cos_f32 v22, v115
    v_sin_f32 v23, v115
    v_pk_mul_f32 v[20:21], v[20:21], v[112:113] op_sel:[0,0] op_sel_hi:[1,0]
    v_pk_mul_f32 v[64:65], v[12:13], v[24:25] op_sel:[1,1] op_sel_hi:[1,0] neg_lo:[1,0]
    v_pk_mul_f32 v[66:67], v[14:15], v[26:27] op_sel:[1,1] op_sel_hi:[1,0] neg_lo:[1,0]
    v_pk_fma_f32 v[12:13], v[12:13], v[24:25], v[64:65] op_sel:[0,0,0] op_sel_hi:[0,1,1]
    v_pk_fma_f32 v[14:15], v[14:15], v[26:27], v[66:67] op_sel:[0,0,0] op_sel_hi:[0,1,1]
    v_cvt_pk_bf16_f32 v70, v12, v13
    v_cvt_pk_bf16_f32 v71, v14, v15
    ds_write_addtid_b32 v70 offset:4752
    ds_write_addtid_b32 v71 offset:5008
    v_pk_mul_f32 v[22:23], v[22:23], v[114:115] op_sel:[0,0] op_sel_hi:[1,0]
    v_mul_f32 v112, 0x43000000, v72
    v_mul_f32 v113, 0x43000000, v74
    v_pk_mul_f32 v[64:65], v[12:13], v[24:25] op_sel:[1,1] op_sel_hi:[1,0] neg_lo:[1,0]
    v_pk_mul_f32 v[66:67], v[14:15], v[26:27] op_sel:[1,1] op_sel_hi:[1,0] neg_lo:[1,0]
    v_pk_fma_f32 v[12:13], v[12:13], v[24:25], v[64:65] op_sel:[0,0,0] op_sel_hi:[0,1,1]
    v_pk_fma_f32 v[14:15], v[14:15], v[26:27], v[66:67] op_sel:[0,0,0] op_sel_hi:[0,1,1]
    v_cvt_pk_bf16_f32 v68, v12, v13
    v_cvt_pk_bf16_f32 v69, v14, v15
    ds_write_addtid_b32 v68 offset:5280
    ds_write_addtid_b32 v69 offset:5536
    v_mul_f32 v114, 0x43000000, v73
    v_mul_f32 v115, 0x43000000, v75
    v_exp_f32 v112, v112
    v_pk_mul_f32 v[64:65], v[12:13], v[24:25] op_sel:[1,1] op_sel_hi:[1,0] neg_lo:[1,0]
    v_pk_mul_f32 v[66:67], v[14:15], v[26:27] op_sel:[1,1] op_sel_hi:[1,0] neg_lo:[1,0]
    v_pk_fma_f32 v[12:13], v[12:13], v[24:25], v[64:65] op_sel:[0,0,0] op_sel_hi:[0,1,1]
    v_pk_fma_f32 v[14:15], v[14:15], v[26:27], v[66:67] op_sel:[0,0,0] op_sel_hi:[0,1,1]
    v_cvt_pk_bf16_f32 v70, v12, v13
    v_cvt_pk_bf16_f32 v71, v14, v15
    ds_write_addtid_b32 v70 offset:5808
    ds_write_addtid_b32 v71 offset:6064
    v_fract_f32 v113, v113
    v_exp_f32 v114, v114
    v_fract_f32 v115, v115
    v_pk_mul_f32 v[64:65], v[12:13], v[24:25] op_sel:[1,1] op_sel_hi:[1,0] neg_lo:[1,0]
    v_pk_mul_f32 v[66:67], v[14:15], v[26:27] op_sel:[1,1] op_sel_hi:[1,0] neg_lo:[1,0]
    v_pk_fma_f32 v[12:13], v[12:13], v[24:25], v[64:65] op_sel:[0,0,0] op_sel_hi:[0,1,1]
    v_pk_fma_f32 v[14:15], v[14:15], v[26:27], v[66:67] op_sel:[0,0,0] op_sel_hi:[0,1,1]
    v_cvt_pk_bf16_f32 v68, v12, v13
    v_cvt_pk_bf16_f32 v69, v14, v15
    ds_write_addtid_b32 v68 offset:6336
    ds_write_addtid_b32 v69 offset:6592
    v_cos_f32 v28, v113
    v_sin_f32 v29, v113
    v_cos_f32 v30, v115
    v_pk_mul_f32 v[64:65], v[12:13], v[24:25] op_sel:[1,1] op_sel_hi:[1,0] neg_lo:[1,0]
    v_pk_mul_f32 v[66:67], v[14:15], v[26:27] op_sel:[1,1] op_sel_hi:[1,0] neg_lo:[1,0]
    v_pk_fma_f32 v[12:13], v[12:13], v[24:25], v[64:65] op_sel:[0,0,0] op_sel_hi:[0,1,1]
    v_pk_fma_f32 v[14:15], v[14:15], v[26:27], v[66:67] op_sel:[0,0,0] op_sel_hi:[0,1,1]
    v_cvt_pk_bf16_f32 v70, v12, v13
    v_cvt_pk_bf16_f32 v71, v14, v15
    ds_write_addtid_b32 v70 offset:6864
    ds_write_addtid_b32 v71 offset:7120
    v_sin_f32 v31, v115
    v_pk_mul_f32 v[28:29], v[28:29], v[112:113] op_sel:[0,0] op_sel_hi:[1,0]
    v_pk_mul_f32 v[30:31], v[30:31], v[114:115] op_sel:[0,0] op_sel_hi:[1,0]
    v_pk_mul_f32 v[64:65], v[12:13], v[24:25] op_sel:[1,1] op_sel_hi:[1,0] neg_lo:[1,0]
    v_pk_mul_f32 v[66:67], v[14:15], v[26:27] op_sel:[1,1] op_sel_hi:[1,0] neg_lo:[1,0]
    v_pk_fma_f32 v[12:13], v[12:13], v[24:25], v[64:65] op_sel:[0,0,0] op_sel_hi:[0,1,1]
    v_pk_fma_f32 v[14:15], v[14:15], v[26:27], v[66:67] op_sel:[0,0,0] op_sel_hi:[0,1,1]
    v_cvt_pk_bf16_f32 v68, v12, v13
    v_cvt_pk_bf16_f32 v69, v14, v15
    ds_write_addtid_b32 v68 offset:7392
    ds_write_addtid_b32 v69 offset:7648
    v_pk_mul_f32 v[64:65], v[12:13], v[24:25] op_sel:[1,1] op_sel_hi:[1,0] neg_lo:[1,0]
    v_pk_mul_f32 v[66:67], v[14:15], v[26:27] op_sel:[1,1] op_sel_hi:[1,0] neg_lo:[1,0]
    v_pk_fma_f32 v[12:13], v[12:13], v[24:25], v[64:65] op_sel:[0,0,0] op_sel_hi:[0,1,1]
    v_pk_fma_f32 v[14:15], v[14:15], v[26:27], v[66:67] op_sel:[0,0,0] op_sel_hi:[0,1,1]
    v_cvt_pk_bf16_f32 v70, v12, v13
    v_cvt_pk_bf16_f32 v71, v14, v15
    ds_write_addtid_b32 v70 offset:7920
    ds_write_addtid_b32 v71 offset:8176
    ds_read_b128 v[80:83], v6 offset:0
    ds_read_b128 v[84:87], v6 offset:32
    ds_read_b128 v[88:91], v6 offset:64
    ds_read_b128 v[92:95], v6 offset:96
    ds_read_b128 v[96:99], v6 offset:128
    ds_read_b128 v[100:103], v6 offset:160
    ds_read_b128 v[104:107], v6 offset:192
    ds_read_b128 v[108:111], v6 offset:224
    v_cvt_pk_bf16_f32 v68, v32, v33
    v_cvt_pk_bf16_f32 v69, v34, v35
    ds_write_addtid_b32 v68 offset:0
    ds_write_addtid_b32 v69 offset:256
    v_pk_mul_f32 v[64:65], v[32:33], v[20:21] op_sel:[1,1] op_sel_hi:[1,0] neg_lo:[1,0]
    v_pk_mul_f32 v[66:67], v[34:35], v[22:23] op_sel:[1,1] op_sel_hi:[1,0] neg_lo:[1,0]
    v_pk_fma_f32 v[36:37], v[32:33], v[20:21], v[64:65] op_sel:[0,0,0] op_sel_hi:[0,1,1]
    v_pk_fma_f32 v[38:39], v[34:35], v[22:23], v[66:67] op_sel:[0,0,0] op_sel_hi:[0,1,1]
    v_cvt_pk_bf16_f32 v70, v36, v37
    v_cvt_pk_bf16_f32 v71, v38, v39
    ds_write_addtid_b32 v70 offset:528
    ds_write_addtid_b32 v71 offset:784
    v_pk_mul_f32 v[64:65], v[36:37], v[20:21] op_sel:[1,1] op_sel_hi:[1,0] neg_lo:[1,0]
    v_pk_mul_f32 v[66:67], v[38:39], v[22:23] op_sel:[1,1] op_sel_hi:[1,0] neg_lo:[1,0]
    v_pk_fma_f32 v[40:41], v[36:37], v[20:21], v[64:65] op_sel:[0,0,0] op_sel_hi:[0,1,1]
    v_pk_fma_f32 v[42:43], v[38:39], v[22:23], v[66:67] op_sel:[0,0,0] op_sel_hi:[0,1,1]
    v_cvt_pk_bf16_f32 v68, v40, v41
    v_cvt_pk_bf16_f32 v69, v42, v43
    ds_write_addtid_b32 v68 offset:1056
    ds_write_addtid_b32 v69 offset:1312
    v_pk_mul_f32 v[64:65], v[40:41], v[20:21] op_sel:[1,1] op_sel_hi:[1,0] neg_lo:[1,0]
    v_pk_mul_f32 v[66:67], v[42:43], v[22:23] op_sel:[1,1] op_sel_hi:[1,0] neg_lo:[1,0]
    v_pk_fma_f32 v[44:45], v[40:41], v[20:21], v[64:65] op_sel:[0,0,0] op_sel_hi:[0,1,1]
    v_pk_fma_f32 v[46:47], v[42:43], v[22:23], v[66:67] op_sel:[0,0,0] op_sel_hi:[0,1,1]
    v_cvt_pk_bf16_f32 v70, v44, v45
    v_cvt_pk_bf16_f32 v71, v46, v47
    ds_write_addtid_b32 v70 offset:1584
    ds_write_addtid_b32 v71 offset:1840
    v_pk_mul_f32 v[64:65], v[44:45], v[20:21] op_sel:[1,1] op_sel_hi:[1,0] neg_lo:[1,0]
    v_pk_mul_f32 v[66:67], v[46:47], v[22:23] op_sel:[1,1] op_sel_hi:[1,0] neg_lo:[1,0]
    s_waitcnt vmcnt(0)
    buffer_load_dwordx4 v[240:243], v9, s[36:39], 0 offen offset:0
    v_pk_fma_f32 v[48:49], v[44:45], v[20:21], v[64:65] op_sel:[0,0,0] op_sel_hi:[0,1,1]
    v_pk_fma_f32 v[50:51], v[46:47], v[22:23], v[66:67] op_sel:[0,0,0] op_sel_hi:[0,1,1]
    v_cvt_pk_bf16_f32 v68, v48, v49
    v_cvt_pk_bf16_f32 v69, v50, v51
    ds_write_addtid_b32 v68 offset:2112
    ds_write_addtid_b32 v69 offset:2368
    v_pk_mul_f32 v[64:65], v[48:49], v[20:21] op_sel:[1,1] op_sel_hi:[1,0] neg_lo:[1,0]
    v_pk_mul_f32 v[66:67], v[50:51], v[22:23] op_sel:[1,1] op_sel_hi:[1,0] neg_lo:[1,0]
    v_pk_fma_f32 v[52:53], v[48:49], v[20:21], v[64:65] op_sel:[0,0,0] op_sel_hi:[0,1,1]
    v_pk_fma_f32 v[54:55], v[50:51], v[22:23], v[66:67] op_sel:[0,0,0] op_sel_hi:[0,1,1]
    v_cvt_pk_bf16_f32 v70, v52, v53
    v_cvt_pk_bf16_f32 v71, v54, v55
    ds_write_addtid_b32 v70 offset:2640
    ds_write_addtid_b32 v71 offset:2896
    v_pk_mul_f32 v[64:65], v[52:53], v[20:21] op_sel:[1,1] op_sel_hi:[1,0] neg_lo:[1,0]
    v_pk_mul_f32 v[66:67], v[54:55], v[22:23] op_sel:[1,1] op_sel_hi:[1,0] neg_lo:[1,0]
    v_pk_fma_f32 v[56:57], v[52:53], v[20:21], v[64:65] op_sel:[0,0,0] op_sel_hi:[0,1,1]
    v_pk_fma_f32 v[58:59], v[54:55], v[22:23], v[66:67] op_sel:[0,0,0] op_sel_hi:[0,1,1]
    v_cvt_pk_bf16_f32 v68, v56, v57
    v_cvt_pk_bf16_f32 v69, v58, v59
    ds_write_addtid_b32 v68 offset:3168
    ds_write_addtid_b32 v69 offset:3424
    v_pk_mul_f32 v[64:65], v[56:57], v[20:21] op_sel:[1,1] op_sel_hi:[1,0] neg_lo:[1,0]
    v_pk_mul_f32 v[66:67], v[58:59], v[22:23] op_sel:[1,1] op_sel_hi:[1,0] neg_lo:[1,0]
    v_pk_fma_f32 v[60:61], v[56:57], v[20:21], v[64:65] op_sel:[0,0,0] op_sel_hi:[0,1,1]
    v_pk_fma_f32 v[62:63], v[58:59], v[22:23], v[66:67] op_sel:[0,0,0] op_sel_hi:[0,1,1]
    v_cvt_pk_bf16_f32 v70, v60, v61
    v_cvt_pk_bf16_f32 v71, v62, v63
    ds_write_addtid_b32 v70 offset:3696
    ds_write_addtid_b32 v71 offset:3952
    v_pk_mul_f32 v[64:65], v[32:33], v[28:29] op_sel:[1,1] op_sel_hi:[1,0] neg_lo:[1,0]
    v_pk_mul_f32 v[66:67], v[34:35], v[30:31] op_sel:[1,1] op_sel_hi:[1,0] neg_lo:[1,0]
    v_pk_fma_f32 v[32:33], v[32:33], v[28:29], v[64:65] op_sel:[0,0,0] op_sel_hi:[0,1,1]
    v_pk_fma_f32 v[34:35], v[34:35], v[30:31], v[66:67] op_sel:[0,0,0] op_sel_hi:[0,1,1]
    v_cvt_pk_bf16_f32 v68, v32, v33
    v_cvt_pk_bf16_f32 v69, v34, v35
    ds_write_addtid_b32 v68 offset:4224
    ds_write_addtid_b32 v69 offset:4480
    v_pk_mul_f32 v[64:65], v[36:37], v[28:29] op_sel:[1,1] op_sel_hi:[1,0] neg_lo:[1,0]
    v_pk_mul_f32 v[66:67], v[38:39], v[30:31] op_sel:[1,1] op_sel_hi:[1,0] neg_lo:[1,0]
    v_pk_fma_f32 v[36:37], v[36:37], v[28:29], v[64:65] op_sel:[0,0,0] op_sel_hi:[0,1,1]
    v_pk_fma_f32 v[38:39], v[38:39], v[30:31], v[66:67] op_sel:[0,0,0] op_sel_hi:[0,1,1]
    v_cvt_pk_bf16_f32 v70, v36, v37
    v_cvt_pk_bf16_f32 v71, v38, v39
    ds_write_addtid_b32 v70 offset:4752
    ds_write_addtid_b32 v71 offset:5008
    v_pk_mul_f32 v[64:65], v[40:41], v[28:29] op_sel:[1,1] op_sel_hi:[1,0] neg_lo:[1,0]
    v_pk_mul_f32 v[66:67], v[42:43], v[30:31] op_sel:[1,1] op_sel_hi:[1,0] neg_lo:[1,0]
    v_pk_fma_f32 v[40:41], v[40:41], v[28:29], v[64:65] op_sel:[0,0,0] op_sel_hi:[0,1,1]
    v_pk_fma_f32 v[42:43], v[42:43], v[30:31], v[66:67] op_sel:[0,0,0] op_sel_hi:[0,1,1]
    v_cvt_pk_bf16_f32 v68, v40, v41
    v_cvt_pk_bf16_f32 v69, v42, v43
    ds_write_addtid_b32 v68 offset:5280
    ds_write_addtid_b32 v69 offset:5536
    v_pk_mul_f32 v[64:65], v[44:45], v[28:29] op_sel:[1,1] op_sel_hi:[1,0] neg_lo:[1,0]
    v_pk_mul_f32 v[66:67], v[46:47], v[30:31] op_sel:[1,1] op_sel_hi:[1,0] neg_lo:[1,0]
    v_pk_fma_f32 v[44:45], v[44:45], v[28:29], v[64:65] op_sel:[0,0,0] op_sel_hi:[0,1,1]
    v_pk_fma_f32 v[46:47], v[46:47], v[30:31], v[66:67] op_sel:[0,0,0] op_sel_hi:[0,1,1]
    v_cvt_pk_bf16_f32 v70, v44, v45
    v_cvt_pk_bf16_f32 v71, v46, v47
    buffer_load_dwordx4 v[244:247], v9, s[36:39], 0 offen offset:2048
    ds_write_addtid_b32 v70 offset:5808
    ds_write_addtid_b32 v71 offset:6064
    v_pk_mul_f32 v[64:65], v[48:49], v[28:29] op_sel:[1,1] op_sel_hi:[1,0] neg_lo:[1,0]
    v_pk_mul_f32 v[66:67], v[50:51], v[30:31] op_sel:[1,1] op_sel_hi:[1,0] neg_lo:[1,0]
    v_pk_fma_f32 v[48:49], v[48:49], v[28:29], v[64:65] op_sel:[0,0,0] op_sel_hi:[0,1,1]
    v_pk_fma_f32 v[50:51], v[50:51], v[30:31], v[66:67] op_sel:[0,0,0] op_sel_hi:[0,1,1]
    v_cvt_pk_bf16_f32 v68, v48, v49
    v_cvt_pk_bf16_f32 v69, v50, v51
    ds_write_addtid_b32 v68 offset:6336
    ds_write_addtid_b32 v69 offset:6592
    v_pk_mul_f32 v[64:65], v[52:53], v[28:29] op_sel:[1,1] op_sel_hi:[1,0] neg_lo:[1,0]
    v_pk_mul_f32 v[66:67], v[54:55], v[30:31] op_sel:[1,1] op_sel_hi:[1,0] neg_lo:[1,0]
    v_pk_fma_f32 v[52:53], v[52:53], v[28:29], v[64:65] op_sel:[0,0,0] op_sel_hi:[0,1,1]
    v_pk_fma_f32 v[54:55], v[54:55], v[30:31], v[66:67] op_sel:[0,0,0] op_sel_hi:[0,1,1]
    v_cvt_pk_bf16_f32 v70, v52, v53
    v_cvt_pk_bf16_f32 v71, v54, v55
    ds_write_addtid_b32 v70 offset:6864
    ds_write_addtid_b32 v71 offset:7120
    v_pk_mul_f32 v[64:65], v[56:57], v[28:29] op_sel:[1,1] op_sel_hi:[1,0] neg_lo:[1,0]
    v_pk_mul_f32 v[66:67], v[58:59], v[30:31] op_sel:[1,1] op_sel_hi:[1,0] neg_lo:[1,0]
    v_pk_fma_f32 v[56:57], v[56:57], v[28:29], v[64:65] op_sel:[0,0,0] op_sel_hi:[0,1,1]
    v_pk_fma_f32 v[58:59], v[58:59], v[30:31], v[66:67] op_sel:[0,0,0] op_sel_hi:[0,1,1]
    v_cvt_pk_bf16_f32 v68, v56, v57
    v_cvt_pk_bf16_f32 v69, v58, v59
    ds_write_addtid_b32 v68 offset:7392
    ds_write_addtid_b32 v69 offset:7648
    v_pk_mul_f32 v[64:65], v[60:61], v[28:29] op_sel:[1,1] op_sel_hi:[1,0] neg_lo:[1,0]
    v_pk_mul_f32 v[66:67], v[62:63], v[30:31] op_sel:[1,1] op_sel_hi:[1,0] neg_lo:[1,0]
    v_pk_fma_f32 v[60:61], v[60:61], v[28:29], v[64:65] op_sel:[0,0,0] op_sel_hi:[0,1,1]
    v_pk_fma_f32 v[62:63], v[62:63], v[30:31], v[66:67] op_sel:[0,0,0] op_sel_hi:[0,1,1]
    v_cvt_pk_bf16_f32 v70, v60, v61
    v_cvt_pk_bf16_f32 v71, v62, v63
    ds_write_addtid_b32 v70 offset:7920
    ds_write_addtid_b32 v71 offset:8176
    ds_read_b128 v[176:179], v6 offset:0
    ds_read_b128 v[180:183], v6 offset:32
    ds_read_b128 v[184:187], v6 offset:64
    ds_read_b128 v[188:191], v6 offset:96
    ds_read_b128 v[192:195], v6 offset:128
    ds_read_b128 v[196:199], v6 offset:160
    ds_read_b128 v[200:203], v6 offset:192
    ds_read_b128 v[204:207], v6 offset:224
    v_pk_mul_f32 v[64:65], v[32:33], v[28:29] op_sel:[1,1] op_sel_hi:[1,0] neg_lo:[1,0]
    v_pk_mul_f32 v[66:67], v[34:35], v[30:31] op_sel:[1,1] op_sel_hi:[1,0] neg_lo:[1,0]
    v_pk_fma_f32 v[32:33], v[32:33], v[28:29], v[64:65] op_sel:[0,0,0] op_sel_hi:[0,1,1]
    v_pk_fma_f32 v[34:35], v[34:35], v[30:31], v[66:67] op_sel:[0,0,0] op_sel_hi:[0,1,1]
    v_cvt_pk_bf16_f32 v68, v32, v33
    v_cvt_pk_bf16_f32 v69, v34, v35
    ds_write_addtid_b32 v68 offset:0
    ds_write_addtid_b32 v69 offset:256
    v_pk_mul_f32 v[64:65], v[40:41], v[28:29] op_sel:[1,1] op_sel_hi:[1,0] neg_lo:[1,0]
    v_pk_mul_f32 v[66:67], v[42:43], v[30:31] op_sel:[1,1] op_sel_hi:[1,0] neg_lo:[1,0]
    v_pk_fma_f32 v[40:41], v[40:41], v[28:29], v[64:65] op_sel:[0,0,0] op_sel_hi:[0,1,1]
    v_pk_fma_f32 v[42:43], v[42:43], v[30:31], v[66:67] op_sel:[0,0,0] op_sel_hi:[0,1,1]
    v_cvt_pk_bf16_f32 v70, v40, v41
    v_cvt_pk_bf16_f32 v71, v42, v43
    ds_write_addtid_b32 v70 offset:528
    ds_write_addtid_b32 v71 offset:784
    v_pk_mul_f32 v[64:65], v[48:49], v[28:29] op_sel:[1,1] op_sel_hi:[1,0] neg_lo:[1,0]
    v_pk_mul_f32 v[66:67], v[50:51], v[30:31] op_sel:[1,1] op_sel_hi:[1,0] neg_lo:[1,0]
    buffer_load_dwordx4 v[248:251], v9, s[36:39], s53 offen offset:0
    v_pk_fma_f32 v[48:49], v[48:49], v[28:29], v[64:65] op_sel:[0,0,0] op_sel_hi:[0,1,1]
    v_pk_fma_f32 v[50:51], v[50:51], v[30:31], v[66:67] op_sel:[0,0,0] op_sel_hi:[0,1,1]
    v_cvt_pk_bf16_f32 v68, v48, v49
    v_cvt_pk_bf16_f32 v69, v50, v51
    ds_write_addtid_b32 v68 offset:1056
    ds_write_addtid_b32 v69 offset:1312
    v_pk_mul_f32 v[64:65], v[56:57], v[28:29] op_sel:[1,1] op_sel_hi:[1,0] neg_lo:[1,0]
    v_pk_mul_f32 v[66:67], v[58:59], v[30:31] op_sel:[1,1] op_sel_hi:[1,0] neg_lo:[1,0]
    v_pk_fma_f32 v[56:57], v[56:57], v[28:29], v[64:65] op_sel:[0,0,0] op_sel_hi:[0,1,1]
    v_pk_fma_f32 v[58:59], v[58:59], v[30:31], v[66:67] op_sel:[0,0,0] op_sel_hi:[0,1,1]
    v_cvt_pk_bf16_f32 v70, v56, v57
    v_cvt_pk_bf16_f32 v71, v58, v59
    ds_write_addtid_b32 v70 offset:1584
    ds_write_addtid_b32 v71 offset:1840
    s_waitcnt lgkmcnt(15)
    v_mfma_f32_16x16x32_bf16 v[208:211], v[176:179], v[80:83], 0
    v_pk_mul_f32 v[64:65], v[32:33], v[28:29] op_sel:[1,1] op_sel_hi:[1,0] neg_lo:[1,0]
    v_pk_mul_f32 v[66:67], v[34:35], v[30:31] op_sel:[1,1] op_sel_hi:[1,0] neg_lo:[1,0]
    v_pk_fma_f32 v[32:33], v[32:33], v[28:29], v[64:65] op_sel:[0,0,0] op_sel_hi:[0,1,1]
    v_pk_fma_f32 v[34:35], v[34:35], v[30:31], v[66:67] op_sel:[0,0,0] op_sel_hi:[0,1,1]
    v_cvt_pk_bf16_f32 v68, v32, v33
    v_cvt_pk_bf16_f32 v69, v34, v35
    ds_write_addtid_b32 v68 offset:2112
    ds_write_addtid_b32 v69 offset:2368
    s_waitcnt lgkmcnt(15)
    v_mfma_f32_16x16x32_bf16 v[208:211], v[180:183], v[84:87], v[208:211]
    v_pk_mul_f32 v[64:65], v[40:41], v[28:29] op_sel:[1,1] op_sel_hi:[1,0] neg_lo:[1,0]
    v_pk_mul_f32 v[66:67], v[42:43], v[30:31] op_sel:[1,1] op_sel_hi:[1,0] neg_lo:[1,0]
    v_pk_fma_f32 v[40:41], v[40:41], v[28:29], v[64:65] op_sel:[0,0,0] op_sel_hi:[0,1,1]
    v_pk_fma_f32 v[42:43], v[42:43], v[30:31], v[66:67] op_sel:[0,0,0] op_sel_hi:[0,1,1]
    v_cvt_pk_bf16_f32 v70, v40, v41
    v_cvt_pk_bf16_f32 v71, v42, v43
    ds_write_addtid_b32 v70 offset:2640
    ds_write_addtid_b32 v71 offset:2896
    v_mfma_f32_16x16x32_bf16 v[208:211], v[184:187], v[88:91], v[208:211]
    v_pk_mul_f32 v[64:65], v[48:49], v[28:29] op_sel:[1,1] op_sel_hi:[1,0] neg_lo:[1,0]
    v_pk_mul_f32 v[66:67], v[50:51], v[30:31] op_sel:[1,1] op_sel_hi:[1,0] neg_lo:[1,0]
    v_pk_fma_f32 v[48:49], v[48:49], v[28:29], v[64:65] op_sel:[0,0,0] op_sel_hi:[0,1,1]
    v_pk_fma_f32 v[50:51], v[50:51], v[30:31], v[66:67] op_sel:[0,0,0] op_sel_hi:[0,1,1]
    v_cvt_pk_bf16_f32 v68, v48, v49
    v_cvt_pk_bf16_f32 v69, v50, v51
    ds_write_addtid_b32 v68 offset:3168
    ds_write_addtid_b32 v69 offset:3424
    s_waitcnt lgkmcnt(15)
    v_mfma_f32_16x16x32_bf16 v[208:211], v[188:191], v[92:95], v[208:211]
    v_pk_mul_f32 v[64:65], v[56:57], v[28:29] op_sel:[1,1] op_sel_hi:[1,0] neg_lo:[1,0]
    v_pk_mul_f32 v[66:67], v[58:59], v[30:31] op_sel:[1,1] op_sel_hi:[1,0] neg_lo:[1,0]
    v_pk_fma_f32 v[56:57], v[56:57], v[28:29], v[64:65] op_sel:[0,0,0] op_sel_hi:[0,1,1]
    v_pk_fma_f32 v[58:59], v[58:59], v[30:31], v[66:67] op_sel:[0,0,0] op_sel_hi:[0,1,1]
    v_cvt_pk_bf16_f32 v70, v56, v57
    v_cvt_pk_bf16_f32 v71, v58, v59
    ds_write_addtid_b32 v70 offset:3696
    ds_write_addtid_b32 v71 offset:3952
    v_mfma_f32_16x16x32_bf16 v[208:211], v[192:195], v[96:99], v[208:211]
    v_pk_mul_f32 v[64:65], v[32:33], v[28:29] op_sel:[1,1] op_sel_hi:[1,0] neg_lo:[1,0]
    v_pk_mul_f32 v[66:67], v[34:35], v[30:31] op_sel:[1,1] op_sel_hi:[1,0] neg_lo:[1,0]
    v_pk_fma_f32 v[32:33], v[32:33], v[28:29], v[64:65] op_sel:[0,0,0] op_sel_hi:[0,1,1]
    v_pk_fma_f32 v[34:35], v[34:35], v[30:31], v[66:67] op_sel:[0,0,0] op_sel_hi:[0,1,1]
    v_cvt_pk_bf16_f32 v68, v32, v33
    v_cvt_pk_bf16_f32 v69, v34, v35
    buffer_load_dwordx4 v[252:255], v9, s[36:39], s53 offen offset:2048
    ds_write_addtid_b32 v68 offset:4224
    ds_write_addtid_b32 v69 offset:4480
    v_mfma_f32_16x16x32_bf16 v[208:211], v[196:199], v[100:103], v[208:211]
    v_pk_mul_f32 v[64:65], v[48:49], v[28:29] op_sel:[1,1] op_sel_hi:[1,0] neg_lo:[1,0]
    v_pk_mul_f32 v[66:67], v[50:51], v[30:31] op_sel:[1,1] op_sel_hi:[1,0] neg_lo:[1,0]
    v_pk_fma_f32 v[48:49], v[48:49], v[28:29], v[64:65] op_sel:[0,0,0] op_sel_hi:[0,1,1]
    v_pk_fma_f32 v[50:51], v[50:51], v[30:31], v[66:67] op_sel:[0,0,0] op_sel_hi:[0,1,1]
    v_cvt_pk_bf16_f32 v70, v48, v49
    v_cvt_pk_bf16_f32 v71, v50, v51
    ds_write_addtid_b32 v70 offset:4752
    ds_write_addtid_b32 v71 offset:5008
    v_mfma_f32_16x16x32_bf16 v[208:211], v[200:203], v[104:107], v[208:211]
    v_pk_mul_f32 v[64:65], v[32:33], v[28:29] op_sel:[1,1] op_sel_hi:[1,0] neg_lo:[1,0]
    v_pk_mul_f32 v[66:67], v[34:35], v[30:31] op_sel:[1,1] op_sel_hi:[1,0] neg_lo:[1,0]
    v_pk_fma_f32 v[32:33], v[32:33], v[28:29], v[64:65] op_sel:[0,0,0] op_sel_hi:[0,1,1]
    v_pk_fma_f32 v[34:35], v[34:35], v[30:31], v[66:67] op_sel:[0,0,0] op_sel_hi:[0,1,1]
    v_cvt_pk_bf16_f32 v68, v32, v33
    v_cvt_pk_bf16_f32 v69, v34, v35
    ds_write_addtid_b32 v68 offset:5280
    ds_write_addtid_b32 v69 offset:5536
    s_waitcnt lgkmcnt(15)
    v_mfma_f32_16x16x32_bf16 v[208:211], v[204:207], v[108:111], v[208:211]
    v_pk_mul_f32 v[64:65], v[48:49], v[28:29] op_sel:[1,1] op_sel_hi:[1,0] neg_lo:[1,0]
    v_pk_mul_f32 v[66:67], v[50:51], v[30:31] op_sel:[1,1] op_sel_hi:[1,0] neg_lo:[1,0]
    v_pk_fma_f32 v[48:49], v[48:49], v[28:29], v[64:65] op_sel:[0,0,0] op_sel_hi:[0,1,1]
    v_pk_fma_f32 v[50:51], v[50:51], v[30:31], v[66:67] op_sel:[0,0,0] op_sel_hi:[0,1,1]
    v_cvt_pk_bf16_f32 v70, v48, v49
    v_cvt_pk_bf16_f32 v71, v50, v51
    ds_write_addtid_b32 v70 offset:5808
    ds_write_addtid_b32 v71 offset:6064
    v_pk_mul_f32 v[64:65], v[32:33], v[28:29] op_sel:[1,1] op_sel_hi:[1,0] neg_lo:[1,0]
    v_pk_mul_f32 v[66:67], v[34:35], v[30:31] op_sel:[1,1] op_sel_hi:[1,0] neg_lo:[1,0]
    v_pk_fma_f32 v[32:33], v[32:33], v[28:29], v[64:65] op_sel:[0,0,0] op_sel_hi:[0,1,1]
    v_pk_fma_f32 v[34:35], v[34:35], v[30:31], v[66:67] op_sel:[0,0,0] op_sel_hi:[0,1,1]
    v_cvt_pk_bf16_f32 v68, v32, v33
    v_cvt_pk_bf16_f32 v69, v34, v35
    ds_write_addtid_b32 v68 offset:6336
    ds_write_addtid_b32 v69 offset:6592
    v_pk_mul_f32 v[64:65], v[48:49], v[28:29] op_sel:[1,1] op_sel_hi:[1,0] neg_lo:[1,0]
    v_pk_mul_f32 v[66:67], v[50:51], v[30:31] op_sel:[1,1] op_sel_hi:[1,0] neg_lo:[1,0]
    v_pk_fma_f32 v[48:49], v[48:49], v[28:29], v[64:65] op_sel:[0,0,0] op_sel_hi:[0,1,1]
    v_pk_fma_f32 v[50:51], v[50:51], v[30:31], v[66:67] op_sel:[0,0,0] op_sel_hi:[0,1,1]
    v_cvt_pk_bf16_f32 v70, v48, v49
    v_cvt_pk_bf16_f32 v71, v50, v51
    ds_write_addtid_b32 v70 offset:6864
    ds_write_addtid_b32 v71 offset:7120
    v_pk_mul_f32 v[64:65], v[32:33], v[28:29] op_sel:[1,1] op_sel_hi:[1,0] neg_lo:[1,0]
    v_pk_mul_f32 v[66:67], v[34:35], v[30:31] op_sel:[1,1] op_sel_hi:[1,0] neg_lo:[1,0]
    v_pk_fma_f32 v[32:33], v[32:33], v[28:29], v[64:65] op_sel:[0,0,0] op_sel_hi:[0,1,1]
    v_pk_fma_f32 v[34:35], v[34:35], v[30:31], v[66:67] op_sel:[0,0,0] op_sel_hi:[0,1,1]
    v_cvt_pk_bf16_f32 v68, v32, v33
    v_cvt_pk_bf16_f32 v69, v34, v35
    ds_write_addtid_b32 v68 offset:7392
    ds_write_addtid_b32 v69 offset:7648
    v_pk_mul_f32 v[64:65], v[48:49], v[28:29] op_sel:[1,1] op_sel_hi:[1,0] neg_lo:[1,0]
    v_pk_mul_f32 v[66:67], v[50:51], v[30:31] op_sel:[1,1] op_sel_hi:[1,0] neg_lo:[1,0]
    v_pk_fma_f32 v[48:49], v[48:49], v[28:29], v[64:65] op_sel:[0,0,0] op_sel_hi:[0,1,1]
    v_pk_fma_f32 v[50:51], v[50:51], v[30:31], v[66:67] op_sel:[0,0,0] op_sel_hi:[0,1,1]
    v_cvt_pk_bf16_f32 v70, v48, v49
    v_cvt_pk_bf16_f32 v71, v50, v51
    ds_write_addtid_b32 v70 offset:7920
    ds_write_addtid_b32 v71 offset:8176
    ds_read_b128 v[176:179], v6 offset:0
    ds_read_b128 v[180:183], v6 offset:32
    ds_read_b128 v[184:187], v6 offset:64
    ds_read_b128 v[188:191], v6 offset:96
    ds_read_b128 v[192:195], v6 offset:128
    ds_read_b128 v[196:199], v6 offset:160
    ds_read_b128 v[200:203], v6 offset:192
    ds_read_b128 v[204:207], v6 offset:224
    v_pk_mul_f32 v[64:65], v[32:33], v[28:29] op_sel:[1,1] op_sel_hi:[1,0] neg_lo:[1,0]
    v_pk_mul_f32 v[66:67], v[34:35], v[30:31] op_sel:[1,1] op_sel_hi:[1,0] neg_lo:[1,0]
    v_pk_fma_f32 v[32:33], v[32:33], v[28:29], v[64:65] op_sel:[0,0,0] op_sel_hi:[0,1,1]
    v_pk_fma_f32 v[34:35], v[34:35], v[30:31], v[66:67] op_sel:[0,0,0] op_sel_hi:[0,1,1]
    v_cvt_pk_bf16_f32 v68, v32, v33
    v_cvt_pk_bf16_f32 v69, v34, v35
    ds_write_addtid_b32 v68 offset:0
    ds_write_addtid_b32 v69 offset:256
    v_pk_mul_f32 v[64:65], v[32:33], v[28:29] op_sel:[1,1] op_sel_hi:[1,0] neg_lo:[1,0]
    v_pk_mul_f32 v[66:67], v[34:35], v[30:31] op_sel:[1,1] op_sel_hi:[1,0] neg_lo:[1,0]
    v_pk_fma_f32 v[32:33], v[32:33], v[28:29], v[64:65] op_sel:[0,0,0] op_sel_hi:[0,1,1]
    v_pk_fma_f32 v[34:35], v[34:35], v[30:31], v[66:67] op_sel:[0,0,0] op_sel_hi:[0,1,1]
    v_cvt_pk_bf16_f32 v70, v32, v33
    v_cvt_pk_bf16_f32 v71, v34, v35
    ds_write_addtid_b32 v70 offset:528
    ds_write_addtid_b32 v71 offset:784
    v_pk_mul_f32 v[64:65], v[32:33], v[28:29] op_sel:[1,1] op_sel_hi:[1,0] neg_lo:[1,0]
    v_pk_mul_f32 v[66:67], v[34:35], v[30:31] op_sel:[1,1] op_sel_hi:[1,0] neg_lo:[1,0]
    v_pk_fma_f32 v[32:33], v[32:33], v[28:29], v[64:65] op_sel:[0,0,0] op_sel_hi:[0,1,1]
    v_pk_fma_f32 v[34:35], v[34:35], v[30:31], v[66:67] op_sel:[0,0,0] op_sel_hi:[0,1,1]
    v_cvt_pk_bf16_f32 v68, v32, v33
    v_cvt_pk_bf16_f32 v69, v34, v35
    ds_write_addtid_b32 v68 offset:1056
    ds_write_addtid_b32 v69 offset:1312
    s_waitcnt lgkmcnt(13)
    v_mfma_f32_16x16x32_bf16 v[212:215], v[176:179], v[80:83], 0
    v_pk_mul_f32 v[64:65], v[32:33], v[28:29] op_sel:[1,1] op_sel_hi:[1,0] neg_lo:[1,0]
    v_pk_mul_f32 v[66:67], v[34:35], v[30:31] op_sel:[1,1] op_sel_hi:[1,0] neg_lo:[1,0]
    v_pk_fma_f32 v[32:33], v[32:33], v[28:29], v[64:65] op_sel:[0,0,0] op_sel_hi:[0,1,1]
    v_pk_fma_f32 v[34:35], v[34:35], v[30:31], v[66:67] op_sel:[0,0,0] op_sel_hi:[0,1,1]
    v_cvt_pk_bf16_f32 v70, v32, v33
    v_cvt_pk_bf16_f32 v71, v34, v35
    ds_write_addtid_b32 v70 offset:1584
    ds_write_addtid_b32 v71 offset:1840
    s_waitcnt lgkmcnt(14)
    v_mfma_f32_16x16x32_bf16 v[212:215], v[180:183], v[84:87], v[212:215]
    v_pk_mul_f32 v[64:65], v[32:33], v[28:29] op_sel:[1,1] op_sel_hi:[1,0] neg_lo:[1,0]
    v_pk_mul_f32 v[66:67], v[34:35], v[30:31] op_sel:[1,1] op_sel_hi:[1,0] neg_lo:[1,0]
    v_pk_fma_f32 v[32:33], v[32:33], v[28:29], v[64:65] op_sel:[0,0,0] op_sel_hi:[0,1,1]
    v_pk_fma_f32 v[34:35], v[34:35], v[30:31], v[66:67] op_sel:[0,0,0] op_sel_hi:[0,1,1]
    v_cvt_pk_bf16_f32 v68, v32, v33
    v_cvt_pk_bf16_f32 v69, v34, v35
    ds_write_addtid_b32 v68 offset:2112
    ds_write_addtid_b32 v69 offset:2368
    s_waitcnt lgkmcnt(15)
    v_mfma_f32_16x16x32_bf16 v[212:215], v[184:187], v[88:91], v[212:215]
    v_pk_mul_f32 v[64:65], v[32:33], v[28:29] op_sel:[1,1] op_sel_hi:[1,0] neg_lo:[1,0]
    v_pk_mul_f32 v[66:67], v[34:35], v[30:31] op_sel:[1,1] op_sel_hi:[1,0] neg_lo:[1,0]
    v_pk_fma_f32 v[32:33], v[32:33], v[28:29], v[64:65] op_sel:[0,0,0] op_sel_hi:[0,1,1]
    v_pk_fma_f32 v[34:35], v[34:35], v[30:31], v[66:67] op_sel:[0,0,0] op_sel_hi:[0,1,1]
    v_cvt_pk_bf16_f32 v70, v32, v33
    v_cvt_pk_bf16_f32 v71, v34, v35
    ds_write_addtid_b32 v70 offset:2640
    ds_write_addtid_b32 v71 offset:2896
    s_waitcnt lgkmcnt(15)
    v_mfma_f32_16x16x32_bf16 v[212:215], v[188:191], v[92:95], v[212:215]
    v_pk_mul_f32 v[64:65], v[32:33], v[28:29] op_sel:[1,1] op_sel_hi:[1,0] neg_lo:[1,0]
    v_pk_mul_f32 v[66:67], v[34:35], v[30:31] op_sel:[1,1] op_sel_hi:[1,0] neg_lo:[1,0]
    v_pk_fma_f32 v[32:33], v[32:33], v[28:29], v[64:65] op_sel:[0,0,0] op_sel_hi:[0,1,1]
    v_pk_fma_f32 v[34:35], v[34:35], v[30:31], v[66:67] op_sel:[0,0,0] op_sel_hi:[0,1,1]
    v_cvt_pk_bf16_f32 v68, v32, v33
    v_cvt_pk_bf16_f32 v69, v34, v35
    ds_write_addtid_b32 v68 offset:3168
    ds_write_addtid_b32 v69 offset:3424
    v_mfma_f32_16x16x32_bf16 v[212:215], v[192:195], v[96:99], v[212:215]
    v_pk_mul_f32 v[64:65], v[32:33], v[28:29] op_sel:[1,1] op_sel_hi:[1,0] neg_lo:[1,0]
    v_pk_mul_f32 v[66:67], v[34:35], v[30:31] op_sel:[1,1] op_sel_hi:[1,0] neg_lo:[1,0]
    v_pk_fma_f32 v[32:33], v[32:33], v[28:29], v[64:65] op_sel:[0,0,0] op_sel_hi:[0,1,1]
    v_pk_fma_f32 v[34:35], v[34:35], v[30:31], v[66:67] op_sel:[0,0,0] op_sel_hi:[0,1,1]
    v_cvt_pk_bf16_f32 v70, v32, v33
    v_cvt_pk_bf16_f32 v71, v34, v35
    ds_write_addtid_b32 v70 offset:3696
    ds_write_addtid_b32 v71 offset:3952
    s_waitcnt lgkmcnt(15)
    v_mfma_f32_16x16x32_bf16 v[212:215], v[196:199], v[100:103], v[212:215]
    v_pk_mul_f32 v[64:65], v[32:33], v[28:29] op_sel:[1,1] op_sel_hi:[1,0] neg_lo:[1,0]
    v_pk_mul_f32 v[66:67], v[34:35], v[30:31] op_sel:[1,1] op_sel_hi:[1,0] neg_lo:[1,0]
    v_pk_fma_f32 v[32:33], v[32:33], v[28:29], v[64:65] op_sel:[0,0,0] op_sel_hi:[0,1,1]
    v_pk_fma_f32 v[34:35], v[34:35], v[30:31], v[66:67] op_sel:[0,0,0] op_sel_hi:[0,1,1]
    v_cvt_pk_bf16_f32 v68, v32, v33
    v_cvt_pk_bf16_f32 v69, v34, v35
    ds_write_addtid_b32 v68 offset:4224
    ds_write_addtid_b32 v69 offset:4480
    v_mfma_f32_16x16x32_bf16 v[212:215], v[200:203], v[104:107], v[212:215]
    v_mfma_f32_16x16x32_bf16 v[212:215], v[204:207], v[108:111], v[212:215]
    ds_read_b128 v[176:179], v6 offset:0
    ds_read_b128 v[180:183], v6 offset:32
    ds_read_b128 v[184:187], v6 offset:64
    ds_read_b128 v[188:191], v6 offset:96
    ds_read_b128 v[192:195], v6 offset:128
    ds_read_b128 v[196:199], v6 offset:160
    ds_read_b128 v[200:203], v6 offset:192
    ds_read_b128 v[204:207], v6 offset:224
    v_add_f32 v208, v208, v169
    v_cndmask_b32 v72, v213, v212, s[62:63]
    v_cndmask_b32 v73, v214, v213, s[62:63]
    v_cndmask_b32 v74, v215, 0, s[62:63]
    v_cvt_pk_bf16_f32 v76, v212, v213
    v_cvt_pk_bf16_f32 v77, v214, v215
    s_waitcnt lgkmcnt(7)
    v_mfma_f32_16x16x32_bf16 v[216:219], v[176:179], v[80:83], 0
    s_waitcnt lgkmcnt(6)
    v_mfma_f32_16x16x32_bf16 v[216:219], v[180:183], v[84:87], v[216:219]
    v_cvt_pk_bf16_f32 v64, v212, v212
    v_cvt_pk_bf16_f32 v65, v212, v212
    v_cvt_pk_bf16_f32 v66, v72, v212
    v_cvt_pk_bf16_f32 v67, v73, v72
    s_waitcnt lgkmcnt(5)
    v_mfma_f32_16x16x32_bf16 v[216:219], v[184:187], v[88:91], v[216:219]
    s_waitcnt lgkmcnt(4)
    v_mfma_f32_16x16x32_bf16 v[216:219], v[188:191], v[92:95], v[216:219]
    v_cvt_pk_bf16_f32 v68, v73, v73
    v_cvt_pk_bf16_f32 v69, v73, v73
    v_cvt_pk_bf16_f32 v70, v74, v73
    v_cvt_pk_bf16_f32 v71, v74, v74
    s_waitcnt lgkmcnt(3)
    v_mfma_f32_16x16x32_bf16 v[216:219], v[192:195], v[96:99], v[216:219]
    s_waitcnt lgkmcnt(2)
    v_mfma_f32_16x16x32_bf16 v[216:219], v[196:199], v[100:103], v[216:219]
    v_cndmask_b32 v76, v76, 0, s[62:63]
    s_mov_b32 exec_hi, 1
    ds_write_b128 v160, v[64:67] offset:4
    ds_write_b128 v160, v[68:71] offset:20
    ds_write_b16 v160, v64
    s_mov_b32 exec_hi, -1
    s_waitcnt lgkmcnt(4)
    v_mfma_f32_16x16x32_bf16 v[216:219], v[200:203], v[104:107], v[216:219]
    s_waitcnt lgkmcnt(3)
    v_mfma_f32_16x16x32_bf16 v[216:219], v[204:207], v[108:111], v[216:219]
    v_cvt_pk_bf16_f32 v72, v208, v211
    v_cvt_pk_bf16_f32 v73, v209, v208
    v_cvt_pk_bf16_f32 v74, v210, v209
    v_cvt_pk_bf16_f32 v75, v211, v210
    ds_write_b16 v161, v72
    ds_write2_b32 v161, v73, v74 offset0:1 offset1:2
    ds_write_b32 v161, v75 offset:12
    ds_write_b16_d16_hi v161, v72 offset:18
    s_mov_b32 exec_lo, 0
    ds_write2_b32 v162, v76, v77 offset0:0 offset1:8
    s_mov_b32 exec_lo, -1
    v_cvt_pk_bf16_f32 v100, v216, v217
    v_cvt_pk_bf16_f32 v101, v218, v219
    v_cvt_pk_bf16_f32 v102, v216, v216
    s_mov_b32 exec_hi, 1
    ds_write_b16 v164, v100
    s_mov_b32 exec_hi, 0
    ds_write_b16_d16_hi v163, v100 offset:32
    ds_write_b16 v163, v101 offset:64
    ds_write_b16_d16_hi v163, v101 offset:96
    s_mov_b32 exec_hi, -1
    v_readlane_b32 s52, v102, 0
    s_nop 1
    v_and_b32 v124, s52, v124
    v_and_b32 v125, s52, v125
    v_and_b32 v126, s52, v126
    v_and_b32 v127, s52, v127
    v_mov_b32 v12, v165
    v_mov_b32 v13, v166
    v_mov_b32 v14, v167
    v_mov_b32 v15, v168
    v_mov_b32 v5, v174
    v_mov_b32 v6, v223
    v_readfirstlane_b32 s61, v175
    s_waitcnt vmcnt(0)
    buffer_load_dwordx4 v[144:147], v221, s[40:43], 0 offen sc1
    buffer_load_dwordx4 v[148:151], v221, s[40:43], s53 offen sc1
    s_mul_i32 s60, s61, 0x9e3779b1
    s_add_u32 s60, s60, 0x7f4a7c15
    v_perm_b32 v224, v244, v240, s64
    v_perm_b32 v225, v252, v248, s64
    ds_write_b64 v222, v[224:225] offset:0
    v_perm_b32 v226, v244, v240, s65
    v_perm_b32 v227, v252, v248, s65
    ds_write_b64 v222, v[226:227] offset:4160
    v_perm_b32 v228, v245, v241, s64
    v_perm_b32 v229, v253, v249, s64
    ds_write_b64 v222, v[228:229] offset:8320
    v_perm_b32 v230, v245, v241, s65
    v_perm_b32 v231, v253, v249, s65
    ds_write_b64 v222, v[230:231] offset:12480
    v_perm_b32 v232, v246, v242, s64
    v_perm_b32 v233, v254, v250, s64
    ds_write_b64 v222, v[232:233] offset:16640
    v_perm_b32 v234, v246, v242, s65
    v_perm_b32 v235, v254, v250, s65
    ds_write_b64 v222, v[234:235] offset:20800
    v_perm_b32 v236, v247, v243, s64
    v_perm_b32 v237, v255, v251, s64
    ds_write_b64 v222, v[236:237] offset:24960
    v_perm_b32 v238, v247, v243, s65
    v_perm_b32 v239, v255, v251, s65
    ds_write_b64 v222, v[238:239] offset:29120
    v_lshlrev_b32 v176, 16, v240
    v_and_b32 v180, 0xffff0000, v240
    v_lshlrev_b32 v184, 16, v241
    v_and_b32 v188, 0xffff0000, v241
    ds_read2_b32 v[96:97], v15 offset0:67 offset1:66
    v_lshlrev_b32 v192, 16, v242
    v_and_b32 v196, 0xffff0000, v242
    v_lshlrev_b32 v200, 16, v243
    v_and_b32 v204, 0xffff0000, v243
    ds_read2_b32 v[98:99], v15 offset0:65 offset1:64
    v_lshlrev_b32 v177, 16, v244
    v_and_b32 v181, 0xffff0000, v244
    v_lshlrev_b32 v185, 16, v245
    v_and_b32 v189, 0xffff0000, v245
    ds_read2_b32 v[100:101], v15 offset0:83 offset1:82
    v_lshlrev_b32 v193, 16, v246
    v_and_b32 v197, 0xffff0000, v246
    v_lshlrev_b32 v201, 16, v247
    v_and_b32 v205, 0xffff0000, v247
    ds_read2_b32 v[102:103], v15 offset0:81 offset1:80
    v_lshlrev_b32 v178, 16, v248
    v_and_b32 v182, 0xffff0000, v248
    v_lshlrev_b32 v186, 16, v249
    v_and_b32 v190, 0xffff0000, v249
    ds_read2_b32 v[104:105], v15 offset0:99 offset1:98
    v_lshlrev_b32 v194, 16, v250
    v_and_b32 v198, 0xffff0000, v250
    v_lshlrev_b32 v202, 16, v251
    v_and_b32 v206, 0xffff0000, v251
    ds_read2_b32 v[106:107], v15 offset0:97 offset1:96
    v_lshlrev_b32 v179, 16, v252
    v_and_b32 v183, 0xffff0000, v252
    v_lshlrev_b32 v187, 16, v253
    v_and_b32 v191, 0xffff0000, v253
    ds_read2_b32 v[84:85], v15 offset0:3 offset1:2
    v_lshlrev_b32 v195, 16, v254
    v_and_b32 v199, 0xffff0000, v254
    v_lshlrev_b32 v203, 16, v255
    v_and_b32 v207, 0xffff0000, v255
    ds_read2_b32 v[86:87], v15 offset0:1 offset1:0
    s_mov_b32 s54, 0
L_poll_conv:
    s_waitcnt vmcnt(0)
    v_cmp_ne_u32 s[8:9], s60, v147
    v_cmp_ne_u32 s[10:11], s60, v151
    s_or_b64 vcc, s[8:9], s[10:11]
    s_cbranch_scc0 L_polled_conv
    s_add_u32 s54, s54, 1
    s_cmp_ge_u32 s54, 65536
    s_cbranch_scc1 L_polled_conv
    s_sleep 2
    s_mov_b64 exec, s[8:9]
    s_cbranch_execz L_ps_conv_0
    buffer_load_dwordx4 v[144:147], v221, s[40:43], 0 offen sc1
L_ps_conv_0:
    s_mov_b64 exec, s[10:11]
    s_cbranch_execz L_ps_conv_1
    buffer_load_dwordx4 v[148:151], v221, s[40:43], s53 offen sc1
L_ps_conv_1:
    s_mov_b64 exec, -1
    s_branch L_poll_conv
L_polled_conv:
    v_and_b32 v160, 0xffff0000, v144
    v_and_b32 v161, 0xffff0000, v145
    v_and_b32 v162, 0xffff0000, v148
    v_and_b32 v163, 0xffff0000, v149
    v_rcp_f32 v160, v160
    ds_read2_b32 v[88:89], v15 offset0:19 offset1:18
    v_rcp_f32 v161, v161
    ds_read2_b32 v[90:91], v15 offset0:17 offset1:16
    v_rcp_f32 v162, v162
    ds_read2_b32 v[92:93], v15 offset0:35 offset1:34
    v_rcp_f32 v163, v163
    ds_read2_b32 v[94:95], v15 offset0:33 offset1:32
    v_lshlrev_b32 v164, 16, v144
    v_lshlrev_b32 v165, 16, v145
    v_lshlrev_b32 v166, 16, v148
    v_lshlrev_b32 v167, 16, v149
    v_pk_mul_f32 v[164:165], v[164:165], v[160:161] neg_lo:[1,0] neg_hi:[1,0]
    v_pk_mul_f32 v[166:167], v[166:167], v[162:163] neg_lo:[1,0] neg_hi:[1,0]
    v_pk_fma_f32 v[176:177], v[176:177], v[160:161], v[164:165]
    v_pk_fma_f32 v[178:179], v[178:179], v[162:163], v[166:167]
    v_cvt_pk_bf16_f32 v224, v176, v177
    v_cvt_pk_bf16_f32 v225, v178, v179
    ds_write_b64 v220, v[224:225] offset:0
    v_pk_fma_f32 v[180:181], v[180:181], v[160:161], v[164:165]
    v_pk_fma_f32 v[182:183], v[182:183], v[162:163], v[166:167]
    v_cvt_pk_bf16_f32 v226, v180, v181
    v_cvt_pk_bf16_f32 v227, v182, v183
    ds_write_b64 v220, v[226:227] offset:4608
    v_pk_fma_f32 v[184:185], v[184:185], v[160:161], v[164:165]
    v_pk_fma_f32 v[186:187], v[186:187], v[162:163], v[166:167]
    v_cvt_pk_bf16_f32 v228, v184, v185
    v_cvt_pk_bf16_f32 v229, v186, v187
    ds_write_b64 v220, v[228:229] offset:9216
    v_pk_fma_f32 v[188:189], v[188:189], v[160:161], v[164:165]
    v_pk_fma_f32 v[190:191], v[190:191], v[162:163], v[166:167]
    v_cvt_pk_bf16_f32 v230, v188, v189
    v_cvt_pk_bf16_f32 v231, v190, v191
    ds_write_b64 v220, v[230:231] offset:13824
    v_pk_fma_f32 v[192:193], v[192:193], v[160:161], v[164:165]
    v_pk_fma_f32 v[194:195], v[194:195], v[162:163], v[166:167]
    v_cvt_pk_bf16_f32 v232, v192, v193
    v_cvt_pk_bf16_f32 v233, v194, v195
    ds_write_b64 v220, v[232:233] offset:18432
    v_pk_fma_f32 v[196:197], v[196:197], v[160:161], v[164:165]
    v_pk_fma_f32 v[198:199], v[198:199], v[162:163], v[166:167]
    v_cvt_pk_bf16_f32 v234, v196, v197
    v_cvt_pk_bf16_f32 v235, v198, v199
    ds_write_b64 v220, v[234:235] offset:23040
    v_pk_fma_f32 v[200:201], v[200:201], v[160:161], v[164:165]
    v_pk_fma_f32 v[202:203], v[202:203], v[162:163], v[166:167]
    v_cvt_pk_bf16_f32 v236, v200, v201
    v_cvt_pk_bf16_f32 v237, v202, v203
    ds_write_b64 v220, v[236:237] offset:27648
    v_pk_fma_f32 v[204:205], v[204:205], v[160:161], v[164:165]
    v_pk_fma_f32 v[206:207], v[206:207], v[162:163], v[166:167]
    v_cvt_pk_bf16_f32 v238, v204, v205
    v_cvt_pk_bf16_f32 v239, v206, v207
    ds_write_b64 v220, v[238:239] offset:32256
    s_waitcnt lgkmcnt(0)
    s_barrier
    s_cmp_lg_u32 s56, 0
    s_cbranch_scc1 L_conv_noack
    s_lshl_b32 s6, s57, 2
    s_add_u32 s6, s6, 2048
    v_mov_b32 v10, s6
    v_mov_b32 v11, s60
    s_mov_b64 exec, 1
    buffer_store_dword v11, v10, s[40:43], 0 offen sc1
    s_mov_b64 exec, -1
L_conv_noack:
    ds_read_b128 v[176:179], v7 offset:448
    ds_read_b128 v[180:183], v7 offset:432
    ds_read_b64 v[248:249], v8 offset:2048
    s_waitcnt lgkmcnt(2)
    v_mfma_f32_16x16x32_bf16 v[212:215], v[176:179], v[128:131], 0
    ds_read_b128 v[184:187], v7 offset:960
    ds_read_b128 v[188:191], v7 offset:944
    v_mfma_f32_16x16x32_bf16 v[216:219], v[176:179], v[132:135], 0
    ds_read_b64 v[250:251], v8 offset:2560
    s_waitcnt lgkmcnt(4)
    v_mfma_f32_16x16x32_bf16 v[204:207], v[180:183], v[128:131], 0
    s_waitcnt lgkmcnt(3)
    v_lshlrev_b32 v160, 16, v248
    v_and_b32 v161, 0xffff0000, v248
    v_lshlrev_b32 v162, 16, v249
    v_and_b32 v163, 0xffff0000, v249
    v_mfma_f32_16x16x32_bf16 v[208:211], v[180:183], v[132:135], 0
    ds_read_b64 v[244:245], v8 offset:1024
    ds_read_b64 v[246:247], v8 offset:1536
    v_mfma_f32_16x16x32_bf16 v[160:163], v[124:127], v[176:179], v[160:163]
    ds_read_b64 v[252:253], v8 offset:3072
    ds_read2_b32 v[108:109], v15 offset0:131 offset1:130
    v_mfma_f32_16x16x32_bf16 v[224:227], v[176:179], v[140:143], 0
    s_waitcnt lgkmcnt(4)
    v_lshlrev_b32 v164, 16, v250
    v_mfma_f32_16x16x32_bf16 v[220:223], v[180:183], v[136:139], 0
    v_cvt_pk_bf16_f32 v232, v212, v216
    v_cvt_pk_bf16_f32 v233, v213, v217
    v_cvt_pk_bf16_f32 v234, v214, v218
    v_cvt_pk_bf16_f32 v235, v215, v219
    v_mfma_f32_16x16x32_bf16 v[212:215], v[184:187], v[128:131], 0
    v_and_b32 v165, 0xffff0000, v250
    v_lshlrev_b32 v166, 16, v251
    v_mfma_f32_16x16x32_bf16 v[216:219], v[184:187], v[132:135], 0
    v_cvt_pk_bf16_f32 v228, v204, v208
    v_cvt_pk_bf16_f32 v229, v205, v209
    v_cvt_pk_bf16_f32 v230, v206, v210
    v_cvt_pk_bf16_f32 v231, v207, v211
    v_mfma_f32_16x16x32_bf16 v[204:207], v[188:191], v[128:131], 0
    v_and_b32 v167, 0xffff0000, v251
    ds_read2_b32 v[110:111], v15 offset0:129 offset1:128
    v_mfma_f32_16x16x32_bf16 v[208:211], v[188:191], v[132:135], 0
    s_waitcnt lgkmcnt(1)
    v_lshlrev_b32 v152, 16, v244
    v_mfma_f32_16x16x32_bf16 v[164:167], v[124:127], v[184:187], v[164:167]
    v_cvt_pk_bf16_f32 v236, v220, v224
    v_cvt_pk_bf16_f32 v237, v221, v225
    v_cvt_pk_bf16_f32 v238, v222, v226
    v_cvt_pk_bf16_f32 v239, v223, v227
    v_mfma_f32_16x16x32_bf16 v[224:227], v[184:187], v[140:143], 0
    v_and_b32 v153, 0xffff0000, v244
    v_lshlrev_b32 v154, 16, v245
    v_and_b32 v155, 0xffff0000, v245
    v_mfma_f32_16x16x32_bf16 v[220:223], v[188:191], v[136:139], 0
    v_lshlrev_b32 v156, 16, v246
    v_and_b32 v157, 0xffff0000, v246
    v_lshlrev_b32 v158, 16, v247
    v_and_b32 v159, 0xffff0000, v247
    ds_read_b64 v[254:255], v8 offset:3584
    v_mfma_f32_16x16x32_bf16 v[152:155], v[232:235], v[96:99], v[152:155]
    ds_read2_b32 v[112:113], v15 offset0:147 offset1:146
    ds_read2_b32 v[114:115], v15 offset0:145 offset1:144
    v_mfma_f32_16x16x32_bf16 v[156:159], v[232:235], v[100:103], v[156:159]
    ds_read2_b32 v[116:117], v15 offset0:163 offset1:162
    ds_read2_b32 v[118:119], v15 offset0:161 offset1:160
    v_mfma_f32_16x16x32_bf16 v[160:163], v[232:235], v[104:107], v[160:163]
    ds_read2_b32 v[120:121], v15 offset0:179 offset1:178
    ds_read2_b32 v[122:123], v15 offset0:177 offset1:176
    v_mfma_f32_16x16x32_bf16 v[152:155], v[228:231], v[84:87], v[152:155]
    ds_read_b128 v[176:179], v7 offset:1472
    ds_read_b128 v[180:183], v7 offset:1456
    v_mfma_f32_16x16x32_bf16 v[156:159], v[228:231], v[88:91], v[156:159]
    v_lshlrev_b32 v168, 16, v252
    v_and_b32 v169, 0xffff0000, v252
    v_mfma_f32_16x16x32_bf16 v[160:163], v[228:231], v[92:95], v[160:163]
    v_lshlrev_b32 v170, 16, v253
    s_waitcnt lgkmcnt(6)
    v_mfma_f32_16x16x32_bf16 v[160:163], v[236:239], v[108:111], v[160:163]
    v_and_b32 v171, 0xffff0000, v253
    v_lshlrev_b32 v172, 16, v254
    v_mfma_f32_16x16x32_bf16 v[164:167], v[236:239], v[112:115], v[164:167]
    v_and_b32 v173, 0xffff0000, v254
    v_lshlrev_b32 v174, 16, v255
    v_and_b32 v175, 0xffff0000, v255
    s_waitcnt lgkmcnt(2)
    v_mfma_f32_16x16x32_bf16 v[168:171], v[236:239], v[116:119], v[168:171]
    v_cvt_pk_bf16_f32 v232, v212, v216
    v_cvt_pk_bf16_f32 v233, v213, v217
    v_mfma_f32_16x16x32_bf16 v[172:175], v[236:239], v[120:123], v[172:175]
    v_cvt_pk_bf16_f32 v234, v214, v218
    v_cvt_pk_bf16_f32 v235, v215, v219
    s_waitcnt lgkmcnt(0)
    v_mfma_f32_16x16x32_bf16 v[212:215], v[176:179], v[128:131], 0
    v_cvt_pk_bf16_f32 v228, v204, v208
    v_cvt_pk_bf16_f32 v229, v205, v209
    v_mfma_f32_16x16x32_bf16 v[216:219], v[176:179], v[132:135], 0
    v_cvt_pk_bf16_f32 v230, v206, v210
    v_cvt_pk_bf16_f32 v231, v207, v211
    v_mfma_f32_16x16x32_bf16 v[204:207], v[180:183], v[128:131], 0
    v_cvt_pk_bf16_f32 v236, v220, v224
    v_cvt_pk_bf16_f32 v237, v221, v225
    v_mfma_f32_16x16x32_bf16 v[208:211], v[180:183], v[132:135], 0
    v_cvt_pk_bf16_f32 v238, v222, v226
    v_cvt_pk_bf16_f32 v239, v223, v227
    v_mfma_f32_16x16x32_bf16 v[168:171], v[124:127], v[176:179], v[168:171]
    ds_read_b128 v[184:187], v7 offset:1984
    ds_read_b128 v[188:191], v7 offset:1968
    v_mfma_f32_16x16x32_bf16 v[224:227], v[176:179], v[140:143], 0
    ds_read_b64 v[240:241], v8 offset:0
    ds_read_b64 v[242:243], v8 offset:512
    v_mfma_f32_16x16x32_bf16 v[220:223], v[180:183], v[136:139], 0
    ds_read_b128 v[176:179], v7 offset:2496
    ds_read_b128 v[180:183], v7 offset:2480
    v_mfma_f32_16x16x32_bf16 v[156:159], v[232:235], v[96:99], v[156:159]
    ds_read2_b32 v[44:45], v12 offset0:230 offset1:228
    ds_read2_b32 v[46:47], v12 offset0:226 offset1:224
    v_mfma_f32_16x16x32_bf16 v[160:163], v[232:235], v[100:103], v[160:163]
    ds_read2_b32 v[76:77], v13 offset0:230 offset1:228
    ds_read2_b32 v[78:79], v13 offset0:226 offset1:224
    v_mfma_f32_16x16x32_bf16 v[164:167], v[232:235], v[104:107], v[164:167]
    v_cvt_pk_bf16_f32 v232, v212, v216
    v_cvt_pk_bf16_f32 v233, v213, v217
    v_mfma_f32_16x16x32_bf16 v[156:159], v[228:231], v[84:87], v[156:159]
    v_cvt_pk_bf16_f32 v234, v214, v218
    v_cvt_pk_bf16_f32 v235, v215, v219
    v_mfma_f32_16x16x32_bf16 v[160:163], v[228:231], v[88:91], v[160:163]
    ds_read2_b32 v[40:41], v12 offset0:198 offset1:196
    ds_read2_b32 v[42:43], v12 offset0:194 offset1:192
    v_mfma_f32_16x16x32_bf16 v[164:167], v[228:231], v[92:95], v[164:167]
    v_cvt_pk_bf16_f32 v228, v204, v208
    v_cvt_pk_bf16_f32 v229, v205, v209
    v_mfma_f32_16x16x32_bf16 v[164:167], v[236:239], v[108:111], v[164:167]
    v_cvt_pk_bf16_f32 v230, v206, v210
    v_cvt_pk_bf16_f32 v231, v207, v211
    v_mfma_f32_16x16x32_bf16 v[168:171], v[236:239], v[112:115], v[168:171]
    ds_read2_b32 v[72:73], v13 offset0:198 offset1:196
    ds_read2_b32 v[74:75], v13 offset0:194 offset1:192
    v_mfma_f32_16x16x32_bf16 v[172:175], v[236:239], v[116:119], v[172:175]
    v_cvt_pk_bf16_f32 v236, v220, v224
    s_waitcnt lgkmcnt(4)
    v_mfma_f32_16x16x32_bf16 v[212:215], v[184:187], v[128:131], 0
    v_cvt_pk_bf16_f32 v237, v221, v225
    v_cvt_pk_bf16_f32 v238, v222, v226
    v_mfma_f32_16x16x32_bf16 v[216:219], v[184:187], v[132:135], 0
    v_cvt_pk_bf16_f32 v239, v223, v227
    ds_read2_b32 v[36:37], v12 offset0:166 offset1:164
    v_mfma_f32_16x16x32_bf16 v[204:207], v[188:191], v[128:131], 0
    ds_read2_b32 v[38:39], v12 offset0:162 offset1:160
    ds_read2_b32 v[68:69], v13 offset0:166 offset1:164
    v_mfma_f32_16x16x32_bf16 v[208:211], v[188:191], v[132:135], 0
    ds_read2_b32 v[70:71], v13 offset0:162 offset1:160
    v_lshlrev_b32 v144, 16, v240
    v_mfma_f32_16x16x32_bf16 v[172:175], v[124:127], v[184:187], v[172:175]
    v_and_b32 v145, 0xffff0000, v240
    v_lshlrev_b32 v146, 16, v241
    v_mfma_f32_16x16x32_bf16 v[224:227], v[184:187], v[140:143], 0
    v_and_b32 v147, 0xffff0000, v241
    ds_read2_b32 v[32:33], v12 offset0:134 offset1:132
    v_mfma_f32_16x16x32_bf16 v[220:223], v[188:191], v[136:139], 0
    ds_read_b128 v[184:187], v7 offset:3008
    ds_read_b128 v[188:191], v7 offset:2992
    v_mfma_f32_16x16x32_bf16 v[160:163], v[232:235], v[96:99], v[160:163]
    ds_read2_b32 v[34:35], v12 offset0:130 offset1:128
    v_lshlrev_b32 v148, 16, v242
    v_mfma_f32_16x16x32_bf16 v[164:167], v[232:235], v[100:103], v[164:167]
    v_and_b32 v149, 0xffff0000, v242
    v_lshlrev_b32 v150, 16, v243
    v_mfma_f32_16x16x32_bf16 v[168:171], v[232:235], v[104:107], v[168:171]
    v_cvt_pk_bf16_f32 v232, v212, v216
    v_cvt_pk_bf16_f32 v233, v213, v217
    v_mfma_f32_16x16x32_bf16 v[160:163], v[228:231], v[84:87], v[160:163]
    v_cvt_pk_bf16_f32 v234, v214, v218
    v_cvt_pk_bf16_f32 v235, v215, v219
    v_mfma_f32_16x16x32_bf16 v[164:167], v[228:231], v[88:91], v[164:167]
    v_and_b32 v151, 0xffff0000, v243
    ds_read2_b32 v[64:65], v13 offset0:134 offset1:132
    v_mfma_f32_16x16x32_bf16 v[168:171], v[228:231], v[92:95], v[168:171]
    v_cvt_pk_bf16_f32 v228, v204, v208
    v_cvt_pk_bf16_f32 v229, v205, v209
    v_mfma_f32_16x16x32_bf16 v[168:171], v[236:239], v[108:111], v[168:171]
    v_cvt_pk_bf16_f32 v230, v206, v210
    v_cvt_pk_bf16_f32 v231, v207, v211
    v_mfma_f32_16x16x32_bf16 v[172:175], v[236:239], v[112:115], v[172:175]
    v_cvt_pk_bf16_f32 v236, v220, v224
    v_cvt_pk_bf16_f32 v237, v221, v225
    v_mfma_f32_16x16x32_bf16 v[212:215], v[176:179], v[128:131], 0
    v_cvt_pk_bf16_f32 v238, v222, v226
    v_cvt_pk_bf16_f32 v239, v223, v227
    v_mfma_f32_16x16x32_bf16 v[216:219], v[176:179], v[132:135], 0
    ds_read2_b32 v[66:67], v13 offset0:130 offset1:128
    ds_read2_b32 v[28:29], v12 offset0:102 offset1:100
    v_mfma_f32_16x16x32_bf16 v[204:207], v[180:183], v[128:131], 0
    ds_read2_b32 v[30:31], v12 offset0:98 offset1:96
    ds_read2_b32 v[60:61], v13 offset0:102 offset1:100
    v_mfma_f32_16x16x32_bf16 v[208:211], v[180:183], v[132:135], 0
    ds_read_b128 v[176:179], v7 offset:0
    ds_read_b128 v[180:183], v7 offset:64
    v_mfma_f32_16x16x32_bf16 v[164:167], v[232:235], v[96:99], v[164:167]
    ds_read2_b32 v[62:63], v13 offset0:98 offset1:96
    ds_read2_b32 v[24:25], v12 offset0:70 offset1:68
    v_mfma_f32_16x16x32_bf16 v[168:171], v[232:235], v[100:103], v[168:171]
    ds_read2_b32 v[26:27], v12 offset0:66 offset1:64
    ds_read2_b32 v[56:57], v13 offset0:70 offset1:68
    v_mfma_f32_16x16x32_bf16 v[172:175], v[232:235], v[104:107], v[172:175]
    ds_read2_b32 v[58:59], v13 offset0:66 offset1:64
    ds_read2_b32 v[20:21], v12 offset0:38 offset1:36
    v_mfma_f32_16x16x32_bf16 v[164:167], v[228:231], v[84:87], v[164:167]
    ds_read2_b32 v[22:23], v12 offset0:34 offset1:32
    ds_read2_b32 v[52:53], v13 offset0:38 offset1:36
    v_mfma_f32_16x16x32_bf16 v[168:171], v[228:231], v[88:91], v[168:171]
    v_cvt_pk_bf16_f32 v232, v212, v216
    v_cvt_pk_bf16_f32 v233, v213, v217
    v_mfma_f32_16x16x32_bf16 v[172:175], v[228:231], v[92:95], v[172:175]
    v_cvt_pk_bf16_f32 v234, v214, v218
    v_cvt_pk_bf16_f32 v235, v215, v219
    v_mfma_f32_16x16x32_bf16 v[172:175], v[236:239], v[108:111], v[172:175]
    v_cvt_pk_bf16_f32 v228, v204, v208
    s_waitcnt lgkmcnt(4)
    v_mfma_f32_16x16x32_bf16 v[212:215], v[184:187], v[128:131], 0
    v_cvt_pk_bf16_f32 v229, v205, v209
    v_cvt_pk_bf16_f32 v230, v206, v210
    v_mfma_f32_16x16x32_bf16 v[216:219], v[184:187], v[132:135], 0
    v_cvt_pk_bf16_f32 v231, v207, v211
    ds_read2_b32 v[54:55], v13 offset0:34 offset1:32
    v_mfma_f32_16x16x32_bf16 v[204:207], v[188:191], v[128:131], 0
    ds_read2_b32 v[16:17], v12 offset0:6 offset1:4
    ds_read2_b32 v[18:19], v12 offset0:2 offset1:0
    v_mfma_f32_16x16x32_bf16 v[208:211], v[188:191], v[132:135], 0
    ds_read_b128 v[184:187], v7 offset:128
    ds_read_b128 v[188:191], v7 offset:192
    v_mfma_f32_16x16x32_bf16 v[168:171], v[232:235], v[96:99], v[168:171]
    ds_read_b128 v[192:195], v7 offset:256
    ds_read_b128 v[196:199], v7 offset:320
    v_mfma_f32_16x16x32_bf16 v[172:175], v[232:235], v[100:103], v[172:175]
    ds_read2_b32 v[48:49], v13 offset0:6 offset1:4
    ds_read2_b32 v[50:51], v13 offset0:2 offset1:0
    v_mfma_f32_16x16x32_bf16 v[168:171], v[228:231], v[84:87], v[168:171]
    v_cvt_pk_bf16_f32 v232, v212, v216
    v_cvt_pk_bf16_f32 v233, v213, v217
    v_cvt_pk_bf16_f32 v234, v214, v218
    v_cvt_pk_bf16_f32 v235, v215, v219
    v_mfma_f32_16x16x32_bf16 v[172:175], v[228:231], v[88:91], v[172:175]
    v_cvt_pk_bf16_f32 v228, v204, v208
    v_cvt_pk_bf16_f32 v229, v205, v209
    v_cvt_pk_bf16_f32 v230, v206, v210
    v_cvt_pk_bf16_f32 v231, v207, v211
    v_mfma_f32_16x16x32_bf16 v[172:175], v[232:235], v[96:99], v[172:175]
    ds_read2_b32 v[80:81], v14 offset0:6 offset1:4
    ds_read2_b32 v[82:83], v14 offset0:2 offset1:0
    v_mfma_f32_16x16x32_bf16 v[172:175], v[228:231], v[84:87], v[172:175]
    v_mfma_f32_16x16x32_bf16 v[144:147], v[44:47], v[176:179], v[144:147]
    v_mfma_f32_16x16x32_bf16 v[148:151], v[76:79], v[176:179], v[148:151]
    ds_read_b128 v[176:179], v7 offset:384
    v_mfma_f32_16x16x32_bf16 v[144:147], v[40:43], v[180:183], v[144:147]
    v_mfma_f32_16x16x32_bf16 v[148:151], v[72:75], v[180:183], v[148:151]
    ds_read_b128 v[180:183], v7 offset:448
    s_waitcnt lgkmcnt(2)
    v_mfma_f32_16x16x32_bf16 v[144:147], v[36:39], v[184:187], v[144:147]
    v_mfma_f32_16x16x32_bf16 v[148:151], v[68:71], v[184:187], v[148:151]
    ds_read_b128 v[184:187], v7 offset:512
    v_mfma_f32_16x16x32_bf16 v[144:147], v[32:35], v[188:191], v[144:147]
    v_mfma_f32_16x16x32_bf16 v[148:151], v[64:67], v[188:191], v[148:151]
    ds_read_b128 v[188:191], v7 offset:576
    v_mfma_f32_16x16x32_bf16 v[144:147], v[28:31], v[192:195], v[144:147]
    v_mfma_f32_16x16x32_bf16 v[148:151], v[60:63], v[192:195], v[148:151]
    ds_read_b128 v[192:195], v7 offset:640
    v_mfma_f32_16x16x32_bf16 v[144:147], v[24:27], v[196:199], v[144:147]
    v_mfma_f32_16x16x32_bf16 v[148:151], v[56:59], v[196:199], v[148:151]
    ds_read_b128 v[196:199], v7 offset:704
    s_waitcnt lgkmcnt(3)
    v_mfma_f32_16x16x32_bf16 v[144:147], v[20:23], v[176:179], v[144:147]
    v_mfma_f32_16x16x32_bf16 v[148:151], v[52:55], v[176:179], v[148:151]
    ds_read_b128 v[176:179], v7 offset:768
    v_mfma_f32_16x16x32_bf16 v[144:147], v[16:19], v[180:183], v[144:147]
    v_mfma_f32_16x16x32_bf16 v[148:151], v[48:51], v[180:183], v[148:151]
    v_mfma_f32_16x16x32_bf16 v[152:155], v[80:83], v[180:183], v[152:155]
    ds_read_b128 v[180:183], v7 offset:832
    v_mfma_f32_16x16x32_bf16 v[148:151], v[44:47], v[184:187], v[148:151]
    v_mfma_f32_16x16x32_bf16 v[152:155], v[76:79], v[184:187], v[152:155]
    ds_read_b128 v[184:187], v7 offset:896
    s_waitcnt lgkmcnt(2)
    v_mfma_f32_16x16x32_bf16 v[148:151], v[40:43], v[188:191], v[148:151]
    v_mfma_f32_16x16x32_bf16 v[152:155], v[72:75], v[188:191], v[152:155]
    ds_read_b128 v[188:191], v7 offset:960
    v_mfma_f32_16x16x32_bf16 v[148:151], v[36:39], v[192:195], v[148:151]
    v_cvt_pk_bf16_f32 v10, v144, v145
    v_cvt_pk_bf16_f32 v11, v146, v147
    v_mfma_f32_16x16x32_bf16 v[152:155], v[68:71], v[192:195], v[152:155]
    ds_write_b64 v8, v[10:11] offset:0
    ds_read_b128 v[192:195], v7 offset:1024
    v_mfma_f32_16x16x32_bf16 v[148:151], v[32:35], v[196:199], v[148:151]
    v_mfma_f32_16x16x32_bf16 v[152:155], v[64:67], v[196:199], v[152:155]
    ds_read_b128 v[196:199], v7 offset:1088
    v_mfma_f32_16x16x32_bf16 v[148:151], v[28:31], v[176:179], v[148:151]
    v_mfma_f32_16x16x32_bf16 v[152:155], v[60:63], v[176:179], v[152:155]
    ds_read_b128 v[176:179], v7 offset:1152
    s_waitcnt lgkmcnt(4)
    v_mfma_f32_16x16x32_bf16 v[148:151], v[24:27], v[180:183], v[148:151]
    v_mfma_f32_16x16x32_bf16 v[152:155], v[56:59], v[180:183], v[152:155]
    ds_read_b128 v[180:183], v7 offset:1216
    v_mfma_f32_16x16x32_bf16 v[148:151], v[20:23], v[184:187], v[148:151]
    v_mfma_f32_16x16x32_bf16 v[152:155], v[52:55], v[184:187], v[152:155]
    ds_read_b128 v[184:187], v7 offset:1280
    v_mfma_f32_16x16x32_bf16 v[148:151], v[16:19], v[188:191], v[148:151]
    v_mfma_f32_16x16x32_bf16 v[152:155], v[48:51], v[188:191], v[152:155]
    v_mfma_f32_16x16x32_bf16 v[156:159], v[80:83], v[188:191], v[156:159]
    ds_read_b128 v[188:191], v7 offset:1344
    s_waitcnt lgkmcnt(2)
    v_mfma_f32_16x16x32_bf16 v[152:155], v[44:47], v[192:195], v[152:155]
    v_mfma_f32_16x16x32_bf16 v[156:159], v[76:79], v[192:195], v[156:159]
    ds_read_b128 v[192:195], v7 offset:1408
    v_mfma_f32_16x16x32_bf16 v[152:155], v[40:43], v[196:199], v[152:155]
    v_mfma_f32_16x16x32_bf16 v[156:159], v[72:75], v[196:199], v[156:159]
    ds_read_b128 v[196:199], v7 offset:1472
    v_mfma_f32_16x16x32_bf16 v[152:155], v[36:39], v[176:179], v[152:155]
    v_cvt_pk_bf16_f32 v10, v148, v149
    v_cvt_pk_bf16_f32 v11, v150, v151
    v_mfma_f32_16x16x32_bf16 v[156:159], v[68:71], v[176:179], v[156:159]
    ds_write_b64 v8, v[10:11] offset:512
    ds_read_b128 v[176:179], v7 offset:1536
    v_mfma_f32_16x16x32_bf16 v[152:155], v[32:35], v[180:183], v[152:155]
    v_mfma_f32_16x16x32_bf16 v[156:159], v[64:67], v[180:183], v[156:159]
    ds_read_b128 v[180:183], v7 offset:1600
    s_waitcnt lgkmcnt(4)
    v_mfma_f32_16x16x32_bf16 v[152:155], v[28:31], v[184:187], v[152:155]
    v_mfma_f32_16x16x32_bf16 v[156:159], v[60:63], v[184:187], v[156:159]
    ds_read_b128 v[184:187], v7 offset:1664
    v_mfma_f32_16x16x32_bf16 v[152:155], v[24:27], v[188:191], v[152:155]
    s_waitcnt lgkmcnt(3)
    s_barrier
    v_mfma_f32_16x16x32_bf16 v[156:159], v[56:59], v[188:191], v[156:159]
    ds_read_b64_tr_b16 v[12:13], v4 offset:0
    ds_read_b64_tr_b16 v[14:15], v4 offset:16640
    v_mfma_f32_16x16x32_bf16 v[152:155], v[20:23], v[192:195], v[152:155]
    ds_read_b128 v[188:191], v7 offset:1728
    v_mfma_f32_16x16x32_bf16 v[156:159], v[52:55], v[192:195], v[156:159]
    ds_read_b128 v[192:195], v7 offset:1792
    v_mfma_f32_16x16x32_bf16 v[152:155], v[16:19], v[196:199], v[152:155]
    v_mfma_f32_16x16x32_bf16 v[156:159], v[48:51], v[196:199], v[156:159]
    v_mfma_f32_16x16x32_bf16 v[160:163], v[80:83], v[196:199], v[160:163]
    ds_read_b128 v[196:199], v7 offset:1856
    s_waitcnt lgkmcnt(3)
    v_mfma_f32_16x16x32_bf16 v[156:159], v[44:47], v[176:179], v[156:159]
    buffer_store_dwordx4 v[12:15], v5, s[44:47], 0 offen
    v_mfma_f32_16x16x32_bf16 v[160:163], v[76:79], v[176:179], v[160:163]
    ds_read_b128 v[176:179], v7 offset:1920
    v_mfma_f32_16x16x32_bf16 v[156:159], v[40:43], v[180:183], v[156:159]
    v_mfma_f32_16x16x32_bf16 v[160:163], v[72:75], v[180:183], v[160:163]
    ds_read_b128 v[180:183], v7 offset:1984
    v_mfma_f32_16x16x32_bf16 v[156:159], v[36:39], v[184:187], v[156:159]
    v_cvt_pk_bf16_f32 v10, v152, v153
    v_cvt_pk_bf16_f32 v11, v154, v155
    v_mfma_f32_16x16x32_bf16 v[160:163], v[68:71], v[184:187], v[160:163]
    ds_write_b64 v8, v[10:11] offset:1024
    s_waitcnt lgkmcnt(3)
    v_mfma_f32_16x16x32_bf16 v[156:159], v[32:35], v[188:191], v[156:159]
    ds_read_b128 v[184:187], v7 offset:2048
    v_mfma_f32_16x16x32_bf16 v[160:163], v[64:67], v[188:191], v[160:163]
    ds_read_b128 v[188:191], v7 offset:2112
    v_mfma_f32_16x16x32_bf16 v[156:159], v[28:31], v[192:195], v[156:159]
    v_mfma_f32_16x16x32_bf16 v[160:163], v[60:63], v[192:195], v[160:163]
    ds_read_b128 v[192:195], v7 offset:2176
    v_mfma_f32_16x16x32_bf16 v[156:159], v[24:27], v[196:199], v[156:159]
    v_mfma_f32_16x16x32_bf16 v[160:163], v[56:59], v[196:199], v[160:163]
    ds_read_b128 v[196:199], v7 offset:2240
    s_waitcnt lgkmcnt(3)
    v_mfma_f32_16x16x32_bf16 v[156:159], v[20:23], v[176:179], v[156:159]
    v_mfma_f32_16x16x32_bf16 v[160:163], v[52:55], v[176:179], v[160:163]
    ds_read_b128 v[176:179], v7 offset:2304
    v_mfma_f32_16x16x32_bf16 v[156:159], v[16:19], v[180:183], v[156:159]
    v_mfma_f32_16x16x32_bf16 v[160:163], v[48:51], v[180:183], v[160:163]
    v_mfma_f32_16x16x32_bf16 v[164:167], v[80:83], v[180:183], v[164:167]
    ds_read_b128 v[180:183], v7 offset:2368
    v_mfma_f32_16x16x32_bf16 v[160:163], v[44:47], v[184:187], v[160:163]
    v_mfma_f32_16x16x32_bf16 v[164:167], v[76:79], v[184:187], v[164:167]
    ds_read_b128 v[184:187], v7 offset:2432
    s_waitcnt lgkmcnt(2)
    v_mfma_f32_16x16x32_bf16 v[160:163], v[40:43], v[188:191], v[160:163]
    v_mfma_f32_16x16x32_bf16 v[164:167], v[72:75], v[188:191], v[164:167]
    ds_read_b128 v[188:191], v7 offset:2496
    v_mfma_f32_16x16x32_bf16 v[160:163], v[36:39], v[192:195], v[160:163]
    v_cvt_pk_bf16_f32 v10, v156, v157
    v_cvt_pk_bf16_f32 v11, v158, v159
    v_mfma_f32_16x16x32_bf16 v[164:167], v[68:71], v[192:195], v[164:167]
    ds_write_b64 v8, v[10:11] offset:1536
    ds_read_b128 v[192:195], v7 offset:2560
    v_mfma_f32_16x16x32_bf16 v[160:163], v[32:35], v[196:199], v[160:163]
    v_mfma_f32_16x16x32_bf16 v[164:167], v[64:67], v[196:199], v[164:167]
    ds_read_b128 v[196:199], v7 offset:2624
    v_mfma_f32_16x16x32_bf16 v[160:163], v[28:31], v[176:179], v[160:163]
    v_mfma_f32_16x16x32_bf16 v[164:167], v[60:63], v[176:179], v[164:167]
    ds_read_b128 v[176:179], v7 offset:2688
    s_waitcnt lgkmcnt(4)
    v_mfma_f32_16x16x32_bf16 v[160:163], v[24:27], v[180:183], v[160:163]
    buffer_load_dwordx4 v[108:111], v6, s[40:43], 0 offen sc1
    v_mfma_f32_16x16x32_bf16 v[164:167], v[56:59], v[180:183], v[164:167]
    s_waitcnt lgkmcnt(2)
    s_barrier
    v_mfma_f32_16x16x32_bf16 v[160:163], v[20:23], v[184:187], v[160:163]
    ds_read_b64_tr_b16 v[12:13], v4 offset:1024
    ds_read_b64_tr_b16 v[14:15], v4 offset:17664
    v_mfma_f32_16x16x32_bf16 v[164:167], v[52:55], v[184:187], v[164:167]
    ds_read_b128 v[180:183], v7 offset:2752
    ds_read_b128 v[184:187], v7 offset:2816
    v_mfma_f32_16x16x32_bf16 v[160:163], v[16:19], v[188:191], v[160:163]
    v_mfma_f32_16x16x32_bf16 v[164:167], v[48:51], v[188:191], v[164:167]
    v_mfma_f32_16x16x32_bf16 v[168:171], v[80:83], v[188:191], v[168:171]
    ds_read_b128 v[188:191], v7 offset:2880
    v_mfma_f32_16x16x32_bf16 v[164:167], v[44:47], v[192:195], v[164:167]
    s_waitcnt lgkmcnt(3)
    buffer_store_dwordx4 v[12:15], v5, s[44:47], s50 offen
    v_mfma_f32_16x16x32_bf16 v[168:171], v[76:79], v[192:195], v[168:171]
    ds_read_b128 v[192:195], v7 offset:2944
    v_mfma_f32_16x16x32_bf16 v[164:167], v[40:43], v[196:199], v[164:167]
    v_mfma_f32_16x16x32_bf16 v[168:171], v[72:75], v[196:199], v[168:171]
    ds_read_b128 v[196:199], v7 offset:3008
    v_mfma_f32_16x16x32_bf16 v[164:167], v[36:39], v[176:179], v[164:167]
    v_cvt_pk_bf16_f32 v10, v160, v161
    v_cvt_pk_bf16_f32 v11, v162, v163
    v_mfma_f32_16x16x32_bf16 v[168:171], v[68:71], v[176:179], v[168:171]
    ds_write_b64 v8, v[10:11] offset:2048
    s_waitcnt lgkmcnt(3)
    v_mfma_f32_16x16x32_bf16 v[164:167], v[32:35], v[180:183], v[164:167]
    ds_read_b128 v[176:179], v7 offset:3072
    v_mfma_f32_16x16x32_bf16 v[168:171], v[64:67], v[180:183], v[168:171]
    ds_read_b128 v[180:183], v7 offset:3136
    v_mfma_f32_16x16x32_bf16 v[164:167], v[28:31], v[184:187], v[164:167]
    v_mfma_f32_16x16x32_bf16 v[168:171], v[60:63], v[184:187], v[168:171]
    ds_read_b128 v[184:187], v7 offset:3200
    v_mfma_f32_16x16x32_bf16 v[164:167], v[24:27], v[188:191], v[164:167]
    v_mfma_f32_16x16x32_bf16 v[168:171], v[56:59], v[188:191], v[168:171]
    ds_read_b128 v[188:191], v7 offset:3264
    s_waitcnt lgkmcnt(3)
    v_mfma_f32_16x16x32_bf16 v[164:167], v[20:23], v[192:195], v[164:167]
    v_mfma_f32_16x16x32_bf16 v[168:171], v[52:55], v[192:195], v[168:171]
    ds_read_b128 v[192:195], v7 offset:3328
    v_mfma_f32_16x16x32_bf16 v[164:167], v[16:19], v[196:199], v[164:167]
    v_mfma_f32_16x16x32_bf16 v[168:171], v[48:51], v[196:199], v[168:171]
    v_mfma_f32_16x16x32_bf16 v[172:175], v[80:83], v[196:199], v[172:175]
    ds_read_b128 v[196:199], v7 offset:3392
    v_mfma_f32_16x16x32_bf16 v[168:171], v[44:47], v[176:179], v[168:171]
    v_mfma_f32_16x16x32_bf16 v[172:175], v[76:79], v[176:179], v[172:175]
    ds_read_b128 v[176:179], v7 offset:3456
    s_waitcnt lgkmcnt(2)
    v_mfma_f32_16x16x32_bf16 v[168:171], v[40:43], v[180:183], v[168:171]
    v_mfma_f32_16x16x32_bf16 v[172:175], v[72:75], v[180:183], v[172:175]
    ds_read_b128 v[180:183], v7 offset:3520
    v_mfma_f32_16x16x32_bf16 v[168:171], v[36:39], v[184:187], v[168:171]
    v_cvt_pk_bf16_f32 v10, v164, v165
    v_cvt_pk_bf16_f32 v11, v166, v167
    v_mfma_f32_16x16x32_bf16 v[172:175], v[68:71], v[184:187], v[172:175]
    ds_read_b128 v[184:187], v7 offset:3584
    ds_write_b64 v8, v[10:11] offset:2560
    v_mfma_f32_16x16x32_bf16 v[168:171], v[32:35], v[188:191], v[168:171]
    v_mfma_f32_16x16x32_bf16 v[172:175], v[64:67], v[188:191], v[172:175]
    ds_read_b128 v[188:191], v7 offset:3648
    v_mfma_f32_16x16x32_bf16 v[168:171], v[28:31], v[192:195], v[168:171]
    v_mfma_f32_16x16x32_bf16 v[172:175], v[60:63], v[192:195], v[172:175]
    ds_read_b128 v[192:195], v7 offset:3712
    s_waitcnt lgkmcnt(4)
    v_mfma_f32_16x16x32_bf16 v[168:171], v[24:27], v[196:199], v[168:171]
    s_waitcnt lgkmcnt(2)
    s_barrier
    v_mfma_f32_16x16x32_bf16 v[172:175], v[56:59], v[196:199], v[172:175]
    ds_read_b128 v[196:199], v7 offset:3776
    ds_read_b64_tr_b16 v[12:13], v4 offset:2048
    v_mfma_f32_16x16x32_bf16 v[168:171], v[20:23], v[176:179], v[168:171]
    ds_read_b64_tr_b16 v[14:15], v4 offset:18688
    v_mfma_f32_16x16x32_bf16 v[172:175], v[52:55], v[176:179], v[172:175]
    ds_read_b128 v[176:179], v7 offset:3840
    v_mfma_f32_16x16x32_bf16 v[168:171], v[16:19], v[180:183], v[168:171]
    v_mfma_f32_16x16x32_bf16 v[172:175], v[48:51], v[180:183], v[172:175]
    ds_read_b128 v[180:183], v7 offset:3904
    v_mfma_f32_16x16x32_bf16 v[172:175], v[44:47], v[184:187], v[172:175]
    ds_read_b128 v[184:187], v7 offset:3968
    s_waitcnt lgkmcnt(4)
    v_mfma_f32_16x16x32_bf16 v[172:175], v[40:43], v[188:191], v[172:175]
    ds_read_b128 v[188:191], v7 offset:4032
    v_mfma_f32_16x16x32_bf16 v[172:175], v[36:39], v[192:195], v[172:175]
    s_waitcnt lgkmcnt(4)
    buffer_store_dwordx4 v[12:15], v5, s[44:47], s51 offen
    v_mfma_f32_16x16x32_bf16 v[172:175], v[32:35], v[196:199], v[172:175]
    s_waitcnt lgkmcnt(3)
    v_mfma_f32_16x16x32_bf16 v[172:175], v[28:31], v[176:179], v[172:175]
    s_waitcnt lgkmcnt(2)
    v_mfma_f32_16x16x32_bf16 v[172:175], v[24:27], v[180:183], v[172:175]
    v_cvt_pk_bf16_f32 v10, v168, v169
    s_waitcnt lgkmcnt(1)
    v_mfma_f32_16x16x32_bf16 v[172:175], v[20:23], v[184:187], v[172:175]
    v_cvt_pk_bf16_f32 v11, v170, v171
    s_waitcnt lgkmcnt(0)
    v_mfma_f32_16x16x32_bf16 v[172:175], v[16:19], v[188:191], v[172:175]
    ds_write_b64 v8, v[10:11] offset:3072
    s_waitcnt vmcnt(2)
    v_cmp_ne_u32 vcc, s60, v111
    s_cbranch_vccz L_conv_selok
    s_mov_b32 s54, 0
L_poll_sel:
    buffer_load_dwordx4 v[108:111], v6, s[40:43], 0 offen sc1
    s_waitcnt vmcnt(0)
    v_xor_b32 v16, s60, v111
    v_cmp_ne_u32 vcc, 0, v16
    s_cbranch_vccz L_polled_sel
    s_add_u32 s54, s54, 1
    s_cmp_ge_u32 s54, 65536
    s_cbranch_scc1 L_polled_sel
    s_sleep 2
    s_branch L_poll_sel
L_polled_sel:
L_conv_selok:
    s_lshl_b32 s6, s57, 11
    s_add_u32 s6, s6, 491520
    v_bfe_u32 v16, v1, 2, 1
    v_lshlrev_b32 v16, 7, v16
    v_and_b32 v17, 3, v1
    v_lshl_add_u32 v16, v17, 2, v16
    v_subrev_u32 v18, 24576, v6
    v_add3_u32 v9, v16, v18, s6
    s_cmp_lg_u32 s56, 0
    s_cbranch_scc1 L_conv_noy
    buffer_load_dword v112, v9, s[40:43], 0 offen offset:0 sc1
    buffer_load_dword v113, v9, s[40:43], 0 offen offset:256 sc1
    buffer_load_dword v114, v9, s[40:43], 0 offen offset:512 sc1
    buffer_load_dword v115, v9, s[40:43], 0 offen offset:768 sc1
    buffer_load_dword v116, v9, s[40:43], 0 offen offset:1024 sc1
    buffer_load_dword v117, v9, s[40:43], 0 offen offset:1280 sc1
    buffer_load_dword v118, v9, s[40:43], 0 offen offset:1536 sc1
    buffer_load_dword v119, v9, s[40:43], 0 offen offset:1792 sc1
L_conv_noy:
    v_cvt_pk_bf16_f32 v10, v172, v173
    v_cvt_pk_bf16_f32 v11, v174, v175
    ds_write_b64 v8, v[10:11] offset:3584
    v_readlane_b32 s8, v108, 0
    v_readlane_b32 s9, v108, 8
    v_readlane_b32 s10, v108, 16
    v_readlane_b32 s11, v108, 24
    v_readlane_b32 s12, v108, 32
    v_readlane_b32 s13, v108, 40
    v_readlane_b32 s14, v108, 48
    v_readlane_b32 s15, v108, 56
    v_add_u32 v16, 1536, v0
    s_mov_b32 s54, 0x300000
    v_cmp_ne_u32 s[16:17], s8, v16
    v_cmp_ne_u32 s[18:19], s9, v16
    v_cmp_ne_u32 s[20:21], s10, v16
    v_cmp_ne_u32 s[22:23], s11, v16
    v_cmp_ne_u32 s[24:25], s12, v16
    v_cmp_ne_u32 s[26:27], s13, v16
    v_cmp_ne_u32 s[28:29], s14, v16
    v_cmp_ne_u32 s[30:31], s15, v16
    s_and_b64 s[16:17], s[16:17], s[18:19]
    s_and_b64 s[20:21], s[20:21], s[22:23]
    s_and_b64 s[24:25], s[24:25], s[26:27]
    s_and_b64 s[28:29], s[28:29], s[30:31]
    s_and_b64 s[16:17], s[16:17], s[20:21]
    s_and_b64 s[24:25], s[24:25], s[28:29]
    s_and_b64 s[16:17], s[16:17], s[24:25]
    s_waitcnt lgkmcnt(0)
    s_barrier
    ds_read_b64_tr_b16 v[12:13], v4 offset:3072
    ds_read_b64_tr_b16 v[14:15], v4 offset:19712
    s_cmp_eq_u32 s56, 0
    s_cbranch_scc1 L_conv_fin
    s_waitcnt lgkmcnt(0)
    s_mov_b64 exec, s[16:17]
    buffer_store_dwordx4 v[12:15], v5, s[44:47], s54 offen
    s_waitcnt vmcnt(1)
    s_barrier
    s_branch L_conv_end
L_conv_fin:
    v_and_b32 v16, 7, v1
    v_mul_u32_u24 v18, 4160, v16
    v_lshl_add_u32 v18, v108, 1, v18
    v_add_u32 v18, 129024, v18
    ds_read_u16 v20, v18
    v_lshlrev_b32 v18, 11, v108
    v_lshl_add_u32 v18, v16, 1, v18
    v_add_u32 v18, s58, v18
    v_lshlrev_b32 v17, 3, v17
    v_lshrrev_b32 v17, v17, s60
    v_mov_b32 v19, 0xff
    s_waitcnt lgkmcnt(1)
    s_mov_b64 exec, s[16:17]
    buffer_store_dwordx4 v[12:15], v5, s[44:47], s54 offen
    s_mov_b64 exec, -1
    s_mov_b32 s54, 0
    s_waitcnt vmcnt(1)
L_conv_y:
    v_bitop3_b32 v24, v112, v113, v17 bitop3:0x7e
    v_bitop3_b32 v25, v114, v115, v17 bitop3:0x7e
    v_bitop3_b32 v26, v116, v117, v17 bitop3:0x7e
    v_bitop3_b32 v27, v118, v119, v17 bitop3:0x7e
    v_or3_b32 v24, v24, v25, v26
    v_bitop3_b32 v24, v24, v27, v19 bitop3:0xa8
    v_cmp_ne_u32 vcc, 0, v24
    s_cbranch_vccz L_conv_yok
    s_add_u32 s54, s54, 1
    s_cmp_ge_u32 s54, 65536
    s_cbranch_scc1 L_conv_yok
    buffer_load_dword v112, v9, s[40:43], 0 offen offset:0 sc1
    buffer_load_dword v113, v9, s[40:43], 0 offen offset:256 sc1
    buffer_load_dword v114, v9, s[40:43], 0 offen offset:512 sc1
    buffer_load_dword v115, v9, s[40:43], 0 offen offset:768 sc1
    buffer_load_dword v116, v9, s[40:43], 0 offen offset:1024 sc1
    buffer_load_dword v117, v9, s[40:43], 0 offen offset:1280 sc1
    buffer_load_dword v118, v9, s[40:43], 0 offen offset:1536 sc1
    buffer_load_dword v119, v9, s[40:43], 0 offen offset:1792 sc1
    s_waitcnt vmcnt(0)
    s_branch L_conv_y
L_conv_yok:
    v_pk_add_f32 v[112:113], v[112:113], v[116:117]
    v_pk_add_f32 v[114:115], v[114:115], v[118:119]
    s_waitcnt lgkmcnt(0)
    v_lshlrev_b32 v20, 16, v20
    v_pk_add_f32 v[112:113], v[112:113], v[114:115]
    v_add_f32 v112, v112, v113
    v_fma_f32 v20, v112, v109, v20
    v_cvt_pk_bf16_f32 v20, v20, v20
    s_barrier
    buffer_store_short v20, v18, s[44:47], 0 offen
L_conv_end:
    s_endpgm
L_code_end:
.p2align 7
L_bands:
.long 0x0, 0x0, 0x0, 0x3f803f80
.long 0x0, 0x0, 0x0, 0x3f800000
.long 0x0, 0x0, 0x0, 0x0
.long 0x0, 0x0, 0x0, 0x0
.long 0x0, 0x0, 0x0, 0x0
.long 0x0, 0x0, 0x0, 0x0
.long 0x0, 0x0, 0x0, 0x0
.long 0x0, 0x0, 0x0, 0x0
.long 0x0, 0x0, 0x0, 0x0
.long 0x0, 0x0, 0x0, 0x0
.long 0x0, 0x0, 0x0, 0x0
.long 0x0, 0x0, 0x0, 0x0
.long 0x0, 0x0, 0x0, 0x0
.long 0x0, 0x0, 0x0, 0x0
.long 0x0, 0x0, 0x0, 0x0
.long 0x0, 0x0, 0x0, 0x0
.long 0x3f803f80, 0x3f80, 0x0, 0x0
.long 0x3f803f80, 0x3f803f80, 0x0, 0x0
.long 0x3f803f80, 0x3f803f80, 0x3f80, 0x0
.long 0x3f800000, 0x3f803f80, 0x3f803f80, 0x0
.long 0x0, 0x3f803f80, 0x3f803f80, 0x3f80
.long 0x0, 0x3f800000, 0x3f803f80, 0x3f803f80
.long 0x0, 0x0, 0x3f803f80, 0x3f803f80
.long 0x0, 0x0, 0x3f800000, 0x3f803f80
.long 0x0, 0x0, 0x0, 0x3f803f80
.long 0x0, 0x0, 0x0, 0x3f800000
.long 0x0, 0x0, 0x0, 0x0
.long 0x0, 0x0, 0x0, 0x0
.long 0x0, 0x0, 0x0, 0x0
.long 0x0, 0x0, 0x0, 0x0
.long 0x0, 0x0, 0x0, 0x0
.long 0x0, 0x0, 0x0, 0x0
.long 0x0, 0x0, 0x0, 0x0
.long 0x0, 0x0, 0x0, 0x0
.long 0x0, 0x0, 0x0, 0x0
.long 0x0, 0x0, 0x0, 0x0
.long 0x0, 0x0, 0x0, 0x0
.long 0x0, 0x0, 0x0, 0x0
.long 0x3f80, 0x0, 0x0, 0x0
.long 0x3f803f80, 0x0, 0x0, 0x0
.long 0x3f803f80, 0x3f80, 0x0, 0x0
.long 0x3f803f80, 0x3f803f80, 0x0, 0x0
.long 0x3f803f80, 0x3f803f80, 0x3f80, 0x0
.long 0x3f800000, 0x3f803f80, 0x3f803f80, 0x0
.long 0x0, 0x3f803f80, 0x3f803f80, 0x3f80
.long 0x0, 0x3f800000, 0x3f803f80, 0x3f803f80
.long 0x0, 0x0, 0x3f803f80, 0x3f803f80
.long 0x0, 0x0, 0x3f800000, 0x3f803f80
.long 0x0, 0x0, 0x0, 0x0
.long 0x0, 0x0, 0x0, 0x0
.long 0x0, 0x0, 0x0, 0x0
.long 0x0, 0x0, 0x0, 0x0
.long 0x0, 0x0, 0x0, 0x0
.long 0x0, 0x0, 0x0, 0x0
.long 0x0, 0x0, 0x0, 0x0
.long 0x0, 0x0, 0x0, 0x0
.long 0x0, 0x0, 0x0, 0x0
.long 0x0, 0x0, 0x0, 0x0
.long 0x0, 0x0, 0x0, 0x0
.long 0x0, 0x0, 0x0, 0x0
.long 0x0, 0x0, 0x0, 0x0
.long 0x0, 0x0, 0x0, 0x0
.long 0x3f80, 0x0, 0x0, 0x0
.long 0x3f803f80, 0x0, 0x0, 0x0
.long 0x0, 0x3f800000, 0x3f803f80, 0x0
.long 0x0, 0x0, 0x3f803f80, 0x3f80
.long 0x0, 0x0, 0x3f800000, 0x3f803f80
.long 0x0, 0x0, 0x0, 0x3f803f80
.long 0x0, 0x0, 0x0, 0x3f800000
.long 0x0, 0x0, 0x0, 0x0
.long 0x0, 0x0, 0x0, 0x0
.long 0x0, 0x0, 0x0, 0x0
.long 0x0, 0x0, 0x0, 0x0
.long 0x0, 0x0, 0x0, 0x0
.long 0x0, 0x0, 0x0, 0x0
.long 0x0, 0x0, 0x0, 0x0
.long 0x0, 0x0, 0x0, 0x0
.long 0x0, 0x0, 0x0, 0x0
.long 0x0, 0x0, 0x0, 0x0
.long 0x0, 0x0, 0x0, 0x0
.long 0x0, 0x0, 0x0, 0x0
.long 0x0, 0x0, 0x0, 0x0
.long 0x0, 0x0, 0x0, 0x0
.long 0x3f80, 0x0, 0x0, 0x0
.long 0x3f803f80, 0x0, 0x0, 0x0
.long 0x3f803f80, 0x3f80, 0x0, 0x0
.long 0x3f800000, 0x3f803f80, 0x0, 0x0
.long 0x0, 0x3f803f80, 0x3f80, 0x0
.long 0x0, 0x3f800000, 0x3f803f80, 0x0
.long 0x0, 0x0, 0x3f803f80, 0x3f80
.long 0x0, 0x0, 0x3f800000, 0x3f803f80
.long 0x0, 0x0, 0x0, 0x3f803f80
.long 0x0, 0x0, 0x0, 0x3f800000
.long 0x0, 0x0, 0x0, 0x0
.long 0x0, 0x0, 0x0, 0x0
.long 0x0, 0x0, 0x0, 0x0
.long 0x0, 0x0, 0x0, 0x0
.long 0x0, 0x0, 0x0, 0x0
.long 0x0, 0x0, 0x0, 0x0
.long 0x0, 0x0, 0x0, 0x0
.long 0x0, 0x0, 0x0, 0x0
.long 0x0, 0x0, 0x0, 0x0
.long 0x0, 0x0, 0x0, 0x0
.long 0x0, 0x0, 0x0, 0x0
.long 0x0, 0x0, 0x0, 0x0
.long 0x0, 0x0, 0x0, 0x0
.long 0x0, 0x0, 0x0, 0x0
.long 0x3f80, 0x0, 0x0, 0x0
.long 0x3f803f80, 0x0, 0x0, 0x0
.long 0x3f803f80, 0x3f80, 0x0, 0x0
.long 0x3f800000, 0x3f803f80, 0x0, 0x0
.long 0x0, 0x3f803f80, 0x3f80, 0x0
.long 0x0, 0x0, 0x0, 0x0
.long 0x0, 0x0, 0x0, 0x0
.long 0x0, 0x0, 0x0, 0x0
.long 0x0, 0x0, 0x0, 0x0
.long 0x0, 0x0, 0x0, 0x0
.long 0x0, 0x0, 0x0, 0x0
.long 0x0, 0x0, 0x0, 0x0
.long 0x0, 0x0, 0x0, 0x0
.long 0x0, 0x0, 0x0, 0x0
.long 0x0, 0x0, 0x0, 0x0
.long 0x0, 0x0, 0x0, 0x0
.long 0x0, 0x0, 0x0, 0x0
.long 0x0, 0x0, 0x0, 0x0
.long 0x0, 0x0, 0x0, 0x0
.long 0x0, 0x0, 0x0, 0x0
.long 0x0, 0x0, 0x0, 0x0
.long 0x0, 0x0, 0x3f803f80, 0x3f803f80
.long 0x0, 0x0, 0x3f800000, 0x3f803f80
.long 0x0, 0x0, 0x0, 0x3f803f80
.long 0x0, 0x0, 0x0, 0x3f800000
.long 0x0, 0x0, 0x0, 0x0
.long 0x0, 0x0, 0x0, 0x0
.long 0x0, 0x0, 0x0, 0x0
.long 0x0, 0x0, 0x0, 0x0
.long 0x0, 0x0, 0x0, 0x0
.long 0x0, 0x0, 0x0, 0x0
.long 0x0, 0x0, 0x0, 0x0
.long 0x0, 0x0, 0x0, 0x0
.long 0x0, 0x0, 0x0, 0x0
.long 0x0, 0x0, 0x0, 0x0
.long 0x0, 0x0, 0x0, 0x0
.long 0x0, 0x0, 0x0, 0x0
.long 0x3f803f80, 0x3f803f80, 0x3f80, 0x0
.long 0x3f803f80, 0x3f803f80, 0x3f803f80, 0x0
.long 0x3f803f80, 0x3f803f80, 0x3f803f80, 0x3f80
.long 0x3f803f80, 0x3f803f80, 0x3f803f80, 0x3f803f80
.long 0x3f803f80, 0x3f803f80, 0x3f803f80, 0x3f803f80
.long 0x3f800000, 0x3f803f80, 0x3f803f80, 0x3f803f80
.long 0x0, 0x3f803f80, 0x3f803f80, 0x3f803f80
.long 0x0, 0x3f800000, 0x3f803f80, 0x3f803f80
.long 0x0, 0x0, 0x3f803f80, 0x3f803f80
.long 0x0, 0x0, 0x3f800000, 0x3f803f80
.long 0x0, 0x0, 0x0, 0x3f803f80
.long 0x0, 0x0, 0x0, 0x3f800000
.long 0x0, 0x0, 0x0, 0x0
.long 0x0, 0x0, 0x0, 0x0
.long 0x0, 0x0, 0x0, 0x0
.long 0x0, 0x0, 0x0, 0x0
.long 0x0, 0x0, 0x0, 0x0
.long 0x0, 0x0, 0x0, 0x0
.long 0x0, 0x0, 0x0, 0x0
.long 0x0, 0x0, 0x0, 0x0
.long 0x3f80, 0x0, 0x0, 0x0
.long 0x3f803f80, 0x0, 0x0, 0x0
.long 0x3f803f80, 0x3f80, 0x0, 0x0
.long 0x3f803f80, 0x3f803f80, 0x0, 0x0
.long 0x3f803f80, 0x3f803f80, 0x3f80, 0x0
.long 0x3f803f80, 0x3f803f80, 0x3f803f80, 0x0
.long 0x3f803f80, 0x3f803f80, 0x3f803f80, 0x3f80
.long 0x3f803f80, 0x3f803f80, 0x3f803f80, 0x3f803f80
.long 0x3f803f80, 0x3f803f80, 0x3f803f80, 0x3f803f80
.long 0x3f800000, 0x3f803f80, 0x3f803f80, 0x3f803f80
.long 0x0, 0x3f803f80, 0x3f803f80, 0x3f803f80
.long 0x0, 0x3f800000, 0x3f803f80, 0x3f803f80
.long 0x0, 0x0, 0x0, 0x0
.long 0x0, 0x0, 0x0, 0x0
.long 0x0, 0x0, 0x0, 0x0
.long 0x0, 0x0, 0x0, 0x0
.long 0x0, 0x0, 0x0, 0x0
.long 0x0, 0x0, 0x0, 0x0
.long 0x0, 0x0, 0x0, 0x0
.long 0x0, 0x0, 0x0, 0x0
.long 0x0, 0x0, 0x0, 0x0
.long 0x0, 0x0, 0x0, 0x0
.long 0x0, 0x0, 0x0, 0x0
.long 0x0, 0x0, 0x0, 0x0
.long 0x3f80, 0x0, 0x0, 0x0
.long 0x3f803f80, 0x0, 0x0, 0x0
.long 0x3f803f80, 0x3f80, 0x0, 0x0
.long 0x3f803f80, 0x3f803f80, 0x0, 0x0
.long 0x0, 0x0, 0x3f800000, 0x3f803f80
.long 0x0, 0x0, 0x0, 0x3f803f80
.long 0x0, 0x0, 0x0, 0x3f800000
.long 0x0, 0x0, 0x0, 0x0
.long 0x0, 0x0, 0x0, 0x0
.long 0x0, 0x0, 0x0, 0x0
.long 0x0, 0x0, 0x0, 0x0
.long 0x0, 0x0, 0x0, 0x0
.long 0x0, 0x0, 0x0, 0x0
.long 0x0, 0x0, 0x0, 0x0
.long 0x0, 0x0, 0x0, 0x0
.long 0x0, 0x0, 0x0, 0x0
.long 0x0, 0x0, 0x0, 0x0
.long 0x0, 0x0, 0x0, 0x0
.long 0x0, 0x0, 0x0, 0x0
.long 0x0, 0x0, 0x0, 0x0
.long 0x3f803f80, 0x3f803f80, 0x0, 0x0
.long 0x3f803f80, 0x3f803f80, 0x3f80, 0x0
.long 0x3f803f80, 0x3f803f80, 0x3f803f80, 0x0
.long 0x3f803f80, 0x3f803f80, 0x3f803f80, 0x3f80
.long 0x3f800000, 0x3f803f80, 0x3f803f80, 0x3f803f80
.long 0x0, 0x3f803f80, 0x3f803f80, 0x3f803f80
.long 0x0, 0x3f800000, 0x3f803f80, 0x3f803f80
.long 0x0, 0x0, 0x3f803f80, 0x3f803f80
.long 0x0, 0x0, 0x3f800000, 0x3f803f80
.long 0x0, 0x0, 0x0, 0x3f803f80
.long 0x0, 0x0, 0x0, 0x3f800000
.long 0x0, 0x0, 0x0, 0x0
.long 0x0, 0x0, 0x0, 0x0
.long 0x0, 0x0, 0x0, 0x0
.long 0x0, 0x0, 0x0, 0x0
.long 0x0, 0x0, 0x0, 0x0
.long 0x0, 0x0, 0x0, 0x0
.long 0x0, 0x0, 0x0, 0x0
.long 0x0, 0x0, 0x0, 0x0
.long 0x0, 0x0, 0x0, 0x0
.long 0x0, 0x0, 0x0, 0x0
.long 0x3f80, 0x0, 0x0, 0x0
.long 0x3f803f80, 0x0, 0x0, 0x0
.long 0x3f803f80, 0x3f80, 0x0, 0x0
.long 0x3f803f80, 0x3f803f80, 0x0, 0x0
.long 0x3f803f80, 0x3f803f80, 0x3f80, 0x0
.long 0x3f803f80, 0x3f803f80, 0x3f803f80, 0x0
.long 0x3f803f80, 0x3f803f80, 0x3f803f80, 0x3f80
.long 0x3f800000, 0x3f803f80, 0x3f803f80, 0x3f803f80
.long 0x0, 0x3f803f80, 0x3f803f80, 0x3f803f80
.long 0x0, 0x3f800000, 0x3f803f80, 0x3f803f80
.long 0x0, 0x0, 0x3f803f80, 0x3f803f80
.long 0x0, 0x0, 0x0, 0x0
.long 0x0, 0x0, 0x0, 0x0
.long 0x0, 0x0, 0x0, 0x0
.long 0x0, 0x0, 0x0, 0x0
.long 0x0, 0x0, 0x0, 0x0
.long 0x0, 0x0, 0x0, 0x0
.long 0x0, 0x0, 0x0, 0x0
.long 0x0, 0x0, 0x0, 0x0
.long 0x0, 0x0, 0x0, 0x0
.long 0x0, 0x0, 0x0, 0x0
.long 0x0, 0x0, 0x0, 0x0
.long 0x0, 0x0, 0x0, 0x0
.long 0x0, 0x0, 0x0, 0x0
.long 0x3f80, 0x0, 0x0, 0x0
.long 0x3f803f80, 0x0, 0x0, 0x0
.long 0x3f803f80, 0x3f80, 0x0, 0x0
.long 0x0, 0x0, 0x0, 0x0
.long 0x0, 0x0, 0x0, 0x0
.long 0x0, 0x0, 0x0, 0x0
.long 0x0, 0x0, 0x0, 0x0
.long 0x0, 0x0, 0x0, 0x0
.long 0x0, 0x0, 0x0, 0x0
.long 0x0, 0x0, 0x0, 0x0
.long 0x0, 0x0, 0x0, 0x0
.long 0x0, 0x0, 0x0, 0x0
.long 0x0, 0x0, 0x0, 0x0
.long 0x0, 0x0, 0x0, 0x0
.long 0x0, 0x0, 0x0, 0x0
.long 0x0, 0x0, 0x0, 0x0
.long 0x0, 0x0, 0x0, 0x0
.long 0x0, 0x0, 0x0, 0x0
.long 0x0, 0x0, 0x0, 0x0
.long 0x0, 0x0, 0xffffffff, 0x0
.long 0x0, 0x0, 0xffff0000, 0xffff
.long 0x0, 0x0, 0x0, 0xffffffff
.long 0x0, 0x0, 0x0, 0xffff0000
.long 0x0, 0x0, 0x0, 0x0
.long 0x0, 0x0, 0x0, 0x0
.long 0x0, 0x0, 0x0, 0x0
.long 0x0, 0x0, 0x0, 0x0
.long 0x0, 0x0, 0x0, 0x0
.long 0x0, 0x0, 0x0, 0x0
.long 0x0, 0x0, 0x0, 0x0
.long 0x0, 0x0, 0x0, 0x0
.long 0x0, 0x0, 0x0, 0x0
.long 0x0, 0x0, 0x0, 0x0
.long 0x0, 0x0, 0x0, 0x0
.long 0x0, 0x0, 0x0, 0x0
.long 0x0, 0x0, 0x0, 0x0
.long 0x0, 0x0, 0x0, 0x0
.long 0x0, 0x0, 0x0, 0x0
.long 0xffff, 0x0, 0x0, 0x0
.long 0xffffffff, 0x0, 0x0, 0x0
.long 0xffff0000, 0xffff, 0x0, 0x0
.long 0x0, 0xffffffff, 0x0, 0x0
.long 0x0, 0xffff0000, 0xffff, 0x0
.long 0x0, 0x0, 0xffffffff, 0x0
.long 0x0, 0x0, 0xffff0000, 0xffff
.long 0x0, 0x0, 0x0, 0xffffffff
.long 0x0, 0x0, 0x0, 0xffff0000
.long 0x0, 0x0, 0x0, 0x0
.long 0x0, 0x0, 0x0, 0x0
.long 0x0, 0x0, 0x0, 0x0
.long 0x0, 0x0, 0x0, 0x0
.long 0x0, 0x0, 0x0, 0x0
.long 0x0, 0x0, 0x0, 0x0
.long 0x0, 0x0, 0x0, 0x0
.long 0x0, 0x0, 0x0, 0x0
.long 0x0, 0x0, 0x0, 0x0
.long 0x0, 0x0, 0x0, 0x0
.long 0x0, 0x0, 0x0, 0x0
.long 0x0, 0x0, 0x0, 0x0
.long 0x0, 0x0, 0x0, 0x0
.long 0x0, 0x0, 0x0, 0x0
.long 0x0, 0x0, 0x0, 0x0
.long 0xffff, 0x0, 0x0, 0x0
.long 0xffffffff, 0x0, 0x0, 0x0
.long 0xffff0000, 0xffff, 0x0, 0x0
.long 0x0, 0xffffffff, 0x0, 0x0
.long 0x0, 0xffff0000, 0xffff, 0x0
.section .rodata,"a"
.p2align 6
.amdhsa_kernel parallel_sum__ssm_conv_s4d__moe_arch_mod__prompt_kernel
  .amdhsa_next_free_vgpr 256
  .amdhsa_next_free_sgpr 96
  .amdhsa_accum_offset 256
  .amdhsa_group_segment_fixed_size 0
  .amdhsa_kernarg_size 120
  .amdhsa_user_sgpr_count 2
  .amdhsa_user_sgpr_kernarg_segment_ptr 1
  .amdhsa_system_sgpr_workgroup_id_x 1
.end_amdhsa_kernel
```

```asm
; @launch grid=(256,1,1) block=(512,1,1) lds=162368
.amdgcn_target "amdgcn-amd-amdhsa--gfx950"
.text
.globl parallel_sum__ssm_conv_s4d__moe_arch_mod__prompt_kernel
.p2align 8
.type parallel_sum__ssm_conv_s4d__moe_arch_mod__prompt_kernel,@function
parallel_sum__ssm_conv_s4d__moe_arch_mod__prompt_kernel:
    s_cmp_ge_u32 s2, 256
    s_cbranch_scc1 L_exit
    s_load_dwordx16 s[4:19], s[0:1], 0
    s_load_dwordx16 s[20:35], s[0:1], 56
    v_readfirstlane_b32 s56, v0
    s_bfe_u32 s3, s2, 0x40003
    v_and_b32 v1, 63, v0
    s_lshr_b32 s56, s56, 6
    s_cmp_ge_u32 s3, 2
    s_cbranch_scc1 L_nocp
    s_cmp_lg_u32 s56, 7
    s_cbranch_scc1 L_nocp
    s_getpc_b64 s[36:37]
L_pc_all:
    s_add_u32 s36, s36, L_auxk-L_pc_all
    s_addc_u32 s37, s37, 0
    s_mov_b32 s38, L_code_end-L_auxk
    s_mov_b32 s39, 0x00020000
    v_lshlrev_b32 v172, 7, v1
    buffer_load_dword v173, v172, s[36:39], 0 offen
    v_add_u32 v172, 8192, v172
    buffer_load_dword v173, v172, s[36:39], 0 offen
    v_add_u32 v172, 8192, v172
    buffer_load_dword v173, v172, s[36:39], 0 offen
L_nocp:
    s_bitcmp1_b32 s2, 7
    s_cbranch_scc0 L_auxk
    s_and_b32 s59, s2, 7
    s_lshl_b32 s57, s59, 4
    s_add_u32 s57, s57, s3
    s_lshl_b32 s36, s57, 3
    s_add_u32 s36, s36, s56
    s_lshl_b32 s37, s36, 8
    s_lshl_b32 s36, s36, 1
    v_lshl_add_u32 v4, v1, 2, s37
    v_mov_b32 v5, s36
    v_mov_b32 v6, 0
    s_waitcnt lgkmcnt(0)
    global_load_ushort v15, v5, s[14:15]
    global_load_dword v16, v4, s[6:7] nt
    global_load_dword v17, v4, s[8:9] nt
    global_load_dword v18, v4, s[10:11] nt
    global_load_dword v19, v4, s[12:13] nt
    global_load_ushort v14, v5, s[16:17]
    global_load_dword v175, v6, s[34:35]
    s_branch L_conv
L_auxk:
    s_and_b32 s57, s2, 7
    s_lshl_b32 s58, s57, 4
    s_add_u32 s58, s58, s3
    s_cmp_ge_u32 s56, 4
    s_cbranch_scc1 L_aux_sinit
    s_lshl_b32 s36, s58, 2
    s_add_u32 s36, s36, s56
    s_lshl_b32 s36, s36, 13
    s_add_u32 s36, s36, 4096
    v_lshlrev_b32 v28, 4, v1
    v_add_u32 v30, s36, v28
    s_waitcnt lgkmcnt(0)
    global_load_dwordx4 v[64:67], v28, s[22:23] offset:0
    global_load_dwordx4 v[68:71], v28, s[22:23] offset:1024
    global_load_dwordx4 v[32:35], v30, s[4:5] offset:-4096
    global_load_dwordx4 v[36:39], v30, s[4:5] offset:-3072
    global_load_dwordx4 v[40:43], v30, s[4:5] offset:-2048
    global_load_dwordx4 v[44:47], v30, s[4:5] offset:-1024
    global_load_dwordx4 v[48:51], v30, s[4:5] offset:0
    global_load_dwordx4 v[52:55], v30, s[4:5] offset:1024
    global_load_dwordx4 v[56:59], v30, s[4:5] offset:2048
    global_load_dwordx4 v[60:63], v30, s[4:5] offset:3072
    s_load_dword s59, s[34:35], 0
L_entry_end:
    s_setprio 2
    s_mov_b64 s[36:37], s[4:5]
    s_mov_b32 s38, 4194304
    s_mov_b32 s39, 0x00020000
    s_mov_b64 s[52:53], s[28:29]
    s_mov_b32 s54, 7340032
    s_mov_b32 s55, 0x00020000
    v_and_b32 v2, 15, v0
    v_bfe_u32 v3, v0, 4, 2
    v_mov_b32 v22, 148624
    v_mov_b32 v23, 1
    s_mov_b64 s[40:41], s[34:35]
    s_mov_b32 s42, 753664
    s_mov_b32 s43, 0x00020000
    s_and_b32 s61, s3, 1
    s_lshr_b32 s6, s3, 1
    s_add_u32 s7, s57, 3
    s_and_b32 s7, s7, 7
    s_cmp_eq_u32 s7, 7
    s_cselect_b32 s8, 7, 6
    s_add_u32 s9, s6, 1
    s_cmp_eq_u32 s9, s8
    s_cselect_b32 s9, 0, s9
    s_cmp_ge_u32 s9, s7
    s_addc_u32 s9, s9, 0
    s_cmp_ge_u32 s6, s7
    s_addc_u32 s10, s6, 0
    s_cmp_eq_u32 s7, 7
    s_cselect_b32 s62, 0, 1
    s_cmp_lt_u32 s6, s8
    s_cselect_b32 s62, 2, s62
    s_cselect_b32 s10, s10, s7
    s_cselect_b32 s11, 0, s6
    s_and_b32 s11, s11, 1
    s_cmp_ge_u32 s3, 3
    s_addc_u32 s63, s3, 0
    s_cmp_ge_u32 s3, 10
    s_addc_u32 s63, s63, 0
    s_sub_u32 s12, s6, s8
    s_cmp_eq_u32 s12, 1
    s_cselect_b32 s63, s3, s63
    s_lshl_b32 s13, s61, 3
    s_add_u32 s13, s13, 3
    s_cmp_eq_u32 s12, 0
    s_cselect_b32 s63, s13, s63
    s_mul_i32 s64, s57, 57344
    s_add_u32 s64, s64, 32768
    s_barrier
    s_lshl_b32 s6, s58, 5
    s_add_u32 s6, s6, 4096
    v_bfe_u32 v11, v1, 1, 2
    v_lshlrev_b32 v11, 12, v11
    v_and_b32 v10, 1, v1
    v_lshl_add_u32 v11, v10, 4, v11
    v_add_u32 v11, s6, v11
    s_and_b32 s6, s56, 1
    s_lshl_b32 s6, s6, 6
    s_lshr_b32 s7, s56, 1
    s_lshl_b32 s7, s7, 4
    s_add_u32 s6, s6, s7
    s_add_u32 s6, s6, 148944
    v_lshlrev_b32 v10, 5, v3
    v_add_u32 v10, s6, v10
    v_lshl_add_u32 v9, v1, 4, v22
    s_mov_b32 s8, 0x3f803f80
    s_waitcnt vmcnt(8)
    v_dot2_f32_bf16 v84, s8, v64, 0
    v_dot2_f32_bf16 v85, s8, v65, 0
    s_nop 1
    v_dot2c_f32_bf16 v84, s8, v66
    v_dot2c_f32_bf16 v85, s8, v67
    v_dot2c_f32_bf16 v84, s8, v68
    v_dot2c_f32_bf16 v85, s8, v69
    v_dot2c_f32_bf16 v84, s8, v70
    v_dot2c_f32_bf16 v85, s8, v71
    s_waitcnt vmcnt(6)
    v_dot2_f32_bf16 v72, s8, v32, 0
    v_dot2_f32_bf16 v76, v32, v32, 0
    v_dot2_f32_bf16 v80, v64, v32, 0
    s_nop 0
    v_dot2c_f32_bf16 v72, s8, v33
    v_dot2c_f32_bf16 v76, v33, v33
    v_dot2c_f32_bf16 v80, v65, v33
    v_dot2c_f32_bf16 v72, s8, v34
    v_dot2c_f32_bf16 v76, v34, v34
    v_dot2c_f32_bf16 v80, v66, v34
    v_dot2c_f32_bf16 v72, s8, v35
    v_dot2c_f32_bf16 v76, v35, v35
    v_dot2c_f32_bf16 v80, v67, v35
    v_dot2c_f32_bf16 v72, s8, v36
    v_dot2c_f32_bf16 v76, v36, v36
    v_dot2c_f32_bf16 v80, v68, v36
    v_dot2c_f32_bf16 v72, s8, v37
    v_dot2c_f32_bf16 v76, v37, v37
    v_dot2c_f32_bf16 v80, v69, v37
    v_dot2c_f32_bf16 v72, s8, v38
    v_dot2c_f32_bf16 v76, v38, v38
    v_dot2c_f32_bf16 v80, v70, v38
    v_dot2c_f32_bf16 v72, s8, v39
    v_dot2c_f32_bf16 v76, v39, v39
    v_dot2c_f32_bf16 v80, v71, v39
    v_add_f32 v84, v84, v85
    s_waitcnt vmcnt(4)
    v_dot2_f32_bf16 v73, s8, v40, 0
    v_dot2_f32_bf16 v77, v40, v40, 0
    v_dot2_f32_bf16 v81, v64, v40, 0
    s_nop 0
    v_dot2c_f32_bf16 v73, s8, v41
    v_dot2c_f32_bf16 v77, v41, v41
    v_dot2c_f32_bf16 v81, v65, v41
    v_dot2c_f32_bf16 v73, s8, v42
    v_dot2c_f32_bf16 v77, v42, v42
    v_dot2c_f32_bf16 v81, v66, v42
    v_dot2c_f32_bf16 v73, s8, v43
    v_dot2c_f32_bf16 v77, v43, v43
    v_dot2c_f32_bf16 v81, v67, v43
    v_dot2c_f32_bf16 v73, s8, v44
    v_dot2c_f32_bf16 v77, v44, v44
    v_dot2c_f32_bf16 v81, v68, v44
    v_dot2c_f32_bf16 v73, s8, v45
    v_dot2c_f32_bf16 v77, v45, v45
    v_dot2c_f32_bf16 v81, v69, v45
    v_dot2c_f32_bf16 v73, s8, v46
    v_dot2c_f32_bf16 v77, v46, v46
    v_dot2c_f32_bf16 v81, v70, v46
    v_dot2c_f32_bf16 v73, s8, v47
    v_dot2c_f32_bf16 v77, v47, v47
    v_dot2c_f32_bf16 v81, v71, v47
    v_mov_b32 v85, v84
    s_waitcnt vmcnt(2)
    v_dot2_f32_bf16 v74, s8, v48, 0
    v_dot2_f32_bf16 v78, v48, v48, 0
    v_dot2_f32_bf16 v82, v64, v48, 0
    s_nop 0
    v_dot2c_f32_bf16 v74, s8, v49
    v_dot2c_f32_bf16 v78, v49, v49
    v_dot2c_f32_bf16 v82, v65, v49
    v_dot2c_f32_bf16 v74, s8, v50
    v_dot2c_f32_bf16 v78, v50, v50
    v_dot2c_f32_bf16 v82, v66, v50
    v_dot2c_f32_bf16 v74, s8, v51
    v_dot2c_f32_bf16 v78, v51, v51
    v_dot2c_f32_bf16 v82, v67, v51
    v_dot2c_f32_bf16 v74, s8, v52
    v_dot2c_f32_bf16 v78, v52, v52
    v_dot2c_f32_bf16 v82, v68, v52
    v_dot2c_f32_bf16 v74, s8, v53
    v_dot2c_f32_bf16 v78, v53, v53
    v_dot2c_f32_bf16 v82, v69, v53
    v_dot2c_f32_bf16 v74, s8, v54
    v_dot2c_f32_bf16 v78, v54, v54
    v_dot2c_f32_bf16 v82, v70, v54
    v_dot2c_f32_bf16 v74, s8, v55
    v_dot2c_f32_bf16 v78, v55, v55
    v_dot2c_f32_bf16 v82, v71, v55
    s_waitcnt vmcnt(0)
    v_dot2_f32_bf16 v75, s8, v56, 0
    v_dot2_f32_bf16 v79, v56, v56, 0
    v_dot2_f32_bf16 v83, v64, v56, 0
    s_nop 0
    v_dot2c_f32_bf16 v75, s8, v57
    v_dot2c_f32_bf16 v79, v57, v57
    v_dot2c_f32_bf16 v83, v65, v57
    v_dot2c_f32_bf16 v75, s8, v58
    v_dot2c_f32_bf16 v79, v58, v58
    v_dot2c_f32_bf16 v83, v66, v58
    v_dot2c_f32_bf16 v75, s8, v59
    v_dot2c_f32_bf16 v79, v59, v59
    v_dot2c_f32_bf16 v83, v67, v59
    v_dot2c_f32_bf16 v75, s8, v60
    v_dot2c_f32_bf16 v79, v60, v60
    v_dot2c_f32_bf16 v83, v68, v60
    v_dot2c_f32_bf16 v75, s8, v61
    v_dot2c_f32_bf16 v79, v61, v61
    v_dot2c_f32_bf16 v83, v69, v61
    v_dot2c_f32_bf16 v75, s8, v62
    v_dot2c_f32_bf16 v79, v62, v62
    v_dot2c_f32_bf16 v83, v70, v62
    v_dot2c_f32_bf16 v75, s8, v63
    v_dot2c_f32_bf16 v79, v63, v63
    v_dot2c_f32_bf16 v83, v71, v63
    v_permlane32_swap_b32 v84, v85
    v_permlane32_swap_b32 v72, v73
    v_permlane32_swap_b32 v76, v77
    v_permlane32_swap_b32 v80, v81
    v_permlane32_swap_b32 v74, v75
    v_permlane32_swap_b32 v78, v79
    v_permlane32_swap_b32 v82, v83
    v_add_f32 v84, v84, v85
    v_add_f32 v72, v72, v73
    v_add_f32 v76, v76, v77
    v_add_f32 v80, v80, v81
    v_add_f32 v74, v74, v75
    v_add_f32 v78, v78, v79
    v_add_f32 v82, v82, v83
    v_mov_b32 v86, v84
    v_permlane16_swap_b32 v72, v74
    v_permlane16_swap_b32 v76, v78
    v_permlane16_swap_b32 v80, v82
    v_permlane16_swap_b32 v84, v86
    v_add_f32 v72, v72, v74
    v_add_f32 v76, v76, v78
    v_add_f32 v80, v80, v82
    v_add_f32 v84, v84, v86
    v_add_f32_dpp v72, v72, v72 row_ror:8 row_mask:0xf bank_mask:0xf
    v_add_f32_dpp v76, v76, v76 row_ror:8 row_mask:0xf bank_mask:0xf
    v_add_f32_dpp v80, v80, v80 row_ror:8 row_mask:0xf bank_mask:0xf
    v_add_f32_dpp v84, v84, v84 row_ror:8 row_mask:0xf bank_mask:0xf
    v_add_f32_dpp v72, v72, v72 row_ror:4 row_mask:0xf bank_mask:0xf
    v_add_f32_dpp v76, v76, v76 row_ror:4 row_mask:0xf bank_mask:0xf
    v_add_f32_dpp v80, v80, v80 row_ror:4 row_mask:0xf bank_mask:0xf
    v_add_f32_dpp v84, v84, v84 row_ror:4 row_mask:0xf bank_mask:0xf
    v_add_f32_dpp v72, v72, v72 row_ror:2 row_mask:0xf bank_mask:0xf
    v_add_f32_dpp v76, v76, v76 row_ror:2 row_mask:0xf bank_mask:0xf
    v_add_f32_dpp v80, v80, v80 row_ror:2 row_mask:0xf bank_mask:0xf
    v_add_f32_dpp v84, v84, v84 row_ror:2 row_mask:0xf bank_mask:0xf
    v_add_f32_dpp v72, v72, v72 row_ror:1 row_mask:0xf bank_mask:0xf
    v_add_f32_dpp v76, v76, v76 row_ror:1 row_mask:0xf bank_mask:0xf
    v_add_f32_dpp v80, v80, v80 row_ror:1 row_mask:0xf bank_mask:0xf
    v_add_f32_dpp v84, v84, v84 row_ror:1 row_mask:0xf bank_mask:0xf
    s_waitcnt lgkmcnt(0)
    s_mul_i32 s60, s59, 0x9e3779b1
    s_add_u32 s60, s60, 0x7f4a7c15
    v_mul_f32 v42, 0x3a800000, v72
    v_mul_f32 v43, 0x3a800000, v76
    v_fma_f32 v43, -v42, v42, v43
    v_max_f32 v43, 0, v43
    v_cvt_pk_bf16_f32 v42, v42, v43
    v_and_b32 v43, 0xffff0000, v42
    v_lshlrev_b32 v45, 16, v42
    v_add_f32 v43, 0x3727c5ac, v43
    v_cvt_pk_bf16_f32 v43, v43, v43
    v_and_b32 v43, 0xffff0000, v43
    v_sqrt_f32 v43, v43
    v_fma_f32 v44, -v45, v84, v80
    v_cvt_pk_bf16_f32 v60, v45, v43
    v_and_b32 v43, 0xffff0000, v60
    v_rcp_f32 v46, v43
    v_mov_b32 v61, v60
    v_mul_f32 v44, v44, v46
    v_cvt_pk_bf16_f32 v64, v44, v44
    v_ashrrev_i32 v65, 31, v64
    v_or_b32 v65, 0x80000000, v65
    v_xor_b32 v64, v64, v65
    v_permlane32_swap_b32 v60, v61
    v_lshrrev_b32 v64, 16, v64
    v_mov_b32 v63, s60
    v_mov_b32 v65, v64
    s_nop 1
    v_permlane32_swap_b32 v64, v65
    v_lshl_or_b32 v62, v65, 16, v64
    s_mov_b64 exec, 0x10001
    ds_write_b128 v10, v[60:63]
    s_mov_b64 exec, 1
    ds_add_rtn_u32 v13, v22, v23 offset:264
    s_mov_b64 exec, 0xff
    ds_read_b128 v[60:63], v9 offset:320
    s_waitcnt lgkmcnt(0)
    v_readfirstlane_b32 s6, v13
    s_cmp_lg_u32 s6, 3
    s_cbranch_scc1 L_aux_nopub
    buffer_store_dwordx4 v[60:63], v11, s[40:43], 0 offen sc1
    ds_write_b32 v22, v63 offset:284
    ds_write_b32 v22, v23 offset:260
L_aux_nopub:
    s_mov_b64 exec, -1
    s_bfe_u32 s65, s60, 0x80000
    s_bfe_u32 s66, s60, 0x80008
    s_bfe_u32 s67, s60, 0x80010
    s_bfe_u32 s68, s60, 0x80018
    s_cmp_lg_u32 s58, 78
    s_cbranch_scc1 L_aux_cons
    v_lshlrev_b32 v12, 4, v0
    v_add_u32 v12, 4096, v12
    v_lshlrev_b32 v13, 3, v0
    v_sub_u32 v13, 0x800, v13
    v_subrev_u32 v88, 0, v13
    v_subrev_u32 v89, 1, v13
    v_subrev_u32 v90, 2, v13
    v_subrev_u32 v91, 3, v13
    v_subrev_u32 v92, 4, v13
    v_subrev_u32 v93, 5, v13
    v_subrev_u32 v94, 6, v13
    v_subrev_u32 v95, 7, v13
    s_mov_b32 s6, 4096
    s_mov_b32 s7, 8192
    s_mov_b32 s8, 12288
    s_mov_b32 s9, 0xffff0000
    v_lshrrev_b32 v24, 4, v0
    v_lshl_add_u32 v24, v24, 2, v22
    v_lshl_add_u32 v25, v2, 2, v22
    v_and_b32 v26, 31, v1
    v_lshl_add_u32 v26, v26, 2, v22
    v_lshrrev_b32 v27, 5, v1
    v_lshl_add_u32 v27, v27, 6, v22
    s_lshl_b32 s10, s56, 5
    s_add_u32 s10, s10, 148688
    v_lshl_add_u32 v31, v1, 2, s10
    v_lshlrev_b32 v9, 5, v0
    s_sleep 28
    buffer_load_dwordx4 v[64:67], v12, s[40:43], 0 offen sc1
    buffer_load_dwordx4 v[68:71], v12, s[40:43], s6 offen sc1
    buffer_load_dwordx4 v[72:75], v12, s[40:43], s7 offen sc1
    buffer_load_dwordx4 v[76:79], v12, s[40:43], s8 offen sc1
    s_mov_b32 s11, 0
L_poll_aux:
    s_waitcnt vmcnt(0)
    v_cmp_ne_u32 s[12:13], s60, v67
    v_cmp_ne_u32 s[14:15], s60, v71
    v_cmp_ne_u32 s[16:17], s60, v75
    v_cmp_ne_u32 s[18:19], s60, v79
    s_or_b64 vcc, s[12:13], s[14:15]
    s_or_b64 vcc, vcc, s[16:17]
    s_or_b64 vcc, vcc, s[18:19]
    s_cbranch_scc0 L_polled_aux
    s_add_u32 s11, s11, 1
    s_cmp_ge_u32 s11, 65536
    s_cbranch_scc1 L_polled_aux
    s_sleep 2
    s_mov_b64 exec, s[12:13]
    s_cbranch_execz L_ps_aux_0
    buffer_load_dwordx4 v[64:67], v12, s[40:43], 0 offen sc1
L_ps_aux_0:
    s_mov_b64 exec, s[14:15]
    s_cbranch_execz L_ps_aux_1
    buffer_load_dwordx4 v[68:71], v12, s[40:43], s6 offen sc1
L_ps_aux_1:
    s_mov_b64 exec, s[16:17]
    s_cbranch_execz L_ps_aux_2
    buffer_load_dwordx4 v[72:75], v12, s[40:43], s7 offen sc1
L_ps_aux_2:
    s_mov_b64 exec, s[18:19]
    s_cbranch_execz L_ps_aux_3
    buffer_load_dwordx4 v[76:79], v12, s[40:43], s8 offen sc1
L_ps_aux_3:
    s_mov_b64 exec, -1
    s_branch L_poll_aux
L_polled_aux:
    v_lshl_or_b32 v80, v66, 16, v88
    v_and_or_b32 v81, v66, s9, v89
    v_lshl_or_b32 v82, v70, 16, v90
    v_and_or_b32 v83, v70, s9, v91
    v_lshl_or_b32 v84, v74, 16, v92
    v_and_or_b32 v85, v74, s9, v93
    v_lshl_or_b32 v86, v78, 16, v94
    v_and_or_b32 v87, v78, s9, v95
    v_max3_u32 v17, v80, v81, v82
    v_max3_u32 v18, v83, v84, v85
    v_max3_u32 v17, v17, v86, v87
    v_max_u32 v17, v17, v18
    v_max_u32 v14, v80, v81
    v_min_u32 v15, v80, v81
    v_max_u32_dpp v17, v17, v17 row_ror:8 row_mask:0xf bank_mask:0xf
    v_mov_b32 v16, 0
    v_med3_u32 v16, v15, v16, v82
    v_max_u32_dpp v17, v17, v17 row_ror:4 row_mask:0xf bank_mask:0xf
    v_med3_u32 v15, v14, v15, v82
    v_max_u32 v14, v14, v82
    v_max_u32_dpp v17, v17, v17 row_ror:2 row_mask:0xf bank_mask:0xf
    v_med3_u32 v16, v15, v16, v83
    v_med3_u32 v15, v14, v15, v83
    v_max_u32_dpp v17, v17, v17 row_ror:1 row_mask:0xf bank_mask:0xf
    ds_write_b32 v24, v17
    ds_read_b32 v17, v25
    ds_write_b64 v9, v[64:65] offset:0
    ds_write_b64 v9, v[68:69] offset:8
    ds_write_b64 v9, v[72:73] offset:16
    ds_write_b64 v9, v[76:77] offset:24
    v_max_u32 v14, v14, v83
    v_med3_u32 v16, v15, v16, v84
    v_med3_u32 v15, v14, v15, v84
    v_max_u32 v14, v14, v84
    v_med3_u32 v16, v15, v16, v85
    v_med3_u32 v15, v14, v15, v85
    v_max_u32 v14, v14, v85
    v_med3_u32 v16, v15, v16, v86
    v_med3_u32 v15, v14, v15, v86
    v_max_u32 v14, v14, v86
    v_med3_u32 v16, v15, v16, v87
    v_med3_u32 v15, v14, v15, v87
    v_max_u32 v14, v14, v87
    v_mov_b32 v19, 0
    s_mov_b32 s11, 0
    s_waitcnt lgkmcnt(4)
L_aux_gm:
    v_cmp_eq_u32 vcc, 0, v17
    s_cbranch_vccz L_aux_gmok
    ds_read_b32 v17, v25
    s_waitcnt lgkmcnt(0)
    s_add_u32 s11, s11, 1
    s_cmp_ge_u32 s11, 524288
    s_cbranch_scc1 L_aux_gmok
    s_branch L_aux_gm
L_aux_gmok:
    v_sub_co_u32_dpp v20, vcc, v17, v17 row_ror:1 row_mask:0xf bank_mask:0xf
    v_addc_co_u32 v19, vcc, 0, v19, vcc
    v_sub_co_u32_dpp v20, vcc, v17, v17 row_ror:2 row_mask:0xf bank_mask:0xf
    v_addc_co_u32 v19, vcc, 0, v19, vcc
    v_sub_co_u32_dpp v20, vcc, v17, v17 row_ror:3 row_mask:0xf bank_mask:0xf
    v_addc_co_u32 v19, vcc, 0, v19, vcc
    v_sub_co_u32_dpp v20, vcc, v17, v17 row_ror:4 row_mask:0xf bank_mask:0xf
    v_addc_co_u32 v19, vcc, 0, v19, vcc
    v_sub_co_u32_dpp v20, vcc, v17, v17 row_ror:5 row_mask:0xf bank_mask:0xf
    v_addc_co_u32 v19, vcc, 0, v19, vcc
    v_sub_co_u32_dpp v20, vcc, v17, v17 row_ror:6 row_mask:0xf bank_mask:0xf
    v_addc_co_u32 v19, vcc, 0, v19, vcc
    v_sub_co_u32_dpp v20, vcc, v17, v17 row_ror:7 row_mask:0xf bank_mask:0xf
    v_addc_co_u32 v19, vcc, 0, v19, vcc
    v_sub_co_u32_dpp v20, vcc, v17, v17 row_ror:8 row_mask:0xf bank_mask:0xf
    v_addc_co_u32 v19, vcc, 0, v19, vcc
    v_sub_co_u32_dpp v20, vcc, v17, v17 row_ror:9 row_mask:0xf bank_mask:0xf
    v_addc_co_u32 v19, vcc, 0, v19, vcc
    v_sub_co_u32_dpp v20, vcc, v17, v17 row_ror:10 row_mask:0xf bank_mask:0xf
    v_addc_co_u32 v19, vcc, 0, v19, vcc
    v_sub_co_u32_dpp v20, vcc, v17, v17 row_ror:11 row_mask:0xf bank_mask:0xf
    v_addc_co_u32 v19, vcc, 0, v19, vcc
    v_sub_co_u32_dpp v20, vcc, v17, v17 row_ror:12 row_mask:0xf bank_mask:0xf
    v_addc_co_u32 v19, vcc, 0, v19, vcc
    v_sub_co_u32_dpp v20, vcc, v17, v17 row_ror:13 row_mask:0xf bank_mask:0xf
    v_addc_co_u32 v19, vcc, 0, v19, vcc
    v_sub_co_u32_dpp v20, vcc, v17, v17 row_ror:14 row_mask:0xf bank_mask:0xf
    v_addc_co_u32 v19, vcc, 0, v19, vcc
    v_sub_co_u32_dpp v20, vcc, v17, v17 row_ror:15 row_mask:0xf bank_mask:0xf
    v_addc_co_u32 v19, vcc, 0, v19, vcc
    v_cmp_eq_u32 vcc, 8, v19
    s_ff1_i32_b64 s12, vcc
    v_readlane_b32 s12, v17, s12
    v_mov_b32 v18, 1
    s_nop 0
    v_cmp_le_u32 s[14:15], s12, v14
    v_cmp_le_u32 s[16:17], s12, v15
    v_cmp_le_u32 s[18:19], s12, v16
    s_bcnt1_i32_b64 s12, s[14:15]
    s_bcnt1_i32_b64 s20, s[16:17]
    v_mbcnt_lo_u32_b32 v20, s14, 0
    v_mbcnt_lo_u32_b32 v21, s16, 0
    v_mbcnt_hi_u32_b32 v20, s15, v20
    v_mbcnt_hi_u32_b32 v21, s17, v21
    s_add_u32 s20, s20, s12
    s_lshl_b32 s12, s12, 2
    s_add_u32 s12, s12, s10
    v_lshl_add_u32 v20, v20, 2, s10
    v_lshl_add_u32 v21, v21, 2, s12
    s_cmp_lg_u64 s[18:19], 0
    s_cselect_b32 s20, 9, s20
    s_cmp_gt_u32 s20, 8
    s_cbranch_scc0 L_aux_fit
    s_mov_b64 s[14:15], 0
    s_mov_b64 s[16:17], 0
    s_mov_b32 s20, 0
    v_mov_b32 v18, 2
L_aux_fit:
    s_lshl_b32 s20, 0xff, s20
    s_and_b32 s20, s20, 0xff
    s_mov_b32 s21, 0
    s_mov_b64 exec, s[14:15]
    ds_write_b32 v20, v14
    s_mov_b64 exec, s[16:17]
    ds_write_b32 v21, v15
    s_mov_b64 exec, s[20:21]
    ds_write_b32 v31, v18
    s_mov_b64 exec, -1
    s_mov_b32 s11, 0
    v_mov_b32 v20, 0
L_aux_ls:
    ds_read_b32 v17, v26 offset:64
    ds_read_b128 v[64:67], v27 offset:64
    ds_read_b128 v[68:71], v27 offset:80
    ds_read_b128 v[72:75], v27 offset:96
    ds_read_b128 v[76:79], v27 offset:112
    s_waitcnt lgkmcnt(4)
    v_cmp_eq_u32 vcc, 0, v17
    s_cbranch_vccz L_aux_lsok
    s_waitcnt lgkmcnt(0)
    s_add_u32 s11, s11, 1
    s_cmp_ge_u32 s11, 524288
    s_cbranch_scc1 L_aux_lsok
    s_branch L_aux_ls
L_aux_lsok:
    v_cmp_eq_u32 vcc, 2, v17
    s_cbranch_vccnz L_aux_slow
    s_cmp_ge_u32 s56, 2
    s_cbranch_scc1 L_aux_wd
    s_cmp_eq_u32 s56, 1
    s_cbranch_scc1 L_aux_nox
    v_and_b32 v60, 0xfff, v17
    v_sub_u32 v60, 0x800, v60
    v_lshlrev_b32 v15, 2, v60
    ds_read_b32 v62, v15
    s_waitcnt lgkmcnt(4)
    v_cmp_gt_u32 vcc, v64, v17
    v_addc_co_u32 v20, vcc, 0, v20, vcc
    v_cmp_gt_u32 vcc, v65, v17
    v_addc_co_u32 v20, vcc, 0, v20, vcc
    v_cmp_gt_u32 vcc, v66, v17
    v_addc_co_u32 v20, vcc, 0, v20, vcc
    v_cmp_gt_u32 vcc, v67, v17
    v_addc_co_u32 v20, vcc, 0, v20, vcc
    s_waitcnt lgkmcnt(3)
    v_cmp_gt_u32 vcc, v68, v17
    v_addc_co_u32 v20, vcc, 0, v20, vcc
    v_cmp_gt_u32 vcc, v69, v17
    v_addc_co_u32 v20, vcc, 0, v20, vcc
    v_cmp_gt_u32 vcc, v70, v17
    v_addc_co_u32 v20, vcc, 0, v20, vcc
    v_cmp_gt_u32 vcc, v71, v17
    v_addc_co_u32 v20, vcc, 0, v20, vcc
    s_waitcnt lgkmcnt(2)
    v_cmp_gt_u32 vcc, v72, v17
    v_addc_co_u32 v20, vcc, 0, v20, vcc
    v_cmp_gt_u32 vcc, v73, v17
    v_addc_co_u32 v20, vcc, 0, v20, vcc
    v_cmp_gt_u32 vcc, v74, v17
    v_addc_co_u32 v20, vcc, 0, v20, vcc
    v_cmp_gt_u32 vcc, v75, v17
    v_addc_co_u32 v20, vcc, 0, v20, vcc
    s_waitcnt lgkmcnt(1)
    v_cmp_gt_u32 vcc, v76, v17
    v_addc_co_u32 v20, vcc, 0, v20, vcc
    v_cmp_gt_u32 vcc, v77, v17
    v_addc_co_u32 v20, vcc, 0, v20, vcc
    v_cmp_gt_u32 vcc, v78, v17
    v_addc_co_u32 v20, vcc, 0, v20, vcc
    v_cmp_gt_u32 vcc, v79, v17
    v_addc_co_u32 v20, vcc, 0, v20, vcc
    v_mov_b32 v21, v20
    v_and_b32 v14, 0xffff0000, v17
    v_ashrrev_i32 v15, 31, v14
    v_permlane32_swap_b32 v20, v21
    v_not_b32 v15, v15
    v_add_u32 v20, v20, v21
    v_or_b32 v15, 0x80000000, v15
    v_xor_b32 v14, v14, v15
    v_and_b32 v14, 0xffff0000, v14
    v_mul_f32 v14, 0xbfb8aa3b, v14
    v_exp_f32 v14, v14
    v_mov_b32 v63, s60
    v_add_f32 v14, 1.0, v14
    v_rcp_f32 v14, v14
L_aux_sel:
    v_cmp_gt_u32 vcc, 8, v20
    v_lshlrev_b32 v21, 4, v20
    v_add_u32 v21, 24576, v21
    v_cvt_pk_bf16_f32 v14, v14, v14
    v_and_b32 v61, 0xffff0000, v14
    s_mov_b32 exec_lo, vcc_lo
    s_mov_b32 exec_hi, 0
    s_waitcnt lgkmcnt(0)
    buffer_store_dwordx4 v[60:63], v21, s[40:43], 0 offen sc1
    s_mov_b64 exec, -1
L_aux_nox:
    s_mov_b64 exec, 1
    ds_add_u32 v22, v23 offset:268
    s_mov_b64 exec, -1
    s_branch L_aux_b4
L_aux_cons:
    s_cmp_ge_u32 s56, 2
    s_cbranch_scc1 L_aux_wd
    s_cmp_eq_u32 s62, 0
    s_cbranch_scc1 L_aux_nox
    v_and_b32 v14, 7, v1
    v_lshlrev_b32 v21, 4, v14
    v_add_u32 v21, 24576, v21
    v_lshl_add_u32 v15, v14, 2, v22
    s_mul_i32 s6, s56, 4160
    s_add_u32 s6, s6, 131072
    s_lshl_b32 s7, s61, 10
    s_lshl_b32 s9, s56, 2
    s_sleep 86
    s_mov_b64 exec, 0xff
    s_mov_b32 s11, 0
L_aux_sp:
    buffer_load_dwordx4 v[60:63], v21, s[40:43], 0 offen sc1
    s_waitcnt vmcnt(0)
    v_cmp_ne_u32 vcc, s60, v63
    s_cbranch_vccz L_aux_spok
    s_add_u32 s11, s11, 1
    s_cmp_ge_u32 s11, 65536
    s_cbranch_scc1 L_aux_spok
    s_sleep 2
    s_branch L_aux_sp
L_aux_spok:
    v_lshl_add_u32 v60, v60, 11, s7
    ds_write_b32 v15, v62 offset:192
    s_mov_b64 exec, -1
    v_readlane_b32 s12, v60, s9
    s_add_u32 s9, s9, 1
    v_readlane_b32 s13, v60, s9
    s_add_u32 s9, s9, 1
    v_readlane_b32 s14, v60, s9
    s_add_u32 s9, s9, 1
    v_readlane_b32 s15, v60, s9
    s_add_u32 m0, s6, 0
    s_nop 0
    buffer_load_dwordx4 v28, s[36:39], s12 offen lds
    s_add_u32 m0, s6, 1040
    s_nop 0
    buffer_load_dwordx4 v28, s[36:39], s13 offen lds
    s_add_u32 m0, s6, 2080
    s_nop 0
    buffer_load_dwordx4 v28, s[36:39], s14 offen lds
    s_add_u32 m0, s6, 3120
    s_nop 0
    buffer_load_dwordx4 v28, s[36:39], s15 offen lds
    s_mov_b64 exec, 1
    ds_add_u32 v22, v23 offset:268
    s_waitcnt vmcnt(0)
    ds_add_u32 v22, v23 offset:272
    s_mov_b64 exec, -1
    s_branch L_aux_b4
L_aux_wd:
    s_mul_i32 s6, s57, 917504
    s_lshl_b32 s7, s63, 7
    s_add_u32 s6, s6, s7
    s_and_b32 s7, s56, 1
    s_lshl_b32 s8, s7, 14
    s_add_u32 s6, s6, s8
    v_lshrrev_b32 v14, 3, v1
    v_and_b32 v15, 7, v1
    v_xor_b32 v15, v15, v3
    s_lshl_b32 s8, s7, 2
    v_xor_b32 v15, s8, v15
    v_lshlrev_b32 v14, 11, v14
    v_lshl_add_u32 v14, v15, 4, v14
    v_add_u32 v14, s6, v14
    s_lshl_b32 s7, s7, 10
    s_setprio 0
    v_lshl_add_u32 v20, v1, 4, s7
    v_add_u32 v21, 0x10000, v20
    s_and_b32 s8, s63, 7
    s_cmp_eq_u32 s8, 3
    s_cselect_b32 s8, s62, 0
    s_cmp_lg_u32 s8, 1
    s_cbranch_scc1 L_aux_wdl
    s_mov_b32 s11, 0
L_lw_iss:
    ds_read_b32 v18, v22 offset:280
    s_add_u32 s11, s11, 1
    s_cmp_ge_u32 s11, 524288
    s_cbranch_scc1 L_lwx_iss
    s_waitcnt lgkmcnt(0)
    v_readfirstlane_b32 s8, v18
    s_cmp_ge_u32 s8, 4
    s_cbranch_scc1 L_lwx_iss
    s_sleep 1
    s_branch L_lw_iss
L_lwx_iss:
    s_waitcnt lgkmcnt(0)
    s_mov_b32 s6, 0
    buffer_load_dwordx4 v[128:131], v14, s[52:55], s6 offen nt
    s_mov_b32 s6, 32768
    buffer_load_dwordx4 v[132:135], v14, s[52:55], s6 offen nt
    s_mov_b32 s6, 65536
    buffer_load_dwordx4 v[136:139], v14, s[52:55], s6 offen nt
    s_mov_b32 s6, 98304
    buffer_load_dwordx4 v[140:143], v14, s[52:55], s6 offen nt
    s_mov_b32 s6, 131072
    buffer_load_dwordx4 v[144:147], v14, s[52:55], s6 offen nt
    s_mov_b32 s6, 163840
    buffer_load_dwordx4 v[148:151], v14, s[52:55], s6 offen nt
    s_mov_b32 s6, 196608
    buffer_load_dwordx4 v[152:155], v14, s[52:55], s6 offen nt
    s_mov_b32 s6, 229376
    buffer_load_dwordx4 v[156:159], v14, s[52:55], s6 offen nt
    s_mov_b32 s6, 262144
    buffer_load_dwordx4 v[160:163], v14, s[52:55], s6 offen nt
    s_mov_b32 s6, 294912
    buffer_load_dwordx4 v[164:167], v14, s[52:55], s6 offen nt
    s_mov_b32 s6, 327680
    buffer_load_dwordx4 v[168:171], v14, s[52:55], s6 offen nt
    s_mov_b32 s6, 360448
    buffer_load_dwordx4 v[172:175], v14, s[52:55], s6 offen nt
    s_mov_b32 s11, 0
L_lw_wd2:
    ds_read_b32 v18, v22 offset:268
    s_add_u32 s11, s11, 1
    s_cmp_ge_u32 s11, 524288
    s_cbranch_scc1 L_lwx_wd2
    s_waitcnt lgkmcnt(0)
    v_readfirstlane_b32 s8, v18
    s_cmp_ge_u32 s8, 2
    s_cbranch_scc1 L_lwx_wd2
    s_branch L_lw_wd2
L_lwx_wd2:
    s_waitcnt lgkmcnt(0)
    s_branch L_aux_wdr
L_aux_wdl:
    s_mov_b32 s11, 0
L_lw_wd:
    ds_read_b32 v18, v22 offset:268
    s_add_u32 s11, s11, 1
    s_cmp_ge_u32 s11, 524288
    s_cbranch_scc1 L_lwx_wd
    s_waitcnt lgkmcnt(0)
    v_readfirstlane_b32 s8, v18
    s_cmp_ge_u32 s8, 2
    s_cbranch_scc1 L_lwx_wd
    s_branch L_lw_wd
L_lwx_wd:
    s_waitcnt lgkmcnt(0)
    s_mov_b32 s6, 0
    buffer_load_dwordx4 v[128:131], v14, s[52:55], s6 offen nt
    s_mov_b32 s6, 32768
    buffer_load_dwordx4 v[132:135], v14, s[52:55], s6 offen nt
    s_mov_b32 s6, 65536
    buffer_load_dwordx4 v[136:139], v14, s[52:55], s6 offen nt
    s_mov_b32 s6, 98304
    buffer_load_dwordx4 v[140:143], v14, s[52:55], s6 offen nt
    s_mov_b32 s6, 131072
    buffer_load_dwordx4 v[144:147], v14, s[52:55], s6 offen nt
    s_mov_b32 s6, 163840
    buffer_load_dwordx4 v[148:151], v14, s[52:55], s6 offen nt
    s_mov_b32 s6, 196608
    buffer_load_dwordx4 v[152:155], v14, s[52:55], s6 offen nt
    s_mov_b32 s6, 229376
    buffer_load_dwordx4 v[156:159], v14, s[52:55], s6 offen nt
    s_mov_b32 s6, 262144
    buffer_load_dwordx4 v[160:163], v14, s[52:55], s6 offen nt
    s_mov_b32 s6, 294912
    buffer_load_dwordx4 v[164:167], v14, s[52:55], s6 offen nt
    s_mov_b32 s6, 327680
    buffer_load_dwordx4 v[168:171], v14, s[52:55], s6 offen nt
    s_mov_b32 s6, 360448
    buffer_load_dwordx4 v[172:175], v14, s[52:55], s6 offen nt
L_aux_wdr:
    s_mov_b32 s6, 393216
    buffer_load_dwordx4 v[176:179], v14, s[52:55], s6 offen nt
    s_mov_b32 s6, 425984
    buffer_load_dwordx4 v[180:183], v14, s[52:55], s6 offen nt
    s_mov_b32 s6, 458752
    buffer_load_dwordx4 v[184:187], v14, s[52:55], s6 offen nt
    s_mov_b32 s6, 491520
    buffer_load_dwordx4 v[188:191], v14, s[52:55], s6 offen nt
    s_mov_b32 s6, 524288
    buffer_load_dwordx4 v[192:195], v14, s[52:55], s6 offen nt
    s_mov_b32 s6, 557056
    buffer_load_dwordx4 v[196:199], v14, s[52:55], s6 offen nt
    s_mov_b32 s6, 589824
    buffer_load_dwordx4 v[200:203], v14, s[52:55], s6 offen nt
    s_mov_b32 s6, 622592
    buffer_load_dwordx4 v[204:207], v14, s[52:55], s6 offen nt
    s_mov_b32 s6, 655360
    buffer_load_dwordx4 v[208:211], v14, s[52:55], s6 offen nt
    s_mov_b32 s6, 688128
    buffer_load_dwordx4 v[212:215], v14, s[52:55], s6 offen nt
    s_mov_b32 s6, 720896
    buffer_load_dwordx4 v[216:219], v14, s[52:55], s6 offen nt
    s_mov_b32 s6, 753664
    buffer_load_dwordx4 v[220:223], v14, s[52:55], s6 offen nt
    s_mov_b32 s6, 786432
    buffer_load_dwordx4 v[224:227], v14, s[52:55], s6 offen nt
    s_mov_b32 s6, 819200
    buffer_load_dwordx4 v[228:231], v14, s[52:55], s6 offen nt
    s_mov_b32 s6, 851968
    buffer_load_dwordx4 v[232:235], v14, s[52:55], s6 offen nt
    s_mov_b32 s6, 884736
    buffer_load_dwordx4 v[236:239], v14, s[52:55], s6 offen nt
    s_mov_b32 s11, 0
L_lw_gp:
    ds_read_b32 v18, v22 offset:292
    s_add_u32 s11, s11, 1
    s_cmp_ge_u32 s11, 524288
    s_cbranch_scc1 L_lwx_gp
    s_waitcnt lgkmcnt(0)
    v_readfirstlane_b32 s8, v18
    s_cmp_ge_u32 s8, 4
    s_cbranch_scc1 L_lwx_gp
    s_sleep 1
    s_branch L_lw_gp
L_lwx_gp:
    s_waitcnt lgkmcnt(0)
    s_waitcnt vmcnt(24)
    ds_write_b128 v20, v[128:131] offset:0
    ds_write_b128 v20, v[132:135] offset:2048
    ds_write_b128 v20, v[136:139] offset:4096
    ds_write_b128 v20, v[140:143] offset:6144
    s_waitcnt vmcnt(20)
    ds_write_b128 v20, v[144:147] offset:8192
    ds_write_b128 v20, v[148:151] offset:10240
    ds_write_b128 v20, v[152:155] offset:12288
    ds_write_b128 v20, v[156:159] offset:14336
    s_waitcnt vmcnt(16)
    ds_write_b128 v20, v[160:163] offset:32768
    ds_write_b128 v20, v[164:167] offset:34816
    ds_write_b128 v20, v[168:171] offset:36864
    ds_write_b128 v20, v[172:175] offset:38912
    s_waitcnt vmcnt(12)
    ds_write_b128 v20, v[176:179] offset:40960
    ds_write_b128 v20, v[180:183] offset:43008
    ds_write_b128 v20, v[184:187] offset:45056
    ds_write_b128 v20, v[188:191] offset:47104
    s_waitcnt vmcnt(8)
    ds_write_b128 v21, v[192:195] offset:0
    ds_write_b128 v21, v[196:199] offset:2048
    ds_write_b128 v21, v[200:203] offset:4096
    ds_write_b128 v21, v[204:207] offset:6144
    s_waitcnt vmcnt(4)
    ds_write_b128 v21, v[208:211] offset:8192
    ds_write_b128 v21, v[212:215] offset:10240
    ds_write_b128 v21, v[216:219] offset:12288
    ds_write_b128 v21, v[220:223] offset:14336
    s_waitcnt vmcnt(0)
    ds_write_b128 v21, v[224:227] offset:32768
    ds_write_b128 v21, v[228:231] offset:34816
    ds_write_b128 v21, v[232:235] offset:36864
    ds_write_b128 v21, v[236:239] offset:38912
    s_waitcnt lgkmcnt(0)
    s_branch L_aux_b5
L_aux_sinit:
    v_mov_b32 v98, 148624
    v_mov_b32 v96, 0
    v_mov_b32 v97, 0
    v_lshl_add_u32 v98, v1, 3, v98
    ds_write_b64 v98, v[96:97]
    v_mov_b32 v96, 0x3f803f80
    v_and_b32 v98, 255, v0
    v_lshlrev_b32 v98, 2, v98
    v_add_u32 v98, 139392, v98
    ds_write_b32 v98, v96
    s_waitcnt lgkmcnt(0)
    v_and_b32 v2, 15, v0
    v_bfe_u32 v3, v0, 4, 2
    v_mov_b32 v22, 148624
    v_mov_b32 v23, 1
    s_mov_b64 s[40:41], s[34:35]
    s_mov_b32 s42, 753664
    s_mov_b32 s43, 0x00020000
    s_and_b32 s61, s3, 1
    s_lshr_b32 s6, s3, 1
    s_add_u32 s7, s57, 3
    s_and_b32 s7, s7, 7
    s_cmp_eq_u32 s7, 7
    s_cselect_b32 s8, 7, 6
    s_add_u32 s9, s6, 1
    s_cmp_eq_u32 s9, s8
    s_cselect_b32 s9, 0, s9
    s_cmp_ge_u32 s9, s7
    s_addc_u32 s9, s9, 0
    s_cmp_ge_u32 s6, s7
    s_addc_u32 s10, s6, 0
    s_cmp_eq_u32 s7, 7
    s_cselect_b32 s62, 0, 1
    s_cmp_lt_u32 s6, s8
    s_cselect_b32 s62, 2, s62
    s_cselect_b32 s10, s10, s7
    s_cselect_b32 s11, 0, s6
    s_and_b32 s11, s11, 1
    s_cmp_ge_u32 s3, 3
    s_addc_u32 s63, s3, 0
    s_cmp_ge_u32 s3, 10
    s_addc_u32 s63, s63, 0
    s_sub_u32 s12, s6, s8
    s_cmp_eq_u32 s12, 1
    s_cselect_b32 s63, s3, s63
    s_lshl_b32 s13, s61, 3
    s_add_u32 s13, s13, 3
    s_cmp_eq_u32 s12, 0
    s_cselect_b32 s63, s13, s63
    s_mul_i32 s64, s57, 57344
    s_add_u32 s64, s64, 32768
    s_cmp_eq_u32 s11, 1
    s_cselect_b64 s[44:45], s[26:27], s[24:25]
    s_mov_b32 s46, 7340032
    s_mov_b32 s47, 0x00020000
    s_mov_b64 s[48:49], s[26:27]
    s_mov_b32 s50, 7340032
    s_mov_b32 s51, 0x00020000
    s_lshl_b32 s12, s61, 1
    s_add_u32 s13, s12, s11
    s_mul_i32 s13, s13, 14336
    s_lshl_b32 s30, s10, 11
    s_add_u32 s30, s30, s13
    s_add_u32 s13, s12, 1
    s_mul_i32 s13, s13, 14336
    s_lshl_b32 s31, s9, 11
    s_add_u32 s31, s31, s13
    v_bfe_u32 v96, v1, 3, 2
    v_lshrrev_b32 v97, 5, v1
    v_lshl_add_u32 v96, v97, 3, v96
    v_mul_u32_u24 v96, 7168, v96
    v_lshlrev_b32 v98, 1, v3
    v_and_b32 v94, 7, v1
    v_xor_b32 v98, v98, v94
    s_mul_i32 s12, s57, 896
    s_lshl_b32 s10, s10, 7
    s_lshl_b32 s9, s9, 7
    s_add_u32 s10, s10, s12
    s_add_u32 s9, s9, s12
    v_lshl_add_u32 v96, v98, 4, v96
    v_add_u32 v97, s9, v96
    v_add_u32 v96, s10, v96
    s_sub_u32 s32, s56, 4
    s_lshl_b32 s33, s61, 2
    s_add_u32 s33, s33, s32
    s_mul_i32 s33, s33, 917504
    s_lshl_b32 s32, s32, 15
    s_barrier
    s_cmp_eq_u32 s62, 0
    s_cbranch_scc1 L_aux_idle
    s_add_u32 s6, s33, 0
    s_add_u32 m0, s32, 16384
    s_nop 0
    buffer_load_dwordx4 v96, s[44:47], s6 offen nt lds
    s_add_u32 s6, s33, 114688
    s_add_u32 m0, s32, 17408
    s_nop 0
    buffer_load_dwordx4 v96, s[44:47], s6 offen nt lds
    s_add_u32 s6, s33, 28672
    s_add_u32 m0, s32, 18432
    s_nop 0
    buffer_load_dwordx4 v96, s[44:47], s6 offen nt lds
    s_add_u32 s6, s33, 143360
    s_add_u32 m0, s32, 19456
    s_nop 0
    buffer_load_dwordx4 v96, s[44:47], s6 offen nt lds
    s_add_u32 s6, s33, 229376
    s_add_u32 m0, s32, 20480
    s_nop 0
    buffer_load_dwordx4 v96, s[44:47], s6 offen nt lds
    s_add_u32 s6, s33, 344064
    s_add_u32 m0, s32, 21504
    s_nop 0
    buffer_load_dwordx4 v96, s[44:47], s6 offen nt lds
    s_add_u32 s6, s33, 258048
    s_add_u32 m0, s32, 22528
    s_nop 0
    buffer_load_dwordx4 v96, s[44:47], s6 offen nt lds
    s_add_u32 s6, s33, 372736
    s_add_u32 m0, s32, 23552
    s_nop 0
    buffer_load_dwordx4 v96, s[44:47], s6 offen nt lds
    s_mov_b32 s11, 0
L_lw_st:
    ds_read_b32 v18, v22 offset:260
    s_add_u32 s11, s11, 1
    s_cmp_ge_u32 s11, 524288
    s_cbranch_scc1 L_lwx_st
    s_waitcnt lgkmcnt(0)
    v_readfirstlane_b32 s8, v18
    s_cmp_ge_u32 s8, 1
    s_cbranch_scc1 L_lwx_st
    s_sleep 1
    s_branch L_lw_st
L_lwx_st:
    s_waitcnt lgkmcnt(0)
    ds_read_b32 v18, v22 offset:284
    s_waitcnt lgkmcnt(0)
    v_readfirstlane_b32 s60, v18
    s_add_u32 s6, s33, 458752
    s_add_u32 m0, s32, 24576
    s_nop 0
    buffer_load_dwordx4 v96, s[44:47], s6 offen nt lds
    s_add_u32 s6, s33, 573440
    s_add_u32 m0, s32, 25600
    s_nop 0
    buffer_load_dwordx4 v96, s[44:47], s6 offen nt lds
    s_add_u32 s6, s33, 487424
    s_add_u32 m0, s32, 26624
    s_nop 0
    buffer_load_dwordx4 v96, s[44:47], s6 offen nt lds
    s_add_u32 s6, s33, 602112
    s_add_u32 m0, s32, 27648
    s_nop 0
    buffer_load_dwordx4 v96, s[44:47], s6 offen nt lds
    s_add_u32 s6, s33, 688128
    s_add_u32 m0, s32, 28672
    s_nop 0
    buffer_load_dwordx4 v96, s[44:47], s6 offen nt lds
    s_add_u32 s6, s33, 802816
    s_add_u32 m0, s32, 29696
    s_nop 0
    buffer_load_dwordx4 v96, s[44:47], s6 offen nt lds
    s_add_u32 s6, s33, 716800
    s_add_u32 m0, s32, 30720
    s_nop 0
    buffer_load_dwordx4 v96, s[44:47], s6 offen nt lds
    s_add_u32 s6, s33, 831488
    s_add_u32 m0, s32, 31744
    s_nop 0
    buffer_load_dwordx4 v96, s[44:47], s6 offen nt lds
    s_cmp_eq_u32 s62, 1
    s_cbranch_scc1 L_aux_one1
    s_add_u32 s6, s33, 0
    s_add_u32 m0, s32, 0
    s_nop 0
    buffer_load_dwordx4 v97, s[48:51], s6 offen nt lds
    s_add_u32 s6, s33, 114688
    s_add_u32 m0, s32, 1024
    s_nop 0
    buffer_load_dwordx4 v97, s[48:51], s6 offen nt lds
    s_add_u32 s6, s33, 28672
    s_add_u32 m0, s32, 2048
    s_nop 0
    buffer_load_dwordx4 v97, s[48:51], s6 offen nt lds
    s_add_u32 s6, s33, 143360
    s_add_u32 m0, s32, 3072
    s_nop 0
    buffer_load_dwordx4 v97, s[48:51], s6 offen nt lds
    s_add_u32 s6, s33, 229376
    s_add_u32 m0, s32, 4096
    s_nop 0
    buffer_load_dwordx4 v97, s[48:51], s6 offen nt lds
    s_add_u32 s6, s33, 344064
    s_add_u32 m0, s32, 5120
    s_nop 0
    buffer_load_dwordx4 v97, s[48:51], s6 offen nt lds
    s_add_u32 s6, s33, 258048
    s_add_u32 m0, s32, 6144
    s_nop 0
    buffer_load_dwordx4 v97, s[48:51], s6 offen nt lds
    s_add_u32 s6, s33, 372736
    s_add_u32 m0, s32, 7168
    s_nop 0
    buffer_load_dwordx4 v97, s[48:51], s6 offen nt lds
    s_add_u32 s6, s33, 458752
    s_add_u32 m0, s32, 8192
    s_nop 0
    buffer_load_dwordx4 v97, s[48:51], s6 offen nt lds
    s_add_u32 s6, s33, 573440
    s_add_u32 m0, s32, 9216
    s_nop 0
    buffer_load_dwordx4 v97, s[48:51], s6 offen nt lds
    s_add_u32 s6, s33, 487424
    s_add_u32 m0, s32, 10240
    s_nop 0
    buffer_load_dwordx4 v97, s[48:51], s6 offen nt lds
    s_add_u32 s6, s33, 602112
    s_add_u32 m0, s32, 11264
    s_nop 0
    buffer_load_dwordx4 v97, s[48:51], s6 offen nt lds
    s_add_u32 s6, s33, 688128
    s_add_u32 m0, s32, 12288
    s_nop 0
    buffer_load_dwordx4 v97, s[48:51], s6 offen nt lds
    s_add_u32 s6, s33, 802816
    s_add_u32 m0, s32, 13312
    s_nop 0
    buffer_load_dwordx4 v97, s[48:51], s6 offen nt lds
    s_add_u32 s6, s33, 716800
    s_add_u32 m0, s32, 14336
    s_nop 0
    buffer_load_dwordx4 v97, s[48:51], s6 offen nt lds
    s_add_u32 s6, s33, 831488
    s_add_u32 m0, s32, 15360
    s_nop 0
    buffer_load_dwordx4 v97, s[48:51], s6 offen nt lds
L_aux_one1:
    s_mov_b64 exec, 1
    ds_add_u32 v22, v23 offset:280
    s_mov_b64 exec, -1
    s_bfe_u32 s65, s60, 0x80000
    s_bfe_u32 s66, s60, 0x80008
    s_bfe_u32 s67, s60, 0x80010
    s_bfe_u32 s68, s60, 0x80018
    v_bfe_u32 v14, v1, 2, 3
    v_lshrrev_b32 v15, 1, v14
    v_lshlrev_b32 v14, 7, v14
    v_lshrrev_b32 v13, 5, v1
    v_lshl_add_u32 v14, v13, 10, v14
    v_and_b32 v13, 3, v1
    v_lshl_add_u32 v14, v13, 3, v14
    v_add_u32 v14, s32, v14
    v_xor_b32 v13, 0, v15
    v_lshl_add_u32 v24, v13, 5, v14
    v_xor_b32 v13, 1, v15
    v_lshl_add_u32 v25, v13, 5, v14
    v_xor_b32 v13, 2, v15
    v_lshl_add_u32 v26, v13, 5, v14
    v_xor_b32 v13, 3, v15
    v_lshl_add_u32 v27, v13, 5, v14
    v_min_u32 v20, 8, v2
    v_mul_u32_u24 v20, 1040, v20
    v_lshl_add_u32 v20, v3, 4, v20
    s_lshr_b32 s6, s32, 7
    s_add_u32 s6, s6, 131072
    v_add_u32 v20, s6, v20
    v_lshlrev_b32 v19, 6, v2
    v_lshl_add_u32 v19, v3, 4, v19
    s_lshr_b32 s6, s32, 11
    s_add_u32 s6, s6, s32
    s_add_u32 s6, s6, 24512
    v_add_u32 v19, s6, v19
    v_and_b32 v242, 7, v1
    v_lshl_add_u32 v243, v242, 2, v22
    v_bfe_u32 v241, v1, 3, 2
    v_mul_u32_u24 v241, 32784, v241
    v_lshrrev_b32 v240, 5, v1
    v_lshl_add_u32 v241, v240, 12, v241
    s_lshr_b32 s6, s32, 11
    s_add_u32 s6, s6, 24512
    v_add_u32 v241, s6, v241
    s_sub_u32 s6, s31, s30
    v_mul_i32_i24 v244, s6, v240
    v_lshl_add_u32 v244, v242, 4, v244
    v_bfe_u32 v240, v1, 4, 1
    v_lshl_add_u32 v244, v240, 9, v244
    v_bfe_u32 v240, v1, 3, 1
    v_lshl_add_u32 v244, v240, 10, v244
    s_lshr_b32 s6, s32, 8
    s_add_u32 s6, s6, s30
    s_add_u32 s6, s6, s64
    v_add_u32 v244, s6, v244
    v_lshl_add_u32 v242, v242, 6, v241
    v_mov_b32 v245, 0xffffff00
    v_cmp_eq_u32 s[70:71], 1, v240
    s_cmp_eq_u32 s62, 1
    s_cbranch_scc1 L_aux_one2
    s_waitcnt vmcnt(28)
    ds_read_b64_tr_b16 v[64:65], v24 offset:16384
    ds_read_b64_tr_b16 v[66:67], v24 offset:18432
    ds_read_b64_tr_b16 v[68:69], v25 offset:16384
    ds_read_b64_tr_b16 v[70:71], v25 offset:18432
    ds_read_b64_tr_b16 v[72:73], v26 offset:16384
    ds_read_b64_tr_b16 v[74:75], v26 offset:18432
    ds_read_b64_tr_b16 v[76:77], v27 offset:16384
    ds_read_b64_tr_b16 v[78:79], v27 offset:18432
    s_waitcnt vmcnt(24)
    ds_read_b64_tr_b16 v[96:97], v24 offset:20480
    ds_read_b64_tr_b16 v[98:99], v24 offset:22528
    ds_read_b64_tr_b16 v[100:101], v25 offset:20480
    ds_read_b64_tr_b16 v[102:103], v25 offset:22528
    ds_read_b64_tr_b16 v[104:105], v26 offset:20480
    ds_read_b64_tr_b16 v[106:107], v26 offset:22528
    ds_read_b64_tr_b16 v[108:109], v27 offset:20480
    ds_read_b64_tr_b16 v[110:111], v27 offset:22528
    s_waitcnt vmcnt(20)
    ds_read_b64_tr_b16 v[128:129], v24 offset:24576
    ds_read_b64_tr_b16 v[130:131], v24 offset:26624
    ds_read_b64_tr_b16 v[132:133], v25 offset:24576
    ds_read_b64_tr_b16 v[134:135], v25 offset:26624
    ds_read_b64_tr_b16 v[136:137], v26 offset:24576
    ds_read_b64_tr_b16 v[138:139], v26 offset:26624
    ds_read_b64_tr_b16 v[140:141], v27 offset:24576
    ds_read_b64_tr_b16 v[142:143], v27 offset:26624
    s_waitcnt vmcnt(16)
    ds_read_b64_tr_b16 v[160:161], v24 offset:28672
    ds_read_b64_tr_b16 v[162:163], v24 offset:30720
    ds_read_b64_tr_b16 v[164:165], v25 offset:28672
    ds_read_b64_tr_b16 v[166:167], v25 offset:30720
    ds_read_b64_tr_b16 v[168:169], v26 offset:28672
    ds_read_b64_tr_b16 v[170:171], v26 offset:30720
    ds_read_b64_tr_b16 v[172:173], v27 offset:28672
    ds_read_b64_tr_b16 v[174:175], v27 offset:30720
    s_waitcnt vmcnt(12)
    ds_read_b64_tr_b16 v[80:81], v24 offset:0
    ds_read_b64_tr_b16 v[82:83], v24 offset:2048
    ds_read_b64_tr_b16 v[84:85], v25 offset:0
    ds_read_b64_tr_b16 v[86:87], v25 offset:2048
    ds_read_b64_tr_b16 v[88:89], v26 offset:0
    ds_read_b64_tr_b16 v[90:91], v26 offset:2048
    ds_read_b64_tr_b16 v[92:93], v27 offset:0
    ds_read_b64_tr_b16 v[94:95], v27 offset:2048
    s_waitcnt vmcnt(8)
    ds_read_b64_tr_b16 v[112:113], v24 offset:4096
    ds_read_b64_tr_b16 v[114:115], v24 offset:6144
    ds_read_b64_tr_b16 v[116:117], v25 offset:4096
    ds_read_b64_tr_b16 v[118:119], v25 offset:6144
    ds_read_b64_tr_b16 v[120:121], v26 offset:4096
    ds_read_b64_tr_b16 v[122:123], v26 offset:6144
    ds_read_b64_tr_b16 v[124:125], v27 offset:4096
    ds_read_b64_tr_b16 v[126:127], v27 offset:6144
    s_waitcnt vmcnt(4)
    ds_read_b64_tr_b16 v[144:145], v24 offset:8192
    ds_read_b64_tr_b16 v[146:147], v24 offset:10240
    ds_read_b64_tr_b16 v[148:149], v25 offset:8192
    ds_read_b64_tr_b16 v[150:151], v25 offset:10240
    ds_read_b64_tr_b16 v[152:153], v26 offset:8192
    ds_read_b64_tr_b16 v[154:155], v26 offset:10240
    ds_read_b64_tr_b16 v[156:157], v27 offset:8192
    ds_read_b64_tr_b16 v[158:159], v27 offset:10240
    s_waitcnt vmcnt(0)
    ds_read_b64_tr_b16 v[176:177], v24 offset:12288
    ds_read_b64_tr_b16 v[178:179], v24 offset:14336
    ds_read_b64_tr_b16 v[180:181], v25 offset:12288
    ds_read_b64_tr_b16 v[182:183], v25 offset:14336
    ds_read_b64_tr_b16 v[184:185], v26 offset:12288
    ds_read_b64_tr_b16 v[186:187], v26 offset:14336
    ds_read_b64_tr_b16 v[188:189], v27 offset:12288
    ds_read_b64_tr_b16 v[190:191], v27 offset:14336
    s_branch L_aux_two2
L_aux_one2:
    s_waitcnt vmcnt(12)
    ds_read_b64_tr_b16 v[64:65], v24 offset:16384
    ds_read_b64_tr_b16 v[66:67], v24 offset:18432
    ds_read_b64_tr_b16 v[68:69], v25 offset:16384
    ds_read_b64_tr_b16 v[70:71], v25 offset:18432
    ds_read_b64_tr_b16 v[72:73], v26 offset:16384
    ds_read_b64_tr_b16 v[74:75], v26 offset:18432
    ds_read_b64_tr_b16 v[76:77], v27 offset:16384
    ds_read_b64_tr_b16 v[78:79], v27 offset:18432
    s_waitcnt vmcnt(8)
    ds_read_b64_tr_b16 v[96:97], v24 offset:20480
    ds_read_b64_tr_b16 v[98:99], v24 offset:22528
    ds_read_b64_tr_b16 v[100:101], v25 offset:20480
    ds_read_b64_tr_b16 v[102:103], v25 offset:22528
    ds_read_b64_tr_b16 v[104:105], v26 offset:20480
    ds_read_b64_tr_b16 v[106:107], v26 offset:22528
    ds_read_b64_tr_b16 v[108:109], v27 offset:20480
    ds_read_b64_tr_b16 v[110:111], v27 offset:22528
    s_waitcnt vmcnt(4)
    ds_read_b64_tr_b16 v[128:129], v24 offset:24576
    ds_read_b64_tr_b16 v[130:131], v24 offset:26624
    ds_read_b64_tr_b16 v[132:133], v25 offset:24576
    ds_read_b64_tr_b16 v[134:135], v25 offset:26624
    ds_read_b64_tr_b16 v[136:137], v26 offset:24576
    ds_read_b64_tr_b16 v[138:139], v26 offset:26624
    ds_read_b64_tr_b16 v[140:141], v27 offset:24576
    ds_read_b64_tr_b16 v[142:143], v27 offset:26624
    s_waitcnt vmcnt(0)
    ds_read_b64_tr_b16 v[160:161], v24 offset:28672
    ds_read_b64_tr_b16 v[162:163], v24 offset:30720
    ds_read_b64_tr_b16 v[164:165], v25 offset:28672
    ds_read_b64_tr_b16 v[166:167], v25 offset:30720
    ds_read_b64_tr_b16 v[168:169], v26 offset:28672
    ds_read_b64_tr_b16 v[170:171], v26 offset:30720
    ds_read_b64_tr_b16 v[172:173], v27 offset:28672
    ds_read_b64_tr_b16 v[174:175], v27 offset:30720
L_aux_two2:
    s_waitcnt lgkmcnt(0)
    s_mov_b32 s11, 0
L_lw_xs:
    ds_read_b32 v18, v22 offset:272
    s_add_u32 s11, s11, 1
    s_cmp_ge_u32 s11, 524288
    s_cbranch_scc1 L_lwx_xs
    s_waitcnt lgkmcnt(0)
    v_readfirstlane_b32 s8, v18
    s_cmp_ge_u32 s8, 2
    s_cbranch_scc1 L_lwx_xs
    s_branch L_lw_xs
L_lwx_xs:
    s_waitcnt lgkmcnt(0)
    ds_read_b32 v28, v243 offset:192
    ds_read_b128 v[32:35], v20 offset:0
    ds_read_b128 v[36:39], v20 offset:64
    ds_read_b128 v[40:43], v20 offset:128
    ds_read_b128 v[44:47], v20 offset:192
    s_waitcnt lgkmcnt(3)
    v_mfma_f32_16x16x32_bf16 v[192:195], v[64:67], v[32:35], 0
    s_waitcnt lgkmcnt(2)
    v_mfma_f32_16x16x32_bf16 v[192:195], v[96:99], v[36:39], v[192:195]
    s_waitcnt lgkmcnt(1)
    v_mfma_f32_16x16x32_bf16 v[192:195], v[128:131], v[40:43], v[192:195]
    s_waitcnt lgkmcnt(0)
    v_mfma_f32_16x16x32_bf16 v[192:195], v[160:163], v[44:47], v[192:195]
    v_mfma_f32_16x16x32_bf16 v[196:199], v[68:71], v[32:35], 0
    v_mfma_f32_16x16x32_bf16 v[196:199], v[100:103], v[36:39], v[196:199]
    v_mfma_f32_16x16x32_bf16 v[196:199], v[132:135], v[40:43], v[196:199]
    v_mfma_f32_16x16x32_bf16 v[196:199], v[164:167], v[44:47], v[196:199]
    v_mfma_f32_16x16x32_bf16 v[200:203], v[72:75], v[32:35], 0
    v_mfma_f32_16x16x32_bf16 v[200:203], v[104:107], v[36:39], v[200:203]
    v_mfma_f32_16x16x32_bf16 v[200:203], v[136:139], v[40:43], v[200:203]
    v_mfma_f32_16x16x32_bf16 v[200:203], v[168:171], v[44:47], v[200:203]
    ds_write_b128 v19, v[192:195] offset:0
    v_mfma_f32_16x16x32_bf16 v[204:207], v[76:79], v[32:35], 0
    v_mfma_f32_16x16x32_bf16 v[204:207], v[108:111], v[36:39], v[204:207]
    v_mfma_f32_16x16x32_bf16 v[204:207], v[140:143], v[40:43], v[204:207]
    v_mfma_f32_16x16x32_bf16 v[204:207], v[172:175], v[44:47], v[204:207]
    ds_write_b128 v19, v[196:199] offset:1024
    s_cmp_eq_u32 s62, 1
    s_cbranch_scc1 L_aux_one3
    v_mfma_f32_16x16x32_bf16 v[208:211], v[80:83], v[32:35], 0
    v_mfma_f32_16x16x32_bf16 v[208:211], v[112:115], v[36:39], v[208:211]
    v_mfma_f32_16x16x32_bf16 v[208:211], v[144:147], v[40:43], v[208:211]
    v_mfma_f32_16x16x32_bf16 v[208:211], v[176:179], v[44:47], v[208:211]
    ds_write_b128 v19, v[200:203] offset:2048
    v_mfma_f32_16x16x32_bf16 v[212:215], v[84:87], v[32:35], 0
    v_mfma_f32_16x16x32_bf16 v[212:215], v[116:119], v[36:39], v[212:215]
    v_mfma_f32_16x16x32_bf16 v[212:215], v[148:151], v[40:43], v[212:215]
    v_mfma_f32_16x16x32_bf16 v[212:215], v[180:183], v[44:47], v[212:215]
    ds_write_b128 v19, v[204:207] offset:3072
    v_mfma_f32_16x16x32_bf16 v[216:219], v[88:91], v[32:35], 0
    v_mfma_f32_16x16x32_bf16 v[216:219], v[120:123], v[36:39], v[216:219]
    v_mfma_f32_16x16x32_bf16 v[216:219], v[152:155], v[40:43], v[216:219]
    v_mfma_f32_16x16x32_bf16 v[216:219], v[184:187], v[44:47], v[216:219]
    ds_write_b128 v19, v[208:211] offset:4096
    v_mfma_f32_16x16x32_bf16 v[220:223], v[92:95], v[32:35], 0
    v_mfma_f32_16x16x32_bf16 v[220:223], v[124:127], v[36:39], v[220:223]
    v_mfma_f32_16x16x32_bf16 v[220:223], v[156:159], v[40:43], v[220:223]
    v_mfma_f32_16x16x32_bf16 v[220:223], v[188:191], v[44:47], v[220:223]
    ds_write_b128 v19, v[212:215] offset:5120
    s_nop 1
    ds_write_b128 v19, v[216:219] offset:6144
    s_nop 3
    ds_write_b128 v19, v[220:223] offset:7168
    s_branch L_aux_two3
L_aux_one3:
    s_nop 7
    ds_write_b128 v19, v[200:203] offset:2048
    ds_write_b128 v19, v[204:207] offset:3072
L_aux_two3:
    s_mov_b64 exec, 1
    ds_add_u32 v22, v23 offset:276
    s_mov_b64 exec, -1
    v_and_b32 v25, 0xffff0000, v28
    v_lshlrev_b32 v24, 16, v28
    v_rcp_f32 v25, v25
    s_mov_b32 s11, 0
L_lw_pp:
    ds_read_b32 v18, v22 offset:276
    s_add_u32 s11, s11, 1
    s_cmp_ge_u32 s11, 524288
    s_cbranch_scc1 L_lwx_pp
    s_waitcnt lgkmcnt(0)
    v_readfirstlane_b32 s8, v18
    s_cmp_ge_u32 s8, 4
    s_cbranch_scc1 L_lwx_pp
    s_branch L_lw_pp
L_lwx_pp:
    s_waitcnt lgkmcnt(0)
    ds_read_b128 v[64:67], v242 offset:0
    ds_read_b128 v[72:75], v241 offset:512
    ds_read_b128 v[68:71], v242 offset:2048
    ds_read_b128 v[76:79], v241 offset:2560
    ds_read_b128 v[80:83], v242 offset:1024
    ds_read_b128 v[88:91], v241 offset:1536
    ds_read_b128 v[84:87], v242 offset:3072
    ds_read_b128 v[92:95], v241 offset:3584
    s_cmp_eq_u32 s62, 1
    s_cselect_b32 s6, 0, -1
    s_waitcnt lgkmcnt(4)
    v_pk_fma_f32 v[64:65], v[72:73], v[24:25], v[64:65] op_sel:[0,0,0] op_sel_hi:[1,0,1] neg_lo:[1,0,0] neg_hi:[1,0,0]
    v_pk_fma_f32 v[66:67], v[74:75], v[24:25], v[66:67] op_sel:[0,0,0] op_sel_hi:[1,0,1] neg_lo:[1,0,0] neg_hi:[1,0,0]
    v_pk_fma_f32 v[68:69], v[76:77], v[24:25], v[68:69] op_sel:[0,0,0] op_sel_hi:[1,0,1] neg_lo:[1,0,0] neg_hi:[1,0,0]
    v_pk_fma_f32 v[70:71], v[78:79], v[24:25], v[70:71] op_sel:[0,0,0] op_sel_hi:[1,0,1] neg_lo:[1,0,0] neg_hi:[1,0,0]
    v_cndmask_b32 v72, v68, v64, s[70:71]
    v_cndmask_b32 v73, v69, v65, s[70:71]
    v_cndmask_b32 v74, v70, v66, s[70:71]
    v_cndmask_b32 v75, v71, v67, s[70:71]
    v_cndmask_b32 v64, v64, v68, s[70:71]
    v_cndmask_b32 v65, v65, v69, s[70:71]
    v_cndmask_b32 v66, v66, v70, s[70:71]
    v_cndmask_b32 v67, v67, v71, s[70:71]
    v_add_f32_dpp v64, v72, v64 row_ror:8 row_mask:0xf bank_mask:0xf
    v_add_f32_dpp v65, v73, v65 row_ror:8 row_mask:0xf bank_mask:0xf
    v_add_f32_dpp v66, v74, v66 row_ror:8 row_mask:0xf bank_mask:0xf
    v_add_f32_dpp v67, v75, v67 row_ror:8 row_mask:0xf bank_mask:0xf
    s_waitcnt lgkmcnt(0)
    v_pk_fma_f32 v[80:81], v[88:89], v[24:25], v[80:81] op_sel:[0,0,0] op_sel_hi:[1,0,1] neg_lo:[1,0,0] neg_hi:[1,0,0]
    v_pk_fma_f32 v[82:83], v[90:91], v[24:25], v[82:83] op_sel:[0,0,0] op_sel_hi:[1,0,1] neg_lo:[1,0,0] neg_hi:[1,0,0]
    v_pk_fma_f32 v[84:85], v[92:93], v[24:25], v[84:85] op_sel:[0,0,0] op_sel_hi:[1,0,1] neg_lo:[1,0,0] neg_hi:[1,0,0]
    v_pk_fma_f32 v[86:87], v[94:95], v[24:25], v[86:87] op_sel:[0,0,0] op_sel_hi:[1,0,1] neg_lo:[1,0,0] neg_hi:[1,0,0]
    v_cndmask_b32 v88, v84, v80, s[70:71]
    v_cndmask_b32 v89, v85, v81, s[70:71]
    v_cndmask_b32 v90, v86, v82, s[70:71]
    v_cndmask_b32 v91, v87, v83, s[70:71]
    v_cndmask_b32 v80, v80, v84, s[70:71]
    v_cndmask_b32 v81, v81, v85, s[70:71]
    v_cndmask_b32 v82, v82, v86, s[70:71]
    v_cndmask_b32 v83, v83, v87, s[70:71]
    v_add_f32_dpp v80, v88, v80 row_ror:8 row_mask:0xf bank_mask:0xf
    v_add_f32_dpp v81, v89, v81 row_ror:8 row_mask:0xf bank_mask:0xf
    v_add_f32_dpp v82, v90, v82 row_ror:8 row_mask:0xf bank_mask:0xf
    v_add_f32_dpp v83, v91, v83 row_ror:8 row_mask:0xf bank_mask:0xf
    v_permlane16_swap_b32 v64, v80
    v_permlane16_swap_b32 v65, v81
    v_permlane16_swap_b32 v66, v82
    v_permlane16_swap_b32 v67, v83
    v_pk_add_f32 v[64:65], v[64:65], v[80:81]
    v_pk_add_f32 v[66:67], v[66:67], v[82:83]
    v_pk_mul_f32 v[64:65], v[64:65], v[24:25] op_sel:[0,1] op_sel_hi:[1,1]
    v_pk_mul_f32 v[66:67], v[66:67], v[24:25] op_sel:[0,1] op_sel_hi:[1,1]
    v_and_or_b32 v64, v64, v245, s65
    v_and_or_b32 v65, v65, v245, s66
    v_and_or_b32 v66, v66, v245, s67
    v_and_or_b32 v67, v67, v245, s68
    s_mov_b32 exec_hi, s6
    buffer_store_dwordx4 v[64:67], v244, s[40:43], 0 offen sc1
    s_mov_b64 exec, 1
    ds_add_u32 v22, v23 offset:292
    s_mov_b64 exec, -1
    s_branch L_aux_b5
L_aux_idle:
    s_mov_b32 s11, 0
L_lw_id:
    ds_read_b32 v18, v22 offset:260
    s_add_u32 s11, s11, 1
    s_cmp_ge_u32 s11, 524288
    s_cbranch_scc1 L_lwx_id
    s_waitcnt lgkmcnt(0)
    v_readfirstlane_b32 s8, v18
    s_cmp_ge_u32 s8, 1
    s_cbranch_scc1 L_lwx_id
    s_sleep 1
    s_branch L_lw_id
L_lwx_id:
    s_waitcnt lgkmcnt(0)
    ds_read_b32 v18, v22 offset:284
    s_waitcnt lgkmcnt(0)
    v_readfirstlane_b32 s60, v18
    s_bfe_u32 s65, s60, 0x80000
    s_bfe_u32 s66, s60, 0x80008
    s_bfe_u32 s67, s60, 0x80010
    s_bfe_u32 s68, s60, 0x80018
    s_mov_b64 exec, 1
    ds_add_u32 v22, v23 offset:292
    s_mov_b64 exec, -1
    s_branch L_aux_b5
L_aux_b4:
L_aux_b5:
    v_bfe_u32 v11, v1, 1, 1
    v_bfe_u32 v10, v1, 2, 2
    v_lshl_add_u32 v10, v11, 2, v10
    v_lshl_add_u32 v10, v3, 3, v10
    v_bfe_u32 v11, v10, 1, 3
    v_xor_b32 v11, s56, v11
    v_lshlrev_b32 v10, 7, v10
    v_lshl_add_u32 v10, v11, 4, v10
    v_and_b32 v11, 1, v1
    v_lshl_add_u32 v10, v11, 3, v10
    v_add_u32 v11, 0x10000, v10
    v_lshl_add_u32 v14, v0, 4, s64
    v_lshlrev_b32 v15, 3, v1
    v_add_u32 v15, 131072, v15
    s_lshl_b32 s6, s56, 9
    v_add_u32 v16, s6, v15
    s_mov_b32 s21, 7168
    s_mov_b32 s22, 14336
    s_mov_b32 s23, 21504
    s_mov_b32 s24, 28672
    s_mov_b32 s25, 35840
    s_mov_b32 s26, 43008
    s_mov_b32 s27, 50176
    s_mov_b32 s18, 0xbfb8aa3b
    s_mov_b32 s16, 0
    v_mov_b32 v17, 0xff
    v_mov_b32 v245, 0xffffff00
    s_lshl_b32 s6, s63, 3
    s_add_u32 s6, s6, s56
    s_lshl_b32 s6, s6, 3
    s_add_u32 s6, s6, s57
    s_lshl_b32 s6, s6, 8
    s_add_u32 s6, s6, 491520
    v_lshlrev_b32 v12, 7, v3
    v_lshl_add_u32 v12, v2, 4, v12
    v_add_u32 v12, s6, v12
    s_barrier
    ds_read_b64_tr_b16 v[64:65], v10 offset:0
    ds_read_b64_tr_b16 v[66:67], v10 offset:4096
    ds_read_b64_tr_b16 v[68:69], v10 offset:8192
    ds_read_b64_tr_b16 v[70:71], v10 offset:12288
    ds_read_b64_tr_b16 v[72:73], v10 offset:32768
    ds_read_b64_tr_b16 v[74:75], v10 offset:36864
    ds_read_b64_tr_b16 v[76:77], v10 offset:40960
    ds_read_b64_tr_b16 v[78:79], v10 offset:45056
    ds_read_b64_tr_b16 v[80:81], v11 offset:0
    ds_read_b64_tr_b16 v[82:83], v11 offset:4096
    ds_read_b64_tr_b16 v[84:85], v11 offset:8192
    ds_read_b64_tr_b16 v[86:87], v11 offset:12288
    ds_read_b64_tr_b16 v[88:89], v11 offset:32768
    ds_read_b64_tr_b16 v[90:91], v11 offset:36864
    s_cmp_eq_u32 s56, 7
    s_cbranch_scc1 L_aux_nohp
    s_sleep 3
    buffer_load_dwordx4 v[128:131], v14, s[40:43], 0 offen sc1
    buffer_load_dwordx4 v[132:135], v14, s[40:43], s21 offen sc1
    buffer_load_dwordx4 v[136:139], v14, s[40:43], s22 offen sc1
    buffer_load_dwordx4 v[140:143], v14, s[40:43], s23 offen sc1
    buffer_load_dwordx4 v[144:147], v14, s[40:43], s24 offen sc1
    buffer_load_dwordx4 v[148:151], v14, s[40:43], s25 offen sc1
    buffer_load_dwordx4 v[152:155], v14, s[40:43], s26 offen sc1
    buffer_load_dwordx4 v[156:159], v14, s[40:43], s27 offen sc1
L_aux_gp:
    s_waitcnt vmcnt(0)
    v_bitop3_b32 v32, v128, v132, s65 bitop3:0x7e
    v_bitop3_b32 v36, v136, v140, s65 bitop3:0x7e
    v_bitop3_b32 v40, v144, v148, s65 bitop3:0x7e
    v_bitop3_b32 v44, v152, v156, s65 bitop3:0x7e
    v_bitop3_b32 v33, v129, v133, s66 bitop3:0x7e
    v_bitop3_b32 v37, v137, v141, s66 bitop3:0x7e
    v_bitop3_b32 v41, v145, v149, s66 bitop3:0x7e
    v_bitop3_b32 v45, v153, v157, s66 bitop3:0x7e
    v_bitop3_b32 v34, v130, v134, s67 bitop3:0x7e
    v_bitop3_b32 v38, v138, v142, s67 bitop3:0x7e
    v_bitop3_b32 v42, v146, v150, s67 bitop3:0x7e
    v_bitop3_b32 v46, v154, v158, s67 bitop3:0x7e
    v_bitop3_b32 v35, v131, v135, s68 bitop3:0x7e
    v_bitop3_b32 v39, v139, v143, s68 bitop3:0x7e
    v_bitop3_b32 v43, v147, v151, s68 bitop3:0x7e
    v_bitop3_b32 v47, v155, v159, s68 bitop3:0x7e
    v_or3_b32 v32, v32, v33, v34
    v_or3_b32 v36, v36, v37, v38
    v_or3_b32 v40, v40, v41, v42
    v_or3_b32 v44, v44, v45, v46
    v_bitop3_b32 v32, v32, v35, v17 bitop3:0xa8
    v_bitop3_b32 v36, v36, v39, v17 bitop3:0xa8
    v_bitop3_b32 v40, v40, v43, v17 bitop3:0xa8
    v_bitop3_b32 v44, v44, v47, v17 bitop3:0xa8
    v_cmp_ne_u32 s[6:7], 0, v32
    v_cmp_ne_u32 s[8:9], 0, v36
    v_cmp_ne_u32 s[10:11], 0, v40
    v_cmp_ne_u32 s[12:13], 0, v44
    s_or_b64 vcc, s[6:7], s[8:9]
    s_or_b64 s[14:15], s[10:11], s[12:13]
    s_or_b64 vcc, vcc, s[14:15]
    s_cbranch_scc0 L_aux_gok
    s_add_u32 s16, s16, 1
    s_cmp_ge_u32 s16, 65536
    s_cbranch_scc1 L_aux_gok
    s_sleep 2
    s_mov_b64 exec, s[6:7]
    s_cbranch_execz L_aux_gs0
    buffer_load_dwordx4 v[128:131], v14, s[40:43], 0 offen sc1
    buffer_load_dwordx4 v[132:135], v14, s[40:43], s21 offen sc1
L_aux_gs0:
    s_mov_b64 exec, s[8:9]
    s_cbranch_execz L_aux_gs1
    buffer_load_dwordx4 v[136:139], v14, s[40:43], s22 offen sc1
    buffer_load_dwordx4 v[140:143], v14, s[40:43], s23 offen sc1
L_aux_gs1:
    s_mov_b64 exec, s[10:11]
    s_cbranch_execz L_aux_gs2
    buffer_load_dwordx4 v[144:147], v14, s[40:43], s24 offen sc1
    buffer_load_dwordx4 v[148:151], v14, s[40:43], s25 offen sc1
L_aux_gs2:
    s_mov_b64 exec, s[12:13]
    s_cbranch_execz L_aux_gs3
    buffer_load_dwordx4 v[152:155], v14, s[40:43], s26 offen sc1
    buffer_load_dwordx4 v[156:159], v14, s[40:43], s27 offen sc1
L_aux_gs3:
    s_mov_b64 exec, -1
    s_branch L_aux_gp
L_aux_gok:
    v_pk_add_f32 v[128:129], v[128:129], v[144:145]
    v_pk_add_f32 v[130:131], v[130:131], v[146:147]
    v_pk_add_f32 v[132:133], v[132:133], v[148:149]
    v_pk_add_f32 v[134:135], v[134:135], v[150:151]
    v_pk_mul_f32 v[144:145], v[128:129], s[18:19] op_sel_hi:[1,0]
    v_pk_mul_f32 v[146:147], v[130:131], s[18:19] op_sel_hi:[1,0]
    v_pk_mul_f32 v[148:149], v[132:133], s[18:19] op_sel_hi:[1,0]
    v_pk_mul_f32 v[150:151], v[134:135], s[18:19] op_sel_hi:[1,0]
    v_exp_f32 v144, v144
    v_exp_f32 v145, v145
    v_exp_f32 v146, v146
    v_exp_f32 v147, v147
    v_pk_add_f32 v[136:137], v[136:137], v[152:153]
    v_pk_add_f32 v[138:139], v[138:139], v[154:155]
    v_exp_f32 v148, v148
    v_exp_f32 v149, v149
    v_exp_f32 v150, v150
    v_exp_f32 v151, v151
    v_pk_add_f32 v[140:141], v[140:141], v[156:157]
    v_pk_add_f32 v[142:143], v[142:143], v[158:159]
    v_pk_add_f32 v[144:145], v[144:145], 1.0 op_sel_hi:[1,0]
    v_pk_add_f32 v[146:147], v[146:147], 1.0 op_sel_hi:[1,0]
    v_pk_add_f32 v[148:149], v[148:149], 1.0 op_sel_hi:[1,0]
    v_pk_add_f32 v[150:151], v[150:151], 1.0 op_sel_hi:[1,0]
    v_rcp_f32 v144, v144
    v_rcp_f32 v145, v145
    v_rcp_f32 v146, v146
    v_rcp_f32 v147, v147
    v_pk_mul_f32 v[128:129], v[128:129], v[136:137]
    v_pk_mul_f32 v[130:131], v[130:131], v[138:139]
    v_rcp_f32 v148, v148
    v_rcp_f32 v149, v149
    v_rcp_f32 v150, v150
    v_rcp_f32 v151, v151
    v_pk_mul_f32 v[132:133], v[132:133], v[140:141]
    v_pk_mul_f32 v[134:135], v[134:135], v[142:143]
    v_pk_mul_f32 v[128:129], v[128:129], v[144:145]
    v_pk_mul_f32 v[130:131], v[130:131], v[146:147]
    v_cvt_pk_bf16_f32 v136, v128, v129
    v_cvt_pk_bf16_f32 v137, v130, v131
    ds_write_b64 v16, v[136:137] offset:0
    v_pk_mul_f32 v[132:133], v[132:133], v[148:149]
    v_pk_mul_f32 v[134:135], v[134:135], v[150:151]
    v_cvt_pk_bf16_f32 v140, v132, v133
    v_cvt_pk_bf16_f32 v141, v134, v135
    ds_write_b64 v16, v[140:141] offset:3584
L_aux_nohp:
    s_waitcnt lgkmcnt(0)
    s_barrier
    ds_read2st64_b64 v[96:99], v15 offset0:0 offset1:1
    ds_read2st64_b64 v[100:103], v15 offset0:2 offset1:3
    ds_read2st64_b64 v[104:107], v15 offset0:4 offset1:5
    ds_read2st64_b64 v[108:111], v15 offset0:6 offset1:7
    ds_read2st64_b64 v[112:115], v15 offset0:8 offset1:9
    ds_read2st64_b64 v[116:119], v15 offset0:10 offset1:11
    ds_read2st64_b64 v[120:123], v15 offset0:12 offset1:13
    s_waitcnt lgkmcnt(6)
    v_mfma_f32_16x16x32_bf16 v[32:35], v[64:67], v[96:99], 0
    s_waitcnt lgkmcnt(5)
    v_mfma_f32_16x16x32_bf16 v[32:35], v[68:71], v[100:103], v[32:35]
    s_waitcnt lgkmcnt(4)
    v_mfma_f32_16x16x32_bf16 v[32:35], v[72:75], v[104:107], v[32:35]
    s_waitcnt lgkmcnt(3)
    v_mfma_f32_16x16x32_bf16 v[32:35], v[76:79], v[108:111], v[32:35]
    s_waitcnt lgkmcnt(2)
    v_mfma_f32_16x16x32_bf16 v[32:35], v[80:83], v[112:115], v[32:35]
    s_waitcnt lgkmcnt(1)
    v_mfma_f32_16x16x32_bf16 v[32:35], v[84:87], v[116:119], v[32:35]
    s_waitcnt lgkmcnt(0)
    v_mfma_f32_16x16x32_bf16 v[32:35], v[88:91], v[120:123], v[32:35]
    s_nop 7
    v_mov_b32_dpp v36, v32 row_ror:8 row_mask:0xf bank_mask:0xf
    v_mov_b32_dpp v37, v33 row_ror:8 row_mask:0xf bank_mask:0xf
    v_mov_b32_dpp v38, v34 row_ror:8 row_mask:0xf bank_mask:0xf
    v_mov_b32_dpp v39, v35 row_ror:8 row_mask:0xf bank_mask:0xf
    v_permlane32_swap_b32 v36, v40
    v_permlane32_swap_b32 v37, v41
    v_permlane32_swap_b32 v38, v42
    v_permlane32_swap_b32 v39, v43
    v_pk_add_f32 v[32:33], v[32:33], v[40:41]
    v_pk_add_f32 v[34:35], v[34:35], v[42:43]
    v_and_or_b32 v32, v32, v245, s65
    v_and_or_b32 v33, v33, v245, s66
    v_and_or_b32 v34, v34, v245, s67
    v_and_or_b32 v35, v35, v245, s68
    s_mov_b64 exec, 0x00ff00ff
    buffer_store_dwordx4 v[32:35], v12, s[40:43], 0 offen sc1
    s_mov_b64 exec, -1
    s_lshl_b32 s6, s58, 3
    s_add_u32 s6, s6, s56
    s_cmp_lg_u32 s6, 632
    s_cbranch_scc1 L_aux_done
    v_lshlrev_b32 v21, 3, v1
    v_add_u32 v21, 2048, v21
    s_mov_b32 s11, 0
L_poll_ack:
    buffer_load_dwordx2 v[60:61], v21, s[40:43], 0 offen sc1
    s_waitcnt vmcnt(0)
    v_xor_b32 v14, s60, v60
    v_bitop3_b32 v14, v14, v61, s60 bitop3:0xf6
    v_cmp_ne_u32 vcc, 0, v14
    s_cbranch_vccz L_polled_ack
    s_add_u32 s11, s11, 1
    s_cmp_ge_u32 s11, 65536
    s_cbranch_scc1 L_polled_ack
    s_sleep 4
    s_branch L_poll_ack
L_polled_ack:
    v_mov_b32 v5, s60
    v_mov_b32 v4, 0
    s_mov_b64 exec, 1
    buffer_store_dword v5, v4, s[40:43], 0 offen sc1
L_aux_done:
    s_endpgm
L_aux_slow:
    s_waitcnt lgkmcnt(0)
    v_lshlrev_b32 v14, 5, v0
    v_add_u32 v14, 140432, v14
    ds_write_b128 v14, v[80:83]
    ds_write_b128 v14, v[84:87] offset:16
    s_mov_b64 exec, 1
    ds_add_u32 v22, v23 offset:256
    s_mov_b64 exec, -1
    s_cmp_ge_u32 s56, 2
    s_cbranch_scc1 L_aux_wd
    s_cmp_eq_u32 s56, 1
    s_cbranch_scc1 L_aux_nox
    s_mov_b32 s11, 0
L_lw_slow:
    ds_read_b32 v18, v22 offset:256
    s_add_u32 s11, s11, 1
    s_cmp_ge_u32 s11, 524288
    s_cbranch_scc1 L_lwx_slow
    s_waitcnt lgkmcnt(0)
    v_readfirstlane_b32 s8, v18
    s_cmp_ge_u32 s8, 4
    s_cbranch_scc1 L_lwx_slow
    s_branch L_lw_slow
L_lwx_slow:
    s_waitcnt lgkmcnt(0)
    v_lshlrev_b32 v14, 4, v1
    v_add_u32 v14, 140432, v14
    ds_read_b128 v[128:131], v14 offset:0
    ds_read_b128 v[132:135], v14 offset:1024
    ds_read_b128 v[136:139], v14 offset:2048
    ds_read_b128 v[140:143], v14 offset:3072
    ds_read_b128 v[144:147], v14 offset:4096
    ds_read_b128 v[148:151], v14 offset:5120
    ds_read_b128 v[152:155], v14 offset:6144
    ds_read_b128 v[156:159], v14 offset:7168
    s_waitcnt lgkmcnt(0)
    s_mov_b32 s8, 0
    v_mov_b32 v20, v1
    v_mov_b32 v17, 1
L_aux_slow2:
    v_max3_u32 v14, v128, v129, v130
    v_max3_u32 v14, v14, v131, v132
    v_max3_u32 v14, v14, v133, v134
    v_max3_u32 v14, v14, v135, v136
    v_max3_u32 v14, v14, v137, v138
    v_max3_u32 v14, v14, v139, v140
    v_max3_u32 v14, v14, v141, v142
    v_max3_u32 v14, v14, v143, v144
    v_max3_u32 v14, v14, v145, v146
    v_max3_u32 v14, v14, v147, v148
    v_max3_u32 v14, v14, v149, v150
    v_max3_u32 v14, v14, v151, v152
    v_max3_u32 v14, v14, v153, v154
    v_max3_u32 v14, v14, v155, v156
    v_max3_u32 v14, v14, v157, v158
    v_max_u32 v14, v14, v159
    s_nop 1
    v_max_u32_dpp v14, v14, v14 row_ror:8 row_mask:0xf bank_mask:0xf
    s_nop 1
    v_max_u32_dpp v14, v14, v14 row_ror:4 row_mask:0xf bank_mask:0xf
    s_nop 1
    v_max_u32_dpp v14, v14, v14 row_ror:2 row_mask:0xf bank_mask:0xf
    s_nop 1
    v_max_u32_dpp v14, v14, v14 row_ror:1 row_mask:0xf bank_mask:0xf
    v_mov_b32 v15, v14
    s_nop 1
    v_permlane16_swap_b32 v14, v15
    v_max_u32 v14, v14, v15
    v_mov_b32 v15, v14
    s_nop 1
    v_permlane32_swap_b32 v14, v15
    v_max_u32 v14, v14, v15
    v_cmp_eq_u32 vcc, s8, v20
    s_nop 1
    v_cndmask_b32 v17, v17, v14, vcc
    v_cmp_ne_u32 vcc, v14, v128
    s_nop 1
    v_cndmask_b32 v128, 0, v128, vcc
    v_cmp_ne_u32 vcc, v14, v129
    s_nop 1
    v_cndmask_b32 v129, 0, v129, vcc
    v_cmp_ne_u32 vcc, v14, v130
    s_nop 1
    v_cndmask_b32 v130, 0, v130, vcc
    v_cmp_ne_u32 vcc, v14, v131
    s_nop 1
    v_cndmask_b32 v131, 0, v131, vcc
    v_cmp_ne_u32 vcc, v14, v132
    s_nop 1
    v_cndmask_b32 v132, 0, v132, vcc
    v_cmp_ne_u32 vcc, v14, v133
    s_nop 1
    v_cndmask_b32 v133, 0, v133, vcc
    v_cmp_ne_u32 vcc, v14, v134
    s_nop 1
    v_cndmask_b32 v134, 0, v134, vcc
    v_cmp_ne_u32 vcc, v14, v135
    s_nop 1
    v_cndmask_b32 v135, 0, v135, vcc
    v_cmp_ne_u32 vcc, v14, v136
    s_nop 1
    v_cndmask_b32 v136, 0, v136, vcc
    v_cmp_ne_u32 vcc, v14, v137
    s_nop 1
    v_cndmask_b32 v137, 0, v137, vcc
    v_cmp_ne_u32 vcc, v14, v138
    s_nop 1
    v_cndmask_b32 v138, 0, v138, vcc
    v_cmp_ne_u32 vcc, v14, v139
    s_nop 1
    v_cndmask_b32 v139, 0, v139, vcc
    v_cmp_ne_u32 vcc, v14, v140
    s_nop 1
    v_cndmask_b32 v140, 0, v140, vcc
    v_cmp_ne_u32 vcc, v14, v141
    s_nop 1
    v_cndmask_b32 v141, 0, v141, vcc
    v_cmp_ne_u32 vcc, v14, v142
    s_nop 1
    v_cndmask_b32 v142, 0, v142, vcc
    v_cmp_ne_u32 vcc, v14, v143
    s_nop 1
    v_cndmask_b32 v143, 0, v143, vcc
    v_cmp_ne_u32 vcc, v14, v144
    s_nop 1
    v_cndmask_b32 v144, 0, v144, vcc
    v_cmp_ne_u32 vcc, v14, v145
    s_nop 1
    v_cndmask_b32 v145, 0, v145, vcc
    v_cmp_ne_u32 vcc, v14, v146
    s_nop 1
    v_cndmask_b32 v146, 0, v146, vcc
    v_cmp_ne_u32 vcc, v14, v147
    s_nop 1
    v_cndmask_b32 v147, 0, v147, vcc
    v_cmp_ne_u32 vcc, v14, v148
    s_nop 1
    v_cndmask_b32 v148, 0, v148, vcc
    v_cmp_ne_u32 vcc, v14, v149
    s_nop 1
    v_cndmask_b32 v149, 0, v149, vcc
    v_cmp_ne_u32 vcc, v14, v150
    s_nop 1
    v_cndmask_b32 v150, 0, v150, vcc
    v_cmp_ne_u32 vcc, v14, v151
    s_nop 1
    v_cndmask_b32 v151, 0, v151, vcc
    v_cmp_ne_u32 vcc, v14, v152
    s_nop 1
    v_cndmask_b32 v152, 0, v152, vcc
    v_cmp_ne_u32 vcc, v14, v153
    s_nop 1
    v_cndmask_b32 v153, 0, v153, vcc
    v_cmp_ne_u32 vcc, v14, v154
    s_nop 1
    v_cndmask_b32 v154, 0, v154, vcc
    v_cmp_ne_u32 vcc, v14, v155
    s_nop 1
    v_cndmask_b32 v155, 0, v155, vcc
    v_cmp_ne_u32 vcc, v14, v156
    s_nop 1
    v_cndmask_b32 v156, 0, v156, vcc
    v_cmp_ne_u32 vcc, v14, v157
    s_nop 1
    v_cndmask_b32 v157, 0, v157, vcc
    v_cmp_ne_u32 vcc, v14, v158
    s_nop 1
    v_cndmask_b32 v158, 0, v158, vcc
    v_cmp_ne_u32 vcc, v14, v159
    s_nop 1
    v_cndmask_b32 v159, 0, v159, vcc
    s_add_u32 s8, s8, 1
    s_cmp_lt_u32 s8, 8
    s_cbranch_scc1 L_aux_slow2
    v_and_b32 v60, 0xfff, v17
    v_sub_u32 v60, 0x800, v60
    v_lshlrev_b32 v15, 2, v60
    ds_read_b32 v62, v15
    v_and_b32 v14, 0xffff0000, v17
    v_ashrrev_i32 v15, 31, v14
    v_not_b32 v15, v15
    v_or_b32 v15, 0x80000000, v15
    v_xor_b32 v14, v14, v15
    v_and_b32 v14, 0xffff0000, v14
    v_mul_f32 v14, 0xbfb8aa3b, v14
    v_exp_f32 v14, v14
    v_mov_b32 v63, s60
    v_add_f32 v14, 1.0, v14
    v_rcp_f32 v14, v14
    s_branch L_aux_sel
L_exit:
    s_endpgm
.p2align 6
L_conv:
    v_and_b32 v2, 15, v0
    v_bfe_u32 v3, v0, 4, 2
    s_getpc_b64 s[36:37]
L_pc_band:
    s_add_u32 s36, s36, L_bands-L_pc_band
    s_addc_u32 s37, s37, 0
    s_mov_b32 s38, 5120
    s_mov_b32 s39, 0x00020000
    v_lshlrev_b32 v10, 4, v1
    s_mov_b32 s53, 4096
    buffer_load_dwordx4 v[128:131], v10, s[36:39], 0 offen offset:0
    buffer_load_dwordx4 v[132:135], v10, s[36:39], 0 offen offset:1024
    buffer_load_dwordx4 v[136:139], v10, s[36:39], 0 offen offset:2048
    buffer_load_dwordx4 v[140:143], v10, s[36:39], 0 offen offset:3072
    buffer_load_dwordx4 v[124:127], v10, s[36:39], s53 offen
    s_mov_b64 s[36:37], s[4:5]
    s_mov_b32 s38, 4194304
    s_mov_b32 s39, 0x00020000
    s_mov_b64 s[40:41], s[34:35]
    s_mov_b32 s42, 753664
    s_mov_b32 s43, 0x00020000
    s_mov_b64 s[44:45], s[30:31]
    s_mov_b32 s46, 4194304
    s_mov_b32 s47, 0x00020000
    s_mov_b32 s48, 0x3fb8aa3b
    s_mov_b32 s49, 0x32a57060
    s_lshl_b32 s58, s57, 4
    v_lshlrev_b32 v9, 14, v0
    v_add_u32 v9, s58, v9
    s_lshl_b32 s6, s3, 7
    s_lshl_b32 s7, s56, 4
    s_add_u32 s6, s6, s7
    s_lshl_b32 s6, s6, 11
    s_lshl_b32 s7, s59, 8
    s_add_u32 s6, s6, s7
    v_lshrrev_b32 v11, 1, v1
    v_lshlrev_b32 v11, 11, v11
    v_and_b32 v10, 1, v1
    v_lshl_add_u32 v11, v10, 7, v11
    v_add_u32 v11, s6, v11
    s_mul_i32 s6, s56, 3072
    s_add_u32 s6, s6, 67584
    s_mul_i32 s7, s56, 4608
    s_add_u32 s7, s7, 92160
    v_mov_b32 v64, 0
    v_mov_b32 v65, 0
    v_mov_b32 v66, 0
    v_mov_b32 v67, 0
    v_lshl_add_u32 v10, v1, 4, s6
    ds_write_b128 v10, v[64:67] offset:0
    ds_write_b128 v10, v[64:67] offset:1024
    ds_write_b128 v10, v[64:67] offset:2048
    v_lshl_add_u32 v10, v1, 3, s7
    ds_write_b64 v10, v[64:65]
    v_lshlrev_b32 v10, 5, v2
    v_lshl_add_u32 v160, v3, 9, v10
    v_add_u32 v160, s6, v160
    v_add_u32 v160, 1084, v160
    v_and_b32 v12, 1, v3
    v_lshl_add_u32 v161, v12, 4, v10
    v_lshrrev_b32 v12, 1, v3
    v_lshl_add_u32 v161, v12, 9, v161
    v_add3_u32 v161, v161, s6, 64
    v_and_b32 v12, 1, v2
    v_lshrrev_b32 v13, 1, v2
    v_lshlrev_b32 v162, 2, v13
    v_lshl_add_u32 v162, v3, 6, v162
    v_mul_u32_u24 v13, 260, v12
    v_add3_u32 v162, v162, v13, s6
    v_add_u32 v162, 2172, v162
    v_lshlrev_b32 v163, 1, v2
    v_lshl_add_u32 v163, v3, 7, v163
    v_lshl_add_u32 v163, v12, 2, v163
    v_add_u32 v163, s6, v163
    v_add_u32 v163, 2812, v163
    v_mov_b32 v164, v163
    s_add_u32 s54, s6, 2428
    v_writelane_b32 v164, s54, 0
    v_lshl_add_u32 v10, v2, 2, s6
    v_lshlrev_b32 v12, 5, v3
    v_sub_u32 v165, v10, v12
    v_add_u32 v165, 104, v165
    v_add_u32 v166, 1024, v165
    v_add_u32 v167, 2048, v165
    v_lshlrev_b32 v12, 4, v3
    v_sub_u32 v168, v10, v12
    v_add_u32 v168, 2292, v168
    v_mov_b32 v169, 0
    v_writelane_b32 v169, -1, 0
    s_mov_b32 s62, 0
    s_mov_b32 s63, 1
    s_mul_i32 s8, s56, 8448
    s_mov_b32 m0, s8
    v_bfe_u32 v10, v0, 2, 2
    v_mul_u32_u24 v10, 4160, v10
    v_lshrrev_b32 v12, 4, v0
    v_lshl_add_u32 v10, v12, 5, v10
    v_and_b32 v12, 3, v0
    v_lshl_add_u32 v10, v12, 3, v10
    v_add_u32 v4, 129024, v10
    v_lshlrev_b32 v10, 11, v0
    v_add_u32 v174, s58, v10
    v_lshlrev_b32 v10, 4, v0
    v_add_u32 v121, 92672, v10
    v_add_u32 v123, 129024, v10
    v_add_u32 v122, 4096, v10
    v_lshrrev_b32 v10, 3, v1
    v_lshlrev_b32 v10, 4, v10
    v_add_u32 v171, 24576, v10
    s_mov_b32 s66, 8192
    s_mov_b32 s67, 12288
    s_mov_b32 s50, 0x100000
    s_mov_b32 s51, 0x200000
    s_mov_b32 s64, 0x05040100
    s_mov_b32 s65, 0x07060302
    v_lshl_add_u32 v5, v1, 3, s8
    v_mul_u32_u24 v6, 528, v2
    v_and_b32 v10, 1, v3
    v_lshl_add_u32 v6, v10, 8, v6
    v_lshrrev_b32 v10, 1, v3
    v_lshl_add_u32 v6, v10, 4, v6
    v_add_u32 v6, s8, v6
    v_lshlrev_b32 v10, 5, v2
    v_lshl_add_u32 v7, v3, 4, v10
    v_add3_u32 v7, v7, s7, 32
    s_mul_i32 s8, s56, 4160
    s_add_u32 s8, s8, 129024
    v_lshl_add_u32 v8, v3, 3, v10
    v_add_u32 v8, s8, v8
    s_waitcnt vmcnt(6)
L_conv_kg:
    s_mov_b32 exec_hi, 0
    buffer_load_dword v170, v11, s[36:39], 0 offen
    s_mov_b32 exec_hi, -1
    v_lshlrev_b32 v15, 16, v15
    v_lshlrev_b32 v116, 16, v16
    v_and_b32 v117, 0xffff0000, v16
    v_mul_f32 v112, s48, v15
    v_mul_f32 v116, s48, v116
    v_fma_f32 v113, v15, s48, -v112
    v_mul_f32 v117, s48, v117
    v_fma_f32 v113, v15, s49, v113
    v_exp_f32 v76, v112
    v_exp_f32 v72, v116
    v_mul_f32 v113, 0x3f317218, v113
    v_exp_f32 v73, v117
    v_fma_f32 v76, v76, v113, v76
    v_lshlrev_b32 v74, 16, v17
    v_and_b32 v75, 0xffff0000, v17
    v_cvt_pk_bf16_f32 v76, v76, v76
    v_cvt_pk_bf16_f32 v64, v72, v73
    v_and_b32 v76, 0xffff0000, v76
    v_lshlrev_b32 v72, 16, v64
    v_and_b32 v73, 0xffff0000, v64
    v_pk_mul_f32 v[74:75], v[74:75], v[76:77] op_sel_hi:[1,0]
    v_pk_mul_f32 v[72:73], v[72:73], v[76:77] op_sel_hi:[1,0]
    v_mul_f32 v74, 0.15915494, v74
    v_mul_f32 v72, 0xbfb8aa3b, v72
    v_mul_f32 v75, 0.15915494, v75
    v_mul_f32 v73, 0xbfb8aa3b, v73
    v_mul_f32 v112, 0x41000000, v72
    v_mul_f32 v113, 0x41000000, v74
    v_mul_f32 v114, 0x41000000, v73
    v_mul_f32 v115, 0x41000000, v75
    v_exp_f32 v112, v112
    v_fract_f32 v113, v113
    v_exp_f32 v114, v114
    v_fract_f32 v115, v115
    v_cos_f32 v24, v113
    v_sin_f32 v25, v113
    v_cos_f32 v26, v115
    v_sin_f32 v27, v115
    v_pk_mul_f32 v[24:25], v[24:25], v[112:113] op_sel:[0,0] op_sel_hi:[1,0] neg_hi:[1,0]
    v_pk_mul_f32 v[26:27], v[26:27], v[114:115] op_sel:[0,0] op_sel_hi:[1,0] neg_hi:[1,0]
    v_lshlrev_b32 v120, 16, v14
    v_mov_b32 v68, 0x3f80
    v_mov_b32 v69, 0x3f80
    ds_write_addtid_b32 v68 offset:0
    ds_write_addtid_b32 v69 offset:256
    v_cvt_pk_bf16_f32 v70, v24, v25
    v_cvt_pk_bf16_f32 v71, v26, v27
    ds_write_addtid_b32 v70 offset:528
    ds_write_addtid_b32 v71 offset:784
    v_pk_mul_f32 v[64:65], v[24:25], v[24:25] op_sel:[1,1] op_sel_hi:[1,0] neg_lo:[1,0]
    v_pk_mul_f32 v[66:67], v[26:27], v[26:27] op_sel:[1,1] op_sel_hi:[1,0] neg_lo:[1,0]
    v_pk_fma_f32 v[12:13], v[24:25], v[24:25], v[64:65] op_sel:[0,0,0] op_sel_hi:[0,1,1]
    v_pk_fma_f32 v[14:15], v[26:27], v[26:27], v[66:67] op_sel:[0,0,0] op_sel_hi:[0,1,1]
    v_cvt_pk_bf16_f32 v68, v12, v13
    v_cvt_pk_bf16_f32 v69, v14, v15
    ds_write_addtid_b32 v68 offset:1056
    ds_write_addtid_b32 v69 offset:1312
    v_pk_mul_f32 v[64:65], v[12:13], v[24:25] op_sel:[1,1] op_sel_hi:[1,0] neg_lo:[1,0]
    v_pk_mul_f32 v[66:67], v[14:15], v[26:27] op_sel:[1,1] op_sel_hi:[1,0] neg_lo:[1,0]
    v_pk_fma_f32 v[12:13], v[12:13], v[24:25], v[64:65] op_sel:[0,0,0] op_sel_hi:[0,1,1]
    v_pk_fma_f32 v[14:15], v[14:15], v[26:27], v[66:67] op_sel:[0,0,0] op_sel_hi:[0,1,1]
    v_cvt_pk_bf16_f32 v70, v12, v13
    v_cvt_pk_bf16_f32 v71, v14, v15
    ds_write_addtid_b32 v70 offset:1584
    ds_write_addtid_b32 v71 offset:1840
    v_add_f32 v77, v76, v76
    v_add_f32 v120, 1.0, v120
    v_lshlrev_b32 v32, 16, v18
    v_pk_mul_f32 v[64:65], v[12:13], v[24:25] op_sel:[1,1] op_sel_hi:[1,0] neg_lo:[1,0]
    v_pk_mul_f32 v[66:67], v[14:15], v[26:27] op_sel:[1,1] op_sel_hi:[1,0] neg_lo:[1,0]
    v_pk_fma_f32 v[12:13], v[12:13], v[24:25], v[64:65] op_sel:[0,0,0] op_sel_hi:[0,1,1]
    v_pk_fma_f32 v[14:15], v[14:15], v[26:27], v[66:67] op_sel:[0,0,0] op_sel_hi:[0,1,1]
    v_cvt_pk_bf16_f32 v68, v12, v13
    v_cvt_pk_bf16_f32 v69, v14, v15
    ds_write_addtid_b32 v68 offset:2112
    ds_write_addtid_b32 v69 offset:2368
    v_lshlrev_b32 v33, 16, v19
    v_and_b32 v34, 0xffff0000, v18
    v_and_b32 v35, 0xffff0000, v19
    v_pk_mul_f32 v[64:65], v[12:13], v[24:25] op_sel:[1,1] op_sel_hi:[1,0] neg_lo:[1,0]
    v_pk_mul_f32 v[66:67], v[14:15], v[26:27] op_sel:[1,1] op_sel_hi:[1,0] neg_lo:[1,0]
    v_pk_fma_f32 v[12:13], v[12:13], v[24:25], v[64:65] op_sel:[0,0,0] op_sel_hi:[0,1,1]
    v_pk_fma_f32 v[14:15], v[14:15], v[26:27], v[66:67] op_sel:[0,0,0] op_sel_hi:[0,1,1]
    v_cvt_pk_bf16_f32 v70, v12, v13
    v_cvt_pk_bf16_f32 v71, v14, v15
    ds_write_addtid_b32 v70 offset:2640
    ds_write_addtid_b32 v71 offset:2896
    v_and_b32 v169, v169, v120
    v_pk_mul_f32 v[32:33], v[32:33], v[76:77] op_sel:[0,1] op_sel_hi:[1,1]
    v_pk_mul_f32 v[34:35], v[34:35], v[76:77] op_sel:[0,1] op_sel_hi:[1,1]
    v_pk_mul_f32 v[64:65], v[12:13], v[24:25] op_sel:[1,1] op_sel_hi:[1,0] neg_lo:[1,0]
    v_pk_mul_f32 v[66:67], v[14:15], v[26:27] op_sel:[1,1] op_sel_hi:[1,0] neg_lo:[1,0]
    v_pk_fma_f32 v[12:13], v[12:13], v[24:25], v[64:65] op_sel:[0,0,0] op_sel_hi:[0,1,1]
    v_pk_fma_f32 v[14:15], v[14:15], v[26:27], v[66:67] op_sel:[0,0,0] op_sel_hi:[0,1,1]
    v_cvt_pk_bf16_f32 v68, v12, v13
    v_cvt_pk_bf16_f32 v69, v14, v15
    ds_write_addtid_b32 v68 offset:3168
    ds_write_addtid_b32 v69 offset:3424
    v_exp_f32 v112, v72
    v_fract_f32 v113, v74
    v_exp_f32 v114, v73
    v_pk_mul_f32 v[64:65], v[12:13], v[24:25] op_sel:[1,1] op_sel_hi:[1,0] neg_lo:[1,0]
    v_pk_mul_f32 v[66:67], v[14:15], v[26:27] op_sel:[1,1] op_sel_hi:[1,0] neg_lo:[1,0]
    v_pk_fma_f32 v[12:13], v[12:13], v[24:25], v[64:65] op_sel:[0,0,0] op_sel_hi:[0,1,1]
    v_pk_fma_f32 v[14:15], v[14:15], v[26:27], v[66:67] op_sel:[0,0,0] op_sel_hi:[0,1,1]
    v_cvt_pk_bf16_f32 v70, v12, v13
    v_cvt_pk_bf16_f32 v71, v14, v15
    ds_write_addtid_b32 v70 offset:3696
    ds_write_addtid_b32 v71 offset:3952
    v_fract_f32 v115, v75
    v_cos_f32 v20, v113
    v_sin_f32 v21, v113
    v_pk_mul_f32 v[64:65], v[12:13], v[24:25] op_sel:[1,1] op_sel_hi:[1,0] neg_lo:[1,0]
    v_pk_mul_f32 v[66:67], v[14:15], v[26:27] op_sel:[1,1] op_sel_hi:[1,0] neg_lo:[1,0]
    v_pk_fma_f32 v[12:13], v[12:13], v[24:25], v[64:65] op_sel:[0,0,0] op_sel_hi:[0,1,1]
    v_pk_fma_f32 v[14:15], v[14:15], v[26:27], v[66:67] op_sel:[0,0,0] op_sel_hi:[0,1,1]
    v_cvt_pk_bf16_f32 v68, v12, v13
    v_cvt_pk_bf16_f32 v69, v14, v15
    ds_write_addtid_b32 v68 offset:4224
    ds_write_addtid_b32 v69 offset:4480
    v_cos_f32 v22, v115
    v_sin_f32 v23, v115
    v_pk_mul_f32 v[20:21], v[20:21], v[112:113] op_sel:[0,0] op_sel_hi:[1,0]
    v_pk_mul_f32 v[64:65], v[12:13], v[24:25] op_sel:[1,1] op_sel_hi:[1,0] neg_lo:[1,0]
    v_pk_mul_f32 v[66:67], v[14:15], v[26:27] op_sel:[1,1] op_sel_hi:[1,0] neg_lo:[1,0]
    v_pk_fma_f32 v[12:13], v[12:13], v[24:25], v[64:65] op_sel:[0,0,0] op_sel_hi:[0,1,1]
    v_pk_fma_f32 v[14:15], v[14:15], v[26:27], v[66:67] op_sel:[0,0,0] op_sel_hi:[0,1,1]
    v_cvt_pk_bf16_f32 v70, v12, v13
    v_cvt_pk_bf16_f32 v71, v14, v15
    ds_write_addtid_b32 v70 offset:4752
    ds_write_addtid_b32 v71 offset:5008
    v_pk_mul_f32 v[22:23], v[22:23], v[114:115] op_sel:[0,0] op_sel_hi:[1,0]
    v_mul_f32 v112, 0x43000000, v72
    v_mul_f32 v113, 0x43000000, v74
    v_pk_mul_f32 v[64:65], v[12:13], v[24:25] op_sel:[1,1] op_sel_hi:[1,0] neg_lo:[1,0]
    v_pk_mul_f32 v[66:67], v[14:15], v[26:27] op_sel:[1,1] op_sel_hi:[1,0] neg_lo:[1,0]
    v_pk_fma_f32 v[12:13], v[12:13], v[24:25], v[64:65] op_sel:[0,0,0] op_sel_hi:[0,1,1]
    v_pk_fma_f32 v[14:15], v[14:15], v[26:27], v[66:67] op_sel:[0,0,0] op_sel_hi:[0,1,1]
    v_cvt_pk_bf16_f32 v68, v12, v13
    v_cvt_pk_bf16_f32 v69, v14, v15
    ds_write_addtid_b32 v68 offset:5280
    ds_write_addtid_b32 v69 offset:5536
    v_mul_f32 v114, 0x43000000, v73
    v_mul_f32 v115, 0x43000000, v75
    v_exp_f32 v112, v112
    v_pk_mul_f32 v[64:65], v[12:13], v[24:25] op_sel:[1,1] op_sel_hi:[1,0] neg_lo:[1,0]
    v_pk_mul_f32 v[66:67], v[14:15], v[26:27] op_sel:[1,1] op_sel_hi:[1,0] neg_lo:[1,0]
    v_pk_fma_f32 v[12:13], v[12:13], v[24:25], v[64:65] op_sel:[0,0,0] op_sel_hi:[0,1,1]
    v_pk_fma_f32 v[14:15], v[14:15], v[26:27], v[66:67] op_sel:[0,0,0] op_sel_hi:[0,1,1]
    v_cvt_pk_bf16_f32 v70, v12, v13
    v_cvt_pk_bf16_f32 v71, v14, v15
    ds_write_addtid_b32 v70 offset:5808
    ds_write_addtid_b32 v71 offset:6064
    v_fract_f32 v113, v113
    v_exp_f32 v114, v114
    v_fract_f32 v115, v115
    v_pk_mul_f32 v[64:65], v[12:13], v[24:25] op_sel:[1,1] op_sel_hi:[1,0] neg_lo:[1,0]
    v_pk_mul_f32 v[66:67], v[14:15], v[26:27] op_sel:[1,1] op_sel_hi:[1,0] neg_lo:[1,0]
    v_pk_fma_f32 v[12:13], v[12:13], v[24:25], v[64:65] op_sel:[0,0,0] op_sel_hi:[0,1,1]
    v_pk_fma_f32 v[14:15], v[14:15], v[26:27], v[66:67] op_sel:[0,0,0] op_sel_hi:[0,1,1]
    v_cvt_pk_bf16_f32 v68, v12, v13
    v_cvt_pk_bf16_f32 v69, v14, v15
    ds_write_addtid_b32 v68 offset:6336
    ds_write_addtid_b32 v69 offset:6592
    v_cos_f32 v28, v113
    v_sin_f32 v29, v113
    v_cos_f32 v30, v115
    v_pk_mul_f32 v[64:65], v[12:13], v[24:25] op_sel:[1,1] op_sel_hi:[1,0] neg_lo:[1,0]
    v_pk_mul_f32 v[66:67], v[14:15], v[26:27] op_sel:[1,1] op_sel_hi:[1,0] neg_lo:[1,0]
    v_pk_fma_f32 v[12:13], v[12:13], v[24:25], v[64:65] op_sel:[0,0,0] op_sel_hi:[0,1,1]
    v_pk_fma_f32 v[14:15], v[14:15], v[26:27], v[66:67] op_sel:[0,0,0] op_sel_hi:[0,1,1]
    v_cvt_pk_bf16_f32 v70, v12, v13
    v_cvt_pk_bf16_f32 v71, v14, v15
    ds_write_addtid_b32 v70 offset:6864
    ds_write_addtid_b32 v71 offset:7120
    v_sin_f32 v31, v115
    v_pk_mul_f32 v[28:29], v[28:29], v[112:113] op_sel:[0,0] op_sel_hi:[1,0]
    v_pk_mul_f32 v[30:31], v[30:31], v[114:115] op_sel:[0,0] op_sel_hi:[1,0]
    v_pk_mul_f32 v[64:65], v[12:13], v[24:25] op_sel:[1,1] op_sel_hi:[1,0] neg_lo:[1,0]
    v_pk_mul_f32 v[66:67], v[14:15], v[26:27] op_sel:[1,1] op_sel_hi:[1,0] neg_lo:[1,0]
    v_pk_fma_f32 v[12:13], v[12:13], v[24:25], v[64:65] op_sel:[0,0,0] op_sel_hi:[0,1,1]
    v_pk_fma_f32 v[14:15], v[14:15], v[26:27], v[66:67] op_sel:[0,0,0] op_sel_hi:[0,1,1]
    v_cvt_pk_bf16_f32 v68, v12, v13
    v_cvt_pk_bf16_f32 v69, v14, v15
    ds_write_addtid_b32 v68 offset:7392
    ds_write_addtid_b32 v69 offset:7648
    v_pk_mul_f32 v[64:65], v[12:13], v[24:25] op_sel:[1,1] op_sel_hi:[1,0] neg_lo:[1,0]
    v_pk_mul_f32 v[66:67], v[14:15], v[26:27] op_sel:[1,1] op_sel_hi:[1,0] neg_lo:[1,0]
    v_pk_fma_f32 v[12:13], v[12:13], v[24:25], v[64:65] op_sel:[0,0,0] op_sel_hi:[0,1,1]
    v_pk_fma_f32 v[14:15], v[14:15], v[26:27], v[66:67] op_sel:[0,0,0] op_sel_hi:[0,1,1]
    v_cvt_pk_bf16_f32 v70, v12, v13
    v_cvt_pk_bf16_f32 v71, v14, v15
    ds_write_addtid_b32 v70 offset:7920
    ds_write_addtid_b32 v71 offset:8176
    ds_read_b128 v[80:83], v6 offset:0
    ds_read_b128 v[84:87], v6 offset:32
    ds_read_b128 v[88:91], v6 offset:64
    ds_read_b128 v[92:95], v6 offset:96
    ds_read_b128 v[96:99], v6 offset:128
    ds_read_b128 v[100:103], v6 offset:160
    ds_read_b128 v[104:107], v6 offset:192
    ds_read_b128 v[108:111], v6 offset:224
    v_cvt_pk_bf16_f32 v68, v32, v33
    v_cvt_pk_bf16_f32 v69, v34, v35
    ds_write_addtid_b32 v68 offset:0
    ds_write_addtid_b32 v69 offset:256
    v_pk_mul_f32 v[64:65], v[32:33], v[20:21] op_sel:[1,1] op_sel_hi:[1,0] neg_lo:[1,0]
    v_pk_mul_f32 v[66:67], v[34:35], v[22:23] op_sel:[1,1] op_sel_hi:[1,0] neg_lo:[1,0]
    v_pk_fma_f32 v[36:37], v[32:33], v[20:21], v[64:65] op_sel:[0,0,0] op_sel_hi:[0,1,1]
    v_pk_fma_f32 v[38:39], v[34:35], v[22:23], v[66:67] op_sel:[0,0,0] op_sel_hi:[0,1,1]
    v_cvt_pk_bf16_f32 v70, v36, v37
    v_cvt_pk_bf16_f32 v71, v38, v39
    ds_write_addtid_b32 v70 offset:528
    ds_write_addtid_b32 v71 offset:784
    v_pk_mul_f32 v[64:65], v[36:37], v[20:21] op_sel:[1,1] op_sel_hi:[1,0] neg_lo:[1,0]
    v_pk_mul_f32 v[66:67], v[38:39], v[22:23] op_sel:[1,1] op_sel_hi:[1,0] neg_lo:[1,0]
    v_pk_fma_f32 v[40:41], v[36:37], v[20:21], v[64:65] op_sel:[0,0,0] op_sel_hi:[0,1,1]
    v_pk_fma_f32 v[42:43], v[38:39], v[22:23], v[66:67] op_sel:[0,0,0] op_sel_hi:[0,1,1]
    v_cvt_pk_bf16_f32 v68, v40, v41
    v_cvt_pk_bf16_f32 v69, v42, v43
    ds_write_addtid_b32 v68 offset:1056
    ds_write_addtid_b32 v69 offset:1312
    v_pk_mul_f32 v[64:65], v[40:41], v[20:21] op_sel:[1,1] op_sel_hi:[1,0] neg_lo:[1,0]
    v_pk_mul_f32 v[66:67], v[42:43], v[22:23] op_sel:[1,1] op_sel_hi:[1,0] neg_lo:[1,0]
    v_pk_fma_f32 v[44:45], v[40:41], v[20:21], v[64:65] op_sel:[0,0,0] op_sel_hi:[0,1,1]
    v_pk_fma_f32 v[46:47], v[42:43], v[22:23], v[66:67] op_sel:[0,0,0] op_sel_hi:[0,1,1]
    v_cvt_pk_bf16_f32 v70, v44, v45
    v_cvt_pk_bf16_f32 v71, v46, v47
    ds_write_addtid_b32 v70 offset:1584
    ds_write_addtid_b32 v71 offset:1840
    v_pk_mul_f32 v[64:65], v[44:45], v[20:21] op_sel:[1,1] op_sel_hi:[1,0] neg_lo:[1,0]
    v_pk_mul_f32 v[66:67], v[46:47], v[22:23] op_sel:[1,1] op_sel_hi:[1,0] neg_lo:[1,0]
    v_pk_fma_f32 v[48:49], v[44:45], v[20:21], v[64:65] op_sel:[0,0,0] op_sel_hi:[0,1,1]
    v_pk_fma_f32 v[50:51], v[46:47], v[22:23], v[66:67] op_sel:[0,0,0] op_sel_hi:[0,1,1]
    v_cvt_pk_bf16_f32 v68, v48, v49
    v_cvt_pk_bf16_f32 v69, v50, v51
    ds_write_addtid_b32 v68 offset:2112
    ds_write_addtid_b32 v69 offset:2368
    v_pk_mul_f32 v[64:65], v[48:49], v[20:21] op_sel:[1,1] op_sel_hi:[1,0] neg_lo:[1,0]
    v_pk_mul_f32 v[66:67], v[50:51], v[22:23] op_sel:[1,1] op_sel_hi:[1,0] neg_lo:[1,0]
    v_pk_fma_f32 v[52:53], v[48:49], v[20:21], v[64:65] op_sel:[0,0,0] op_sel_hi:[0,1,1]
    v_pk_fma_f32 v[54:55], v[50:51], v[22:23], v[66:67] op_sel:[0,0,0] op_sel_hi:[0,1,1]
    v_cvt_pk_bf16_f32 v70, v52, v53
    v_cvt_pk_bf16_f32 v71, v54, v55
    ds_write_addtid_b32 v70 offset:2640
    ds_write_addtid_b32 v71 offset:2896
    v_pk_mul_f32 v[64:65], v[52:53], v[20:21] op_sel:[1,1] op_sel_hi:[1,0] neg_lo:[1,0]
    v_pk_mul_f32 v[66:67], v[54:55], v[22:23] op_sel:[1,1] op_sel_hi:[1,0] neg_lo:[1,0]
    v_pk_fma_f32 v[56:57], v[52:53], v[20:21], v[64:65] op_sel:[0,0,0] op_sel_hi:[0,1,1]
    v_pk_fma_f32 v[58:59], v[54:55], v[22:23], v[66:67] op_sel:[0,0,0] op_sel_hi:[0,1,1]
    v_cvt_pk_bf16_f32 v68, v56, v57
    v_cvt_pk_bf16_f32 v69, v58, v59
    ds_write_addtid_b32 v68 offset:3168
    ds_write_addtid_b32 v69 offset:3424
    v_pk_mul_f32 v[64:65], v[56:57], v[20:21] op_sel:[1,1] op_sel_hi:[1,0] neg_lo:[1,0]
    v_pk_mul_f32 v[66:67], v[58:59], v[22:23] op_sel:[1,1] op_sel_hi:[1,0] neg_lo:[1,0]
    v_pk_fma_f32 v[60:61], v[56:57], v[20:21], v[64:65] op_sel:[0,0,0] op_sel_hi:[0,1,1]
    v_pk_fma_f32 v[62:63], v[58:59], v[22:23], v[66:67] op_sel:[0,0,0] op_sel_hi:[0,1,1]
    v_cvt_pk_bf16_f32 v70, v60, v61
    v_cvt_pk_bf16_f32 v71, v62, v63
    ds_write_addtid_b32 v70 offset:3696
    ds_write_addtid_b32 v71 offset:3952
    v_pk_mul_f32 v[64:65], v[32:33], v[28:29] op_sel:[1,1] op_sel_hi:[1,0] neg_lo:[1,0]
    v_pk_mul_f32 v[66:67], v[34:35], v[30:31] op_sel:[1,1] op_sel_hi:[1,0] neg_lo:[1,0]
    v_pk_fma_f32 v[32:33], v[32:33], v[28:29], v[64:65] op_sel:[0,0,0] op_sel_hi:[0,1,1]
    v_pk_fma_f32 v[34:35], v[34:35], v[30:31], v[66:67] op_sel:[0,0,0] op_sel_hi:[0,1,1]
    s_cmp_ge_u32 s56, 4
    s_cbranch_scc1 L_conv_nx0
    s_waitcnt vmcnt(0)
    buffer_load_dwordx4 v[224:227], v9, s[36:39], 0 offen offset:0
    buffer_load_dwordx4 v[228:231], v9, s[36:39], 0 offen offset:2048
L_conv_nx0:
    v_cvt_pk_bf16_f32 v68, v32, v33
    v_cvt_pk_bf16_f32 v69, v34, v35
    ds_write_addtid_b32 v68 offset:4224
    ds_write_addtid_b32 v69 offset:4480
    v_pk_mul_f32 v[64:65], v[36:37], v[28:29] op_sel:[1,1] op_sel_hi:[1,0] neg_lo:[1,0]
    v_pk_mul_f32 v[66:67], v[38:39], v[30:31] op_sel:[1,1] op_sel_hi:[1,0] neg_lo:[1,0]
    v_pk_fma_f32 v[36:37], v[36:37], v[28:29], v[64:65] op_sel:[0,0,0] op_sel_hi:[0,1,1]
    v_pk_fma_f32 v[38:39], v[38:39], v[30:31], v[66:67] op_sel:[0,0,0] op_sel_hi:[0,1,1]
    v_cvt_pk_bf16_f32 v70, v36, v37
    v_cvt_pk_bf16_f32 v71, v38, v39
    ds_write_addtid_b32 v70 offset:4752
    ds_write_addtid_b32 v71 offset:5008
    v_pk_mul_f32 v[64:65], v[40:41], v[28:29] op_sel:[1,1] op_sel_hi:[1,0] neg_lo:[1,0]
    v_pk_mul_f32 v[66:67], v[42:43], v[30:31] op_sel:[1,1] op_sel_hi:[1,0] neg_lo:[1,0]
    v_pk_fma_f32 v[40:41], v[40:41], v[28:29], v[64:65] op_sel:[0,0,0] op_sel_hi:[0,1,1]
    v_pk_fma_f32 v[42:43], v[42:43], v[30:31], v[66:67] op_sel:[0,0,0] op_sel_hi:[0,1,1]
    v_cvt_pk_bf16_f32 v68, v40, v41
    v_cvt_pk_bf16_f32 v69, v42, v43
    ds_write_addtid_b32 v68 offset:5280
    ds_write_addtid_b32 v69 offset:5536
    v_pk_mul_f32 v[64:65], v[44:45], v[28:29] op_sel:[1,1] op_sel_hi:[1,0] neg_lo:[1,0]
    v_pk_mul_f32 v[66:67], v[46:47], v[30:31] op_sel:[1,1] op_sel_hi:[1,0] neg_lo:[1,0]
    v_pk_fma_f32 v[44:45], v[44:45], v[28:29], v[64:65] op_sel:[0,0,0] op_sel_hi:[0,1,1]
    v_pk_fma_f32 v[46:47], v[46:47], v[30:31], v[66:67] op_sel:[0,0,0] op_sel_hi:[0,1,1]
    v_cvt_pk_bf16_f32 v70, v44, v45
    v_cvt_pk_bf16_f32 v71, v46, v47
    ds_write_addtid_b32 v70 offset:5808
    ds_write_addtid_b32 v71 offset:6064
    v_pk_mul_f32 v[64:65], v[48:49], v[28:29] op_sel:[1,1] op_sel_hi:[1,0] neg_lo:[1,0]
    v_pk_mul_f32 v[66:67], v[50:51], v[30:31] op_sel:[1,1] op_sel_hi:[1,0] neg_lo:[1,0]
    v_pk_fma_f32 v[48:49], v[48:49], v[28:29], v[64:65] op_sel:[0,0,0] op_sel_hi:[0,1,1]
    v_pk_fma_f32 v[50:51], v[50:51], v[30:31], v[66:67] op_sel:[0,0,0] op_sel_hi:[0,1,1]
    v_cvt_pk_bf16_f32 v68, v48, v49
    v_cvt_pk_bf16_f32 v69, v50, v51
    ds_write_addtid_b32 v68 offset:6336
    ds_write_addtid_b32 v69 offset:6592
    v_pk_mul_f32 v[64:65], v[52:53], v[28:29] op_sel:[1,1] op_sel_hi:[1,0] neg_lo:[1,0]
    v_pk_mul_f32 v[66:67], v[54:55], v[30:31] op_sel:[1,1] op_sel_hi:[1,0] neg_lo:[1,0]
    v_pk_fma_f32 v[52:53], v[52:53], v[28:29], v[64:65] op_sel:[0,0,0] op_sel_hi:[0,1,1]
    v_pk_fma_f32 v[54:55], v[54:55], v[30:31], v[66:67] op_sel:[0,0,0] op_sel_hi:[0,1,1]
    v_cvt_pk_bf16_f32 v70, v52, v53
    v_cvt_pk_bf16_f32 v71, v54, v55
    ds_write_addtid_b32 v70 offset:6864
    ds_write_addtid_b32 v71 offset:7120
    v_pk_mul_f32 v[64:65], v[56:57], v[28:29] op_sel:[1,1] op_sel_hi:[1,0] neg_lo:[1,0]
    v_pk_mul_f32 v[66:67], v[58:59], v[30:31] op_sel:[1,1] op_sel_hi:[1,0] neg_lo:[1,0]
    v_pk_fma_f32 v[56:57], v[56:57], v[28:29], v[64:65] op_sel:[0,0,0] op_sel_hi:[0,1,1]
    v_pk_fma_f32 v[58:59], v[58:59], v[30:31], v[66:67] op_sel:[0,0,0] op_sel_hi:[0,1,1]
    v_cvt_pk_bf16_f32 v68, v56, v57
    v_cvt_pk_bf16_f32 v69, v58, v59
    ds_write_addtid_b32 v68 offset:7392
    ds_write_addtid_b32 v69 offset:7648
    v_pk_mul_f32 v[64:65], v[60:61], v[28:29] op_sel:[1,1] op_sel_hi:[1,0] neg_lo:[1,0]
    v_pk_mul_f32 v[66:67], v[62:63], v[30:31] op_sel:[1,1] op_sel_hi:[1,0] neg_lo:[1,0]
    v_pk_fma_f32 v[60:61], v[60:61], v[28:29], v[64:65] op_sel:[0,0,0] op_sel_hi:[0,1,1]
    v_pk_fma_f32 v[62:63], v[62:63], v[30:31], v[66:67] op_sel:[0,0,0] op_sel_hi:[0,1,1]
    v_cvt_pk_bf16_f32 v70, v60, v61
    s_cmp_ge_u32 s56, 4
    s_cbranch_scc1 L_conv_nx2
    buffer_load_dwordx4 v[232:235], v9, s[36:39], s53 offen offset:0
    buffer_load_dwordx4 v[236:239], v9, s[36:39], s53 offen offset:2048
L_conv_nx2:
    v_cvt_pk_bf16_f32 v71, v62, v63
    ds_write_addtid_b32 v70 offset:7920
    ds_write_addtid_b32 v71 offset:8176
    ds_read_b128 v[176:179], v6 offset:0
    ds_read_b128 v[180:183], v6 offset:32
    ds_read_b128 v[184:187], v6 offset:64
    ds_read_b128 v[188:191], v6 offset:96
    ds_read_b128 v[192:195], v6 offset:128
    ds_read_b128 v[196:199], v6 offset:160
    ds_read_b128 v[200:203], v6 offset:192
    ds_read_b128 v[204:207], v6 offset:224
    v_pk_mul_f32 v[64:65], v[32:33], v[28:29] op_sel:[1,1] op_sel_hi:[1,0] neg_lo:[1,0]
    v_pk_mul_f32 v[66:67], v[34:35], v[30:31] op_sel:[1,1] op_sel_hi:[1,0] neg_lo:[1,0]
    v_pk_fma_f32 v[32:33], v[32:33], v[28:29], v[64:65] op_sel:[0,0,0] op_sel_hi:[0,1,1]
    v_pk_fma_f32 v[34:35], v[34:35], v[30:31], v[66:67] op_sel:[0,0,0] op_sel_hi:[0,1,1]
    v_cvt_pk_bf16_f32 v68, v32, v33
    v_cvt_pk_bf16_f32 v69, v34, v35
    ds_write_addtid_b32 v68 offset:0
    ds_write_addtid_b32 v69 offset:256
    v_pk_mul_f32 v[64:65], v[40:41], v[28:29] op_sel:[1,1] op_sel_hi:[1,0] neg_lo:[1,0]
    v_pk_mul_f32 v[66:67], v[42:43], v[30:31] op_sel:[1,1] op_sel_hi:[1,0] neg_lo:[1,0]
    v_pk_fma_f32 v[40:41], v[40:41], v[28:29], v[64:65] op_sel:[0,0,0] op_sel_hi:[0,1,1]
    v_pk_fma_f32 v[42:43], v[42:43], v[30:31], v[66:67] op_sel:[0,0,0] op_sel_hi:[0,1,1]
    v_cvt_pk_bf16_f32 v70, v40, v41
    v_cvt_pk_bf16_f32 v71, v42, v43
    ds_write_addtid_b32 v70 offset:528
    ds_write_addtid_b32 v71 offset:784
    v_pk_mul_f32 v[64:65], v[48:49], v[28:29] op_sel:[1,1] op_sel_hi:[1,0] neg_lo:[1,0]
    v_pk_mul_f32 v[66:67], v[50:51], v[30:31] op_sel:[1,1] op_sel_hi:[1,0] neg_lo:[1,0]
    v_pk_fma_f32 v[48:49], v[48:49], v[28:29], v[64:65] op_sel:[0,0,0] op_sel_hi:[0,1,1]
    v_pk_fma_f32 v[50:51], v[50:51], v[30:31], v[66:67] op_sel:[0,0,0] op_sel_hi:[0,1,1]
    v_cvt_pk_bf16_f32 v68, v48, v49
    v_cvt_pk_bf16_f32 v69, v50, v51
    ds_write_addtid_b32 v68 offset:1056
    ds_write_addtid_b32 v69 offset:1312
    v_pk_mul_f32 v[64:65], v[56:57], v[28:29] op_sel:[1,1] op_sel_hi:[1,0] neg_lo:[1,0]
    v_pk_mul_f32 v[66:67], v[58:59], v[30:31] op_sel:[1,1] op_sel_hi:[1,0] neg_lo:[1,0]
    v_pk_fma_f32 v[56:57], v[56:57], v[28:29], v[64:65] op_sel:[0,0,0] op_sel_hi:[0,1,1]
    v_pk_fma_f32 v[58:59], v[58:59], v[30:31], v[66:67] op_sel:[0,0,0] op_sel_hi:[0,1,1]
    v_cvt_pk_bf16_f32 v70, v56, v57
    v_cvt_pk_bf16_f32 v71, v58, v59
    ds_write_addtid_b32 v70 offset:1584
    ds_write_addtid_b32 v71 offset:1840
    s_waitcnt lgkmcnt(15)
    v_mfma_f32_16x16x32_bf16 v[208:211], v[176:179], v[80:83], 0
    v_pk_mul_f32 v[64:65], v[32:33], v[28:29] op_sel:[1,1] op_sel_hi:[1,0] neg_lo:[1,0]
    v_pk_mul_f32 v[66:67], v[34:35], v[30:31] op_sel:[1,1] op_sel_hi:[1,0] neg_lo:[1,0]
    v_pk_fma_f32 v[32:33], v[32:33], v[28:29], v[64:65] op_sel:[0,0,0] op_sel_hi:[0,1,1]
    v_pk_fma_f32 v[34:35], v[34:35], v[30:31], v[66:67] op_sel:[0,0,0] op_sel_hi:[0,1,1]
    v_cvt_pk_bf16_f32 v68, v32, v33
    v_cvt_pk_bf16_f32 v69, v34, v35
    ds_write_addtid_b32 v68 offset:2112
    ds_write_addtid_b32 v69 offset:2368
    s_waitcnt lgkmcnt(15)
    v_mfma_f32_16x16x32_bf16 v[208:211], v[180:183], v[84:87], v[208:211]
    v_pk_mul_f32 v[64:65], v[40:41], v[28:29] op_sel:[1,1] op_sel_hi:[1,0] neg_lo:[1,0]
    v_pk_mul_f32 v[66:67], v[42:43], v[30:31] op_sel:[1,1] op_sel_hi:[1,0] neg_lo:[1,0]
    s_cmp_ge_u32 s56, 4
    s_cbranch_scc1 L_conv_nx4
    buffer_load_dwordx4 v[240:243], v9, s[36:39], s66 offen offset:0
    buffer_load_dwordx4 v[244:247], v9, s[36:39], s66 offen offset:2048
L_conv_nx4:
    v_pk_fma_f32 v[40:41], v[40:41], v[28:29], v[64:65] op_sel:[0,0,0] op_sel_hi:[0,1,1]
    v_pk_fma_f32 v[42:43], v[42:43], v[30:31], v[66:67] op_sel:[0,0,0] op_sel_hi:[0,1,1]
    v_cvt_pk_bf16_f32 v70, v40, v41
    v_cvt_pk_bf16_f32 v71, v42, v43
    ds_write_addtid_b32 v70 offset:2640
    ds_write_addtid_b32 v71 offset:2896
    v_mfma_f32_16x16x32_bf16 v[208:211], v[184:187], v[88:91], v[208:211]
    v_pk_mul_f32 v[64:65], v[48:49], v[28:29] op_sel:[1,1] op_sel_hi:[1,0] neg_lo:[1,0]
    v_pk_mul_f32 v[66:67], v[50:51], v[30:31] op_sel:[1,1] op_sel_hi:[1,0] neg_lo:[1,0]
    v_pk_fma_f32 v[48:49], v[48:49], v[28:29], v[64:65] op_sel:[0,0,0] op_sel_hi:[0,1,1]
    v_pk_fma_f32 v[50:51], v[50:51], v[30:31], v[66:67] op_sel:[0,0,0] op_sel_hi:[0,1,1]
    v_cvt_pk_bf16_f32 v68, v48, v49
    v_cvt_pk_bf16_f32 v69, v50, v51
    ds_write_addtid_b32 v68 offset:3168
    ds_write_addtid_b32 v69 offset:3424
    s_waitcnt lgkmcnt(15)
    v_mfma_f32_16x16x32_bf16 v[208:211], v[188:191], v[92:95], v[208:211]
    v_pk_mul_f32 v[64:65], v[56:57], v[28:29] op_sel:[1,1] op_sel_hi:[1,0] neg_lo:[1,0]
    v_pk_mul_f32 v[66:67], v[58:59], v[30:31] op_sel:[1,1] op_sel_hi:[1,0] neg_lo:[1,0]
    v_pk_fma_f32 v[56:57], v[56:57], v[28:29], v[64:65] op_sel:[0,0,0] op_sel_hi:[0,1,1]
    v_pk_fma_f32 v[58:59], v[58:59], v[30:31], v[66:67] op_sel:[0,0,0] op_sel_hi:[0,1,1]
    v_cvt_pk_bf16_f32 v70, v56, v57
    v_cvt_pk_bf16_f32 v71, v58, v59
    ds_write_addtid_b32 v70 offset:3696
    ds_write_addtid_b32 v71 offset:3952
    v_mfma_f32_16x16x32_bf16 v[208:211], v[192:195], v[96:99], v[208:211]
    v_pk_mul_f32 v[64:65], v[32:33], v[28:29] op_sel:[1,1] op_sel_hi:[1,0] neg_lo:[1,0]
    v_pk_mul_f32 v[66:67], v[34:35], v[30:31] op_sel:[1,1] op_sel_hi:[1,0] neg_lo:[1,0]
    v_pk_fma_f32 v[32:33], v[32:33], v[28:29], v[64:65] op_sel:[0,0,0] op_sel_hi:[0,1,1]
    v_pk_fma_f32 v[34:35], v[34:35], v[30:31], v[66:67] op_sel:[0,0,0] op_sel_hi:[0,1,1]
    v_cvt_pk_bf16_f32 v68, v32, v33
    v_cvt_pk_bf16_f32 v69, v34, v35
    ds_write_addtid_b32 v68 offset:4224
    ds_write_addtid_b32 v69 offset:4480
    v_mfma_f32_16x16x32_bf16 v[208:211], v[196:199], v[100:103], v[208:211]
    v_pk_mul_f32 v[64:65], v[48:49], v[28:29] op_sel:[1,1] op_sel_hi:[1,0] neg_lo:[1,0]
    v_pk_mul_f32 v[66:67], v[50:51], v[30:31] op_sel:[1,1] op_sel_hi:[1,0] neg_lo:[1,0]
    v_pk_fma_f32 v[48:49], v[48:49], v[28:29], v[64:65] op_sel:[0,0,0] op_sel_hi:[0,1,1]
    v_pk_fma_f32 v[50:51], v[50:51], v[30:31], v[66:67] op_sel:[0,0,0] op_sel_hi:[0,1,1]
    v_cvt_pk_bf16_f32 v70, v48, v49
    v_cvt_pk_bf16_f32 v71, v50, v51
    ds_write_addtid_b32 v70 offset:4752
    ds_write_addtid_b32 v71 offset:5008
    v_mfma_f32_16x16x32_bf16 v[208:211], v[200:203], v[104:107], v[208:211]
    v_pk_mul_f32 v[64:65], v[32:33], v[28:29] op_sel:[1,1] op_sel_hi:[1,0] neg_lo:[1,0]
    v_pk_mul_f32 v[66:67], v[34:35], v[30:31] op_sel:[1,1] op_sel_hi:[1,0] neg_lo:[1,0]
    v_pk_fma_f32 v[32:33], v[32:33], v[28:29], v[64:65] op_sel:[0,0,0] op_sel_hi:[0,1,1]
    v_pk_fma_f32 v[34:35], v[34:35], v[30:31], v[66:67] op_sel:[0,0,0] op_sel_hi:[0,1,1]
    v_cvt_pk_bf16_f32 v68, v32, v33
    v_cvt_pk_bf16_f32 v69, v34, v35
    ds_write_addtid_b32 v68 offset:5280
    ds_write_addtid_b32 v69 offset:5536
    s_waitcnt lgkmcnt(15)
    v_mfma_f32_16x16x32_bf16 v[208:211], v[204:207], v[108:111], v[208:211]
    v_pk_mul_f32 v[64:65], v[48:49], v[28:29] op_sel:[1,1] op_sel_hi:[1,0] neg_lo:[1,0]
    v_pk_mul_f32 v[66:67], v[50:51], v[30:31] op_sel:[1,1] op_sel_hi:[1,0] neg_lo:[1,0]
    v_pk_fma_f32 v[48:49], v[48:49], v[28:29], v[64:65] op_sel:[0,0,0] op_sel_hi:[0,1,1]
    s_cmp_ge_u32 s56, 4
    s_cbranch_scc1 L_conv_nx6
    buffer_load_dwordx4 v[248:251], v9, s[36:39], s67 offen offset:0
    buffer_load_dwordx4 v[252:255], v9, s[36:39], s67 offen offset:2048
L_conv_nx6:
    v_pk_fma_f32 v[50:51], v[50:51], v[30:31], v[66:67] op_sel:[0,0,0] op_sel_hi:[0,1,1]
    v_cvt_pk_bf16_f32 v70, v48, v49
    v_cvt_pk_bf16_f32 v71, v50, v51
    ds_write_addtid_b32 v70 offset:5808
    ds_write_addtid_b32 v71 offset:6064
    v_pk_mul_f32 v[64:65], v[32:33], v[28:29] op_sel:[1,1] op_sel_hi:[1,0] neg_lo:[1,0]
    v_pk_mul_f32 v[66:67], v[34:35], v[30:31] op_sel:[1,1] op_sel_hi:[1,0] neg_lo:[1,0]
    v_pk_fma_f32 v[32:33], v[32:33], v[28:29], v[64:65] op_sel:[0,0,0] op_sel_hi:[0,1,1]
    v_pk_fma_f32 v[34:35], v[34:35], v[30:31], v[66:67] op_sel:[0,0,0] op_sel_hi:[0,1,1]
    v_cvt_pk_bf16_f32 v68, v32, v33
    v_cvt_pk_bf16_f32 v69, v34, v35
    ds_write_addtid_b32 v68 offset:6336
    ds_write_addtid_b32 v69 offset:6592
    v_pk_mul_f32 v[64:65], v[48:49], v[28:29] op_sel:[1,1] op_sel_hi:[1,0] neg_lo:[1,0]
    v_pk_mul_f32 v[66:67], v[50:51], v[30:31] op_sel:[1,1] op_sel_hi:[1,0] neg_lo:[1,0]
    v_pk_fma_f32 v[48:49], v[48:49], v[28:29], v[64:65] op_sel:[0,0,0] op_sel_hi:[0,1,1]
    v_pk_fma_f32 v[50:51], v[50:51], v[30:31], v[66:67] op_sel:[0,0,0] op_sel_hi:[0,1,1]
    v_cvt_pk_bf16_f32 v70, v48, v49
    v_cvt_pk_bf16_f32 v71, v50, v51
    ds_write_addtid_b32 v70 offset:6864
    ds_write_addtid_b32 v71 offset:7120
    v_pk_mul_f32 v[64:65], v[32:33], v[28:29] op_sel:[1,1] op_sel_hi:[1,0] neg_lo:[1,0]
    v_pk_mul_f32 v[66:67], v[34:35], v[30:31] op_sel:[1,1] op_sel_hi:[1,0] neg_lo:[1,0]
    v_pk_fma_f32 v[32:33], v[32:33], v[28:29], v[64:65] op_sel:[0,0,0] op_sel_hi:[0,1,1]
    v_pk_fma_f32 v[34:35], v[34:35], v[30:31], v[66:67] op_sel:[0,0,0] op_sel_hi:[0,1,1]
    v_cvt_pk_bf16_f32 v68, v32, v33
    v_cvt_pk_bf16_f32 v69, v34, v35
    ds_write_addtid_b32 v68 offset:7392
    ds_write_addtid_b32 v69 offset:7648
    v_pk_mul_f32 v[64:65], v[48:49], v[28:29] op_sel:[1,1] op_sel_hi:[1,0] neg_lo:[1,0]
    v_pk_mul_f32 v[66:67], v[50:51], v[30:31] op_sel:[1,1] op_sel_hi:[1,0] neg_lo:[1,0]
    v_pk_fma_f32 v[48:49], v[48:49], v[28:29], v[64:65] op_sel:[0,0,0] op_sel_hi:[0,1,1]
    v_pk_fma_f32 v[50:51], v[50:51], v[30:31], v[66:67] op_sel:[0,0,0] op_sel_hi:[0,1,1]
    v_cvt_pk_bf16_f32 v70, v48, v49
    v_cvt_pk_bf16_f32 v71, v50, v51
    ds_write_addtid_b32 v70 offset:7920
    ds_write_addtid_b32 v71 offset:8176
    ds_read_b128 v[176:179], v6 offset:0
    ds_read_b128 v[180:183], v6 offset:32
    ds_read_b128 v[184:187], v6 offset:64
    ds_read_b128 v[188:191], v6 offset:96
    ds_read_b128 v[192:195], v6 offset:128
    ds_read_b128 v[196:199], v6 offset:160
    ds_read_b128 v[200:203], v6 offset:192
    ds_read_b128 v[204:207], v6 offset:224
    v_pk_mul_f32 v[64:65], v[32:33], v[28:29] op_sel:[1,1] op_sel_hi:[1,0] neg_lo:[1,0]
    v_pk_mul_f32 v[66:67], v[34:35], v[30:31] op_sel:[1,1] op_sel_hi:[1,0] neg_lo:[1,0]
    v_pk_fma_f32 v[32:33], v[32:33], v[28:29], v[64:65] op_sel:[0,0,0] op_sel_hi:[0,1,1]
    v_pk_fma_f32 v[34:35], v[34:35], v[30:31], v[66:67] op_sel:[0,0,0] op_sel_hi:[0,1,1]
    v_cvt_pk_bf16_f32 v68, v32, v33
    v_cvt_pk_bf16_f32 v69, v34, v35
    ds_write_addtid_b32 v68 offset:0
    ds_write_addtid_b32 v69 offset:256
    v_pk_mul_f32 v[64:65], v[32:33], v[28:29] op_sel:[1,1] op_sel_hi:[1,0] neg_lo:[1,0]
    v_pk_mul_f32 v[66:67], v[34:35], v[30:31] op_sel:[1,1] op_sel_hi:[1,0] neg_lo:[1,0]
    v_pk_fma_f32 v[32:33], v[32:33], v[28:29], v[64:65] op_sel:[0,0,0] op_sel_hi:[0,1,1]
    v_pk_fma_f32 v[34:35], v[34:35], v[30:31], v[66:67] op_sel:[0,0,0] op_sel_hi:[0,1,1]
    v_cvt_pk_bf16_f32 v70, v32, v33
    v_cvt_pk_bf16_f32 v71, v34, v35
    ds_write_addtid_b32 v70 offset:528
    ds_write_addtid_b32 v71 offset:784
    v_pk_mul_f32 v[64:65], v[32:33], v[28:29] op_sel:[1,1] op_sel_hi:[1,0] neg_lo:[1,0]
    v_pk_mul_f32 v[66:67], v[34:35], v[30:31] op_sel:[1,1] op_sel_hi:[1,0] neg_lo:[1,0]
    v_pk_fma_f32 v[32:33], v[32:33], v[28:29], v[64:65] op_sel:[0,0,0] op_sel_hi:[0,1,1]
    v_pk_fma_f32 v[34:35], v[34:35], v[30:31], v[66:67] op_sel:[0,0,0] op_sel_hi:[0,1,1]
    v_cvt_pk_bf16_f32 v68, v32, v33
    v_cvt_pk_bf16_f32 v69, v34, v35
    ds_write_addtid_b32 v68 offset:1056
    ds_write_addtid_b32 v69 offset:1312
    s_waitcnt lgkmcnt(13)
    v_mfma_f32_16x16x32_bf16 v[212:215], v[176:179], v[80:83], 0
    v_pk_mul_f32 v[64:65], v[32:33], v[28:29] op_sel:[1,1] op_sel_hi:[1,0] neg_lo:[1,0]
    v_pk_mul_f32 v[66:67], v[34:35], v[30:31] op_sel:[1,1] op_sel_hi:[1,0] neg_lo:[1,0]
    v_pk_fma_f32 v[32:33], v[32:33], v[28:29], v[64:65] op_sel:[0,0,0] op_sel_hi:[0,1,1]
    v_pk_fma_f32 v[34:35], v[34:35], v[30:31], v[66:67] op_sel:[0,0,0] op_sel_hi:[0,1,1]
    v_cvt_pk_bf16_f32 v70, v32, v33
    v_cvt_pk_bf16_f32 v71, v34, v35
    ds_write_addtid_b32 v70 offset:1584
    ds_write_addtid_b32 v71 offset:1840
    s_waitcnt lgkmcnt(14)
    v_mfma_f32_16x16x32_bf16 v[212:215], v[180:183], v[84:87], v[212:215]
    v_pk_mul_f32 v[64:65], v[32:33], v[28:29] op_sel:[1,1] op_sel_hi:[1,0] neg_lo:[1,0]
    v_pk_mul_f32 v[66:67], v[34:35], v[30:31] op_sel:[1,1] op_sel_hi:[1,0] neg_lo:[1,0]
    v_pk_fma_f32 v[32:33], v[32:33], v[28:29], v[64:65] op_sel:[0,0,0] op_sel_hi:[0,1,1]
    v_pk_fma_f32 v[34:35], v[34:35], v[30:31], v[66:67] op_sel:[0,0,0] op_sel_hi:[0,1,1]
    v_cvt_pk_bf16_f32 v68, v32, v33
    v_cvt_pk_bf16_f32 v69, v34, v35
    ds_write_addtid_b32 v68 offset:2112
    ds_write_addtid_b32 v69 offset:2368
    s_waitcnt lgkmcnt(15)
    v_mfma_f32_16x16x32_bf16 v[212:215], v[184:187], v[88:91], v[212:215]
    v_pk_mul_f32 v[64:65], v[32:33], v[28:29] op_sel:[1,1] op_sel_hi:[1,0] neg_lo:[1,0]
    v_pk_mul_f32 v[66:67], v[34:35], v[30:31] op_sel:[1,1] op_sel_hi:[1,0] neg_lo:[1,0]
    v_pk_fma_f32 v[32:33], v[32:33], v[28:29], v[64:65] op_sel:[0,0,0] op_sel_hi:[0,1,1]
    v_pk_fma_f32 v[34:35], v[34:35], v[30:31], v[66:67] op_sel:[0,0,0] op_sel_hi:[0,1,1]
    v_cvt_pk_bf16_f32 v70, v32, v33
    v_cvt_pk_bf16_f32 v71, v34, v35
    ds_write_addtid_b32 v70 offset:2640
    ds_write_addtid_b32 v71 offset:2896
    s_waitcnt lgkmcnt(15)
    v_mfma_f32_16x16x32_bf16 v[212:215], v[188:191], v[92:95], v[212:215]
    v_pk_mul_f32 v[64:65], v[32:33], v[28:29] op_sel:[1,1] op_sel_hi:[1,0] neg_lo:[1,0]
    v_pk_mul_f32 v[66:67], v[34:35], v[30:31] op_sel:[1,1] op_sel_hi:[1,0] neg_lo:[1,0]
    v_pk_fma_f32 v[32:33], v[32:33], v[28:29], v[64:65] op_sel:[0,0,0] op_sel_hi:[0,1,1]
    v_pk_fma_f32 v[34:35], v[34:35], v[30:31], v[66:67] op_sel:[0,0,0] op_sel_hi:[0,1,1]
    v_cvt_pk_bf16_f32 v68, v32, v33
    v_cvt_pk_bf16_f32 v69, v34, v35
    ds_write_addtid_b32 v68 offset:3168
    ds_write_addtid_b32 v69 offset:3424
    v_mfma_f32_16x16x32_bf16 v[212:215], v[192:195], v[96:99], v[212:215]
    v_pk_mul_f32 v[64:65], v[32:33], v[28:29] op_sel:[1,1] op_sel_hi:[1,0] neg_lo:[1,0]
    v_pk_mul_f32 v[66:67], v[34:35], v[30:31] op_sel:[1,1] op_sel_hi:[1,0] neg_lo:[1,0]
    v_pk_fma_f32 v[32:33], v[32:33], v[28:29], v[64:65] op_sel:[0,0,0] op_sel_hi:[0,1,1]
    v_pk_fma_f32 v[34:35], v[34:35], v[30:31], v[66:67] op_sel:[0,0,0] op_sel_hi:[0,1,1]
    v_cvt_pk_bf16_f32 v70, v32, v33
    v_cvt_pk_bf16_f32 v71, v34, v35
    ds_write_addtid_b32 v70 offset:3696
    ds_write_addtid_b32 v71 offset:3952
    s_waitcnt lgkmcnt(15)
    v_mfma_f32_16x16x32_bf16 v[212:215], v[196:199], v[100:103], v[212:215]
    v_pk_mul_f32 v[64:65], v[32:33], v[28:29] op_sel:[1,1] op_sel_hi:[1,0] neg_lo:[1,0]
    v_pk_mul_f32 v[66:67], v[34:35], v[30:31] op_sel:[1,1] op_sel_hi:[1,0] neg_lo:[1,0]
    v_pk_fma_f32 v[32:33], v[32:33], v[28:29], v[64:65] op_sel:[0,0,0] op_sel_hi:[0,1,1]
    v_pk_fma_f32 v[34:35], v[34:35], v[30:31], v[66:67] op_sel:[0,0,0] op_sel_hi:[0,1,1]
    v_cvt_pk_bf16_f32 v68, v32, v33
    v_cvt_pk_bf16_f32 v69, v34, v35
    ds_write_addtid_b32 v68 offset:4224
    ds_write_addtid_b32 v69 offset:4480
    v_mfma_f32_16x16x32_bf16 v[212:215], v[200:203], v[104:107], v[212:215]
    v_mfma_f32_16x16x32_bf16 v[212:215], v[204:207], v[108:111], v[212:215]
    ds_read_b128 v[176:179], v6 offset:0
    ds_read_b128 v[180:183], v6 offset:32
    ds_read_b128 v[184:187], v6 offset:64
    ds_read_b128 v[188:191], v6 offset:96
    ds_read_b128 v[192:195], v6 offset:128
    ds_read_b128 v[196:199], v6 offset:160
    ds_read_b128 v[200:203], v6 offset:192
    ds_read_b128 v[204:207], v6 offset:224
    v_add_f32 v208, v208, v169
    v_cndmask_b32 v72, v213, v212, s[62:63]
    v_cndmask_b32 v73, v214, v213, s[62:63]
    v_cndmask_b32 v74, v215, 0, s[62:63]
    v_cvt_pk_bf16_f32 v76, v212, v213
    v_cvt_pk_bf16_f32 v77, v214, v215
    s_waitcnt lgkmcnt(7)
    v_mfma_f32_16x16x32_bf16 v[216:219], v[176:179], v[80:83], 0
    s_waitcnt lgkmcnt(6)
    v_mfma_f32_16x16x32_bf16 v[216:219], v[180:183], v[84:87], v[216:219]
    v_cvt_pk_bf16_f32 v64, v212, v212
    v_cvt_pk_bf16_f32 v65, v212, v212
    v_cvt_pk_bf16_f32 v66, v72, v212
    v_cvt_pk_bf16_f32 v67, v73, v72
    s_waitcnt lgkmcnt(5)
    v_mfma_f32_16x16x32_bf16 v[216:219], v[184:187], v[88:91], v[216:219]
    s_waitcnt lgkmcnt(4)
    v_mfma_f32_16x16x32_bf16 v[216:219], v[188:191], v[92:95], v[216:219]
    v_cvt_pk_bf16_f32 v68, v73, v73
    v_cvt_pk_bf16_f32 v69, v73, v73
    v_cvt_pk_bf16_f32 v70, v74, v73
    v_cvt_pk_bf16_f32 v71, v74, v74
    s_waitcnt lgkmcnt(3)
    v_mfma_f32_16x16x32_bf16 v[216:219], v[192:195], v[96:99], v[216:219]
    s_waitcnt lgkmcnt(2)
    v_mfma_f32_16x16x32_bf16 v[216:219], v[196:199], v[100:103], v[216:219]
    v_cndmask_b32 v76, v76, 0, s[62:63]
    s_mov_b32 exec_hi, 1
    ds_write_b128 v160, v[64:67] offset:4
    ds_write_b128 v160, v[68:71] offset:20
    ds_write_b16 v160, v64
    s_mov_b32 exec_hi, -1
    s_waitcnt lgkmcnt(4)
    v_mfma_f32_16x16x32_bf16 v[216:219], v[200:203], v[104:107], v[216:219]
    s_waitcnt lgkmcnt(3)
    v_mfma_f32_16x16x32_bf16 v[216:219], v[204:207], v[108:111], v[216:219]
    v_cvt_pk_bf16_f32 v72, v208, v211
    v_cvt_pk_bf16_f32 v73, v209, v208
    v_cvt_pk_bf16_f32 v74, v210, v209
    v_cvt_pk_bf16_f32 v75, v211, v210
    ds_write_b16 v161, v72
    ds_write2_b32 v161, v73, v74 offset0:1 offset1:2
    ds_write_b32 v161, v75 offset:12
    ds_write_b16_d16_hi v161, v72 offset:18
    s_mov_b32 exec_lo, 0
    ds_write2_b32 v162, v76, v77 offset0:0 offset1:8
    s_mov_b32 exec_lo, -1
    v_cvt_pk_bf16_f32 v100, v216, v217
    v_cvt_pk_bf16_f32 v101, v218, v219
    v_cvt_pk_bf16_f32 v102, v216, v216
    s_mov_b32 exec_hi, 1
    ds_write_b16 v164, v100
    s_mov_b32 exec_hi, 0
    ds_write_b16_d16_hi v163, v100 offset:32
    ds_write_b16 v163, v101 offset:64
    ds_write_b16_d16_hi v163, v101 offset:96
    s_mov_b32 exec_hi, -1
    v_readlane_b32 s52, v102, 0
    v_mov_b32 v12, v165
    v_mov_b32 v13, v166
    v_mov_b32 v14, v167
    v_mov_b32 v15, v168
    v_mov_b32 v5, v174
    v_mov_b32 v6, v171
    s_waitcnt vmcnt(0)
    v_readfirstlane_b32 s61, v175
    v_and_b32 v124, s52, v124
    v_and_b32 v125, s52, v125
    v_and_b32 v126, s52, v126
    v_and_b32 v127, s52, v127
    s_mul_i32 s60, s61, 0x9e3779b1
    s_add_u32 s60, s60, 0x7f4a7c15
    s_cmp_ge_u32 s56, 4
    s_cbranch_scc1 L_conv_late
    buffer_load_dwordx4 v[144:147], v122, s[40:43], 0 offen sc1
    buffer_load_dwordx4 v[148:151], v122, s[40:43], s53 offen sc1
    buffer_load_dwordx4 v[152:155], v122, s[40:43], s66 offen sc1
    buffer_load_dwordx4 v[156:159], v122, s[40:43], s67 offen sc1
    v_perm_b32 v216, v228, v224, s64
    v_perm_b32 v217, v236, v232, s64
    v_perm_b32 v218, v244, v240, s64
    v_perm_b32 v219, v252, v248, s64
    ds_write_b128 v123, v[216:219] offset:0
    v_perm_b32 v220, v228, v224, s65
    v_perm_b32 v221, v236, v232, s65
    v_perm_b32 v222, v244, v240, s65
    v_perm_b32 v223, v252, v248, s65
    ds_write_b128 v123, v[220:223] offset:4160
    v_perm_b32 v216, v229, v225, s64
    v_perm_b32 v217, v237, v233, s64
    v_perm_b32 v218, v245, v241, s64
    v_perm_b32 v219, v253, v249, s64
    ds_write_b128 v123, v[216:219] offset:8320
    v_perm_b32 v220, v229, v225, s65
    v_perm_b32 v221, v237, v233, s65
    v_perm_b32 v222, v245, v241, s65
    v_perm_b32 v223, v253, v249, s65
    ds_write_b128 v123, v[220:223] offset:12480
    v_perm_b32 v216, v230, v226, s64
    v_perm_b32 v217, v238, v234, s64
    v_perm_b32 v218, v246, v242, s64
    v_perm_b32 v219, v254, v250, s64
    ds_write_b128 v123, v[216:219] offset:16640
    v_perm_b32 v220, v230, v226, s65
    v_perm_b32 v221, v238, v234, s65
    v_perm_b32 v222, v246, v242, s65
    v_perm_b32 v223, v254, v250, s65
    ds_write_b128 v123, v[220:223] offset:20800
    v_perm_b32 v216, v231, v227, s64
    v_perm_b32 v217, v239, v235, s64
    v_perm_b32 v218, v247, v243, s64
    v_perm_b32 v219, v255, v251, s64
    ds_write_b128 v123, v[216:219] offset:24960
    v_perm_b32 v220, v231, v227, s65
    v_perm_b32 v221, v239, v235, s65
    v_perm_b32 v222, v247, v243, s65
    v_perm_b32 v223, v255, v251, s65
    ds_write_b128 v123, v[220:223] offset:29120
    v_lshlrev_b32 v176, 16, v224
    v_lshlrev_b32 v177, 16, v228
    v_lshlrev_b32 v178, 16, v232
    v_lshlrev_b32 v179, 16, v236
    v_lshlrev_b32 v180, 16, v240
    v_lshlrev_b32 v181, 16, v244
    v_lshlrev_b32 v182, 16, v248
    v_lshlrev_b32 v183, 16, v252
    v_and_b32 v184, 0xffff0000, v224
    v_and_b32 v185, 0xffff0000, v228
    v_and_b32 v186, 0xffff0000, v232
    v_and_b32 v187, 0xffff0000, v236
    v_and_b32 v188, 0xffff0000, v240
    v_and_b32 v189, 0xffff0000, v244
    v_and_b32 v190, 0xffff0000, v248
    v_and_b32 v191, 0xffff0000, v252
    v_lshlrev_b32 v192, 16, v225
    v_lshlrev_b32 v193, 16, v229
    v_lshlrev_b32 v194, 16, v233
    v_lshlrev_b32 v195, 16, v237
    v_lshlrev_b32 v196, 16, v241
    v_lshlrev_b32 v197, 16, v245
    v_lshlrev_b32 v198, 16, v249
    v_lshlrev_b32 v199, 16, v253
    v_and_b32 v200, 0xffff0000, v225
    v_and_b32 v201, 0xffff0000, v229
    v_and_b32 v202, 0xffff0000, v233
    v_and_b32 v203, 0xffff0000, v237
    v_and_b32 v204, 0xffff0000, v241
    v_and_b32 v205, 0xffff0000, v245
    v_and_b32 v206, 0xffff0000, v249
    v_and_b32 v207, 0xffff0000, v253
    v_lshlrev_b32 v208, 16, v226
    v_lshlrev_b32 v209, 16, v230
    v_lshlrev_b32 v210, 16, v234
    v_lshlrev_b32 v211, 16, v238
    v_lshlrev_b32 v212, 16, v242
    v_lshlrev_b32 v213, 16, v246
    v_lshlrev_b32 v214, 16, v250
    v_lshlrev_b32 v215, 16, v254
    s_mov_b32 s54, 0
L_poll_conv:
    s_waitcnt vmcnt(0)
    v_cmp_ne_u32 s[8:9], s60, v147
    v_cmp_ne_u32 s[10:11], s60, v151
    v_cmp_ne_u32 s[12:13], s60, v155
    v_cmp_ne_u32 s[14:15], s60, v159
    s_or_b64 vcc, s[8:9], s[10:11]
    s_or_b64 vcc, vcc, s[12:13]
    s_or_b64 vcc, vcc, s[14:15]
    s_cbranch_scc0 L_polled_conv
    s_add_u32 s54, s54, 1
    s_cmp_ge_u32 s54, 65536
    s_cbranch_scc1 L_polled_conv
    s_sleep 2
    s_mov_b64 exec, s[8:9]
    s_cbranch_execz L_ps_conv_0
    buffer_load_dwordx4 v[144:147], v122, s[40:43], 0 offen sc1
L_ps_conv_0:
    s_mov_b64 exec, s[10:11]
    s_cbranch_execz L_ps_conv_1
    buffer_load_dwordx4 v[148:151], v122, s[40:43], s53 offen sc1
L_ps_conv_1:
    s_mov_b64 exec, s[12:13]
    s_cbranch_execz L_ps_conv_2
    buffer_load_dwordx4 v[152:155], v122, s[40:43], s66 offen sc1
L_ps_conv_2:
    s_mov_b64 exec, s[14:15]
    s_cbranch_execz L_ps_conv_3
    buffer_load_dwordx4 v[156:159], v122, s[40:43], s67 offen sc1
L_ps_conv_3:
    s_mov_b64 exec, -1
    s_branch L_poll_conv
L_polled_conv:
    v_and_b32 v160, 0xffff0000, v144
    v_and_b32 v161, 0xffff0000, v145
    v_and_b32 v162, 0xffff0000, v148
    v_and_b32 v163, 0xffff0000, v149
    v_and_b32 v164, 0xffff0000, v152
    v_and_b32 v165, 0xffff0000, v153
    v_and_b32 v166, 0xffff0000, v156
    v_and_b32 v167, 0xffff0000, v157
    v_rcp_f32 v160, v160
    v_rcp_f32 v161, v161
    v_rcp_f32 v162, v162
    v_rcp_f32 v163, v163
    v_rcp_f32 v164, v164
    v_rcp_f32 v165, v165
    v_rcp_f32 v166, v166
    v_rcp_f32 v167, v167
    v_lshlrev_b32 v168, 16, v144
    v_lshlrev_b32 v169, 16, v145
    v_lshlrev_b32 v170, 16, v148
    v_lshlrev_b32 v171, 16, v149
    v_lshlrev_b32 v172, 16, v152
    v_lshlrev_b32 v173, 16, v153
    v_lshlrev_b32 v174, 16, v156
    v_lshlrev_b32 v175, 16, v157
    v_pk_mul_f32 v[168:169], v[168:169], v[160:161] neg_lo:[1,0] neg_hi:[1,0]
    v_pk_mul_f32 v[170:171], v[170:171], v[162:163] neg_lo:[1,0] neg_hi:[1,0]
    v_pk_mul_f32 v[172:173], v[172:173], v[164:165] neg_lo:[1,0] neg_hi:[1,0]
    v_pk_mul_f32 v[174:175], v[174:175], v[166:167] neg_lo:[1,0] neg_hi:[1,0]
    v_pk_fma_f32 v[176:177], v[176:177], v[160:161], v[168:169]
    v_pk_fma_f32 v[178:179], v[178:179], v[162:163], v[170:171]
    v_pk_fma_f32 v[180:181], v[180:181], v[164:165], v[172:173]
    v_pk_fma_f32 v[182:183], v[182:183], v[166:167], v[174:175]
    v_cvt_pk_bf16_f32 v216, v176, v177
    v_cvt_pk_bf16_f32 v217, v178, v179
    v_cvt_pk_bf16_f32 v218, v180, v181
    v_cvt_pk_bf16_f32 v219, v182, v183
    ds_write_b128 v121, v[216:219] offset:0
    v_pk_fma_f32 v[184:185], v[184:185], v[160:161], v[168:169]
    v_pk_fma_f32 v[186:187], v[186:187], v[162:163], v[170:171]
    v_pk_fma_f32 v[188:189], v[188:189], v[164:165], v[172:173]
    v_pk_fma_f32 v[190:191], v[190:191], v[166:167], v[174:175]
    v_cvt_pk_bf16_f32 v220, v184, v185
    v_cvt_pk_bf16_f32 v221, v186, v187
    v_cvt_pk_bf16_f32 v222, v188, v189
    v_cvt_pk_bf16_f32 v223, v190, v191
    ds_write_b128 v121, v[220:223] offset:4608
    v_pk_fma_f32 v[192:193], v[192:193], v[160:161], v[168:169]
    v_pk_fma_f32 v[194:195], v[194:195], v[162:163], v[170:171]
    v_pk_fma_f32 v[196:197], v[196:197], v[164:165], v[172:173]
    v_pk_fma_f32 v[198:199], v[198:199], v[166:167], v[174:175]
    v_cvt_pk_bf16_f32 v216, v192, v193
    v_cvt_pk_bf16_f32 v217, v194, v195
    v_cvt_pk_bf16_f32 v218, v196, v197
    v_cvt_pk_bf16_f32 v219, v198, v199
    ds_write_b128 v121, v[216:219] offset:9216
    v_pk_fma_f32 v[200:201], v[200:201], v[160:161], v[168:169]
    v_pk_fma_f32 v[202:203], v[202:203], v[162:163], v[170:171]
    v_pk_fma_f32 v[204:205], v[204:205], v[164:165], v[172:173]
    v_pk_fma_f32 v[206:207], v[206:207], v[166:167], v[174:175]
    v_cvt_pk_bf16_f32 v220, v200, v201
    v_cvt_pk_bf16_f32 v221, v202, v203
    v_cvt_pk_bf16_f32 v222, v204, v205
    v_cvt_pk_bf16_f32 v223, v206, v207
    ds_write_b128 v121, v[220:223] offset:13824
    v_pk_fma_f32 v[208:209], v[208:209], v[160:161], v[168:169]
    v_pk_fma_f32 v[210:211], v[210:211], v[162:163], v[170:171]
    v_pk_fma_f32 v[212:213], v[212:213], v[164:165], v[172:173]
    v_pk_fma_f32 v[214:215], v[214:215], v[166:167], v[174:175]
    v_cvt_pk_bf16_f32 v216, v208, v209
    v_cvt_pk_bf16_f32 v217, v210, v211
    v_cvt_pk_bf16_f32 v218, v212, v213
    v_cvt_pk_bf16_f32 v219, v214, v215
    ds_write_b128 v121, v[216:219] offset:18432
    v_and_b32 v176, 0xffff0000, v226
    v_and_b32 v177, 0xffff0000, v230
    v_and_b32 v178, 0xffff0000, v234
    v_and_b32 v179, 0xffff0000, v238
    v_and_b32 v180, 0xffff0000, v242
    v_and_b32 v181, 0xffff0000, v246
    v_and_b32 v182, 0xffff0000, v250
    v_and_b32 v183, 0xffff0000, v254
    v_pk_fma_f32 v[176:177], v[176:177], v[160:161], v[168:169]
    v_pk_fma_f32 v[178:179], v[178:179], v[162:163], v[170:171]
    v_pk_fma_f32 v[180:181], v[180:181], v[164:165], v[172:173]
    v_pk_fma_f32 v[182:183], v[182:183], v[166:167], v[174:175]
    v_cvt_pk_bf16_f32 v220, v176, v177
    v_cvt_pk_bf16_f32 v221, v178, v179
    v_cvt_pk_bf16_f32 v222, v180, v181
    v_cvt_pk_bf16_f32 v223, v182, v183
    ds_write_b128 v121, v[220:223] offset:23040
    v_lshlrev_b32 v184, 16, v227
    v_lshlrev_b32 v185, 16, v231
    v_lshlrev_b32 v186, 16, v235
    v_lshlrev_b32 v187, 16, v239
    v_lshlrev_b32 v188, 16, v243
    v_lshlrev_b32 v189, 16, v247
    v_lshlrev_b32 v190, 16, v251
    v_lshlrev_b32 v191, 16, v255
    v_pk_fma_f32 v[184:185], v[184:185], v[160:161], v[168:169]
    v_pk_fma_f32 v[186:187], v[186:187], v[162:163], v[170:171]
    v_pk_fma_f32 v[188:189], v[188:189], v[164:165], v[172:173]
    v_pk_fma_f32 v[190:191], v[190:191], v[166:167], v[174:175]
    v_cvt_pk_bf16_f32 v216, v184, v185
    v_cvt_pk_bf16_f32 v217, v186, v187
    v_cvt_pk_bf16_f32 v218, v188, v189
    v_cvt_pk_bf16_f32 v219, v190, v191
    ds_write_b128 v121, v[216:219] offset:27648
    v_and_b32 v192, 0xffff0000, v227
    v_and_b32 v193, 0xffff0000, v231
    v_and_b32 v194, 0xffff0000, v235
    v_and_b32 v195, 0xffff0000, v239
    v_and_b32 v196, 0xffff0000, v243
    v_and_b32 v197, 0xffff0000, v247
    v_and_b32 v198, 0xffff0000, v251
    v_and_b32 v199, 0xffff0000, v255
    v_pk_fma_f32 v[192:193], v[192:193], v[160:161], v[168:169]
    v_pk_fma_f32 v[194:195], v[194:195], v[162:163], v[170:171]
    v_pk_fma_f32 v[196:197], v[196:197], v[164:165], v[172:173]
    v_pk_fma_f32 v[198:199], v[198:199], v[166:167], v[174:175]
    v_cvt_pk_bf16_f32 v220, v192, v193
    v_cvt_pk_bf16_f32 v221, v194, v195
    v_cvt_pk_bf16_f32 v222, v196, v197
    v_cvt_pk_bf16_f32 v223, v198, v199
    ds_write_b128 v121, v[220:223] offset:32256
L_conv_late:
    s_waitcnt lgkmcnt(0)
    s_barrier
    s_cmp_lg_u32 s56, 0
    s_cbranch_scc1 L_conv_noack
    s_lshl_b32 s6, s57, 2
    s_add_u32 s6, s6, 2048
    v_mov_b32 v10, s6
    v_mov_b32 v11, s60
    s_mov_b64 exec, 1
    buffer_store_dword v11, v10, s[40:43], 0 offen sc1
    s_mov_b64 exec, -1
L_conv_noack:
    ds_read_b128 v[176:179], v7 offset:448
    ds_read_b128 v[180:183], v7 offset:432
    ds_read_b64 v[248:249], v8 offset:2048
    s_waitcnt lgkmcnt(2)
    v_mfma_f32_16x16x32_bf16 v[212:215], v[176:179], v[128:131], 0
    ds_read_b128 v[184:187], v7 offset:960
    ds_read_b128 v[188:191], v7 offset:944
    v_mfma_f32_16x16x32_bf16 v[216:219], v[176:179], v[132:135], 0
    ds_read_b64 v[250:251], v8 offset:2560
    s_waitcnt lgkmcnt(4)
    v_mfma_f32_16x16x32_bf16 v[204:207], v[180:183], v[128:131], 0
    s_waitcnt lgkmcnt(3)
    v_lshlrev_b32 v160, 16, v248
    v_and_b32 v161, 0xffff0000, v248
    v_lshlrev_b32 v162, 16, v249
    v_and_b32 v163, 0xffff0000, v249
    v_mfma_f32_16x16x32_bf16 v[208:211], v[180:183], v[132:135], 0
    ds_read_b64 v[244:245], v8 offset:1024
    ds_read_b64 v[246:247], v8 offset:1536
    v_mfma_f32_16x16x32_bf16 v[160:163], v[124:127], v[176:179], v[160:163]
    ds_read2_b32 v[96:97], v15 offset0:67 offset1:66
    ds_read2_b32 v[98:99], v15 offset0:65 offset1:64
    v_mfma_f32_16x16x32_bf16 v[224:227], v[176:179], v[140:143], 0
    ds_read2_b32 v[100:101], v15 offset0:83 offset1:82
    ds_read2_b32 v[102:103], v15 offset0:81 offset1:80
    v_mfma_f32_16x16x32_bf16 v[220:223], v[180:183], v[136:139], 0
    v_cvt_pk_bf16_f32 v232, v212, v216
    v_cvt_pk_bf16_f32 v233, v213, v217
    v_cvt_pk_bf16_f32 v234, v214, v218
    v_cvt_pk_bf16_f32 v235, v215, v219
    s_waitcnt lgkmcnt(6)
    v_mfma_f32_16x16x32_bf16 v[212:215], v[184:187], v[128:131], 0
    ds_read2_b32 v[104:105], v15 offset0:99 offset1:98
    ds_read2_b32 v[106:107], v15 offset0:97 offset1:96
    v_mfma_f32_16x16x32_bf16 v[216:219], v[184:187], v[132:135], 0
    v_cvt_pk_bf16_f32 v228, v204, v208
    v_cvt_pk_bf16_f32 v229, v205, v209
    v_cvt_pk_bf16_f32 v230, v206, v210
    v_cvt_pk_bf16_f32 v231, v207, v211
    v_mfma_f32_16x16x32_bf16 v[204:207], v[188:191], v[128:131], 0
    v_lshlrev_b32 v164, 16, v250
    v_and_b32 v165, 0xffff0000, v250
    v_lshlrev_b32 v166, 16, v251
    v_and_b32 v167, 0xffff0000, v251
    v_mfma_f32_16x16x32_bf16 v[208:211], v[188:191], v[132:135], 0
    ds_read2_b32 v[84:85], v15 offset0:3 offset1:2
    ds_read2_b32 v[86:87], v15 offset0:1 offset1:0
    v_mfma_f32_16x16x32_bf16 v[164:167], v[124:127], v[184:187], v[164:167]
    ds_read2_b32 v[88:89], v15 offset0:19 offset1:18
    ds_read2_b32 v[90:91], v15 offset0:17 offset1:16
    v_cvt_pk_bf16_f32 v236, v220, v224
    v_cvt_pk_bf16_f32 v237, v221, v225
    v_cvt_pk_bf16_f32 v238, v222, v226
    v_cvt_pk_bf16_f32 v239, v223, v227
    v_mfma_f32_16x16x32_bf16 v[224:227], v[184:187], v[140:143], 0
    ds_read2_b32 v[92:93], v15 offset0:35 offset1:34
    ds_read2_b32 v[94:95], v15 offset0:33 offset1:32
    s_waitcnt lgkmcnt(8)
    v_lshlrev_b32 v152, 16, v244
    v_and_b32 v153, 0xffff0000, v244
    v_lshlrev_b32 v154, 16, v245
    v_and_b32 v155, 0xffff0000, v245
    ds_read_b64 v[252:253], v8 offset:3072
    v_mfma_f32_16x16x32_bf16 v[220:223], v[188:191], v[136:139], 0
    ds_read2_b32 v[108:109], v15 offset0:131 offset1:130
    ds_read2_b32 v[110:111], v15 offset0:129 offset1:128
    v_lshlrev_b32 v156, 16, v246
    v_and_b32 v157, 0xffff0000, v246
    v_lshlrev_b32 v158, 16, v247
    v_and_b32 v159, 0xffff0000, v247
    ds_read_b64 v[254:255], v8 offset:3584
    v_mfma_f32_16x16x32_bf16 v[152:155], v[232:235], v[96:99], v[152:155]
    ds_read2_b32 v[112:113], v15 offset0:147 offset1:146
    ds_read2_b32 v[114:115], v15 offset0:145 offset1:144
    v_mfma_f32_16x16x32_bf16 v[156:159], v[232:235], v[100:103], v[156:159]
    ds_read2_b32 v[116:117], v15 offset0:163 offset1:162
    ds_read2_b32 v[118:119], v15 offset0:161 offset1:160
    s_waitcnt lgkmcnt(12)
    v_mfma_f32_16x16x32_bf16 v[160:163], v[232:235], v[104:107], v[160:163]
    ds_read2_b32 v[120:121], v15 offset0:179 offset1:178
    ds_read2_b32 v[122:123], v15 offset0:177 offset1:176
    v_mfma_f32_16x16x32_bf16 v[152:155], v[228:231], v[84:87], v[152:155]
    ds_read_b128 v[176:179], v7 offset:1472
    ds_read_b128 v[180:183], v7 offset:1456
    s_waitcnt lgkmcnt(11)
    v_mfma_f32_16x16x32_bf16 v[156:159], v[228:231], v[88:91], v[156:159]
    v_lshlrev_b32 v168, 16, v252
    v_and_b32 v169, 0xffff0000, v252
    v_mfma_f32_16x16x32_bf16 v[160:163], v[228:231], v[92:95], v[160:163]
    v_lshlrev_b32 v170, 16, v253
    s_waitcnt lgkmcnt(6)
    v_mfma_f32_16x16x32_bf16 v[160:163], v[236:239], v[108:111], v[160:163]
    v_and_b32 v171, 0xffff0000, v253
    v_lshlrev_b32 v172, 16, v254
    v_mfma_f32_16x16x32_bf16 v[164:167], v[236:239], v[112:115], v[164:167]
    v_and_b32 v173, 0xffff0000, v254
    v_lshlrev_b32 v174, 16, v255
    v_and_b32 v175, 0xffff0000, v255
    s_waitcnt lgkmcnt(2)
    v_mfma_f32_16x16x32_bf16 v[168:171], v[236:239], v[116:119], v[168:171]
    v_cvt_pk_bf16_f32 v232, v212, v216
    v_cvt_pk_bf16_f32 v233, v213, v217
    v_mfma_f32_16x16x32_bf16 v[172:175], v[236:239], v[120:123], v[172:175]
    v_cvt_pk_bf16_f32 v234, v214, v218
    v_cvt_pk_bf16_f32 v235, v215, v219
    s_waitcnt lgkmcnt(0)
    v_mfma_f32_16x16x32_bf16 v[212:215], v[176:179], v[128:131], 0
    v_cvt_pk_bf16_f32 v228, v204, v208
    v_cvt_pk_bf16_f32 v229, v205, v209
    v_mfma_f32_16x16x32_bf16 v[216:219], v[176:179], v[132:135], 0
    v_cvt_pk_bf16_f32 v230, v206, v210
    v_cvt_pk_bf16_f32 v231, v207, v211
    v_mfma_f32_16x16x32_bf16 v[204:207], v[180:183], v[128:131], 0
    v_cvt_pk_bf16_f32 v236, v220, v224
    v_cvt_pk_bf16_f32 v237, v221, v225
    v_mfma_f32_16x16x32_bf16 v[208:211], v[180:183], v[132:135], 0
    v_cvt_pk_bf16_f32 v238, v222, v226
    v_cvt_pk_bf16_f32 v239, v223, v227
    v_mfma_f32_16x16x32_bf16 v[168:171], v[124:127], v[176:179], v[168:171]
    ds_read_b128 v[184:187], v7 offset:1984
    ds_read_b128 v[188:191], v7 offset:1968
    v_mfma_f32_16x16x32_bf16 v[224:227], v[176:179], v[140:143], 0
    ds_read_b64 v[240:241], v8 offset:0
    ds_read_b64 v[242:243], v8 offset:512
    v_mfma_f32_16x16x32_bf16 v[220:223], v[180:183], v[136:139], 0
    ds_read_b128 v[176:179], v7 offset:2496
    ds_read_b128 v[180:183], v7 offset:2480
    v_mfma_f32_16x16x32_bf16 v[156:159], v[232:235], v[96:99], v[156:159]
    ds_read2_b32 v[44:45], v12 offset0:230 offset1:228
    ds_read2_b32 v[46:47], v12 offset0:226 offset1:224
    v_mfma_f32_16x16x32_bf16 v[160:163], v[232:235], v[100:103], v[160:163]
    ds_read2_b32 v[76:77], v13 offset0:230 offset1:228
    ds_read2_b32 v[78:79], v13 offset0:226 offset1:224
    v_mfma_f32_16x16x32_bf16 v[164:167], v[232:235], v[104:107], v[164:167]
    v_cvt_pk_bf16_f32 v232, v212, v216
    v_cvt_pk_bf16_f32 v233, v213, v217
    v_mfma_f32_16x16x32_bf16 v[156:159], v[228:231], v[84:87], v[156:159]
    v_cvt_pk_bf16_f32 v234, v214, v218
    v_cvt_pk_bf16_f32 v235, v215, v219
    v_mfma_f32_16x16x32_bf16 v[160:163], v[228:231], v[88:91], v[160:163]
    ds_read2_b32 v[40:41], v12 offset0:198 offset1:196
    ds_read2_b32 v[42:43], v12 offset0:194 offset1:192
    v_mfma_f32_16x16x32_bf16 v[164:167], v[228:231], v[92:95], v[164:167]
    v_cvt_pk_bf16_f32 v228, v204, v208
    v_cvt_pk_bf16_f32 v229, v205, v209
    v_mfma_f32_16x16x32_bf16 v[164:167], v[236:239], v[108:111], v[164:167]
    v_cvt_pk_bf16_f32 v230, v206, v210
    v_cvt_pk_bf16_f32 v231, v207, v211
    v_mfma_f32_16x16x32_bf16 v[168:171], v[236:239], v[112:115], v[168:171]
    ds_read2_b32 v[72:73], v13 offset0:198 offset1:196
    ds_read2_b32 v[74:75], v13 offset0:194 offset1:192
    v_mfma_f32_16x16x32_bf16 v[172:175], v[236:239], v[116:119], v[172:175]
    v_cvt_pk_bf16_f32 v236, v220, v224
    s_waitcnt lgkmcnt(4)
    v_mfma_f32_16x16x32_bf16 v[212:215], v[184:187], v[128:131], 0
    v_cvt_pk_bf16_f32 v237, v221, v225
    v_cvt_pk_bf16_f32 v238, v222, v226
    v_mfma_f32_16x16x32_bf16 v[216:219], v[184:187], v[132:135], 0
    v_cvt_pk_bf16_f32 v239, v223, v227
    ds_read2_b32 v[36:37], v12 offset0:166 offset1:164
    v_mfma_f32_16x16x32_bf16 v[204:207], v[188:191], v[128:131], 0
    ds_read2_b32 v[38:39], v12 offset0:162 offset1:160
    ds_read2_b32 v[68:69], v13 offset0:166 offset1:164
    v_mfma_f32_16x16x32_bf16 v[208:211], v[188:191], v[132:135], 0
    ds_read2_b32 v[70:71], v13 offset0:162 offset1:160
    v_lshlrev_b32 v144, 16, v240
    v_mfma_f32_16x16x32_bf16 v[172:175], v[124:127], v[184:187], v[172:175]
    v_and_b32 v145, 0xffff0000, v240
    v_lshlrev_b32 v146, 16, v241
    v_mfma_f32_16x16x32_bf16 v[224:227], v[184:187], v[140:143], 0
    v_and_b32 v147, 0xffff0000, v241
    ds_read2_b32 v[32:33], v12 offset0:134 offset1:132
    v_mfma_f32_16x16x32_bf16 v[220:223], v[188:191], v[136:139], 0
    ds_read_b128 v[184:187], v7 offset:3008
    ds_read_b128 v[188:191], v7 offset:2992
    v_mfma_f32_16x16x32_bf16 v[160:163], v[232:235], v[96:99], v[160:163]
    ds_read2_b32 v[34:35], v12 offset0:130 offset1:128
    v_lshlrev_b32 v148, 16, v242
    v_mfma_f32_16x16x32_bf16 v[164:167], v[232:235], v[100:103], v[164:167]
    v_and_b32 v149, 0xffff0000, v242
    v_lshlrev_b32 v150, 16, v243
    v_mfma_f32_16x16x32_bf16 v[168:171], v[232:235], v[104:107], v[168:171]
    v_cvt_pk_bf16_f32 v232, v212, v216
    v_cvt_pk_bf16_f32 v233, v213, v217
    v_mfma_f32_16x16x32_bf16 v[160:163], v[228:231], v[84:87], v[160:163]
    v_cvt_pk_bf16_f32 v234, v214, v218
    v_cvt_pk_bf16_f32 v235, v215, v219
    v_mfma_f32_16x16x32_bf16 v[164:167], v[228:231], v[88:91], v[164:167]
    v_and_b32 v151, 0xffff0000, v243
    ds_read2_b32 v[64:65], v13 offset0:134 offset1:132
    v_mfma_f32_16x16x32_bf16 v[168:171], v[228:231], v[92:95], v[168:171]
    v_cvt_pk_bf16_f32 v228, v204, v208
    v_cvt_pk_bf16_f32 v229, v205, v209
    v_mfma_f32_16x16x32_bf16 v[168:171], v[236:239], v[108:111], v[168:171]
    v_cvt_pk_bf16_f32 v230, v206, v210
    v_cvt_pk_bf16_f32 v231, v207, v211
    v_mfma_f32_16x16x32_bf16 v[172:175], v[236:239], v[112:115], v[172:175]
    v_cvt_pk_bf16_f32 v236, v220, v224
    v_cvt_pk_bf16_f32 v237, v221, v225
    v_mfma_f32_16x16x32_bf16 v[212:215], v[176:179], v[128:131], 0
    v_cvt_pk_bf16_f32 v238, v222, v226
    v_cvt_pk_bf16_f32 v239, v223, v227
    v_mfma_f32_16x16x32_bf16 v[216:219], v[176:179], v[132:135], 0
    ds_read2_b32 v[66:67], v13 offset0:130 offset1:128
    ds_read2_b32 v[28:29], v12 offset0:102 offset1:100
    v_mfma_f32_16x16x32_bf16 v[204:207], v[180:183], v[128:131], 0
    ds_read2_b32 v[30:31], v12 offset0:98 offset1:96
    ds_read2_b32 v[60:61], v13 offset0:102 offset1:100
    v_mfma_f32_16x16x32_bf16 v[208:211], v[180:183], v[132:135], 0
    ds_read_b128 v[176:179], v7 offset:0
    ds_read_b128 v[180:183], v7 offset:64
    v_mfma_f32_16x16x32_bf16 v[164:167], v[232:235], v[96:99], v[164:167]
    ds_read2_b32 v[62:63], v13 offset0:98 offset1:96
    ds_read2_b32 v[24:25], v12 offset0:70 offset1:68
    v_mfma_f32_16x16x32_bf16 v[168:171], v[232:235], v[100:103], v[168:171]
    ds_read2_b32 v[26:27], v12 offset0:66 offset1:64
    ds_read2_b32 v[56:57], v13 offset0:70 offset1:68
    v_mfma_f32_16x16x32_bf16 v[172:175], v[232:235], v[104:107], v[172:175]
    ds_read2_b32 v[58:59], v13 offset0:66 offset1:64
    ds_read2_b32 v[20:21], v12 offset0:38 offset1:36
    v_mfma_f32_16x16x32_bf16 v[164:167], v[228:231], v[84:87], v[164:167]
    ds_read2_b32 v[22:23], v12 offset0:34 offset1:32
    ds_read2_b32 v[52:53], v13 offset0:38 offset1:36
    v_mfma_f32_16x16x32_bf16 v[168:171], v[228:231], v[88:91], v[168:171]
    v_cvt_pk_bf16_f32 v232, v212, v216
    v_cvt_pk_bf16_f32 v233, v213, v217
    v_mfma_f32_16x16x32_bf16 v[172:175], v[228:231], v[92:95], v[172:175]
    v_cvt_pk_bf16_f32 v234, v214, v218
    v_cvt_pk_bf16_f32 v235, v215, v219
    v_mfma_f32_16x16x32_bf16 v[172:175], v[236:239], v[108:111], v[172:175]
    v_cvt_pk_bf16_f32 v228, v204, v208
    s_waitcnt lgkmcnt(4)
    v_mfma_f32_16x16x32_bf16 v[212:215], v[184:187], v[128:131], 0
    v_cvt_pk_bf16_f32 v229, v205, v209
    v_cvt_pk_bf16_f32 v230, v206, v210
    v_mfma_f32_16x16x32_bf16 v[216:219], v[184:187], v[132:135], 0
    v_cvt_pk_bf16_f32 v231, v207, v211
    ds_read2_b32 v[54:55], v13 offset0:34 offset1:32
    v_mfma_f32_16x16x32_bf16 v[204:207], v[188:191], v[128:131], 0
    ds_read2_b32 v[16:17], v12 offset0:6 offset1:4
    ds_read2_b32 v[18:19], v12 offset0:2 offset1:0
    v_mfma_f32_16x16x32_bf16 v[208:211], v[188:191], v[132:135], 0
    ds_read_b128 v[184:187], v7 offset:128
    ds_read_b128 v[188:191], v7 offset:192
    v_mfma_f32_16x16x32_bf16 v[168:171], v[232:235], v[96:99], v[168:171]
    ds_read_b128 v[192:195], v7 offset:256
    ds_read_b128 v[196:199], v7 offset:320
    v_mfma_f32_16x16x32_bf16 v[172:175], v[232:235], v[100:103], v[172:175]
    ds_read2_b32 v[48:49], v13 offset0:6 offset1:4
    ds_read2_b32 v[50:51], v13 offset0:2 offset1:0
    v_mfma_f32_16x16x32_bf16 v[168:171], v[228:231], v[84:87], v[168:171]
    v_cvt_pk_bf16_f32 v232, v212, v216
    v_cvt_pk_bf16_f32 v233, v213, v217
    v_cvt_pk_bf16_f32 v234, v214, v218
    v_cvt_pk_bf16_f32 v235, v215, v219
    v_mfma_f32_16x16x32_bf16 v[172:175], v[228:231], v[88:91], v[172:175]
    v_cvt_pk_bf16_f32 v228, v204, v208
    v_cvt_pk_bf16_f32 v229, v205, v209
    v_cvt_pk_bf16_f32 v230, v206, v210
    v_cvt_pk_bf16_f32 v231, v207, v211
    v_mfma_f32_16x16x32_bf16 v[172:175], v[232:235], v[96:99], v[172:175]
    ds_read2_b32 v[80:81], v14 offset0:6 offset1:4
    ds_read2_b32 v[82:83], v14 offset0:2 offset1:0
    v_mfma_f32_16x16x32_bf16 v[172:175], v[228:231], v[84:87], v[172:175]
    v_mfma_f32_16x16x32_bf16 v[144:147], v[44:47], v[176:179], v[144:147]
    v_mfma_f32_16x16x32_bf16 v[148:151], v[76:79], v[176:179], v[148:151]
    ds_read_b128 v[176:179], v7 offset:384
    v_mfma_f32_16x16x32_bf16 v[144:147], v[40:43], v[180:183], v[144:147]
    v_mfma_f32_16x16x32_bf16 v[148:151], v[72:75], v[180:183], v[148:151]
    ds_read_b128 v[180:183], v7 offset:448
    s_waitcnt lgkmcnt(2)
    v_mfma_f32_16x16x32_bf16 v[144:147], v[36:39], v[184:187], v[144:147]
    v_mfma_f32_16x16x32_bf16 v[148:151], v[68:71], v[184:187], v[148:151]
    ds_read_b128 v[184:187], v7 offset:512
    v_mfma_f32_16x16x32_bf16 v[144:147], v[32:35], v[188:191], v[144:147]
    v_mfma_f32_16x16x32_bf16 v[148:151], v[64:67], v[188:191], v[148:151]
    ds_read_b128 v[188:191], v7 offset:576
    v_mfma_f32_16x16x32_bf16 v[144:147], v[28:31], v[192:195], v[144:147]
    v_mfma_f32_16x16x32_bf16 v[148:151], v[60:63], v[192:195], v[148:151]
    ds_read_b128 v[192:195], v7 offset:640
    v_mfma_f32_16x16x32_bf16 v[144:147], v[24:27], v[196:199], v[144:147]
    v_mfma_f32_16x16x32_bf16 v[148:151], v[56:59], v[196:199], v[148:151]
    ds_read_b128 v[196:199], v7 offset:704
    s_waitcnt lgkmcnt(3)
    v_mfma_f32_16x16x32_bf16 v[144:147], v[20:23], v[176:179], v[144:147]
    v_mfma_f32_16x16x32_bf16 v[148:151], v[52:55], v[176:179], v[148:151]
    ds_read_b128 v[176:179], v7 offset:768
    v_mfma_f32_16x16x32_bf16 v[144:147], v[16:19], v[180:183], v[144:147]
    v_mfma_f32_16x16x32_bf16 v[148:151], v[48:51], v[180:183], v[148:151]
    v_mfma_f32_16x16x32_bf16 v[152:155], v[80:83], v[180:183], v[152:155]
    ds_read_b128 v[180:183], v7 offset:832
    v_mfma_f32_16x16x32_bf16 v[148:151], v[44:47], v[184:187], v[148:151]
    v_mfma_f32_16x16x32_bf16 v[152:155], v[76:79], v[184:187], v[152:155]
    ds_read_b128 v[184:187], v7 offset:896
    s_waitcnt lgkmcnt(2)
    v_mfma_f32_16x16x32_bf16 v[148:151], v[40:43], v[188:191], v[148:151]
    v_mfma_f32_16x16x32_bf16 v[152:155], v[72:75], v[188:191], v[152:155]
    ds_read_b128 v[188:191], v7 offset:960
    v_mfma_f32_16x16x32_bf16 v[148:151], v[36:39], v[192:195], v[148:151]
    v_cvt_pk_bf16_f32 v10, v144, v145
    v_cvt_pk_bf16_f32 v11, v146, v147
    v_mfma_f32_16x16x32_bf16 v[152:155], v[68:71], v[192:195], v[152:155]
    ds_write_b64 v8, v[10:11] offset:0
    ds_read_b128 v[192:195], v7 offset:1024
    v_mfma_f32_16x16x32_bf16 v[148:151], v[32:35], v[196:199], v[148:151]
    v_mfma_f32_16x16x32_bf16 v[152:155], v[64:67], v[196:199], v[152:155]
    ds_read_b128 v[196:199], v7 offset:1088
    v_mfma_f32_16x16x32_bf16 v[148:151], v[28:31], v[176:179], v[148:151]
    v_mfma_f32_16x16x32_bf16 v[152:155], v[60:63], v[176:179], v[152:155]
    ds_read_b128 v[176:179], v7 offset:1152
    s_waitcnt lgkmcnt(4)
    v_mfma_f32_16x16x32_bf16 v[148:151], v[24:27], v[180:183], v[148:151]
    v_mfma_f32_16x16x32_bf16 v[152:155], v[56:59], v[180:183], v[152:155]
    ds_read_b128 v[180:183], v7 offset:1216
    v_mfma_f32_16x16x32_bf16 v[148:151], v[20:23], v[184:187], v[148:151]
    v_mfma_f32_16x16x32_bf16 v[152:155], v[52:55], v[184:187], v[152:155]
    ds_read_b128 v[184:187], v7 offset:1280
    v_mfma_f32_16x16x32_bf16 v[148:151], v[16:19], v[188:191], v[148:151]
    v_mfma_f32_16x16x32_bf16 v[152:155], v[48:51], v[188:191], v[152:155]
    v_mfma_f32_16x16x32_bf16 v[156:159], v[80:83], v[188:191], v[156:159]
    ds_read_b128 v[188:191], v7 offset:1344
    s_waitcnt lgkmcnt(2)
    v_mfma_f32_16x16x32_bf16 v[152:155], v[44:47], v[192:195], v[152:155]
    v_mfma_f32_16x16x32_bf16 v[156:159], v[76:79], v[192:195], v[156:159]
    ds_read_b128 v[192:195], v7 offset:1408
    v_mfma_f32_16x16x32_bf16 v[152:155], v[40:43], v[196:199], v[152:155]
    v_mfma_f32_16x16x32_bf16 v[156:159], v[72:75], v[196:199], v[156:159]
    ds_read_b128 v[196:199], v7 offset:1472
    v_mfma_f32_16x16x32_bf16 v[152:155], v[36:39], v[176:179], v[152:155]
    v_cvt_pk_bf16_f32 v10, v148, v149
    v_cvt_pk_bf16_f32 v11, v150, v151
    v_mfma_f32_16x16x32_bf16 v[156:159], v[68:71], v[176:179], v[156:159]
    ds_write_b64 v8, v[10:11] offset:512
    ds_read_b128 v[176:179], v7 offset:1536
    v_mfma_f32_16x16x32_bf16 v[152:155], v[32:35], v[180:183], v[152:155]
    v_mfma_f32_16x16x32_bf16 v[156:159], v[64:67], v[180:183], v[156:159]
    ds_read_b128 v[180:183], v7 offset:1600
    s_waitcnt lgkmcnt(4)
    v_mfma_f32_16x16x32_bf16 v[152:155], v[28:31], v[184:187], v[152:155]
    v_mfma_f32_16x16x32_bf16 v[156:159], v[60:63], v[184:187], v[156:159]
    ds_read_b128 v[184:187], v7 offset:1664
    v_mfma_f32_16x16x32_bf16 v[152:155], v[24:27], v[188:191], v[152:155]
    s_waitcnt lgkmcnt(3)
    s_barrier
    v_mfma_f32_16x16x32_bf16 v[156:159], v[56:59], v[188:191], v[156:159]
    ds_read_b64_tr_b16 v[12:13], v4 offset:0
    ds_read_b64_tr_b16 v[14:15], v4 offset:16640
    v_mfma_f32_16x16x32_bf16 v[152:155], v[20:23], v[192:195], v[152:155]
    ds_read_b128 v[188:191], v7 offset:1728
    v_mfma_f32_16x16x32_bf16 v[156:159], v[52:55], v[192:195], v[156:159]
    ds_read_b128 v[192:195], v7 offset:1792
    v_mfma_f32_16x16x32_bf16 v[152:155], v[16:19], v[196:199], v[152:155]
    v_mfma_f32_16x16x32_bf16 v[156:159], v[48:51], v[196:199], v[156:159]
    v_mfma_f32_16x16x32_bf16 v[160:163], v[80:83], v[196:199], v[160:163]
    ds_read_b128 v[196:199], v7 offset:1856
    s_waitcnt lgkmcnt(3)
    v_mfma_f32_16x16x32_bf16 v[156:159], v[44:47], v[176:179], v[156:159]
    buffer_store_dwordx4 v[12:15], v5, s[44:47], 0 offen
    v_mfma_f32_16x16x32_bf16 v[160:163], v[76:79], v[176:179], v[160:163]
    ds_read_b128 v[176:179], v7 offset:1920
    v_mfma_f32_16x16x32_bf16 v[156:159], v[40:43], v[180:183], v[156:159]
    v_mfma_f32_16x16x32_bf16 v[160:163], v[72:75], v[180:183], v[160:163]
    ds_read_b128 v[180:183], v7 offset:1984
    v_mfma_f32_16x16x32_bf16 v[156:159], v[36:39], v[184:187], v[156:159]
    v_cvt_pk_bf16_f32 v10, v152, v153
    v_cvt_pk_bf16_f32 v11, v154, v155
    v_mfma_f32_16x16x32_bf16 v[160:163], v[68:71], v[184:187], v[160:163]
    ds_write_b64 v8, v[10:11] offset:1024
    s_waitcnt lgkmcnt(3)
    v_mfma_f32_16x16x32_bf16 v[156:159], v[32:35], v[188:191], v[156:159]
    ds_read_b128 v[184:187], v7 offset:2048
    v_mfma_f32_16x16x32_bf16 v[160:163], v[64:67], v[188:191], v[160:163]
    ds_read_b128 v[188:191], v7 offset:2112
    v_mfma_f32_16x16x32_bf16 v[156:159], v[28:31], v[192:195], v[156:159]
    v_mfma_f32_16x16x32_bf16 v[160:163], v[60:63], v[192:195], v[160:163]
    ds_read_b128 v[192:195], v7 offset:2176
    v_mfma_f32_16x16x32_bf16 v[156:159], v[24:27], v[196:199], v[156:159]
    v_mfma_f32_16x16x32_bf16 v[160:163], v[56:59], v[196:199], v[160:163]
    ds_read_b128 v[196:199], v7 offset:2240
    s_waitcnt lgkmcnt(3)
    v_mfma_f32_16x16x32_bf16 v[156:159], v[20:23], v[176:179], v[156:159]
    v_mfma_f32_16x16x32_bf16 v[160:163], v[52:55], v[176:179], v[160:163]
    ds_read_b128 v[176:179], v7 offset:2304
    v_mfma_f32_16x16x32_bf16 v[156:159], v[16:19], v[180:183], v[156:159]
    v_mfma_f32_16x16x32_bf16 v[160:163], v[48:51], v[180:183], v[160:163]
    v_mfma_f32_16x16x32_bf16 v[164:167], v[80:83], v[180:183], v[164:167]
    ds_read_b128 v[180:183], v7 offset:2368
    v_mfma_f32_16x16x32_bf16 v[160:163], v[44:47], v[184:187], v[160:163]
    v_mfma_f32_16x16x32_bf16 v[164:167], v[76:79], v[184:187], v[164:167]
    ds_read_b128 v[184:187], v7 offset:2432
    s_waitcnt lgkmcnt(2)
    v_mfma_f32_16x16x32_bf16 v[160:163], v[40:43], v[188:191], v[160:163]
    v_mfma_f32_16x16x32_bf16 v[164:167], v[72:75], v[188:191], v[164:167]
    ds_read_b128 v[188:191], v7 offset:2496
    v_mfma_f32_16x16x32_bf16 v[160:163], v[36:39], v[192:195], v[160:163]
    v_cvt_pk_bf16_f32 v10, v156, v157
    v_cvt_pk_bf16_f32 v11, v158, v159
    v_mfma_f32_16x16x32_bf16 v[164:167], v[68:71], v[192:195], v[164:167]
    ds_write_b64 v8, v[10:11] offset:1536
    ds_read_b128 v[192:195], v7 offset:2560
    v_mfma_f32_16x16x32_bf16 v[160:163], v[32:35], v[196:199], v[160:163]
    v_mfma_f32_16x16x32_bf16 v[164:167], v[64:67], v[196:199], v[164:167]
    ds_read_b128 v[196:199], v7 offset:2624
    v_mfma_f32_16x16x32_bf16 v[160:163], v[28:31], v[176:179], v[160:163]
    v_mfma_f32_16x16x32_bf16 v[164:167], v[60:63], v[176:179], v[164:167]
    ds_read_b128 v[176:179], v7 offset:2688
    s_waitcnt lgkmcnt(4)
    v_mfma_f32_16x16x32_bf16 v[160:163], v[24:27], v[180:183], v[160:163]
    buffer_load_dwordx4 v[108:111], v6, s[40:43], 0 offen sc1
    v_mfma_f32_16x16x32_bf16 v[164:167], v[56:59], v[180:183], v[164:167]
    s_waitcnt lgkmcnt(2)
    s_barrier
    v_mfma_f32_16x16x32_bf16 v[160:163], v[20:23], v[184:187], v[160:163]
    ds_read_b64_tr_b16 v[12:13], v4 offset:1024
    ds_read_b64_tr_b16 v[14:15], v4 offset:17664
    v_mfma_f32_16x16x32_bf16 v[164:167], v[52:55], v[184:187], v[164:167]
    ds_read_b128 v[180:183], v7 offset:2752
    ds_read_b128 v[184:187], v7 offset:2816
    v_mfma_f32_16x16x32_bf16 v[160:163], v[16:19], v[188:191], v[160:163]
    v_mfma_f32_16x16x32_bf16 v[164:167], v[48:51], v[188:191], v[164:167]
    v_mfma_f32_16x16x32_bf16 v[168:171], v[80:83], v[188:191], v[168:171]
    ds_read_b128 v[188:191], v7 offset:2880
    v_mfma_f32_16x16x32_bf16 v[164:167], v[44:47], v[192:195], v[164:167]
    s_waitcnt lgkmcnt(3)
    buffer_store_dwordx4 v[12:15], v5, s[44:47], s50 offen
    v_mfma_f32_16x16x32_bf16 v[168:171], v[76:79], v[192:195], v[168:171]
    ds_read_b128 v[192:195], v7 offset:2944
    v_mfma_f32_16x16x32_bf16 v[164:167], v[40:43], v[196:199], v[164:167]
    v_mfma_f32_16x16x32_bf16 v[168:171], v[72:75], v[196:199], v[168:171]
    ds_read_b128 v[196:199], v7 offset:3008
    v_mfma_f32_16x16x32_bf16 v[164:167], v[36:39], v[176:179], v[164:167]
    v_cvt_pk_bf16_f32 v10, v160, v161
    v_cvt_pk_bf16_f32 v11, v162, v163
    v_mfma_f32_16x16x32_bf16 v[168:171], v[68:71], v[176:179], v[168:171]
    ds_write_b64 v8, v[10:11] offset:2048
    s_waitcnt lgkmcnt(3)
    v_mfma_f32_16x16x32_bf16 v[164:167], v[32:35], v[180:183], v[164:167]
    ds_read_b128 v[176:179], v7 offset:3072
    v_mfma_f32_16x16x32_bf16 v[168:171], v[64:67], v[180:183], v[168:171]
    ds_read_b128 v[180:183], v7 offset:3136
    v_mfma_f32_16x16x32_bf16 v[164:167], v[28:31], v[184:187], v[164:167]
    v_mfma_f32_16x16x32_bf16 v[168:171], v[60:63], v[184:187], v[168:171]
    ds_read_b128 v[184:187], v7 offset:3200
    v_mfma_f32_16x16x32_bf16 v[164:167], v[24:27], v[188:191], v[164:167]
    v_mfma_f32_16x16x32_bf16 v[168:171], v[56:59], v[188:191], v[168:171]
    ds_read_b128 v[188:191], v7 offset:3264
    s_waitcnt lgkmcnt(3)
    v_mfma_f32_16x16x32_bf16 v[164:167], v[20:23], v[192:195], v[164:167]
    v_mfma_f32_16x16x32_bf16 v[168:171], v[52:55], v[192:195], v[168:171]
    ds_read_b128 v[192:195], v7 offset:3328
    v_mfma_f32_16x16x32_bf16 v[164:167], v[16:19], v[196:199], v[164:167]
    v_mfma_f32_16x16x32_bf16 v[168:171], v[48:51], v[196:199], v[168:171]
    v_mfma_f32_16x16x32_bf16 v[172:175], v[80:83], v[196:199], v[172:175]
    ds_read_b128 v[196:199], v7 offset:3392
    v_mfma_f32_16x16x32_bf16 v[168:171], v[44:47], v[176:179], v[168:171]
    v_mfma_f32_16x16x32_bf16 v[172:175], v[76:79], v[176:179], v[172:175]
    ds_read_b128 v[176:179], v7 offset:3456
    s_waitcnt lgkmcnt(2)
    v_mfma_f32_16x16x32_bf16 v[168:171], v[40:43], v[180:183], v[168:171]
    v_mfma_f32_16x16x32_bf16 v[172:175], v[72:75], v[180:183], v[172:175]
    ds_read_b128 v[180:183], v7 offset:3520
    v_mfma_f32_16x16x32_bf16 v[168:171], v[36:39], v[184:187], v[168:171]
    v_cvt_pk_bf16_f32 v10, v164, v165
    v_cvt_pk_bf16_f32 v11, v166, v167
    v_mfma_f32_16x16x32_bf16 v[172:175], v[68:71], v[184:187], v[172:175]
    ds_read_b128 v[184:187], v7 offset:3584
    ds_write_b64 v8, v[10:11] offset:2560
    v_mfma_f32_16x16x32_bf16 v[168:171], v[32:35], v[188:191], v[168:171]
    v_mfma_f32_16x16x32_bf16 v[172:175], v[64:67], v[188:191], v[172:175]
    ds_read_b128 v[188:191], v7 offset:3648
    v_mfma_f32_16x16x32_bf16 v[168:171], v[28:31], v[192:195], v[168:171]
    v_mfma_f32_16x16x32_bf16 v[172:175], v[60:63], v[192:195], v[172:175]
    ds_read_b128 v[192:195], v7 offset:3712
    s_waitcnt lgkmcnt(4)
    v_mfma_f32_16x16x32_bf16 v[168:171], v[24:27], v[196:199], v[168:171]
    s_waitcnt lgkmcnt(2)
    s_barrier
    v_mfma_f32_16x16x32_bf16 v[172:175], v[56:59], v[196:199], v[172:175]
    ds_read_b128 v[196:199], v7 offset:3776
    ds_read_b64_tr_b16 v[12:13], v4 offset:2048
    v_mfma_f32_16x16x32_bf16 v[168:171], v[20:23], v[176:179], v[168:171]
    ds_read_b64_tr_b16 v[14:15], v4 offset:18688
    v_mfma_f32_16x16x32_bf16 v[172:175], v[52:55], v[176:179], v[172:175]
    ds_read_b128 v[176:179], v7 offset:3840
    v_mfma_f32_16x16x32_bf16 v[168:171], v[16:19], v[180:183], v[168:171]
    v_mfma_f32_16x16x32_bf16 v[172:175], v[48:51], v[180:183], v[172:175]
    ds_read_b128 v[180:183], v7 offset:3904
    v_mfma_f32_16x16x32_bf16 v[172:175], v[44:47], v[184:187], v[172:175]
    ds_read_b128 v[184:187], v7 offset:3968
    s_waitcnt lgkmcnt(4)
    v_mfma_f32_16x16x32_bf16 v[172:175], v[40:43], v[188:191], v[172:175]
    ds_read_b128 v[188:191], v7 offset:4032
    v_mfma_f32_16x16x32_bf16 v[172:175], v[36:39], v[192:195], v[172:175]
    s_waitcnt lgkmcnt(4)
    buffer_store_dwordx4 v[12:15], v5, s[44:47], s51 offen
    v_mfma_f32_16x16x32_bf16 v[172:175], v[32:35], v[196:199], v[172:175]
    s_waitcnt lgkmcnt(3)
    v_mfma_f32_16x16x32_bf16 v[172:175], v[28:31], v[176:179], v[172:175]
    s_waitcnt lgkmcnt(2)
    v_mfma_f32_16x16x32_bf16 v[172:175], v[24:27], v[180:183], v[172:175]
    v_cvt_pk_bf16_f32 v10, v168, v169
    s_waitcnt lgkmcnt(1)
    v_mfma_f32_16x16x32_bf16 v[172:175], v[20:23], v[184:187], v[172:175]
    v_cvt_pk_bf16_f32 v11, v170, v171
    s_waitcnt lgkmcnt(0)
    v_mfma_f32_16x16x32_bf16 v[172:175], v[16:19], v[188:191], v[172:175]
    ds_write_b64 v8, v[10:11] offset:3072
    s_waitcnt vmcnt(2)
    v_cmp_ne_u32 vcc, s60, v111
    s_cbranch_vccz L_conv_selok
    s_mov_b32 s54, 0
L_poll_sel:
    buffer_load_dwordx4 v[108:111], v6, s[40:43], 0 offen sc1
    s_waitcnt vmcnt(0)
    v_xor_b32 v16, s60, v111
    v_cmp_ne_u32 vcc, 0, v16
    s_cbranch_vccz L_polled_sel
    s_add_u32 s54, s54, 1
    s_cmp_ge_u32 s54, 65536
    s_cbranch_scc1 L_polled_sel
    s_sleep 2
    s_branch L_poll_sel
L_polled_sel:
L_conv_selok:
    s_lshl_b32 s6, s57, 11
    s_add_u32 s6, s6, 491520
    v_bfe_u32 v16, v1, 2, 1
    v_lshlrev_b32 v16, 7, v16
    v_and_b32 v17, 3, v1
    v_lshl_add_u32 v16, v17, 2, v16
    v_subrev_u32 v18, 24576, v6
    v_add3_u32 v9, v16, v18, s6
    s_cmp_lg_u32 s56, 0
    s_cbranch_scc1 L_conv_noy
    buffer_load_dword v112, v9, s[40:43], 0 offen offset:0 sc1
    buffer_load_dword v113, v9, s[40:43], 0 offen offset:256 sc1
    buffer_load_dword v114, v9, s[40:43], 0 offen offset:512 sc1
    buffer_load_dword v115, v9, s[40:43], 0 offen offset:768 sc1
    buffer_load_dword v116, v9, s[40:43], 0 offen offset:1024 sc1
    buffer_load_dword v117, v9, s[40:43], 0 offen offset:1280 sc1
    buffer_load_dword v118, v9, s[40:43], 0 offen offset:1536 sc1
    buffer_load_dword v119, v9, s[40:43], 0 offen offset:1792 sc1
L_conv_noy:
    v_cvt_pk_bf16_f32 v10, v172, v173
    v_cvt_pk_bf16_f32 v11, v174, v175
    ds_write_b64 v8, v[10:11] offset:3584
    v_readlane_b32 s8, v108, 0
    v_readlane_b32 s9, v108, 8
    v_readlane_b32 s10, v108, 16
    v_readlane_b32 s11, v108, 24
    v_readlane_b32 s12, v108, 32
    v_readlane_b32 s13, v108, 40
    v_readlane_b32 s14, v108, 48
    v_readlane_b32 s15, v108, 56
    v_add_u32 v16, 1536, v0
    s_mov_b32 s54, 0x300000
    v_cmp_ne_u32 s[16:17], s8, v16
    v_cmp_ne_u32 s[18:19], s9, v16
    v_cmp_ne_u32 s[20:21], s10, v16
    v_cmp_ne_u32 s[22:23], s11, v16
    v_cmp_ne_u32 s[24:25], s12, v16
    v_cmp_ne_u32 s[26:27], s13, v16
    v_cmp_ne_u32 s[28:29], s14, v16
    v_cmp_ne_u32 s[30:31], s15, v16
    s_and_b64 s[16:17], s[16:17], s[18:19]
    s_and_b64 s[20:21], s[20:21], s[22:23]
    s_and_b64 s[24:25], s[24:25], s[26:27]
    s_and_b64 s[28:29], s[28:29], s[30:31]
    s_and_b64 s[16:17], s[16:17], s[20:21]
    s_and_b64 s[24:25], s[24:25], s[28:29]
    s_and_b64 s[16:17], s[16:17], s[24:25]
    s_waitcnt lgkmcnt(0)
    s_barrier
    ds_read_b64_tr_b16 v[12:13], v4 offset:3072
    ds_read_b64_tr_b16 v[14:15], v4 offset:19712
    s_cmp_eq_u32 s56, 0
    s_cbranch_scc1 L_conv_fin
    s_waitcnt lgkmcnt(0)
    s_mov_b64 exec, s[16:17]
    buffer_store_dwordx4 v[12:15], v5, s[44:47], s54 offen
    s_waitcnt vmcnt(1)
    s_barrier
    s_branch L_conv_end
L_conv_fin:
    v_and_b32 v16, 7, v1
    v_mul_u32_u24 v18, 4160, v16
    v_lshl_add_u32 v18, v108, 1, v18
    v_add_u32 v18, 129024, v18
    ds_read_u16 v20, v18
    v_lshlrev_b32 v18, 11, v108
    v_lshl_add_u32 v18, v16, 1, v18
    v_add_u32 v18, s58, v18
    v_lshlrev_b32 v17, 3, v17
    v_lshrrev_b32 v17, v17, s60
    v_mov_b32 v19, 0xff
    s_waitcnt lgkmcnt(1)
    s_mov_b64 exec, s[16:17]
    buffer_store_dwordx4 v[12:15], v5, s[44:47], s54 offen
    s_mov_b64 exec, -1
    s_mov_b32 s54, 0
    s_waitcnt vmcnt(1)
L_conv_y:
    v_bitop3_b32 v24, v112, v113, v17 bitop3:0x7e
    v_bitop3_b32 v25, v114, v115, v17 bitop3:0x7e
    v_bitop3_b32 v26, v116, v117, v17 bitop3:0x7e
    v_bitop3_b32 v27, v118, v119, v17 bitop3:0x7e
    v_or3_b32 v24, v24, v25, v26
    v_bitop3_b32 v24, v24, v27, v19 bitop3:0xa8
    v_cmp_ne_u32 vcc, 0, v24
    s_cbranch_vccz L_conv_yok
    s_add_u32 s54, s54, 1
    s_cmp_ge_u32 s54, 65536
    s_cbranch_scc1 L_conv_yok
    buffer_load_dword v112, v9, s[40:43], 0 offen offset:0 sc1
    buffer_load_dword v113, v9, s[40:43], 0 offen offset:256 sc1
    buffer_load_dword v114, v9, s[40:43], 0 offen offset:512 sc1
    buffer_load_dword v115, v9, s[40:43], 0 offen offset:768 sc1
    buffer_load_dword v116, v9, s[40:43], 0 offen offset:1024 sc1
    buffer_load_dword v117, v9, s[40:43], 0 offen offset:1280 sc1
    buffer_load_dword v118, v9, s[40:43], 0 offen offset:1536 sc1
    buffer_load_dword v119, v9, s[40:43], 0 offen offset:1792 sc1
    s_waitcnt vmcnt(0)
    s_branch L_conv_y
L_conv_yok:
    v_pk_add_f32 v[112:113], v[112:113], v[116:117]
    v_pk_add_f32 v[114:115], v[114:115], v[118:119]
    s_waitcnt lgkmcnt(0)
    v_lshlrev_b32 v20, 16, v20
    v_pk_add_f32 v[112:113], v[112:113], v[114:115]
    v_add_f32 v112, v112, v113
    v_fma_f32 v20, v112, v109, v20
    v_cvt_pk_bf16_f32 v20, v20, v20
    s_barrier
    buffer_store_short v20, v18, s[44:47], 0 offen
L_conv_end:
    s_endpgm
L_code_end:
.p2align 7
L_bands:
.long 0x0, 0x0, 0x0, 0x3f803f80
.long 0x0, 0x0, 0x0, 0x3f800000
.long 0x0, 0x0, 0x0, 0x0
.long 0x0, 0x0, 0x0, 0x0
.long 0x0, 0x0, 0x0, 0x0
.long 0x0, 0x0, 0x0, 0x0
.long 0x0, 0x0, 0x0, 0x0
.long 0x0, 0x0, 0x0, 0x0
.long 0x0, 0x0, 0x0, 0x0
.long 0x0, 0x0, 0x0, 0x0
.long 0x0, 0x0, 0x0, 0x0
.long 0x0, 0x0, 0x0, 0x0
.long 0x0, 0x0, 0x0, 0x0
.long 0x0, 0x0, 0x0, 0x0
.long 0x0, 0x0, 0x0, 0x0
.long 0x0, 0x0, 0x0, 0x0
.long 0x3f803f80, 0x3f80, 0x0, 0x0
.long 0x3f803f80, 0x3f803f80, 0x0, 0x0
.long 0x3f803f80, 0x3f803f80, 0x3f80, 0x0
.long 0x3f800000, 0x3f803f80, 0x3f803f80, 0x0
.long 0x0, 0x3f803f80, 0x3f803f80, 0x3f80
.long 0x0, 0x3f800000, 0x3f803f80, 0x3f803f80
.long 0x0, 0x0, 0x3f803f80, 0x3f803f80
.long 0x0, 0x0, 0x3f800000, 0x3f803f80
.long 0x0, 0x0, 0x0, 0x3f803f80
.long 0x0, 0x0, 0x0, 0x3f800000
.long 0x0, 0x0, 0x0, 0x0
.long 0x0, 0x0, 0x0, 0x0
.long 0x0, 0x0, 0x0, 0x0
.long 0x0, 0x0, 0x0, 0x0
.long 0x0, 0x0, 0x0, 0x0
.long 0x0, 0x0, 0x0, 0x0
.long 0x0, 0x0, 0x0, 0x0
.long 0x0, 0x0, 0x0, 0x0
.long 0x0, 0x0, 0x0, 0x0
.long 0x0, 0x0, 0x0, 0x0
.long 0x0, 0x0, 0x0, 0x0
.long 0x0, 0x0, 0x0, 0x0
.long 0x3f80, 0x0, 0x0, 0x0
.long 0x3f803f80, 0x0, 0x0, 0x0
.long 0x3f803f80, 0x3f80, 0x0, 0x0
.long 0x3f803f80, 0x3f803f80, 0x0, 0x0
.long 0x3f803f80, 0x3f803f80, 0x3f80, 0x0
.long 0x3f800000, 0x3f803f80, 0x3f803f80, 0x0
.long 0x0, 0x3f803f80, 0x3f803f80, 0x3f80
.long 0x0, 0x3f800000, 0x3f803f80, 0x3f803f80
.long 0x0, 0x0, 0x3f803f80, 0x3f803f80
.long 0x0, 0x0, 0x3f800000, 0x3f803f80
.long 0x0, 0x0, 0x0, 0x0
.long 0x0, 0x0, 0x0, 0x0
.long 0x0, 0x0, 0x0, 0x0
.long 0x0, 0x0, 0x0, 0x0
.long 0x0, 0x0, 0x0, 0x0
.long 0x0, 0x0, 0x0, 0x0
.long 0x0, 0x0, 0x0, 0x0
.long 0x0, 0x0, 0x0, 0x0
.long 0x0, 0x0, 0x0, 0x0
.long 0x0, 0x0, 0x0, 0x0
.long 0x0, 0x0, 0x0, 0x0
.long 0x0, 0x0, 0x0, 0x0
.long 0x0, 0x0, 0x0, 0x0
.long 0x0, 0x0, 0x0, 0x0
.long 0x3f80, 0x0, 0x0, 0x0
.long 0x3f803f80, 0x0, 0x0, 0x0
.long 0x0, 0x3f800000, 0x3f803f80, 0x0
.long 0x0, 0x0, 0x3f803f80, 0x3f80
.long 0x0, 0x0, 0x3f800000, 0x3f803f80
.long 0x0, 0x0, 0x0, 0x3f803f80
.long 0x0, 0x0, 0x0, 0x3f800000
.long 0x0, 0x0, 0x0, 0x0
.long 0x0, 0x0, 0x0, 0x0
.long 0x0, 0x0, 0x0, 0x0
.long 0x0, 0x0, 0x0, 0x0
.long 0x0, 0x0, 0x0, 0x0
.long 0x0, 0x0, 0x0, 0x0
.long 0x0, 0x0, 0x0, 0x0
.long 0x0, 0x0, 0x0, 0x0
.long 0x0, 0x0, 0x0, 0x0
.long 0x0, 0x0, 0x0, 0x0
.long 0x0, 0x0, 0x0, 0x0
.long 0x0, 0x0, 0x0, 0x0
.long 0x0, 0x0, 0x0, 0x0
.long 0x0, 0x0, 0x0, 0x0
.long 0x3f80, 0x0, 0x0, 0x0
.long 0x3f803f80, 0x0, 0x0, 0x0
.long 0x3f803f80, 0x3f80, 0x0, 0x0
.long 0x3f800000, 0x3f803f80, 0x0, 0x0
.long 0x0, 0x3f803f80, 0x3f80, 0x0
.long 0x0, 0x3f800000, 0x3f803f80, 0x0
.long 0x0, 0x0, 0x3f803f80, 0x3f80
.long 0x0, 0x0, 0x3f800000, 0x3f803f80
.long 0x0, 0x0, 0x0, 0x3f803f80
.long 0x0, 0x0, 0x0, 0x3f800000
.long 0x0, 0x0, 0x0, 0x0
.long 0x0, 0x0, 0x0, 0x0
.long 0x0, 0x0, 0x0, 0x0
.long 0x0, 0x0, 0x0, 0x0
.long 0x0, 0x0, 0x0, 0x0
.long 0x0, 0x0, 0x0, 0x0
.long 0x0, 0x0, 0x0, 0x0
.long 0x0, 0x0, 0x0, 0x0
.long 0x0, 0x0, 0x0, 0x0
.long 0x0, 0x0, 0x0, 0x0
.long 0x0, 0x0, 0x0, 0x0
.long 0x0, 0x0, 0x0, 0x0
.long 0x0, 0x0, 0x0, 0x0
.long 0x0, 0x0, 0x0, 0x0
.long 0x3f80, 0x0, 0x0, 0x0
.long 0x3f803f80, 0x0, 0x0, 0x0
.long 0x3f803f80, 0x3f80, 0x0, 0x0
.long 0x3f800000, 0x3f803f80, 0x0, 0x0
.long 0x0, 0x3f803f80, 0x3f80, 0x0
.long 0x0, 0x0, 0x0, 0x0
.long 0x0, 0x0, 0x0, 0x0
.long 0x0, 0x0, 0x0, 0x0
.long 0x0, 0x0, 0x0, 0x0
.long 0x0, 0x0, 0x0, 0x0
.long 0x0, 0x0, 0x0, 0x0
.long 0x0, 0x0, 0x0, 0x0
.long 0x0, 0x0, 0x0, 0x0
.long 0x0, 0x0, 0x0, 0x0
.long 0x0, 0x0, 0x0, 0x0
.long 0x0, 0x0, 0x0, 0x0
.long 0x0, 0x0, 0x0, 0x0
.long 0x0, 0x0, 0x0, 0x0
.long 0x0, 0x0, 0x0, 0x0
.long 0x0, 0x0, 0x0, 0x0
.long 0x0, 0x0, 0x0, 0x0
.long 0x0, 0x0, 0x3f803f80, 0x3f803f80
.long 0x0, 0x0, 0x3f800000, 0x3f803f80
.long 0x0, 0x0, 0x0, 0x3f803f80
.long 0x0, 0x0, 0x0, 0x3f800000
.long 0x0, 0x0, 0x0, 0x0
.long 0x0, 0x0, 0x0, 0x0
.long 0x0, 0x0, 0x0, 0x0
.long 0x0, 0x0, 0x0, 0x0
.long 0x0, 0x0, 0x0, 0x0
.long 0x0, 0x0, 0x0, 0x0
.long 0x0, 0x0, 0x0, 0x0
.long 0x0, 0x0, 0x0, 0x0
.long 0x0, 0x0, 0x0, 0x0
.long 0x0, 0x0, 0x0, 0x0
.long 0x0, 0x0, 0x0, 0x0
.long 0x0, 0x0, 0x0, 0x0
.long 0x3f803f80, 0x3f803f80, 0x3f80, 0x0
.long 0x3f803f80, 0x3f803f80, 0x3f803f80, 0x0
.long 0x3f803f80, 0x3f803f80, 0x3f803f80, 0x3f80
.long 0x3f803f80, 0x3f803f80, 0x3f803f80, 0x3f803f80
.long 0x3f803f80, 0x3f803f80, 0x3f803f80, 0x3f803f80
.long 0x3f800000, 0x3f803f80, 0x3f803f80, 0x3f803f80
.long 0x0, 0x3f803f80, 0x3f803f80, 0x3f803f80
.long 0x0, 0x3f800000, 0x3f803f80, 0x3f803f80
.long 0x0, 0x0, 0x3f803f80, 0x3f803f80
.long 0x0, 0x0, 0x3f800000, 0x3f803f80
.long 0x0, 0x0, 0x0, 0x3f803f80
.long 0x0, 0x0, 0x0, 0x3f800000
.long 0x0, 0x0, 0x0, 0x0
.long 0x0, 0x0, 0x0, 0x0
.long 0x0, 0x0, 0x0, 0x0
.long 0x0, 0x0, 0x0, 0x0
.long 0x0, 0x0, 0x0, 0x0
.long 0x0, 0x0, 0x0, 0x0
.long 0x0, 0x0, 0x0, 0x0
.long 0x0, 0x0, 0x0, 0x0
.long 0x3f80, 0x0, 0x0, 0x0
.long 0x3f803f80, 0x0, 0x0, 0x0
.long 0x3f803f80, 0x3f80, 0x0, 0x0
.long 0x3f803f80, 0x3f803f80, 0x0, 0x0
.long 0x3f803f80, 0x3f803f80, 0x3f80, 0x0
.long 0x3f803f80, 0x3f803f80, 0x3f803f80, 0x0
.long 0x3f803f80, 0x3f803f80, 0x3f803f80, 0x3f80
.long 0x3f803f80, 0x3f803f80, 0x3f803f80, 0x3f803f80
.long 0x3f803f80, 0x3f803f80, 0x3f803f80, 0x3f803f80
.long 0x3f800000, 0x3f803f80, 0x3f803f80, 0x3f803f80
.long 0x0, 0x3f803f80, 0x3f803f80, 0x3f803f80
.long 0x0, 0x3f800000, 0x3f803f80, 0x3f803f80
.long 0x0, 0x0, 0x0, 0x0
.long 0x0, 0x0, 0x0, 0x0
.long 0x0, 0x0, 0x0, 0x0
.long 0x0, 0x0, 0x0, 0x0
.long 0x0, 0x0, 0x0, 0x0
.long 0x0, 0x0, 0x0, 0x0
.long 0x0, 0x0, 0x0, 0x0
.long 0x0, 0x0, 0x0, 0x0
.long 0x0, 0x0, 0x0, 0x0
.long 0x0, 0x0, 0x0, 0x0
.long 0x0, 0x0, 0x0, 0x0
.long 0x0, 0x0, 0x0, 0x0
.long 0x3f80, 0x0, 0x0, 0x0
.long 0x3f803f80, 0x0, 0x0, 0x0
.long 0x3f803f80, 0x3f80, 0x0, 0x0
.long 0x3f803f80, 0x3f803f80, 0x0, 0x0
.long 0x0, 0x0, 0x3f800000, 0x3f803f80
.long 0x0, 0x0, 0x0, 0x3f803f80
.long 0x0, 0x0, 0x0, 0x3f800000
.long 0x0, 0x0, 0x0, 0x0
.long 0x0, 0x0, 0x0, 0x0
.long 0x0, 0x0, 0x0, 0x0
.long 0x0, 0x0, 0x0, 0x0
.long 0x0, 0x0, 0x0, 0x0
.long 0x0, 0x0, 0x0, 0x0
.long 0x0, 0x0, 0x0, 0x0
.long 0x0, 0x0, 0x0, 0x0
.long 0x0, 0x0, 0x0, 0x0
.long 0x0, 0x0, 0x0, 0x0
.long 0x0, 0x0, 0x0, 0x0
.long 0x0, 0x0, 0x0, 0x0
.long 0x0, 0x0, 0x0, 0x0
.long 0x3f803f80, 0x3f803f80, 0x0, 0x0
.long 0x3f803f80, 0x3f803f80, 0x3f80, 0x0
.long 0x3f803f80, 0x3f803f80, 0x3f803f80, 0x0
.long 0x3f803f80, 0x3f803f80, 0x3f803f80, 0x3f80
.long 0x3f800000, 0x3f803f80, 0x3f803f80, 0x3f803f80
.long 0x0, 0x3f803f80, 0x3f803f80, 0x3f803f80
.long 0x0, 0x3f800000, 0x3f803f80, 0x3f803f80
.long 0x0, 0x0, 0x3f803f80, 0x3f803f80
.long 0x0, 0x0, 0x3f800000, 0x3f803f80
.long 0x0, 0x0, 0x0, 0x3f803f80
.long 0x0, 0x0, 0x0, 0x3f800000
.long 0x0, 0x0, 0x0, 0x0
.long 0x0, 0x0, 0x0, 0x0
.long 0x0, 0x0, 0x0, 0x0
.long 0x0, 0x0, 0x0, 0x0
.long 0x0, 0x0, 0x0, 0x0
.long 0x0, 0x0, 0x0, 0x0
.long 0x0, 0x0, 0x0, 0x0
.long 0x0, 0x0, 0x0, 0x0
.long 0x0, 0x0, 0x0, 0x0
.long 0x0, 0x0, 0x0, 0x0
.long 0x3f80, 0x0, 0x0, 0x0
.long 0x3f803f80, 0x0, 0x0, 0x0
.long 0x3f803f80, 0x3f80, 0x0, 0x0
.long 0x3f803f80, 0x3f803f80, 0x0, 0x0
.long 0x3f803f80, 0x3f803f80, 0x3f80, 0x0
.long 0x3f803f80, 0x3f803f80, 0x3f803f80, 0x0
.long 0x3f803f80, 0x3f803f80, 0x3f803f80, 0x3f80
.long 0x3f800000, 0x3f803f80, 0x3f803f80, 0x3f803f80
.long 0x0, 0x3f803f80, 0x3f803f80, 0x3f803f80
.long 0x0, 0x3f800000, 0x3f803f80, 0x3f803f80
.long 0x0, 0x0, 0x3f803f80, 0x3f803f80
.long 0x0, 0x0, 0x0, 0x0
.long 0x0, 0x0, 0x0, 0x0
.long 0x0, 0x0, 0x0, 0x0
.long 0x0, 0x0, 0x0, 0x0
.long 0x0, 0x0, 0x0, 0x0
.long 0x0, 0x0, 0x0, 0x0
.long 0x0, 0x0, 0x0, 0x0
.long 0x0, 0x0, 0x0, 0x0
.long 0x0, 0x0, 0x0, 0x0
.long 0x0, 0x0, 0x0, 0x0
.long 0x0, 0x0, 0x0, 0x0
.long 0x0, 0x0, 0x0, 0x0
.long 0x0, 0x0, 0x0, 0x0
.long 0x3f80, 0x0, 0x0, 0x0
.long 0x3f803f80, 0x0, 0x0, 0x0
.long 0x3f803f80, 0x3f80, 0x0, 0x0
.long 0x0, 0x0, 0x0, 0x0
.long 0x0, 0x0, 0x0, 0x0
.long 0x0, 0x0, 0x0, 0x0
.long 0x0, 0x0, 0x0, 0x0
.long 0x0, 0x0, 0x0, 0x0
.long 0x0, 0x0, 0x0, 0x0
.long 0x0, 0x0, 0x0, 0x0
.long 0x0, 0x0, 0x0, 0x0
.long 0x0, 0x0, 0x0, 0x0
.long 0x0, 0x0, 0x0, 0x0
.long 0x0, 0x0, 0x0, 0x0
.long 0x0, 0x0, 0x0, 0x0
.long 0x0, 0x0, 0x0, 0x0
.long 0x0, 0x0, 0x0, 0x0
.long 0x0, 0x0, 0x0, 0x0
.long 0x0, 0x0, 0x0, 0x0
.long 0x0, 0x0, 0xffffffff, 0x0
.long 0x0, 0x0, 0xffff0000, 0xffff
.long 0x0, 0x0, 0x0, 0xffffffff
.long 0x0, 0x0, 0x0, 0xffff0000
.long 0x0, 0x0, 0x0, 0x0
.long 0x0, 0x0, 0x0, 0x0
.long 0x0, 0x0, 0x0, 0x0
.long 0x0, 0x0, 0x0, 0x0
.long 0x0, 0x0, 0x0, 0x0
.long 0x0, 0x0, 0x0, 0x0
.long 0x0, 0x0, 0x0, 0x0
.long 0x0, 0x0, 0x0, 0x0
.long 0x0, 0x0, 0x0, 0x0
.long 0x0, 0x0, 0x0, 0x0
.long 0x0, 0x0, 0x0, 0x0
.long 0x0, 0x0, 0x0, 0x0
.long 0x0, 0x0, 0x0, 0x0
.long 0x0, 0x0, 0x0, 0x0
.long 0x0, 0x0, 0x0, 0x0
.long 0xffff, 0x0, 0x0, 0x0
.long 0xffffffff, 0x0, 0x0, 0x0
.long 0xffff0000, 0xffff, 0x0, 0x0
.long 0x0, 0xffffffff, 0x0, 0x0
.long 0x0, 0xffff0000, 0xffff, 0x0
.long 0x0, 0x0, 0xffffffff, 0x0
.long 0x0, 0x0, 0xffff0000, 0xffff
.long 0x0, 0x0, 0x0, 0xffffffff
.long 0x0, 0x0, 0x0, 0xffff0000
.long 0x0, 0x0, 0x0, 0x0
.long 0x0, 0x0, 0x0, 0x0
.long 0x0, 0x0, 0x0, 0x0
.long 0x0, 0x0, 0x0, 0x0
.long 0x0, 0x0, 0x0, 0x0
.long 0x0, 0x0, 0x0, 0x0
.long 0x0, 0x0, 0x0, 0x0
.long 0x0, 0x0, 0x0, 0x0
.long 0x0, 0x0, 0x0, 0x0
.long 0x0, 0x0, 0x0, 0x0
.long 0x0, 0x0, 0x0, 0x0
.long 0x0, 0x0, 0x0, 0x0
.long 0x0, 0x0, 0x0, 0x0
.long 0x0, 0x0, 0x0, 0x0
.long 0x0, 0x0, 0x0, 0x0
.long 0xffff, 0x0, 0x0, 0x0
.long 0xffffffff, 0x0, 0x0, 0x0
.long 0xffff0000, 0xffff, 0x0, 0x0
.long 0x0, 0xffffffff, 0x0, 0x0
.long 0x0, 0xffff0000, 0xffff, 0x0
.section .rodata,"a"
.p2align 6
.amdhsa_kernel parallel_sum__ssm_conv_s4d__moe_arch_mod__prompt_kernel
  .amdhsa_next_free_vgpr 256
  .amdhsa_next_free_sgpr 96
  .amdhsa_accum_offset 256
  .amdhsa_group_segment_fixed_size 0
  .amdhsa_kernarg_size 120
  .amdhsa_user_sgpr_count 2
  .amdhsa_user_sgpr_kernarg_segment_ptr 1
  .amdhsa_system_sgpr_workgroup_id_x 1
.end_amdhsa_kernel
```
